```python
import torch

def _softmax(x, axis=-1):
    return torch.softmax(x, dim=axis)
def _gelu(x):
    return torch.nn.functional.gelu(x, approximate="tanh")
def _silu(x):
    return torch.nn.functional.silu(x)
def _sigmoid(x):
    return torch.sigmoid(x)
def _layernorm(x, axis=-1, eps=1e-5):
    m = x.mean(dim=axis, keepdim=True)
    v = x.var(dim=axis, keepdim=True, unbiased=False)
    return (x - m) / torch.sqrt(v + eps)
def _scatter_add(tgt, idx, src, axis=0):
    return tgt.clone().index_add_(axis, idx, src)
def _segment_sum(src, seg, n):
    out = torch.zeros((n,) + src.shape[1:], dtype=src.dtype)
    return out.index_add_(0, seg, src)
def _pad(x, pw):
    flat = tuple(v for pair in reversed(pw) for v in pair)
    return torch.nn.functional.pad(x, flat)

kernel_name = 'standalone__detection_seg_dino__vision'

def setup_inputs():

    _w = (lambda a: (lambda t: t.to(torch.bfloat16) if t.is_floating_point() else t)(torch.as_tensor(a)))
    H = W = (512 // 2) * 2
    C = 192
    Nq = 16
    sc = C ** -0.5
    return {
        "q": _w((lambda *s: torch.randn(*s, dtype=torch.bfloat16) * 0.2)(1, Nq, C)),
        "f0": _w((lambda *s: torch.randn(*s, dtype=torch.bfloat16) * 3.2)(1, H, W, C)),
        "f1": _w((lambda *s: torch.randn(*s, dtype=torch.bfloat16) * 3.2)(1, H // 2, W // 2, C)),
        "wq": _w((lambda *s: torch.randn(*s, dtype=torch.bfloat16) * 1.6)(C, C) * sc),
        "wk": _w((lambda *s: torch.randn(*s, dtype=torch.bfloat16) * 1.6)(C, C) * sc),
        "wv": _w((lambda *s: torch.randn(*s, dtype=torch.bfloat16) * 3.2)(C, C) * sc),
        "wo": _w((lambda *s: torch.randn(*s, dtype=torch.bfloat16) * 3.2)(C, C) * sc),
    }

def reference(q, f0, f1, wq, wk, wv, wo):
    B, H, W, C = f0.shape
    f1u = (lambda x, n, axis: torch.repeat_interleave(x, n, dim=axis))((lambda x, n, axis: torch.repeat_interleave(x, n, dim=axis))(f1, 2, axis=1), 2, axis=2)
    fused = f0 + f1u
    feats = _layernorm(fused.reshape(B, H * W, C), axis=-1)
    qn = _layernorm(q, axis=-1)
    Q = torch.einsum("bnc,cd->bnd", qn, wq)
    K = torch.einsum("bmc,cd->bmd", feats, wk)
    V = torch.einsum("bmc,cd->bmd", feats, wv)
    scale = C ** -0.5
    logits = torch.einsum("bnd,bmd->bnm", Q, K) * scale
    attn = _softmax(logits, axis=-1)
    ctx = torch.einsum("bnm,bmd->bnd", attn, V)
    return q + torch.einsum("bnd,dc->bnc", ctx, wo)
```

```asm
; @launch grid=(256,1,1) block=(512,1,1) lds=160768
.amdgcn_target "amdgcn-amd-amdhsa--gfx950"
.text
.globl standalone__detection_seg_dino__vision_kernel
.p2align 8
.type standalone__detection_seg_dino__vision_kernel,@function
standalone__detection_seg_dino__vision_kernel:
    s_cmp_ge_u32 s2, 0x100
    s_cbranch_scc1 L_exit
    s_load_dwordx16 s[4:19], s[0:1], 0
    s_load_dwordx4 s[20:23], s[0:1], 64
    v_lshrrev_b32 v1, 6, v0
    v_and_b32 v0, 63, v0
    v_readfirstlane_b32 s3, v1
    s_nop 2
    s_cmp_lt_u32 s3, 4
    s_cbranch_scc1 L_compute
    s_cmp_gt_u32 s3, 4
    s_cbranch_scc1 L_aux0
    s_setprio 3
    v_add_u32 v4, 0, v0
    v_mul_u32_u24 v4, 0xaab, v4
    v_lshrrev_b32 v4, 16, v4
    v_and_b32 v11, 6, v4
    v_xor_b32 v11, v11, v0
    v_lshlrev_b32 v1, 4, v11
    v_add_u32 v5, 64, v0
    v_mul_u32_u24 v5, 0xaab, v5
    v_lshrrev_b32 v5, 16, v5
    v_and_b32 v11, 6, v5
    v_xor_b32 v11, v11, v0
    v_lshlrev_b32 v2, 4, v11
    v_add_u32 v6, 0x80, v0
    v_mul_u32_u24 v6, 0xaab, v6
    v_lshrrev_b32 v6, 16, v6
    v_and_b32 v11, 6, v6
    v_xor_b32 v11, v11, v0
    v_lshlrev_b32 v3, 4, v11
    s_and_b32 s38, s2, 7
    s_lshl_b32 s38, s38, 5
    s_lshr_b32 s45, s2, 3
    s_or_b32 s38, s38, s45
    s_lshl_b32 s38, s38, 2
    s_mov_b32 s27, 0x20000
    s_mov_b32 s26, 0x1800000
    s_mul_i32 s39, s38, 0x1800
    s_mov_b32 s44, 0x3400
    s_cmp_lt_u32 s2, 6
    s_cbranch_scc1 L_ld_prod
    s_waitcnt lgkmcnt(0)
    s_mov_b32 s24, s8
    s_mov_b32 s25, s9
L_ld_first:
    s_mov_b32 m0, s44
    s_add_u32 s46, s39, 0xc00
    buffer_load_dwordx4 v1, s[24:27], s39 offen nt lds
    buffer_load_dwordx4 v2, s[24:27], s39 offen offset:1024 nt lds
    buffer_load_dwordx4 v3, s[24:27], s39 offen offset:2048 nt lds
    s_add_u32 m0, s44, 0xc00
    s_add_u32 s44, s44, 0x9000
    buffer_load_dwordx4 v1, s[24:27], s46 offen nt lds
    buffer_load_dwordx4 v2, s[24:27], s46 offen offset:1024 nt lds
    buffer_load_dwordx4 v3, s[24:27], s46 offen offset:2048 nt lds
    s_add_u32 s39, s39, 0x1800
    s_cmp_lt_u32 s44, 0x27400
    s_cbranch_scc1 L_ld_first
    s_branch L_ld_norm
L_aux0:
    s_getpc_b64 s[24:25]
L_aux_pc:
    s_sub_u32 s24, s24, L_aux_pc-standalone__detection_seg_dino__vision_kernel
    s_subb_u32 s25, s25, 0
    s_mov_b32 s26, L_code_end-standalone__detection_seg_dino__vision_kernel
    s_mov_b32 s27, 0x20000
    s_lshr_b32 s39, s2, 3
    s_mul_i32 s38, s39, 3
    s_add_u32 s38, s38, s3
    s_mul_i32 s38, s38, 0x140
    s_sub_u32 s38, s38, 0x640
    v_lshlrev_b32 v14, 6, v0
    s_mov_b64 exec, 31
    buffer_load_dword v253, v14, s[24:27], s38 offen
    s_mov_b64 exec, -1
    s_and_b32 s38, s2, 7
    s_mul_i32 s37, s3, 3
    s_add_u32 s38, s38, 18
    s_sub_u32 s38, s38, s37
    s_cmp_ge_u32 s38, 3
    s_cbranch_scc1 L_aux
    s_mul_i32 s37, s39, 0x900
    v_mul_u32_u24 v13, 36, v0
    s_mov_b32 s30, 0x12000
    s_mov_b32 s42, 0x12000
    s_mov_b32 s31, s27
    s_mov_b32 s43, s27
    s_cmp_eq_u32 s3, 6
    s_waitcnt lgkmcnt(0)
    s_cselect_b64 s[28:29], s[10:11], s[16:17]
    s_cselect_b64 s[40:41], s[12:13], s[14:15]
    buffer_load_dword v254, v13, s[28:31], s37 offen
    buffer_load_dword v255, v13, s[40:43], s37 offen
    s_branch L_aux
L_ld_prod:
    s_mov_b32 s39, 0
    s_cmp_lt_u32 s2, 3
    s_cbranch_scc0 L_ld_wo0
    s_mov_b32 s26, 0x1800
    s_mov_b32 s44, 0x1c00
    s_mov_b32 s48, 1
    s_waitcnt lgkmcnt(0)
    s_mov_b64 s[24:25], s[4:5]
    s_call_b64 s[54:55], L_ld_tiles
    s_branch L_ld_wq
L_ld_tiles:
    s_mov_b32 m0, s44
    s_add_u32 s46, s39, 0xc00
    buffer_load_dwordx4 v1, s[24:27], s39 offen lds
    buffer_load_dwordx4 v2, s[24:27], s39 offen offset:1024 lds
    buffer_load_dwordx4 v3, s[24:27], s39 offen offset:2048 lds
    s_add_u32 m0, s44, 0xc00
    s_add_u32 s44, s44, 0x1800
    buffer_load_dwordx4 v1, s[24:27], s46 offen lds
    buffer_load_dwordx4 v2, s[24:27], s46 offen offset:1024 lds
    buffer_load_dwordx4 v3, s[24:27], s46 offen offset:2048 lds
    s_add_u32 s39, s39, 0x1800
    s_sub_u32 s48, s48, 1
    s_and_b32 s45, s48, 3
    s_cselect_b32 s45, 0, 0x3000
    s_add_u32 s44, s44, s45
    s_cmp_lg_u32 s48, 0
    s_cbranch_scc1 L_ld_tiles
    s_setpc_b64 s[54:55]
L_ld_wq:
    s_mov_b64 s[24:25], s[10:11]
    s_mov_b32 s26, 0x12000
L_ld_w12:
    s_mov_b32 s39, 0
    s_mov_b32 s44, 0x6400
    s_mov_b32 s48, 4
    s_call_b64 s[54:55], L_ld_tiles
    v_mul_u32_u24 v4, 0x180, v4
    v_add_u32 v4, v4, v1
    v_mul_u32_u24 v5, 0x180, v5
    v_add_u32 v5, v5, v2
    v_mul_u32_u24 v6, 0x180, v6
    v_add_u32 v6, v6, v3
    v_mov_b32 v10, 0
    v_lshlrev_b32 v13, 2, v0
    s_mov_b64 exec, 0xffffffff
    ds_write_b32 v13, v10 offset:6912
    v_mov_b32 v11, 0x3f803f80
    s_mov_b64 exec, 3
    ds_write_b32 v13, v11 offset:7056
    s_mov_b64 exec, -1
    s_mov_b32 s50, 0
    s_mov_b32 s51, 0
    s_mov_b32 s52, 0
    s_mov_b32 s53, 0
    s_mov_b32 s36, 0
    s_mov_b32 s37, 0
    s_mov_b32 s57, 0
    s_waitcnt lgkmcnt(0)
    s_barrier
    s_waitcnt vmcnt(24)
    v_mov_b32 v11, 1
    s_mov_b64 exec, 1
    ds_max_u32 v10, v11 offset:6956
    s_mov_b64 exec, -1
    s_mov_b32 s48, 8
    s_call_b64 s[54:55], L_ld_tiles
    s_cmp_ge_u32 s2, 3
    s_cbranch_scc1 L_ld_stepp
    s_mov_b64 s[24:25], s[12:13]
    s_mul_i32 s39, s2, 0x6000
    s_mov_b32 s48, 4
    s_call_b64 s[54:55], L_ld_tiles
    s_branch L_ld_stepp
L_ld_wo0:
    s_mov_b32 s26, 0x12000
    v_lshrrev_b32 v11, 3, v0
    v_mul_u32_u24 v11, 0x180, v11
    v_and_b32 v12, 7, v0
    v_lshl_add_u32 v11, v12, 4, v11
    s_sub_u32 s46, s2, 3
    s_lshl_b32 s46, s46, 7
    s_mov_b32 s45, 0x21400
    s_waitcnt lgkmcnt(0)
    s_mov_b64 s[24:25], s[16:17]
L_ld_wo:
    s_mov_b32 m0, s45
    s_add_u32 s45, s45, 0x400
    buffer_load_dwordx4 v11, s[24:27], s46 offen lds
    s_add_u32 s46, s46, 0xc00
    s_cmp_lt_u32 s45, 0x27400
    s_cbranch_scc1 L_ld_wo
    s_mov_b64 s[24:25], s[14:15]
    s_branch L_ld_w12
L_ld_norm:
    v_mul_u32_u24 v4, 0x180, v4
    v_add_u32 v4, v4, v1
    v_mul_u32_u24 v5, 0x180, v5
    v_add_u32 v5, v5, v2
    v_mul_u32_u24 v6, 0x180, v6
    v_add_u32 v6, v6, v3
    v_mov_b32 v10, 0
    v_lshlrev_b32 v13, 2, v0
    s_mov_b64 exec, 0xffffffff
    ds_write_b32 v13, v10 offset:6912
    v_mov_b32 v11, 0x3f803f80
    s_mov_b64 exec, 3
    ds_write_b32 v13, v11 offset:7056
    s_mov_b64 exec, -1
    s_mov_b32 s50, 0
    s_mov_b32 s51, 0
    s_mov_b32 s52, 0
    s_mov_b32 s53, 0
    s_mov_b32 s36, 1
    s_mov_b32 s37, 1
    s_mov_b32 s57, 1
    s_lshr_b32 s45, s38, 4
    s_mul_i32 s40, s45, 0x60000
    s_and_b32 s45, s38, 15
    s_mul_i32 s45, s45, 0x3000
    s_add_u32 s40, s40, s45
    s_add_u32 s38, s38, 0x400
    s_waitcnt lgkmcnt(0)
    s_barrier
L_ld_step:
    s_cmp_lg_u32 s37, 0
    s_cbranch_scc1 L_ld_fine
    s_mul_i32 s39, s38, 0x1800
    s_lshr_b32 s45, s38, 4
    s_mul_i32 s40, s45, 0x60000
    s_and_b32 s45, s38, 15
    s_mul_i32 s45, s45, 0x3000
    s_add_u32 s40, s40, s45
    s_add_u32 s38, s38, 0x400
    s_mov_b32 s24, s8
    s_mov_b32 s25, s9
    s_mov_b32 s26, 0x1800000
    s_mov_b32 s41, s39
    s_mov_b32 s42, 0x1800
    s_mov_b32 s43, 0xc00
    v_mov_b32 v7, v1
    v_mov_b32 v8, v2
    v_mov_b32 v9, v3
    s_branch L_ld_issue
L_ld_fine:
    s_mov_b32 s24, s6
    s_mov_b32 s25, s7
    s_mov_b32 s26, 0x6000000
    s_sub_u32 s45, s37, 1
    s_lshr_b32 s46, s45, 1
    s_mul_i32 s46, s46, 0x30000
    s_and_b32 s45, s45, 1
    s_mul_i32 s45, s45, 0x180
    s_add_u32 s41, s40, s46
    s_add_u32 s41, s41, s45
    s_mov_b32 s42, 0x3000
    s_mov_b32 s43, 0x1800
    v_mov_b32 v7, v4
    v_mov_b32 v8, v5
    v_mov_b32 v9, v6
L_ld_issue:
    s_mul_i32 s44, s57, 0x1800
    s_add_u32 s44, s44, 0x3400
    s_sub_i32 s48, s36, 5
    s_cmp_ge_i32 s50, s48
    s_cbranch_scc1 L_free1
    s_mov_b32 s56, 0
    s_call_b64 s[54:55], L_ld_wait
    s_mov_b32 s50, s45
L_free1:
    s_add_u32 m0, s44, 0
    s_mov_b32 s46, s41
    buffer_load_dwordx4 v7, s[24:27], s46 offen nt lds
    buffer_load_dwordx4 v8, s[24:27], s46 offen offset:1024 nt lds
    buffer_load_dwordx4 v9, s[24:27], s46 offen offset:2048 nt lds
    s_add_u32 m0, s44, 0xc00
    s_add_u32 s46, s41, s43
    buffer_load_dwordx4 v7, s[24:27], s46 offen nt lds
    buffer_load_dwordx4 v8, s[24:27], s46 offen offset:1024 nt lds
    buffer_load_dwordx4 v9, s[24:27], s46 offen offset:2048 nt lds
    s_add_u32 s41, s41, s42
    s_add_i32 s47, s36, 0
    s_max_i32 s47, s47, 0
    s_waitcnt vmcnt(24)
    v_mov_b32 v11, s47
    s_mov_b64 exec, 1
    ds_max_u32 v10, v11 offset:6912
    s_mov_b64 exec, -1
    s_cmp_ge_i32 s51, s48
    s_cbranch_scc1 L_free2
    s_mov_b32 s56, 1
    s_call_b64 s[54:55], L_ld_wait
    s_mov_b32 s51, s45
L_free2:
    s_add_u32 m0, s44, 0x9000
    s_mov_b32 s46, s41
    buffer_load_dwordx4 v7, s[24:27], s46 offen nt lds
    buffer_load_dwordx4 v8, s[24:27], s46 offen offset:1024 nt lds
    buffer_load_dwordx4 v9, s[24:27], s46 offen offset:2048 nt lds
    s_add_u32 m0, s44, 0x9c00
    s_add_u32 s46, s41, s43
    buffer_load_dwordx4 v7, s[24:27], s46 offen nt lds
    buffer_load_dwordx4 v8, s[24:27], s46 offen offset:1024 nt lds
    buffer_load_dwordx4 v9, s[24:27], s46 offen offset:2048 nt lds
    s_add_u32 s41, s41, s42
    s_add_i32 s47, s36, 0
    s_max_i32 s47, s47, 0
    s_waitcnt vmcnt(24)
    v_mov_b32 v11, s47
    s_mov_b64 exec, 1
    ds_max_u32 v10, v11 offset:6916
    s_mov_b64 exec, -1
    s_cmp_ge_i32 s52, s48
    s_cbranch_scc1 L_free3
    s_mov_b32 s56, 2
    s_call_b64 s[54:55], L_ld_wait
    s_mov_b32 s52, s45
L_free3:
    s_add_u32 m0, s44, 0x12000
    s_mov_b32 s46, s41
    buffer_load_dwordx4 v7, s[24:27], s46 offen nt lds
    buffer_load_dwordx4 v8, s[24:27], s46 offen offset:1024 nt lds
    buffer_load_dwordx4 v9, s[24:27], s46 offen offset:2048 nt lds
    s_add_u32 m0, s44, 0x12c00
    s_add_u32 s46, s41, s43
    buffer_load_dwordx4 v7, s[24:27], s46 offen nt lds
    buffer_load_dwordx4 v8, s[24:27], s46 offen offset:1024 nt lds
    buffer_load_dwordx4 v9, s[24:27], s46 offen offset:2048 nt lds
    s_add_u32 s41, s41, s42
    s_add_i32 s47, s36, 0
    s_max_i32 s47, s47, 0
    s_waitcnt vmcnt(24)
    v_mov_b32 v11, s47
    s_mov_b64 exec, 1
    ds_max_u32 v10, v11 offset:6920
    s_mov_b64 exec, -1
    s_cmp_ge_i32 s53, s48
    s_cbranch_scc1 L_free4
    s_mov_b32 s56, 3
    s_call_b64 s[54:55], L_ld_wait
    s_mov_b32 s53, s45
L_free4:
    s_add_u32 m0, s44, 0x1b000
    s_mov_b32 s46, s41
    buffer_load_dwordx4 v7, s[24:27], s46 offen nt lds
    buffer_load_dwordx4 v8, s[24:27], s46 offen offset:1024 nt lds
    buffer_load_dwordx4 v9, s[24:27], s46 offen offset:2048 nt lds
    s_add_u32 m0, s44, 0x1bc00
    s_add_u32 s46, s41, s43
    buffer_load_dwordx4 v7, s[24:27], s46 offen nt lds
    buffer_load_dwordx4 v8, s[24:27], s46 offen offset:1024 nt lds
    buffer_load_dwordx4 v9, s[24:27], s46 offen offset:2048 nt lds
    s_add_u32 s41, s41, s42
    s_add_i32 s47, s36, 0
    s_max_i32 s47, s47, 0
    s_waitcnt vmcnt(24)
    v_mov_b32 v11, s47
    s_mov_b64 exec, 1
    ds_max_u32 v10, v11 offset:6924
    s_mov_b64 exec, -1
    s_add_u32 s37, s37, 1
    s_cmp_eq_u32 s37, 5
    s_cselect_b32 s37, 0, s37
    s_add_u32 s57, s57, 1
    s_cmp_eq_u32 s57, 6
    s_cselect_b32 s57, 0, s57
    s_add_u32 s36, s36, 1
    s_cmp_lt_u32 s36, 20
    s_cbranch_scc1 L_ld_step
    s_mov_b32 s32, s22
    s_mov_b32 s33, s23
    s_mov_b32 s34, 0x1000000
    s_mov_b32 s35, 0x20000
    v_lshlrev_b32 v12, 4, v0
    s_nop 1
L_spin5:
    ds_read_b32 v11, v10 offset:6976
    s_waitcnt lgkmcnt(0)
    v_readfirstlane_b32 s45, v11
    s_nop 0
    s_cmp_ge_u32 s45, 1
    s_cbranch_scc1 L_spun6
    s_sleep 1
    s_branch L_spin5
L_spun6:
    s_mov_b32 s46, 0x54d800
    buffer_load_dwordx4 v[112:115], v12, s[32:35], s46 offen sc1
    s_mov_b32 s46, 0x54dc00
    buffer_load_dwordx4 v[124:127], v12, s[32:35], s46 offen sc1
    s_mov_b32 s46, 0x54e000
    buffer_load_dwordx4 v[136:139], v12, s[32:35], s46 offen sc1
    s_mov_b32 s46, 0x54e400
    buffer_load_dwordx4 v[148:151], v12, s[32:35], s46 offen sc1
    s_mov_b32 s46, 0x54e800
    buffer_load_dwordx4 v[160:163], v12, s[32:35], s46 offen sc1
    s_mov_b32 s46, 0x54ec00
    buffer_load_dwordx4 v[172:175], v12, s[32:35], s46 offen sc1
    s_mov_b32 s46, 0x54f000
    buffer_load_dwordx4 v[116:119], v12, s[32:35], s46 offen sc1
    s_mov_b32 s46, 0x54f400
    buffer_load_dwordx4 v[128:131], v12, s[32:35], s46 offen sc1
    s_mov_b32 s46, 0x54f800
    buffer_load_dwordx4 v[140:143], v12, s[32:35], s46 offen sc1
    s_mov_b32 s46, 0x54fc00
    buffer_load_dwordx4 v[152:155], v12, s[32:35], s46 offen sc1
    s_mov_b32 s46, 0x550000
    buffer_load_dwordx4 v[164:167], v12, s[32:35], s46 offen sc1
    s_mov_b32 s46, 0x550400
    buffer_load_dwordx4 v[176:179], v12, s[32:35], s46 offen sc1
    s_mov_b32 s46, 0x550800
    buffer_load_dwordx4 v[120:123], v12, s[32:35], s46 offen sc1
    s_mov_b32 s46, 0x550c00
    buffer_load_dwordx4 v[132:135], v12, s[32:35], s46 offen sc1
    s_mov_b32 s46, 0x551000
    buffer_load_dwordx4 v[144:147], v12, s[32:35], s46 offen sc1
    s_mov_b32 s46, 0x551400
    buffer_load_dwordx4 v[156:159], v12, s[32:35], s46 offen sc1
    s_mov_b32 s46, 0x551800
    buffer_load_dwordx4 v[168:171], v12, s[32:35], s46 offen sc1
    s_mov_b32 s46, 0x551c00
    buffer_load_dwordx4 v[180:183], v12, s[32:35], s46 offen sc1
    s_waitcnt vmcnt(36)
    v_mov_b32 v11, 20
    s_mov_b64 exec, 1
    ds_max_u32 v10, v11 offset:6912
    s_mov_b64 exec, -1
    s_waitcnt vmcnt(30)
    v_mov_b32 v11, 20
    s_mov_b64 exec, 1
    ds_max_u32 v10, v11 offset:6916
    s_mov_b64 exec, -1
    s_waitcnt vmcnt(24)
    v_mov_b32 v11, 20
    s_mov_b64 exec, 1
    ds_max_u32 v10, v11 offset:6920
    s_mov_b64 exec, -1
    s_waitcnt vmcnt(18)
    v_mov_b32 v11, 20
    s_mov_b64 exec, 1
    ds_max_u32 v10, v11 offset:6924
    s_mov_b64 exec, -1
    s_setprio 0
    s_mov_b32 s36, 3
    v_mov_b32 v11, 0
    v_and_b32 v1, 15, v0
    s_nop 1
    s_branch L_tail
L_ld_stepp:
    s_cmp_lg_u32 s37, 0
    s_cbranch_scc1 L_ld_finep
    s_mul_i32 s39, s38, 0x1800
    s_lshr_b32 s45, s38, 4
    s_mul_i32 s40, s45, 0x60000
    s_and_b32 s45, s38, 15
    s_mul_i32 s45, s45, 0x3000
    s_add_u32 s40, s40, s45
    s_add_u32 s38, s38, 0x400
    s_mov_b32 s24, s8
    s_mov_b32 s25, s9
    s_mov_b32 s26, 0x1800000
    s_mov_b32 s41, s39
    s_mov_b32 s42, 0x1800
    s_mov_b32 s43, 0xc00
    v_mov_b32 v7, v1
    v_mov_b32 v8, v2
    v_mov_b32 v9, v3
    s_branch L_ld_issuep
L_ld_finep:
    s_mov_b32 s24, s6
    s_mov_b32 s25, s7
    s_mov_b32 s26, 0x6000000
    s_sub_u32 s45, s37, 1
    s_lshr_b32 s46, s45, 1
    s_mul_i32 s46, s46, 0x30000
    s_and_b32 s45, s45, 1
    s_mul_i32 s45, s45, 0x180
    s_add_u32 s41, s40, s46
    s_add_u32 s41, s41, s45
    s_mov_b32 s42, 0x3000
    s_mov_b32 s43, 0x1800
    v_mov_b32 v7, v4
    v_mov_b32 v8, v5
    v_mov_b32 v9, v6
L_ld_issuep:
    s_mul_i32 s44, s57, 0x1800
    s_add_u32 s44, s44, 0x3400
    s_sub_i32 s48, s36, 5
    s_cmp_ge_i32 s50, s48
    s_cbranch_scc1 L_free7
    s_mov_b32 s56, 0
    s_call_b64 s[54:55], L_ld_wait
    s_mov_b32 s50, s45
L_free7:
    s_add_u32 m0, s44, 0
    s_mov_b32 s46, s41
    buffer_load_dwordx4 v7, s[24:27], s46 offen nt lds
    buffer_load_dwordx4 v8, s[24:27], s46 offen offset:1024 nt lds
    buffer_load_dwordx4 v9, s[24:27], s46 offen offset:2048 nt lds
    s_add_u32 m0, s44, 0xc00
    s_add_u32 s46, s41, s43
    buffer_load_dwordx4 v7, s[24:27], s46 offen nt lds
    buffer_load_dwordx4 v8, s[24:27], s46 offen offset:1024 nt lds
    buffer_load_dwordx4 v9, s[24:27], s46 offen offset:2048 nt lds
    s_add_u32 s41, s41, s42
    s_add_i32 s47, s36, -1
    s_max_i32 s47, s47, 0
    s_waitcnt vmcnt(36)
    v_mov_b32 v11, s47
    s_mov_b64 exec, 1
    ds_max_u32 v10, v11 offset:6920
    s_mov_b64 exec, -1
    s_cmp_ge_i32 s51, s48
    s_cbranch_scc1 L_free8
    s_mov_b32 s56, 1
    s_call_b64 s[54:55], L_ld_wait
    s_mov_b32 s51, s45
L_free8:
    s_add_u32 m0, s44, 0x9000
    s_mov_b32 s46, s41
    buffer_load_dwordx4 v7, s[24:27], s46 offen nt lds
    buffer_load_dwordx4 v8, s[24:27], s46 offen offset:1024 nt lds
    buffer_load_dwordx4 v9, s[24:27], s46 offen offset:2048 nt lds
    s_add_u32 m0, s44, 0x9c00
    s_add_u32 s46, s41, s43
    buffer_load_dwordx4 v7, s[24:27], s46 offen nt lds
    buffer_load_dwordx4 v8, s[24:27], s46 offen offset:1024 nt lds
    buffer_load_dwordx4 v9, s[24:27], s46 offen offset:2048 nt lds
    s_add_u32 s41, s41, s42
    s_add_i32 s47, s36, -1
    s_max_i32 s47, s47, 0
    s_waitcnt vmcnt(36)
    v_mov_b32 v11, s47
    s_mov_b64 exec, 1
    ds_max_u32 v10, v11 offset:6924
    s_mov_b64 exec, -1
    s_add_u32 s47, s36, 2
    s_min_u32 s47, s47, 3
    v_mov_b32 v11, s47
    s_mov_b64 exec, 1
    ds_max_u32 v10, v11 offset:6956
    s_mov_b64 exec, -1
    s_cmp_ge_i32 s52, s48
    s_cbranch_scc1 L_free9
    s_mov_b32 s56, 2
    s_call_b64 s[54:55], L_ld_wait
    s_mov_b32 s52, s45
L_free9:
    s_add_u32 m0, s44, 0x12000
    s_mov_b32 s46, s41
    buffer_load_dwordx4 v7, s[24:27], s46 offen nt lds
    buffer_load_dwordx4 v8, s[24:27], s46 offen offset:1024 nt lds
    buffer_load_dwordx4 v9, s[24:27], s46 offen offset:2048 nt lds
    s_add_u32 m0, s44, 0x12c00
    s_add_u32 s46, s41, s43
    buffer_load_dwordx4 v7, s[24:27], s46 offen nt lds
    buffer_load_dwordx4 v8, s[24:27], s46 offen offset:1024 nt lds
    buffer_load_dwordx4 v9, s[24:27], s46 offen offset:2048 nt lds
    s_add_u32 s41, s41, s42
    s_add_i32 s47, s36, 0
    s_max_i32 s47, s47, 0
    s_waitcnt vmcnt(36)
    v_mov_b32 v11, s47
    s_mov_b64 exec, 1
    ds_max_u32 v10, v11 offset:6912
    s_mov_b64 exec, -1
    s_cmp_ge_i32 s53, s48
    s_cbranch_scc1 L_free10
    s_mov_b32 s56, 3
    s_call_b64 s[54:55], L_ld_wait
    s_mov_b32 s53, s45
L_free10:
    s_add_u32 m0, s44, 0x1b000
    s_mov_b32 s46, s41
    buffer_load_dwordx4 v7, s[24:27], s46 offen nt lds
    buffer_load_dwordx4 v8, s[24:27], s46 offen offset:1024 nt lds
    buffer_load_dwordx4 v9, s[24:27], s46 offen offset:2048 nt lds
    s_add_u32 m0, s44, 0x1bc00
    s_add_u32 s46, s41, s43
    buffer_load_dwordx4 v7, s[24:27], s46 offen nt lds
    buffer_load_dwordx4 v8, s[24:27], s46 offen offset:1024 nt lds
    buffer_load_dwordx4 v9, s[24:27], s46 offen offset:2048 nt lds
    s_add_u32 s41, s41, s42
    s_add_i32 s47, s36, 0
    s_max_i32 s47, s47, 0
    s_waitcnt vmcnt(36)
    v_mov_b32 v11, s47
    s_mov_b64 exec, 1
    ds_max_u32 v10, v11 offset:6916
    s_mov_b64 exec, -1
    s_add_u32 s37, s37, 1
    s_cmp_eq_u32 s37, 5
    s_cselect_b32 s37, 0, s37
    s_add_u32 s57, s57, 1
    s_cmp_eq_u32 s57, 6
    s_cselect_b32 s57, 0, s57
    s_cmp_lg_u32 s36, 1
    s_cbranch_scc1 L_ld_noiss
L_spin11:
    ds_read_b32 v11, v10 offset:6952
    s_waitcnt lgkmcnt(0)
    v_readfirstlane_b32 s45, v11
    s_nop 0
    s_cmp_ge_u32 s45, 4
    s_cbranch_scc1 L_spun12
    s_sleep 1
    s_branch L_spin11
L_spun12:
L_ld_noiss:
    s_add_u32 s36, s36, 1
    s_cmp_lt_u32 s36, 20
    s_nop 3
    s_cbranch_scc1 L_ld_stepp
    s_mov_b32 s32, s22
    s_mov_b32 s33, s23
    s_mov_b32 s34, 0x1000000
    s_mov_b32 s35, 0x20000
    v_lshlrev_b32 v12, 4, v0
    s_nop 1
L_spin13:
    ds_read_b32 v11, v10 offset:6976
    s_waitcnt lgkmcnt(0)
    v_readfirstlane_b32 s45, v11
    s_nop 0
    s_cmp_ge_u32 s45, 1
    s_cbranch_scc1 L_spun14
    s_sleep 1
    s_branch L_spin13
L_spun14:
    s_mov_b32 s46, 0x54d800
    buffer_load_dwordx4 v[112:115], v12, s[32:35], s46 offen sc1
    s_mov_b32 s46, 0x54dc00
    buffer_load_dwordx4 v[124:127], v12, s[32:35], s46 offen sc1
    s_mov_b32 s46, 0x54e000
    buffer_load_dwordx4 v[136:139], v12, s[32:35], s46 offen sc1
    s_mov_b32 s46, 0x54e400
    buffer_load_dwordx4 v[148:151], v12, s[32:35], s46 offen sc1
    s_mov_b32 s46, 0x54e800
    buffer_load_dwordx4 v[160:163], v12, s[32:35], s46 offen sc1
    s_mov_b32 s46, 0x54ec00
    buffer_load_dwordx4 v[172:175], v12, s[32:35], s46 offen sc1
    s_mov_b32 s46, 0x54f000
    buffer_load_dwordx4 v[116:119], v12, s[32:35], s46 offen sc1
    s_mov_b32 s46, 0x54f400
    buffer_load_dwordx4 v[128:131], v12, s[32:35], s46 offen sc1
    s_mov_b32 s46, 0x54f800
    buffer_load_dwordx4 v[140:143], v12, s[32:35], s46 offen sc1
    s_mov_b32 s46, 0x54fc00
    buffer_load_dwordx4 v[152:155], v12, s[32:35], s46 offen sc1
    s_mov_b32 s46, 0x550000
    buffer_load_dwordx4 v[164:167], v12, s[32:35], s46 offen sc1
    s_mov_b32 s46, 0x550400
    buffer_load_dwordx4 v[176:179], v12, s[32:35], s46 offen sc1
    s_mov_b32 s46, 0x550800
    buffer_load_dwordx4 v[120:123], v12, s[32:35], s46 offen sc1
    s_mov_b32 s46, 0x550c00
    buffer_load_dwordx4 v[132:135], v12, s[32:35], s46 offen sc1
    s_mov_b32 s46, 0x551000
    buffer_load_dwordx4 v[144:147], v12, s[32:35], s46 offen sc1
    s_mov_b32 s46, 0x551400
    buffer_load_dwordx4 v[156:159], v12, s[32:35], s46 offen sc1
    s_mov_b32 s46, 0x551800
    buffer_load_dwordx4 v[168:171], v12, s[32:35], s46 offen sc1
    s_mov_b32 s46, 0x551c00
    buffer_load_dwordx4 v[180:183], v12, s[32:35], s46 offen sc1
    s_waitcnt vmcnt(48)
    v_mov_b32 v11, 19
    s_mov_b64 exec, 1
    ds_max_u32 v10, v11 offset:6920
    s_mov_b64 exec, -1
    s_waitcnt vmcnt(42)
    v_mov_b32 v11, 19
    s_mov_b64 exec, 1
    ds_max_u32 v10, v11 offset:6924
    s_mov_b64 exec, -1
    s_waitcnt vmcnt(36)
    v_mov_b32 v11, 20
    s_mov_b64 exec, 1
    ds_max_u32 v10, v11 offset:6912
    s_mov_b64 exec, -1
    s_waitcnt vmcnt(30)
    v_mov_b32 v11, 20
    s_mov_b64 exec, 1
    ds_max_u32 v10, v11 offset:6916
    s_mov_b64 exec, -1
    s_waitcnt vmcnt(24)
    v_mov_b32 v11, 20
    s_mov_b64 exec, 1
    ds_max_u32 v10, v11 offset:6920
    s_mov_b64 exec, -1
    s_waitcnt vmcnt(18)
    v_mov_b32 v11, 20
    s_mov_b64 exec, 1
    ds_max_u32 v10, v11 offset:6924
    s_mov_b64 exec, -1
    s_setprio 0
    s_mov_b32 s36, 3
    v_mov_b32 v11, 0
    v_and_b32 v1, 15, v0
    s_nop 1
    s_branch L_tail
L_ld_wait:
    s_lshl_b32 s45, s56, 2
    v_mov_b32 v12, s45
    ds_read_b32 v11, v12 offset:6928
    s_waitcnt lgkmcnt(0)
    v_readfirstlane_b32 s45, v11
    s_nop 0
    s_cmp_ge_i32 s45, s48
    s_cbranch_scc1 L_ld_wait_ret
    s_waitcnt vmcnt(0)
    v_mov_b32 v11, s36
    v_cmp_gt_u32 vcc, s56, v0
    s_nop 1
    v_addc_co_u32 v11, vcc, v11, 0, vcc
    s_mov_b64 exec, 15
    ds_max_u32 v13, v11 offset:6912
    s_mov_b64 exec, -1
    s_nop 1
L_spin15:
    ds_read_b32 v11, v12 offset:6928
    s_waitcnt lgkmcnt(0)
    v_readfirstlane_b32 s45, v11
    s_nop 0
    s_cmp_ge_u32 s45, s48
    s_cbranch_scc1 L_spun16
    s_sleep 1
    s_branch L_spin15
L_spun16:
L_ld_wait_ret:
    s_setpc_b64 s[54:55]
L_compute:
    s_mul_i32 s36, s3, 0x9000
    s_add_u32 s36, s36, 0x3400
    s_setprio 1
    s_barrier
    v_and_b32 v228, 15, v0
    v_lshrrev_b32 v229, 4, v0
    v_and_b32 v230, 6, v228
    v_xor_b32 v230, v230, v229
    v_mul_u32_u24 v231, 0x180, v228
    v_add_u32 v231, s36, v231
    v_lshl_add_u32 v8, v230, 4, v231
    v_xor_b32 v230, 4, v230
    v_lshl_add_u32 v9, v230, 4, v231
    v_lshrrev_b32 v230, 2, v228
    v_and_b32 v231, 3, v228
    v_lshl_add_u32 v232, v229, 2, v230
    v_mul_u32_u24 v233, 0x180, v232
    v_lshl_add_u32 v233, v231, 3, v233
    v_add_u32 v233, s36, v233
    v_and_b32 v234, 6, v232
    v_xor_b32 v235, 0, v234
    v_lshl_add_u32 v10, v235, 4, v233
    v_xor_b32 v235, 2, v234
    v_lshl_add_u32 v11, v235, 4, v233
    v_xor_b32 v235, 4, v234
    v_lshl_add_u32 v12, v235, 4, v233
    v_xor_b32 v235, 6, v234
    v_lshl_add_u32 v13, v235, 4, v233
    v_subrev_u32 v244, s36, v8
    v_subrev_u32 v245, s36, v9
    v_mov_b32 v24, 0x3f803f80
    v_mov_b32 v240, 0
    v_mov_b32 v248, 0
    v_mov_b32 v25, 0x3f803f80
    v_mov_b32 v241, 0
    v_mov_b32 v249, 0
    v_mov_b32 v26, 0x3f803f80
    v_mov_b32 v242, 0
    v_mov_b32 v250, 0
    v_mov_b32 v27, 0x3f803f80
    v_mov_b32 v243, 0
    v_mov_b32 v251, 0
    v_mov_b32 v20, 1.0
    s_mov_b32 s44, 0x3baaaaab
    s_mov_b32 s46, 0x3727c5ac
    s_mov_b32 s58, 0xaaaaaaaa
    s_mov_b32 s60, 0xcccccccc
    s_mov_b32 s45, 0x3baaaaab
    s_mov_b32 s47, 0x3727c5ac
    s_mov_b32 s59, 0xaaaaaaaa
    s_mov_b32 s61, 0xcccccccc
    s_mov_b32 s38, 0xf0000f
    s_mov_b32 s39, 0xf0000f00
    s_mov_b32 s50, 0x42000000
    s_mov_b32 s41, 0
    s_mov_b32 s51, 0
    s_mov_b32 s52, 0
    s_mov_b32 s54, 0
    s_mov_b32 s56, 0x1800
    s_lshl_b32 s40, s3, 2
    v_mov_b32 v1, s40
    s_waitcnt lgkmcnt(0)
    s_mov_b32 s32, s22
    s_mov_b32 s33, s23
    s_mov_b32 s34, 0x1000000
    s_mov_b32 s35, 0x20000
    s_cmp_lt_u32 s2, 3
    s_cbranch_scc1 L_qkprod
    s_cmp_lt_u32 s2, 6
    s_cbranch_scc1 L_wvprod
L_c_start:
    s_add_u32 s51, s51, 1
    s_cmp_ge_u32 s52, s51
    s_cbranch_scc1 L_have17
L_spin18:
    ds_read_b32 v3, v1 offset:6912
    s_waitcnt lgkmcnt(0)
    v_readfirstlane_b32 s52, v3
    s_nop 0
    s_cmp_ge_u32 s52, s51
    s_cbranch_scc1 L_spun19
    s_sleep 1
    s_branch L_spin18
L_spun19:
L_have17:
    ds_read_b128 v[100:103], v8
    ds_read_b128 v[104:107], v9
    ds_read_b128 v[108:111], v8 offset:128
    ds_read_b128 v[112:115], v9 offset:128
    ds_read_b128 v[116:119], v8 offset:256
    ds_read_b128 v[120:123], v9 offset:256
    ds_read_b64_tr_b16 v[152:153], v10
    ds_read_b64_tr_b16 v[158:159], v11
    ds_read_b64_tr_b16 v[164:165], v12
    ds_read_b64_tr_b16 v[170:171], v13
    ds_read_b64_tr_b16 v[176:177], v10 offset:128
    ds_read_b64_tr_b16 v[182:183], v11 offset:128
    s_waitcnt lgkmcnt(11)
    v_mfma_f32_16x16x32_bf16 v[236:239], v[100:103], v[100:103], 0
    v_mfma_f32_16x16x32_bf16 v[224:227], v[100:103], v[24:27], 0
    ds_read_b64_tr_b16 v[188:189], v12 offset:128
    s_waitcnt lgkmcnt(11)
    v_mfma_f32_16x16x32_bf16 v[236:239], v[104:107], v[104:107], v[236:239]
    v_mfma_f32_16x16x32_bf16 v[224:227], v[104:107], v[24:27], v[224:227]
    ds_read_b64_tr_b16 v[194:195], v13 offset:128
    s_waitcnt lgkmcnt(11)
    v_mfma_f32_16x16x32_bf16 v[236:239], v[108:111], v[108:111], v[236:239]
    v_mfma_f32_16x16x32_bf16 v[224:227], v[108:111], v[24:27], v[224:227]
    ds_read_b64_tr_b16 v[200:201], v10 offset:256
    s_waitcnt lgkmcnt(11)
    v_mfma_f32_16x16x32_bf16 v[236:239], v[112:115], v[112:115], v[236:239]
    v_mfma_f32_16x16x32_bf16 v[224:227], v[112:115], v[24:27], v[224:227]
    ds_read_b64_tr_b16 v[206:207], v11 offset:256
    s_waitcnt lgkmcnt(11)
    v_mfma_f32_16x16x32_bf16 v[236:239], v[116:119], v[116:119], v[236:239]
    v_mfma_f32_16x16x32_bf16 v[224:227], v[116:119], v[24:27], v[224:227]
    ds_read_b64_tr_b16 v[212:213], v12 offset:256
    s_waitcnt lgkmcnt(11)
    v_mfma_f32_16x16x32_bf16 v[236:239], v[120:123], v[120:123], v[236:239]
    v_mfma_f32_16x16x32_bf16 v[224:227], v[120:123], v[24:27], v[224:227]
    ds_read_b64_tr_b16 v[218:219], v13 offset:256
    ds_read_b32 v3, v1 offset:6912
    v_mov_b32 v2, s51
    s_add_u32 s54, s54, 1
    s_cmp_eq_u32 s54, 6
    s_cselect_b32 s55, 0xffff8800, s56
    s_cselect_b32 s54, 0, s54
    v_add_u32 v8, s55, v8
    v_add_u32 v9, s55, v9
    v_add_u32 v10, s55, v10
    v_add_u32 v11, s55, v11
    v_add_u32 v12, s55, v12
    v_add_u32 v13, s55, v13
    s_waitcnt lgkmcnt(0)
    ds_write_b32 v1, v2 offset:6928
    v_cndmask_b32 v22, v236, v237, s[58:59]
    v_cndmask_b32 v23, v238, v239, s[58:59]
    v_cndmask_b32 v255, v22, v23, s[60:61]
    s_add_u32 s51, s51, 1
    s_cmp_ge_u32 s52, s51
    s_cbranch_scc1 L_have20
L_spin21:
    ds_read_b32 v3, v1 offset:6912
    s_waitcnt lgkmcnt(0)
    v_readfirstlane_b32 s52, v3
    s_nop 0
    s_cmp_ge_u32 s52, s51
    s_cbranch_scc1 L_spun22
    s_sleep 1
    s_branch L_spin21
L_spun22:
L_have20:
    ds_read_b128 v[124:127], v8
    ds_read_b128 v[128:131], v9
    ds_read_b128 v[132:135], v8 offset:128
    ds_read_b128 v[136:139], v9 offset:128
    ds_read_b128 v[140:143], v8 offset:256
    ds_read_b128 v[144:147], v9 offset:256
    s_waitcnt lgkmcnt(5)
    v_mfma_f32_16x16x32_bf16 v[236:239], v[124:127], v[124:127], 0
    v_mfma_f32_16x16x32_bf16 v[4:7], v[124:127], v[100:103], 0
    ds_read_b64_tr_b16 v[148:149], v10
    s_waitcnt lgkmcnt(5)
    v_mfma_f32_16x16x32_bf16 v[236:239], v[128:131], v[128:131], v[236:239]
    v_mfma_f32_16x16x32_bf16 v[4:7], v[128:131], v[104:107], v[4:7]
    ds_read_b64_tr_b16 v[154:155], v11
    s_waitcnt lgkmcnt(5)
    v_mfma_f32_16x16x32_bf16 v[236:239], v[132:135], v[132:135], v[236:239]
    ds_read_b64_tr_b16 v[160:161], v12
    v_mfma_f32_16x16x32_bf16 v[4:7], v[132:135], v[108:111], v[4:7]
    ds_read_b64_tr_b16 v[166:167], v13
    s_waitcnt lgkmcnt(6)
    v_mfma_f32_16x16x32_bf16 v[236:239], v[136:139], v[136:139], v[236:239]
    ds_read_b64_tr_b16 v[172:173], v10 offset:128
    v_mfma_f32_16x16x32_bf16 v[4:7], v[136:139], v[112:115], v[4:7]
    ds_read_b64_tr_b16 v[178:179], v11 offset:128
    s_waitcnt lgkmcnt(7)
    v_mfma_f32_16x16x32_bf16 v[236:239], v[140:143], v[140:143], v[236:239]
    ds_read_b64_tr_b16 v[184:185], v12 offset:128
    v_mfma_f32_16x16x32_bf16 v[4:7], v[140:143], v[116:119], v[4:7]
    ds_read_b64_tr_b16 v[190:191], v13 offset:128
    s_waitcnt lgkmcnt(8)
    v_mfma_f32_16x16x32_bf16 v[236:239], v[144:147], v[144:147], v[236:239]
    ds_read_b64_tr_b16 v[196:197], v10 offset:256
    v_mfma_f32_16x16x32_bf16 v[4:7], v[144:147], v[120:123], v[4:7]
    ds_read_b64_tr_b16 v[202:203], v11 offset:256
    v_mfma_f32_16x16x32_bf16 v[232:235], v[124:127], v[24:27], v[224:227]
    ds_read_b64_tr_b16 v[208:209], v12 offset:256
    v_mfma_f32_16x16x32_bf16 v[232:235], v[128:131], v[24:27], v[232:235]
    ds_read_b64_tr_b16 v[214:215], v13 offset:256
    s_nop 2
    v_mfma_f32_16x16x32_bf16 v[232:235], v[132:135], v[24:27], v[232:235]
    v_cndmask_b32 v22, v236, v237, s[58:59]
    v_cndmask_b32 v23, v238, v239, s[58:59]
    v_mfma_f32_16x16x32_bf16 v[232:235], v[136:139], v[24:27], v[232:235]
    v_cndmask_b32 v4, v4, v5, s[58:59]
    v_cndmask_b32 v6, v6, v7, s[58:59]
    v_mfma_f32_16x16x32_bf16 v[232:235], v[140:143], v[24:27], v[232:235]
    v_cndmask_b32 v22, v22, v23, s[60:61]
    v_cndmask_b32 v4, v4, v6, s[60:61]
    v_mfma_f32_16x16x32_bf16 v[232:235], v[144:147], v[24:27], v[232:235]
    v_add_f32 v22, v22, v255
    v_fma_f32 v22, v4, 2.0, v22
    v_cndmask_b32 v22, 0, v22, s[38:39]
    s_nop 1
    v_mfma_f32_16x16x4_f32 v[236:239], v22, v20, 0
    ds_read_b32 v3, v1 offset:6912
    v_mov_b32 v2, s51
    s_add_u32 s54, s54, 1
    s_cmp_eq_u32 s54, 6
    s_cselect_b32 s55, 0xffff8800, s56
    s_cselect_b32 s54, 0, s54
    v_add_u32 v8, s55, v8
    v_add_u32 v9, s55, v9
    v_add_u32 v10, s55, v10
    v_add_u32 v11, s55, v11
    v_add_u32 v12, s55, v12
    v_add_u32 v13, s55, v13
    s_waitcnt lgkmcnt(0)
    ds_write_b32 v1, v2 offset:6928
    s_sub_u32 s40, s2, 3
    s_cmp_ge_u32 s40, 3
    s_cbranch_scc1 L_nowf
    s_mov_b32 s24, s20
    s_mov_b32 s25, s21
    s_mov_b32 s26, 0x100
    s_mov_b32 s27, 0x20000
    s_lshl_b32 s40, s40, 4
    v_mov_b32 v22, 1
    s_waitcnt vmcnt(0)
    s_mov_b64 exec, 1
    buffer_store_dword v22, v1, s[24:27], s40 offen offset:128 sc1
    s_mov_b64 exec, -1
L_nowf:
    s_add_u32 s51, s51, 1
    s_cmp_ge_u32 s52, s51
    s_cbranch_scc1 L_have23
L_spin24:
    ds_read_b32 v3, v1 offset:6912
    s_waitcnt lgkmcnt(0)
    v_readfirstlane_b32 s52, v3
    s_nop 0
    s_cmp_ge_u32 s52, s51
    s_cbranch_scc1 L_spun25
    s_sleep 1
    s_branch L_spin24
L_spun25:
L_have23:
    ds_read_b128 v[52:55], v8
    ds_read_b128 v[56:59], v9
    ds_read_b128 v[60:63], v8 offset:128
    ds_read_b128 v[64:67], v9 offset:128
    ds_read_b128 v[68:71], v8 offset:256
    ds_read_b128 v[72:75], v9 offset:256
    s_waitcnt lgkmcnt(5)
    v_mfma_f32_16x16x32_bf16 v[80:83], v[52:55], v[52:55], 0
    v_mfma_f32_16x16x32_bf16 v[4:7], v[52:55], v[100:103], 0
    ds_read_b64_tr_b16 v[150:151], v10
    s_waitcnt lgkmcnt(5)
    v_mfma_f32_16x16x32_bf16 v[80:83], v[56:59], v[56:59], v[80:83]
    v_mfma_f32_16x16x32_bf16 v[4:7], v[56:59], v[104:107], v[4:7]
    ds_read_b64_tr_b16 v[156:157], v11
    s_waitcnt lgkmcnt(5)
    v_mfma_f32_16x16x32_bf16 v[80:83], v[60:63], v[60:63], v[80:83]
    ds_read_b64_tr_b16 v[162:163], v12
    v_mfma_f32_16x16x32_bf16 v[4:7], v[60:63], v[108:111], v[4:7]
    ds_read_b64_tr_b16 v[168:169], v13
    s_waitcnt lgkmcnt(6)
    v_mfma_f32_16x16x32_bf16 v[80:83], v[64:67], v[64:67], v[80:83]
    ds_read_b64_tr_b16 v[174:175], v10 offset:128
    v_mfma_f32_16x16x32_bf16 v[4:7], v[64:67], v[112:115], v[4:7]
    ds_read_b64_tr_b16 v[180:181], v11 offset:128
    s_waitcnt lgkmcnt(7)
    v_mfma_f32_16x16x32_bf16 v[80:83], v[68:71], v[68:71], v[80:83]
    ds_read_b64_tr_b16 v[186:187], v12 offset:128
    v_mfma_f32_16x16x32_bf16 v[4:7], v[68:71], v[116:119], v[4:7]
    ds_read_b64_tr_b16 v[192:193], v13 offset:128
    s_waitcnt lgkmcnt(8)
    v_mfma_f32_16x16x32_bf16 v[80:83], v[72:75], v[72:75], v[80:83]
    ds_read_b64_tr_b16 v[198:199], v10 offset:256
    v_mfma_f32_16x16x32_bf16 v[4:7], v[72:75], v[120:123], v[4:7]
    ds_read_b64_tr_b16 v[204:205], v11 offset:256
    v_mfma_f32_16x16x32_bf16 v[76:79], v[52:55], v[24:27], v[224:227]
    ds_read_b64_tr_b16 v[210:211], v12 offset:256
    v_mfma_f32_16x16x32_bf16 v[76:79], v[56:59], v[24:27], v[76:79]
    ds_read_b64_tr_b16 v[216:217], v13 offset:256
    s_nop 2
    v_mfma_f32_16x16x32_bf16 v[76:79], v[60:63], v[24:27], v[76:79]
    v_cndmask_b32 v22, v80, v81, s[58:59]
    v_cndmask_b32 v23, v82, v83, s[58:59]
    v_mfma_f32_16x16x32_bf16 v[76:79], v[64:67], v[24:27], v[76:79]
    v_cndmask_b32 v4, v4, v5, s[58:59]
    v_cndmask_b32 v6, v6, v7, s[58:59]
    v_mfma_f32_16x16x32_bf16 v[76:79], v[68:71], v[24:27], v[76:79]
    v_cndmask_b32 v22, v22, v23, s[60:61]
    v_cndmask_b32 v4, v4, v6, s[60:61]
    v_mfma_f32_16x16x32_bf16 v[76:79], v[72:75], v[24:27], v[76:79]
    v_add_f32 v22, v22, v255
    v_fma_f32 v22, v4, 2.0, v22
    v_cndmask_b32 v22, 0, v22, s[38:39]
    s_nop 1
    v_mfma_f32_16x16x4_f32 v[80:83], v22, v20, 0
    ds_read_b32 v3, v1 offset:6912
    v_mov_b32 v2, s51
    s_add_u32 s54, s54, 1
    s_cmp_eq_u32 s54, 6
    s_cselect_b32 s55, 0xffff8800, s56
    s_cselect_b32 s54, 0, s54
    v_add_u32 v8, s55, v8
    v_add_u32 v9, s55, v9
    v_add_u32 v10, s55, v10
    v_add_u32 v11, s55, v11
    v_add_u32 v12, s55, v12
    v_add_u32 v13, s55, v13
    s_waitcnt lgkmcnt(0)
    ds_write_b32 v1, v2 offset:6928
    v_pk_mul_f32 v[232:233], v[232:233], s[44:45]
    v_pk_mul_f32 v[234:235], v[234:235], s[44:45]
    v_pk_fma_f32 v[4:5], v[232:233], v[232:233], s[46:47] neg_lo:[1,0,0] neg_hi:[1,0,0]
    v_pk_fma_f32 v[6:7], v[234:235], v[234:235], s[46:47] neg_lo:[1,0,0] neg_hi:[1,0,0]
    v_pk_fma_f32 v[236:237], v[236:237], s[44:45], v[4:5]
    v_pk_fma_f32 v[238:239], v[238:239], s[44:45], v[6:7]
    v_max_f32 v236, s46, v236
    v_max_f32 v237, s46, v237
    v_max_f32 v238, s46, v238
    v_max_f32 v239, s46, v239
    v_rsq_f32 v236, v236
    v_rsq_f32 v237, v237
    v_rsq_f32 v238, v238
    v_rsq_f32 v239, v239
    v_pk_mul_f32 v[76:77], v[76:77], s[44:45]
    v_pk_mul_f32 v[78:79], v[78:79], s[44:45]
    v_pk_fma_f32 v[4:5], v[76:77], v[76:77], s[46:47] neg_lo:[1,0,0] neg_hi:[1,0,0]
    v_pk_fma_f32 v[6:7], v[78:79], v[78:79], s[46:47] neg_lo:[1,0,0] neg_hi:[1,0,0]
    v_pk_fma_f32 v[80:81], v[80:81], s[44:45], v[4:5]
    v_pk_fma_f32 v[82:83], v[82:83], s[44:45], v[6:7]
    v_max_f32 v80, s46, v80
    v_max_f32 v81, s46, v81
    v_max_f32 v82, s46, v82
    v_max_f32 v83, s46, v83
    v_rsq_f32 v80, v80
    v_rsq_f32 v81, v81
    v_rsq_f32 v82, v82
    v_rsq_f32 v83, v83
    s_add_u32 s51, s51, 1
    s_cmp_ge_u32 s52, s51
    s_cbranch_scc1 L_have26
L_spin27:
    ds_read_b32 v3, v1 offset:6912
    s_waitcnt lgkmcnt(0)
    v_readfirstlane_b32 s52, v3
    s_nop 0
    s_cmp_ge_u32 s52, s51
    s_cbranch_scc1 L_spun28
    s_sleep 1
    s_branch L_spin27
L_spun28:
L_have26:
    v_mov_b32 v21, 0
    s_nop 4
L_spin29:
    ds_read_b32 v3, v21 offset:6944
    s_waitcnt lgkmcnt(0)
    v_readfirstlane_b32 s40, v3
    s_nop 0
    s_cmp_ge_u32 s40, 1
    s_cbranch_scc1 L_spun30
    s_sleep 1
    s_branch L_spin29
L_spun30:
    ds_read_b128 v[28:31], v244
    ds_read_b128 v[32:35], v245
    ds_read_b128 v[36:39], v244 offset:128
    ds_read_b128 v[40:43], v245 offset:128
    ds_read_b128 v[44:47], v244 offset:256
    ds_read_b128 v[48:51], v245 offset:256
    s_waitcnt lgkmcnt(5)
    v_mfma_f32_16x16x32_bf16 v[220:223], v[100:103], v[28:31], 0
    s_waitcnt lgkmcnt(4)
    v_mfma_f32_16x16x32_bf16 v[220:223], v[104:107], v[32:35], v[220:223]
    s_waitcnt lgkmcnt(3)
    v_mfma_f32_16x16x32_bf16 v[220:223], v[108:111], v[36:39], v[220:223]
    s_waitcnt lgkmcnt(2)
    v_mfma_f32_16x16x32_bf16 v[220:223], v[112:115], v[40:43], v[220:223]
    s_waitcnt lgkmcnt(1)
    v_mfma_f32_16x16x32_bf16 v[220:223], v[116:119], v[44:47], v[220:223]
    s_waitcnt lgkmcnt(0)
    v_mfma_f32_16x16x32_bf16 v[220:223], v[120:123], v[48:51], v[220:223]
    v_mfma_f32_16x16x32_bf16 v[228:231], v[124:127], v[28:31], v[220:223]
    v_mfma_f32_16x16x32_bf16 v[84:87], v[52:55], v[28:31], v[220:223]
    v_mfma_f32_16x16x32_bf16 v[228:231], v[128:131], v[32:35], v[228:231]
    v_mfma_f32_16x16x32_bf16 v[84:87], v[56:59], v[32:35], v[84:87]
    v_mfma_f32_16x16x32_bf16 v[228:231], v[132:135], v[36:39], v[228:231]
    v_mfma_f32_16x16x32_bf16 v[84:87], v[60:63], v[36:39], v[84:87]
    v_mfma_f32_16x16x32_bf16 v[228:231], v[136:139], v[40:43], v[228:231]
    v_mfma_f32_16x16x32_bf16 v[84:87], v[64:67], v[40:43], v[84:87]
    v_mfma_f32_16x16x32_bf16 v[228:231], v[140:143], v[44:47], v[228:231]
    v_mfma_f32_16x16x32_bf16 v[84:87], v[68:71], v[44:47], v[84:87]
    v_mfma_f32_16x16x32_bf16 v[228:231], v[144:147], v[48:51], v[228:231]
    v_mfma_f32_16x16x32_bf16 v[84:87], v[72:75], v[48:51], v[84:87]
    ds_read_b128 v[124:127], v8
    ds_read_b128 v[128:131], v9
    ds_read_b128 v[132:135], v8 offset:128
    ds_read_b128 v[136:139], v9 offset:128
    ds_read_b128 v[140:143], v8 offset:256
    ds_read_b128 v[144:147], v9 offset:256
    v_dot2_f32_bf16 v16, v28, v24, 0
    v_dot2_f32_bf16 v17, v29, v24, 0
    v_dot2_f32_bf16 v16, v30, v24, v16
    v_dot2_f32_bf16 v17, v31, v24, v17
    v_dot2_f32_bf16 v16, v32, v24, v16
    v_dot2_f32_bf16 v17, v33, v24, v17
    v_dot2_f32_bf16 v16, v34, v24, v16
    v_dot2_f32_bf16 v17, v35, v24, v17
    v_dot2_f32_bf16 v16, v36, v24, v16
    v_dot2_f32_bf16 v17, v37, v24, v17
    v_dot2_f32_bf16 v16, v38, v24, v16
    v_dot2_f32_bf16 v17, v39, v24, v17
    v_dot2_f32_bf16 v16, v40, v24, v16
    v_dot2_f32_bf16 v17, v41, v24, v17
    v_dot2_f32_bf16 v16, v42, v24, v16
    v_dot2_f32_bf16 v17, v43, v24, v17
    v_dot2_f32_bf16 v16, v44, v24, v16
    v_dot2_f32_bf16 v17, v45, v24, v17
    v_dot2_f32_bf16 v16, v46, v24, v16
    v_dot2_f32_bf16 v17, v47, v24, v17
    v_dot2_f32_bf16 v16, v48, v24, v16
    v_dot2_f32_bf16 v17, v49, v24, v17
    v_dot2_f32_bf16 v16, v50, v24, v16
    v_dot2_f32_bf16 v17, v51, v24, v17
    s_nop 2
    v_add_f32 v16, v16, v17
    v_mov_b32 v22, v16
    v_mov_b32 v23, v16
    s_nop 1
    v_permlane32_swap_b32 v22, v23
    v_add_f32 v16, v22, v23
    v_mov_b32 v22, v16
    v_mov_b32 v23, v16
    s_nop 1
    v_permlane16_swap_b32 v22, v23
    v_add_f32 v16, v22, v23
    v_mov_b32 v17, v16
    v_pk_fma_f32 v[228:229], v[232:233], v[16:17], v[228:229] neg_lo:[1,0,0] neg_hi:[1,0,0]
    v_pk_mul_f32 v[228:229], v[228:229], v[236:237]
    v_pk_fma_f32 v[230:231], v[234:235], v[16:17], v[230:231] neg_lo:[1,0,0] neg_hi:[1,0,0]
    v_pk_mul_f32 v[230:231], v[230:231], v[238:239]
    v_pk_fma_f32 v[84:85], v[76:77], v[16:17], v[84:85] neg_lo:[1,0,0] neg_hi:[1,0,0]
    v_pk_mul_f32 v[84:85], v[84:85], v[80:81]
    v_pk_fma_f32 v[86:87], v[78:79], v[16:17], v[86:87] neg_lo:[1,0,0] neg_hi:[1,0,0]
    v_pk_mul_f32 v[86:87], v[86:87], v[82:83]
    v_max3_f32 v254, v228, v229, v230
    v_max3_f32 v21, v231, v84, v85
    v_max3_f32 v254, v254, v86, v87
    v_max_f32 v254, v254, v21
    v_mov_b32 v22, v254
    v_mov_b32 v23, v254
    s_nop 1
    v_permlane32_swap_b32 v22, v23
    v_max_f32 v254, v22, v23
    v_mov_b32 v22, v254
    v_mov_b32 v23, v254
    s_nop 1
    v_permlane16_swap_b32 v22, v23
    v_max_f32 v254, v22, v23
    v_cmp_le_f32_e64 vcc, |v254|, s50
    s_nop 1
    v_cndmask_b32_e64 v254, v254, 0, vcc
    v_sub_f32 v18, 0, v254
    v_sub_f32 v19, 0, v254
    v_pk_add_f32 v[228:229], v[228:229], v[18:19]
    v_pk_add_f32 v[230:231], v[230:231], v[18:19]
    v_exp_f32 v228, v228
    v_exp_f32 v229, v229
    v_exp_f32 v230, v230
    v_exp_f32 v231, v231
    v_pk_add_f32 v[84:85], v[84:85], v[18:19]
    v_pk_add_f32 v[86:87], v[86:87], v[18:19]
    v_exp_f32 v84, v84
    v_exp_f32 v85, v85
    v_exp_f32 v86, v86
    v_exp_f32 v87, v87
    v_pk_add_f32 v[14:15], v[228:229], v[230:231]
    v_pk_add_f32 v[14:15], v[14:15], v[84:85]
    v_pk_add_f32 v[14:15], v[14:15], v[86:87]
    v_pk_mul_f32 v[228:229], v[228:229], v[236:237]
    v_pk_mul_f32 v[230:231], v[230:231], v[238:239]
    v_pk_mul_f32 v[84:85], v[84:85], v[80:81]
    v_pk_mul_f32 v[86:87], v[86:87], v[82:83]
    v_cvt_pk_bf16_f32 v244, v228, v229
    v_cvt_pk_bf16_f32 v245, v230, v231
    v_cvt_pk_bf16_f32 v246, v84, v85
    v_cvt_pk_bf16_f32 v247, v86, v87
    v_pk_add_f32 v[240:241], v[228:229], v[84:85]
    v_pk_add_f32 v[242:243], v[230:231], v[86:87]
    v_pk_mul_f32 v[252:253], v[228:229], v[232:233]
    v_pk_fma_f32 v[252:253], v[230:231], v[234:235], v[252:253]
    v_pk_fma_f32 v[252:253], v[84:85], v[76:77], v[252:253]
    v_pk_fma_f32 v[252:253], v[86:87], v[78:79], v[252:253]
    v_mov_b32 v21, 0
    v_mfma_f32_16x16x32_bf16 v[52:55], v[148:151], v[244:247], 0
    ds_read_b64_tr_b16 v[148:149], v10
    ds_read_b64 v[150:151], v21 offset:7056
    v_mfma_f32_16x16x32_bf16 v[56:59], v[154:157], v[244:247], 0
    ds_read_b64_tr_b16 v[154:155], v11
    ds_read_b64 v[156:157], v21 offset:7056
    v_mfma_f32_16x16x32_bf16 v[60:63], v[160:163], v[244:247], 0
    ds_read_b64_tr_b16 v[160:161], v12
    ds_read_b64 v[162:163], v21 offset:7056
    v_mfma_f32_16x16x32_bf16 v[64:67], v[166:169], v[244:247], 0
    ds_read_b64_tr_b16 v[166:167], v13
    ds_read_b64 v[168:169], v21 offset:7056
    v_mfma_f32_16x16x32_bf16 v[68:71], v[172:175], v[244:247], 0
    ds_read_b64_tr_b16 v[172:173], v10 offset:128
    ds_read_b64 v[174:175], v21 offset:7056
    v_mfma_f32_16x16x32_bf16 v[72:75], v[178:181], v[244:247], 0
    ds_read_b64_tr_b16 v[178:179], v11 offset:128
    ds_read_b64 v[180:181], v21 offset:7056
    v_mfma_f32_16x16x32_bf16 v[76:79], v[184:187], v[244:247], 0
    ds_read_b64_tr_b16 v[184:185], v12 offset:128
    ds_read_b64 v[186:187], v21 offset:7056
    v_mfma_f32_16x16x32_bf16 v[80:83], v[190:193], v[244:247], 0
    ds_read_b64_tr_b16 v[190:191], v13 offset:128
    ds_read_b64 v[192:193], v21 offset:7056
    v_mfma_f32_16x16x32_bf16 v[84:87], v[196:199], v[244:247], 0
    ds_read_b64_tr_b16 v[196:197], v10 offset:256
    ds_read_b64 v[198:199], v21 offset:7056
    v_mfma_f32_16x16x32_bf16 v[88:91], v[202:205], v[244:247], 0
    ds_read_b64_tr_b16 v[202:203], v11 offset:256
    ds_read_b64 v[204:205], v21 offset:7056
    v_mfma_f32_16x16x32_bf16 v[92:95], v[208:211], v[244:247], 0
    ds_read_b64_tr_b16 v[208:209], v12 offset:256
    ds_read_b64 v[210:211], v21 offset:7056
    v_mfma_f32_16x16x32_bf16 v[96:99], v[214:217], v[244:247], 0
    ds_read_b64_tr_b16 v[214:215], v13 offset:256
    ds_read_b64 v[216:217], v21 offset:7056
    s_nop 5
    s_branch L_tile2b
L_rescale:
    s_nop 15
    v_mul_f32 v4, v228, v236
    v_mul_f32 v5, v229, v237
    v_mul_f32 v6, v230, v238
    v_mul_f32 v7, v231, v239
    v_max3_f32 v21, v4, v5, v6
    v_max3_f32 v21, v21, v7, v254
    v_mov_b32 v22, v21
    v_mov_b32 v23, v21
    s_nop 1
    v_permlane32_swap_b32 v22, v23
    v_max_f32 v21, v22, v23
    v_mov_b32 v22, v21
    v_mov_b32 v23, v21
    s_nop 1
    v_permlane16_swap_b32 v22, v23
    v_max_f32 v21, v22, v23
    v_sub_f32 v22, v254, v21
    v_exp_f32 v22, v22
    v_mov_b32 v254, v21
    v_sub_f32 v18, 0, v21
    v_sub_f32 v19, 0, v21
    v_mov_b32 v23, v22
    v_sub_f32 v4, v4, v21
    v_sub_f32 v5, v5, v21
    v_sub_f32 v6, v6, v21
    v_sub_f32 v7, v7, v21
    v_pk_mul_f32 v[14:15], v[14:15], v[22:23]
    v_pk_mul_f32 v[252:253], v[252:253], v[22:23]
    v_pk_mul_f32 v[240:241], v[240:241], v[22:23]
    v_pk_mul_f32 v[242:243], v[242:243], v[22:23]
    v_pk_mul_f32 v[248:249], v[248:249], v[22:23]
    v_pk_mul_f32 v[250:251], v[250:251], v[22:23]
    v_pk_mul_f32 v[52:53], v[52:53], v[22:23]
    v_pk_mul_f32 v[54:55], v[54:55], v[22:23]
    v_pk_mul_f32 v[56:57], v[56:57], v[22:23]
    v_pk_mul_f32 v[58:59], v[58:59], v[22:23]
    v_pk_mul_f32 v[60:61], v[60:61], v[22:23]
    v_pk_mul_f32 v[62:63], v[62:63], v[22:23]
    v_pk_mul_f32 v[64:65], v[64:65], v[22:23]
    v_pk_mul_f32 v[66:67], v[66:67], v[22:23]
    v_pk_mul_f32 v[68:69], v[68:69], v[22:23]
    v_pk_mul_f32 v[70:71], v[70:71], v[22:23]
    v_pk_mul_f32 v[72:73], v[72:73], v[22:23]
    v_pk_mul_f32 v[74:75], v[74:75], v[22:23]
    v_pk_mul_f32 v[76:77], v[76:77], v[22:23]
    v_pk_mul_f32 v[78:79], v[78:79], v[22:23]
    v_pk_mul_f32 v[80:81], v[80:81], v[22:23]
    v_pk_mul_f32 v[82:83], v[82:83], v[22:23]
    v_pk_mul_f32 v[84:85], v[84:85], v[22:23]
    v_pk_mul_f32 v[86:87], v[86:87], v[22:23]
    v_pk_mul_f32 v[88:89], v[88:89], v[22:23]
    v_pk_mul_f32 v[90:91], v[90:91], v[22:23]
    v_pk_mul_f32 v[92:93], v[92:93], v[22:23]
    v_pk_mul_f32 v[94:95], v[94:95], v[22:23]
    v_pk_mul_f32 v[96:97], v[96:97], v[22:23]
    v_pk_mul_f32 v[98:99], v[98:99], v[22:23]
    s_nop 1
    s_setpc_b64 s[48:49]
L_loop:
    s_add_u32 s51, s51, 1
    s_cmp_lg_u32 s57, 0
    s_cbranch_scc1 L_begun31
L_spin32:
    ds_read_b32 v3, v1 offset:6912
    s_waitcnt lgkmcnt(0)
    v_readfirstlane_b32 s52, v3
    s_nop 0
    s_cmp_ge_u32 s52, s51
    s_cbranch_scc1 L_spun33
    s_sleep 1
    s_branch L_spin32
L_spun33:
    ds_read_b128 v[100:103], v8
    ds_read_b128 v[104:107], v9
    ds_read_b128 v[108:111], v8 offset:128
    ds_read_b128 v[112:115], v9 offset:128
    ds_read_b128 v[116:119], v8 offset:256
    ds_read_b128 v[120:123], v9 offset:256
L_begun31:
    v_mfma_f32_16x16x32_bf16 v[52:55], v[150:153], v[244:247], v[52:55]
    ds_read_b64_tr_b16 v[152:153], v10
    v_mfma_f32_16x16x32_bf16 v[56:59], v[156:159], v[244:247], v[56:59]
    ds_read_b64_tr_b16 v[158:159], v11
    v_mfma_f32_16x16x32_bf16 v[60:63], v[162:165], v[244:247], v[60:63]
    ds_read_b64_tr_b16 v[164:165], v12
    v_mfma_f32_16x16x32_bf16 v[64:67], v[168:171], v[244:247], v[64:67]
    ds_read_b64_tr_b16 v[170:171], v13
    v_mfma_f32_16x16x32_bf16 v[68:71], v[174:177], v[244:247], v[68:71]
    ds_read_b64_tr_b16 v[176:177], v10 offset:128
    v_mfma_f32_16x16x32_bf16 v[72:75], v[180:183], v[244:247], v[72:75]
    ds_read_b64_tr_b16 v[182:183], v11 offset:128
    v_mfma_f32_16x16x32_bf16 v[76:79], v[186:189], v[244:247], v[76:79]
    ds_read_b64_tr_b16 v[188:189], v12 offset:128
    v_mfma_f32_16x16x32_bf16 v[80:83], v[192:195], v[244:247], v[80:83]
    ds_read_b64_tr_b16 v[194:195], v13 offset:128
    v_mfma_f32_16x16x32_bf16 v[84:87], v[198:201], v[244:247], v[84:87]
    ds_read_b64_tr_b16 v[200:201], v10 offset:256
    v_mfma_f32_16x16x32_bf16 v[88:91], v[204:207], v[244:247], v[88:91]
    ds_read_b64_tr_b16 v[206:207], v11 offset:256
    v_mfma_f32_16x16x32_bf16 v[92:95], v[210:213], v[244:247], v[92:95]
    ds_read_b64_tr_b16 v[212:213], v12 offset:256
    v_mfma_f32_16x16x32_bf16 v[96:99], v[216:219], v[244:247], v[96:99]
    ds_read_b64_tr_b16 v[218:219], v13 offset:256
    s_waitcnt lgkmcnt(12)
    v_mfma_f32_16x16x32_bf16 v[236:239], v[100:103], v[100:103], 0
    v_mfma_f32_16x16x32_bf16 v[224:227], v[100:103], v[24:27], 0
    v_mfma_f32_16x16x32_bf16 v[236:239], v[104:107], v[104:107], v[236:239]
    v_mfma_f32_16x16x32_bf16 v[224:227], v[104:107], v[24:27], v[224:227]
    v_mfma_f32_16x16x32_bf16 v[236:239], v[108:111], v[108:111], v[236:239]
    v_mfma_f32_16x16x32_bf16 v[224:227], v[108:111], v[24:27], v[224:227]
    v_mfma_f32_16x16x32_bf16 v[236:239], v[112:115], v[112:115], v[236:239]
    v_mfma_f32_16x16x32_bf16 v[224:227], v[112:115], v[24:27], v[224:227]
    v_mfma_f32_16x16x32_bf16 v[236:239], v[116:119], v[116:119], v[236:239]
    v_mfma_f32_16x16x32_bf16 v[224:227], v[116:119], v[24:27], v[224:227]
    v_mfma_f32_16x16x32_bf16 v[236:239], v[120:123], v[120:123], v[236:239]
    v_mfma_f32_16x16x32_bf16 v[224:227], v[120:123], v[24:27], v[224:227]
    v_mfma_f32_16x16x32_bf16 v[220:223], v[100:103], v[28:31], 0
    v_mfma_f32_16x16x32_bf16 v[220:223], v[104:107], v[32:35], v[220:223]
    v_mfma_f32_16x16x32_bf16 v[220:223], v[108:111], v[36:39], v[220:223]
    v_mfma_f32_16x16x32_bf16 v[220:223], v[112:115], v[40:43], v[220:223]
    v_mfma_f32_16x16x32_bf16 v[220:223], v[116:119], v[44:47], v[220:223]
    v_mfma_f32_16x16x32_bf16 v[220:223], v[120:123], v[48:51], v[220:223]
    ds_read_b32 v3, v1 offset:6912
    v_mov_b32 v2, s51
    s_add_u32 s54, s54, 1
    s_cmp_eq_u32 s54, 6
    s_cselect_b32 s55, 0xffff8800, s56
    s_cselect_b32 s54, 0, s54
    v_add_u32 v8, s55, v8
    v_add_u32 v9, s55, v9
    v_add_u32 v10, s55, v10
    v_add_u32 v11, s55, v11
    v_add_u32 v12, s55, v12
    v_add_u32 v13, s55, v13
    s_waitcnt lgkmcnt(0)
    ds_write_b32 v1, v2 offset:6928
    v_readfirstlane_b32 s52, v3
    s_mov_b32 s57, 0
    s_nop 0
    s_cmp_gt_u32 s52, s51
    s_cbranch_scc0 L_early34
    s_mov_b32 s57, 1
    ds_read_b128 v[124:127], v8
    ds_read_b128 v[128:131], v9
    ds_read_b128 v[132:135], v8 offset:128
    ds_read_b128 v[136:139], v9 offset:128
    ds_read_b128 v[140:143], v8 offset:256
    ds_read_b128 v[144:147], v9 offset:256
L_early34:
    v_cndmask_b32 v22, v236, v237, s[58:59]
    v_cndmask_b32 v23, v238, v239, s[58:59]
    v_cndmask_b32 v255, v22, v23, s[60:61]
    s_add_u32 s51, s51, 1
    s_cmp_lg_u32 s57, 0
    s_cbranch_scc1 L_begun35
L_spin36:
    ds_read_b32 v3, v1 offset:6912
    s_waitcnt lgkmcnt(0)
    v_readfirstlane_b32 s52, v3
    s_nop 0
    s_cmp_ge_u32 s52, s51
    s_cbranch_scc1 L_spun37
    s_sleep 1
    s_branch L_spin36
L_spun37:
    ds_read_b128 v[124:127], v8
    ds_read_b128 v[128:131], v9
    ds_read_b128 v[132:135], v8 offset:128
    ds_read_b128 v[136:139], v9 offset:128
    ds_read_b128 v[140:143], v8 offset:256
    ds_read_b128 v[144:147], v9 offset:256
L_begun35:
    s_waitcnt lgkmcnt(5)
    v_mfma_f32_16x16x32_bf16 v[236:239], v[124:127], v[124:127], 0
    v_mfma_f32_16x16x32_bf16 v[4:7], v[124:127], v[100:103], 0
    ds_read_b64_tr_b16 v[148:149], v10
    s_waitcnt lgkmcnt(5)
    v_mfma_f32_16x16x32_bf16 v[236:239], v[128:131], v[128:131], v[236:239]
    v_mfma_f32_16x16x32_bf16 v[4:7], v[128:131], v[104:107], v[4:7]
    ds_read_b64_tr_b16 v[154:155], v11
    s_waitcnt lgkmcnt(5)
    v_mfma_f32_16x16x32_bf16 v[236:239], v[132:135], v[132:135], v[236:239]
    ds_read_b64_tr_b16 v[160:161], v12
    v_mfma_f32_16x16x32_bf16 v[4:7], v[132:135], v[108:111], v[4:7]
    ds_read_b64_tr_b16 v[166:167], v13
    s_waitcnt lgkmcnt(6)
    v_mfma_f32_16x16x32_bf16 v[236:239], v[136:139], v[136:139], v[236:239]
    ds_read_b64_tr_b16 v[172:173], v10 offset:128
    v_mfma_f32_16x16x32_bf16 v[4:7], v[136:139], v[112:115], v[4:7]
    ds_read_b64_tr_b16 v[178:179], v11 offset:128
    s_waitcnt lgkmcnt(7)
    v_mfma_f32_16x16x32_bf16 v[236:239], v[140:143], v[140:143], v[236:239]
    ds_read_b64_tr_b16 v[184:185], v12 offset:128
    v_mfma_f32_16x16x32_bf16 v[4:7], v[140:143], v[116:119], v[4:7]
    ds_read_b64_tr_b16 v[190:191], v13 offset:128
    s_waitcnt lgkmcnt(8)
    v_mfma_f32_16x16x32_bf16 v[236:239], v[144:147], v[144:147], v[236:239]
    ds_read_b64_tr_b16 v[196:197], v10 offset:256
    v_mfma_f32_16x16x32_bf16 v[4:7], v[144:147], v[120:123], v[4:7]
    ds_read_b64_tr_b16 v[202:203], v11 offset:256
    v_mfma_f32_16x16x32_bf16 v[232:235], v[124:127], v[24:27], v[224:227]
    ds_read_b64_tr_b16 v[208:209], v12 offset:256
    v_mfma_f32_16x16x32_bf16 v[232:235], v[128:131], v[24:27], v[232:235]
    ds_read_b64_tr_b16 v[214:215], v13 offset:256
    s_nop 2
    v_mfma_f32_16x16x32_bf16 v[232:235], v[132:135], v[24:27], v[232:235]
    v_cndmask_b32 v22, v236, v237, s[58:59]
    v_cndmask_b32 v23, v238, v239, s[58:59]
    v_mfma_f32_16x16x32_bf16 v[232:235], v[136:139], v[24:27], v[232:235]
    v_cndmask_b32 v4, v4, v5, s[58:59]
    v_cndmask_b32 v6, v6, v7, s[58:59]
    v_mfma_f32_16x16x32_bf16 v[232:235], v[140:143], v[24:27], v[232:235]
    v_cndmask_b32 v22, v22, v23, s[60:61]
    v_cndmask_b32 v4, v4, v6, s[60:61]
    v_mfma_f32_16x16x32_bf16 v[232:235], v[144:147], v[24:27], v[232:235]
    v_add_f32 v22, v22, v255
    v_fma_f32 v22, v4, 2.0, v22
    v_cndmask_b32 v22, 0, v22, s[38:39]
    v_mfma_f32_16x16x32_bf16 v[228:231], v[124:127], v[28:31], v[220:223]
    s_nop 0
    v_mfma_f32_16x16x4_f32 v[236:239], v22, v20, 0
    v_mfma_f32_16x16x32_bf16 v[228:231], v[128:131], v[32:35], v[228:231]
    v_mfma_f32_16x16x32_bf16 v[228:231], v[132:135], v[36:39], v[228:231]
    v_mul_f32 v232, s44, v232
    v_mul_f32 v233, s44, v233
    v_mfma_f32_16x16x32_bf16 v[228:231], v[136:139], v[40:43], v[228:231]
    v_mul_f32 v234, s44, v234
    v_mul_f32 v235, s44, v235
    v_mfma_f32_16x16x32_bf16 v[228:231], v[140:143], v[44:47], v[228:231]
    v_fma_f32 v4, -v232, v232, s46
    v_fma_f32 v5, -v233, v233, s46
    v_mfma_f32_16x16x32_bf16 v[228:231], v[144:147], v[48:51], v[228:231]
    v_fma_f32 v6, -v234, v234, s46
    v_fma_f32 v7, -v235, v235, s46
    ds_read_b32 v3, v1 offset:6912
    v_mov_b32 v2, s51
    s_add_u32 s54, s54, 1
    s_cmp_eq_u32 s54, 6
    s_cselect_b32 s55, 0xffff8800, s56
    s_cselect_b32 s54, 0, s54
    v_add_u32 v8, s55, v8
    v_add_u32 v9, s55, v9
    v_add_u32 v10, s55, v10
    v_add_u32 v11, s55, v11
    v_add_u32 v12, s55, v12
    v_add_u32 v13, s55, v13
    s_waitcnt lgkmcnt(0)
    ds_write_b32 v1, v2 offset:6928
    v_readfirstlane_b32 s52, v3
    s_mov_b32 s57, 0
    s_nop 0
    s_cmp_gt_u32 s52, s51
    s_cbranch_scc0 L_early38
    s_mov_b32 s57, 1
    ds_read_b128 v[124:127], v8
    ds_read_b128 v[128:131], v9
    ds_read_b128 v[132:135], v8 offset:128
    ds_read_b128 v[136:139], v9 offset:128
    ds_read_b128 v[140:143], v8 offset:256
    ds_read_b128 v[144:147], v9 offset:256
L_early38:
    v_fma_f32 v236, v236, s44, v4
    v_fma_f32 v237, v237, s44, v5
    v_fma_f32 v238, v238, s44, v6
    v_fma_f32 v239, v239, s44, v7
    v_max_f32 v236, s46, v236
    v_max_f32 v237, s46, v237
    v_max_f32 v238, s46, v238
    v_max_f32 v239, s46, v239
    v_rsq_f32 v236, v236
    v_rsq_f32 v237, v237
    v_rsq_f32 v238, v238
    v_rsq_f32 v239, v239
    v_pk_fma_f32 v[228:229], v[232:233], v[16:17], v[228:229] neg_lo:[1,0,0] neg_hi:[1,0,0]
    v_pk_fma_f32 v[230:231], v[234:235], v[16:17], v[230:231] neg_lo:[1,0,0] neg_hi:[1,0,0]
    v_pk_fma_f32 v[4:5], v[228:229], v[236:237], v[18:19]
    v_pk_fma_f32 v[6:7], v[230:231], v[238:239], v[18:19]
    v_max3_f32 v21, v4, v5, v6
    v_max_f32 v21, v21, v7
    v_cmp_lt_f32 vcc, s50, v21
    s_cbranch_vccz L_sm39
    s_call_b64 s[48:49], L_rescale
L_sm39:
    v_exp_f32 v4, v4
    v_exp_f32 v5, v5
    v_exp_f32 v6, v6
    v_exp_f32 v7, v7
    v_pk_mul_f32 v[248:249], v[4:5], v[236:237]
    v_pk_add_f32 v[14:15], v[14:15], v[4:5]
    v_pk_mul_f32 v[250:251], v[6:7], v[238:239]
    v_pk_add_f32 v[14:15], v[14:15], v[6:7]
    v_mov_b32 v240, v248
    v_mov_b32 v241, v249
    v_mov_b32 v242, v250
    v_mov_b32 v243, v251
    v_pk_fma_f32 v[252:253], v[248:249], v[232:233], v[252:253]
    v_pk_fma_f32 v[252:253], v[250:251], v[234:235], v[252:253]
    s_add_u32 s51, s51, 1
    s_cmp_lg_u32 s57, 0
    s_cbranch_scc1 L_begun40
L_spin41:
    ds_read_b32 v3, v1 offset:6912
    s_waitcnt lgkmcnt(0)
    v_readfirstlane_b32 s52, v3
    s_nop 0
    s_cmp_ge_u32 s52, s51
    s_cbranch_scc1 L_spun42
    s_sleep 1
    s_branch L_spin41
L_spun42:
    ds_read_b128 v[124:127], v8
    ds_read_b128 v[128:131], v9
    ds_read_b128 v[132:135], v8 offset:128
    ds_read_b128 v[136:139], v9 offset:128
    ds_read_b128 v[140:143], v8 offset:256
    ds_read_b128 v[144:147], v9 offset:256
L_begun40:
    s_waitcnt lgkmcnt(5)
    v_mfma_f32_16x16x32_bf16 v[236:239], v[124:127], v[124:127], 0
    v_mfma_f32_16x16x32_bf16 v[4:7], v[124:127], v[100:103], 0
    ds_read_b64_tr_b16 v[150:151], v10
    s_waitcnt lgkmcnt(5)
    v_mfma_f32_16x16x32_bf16 v[236:239], v[128:131], v[128:131], v[236:239]
    v_mfma_f32_16x16x32_bf16 v[4:7], v[128:131], v[104:107], v[4:7]
    ds_read_b64_tr_b16 v[156:157], v11
    s_waitcnt lgkmcnt(5)
    v_mfma_f32_16x16x32_bf16 v[236:239], v[132:135], v[132:135], v[236:239]
    ds_read_b64_tr_b16 v[162:163], v12
    v_mfma_f32_16x16x32_bf16 v[4:7], v[132:135], v[108:111], v[4:7]
    ds_read_b64_tr_b16 v[168:169], v13
    s_waitcnt lgkmcnt(6)
    v_mfma_f32_16x16x32_bf16 v[236:239], v[136:139], v[136:139], v[236:239]
    ds_read_b64_tr_b16 v[174:175], v10 offset:128
    v_mfma_f32_16x16x32_bf16 v[4:7], v[136:139], v[112:115], v[4:7]
    ds_read_b64_tr_b16 v[180:181], v11 offset:128
    s_waitcnt lgkmcnt(7)
    v_mfma_f32_16x16x32_bf16 v[236:239], v[140:143], v[140:143], v[236:239]
    ds_read_b64_tr_b16 v[186:187], v12 offset:128
    v_mfma_f32_16x16x32_bf16 v[4:7], v[140:143], v[116:119], v[4:7]
    ds_read_b64_tr_b16 v[192:193], v13 offset:128
    s_waitcnt lgkmcnt(8)
    v_mfma_f32_16x16x32_bf16 v[236:239], v[144:147], v[144:147], v[236:239]
    ds_read_b64_tr_b16 v[198:199], v10 offset:256
    v_mfma_f32_16x16x32_bf16 v[4:7], v[144:147], v[120:123], v[4:7]
    ds_read_b64_tr_b16 v[204:205], v11 offset:256
    v_mfma_f32_16x16x32_bf16 v[232:235], v[124:127], v[24:27], v[224:227]
    ds_read_b64_tr_b16 v[210:211], v12 offset:256
    v_mfma_f32_16x16x32_bf16 v[232:235], v[128:131], v[24:27], v[232:235]
    ds_read_b64_tr_b16 v[216:217], v13 offset:256
    s_nop 2
    v_mfma_f32_16x16x32_bf16 v[232:235], v[132:135], v[24:27], v[232:235]
    v_cndmask_b32 v22, v236, v237, s[58:59]
    v_cndmask_b32 v23, v238, v239, s[58:59]
    v_mfma_f32_16x16x32_bf16 v[232:235], v[136:139], v[24:27], v[232:235]
    v_cndmask_b32 v4, v4, v5, s[58:59]
    v_cndmask_b32 v6, v6, v7, s[58:59]
    v_mfma_f32_16x16x32_bf16 v[232:235], v[140:143], v[24:27], v[232:235]
    v_cndmask_b32 v22, v22, v23, s[60:61]
    v_cndmask_b32 v4, v4, v6, s[60:61]
    v_mfma_f32_16x16x32_bf16 v[232:235], v[144:147], v[24:27], v[232:235]
    v_add_f32 v22, v22, v255
    v_fma_f32 v22, v4, 2.0, v22
    v_cndmask_b32 v22, 0, v22, s[38:39]
    v_mfma_f32_16x16x32_bf16 v[228:231], v[124:127], v[28:31], v[220:223]
    s_nop 0
    v_mfma_f32_16x16x4_f32 v[236:239], v22, v20, 0
    v_mfma_f32_16x16x32_bf16 v[228:231], v[128:131], v[32:35], v[228:231]
    v_mfma_f32_16x16x32_bf16 v[228:231], v[132:135], v[36:39], v[228:231]
    v_mul_f32 v232, s44, v232
    v_mul_f32 v233, s44, v233
    v_mfma_f32_16x16x32_bf16 v[228:231], v[136:139], v[40:43], v[228:231]
    v_mul_f32 v234, s44, v234
    v_mul_f32 v235, s44, v235
    v_mfma_f32_16x16x32_bf16 v[228:231], v[140:143], v[44:47], v[228:231]
    v_fma_f32 v4, -v232, v232, s46
    v_fma_f32 v5, -v233, v233, s46
    v_mfma_f32_16x16x32_bf16 v[228:231], v[144:147], v[48:51], v[228:231]
    v_fma_f32 v6, -v234, v234, s46
    v_fma_f32 v7, -v235, v235, s46
    ds_read_b32 v3, v1 offset:6912
    v_mov_b32 v2, s51
    s_add_u32 s54, s54, 1
    s_cmp_eq_u32 s54, 6
    s_cselect_b32 s55, 0xffff8800, s56
    s_cselect_b32 s54, 0, s54
    v_add_u32 v8, s55, v8
    v_add_u32 v9, s55, v9
    v_add_u32 v10, s55, v10
    v_add_u32 v11, s55, v11
    v_add_u32 v12, s55, v12
    v_add_u32 v13, s55, v13
    s_waitcnt lgkmcnt(0)
    ds_write_b32 v1, v2 offset:6928
    v_readfirstlane_b32 s52, v3
    s_mov_b32 s57, 0
    s_nop 0
    s_cmp_gt_u32 s52, s51
    s_cbranch_scc0 L_early43
    s_mov_b32 s57, 1
    ds_read_b128 v[124:127], v8
    ds_read_b128 v[128:131], v9
    ds_read_b128 v[132:135], v8 offset:128
    ds_read_b128 v[136:139], v9 offset:128
    ds_read_b128 v[140:143], v8 offset:256
    ds_read_b128 v[144:147], v9 offset:256
L_early43:
    v_fma_f32 v236, v236, s44, v4
    v_fma_f32 v237, v237, s44, v5
    v_fma_f32 v238, v238, s44, v6
    v_fma_f32 v239, v239, s44, v7
    v_max_f32 v236, s46, v236
    v_max_f32 v237, s46, v237
    v_max_f32 v238, s46, v238
    v_max_f32 v239, s46, v239
    v_rsq_f32 v236, v236
    v_rsq_f32 v237, v237
    v_rsq_f32 v238, v238
    v_rsq_f32 v239, v239
    v_pk_fma_f32 v[228:229], v[232:233], v[16:17], v[228:229] neg_lo:[1,0,0] neg_hi:[1,0,0]
    v_pk_fma_f32 v[230:231], v[234:235], v[16:17], v[230:231] neg_lo:[1,0,0] neg_hi:[1,0,0]
    v_pk_fma_f32 v[4:5], v[228:229], v[236:237], v[18:19]
    v_pk_fma_f32 v[6:7], v[230:231], v[238:239], v[18:19]
    v_max3_f32 v21, v4, v5, v6
    v_max_f32 v21, v21, v7
    v_cmp_lt_f32 vcc, s50, v21
    s_cbranch_vccz L_sm44
    s_call_b64 s[48:49], L_rescale
L_sm44:
    v_exp_f32 v4, v4
    v_exp_f32 v5, v5
    v_exp_f32 v6, v6
    v_exp_f32 v7, v7
    v_pk_mul_f32 v[228:229], v[4:5], v[236:237]
    v_pk_add_f32 v[14:15], v[14:15], v[4:5]
    v_pk_mul_f32 v[230:231], v[6:7], v[238:239]
    v_pk_add_f32 v[14:15], v[14:15], v[6:7]
    v_pk_add_f32 v[240:241], v[240:241], v[228:229]
    v_pk_add_f32 v[242:243], v[242:243], v[230:231]
    v_pk_fma_f32 v[252:253], v[228:229], v[232:233], v[252:253]
    v_pk_fma_f32 v[252:253], v[230:231], v[234:235], v[252:253]
    v_cvt_pk_bf16_f32 v244, v248, v249
    v_cvt_pk_bf16_f32 v245, v250, v251
    v_cvt_pk_bf16_f32 v246, v228, v229
    v_cvt_pk_bf16_f32 v247, v230, v231
    s_add_u32 s51, s51, 1
    s_cmp_lg_u32 s57, 0
    s_cbranch_scc1 L_begun45
L_spin46:
    ds_read_b32 v3, v1 offset:6912
    s_waitcnt lgkmcnt(0)
    v_readfirstlane_b32 s52, v3
    s_nop 0
    s_cmp_ge_u32 s52, s51
    s_cbranch_scc1 L_spun47
    s_sleep 1
    s_branch L_spin46
L_spun47:
    ds_read_b128 v[124:127], v8
    ds_read_b128 v[128:131], v9
    ds_read_b128 v[132:135], v8 offset:128
    ds_read_b128 v[136:139], v9 offset:128
    ds_read_b128 v[140:143], v8 offset:256
    ds_read_b128 v[144:147], v9 offset:256
L_begun45:
    v_mov_b32 v21, 0
    v_mfma_f32_16x16x32_bf16 v[52:55], v[148:151], v[244:247], v[52:55]
    ds_read_b64_tr_b16 v[148:149], v10
    ds_read_b64 v[150:151], v21 offset:7056
    v_mfma_f32_16x16x32_bf16 v[56:59], v[154:157], v[244:247], v[56:59]
    ds_read_b64_tr_b16 v[154:155], v11
    ds_read_b64 v[156:157], v21 offset:7056
    v_mfma_f32_16x16x32_bf16 v[60:63], v[160:163], v[244:247], v[60:63]
    ds_read_b64_tr_b16 v[160:161], v12
    ds_read_b64 v[162:163], v21 offset:7056
    v_mfma_f32_16x16x32_bf16 v[64:67], v[166:169], v[244:247], v[64:67]
    ds_read_b64_tr_b16 v[166:167], v13
    ds_read_b64 v[168:169], v21 offset:7056
    v_mfma_f32_16x16x32_bf16 v[68:71], v[172:175], v[244:247], v[68:71]
    ds_read_b64_tr_b16 v[172:173], v10 offset:128
    ds_read_b64 v[174:175], v21 offset:7056
    v_mfma_f32_16x16x32_bf16 v[72:75], v[178:181], v[244:247], v[72:75]
    ds_read_b64_tr_b16 v[178:179], v11 offset:128
    ds_read_b64 v[180:181], v21 offset:7056
    v_mfma_f32_16x16x32_bf16 v[76:79], v[184:187], v[244:247], v[76:79]
    ds_read_b64_tr_b16 v[184:185], v12 offset:128
    ds_read_b64 v[186:187], v21 offset:7056
    v_mfma_f32_16x16x32_bf16 v[80:83], v[190:193], v[244:247], v[80:83]
    ds_read_b64_tr_b16 v[190:191], v13 offset:128
    ds_read_b64 v[192:193], v21 offset:7056
    v_mfma_f32_16x16x32_bf16 v[84:87], v[196:199], v[244:247], v[84:87]
    ds_read_b64_tr_b16 v[196:197], v10 offset:256
    ds_read_b64 v[198:199], v21 offset:7056
    v_mfma_f32_16x16x32_bf16 v[88:91], v[202:205], v[244:247], v[88:91]
    ds_read_b64_tr_b16 v[202:203], v11 offset:256
    ds_read_b64 v[204:205], v21 offset:7056
    v_mfma_f32_16x16x32_bf16 v[92:95], v[208:211], v[244:247], v[92:95]
    ds_read_b64_tr_b16 v[208:209], v12 offset:256
    ds_read_b64 v[210:211], v21 offset:7056
    v_mfma_f32_16x16x32_bf16 v[96:99], v[214:217], v[244:247], v[96:99]
    ds_read_b64_tr_b16 v[214:215], v13 offset:256
    ds_read_b64 v[216:217], v21 offset:7056
    s_nop 5
L_tile2b:
    s_waitcnt lgkmcnt(15)
    v_mfma_f32_16x16x32_bf16 v[236:239], v[124:127], v[124:127], 0
    v_mfma_f32_16x16x32_bf16 v[4:7], v[124:127], v[100:103], 0
    v_mfma_f32_16x16x32_bf16 v[236:239], v[128:131], v[128:131], v[236:239]
    v_mfma_f32_16x16x32_bf16 v[4:7], v[128:131], v[104:107], v[4:7]
    v_mfma_f32_16x16x32_bf16 v[236:239], v[132:135], v[132:135], v[236:239]
    v_mfma_f32_16x16x32_bf16 v[4:7], v[132:135], v[108:111], v[4:7]
    v_mfma_f32_16x16x32_bf16 v[236:239], v[136:139], v[136:139], v[236:239]
    v_mfma_f32_16x16x32_bf16 v[4:7], v[136:139], v[112:115], v[4:7]
    v_mfma_f32_16x16x32_bf16 v[236:239], v[140:143], v[140:143], v[236:239]
    v_mfma_f32_16x16x32_bf16 v[4:7], v[140:143], v[116:119], v[4:7]
    v_mfma_f32_16x16x32_bf16 v[236:239], v[144:147], v[144:147], v[236:239]
    v_mfma_f32_16x16x32_bf16 v[4:7], v[144:147], v[120:123], v[4:7]
    v_mfma_f32_16x16x32_bf16 v[232:235], v[124:127], v[24:27], v[224:227]
    v_mfma_f32_16x16x32_bf16 v[232:235], v[128:131], v[24:27], v[232:235]
    s_nop 4
    v_mfma_f32_16x16x32_bf16 v[232:235], v[132:135], v[24:27], v[232:235]
    v_cndmask_b32 v22, v236, v237, s[58:59]
    v_cndmask_b32 v23, v238, v239, s[58:59]
    v_mfma_f32_16x16x32_bf16 v[232:235], v[136:139], v[24:27], v[232:235]
    v_cndmask_b32 v4, v4, v5, s[58:59]
    v_cndmask_b32 v6, v6, v7, s[58:59]
    v_mfma_f32_16x16x32_bf16 v[232:235], v[140:143], v[24:27], v[232:235]
    v_cndmask_b32 v22, v22, v23, s[60:61]
    v_cndmask_b32 v4, v4, v6, s[60:61]
    v_mfma_f32_16x16x32_bf16 v[232:235], v[144:147], v[24:27], v[232:235]
    v_add_f32 v22, v22, v255
    v_fma_f32 v22, v4, 2.0, v22
    v_cndmask_b32 v22, 0, v22, s[38:39]
    v_mfma_f32_16x16x32_bf16 v[228:231], v[124:127], v[28:31], v[220:223]
    s_nop 0
    v_mfma_f32_16x16x4_f32 v[236:239], v22, v20, 0
    v_mfma_f32_16x16x32_bf16 v[228:231], v[128:131], v[32:35], v[228:231]
    v_mfma_f32_16x16x32_bf16 v[228:231], v[132:135], v[36:39], v[228:231]
    v_mul_f32 v232, s44, v232
    v_mul_f32 v233, s44, v233
    v_mfma_f32_16x16x32_bf16 v[228:231], v[136:139], v[40:43], v[228:231]
    v_mul_f32 v234, s44, v234
    v_mul_f32 v235, s44, v235
    v_mfma_f32_16x16x32_bf16 v[228:231], v[140:143], v[44:47], v[228:231]
    v_fma_f32 v4, -v232, v232, s46
    v_fma_f32 v5, -v233, v233, s46
    v_mfma_f32_16x16x32_bf16 v[228:231], v[144:147], v[48:51], v[228:231]
    v_fma_f32 v6, -v234, v234, s46
    v_fma_f32 v7, -v235, v235, s46
    ds_read_b32 v3, v1 offset:6912
    v_mov_b32 v2, s51
    s_add_u32 s54, s54, 1
    s_cmp_eq_u32 s54, 6
    s_cselect_b32 s55, 0xffff8800, s56
    s_cselect_b32 s54, 0, s54
    v_add_u32 v8, s55, v8
    v_add_u32 v9, s55, v9
    v_add_u32 v10, s55, v10
    v_add_u32 v11, s55, v11
    v_add_u32 v12, s55, v12
    v_add_u32 v13, s55, v13
    s_waitcnt lgkmcnt(0)
    ds_write_b32 v1, v2 offset:6928
    v_readfirstlane_b32 s52, v3
    s_mov_b32 s57, 0
    s_nop 0
    s_cmp_gt_u32 s52, s51
    s_cbranch_scc0 L_early48
    s_mov_b32 s57, 1
    ds_read_b128 v[124:127], v8
    ds_read_b128 v[128:131], v9
    ds_read_b128 v[132:135], v8 offset:128
    ds_read_b128 v[136:139], v9 offset:128
    ds_read_b128 v[140:143], v8 offset:256
    ds_read_b128 v[144:147], v9 offset:256
L_early48:
    ds_read_b32 v3, v1 offset:6912
    v_fma_f32 v236, v236, s44, v4
    v_fma_f32 v237, v237, s44, v5
    v_fma_f32 v238, v238, s44, v6
    v_fma_f32 v239, v239, s44, v7
    v_max_f32 v236, s46, v236
    v_max_f32 v237, s46, v237
    v_max_f32 v238, s46, v238
    v_max_f32 v239, s46, v239
    v_rsq_f32 v236, v236
    v_rsq_f32 v237, v237
    v_rsq_f32 v238, v238
    v_rsq_f32 v239, v239
    v_pk_fma_f32 v[228:229], v[232:233], v[16:17], v[228:229] neg_lo:[1,0,0] neg_hi:[1,0,0]
    v_pk_fma_f32 v[230:231], v[234:235], v[16:17], v[230:231] neg_lo:[1,0,0] neg_hi:[1,0,0]
    v_pk_fma_f32 v[4:5], v[228:229], v[236:237], v[18:19]
    v_pk_fma_f32 v[6:7], v[230:231], v[238:239], v[18:19]
    v_max3_f32 v21, v4, v5, v6
    v_max_f32 v21, v21, v7
    v_cmp_lt_f32 vcc, s50, v21
    s_cbranch_vccz L_sm49
    s_call_b64 s[48:49], L_rescale
L_sm49:
    v_exp_f32 v4, v4
    v_exp_f32 v5, v5
    v_exp_f32 v6, v6
    v_exp_f32 v7, v7
    v_pk_mul_f32 v[248:249], v[4:5], v[236:237]
    v_pk_add_f32 v[14:15], v[14:15], v[4:5]
    v_pk_mul_f32 v[250:251], v[6:7], v[238:239]
    v_pk_add_f32 v[14:15], v[14:15], v[6:7]
    v_pk_add_f32 v[240:241], v[240:241], v[248:249]
    v_pk_add_f32 v[242:243], v[242:243], v[250:251]
    v_pk_fma_f32 v[252:253], v[248:249], v[232:233], v[252:253]
    v_pk_fma_f32 v[252:253], v[250:251], v[234:235], v[252:253]
    v_cvt_pk_bf16_f32 v244, v248, v249
    v_cvt_pk_bf16_f32 v245, v250, v251
    v_cvt_pk_bf16_f32 v246, -v252, -v253
    v_mov_b32 v247, 0
    s_waitcnt lgkmcnt(0)
    v_readfirstlane_b32 s52, v3
    s_cmp_lg_u32 s57, 0
    s_cbranch_scc1 L_early50
    s_cmp_gt_u32 s52, s51
    s_cbranch_scc0 L_early50
    s_mov_b32 s57, 1
    ds_read_b128 v[124:127], v8
    ds_read_b128 v[128:131], v9
    ds_read_b128 v[132:135], v8 offset:128
    ds_read_b128 v[136:139], v9 offset:128
    ds_read_b128 v[140:143], v8 offset:256
    ds_read_b128 v[144:147], v9 offset:256
L_early50:
    v_mfma_f32_16x16x32_bf16 v[52:55], v[148:151], v[244:247], v[52:55]
    v_mfma_f32_16x16x32_bf16 v[56:59], v[154:157], v[244:247], v[56:59]
    v_mfma_f32_16x16x32_bf16 v[60:63], v[160:163], v[244:247], v[60:63]
    v_mfma_f32_16x16x32_bf16 v[64:67], v[166:169], v[244:247], v[64:67]
    v_mfma_f32_16x16x32_bf16 v[68:71], v[172:175], v[244:247], v[68:71]
    v_mfma_f32_16x16x32_bf16 v[72:75], v[178:181], v[244:247], v[72:75]
    v_mfma_f32_16x16x32_bf16 v[76:79], v[184:187], v[244:247], v[76:79]
    v_mfma_f32_16x16x32_bf16 v[80:83], v[190:193], v[244:247], v[80:83]
    v_mfma_f32_16x16x32_bf16 v[84:87], v[196:199], v[244:247], v[84:87]
    v_mfma_f32_16x16x32_bf16 v[88:91], v[202:205], v[244:247], v[88:91]
    v_mfma_f32_16x16x32_bf16 v[92:95], v[208:211], v[244:247], v[92:95]
    v_mfma_f32_16x16x32_bf16 v[96:99], v[214:217], v[244:247], v[96:99]
    s_cmp_eq_u32 s41, 3
    s_cbranch_scc1 L_last
    s_add_u32 s51, s51, 1
    s_cmp_lg_u32 s57, 0
    s_cbranch_scc1 L_begun51
    s_nop 2
L_spin52:
    ds_read_b32 v3, v1 offset:6912
    s_waitcnt lgkmcnt(0)
    v_readfirstlane_b32 s52, v3
    s_nop 0
    s_cmp_ge_u32 s52, s51
    s_cbranch_scc1 L_spun53
    s_sleep 1
    s_branch L_spin52
L_spun53:
    ds_read_b128 v[124:127], v8
    ds_read_b128 v[128:131], v9
    ds_read_b128 v[132:135], v8 offset:128
    ds_read_b128 v[136:139], v9 offset:128
    ds_read_b128 v[140:143], v8 offset:256
    ds_read_b128 v[144:147], v9 offset:256
L_begun51:
    s_waitcnt lgkmcnt(5)
    v_mfma_f32_16x16x32_bf16 v[236:239], v[124:127], v[124:127], 0
    v_mfma_f32_16x16x32_bf16 v[4:7], v[124:127], v[100:103], 0
    ds_read_b64_tr_b16 v[150:151], v10
    s_waitcnt lgkmcnt(5)
    v_mfma_f32_16x16x32_bf16 v[236:239], v[128:131], v[128:131], v[236:239]
    v_mfma_f32_16x16x32_bf16 v[4:7], v[128:131], v[104:107], v[4:7]
    ds_read_b64_tr_b16 v[156:157], v11
    s_waitcnt lgkmcnt(5)
    v_mfma_f32_16x16x32_bf16 v[236:239], v[132:135], v[132:135], v[236:239]
    ds_read_b64_tr_b16 v[162:163], v12
    v_mfma_f32_16x16x32_bf16 v[4:7], v[132:135], v[108:111], v[4:7]
    ds_read_b64_tr_b16 v[168:169], v13
    s_waitcnt lgkmcnt(6)
    v_mfma_f32_16x16x32_bf16 v[236:239], v[136:139], v[136:139], v[236:239]
    ds_read_b64_tr_b16 v[174:175], v10 offset:128
    v_mfma_f32_16x16x32_bf16 v[4:7], v[136:139], v[112:115], v[4:7]
    ds_read_b64_tr_b16 v[180:181], v11 offset:128
    s_waitcnt lgkmcnt(7)
    v_mfma_f32_16x16x32_bf16 v[236:239], v[140:143], v[140:143], v[236:239]
    ds_read_b64_tr_b16 v[186:187], v12 offset:128
    v_mfma_f32_16x16x32_bf16 v[4:7], v[140:143], v[116:119], v[4:7]
    ds_read_b64_tr_b16 v[192:193], v13 offset:128
    s_waitcnt lgkmcnt(8)
    v_mfma_f32_16x16x32_bf16 v[236:239], v[144:147], v[144:147], v[236:239]
    ds_read_b64_tr_b16 v[198:199], v10 offset:256
    v_mfma_f32_16x16x32_bf16 v[4:7], v[144:147], v[120:123], v[4:7]
    ds_read_b64_tr_b16 v[204:205], v11 offset:256
    v_mfma_f32_16x16x32_bf16 v[232:235], v[124:127], v[24:27], v[224:227]
    ds_read_b64_tr_b16 v[210:211], v12 offset:256
    v_mfma_f32_16x16x32_bf16 v[232:235], v[128:131], v[24:27], v[232:235]
    ds_read_b64_tr_b16 v[216:217], v13 offset:256
    s_nop 2
    v_mfma_f32_16x16x32_bf16 v[232:235], v[132:135], v[24:27], v[232:235]
    v_cndmask_b32 v22, v236, v237, s[58:59]
    v_cndmask_b32 v23, v238, v239, s[58:59]
    v_mfma_f32_16x16x32_bf16 v[232:235], v[136:139], v[24:27], v[232:235]
    v_cndmask_b32 v4, v4, v5, s[58:59]
    v_cndmask_b32 v6, v6, v7, s[58:59]
    v_mfma_f32_16x16x32_bf16 v[232:235], v[140:143], v[24:27], v[232:235]
    v_cndmask_b32 v22, v22, v23, s[60:61]
    v_cndmask_b32 v4, v4, v6, s[60:61]
    v_mfma_f32_16x16x32_bf16 v[232:235], v[144:147], v[24:27], v[232:235]
    v_add_f32 v22, v22, v255
    v_fma_f32 v22, v4, 2.0, v22
    v_cndmask_b32 v22, 0, v22, s[38:39]
    v_mfma_f32_16x16x32_bf16 v[228:231], v[124:127], v[28:31], v[220:223]
    s_nop 0
    v_mfma_f32_16x16x4_f32 v[236:239], v22, v20, 0
    v_mfma_f32_16x16x32_bf16 v[228:231], v[128:131], v[32:35], v[228:231]
    v_mfma_f32_16x16x32_bf16 v[228:231], v[132:135], v[36:39], v[228:231]
    v_mul_f32 v232, s44, v232
    v_mul_f32 v233, s44, v233
    v_mfma_f32_16x16x32_bf16 v[228:231], v[136:139], v[40:43], v[228:231]
    v_mul_f32 v234, s44, v234
    v_mul_f32 v235, s44, v235
    v_mfma_f32_16x16x32_bf16 v[228:231], v[140:143], v[44:47], v[228:231]
    v_fma_f32 v4, -v232, v232, s46
    v_fma_f32 v5, -v233, v233, s46
    v_mfma_f32_16x16x32_bf16 v[228:231], v[144:147], v[48:51], v[228:231]
    v_fma_f32 v6, -v234, v234, s46
    v_fma_f32 v7, -v235, v235, s46
    ds_read_b32 v3, v1 offset:6912
    v_mov_b32 v2, s51
    s_add_u32 s54, s54, 1
    s_cmp_eq_u32 s54, 6
    s_cselect_b32 s55, 0xffff8800, s56
    s_cselect_b32 s54, 0, s54
    v_add_u32 v8, s55, v8
    v_add_u32 v9, s55, v9
    v_add_u32 v10, s55, v10
    v_add_u32 v11, s55, v11
    v_add_u32 v12, s55, v12
    v_add_u32 v13, s55, v13
    s_waitcnt lgkmcnt(0)
    ds_write_b32 v1, v2 offset:6928
    v_readfirstlane_b32 s52, v3
    s_mov_b32 s57, 0
    s_nop 0
    s_cmp_gt_u32 s52, s51
    s_cbranch_scc0 L_early54
    s_mov_b32 s57, 1
    ds_read_b128 v[100:103], v8
    ds_read_b128 v[104:107], v9
    ds_read_b128 v[108:111], v8 offset:128
    ds_read_b128 v[112:115], v9 offset:128
    ds_read_b128 v[116:119], v8 offset:256
    ds_read_b128 v[120:123], v9 offset:256
L_early54:
    v_fma_f32 v236, v236, s44, v4
    v_fma_f32 v237, v237, s44, v5
    v_fma_f32 v238, v238, s44, v6
    v_fma_f32 v239, v239, s44, v7
    v_max_f32 v236, s46, v236
    v_max_f32 v237, s46, v237
    v_max_f32 v238, s46, v238
    v_max_f32 v239, s46, v239
    v_rsq_f32 v236, v236
    v_rsq_f32 v237, v237
    v_rsq_f32 v238, v238
    v_rsq_f32 v239, v239
    v_pk_fma_f32 v[228:229], v[232:233], v[16:17], v[228:229] neg_lo:[1,0,0] neg_hi:[1,0,0]
    v_pk_fma_f32 v[230:231], v[234:235], v[16:17], v[230:231] neg_lo:[1,0,0] neg_hi:[1,0,0]
    v_pk_fma_f32 v[4:5], v[228:229], v[236:237], v[18:19]
    v_pk_fma_f32 v[6:7], v[230:231], v[238:239], v[18:19]
    v_max3_f32 v21, v4, v5, v6
    v_max_f32 v21, v21, v7
    v_cmp_lt_f32 vcc, s50, v21
    s_cbranch_vccz L_sm55
    s_call_b64 s[48:49], L_rescale
L_sm55:
    v_exp_f32 v4, v4
    v_exp_f32 v5, v5
    v_exp_f32 v6, v6
    v_exp_f32 v7, v7
    v_pk_mul_f32 v[228:229], v[4:5], v[236:237]
    v_pk_add_f32 v[14:15], v[14:15], v[4:5]
    v_pk_mul_f32 v[230:231], v[6:7], v[238:239]
    v_pk_add_f32 v[14:15], v[14:15], v[6:7]
    v_pk_add_f32 v[240:241], v[240:241], v[228:229]
    v_pk_add_f32 v[242:243], v[242:243], v[230:231]
    v_pk_mul_f32 v[252:253], v[228:229], v[232:233]
    v_pk_fma_f32 v[252:253], v[230:231], v[234:235], v[252:253]
    v_cvt_pk_bf16_f32 v244, v228, v229
    v_cvt_pk_bf16_f32 v245, v230, v231
    v_cvt_pk_bf16_f32 v246, v240, v241
    v_cvt_pk_bf16_f32 v247, v242, v243
    s_add_u32 s41, s41, 1
    s_nop 0
    s_branch L_loop
L_last:
    s_setprio 2
    v_and_b32 v22, 15, v0
    v_lshrrev_b32 v23, 4, v0
    v_lshlrev_b32 v148, 4, v0
    v_lshlrev_b32 v23, 2, v23
    v_add_u32 v148, s36, v148
    v_lshl_add_u32 v149, v22, 4, v23
    v_add_u32 v149, s36, v149
    s_add_u32 s51, s51, 1
    s_cmp_lg_u32 s57, 0
    s_cbranch_scc1 L_begun56
L_spin57:
    ds_read_b32 v3, v1 offset:6912
    s_waitcnt lgkmcnt(0)
    v_readfirstlane_b32 s52, v3
    s_nop 0
    s_cmp_ge_u32 s52, s51
    s_cbranch_scc0 L_spin57
    ds_read_b128 v[124:127], v8
    ds_read_b128 v[128:131], v9
    ds_read_b128 v[132:135], v8 offset:128
    ds_read_b128 v[136:139], v9 offset:128
    ds_read_b128 v[140:143], v8 offset:256
    ds_read_b128 v[144:147], v9 offset:256
L_begun56:
    s_waitcnt lgkmcnt(5)
    v_mfma_f32_16x16x32_bf16 v[236:239], v[124:127], v[124:127], 0
    v_mfma_f32_16x16x32_bf16 v[4:7], v[124:127], v[100:103], 0
    ds_read_b64_tr_b16 v[150:151], v10
    s_waitcnt lgkmcnt(5)
    v_mfma_f32_16x16x32_bf16 v[236:239], v[128:131], v[128:131], v[236:239]
    v_mfma_f32_16x16x32_bf16 v[4:7], v[128:131], v[104:107], v[4:7]
    ds_read_b64_tr_b16 v[156:157], v11
    s_waitcnt lgkmcnt(5)
    v_mfma_f32_16x16x32_bf16 v[236:239], v[132:135], v[132:135], v[236:239]
    ds_read_b64_tr_b16 v[162:163], v12
    v_mfma_f32_16x16x32_bf16 v[4:7], v[132:135], v[108:111], v[4:7]
    ds_read_b64_tr_b16 v[168:169], v13
    s_waitcnt lgkmcnt(6)
    v_mfma_f32_16x16x32_bf16 v[236:239], v[136:139], v[136:139], v[236:239]
    ds_read_b64_tr_b16 v[174:175], v10 offset:128
    v_mfma_f32_16x16x32_bf16 v[4:7], v[136:139], v[112:115], v[4:7]
    ds_read_b64_tr_b16 v[180:181], v11 offset:128
    s_waitcnt lgkmcnt(7)
    v_mfma_f32_16x16x32_bf16 v[236:239], v[140:143], v[140:143], v[236:239]
    ds_read_b64_tr_b16 v[186:187], v12 offset:128
    v_mfma_f32_16x16x32_bf16 v[4:7], v[140:143], v[116:119], v[4:7]
    ds_read_b64_tr_b16 v[192:193], v13 offset:128
    s_waitcnt lgkmcnt(8)
    v_mfma_f32_16x16x32_bf16 v[236:239], v[144:147], v[144:147], v[236:239]
    ds_read_b64_tr_b16 v[198:199], v10 offset:256
    v_mfma_f32_16x16x32_bf16 v[4:7], v[144:147], v[120:123], v[4:7]
    ds_read_b64_tr_b16 v[204:205], v11 offset:256
    v_mfma_f32_16x16x32_bf16 v[232:235], v[124:127], v[24:27], v[224:227]
    ds_read_b64_tr_b16 v[210:211], v12 offset:256
    v_mfma_f32_16x16x32_bf16 v[232:235], v[128:131], v[24:27], v[232:235]
    ds_read_b64_tr_b16 v[216:217], v13 offset:256
    s_nop 2
    v_mfma_f32_16x16x32_bf16 v[232:235], v[132:135], v[24:27], v[232:235]
    v_cndmask_b32 v22, v236, v237, s[58:59]
    v_cndmask_b32 v23, v238, v239, s[58:59]
    v_mfma_f32_16x16x32_bf16 v[232:235], v[136:139], v[24:27], v[232:235]
    v_cndmask_b32 v4, v4, v5, s[58:59]
    v_cndmask_b32 v6, v6, v7, s[58:59]
    v_mfma_f32_16x16x32_bf16 v[232:235], v[140:143], v[24:27], v[232:235]
    v_cndmask_b32 v22, v22, v23, s[60:61]
    v_cndmask_b32 v4, v4, v6, s[60:61]
    v_mfma_f32_16x16x32_bf16 v[232:235], v[144:147], v[24:27], v[232:235]
    v_add_f32 v22, v22, v255
    v_fma_f32 v22, v4, 2.0, v22
    v_cndmask_b32 v22, 0, v22, s[38:39]
    v_mfma_f32_16x16x32_bf16 v[228:231], v[124:127], v[28:31], v[220:223]
    s_nop 0
    v_mfma_f32_16x16x4_f32 v[236:239], v22, v20, 0
    v_mfma_f32_16x16x32_bf16 v[228:231], v[128:131], v[32:35], v[228:231]
    v_mfma_f32_16x16x32_bf16 v[228:231], v[132:135], v[36:39], v[228:231]
    v_mul_f32 v232, s44, v232
    v_mul_f32 v233, s44, v233
    v_mfma_f32_16x16x32_bf16 v[228:231], v[136:139], v[40:43], v[228:231]
    v_mul_f32 v234, s44, v234
    v_mul_f32 v235, s44, v235
    v_mfma_f32_16x16x32_bf16 v[228:231], v[140:143], v[44:47], v[228:231]
    v_fma_f32 v4, -v232, v232, s46
    v_fma_f32 v5, -v233, v233, s46
    v_mfma_f32_16x16x32_bf16 v[228:231], v[144:147], v[48:51], v[228:231]
    v_fma_f32 v6, -v234, v234, s46
    v_fma_f32 v7, -v235, v235, s46
    s_waitcnt lgkmcnt(0)
    v_fma_f32 v236, v236, s44, v4
    v_fma_f32 v237, v237, s44, v5
    v_fma_f32 v238, v238, s44, v6
    v_fma_f32 v239, v239, s44, v7
    v_max_f32 v236, s46, v236
    v_max_f32 v237, s46, v237
    v_max_f32 v238, s46, v238
    v_max_f32 v239, s46, v239
    v_rsq_f32 v236, v236
    v_rsq_f32 v237, v237
    v_rsq_f32 v238, v238
    v_rsq_f32 v239, v239
    v_pk_fma_f32 v[228:229], v[232:233], v[16:17], v[228:229] neg_lo:[1,0,0] neg_hi:[1,0,0]
    v_pk_fma_f32 v[230:231], v[234:235], v[16:17], v[230:231] neg_lo:[1,0,0] neg_hi:[1,0,0]
    v_pk_fma_f32 v[4:5], v[228:229], v[236:237], v[18:19]
    v_pk_fma_f32 v[6:7], v[230:231], v[238:239], v[18:19]
    v_max3_f32 v21, v4, v5, v6
    v_max_f32 v21, v21, v7
    v_cmp_lt_f32 vcc, s50, v21
    s_cbranch_vccz L_sm59
    s_call_b64 s[48:49], L_rescale
L_sm59:
    v_exp_f32 v4, v4
    v_exp_f32 v5, v5
    v_exp_f32 v6, v6
    v_exp_f32 v7, v7
    v_pk_mul_f32 v[228:229], v[4:5], v[236:237]
    v_pk_mul_f32 v[230:231], v[6:7], v[238:239]
    v_pk_add_f32 v[240:241], v[240:241], v[228:229]
    v_pk_add_f32 v[242:243], v[242:243], v[230:231]
    v_cvt_pk_bf16_f32 v244, v228, v229
    v_cvt_pk_bf16_f32 v245, v230, v231
    v_cvt_pk_bf16_f32 v246, v240, v241
    v_cvt_pk_bf16_f32 v247, v242, v243
    s_nop 1
    v_mfma_f32_16x16x32_bf16 v[52:55], v[150:153], v[244:247], v[52:55]
    v_cmp_neq_f32 vcc, 0, v254
    v_add_f32 v4, v4, v5
    v_add_f32 v6, v6, v7
    v_mfma_f32_16x16x32_bf16 v[56:59], v[156:159], v[244:247], v[56:59]
    v_add_f32 v14, v14, v15
    v_add_f32 v4, v4, v6
    ds_write_b32 v149, v254 offset:12800
    v_mfma_f32_16x16x32_bf16 v[60:63], v[162:165], v[244:247], v[60:63]
    v_add_f32 v14, v14, v4
    s_cmp_eq_u64 vcc, 0
    s_cselect_b32 s40, 1, 2
    v_mov_b32 v154, s40
    ds_write_b32 v149, v14 offset:12288
    v_mfma_f32_16x16x32_bf16 v[64:67], v[168:171], v[244:247], v[64:67]
    v_cvt_pk_bf16_f32 v100, v52, v53
    v_cvt_pk_bf16_f32 v101, v54, v55
    v_mfma_f32_16x16x32_bf16 v[68:71], v[174:177], v[244:247], v[68:71]
    v_cvt_pk_bf16_f32 v102, v56, v57
    v_cvt_pk_bf16_f32 v103, v58, v59
    ds_write_b128 v148, v[100:103]
    v_mfma_f32_16x16x32_bf16 v[72:75], v[180:183], v[244:247], v[72:75]
    v_cvt_pk_bf16_f32 v104, v60, v61
    v_cvt_pk_bf16_f32 v105, v62, v63
    v_mfma_f32_16x16x32_bf16 v[76:79], v[186:189], v[244:247], v[76:79]
    v_cvt_pk_bf16_f32 v106, v64, v65
    v_cvt_pk_bf16_f32 v107, v66, v67
    ds_write_b128 v148, v[104:107] offset:1024
    v_mfma_f32_16x16x32_bf16 v[80:83], v[192:195], v[244:247], v[80:83]
    v_cvt_pk_bf16_f32 v108, v68, v69
    v_cvt_pk_bf16_f32 v109, v70, v71
    v_mfma_f32_16x16x32_bf16 v[84:87], v[198:201], v[244:247], v[84:87]
    v_cvt_pk_bf16_f32 v110, v72, v73
    v_cvt_pk_bf16_f32 v111, v74, v75
    ds_write_b128 v148, v[108:111] offset:2048
    v_mfma_f32_16x16x32_bf16 v[88:91], v[204:207], v[244:247], v[88:91]
    v_cvt_pk_bf16_f32 v112, v76, v77
    v_cvt_pk_bf16_f32 v113, v78, v79
    v_mfma_f32_16x16x32_bf16 v[92:95], v[210:213], v[244:247], v[92:95]
    v_cvt_pk_bf16_f32 v114, v80, v81
    v_cvt_pk_bf16_f32 v115, v82, v83
    ds_write_b128 v148, v[112:115] offset:3072
    v_mfma_f32_16x16x32_bf16 v[96:99], v[216:219], v[244:247], v[96:99]
    v_cvt_pk_bf16_f32 v116, v84, v85
    v_cvt_pk_bf16_f32 v117, v86, v87
    v_cvt_pk_bf16_f32 v118, v88, v89
    v_cvt_pk_bf16_f32 v119, v90, v91
    ds_write_b128 v148, v[116:119] offset:4096
    v_cvt_pk_bf16_f32 v120, v92, v93
    v_cvt_pk_bf16_f32 v121, v94, v95
    s_nop 0
    v_cvt_pk_bf16_f32 v122, v96, v97
    v_cvt_pk_bf16_f32 v123, v98, v99
    ds_write_b128 v148, v[120:123] offset:5120
    ds_write_b32 v1, v154 offset:6992
    s_setprio 0
    s_cmp_lt_u32 s2, 0x80
    s_cbranch_scc1 L_r_end
    s_sub_u32 s53, s2, 0x80
    s_and_b32 s40, s53, 7
    s_lshr_b32 s42, s53, 4
    s_lshl_b32 s42, s42, 3
    s_or_b32 s40, s40, s42
    s_lshl_b32 s40, s40, 1
    s_bfe_u32 s42, s53, 0x10003
    s_or_b32 s53, s40, s42
    s_mov_b32 s24, s4
    s_mov_b32 s25, s5
    s_mov_b32 s26, 0x1800
    s_mov_b32 s27, 0x20000
    s_mov_b32 s28, s18
    s_mov_b32 s29, s19
    s_mov_b32 s30, 0x1800
    s_mov_b32 s31, 0x20000
    v_and_b32 v28, 3, v0
    v_lshrrev_b32 v29, 2, v0
    v_lshlrev_b32 v30, 15, v29
    v_lshl_add_u32 v30, v28, 4, v30
    v_lshlrev_b32 v32, 2, v28
    ds_read_b32 v38, v32 offset:7040
    s_lshl_b32 s40, s3, 19
    s_lshl_b32 s42, s53, 6
    s_add_u32 s40, s40, s42
    s_and_b32 s42, s53, 3
    s_mul_i32 s42, s42, 0x600
    v_mul_u32_u24 v31, 0x180, v28
    v_add_u32 v31, s42, v31
    s_lshr_b32 s42, s53, 5
    s_mul_i32 s6, s42, 0x60
    s_bfe_u32 s42, s53, 0x20002
    s_lshl_b32 s42, s42, 3
    s_add_u32 s6, s6, s42
    s_bitcmp1_b32 s53, 4
    s_cselect_b32 s4, 36, 0
    s_cselect_b32 s5, 64, 4
    s_cselect_b32 s42, 0x44, 32
    s_add_u32 s4, s4, s6
    s_add_u32 s5, s5, s6
    s_add_u32 s6, s6, s42
    buffer_load_dword v56, v31, s[24:27], s4 offen
    buffer_load_dword v57, v31, s[24:27], s5 offen
    buffer_load_dword v58, v31, s[24:27], s6 offen
    v_lshrrev_b32 v32, 4, v0
    v_lshlrev_b32 v34, 7, v32
    v_lshl_add_u32 v34, v28, 5, v34
    s_lshl_b32 s42, s3, 9
    s_add_u32 s42, s42, 0x9400
    v_add_u32 v34, s42, v34
    v_and_b32 v35, 15, v0
    v_lshlrev_b32 v35, 5, v35
    v_mov_b32 v32, 0
    v_mov_b32 v60, 0
    v_mov_b32 v61, 0
    v_mov_b32 v62, 0
    v_mov_b32 v63, 0
    v_mov_b32 v64, 0
    v_mov_b32 v65, 0
    v_mov_b32 v66, 0
    v_mov_b32 v67, 0
    v_mov_b32 v37, 0
    s_mov_b64 s[44:45], -1
    s_mov_b64 s[46:47], -1
    s_mov_b64 s[58:59], -1
    s_mov_b64 s[60:61], -1
    s_mov_b32 s38, 0x3f80
    s_mov_b32 s39, 0x3f800000
    s_waitcnt vmcnt(0) lgkmcnt(0)
    v_lshlrev_b32 v120, 16, v56
    v_and_b32 v121, 0xffff0000, v56
    v_lshlrev_b32 v122, 16, v57
    v_and_b32 v123, 0xffff0000, v57
    v_lshlrev_b32 v124, 16, v58
    v_and_b32 v125, 0xffff0000, v58
    s_nop 1
L_spin60:
    ds_read_b32 v33, v32 offset:6964
    s_waitcnt lgkmcnt(0)
    v_readfirstlane_b32 s42, v33
    s_nop 0
    s_cmp_ge_u32 s42, 4
    s_cbranch_scc1 L_spun61
    s_sleep 1
    s_branch L_spin60
L_spun61:
    s_mov_b64 exec, 0x1111
L_tpre:
    buffer_load_dword v32, v30, s[32:35], s40 offen offset:12 sc1
    s_waitcnt vmcnt(0)
    v_xor_b32 v32, v32, v38
    v_and_b32 v32, 0xfffe, v32
    v_cmp_ne_u32 vcc, 0, v32
    s_cbranch_vccnz L_tpre
    s_mov_b64 exec, -1
    s_nop 2
L_tpoll:
    s_add_u32 s42, s40, 0
    s_cmp_eq_u64 s[44:45], 0
    s_cbranch_scc1 L_tskip62
    s_mov_b64 exec, s[44:45]
    buffer_load_dwordx4 v[40:43], v30, s[32:35], s42 offen sc1
L_tskip62:
    s_add_u32 s42, s40, 0x2000
    s_cmp_eq_u64 s[46:47], 0
    s_cbranch_scc1 L_tskip63
    s_mov_b64 exec, s[46:47]
    buffer_load_dwordx4 v[44:47], v30, s[32:35], s42 offen sc1
L_tskip63:
    s_add_u32 s42, s40, 0x4000
    s_cmp_eq_u64 s[58:59], 0
    s_cbranch_scc1 L_tskip64
    s_mov_b64 exec, s[58:59]
    buffer_load_dwordx4 v[48:51], v30, s[32:35], s42 offen sc1
L_tskip64:
    s_add_u32 s42, s40, 0x6000
    s_cmp_eq_u64 s[60:61], 0
    s_cbranch_scc1 L_tskip65
    s_mov_b64 exec, s[60:61]
    buffer_load_dwordx4 v[52:55], v30, s[32:35], s42 offen sc1
L_tskip65:
    s_waitcnt vmcnt(0)
    s_cmp_eq_u64 s[44:45], 0
    s_cbranch_scc1 L_tchk66
    s_mov_b64 exec, s[44:45]
    v_xor_b32 v36, v43, v38
    v_and_b32 v32, 0xfffe, v36
    v_and_b32 v33, 0xffff0000, v43
    s_nop 2
    v_or_b32_dpp v32, v32, v32 quad_perm:[1,0,3,2] row_mask:0xf bank_mask:0xf
    s_nop 2
    v_or_b32_dpp v32, v32, v32 quad_perm:[2,3,0,1] row_mask:0xf bank_mask:0xf
    v_cmp_eq_u32 vcc, 0, v32
    s_nop 0
    s_andn2_b64 s[44:45], s[44:45], vcc
    s_and_b64 exec, vcc, vcc
    s_cbranch_scc0 L_tchk66
    v_dot2_f32_bf16 v60, v40, s38, v60
    v_dot2_f32_bf16 v61, v40, s39, v61
    v_dot2_f32_bf16 v62, v41, s38, v62
    v_dot2_f32_bf16 v63, v41, s39, v63
    v_dot2_f32_bf16 v64, v42, s38, v64
    v_dot2_f32_bf16 v65, v42, s39, v65
    v_add_f32 v66, v66, v33
    v_or_b32 v37, v37, v36
L_tchk66:
    s_cmp_eq_u64 s[46:47], 0
    s_cbranch_scc1 L_tchk67
    s_mov_b64 exec, s[46:47]
    v_xor_b32 v36, v47, v38
    v_and_b32 v32, 0xfffe, v36
    v_and_b32 v33, 0xffff0000, v47
    s_nop 2
    v_or_b32_dpp v32, v32, v32 quad_perm:[1,0,3,2] row_mask:0xf bank_mask:0xf
    s_nop 2
    v_or_b32_dpp v32, v32, v32 quad_perm:[2,3,0,1] row_mask:0xf bank_mask:0xf
    v_cmp_eq_u32 vcc, 0, v32
    s_nop 0
    s_andn2_b64 s[46:47], s[46:47], vcc
    s_and_b64 exec, vcc, vcc
    s_cbranch_scc0 L_tchk67
    v_dot2_f32_bf16 v60, v44, s38, v60
    v_dot2_f32_bf16 v61, v44, s39, v61
    v_dot2_f32_bf16 v62, v45, s38, v62
    v_dot2_f32_bf16 v63, v45, s39, v63
    v_dot2_f32_bf16 v64, v46, s38, v64
    v_dot2_f32_bf16 v65, v46, s39, v65
    v_add_f32 v66, v66, v33
    v_or_b32 v37, v37, v36
L_tchk67:
    s_cmp_eq_u64 s[58:59], 0
    s_cbranch_scc1 L_tchk68
    s_mov_b64 exec, s[58:59]
    v_xor_b32 v36, v51, v38
    v_and_b32 v32, 0xfffe, v36
    v_and_b32 v33, 0xffff0000, v51
    s_nop 2
    v_or_b32_dpp v32, v32, v32 quad_perm:[1,0,3,2] row_mask:0xf bank_mask:0xf
    s_nop 2
    v_or_b32_dpp v32, v32, v32 quad_perm:[2,3,0,1] row_mask:0xf bank_mask:0xf
    v_cmp_eq_u32 vcc, 0, v32
    s_nop 0
    s_andn2_b64 s[58:59], s[58:59], vcc
    s_and_b64 exec, vcc, vcc
    s_cbranch_scc0 L_tchk68
    v_dot2_f32_bf16 v60, v48, s38, v60
    v_dot2_f32_bf16 v61, v48, s39, v61
    v_dot2_f32_bf16 v62, v49, s38, v62
    v_dot2_f32_bf16 v63, v49, s39, v63
    v_dot2_f32_bf16 v64, v50, s38, v64
    v_dot2_f32_bf16 v65, v50, s39, v65
    v_add_f32 v66, v66, v33
    v_or_b32 v37, v37, v36
L_tchk68:
    s_cmp_eq_u64 s[60:61], 0
    s_cbranch_scc1 L_tchk69
    s_mov_b64 exec, s[60:61]
    v_xor_b32 v36, v55, v38
    v_and_b32 v32, 0xfffe, v36
    v_and_b32 v33, 0xffff0000, v55
    s_nop 2
    v_or_b32_dpp v32, v32, v32 quad_perm:[1,0,3,2] row_mask:0xf bank_mask:0xf
    s_nop 2
    v_or_b32_dpp v32, v32, v32 quad_perm:[2,3,0,1] row_mask:0xf bank_mask:0xf
    v_cmp_eq_u32 vcc, 0, v32
    s_nop 0
    s_andn2_b64 s[60:61], s[60:61], vcc
    s_and_b64 exec, vcc, vcc
    s_cbranch_scc0 L_tchk69
    v_dot2_f32_bf16 v60, v52, s38, v60
    v_dot2_f32_bf16 v61, v52, s39, v61
    v_dot2_f32_bf16 v62, v53, s38, v62
    v_dot2_f32_bf16 v63, v53, s39, v63
    v_dot2_f32_bf16 v64, v54, s38, v64
    v_dot2_f32_bf16 v65, v54, s39, v65
    v_add_f32 v66, v66, v33
    v_or_b32 v37, v37, v36
L_tchk69:
    s_mov_b64 exec, -1
    s_or_b64 s[56:57], s[44:45], s[46:47]
    s_or_b64 vcc, s[58:59], s[60:61]
    s_or_b64 s[56:57], s[56:57], vcc
    s_cbranch_scc0 L_tfull
    s_mov_b32 s54, 0
    s_bcnt1_i32_b64 s42, s[60:61]
    s_cselect_b32 s55, 0x6000, s55
    s_cselect_b64 s[56:57], s[60:61], s[56:57]
    s_add_u32 s54, s54, s42
    s_bcnt1_i32_b64 s42, s[58:59]
    s_cselect_b32 s55, 0x4000, s55
    s_cselect_b64 s[56:57], s[58:59], s[56:57]
    s_add_u32 s54, s54, s42
    s_bcnt1_i32_b64 s42, s[46:47]
    s_cselect_b32 s55, 0x2000, s55
    s_cselect_b64 s[56:57], s[46:47], s[56:57]
    s_add_u32 s54, s54, s42
    s_bcnt1_i32_b64 s42, s[44:45]
    s_cselect_b32 s55, 0, s55
    s_cselect_b64 s[56:57], s[44:45], s[56:57]
    s_add_u32 s54, s54, s42
    s_cmp_le_u32 s54, 32
    s_cbranch_scc1 L_tpoll
    s_ff1_i32_b64 s42, s[56:57]
    s_lshl_b64 exec, 1, s42
    s_add_u32 s55, s55, s40
L_tprobe:
    buffer_load_dword v32, v30, s[32:35], s55 offen offset:12 sc1
    s_waitcnt vmcnt(0)
    v_xor_b32 v32, v32, v38
    v_and_b32 v32, 0xfffe, v32
    v_cmp_ne_u32 vcc, 0, v32
    s_cbranch_vccnz L_tprobe
    s_mov_b64 exec, -1
    s_branch L_tpoll
    s_nop 1
L_tfull:
    v_and_b32 v32, 1, v37
    v_cmp_ne_u32 vcc, 0, v32
    s_cbranch_vccnz L_tgen
    s_nop 3
L_trows:
    v_add_f32_dpp v60, v60, v60 row_ror:4 row_mask:0xf bank_mask:0xf
    v_add_f32_dpp v61, v61, v61 row_ror:4 row_mask:0xf bank_mask:0xf
    v_add_f32_dpp v62, v62, v62 row_ror:4 row_mask:0xf bank_mask:0xf
    v_add_f32_dpp v63, v63, v63 row_ror:4 row_mask:0xf bank_mask:0xf
    v_add_f32_dpp v64, v64, v64 row_ror:4 row_mask:0xf bank_mask:0xf
    v_add_f32_dpp v65, v65, v65 row_ror:4 row_mask:0xf bank_mask:0xf
    v_add_f32_dpp v66, v66, v66 row_ror:4 row_mask:0xf bank_mask:0xf
    v_add_f32_dpp v60, v60, v60 row_ror:8 row_mask:0xf bank_mask:0xf
    v_add_f32_dpp v61, v61, v61 row_ror:8 row_mask:0xf bank_mask:0xf
    v_add_f32_dpp v62, v62, v62 row_ror:8 row_mask:0xf bank_mask:0xf
    v_add_f32_dpp v63, v63, v63 row_ror:8 row_mask:0xf bank_mask:0xf
    v_add_f32_dpp v64, v64, v64 row_ror:8 row_mask:0xf bank_mask:0xf
    v_add_f32_dpp v65, v65, v65 row_ror:8 row_mask:0xf bank_mask:0xf
    v_add_f32_dpp v66, v66, v66 row_ror:8 row_mask:0xf bank_mask:0xf
    s_mov_b32 s46, 0xf000f
    s_mov_b32 s47, 0xf000f
    s_mov_b64 exec, s[46:47]
    ds_write_b128 v34, v[60:63]
    ds_write_b128 v34, v[64:67] offset:16
    s_mov_b64 exec, -1
    s_waitcnt lgkmcnt(0)
    s_barrier
    s_cmp_lg_u32 s3, 0
    s_cbranch_scc1 L_r_end
    ds_read_b128 v[84:87], v35 offset:37904
    ds_read_b128 v[92:95], v35 offset:38416
    ds_read_b128 v[100:103], v35 offset:38928
    ds_read_b128 v[108:111], v35 offset:39440
    ds_read_b128 v[80:83], v35 offset:37888
    ds_read_b128 v[88:91], v35 offset:38400
    ds_read_b128 v[96:99], v35 offset:38912
    ds_read_b128 v[104:107], v35 offset:39424
    s_waitcnt lgkmcnt(4)
    v_or3_b32 v32, v87, v95, v103
    v_or_b32 v32, v32, v111
    v_cmp_ne_u32 vcc, 0, v32
    s_cbranch_vccnz L_fgen
    s_nop 3
L_fsum:
    v_pk_add_f32 v[66:67], v[86:87], v[94:95]
    v_pk_add_f32 v[102:103], v[102:103], v[110:111]
    v_pk_add_f32 v[64:65], v[84:85], v[92:93]
    v_pk_add_f32 v[100:101], v[100:101], v[108:109]
    s_waitcnt lgkmcnt(0)
    v_pk_add_f32 v[60:61], v[80:81], v[88:89]
    v_pk_add_f32 v[96:97], v[96:97], v[104:105]
    v_pk_add_f32 v[62:63], v[82:83], v[90:91]
    v_pk_add_f32 v[98:99], v[98:99], v[106:107]
    v_pk_add_f32 v[66:67], v[66:67], v[102:103]
    v_pk_add_f32 v[64:65], v[64:65], v[100:101]
    v_pk_add_f32 v[60:61], v[60:61], v[96:97]
    v_pk_add_f32 v[62:63], v[62:63], v[98:99]
    v_add_f32_dpp v66, v66, v66 row_ror:4 row_mask:0xf bank_mask:0xf
    v_add_f32_dpp v60, v60, v60 row_ror:4 row_mask:0xf bank_mask:0xf
    v_add_f32_dpp v61, v61, v61 row_ror:4 row_mask:0xf bank_mask:0xf
    v_add_f32_dpp v62, v62, v62 row_ror:4 row_mask:0xf bank_mask:0xf
    v_add_f32_dpp v63, v63, v63 row_ror:4 row_mask:0xf bank_mask:0xf
    v_add_f32_dpp v64, v64, v64 row_ror:4 row_mask:0xf bank_mask:0xf
    v_add_f32_dpp v65, v65, v65 row_ror:4 row_mask:0xf bank_mask:0xf
    v_add_f32_dpp v66, v66, v66 row_ror:8 row_mask:0xf bank_mask:0xf
    v_add_f32_dpp v60, v60, v60 row_ror:8 row_mask:0xf bank_mask:0xf
    v_add_f32_dpp v61, v61, v61 row_ror:8 row_mask:0xf bank_mask:0xf
    v_rcp_f32 v66, v66
    v_add_f32_dpp v62, v62, v62 row_ror:8 row_mask:0xf bank_mask:0xf
    v_add_f32_dpp v63, v63, v63 row_ror:8 row_mask:0xf bank_mask:0xf
    v_add_f32_dpp v64, v64, v64 row_ror:8 row_mask:0xf bank_mask:0xf
    v_add_f32_dpp v65, v65, v65 row_ror:8 row_mask:0xf bank_mask:0xf
    v_pk_mul_f32 v[60:61], v[60:61], v[66:67] op_sel_hi:[1,0]
    v_pk_mul_f32 v[62:63], v[62:63], v[66:67] op_sel_hi:[1,0]
    v_pk_mul_f32 v[64:65], v[64:65], v[66:67] op_sel_hi:[1,0]
    v_cvt_pk_bf16_f32 v56, v60, v61
    v_cvt_pk_bf16_f32 v57, v62, v63
    v_cvt_pk_bf16_f32 v58, v64, v65
    v_lshlrev_b32 v60, 16, v56
    v_and_b32 v61, 0xffff0000, v56
    v_lshlrev_b32 v62, 16, v57
    v_and_b32 v63, 0xffff0000, v57
    v_lshlrev_b32 v64, 16, v58
    v_and_b32 v65, 0xffff0000, v58
    v_pk_add_f32 v[60:61], v[60:61], v[120:121]
    v_pk_add_f32 v[62:63], v[62:63], v[122:123]
    v_pk_add_f32 v[64:65], v[64:65], v[124:125]
    s_mov_b64 exec, 15
    v_cvt_pk_bf16_f32 v56, v60, v61
    buffer_store_dword v56, v31, s[28:31], s4 offen
    v_cvt_pk_bf16_f32 v57, v62, v63
    buffer_store_dword v57, v31, s[28:31], s5 offen
    v_cvt_pk_bf16_f32 v58, v64, v65
    buffer_store_dword v58, v31, s[28:31], s6 offen
    s_mov_b64 exec, -1
L_r_end:
    s_endpgm
L_tgen:
    s_nop 3
    v_mov_b32 v32, 0
    ds_read_b64 v[72:73], v32 offset:7040
    v_lshlrev_b32 v71, 9, v29
    v_lshl_add_u32 v71, v28, 3, v71
    s_and_b32 s42, s53, 3
    s_lshl_b32 s42, s42, 5
    s_lshl_b32 s55, s3, 13
    s_add_u32 s55, s55, s42
    s_add_u32 s55, s55, 0x400000
    s_waitcnt lgkmcnt(0)
    v_lshl_or_b32 v70, v73, 16, v72
    v_mov_b32 v112, 0
    v_and_b32 v32, 1, v43
    v_cmp_ne_u32 vcc, 0, v32
    s_nop 0
    s_and_b64 exec, vcc, vcc
    s_cbranch_scc0 L_tg0e
    s_nop 1
L_tg0:
    buffer_load_dwordx2 v[112:113], v71, s[32:35], s55 offen sc1
    s_waitcnt vmcnt(0)
    v_cmp_ne_u32 vcc, v113, v70
    s_cbranch_vccnz L_tg0
L_tg0e:
    s_mov_b64 exec, -1
    v_mov_b32 v114, 0
    v_and_b32 v32, 1, v47
    v_cmp_ne_u32 vcc, 0, v32
    s_nop 0
    s_and_b64 exec, vcc, vcc
    s_cbranch_scc0 L_tg1e
    s_nop 1
L_tg1:
    buffer_load_dwordx2 v[114:115], v71, s[32:35], s55 offen offset:128 sc1
    s_waitcnt vmcnt(0)
    v_cmp_ne_u32 vcc, v115, v70
    s_cbranch_vccnz L_tg1
L_tg1e:
    s_mov_b64 exec, -1
    v_mov_b32 v116, 0
    v_and_b32 v32, 1, v51
    v_cmp_ne_u32 vcc, 0, v32
    s_nop 0
    s_and_b64 exec, vcc, vcc
    s_cbranch_scc0 L_tg2e
    s_nop 1
L_tg2:
    buffer_load_dwordx2 v[116:117], v71, s[32:35], s55 offen offset:256 sc1
    s_waitcnt vmcnt(0)
    v_cmp_ne_u32 vcc, v117, v70
    s_cbranch_vccnz L_tg2
L_tg2e:
    s_mov_b64 exec, -1
    v_mov_b32 v118, 0
    v_and_b32 v32, 1, v55
    v_cmp_ne_u32 vcc, 0, v32
    s_nop 0
    s_and_b64 exec, vcc, vcc
    s_cbranch_scc0 L_tg3e
    s_nop 1
L_tg3:
    buffer_load_dwordx2 v[118:119], v71, s[32:35], s55 offen offset:384 sc1
    s_waitcnt vmcnt(0)
    v_cmp_ne_u32 vcc, v119, v70
    s_cbranch_vccnz L_tg3
L_tg3e:
    s_mov_b64 exec, -1
    v_max3_f32 v67, v112, v114, v116
    v_max_f32 v67, v67, v118
    s_nop 1
    v_max_f32_dpp v67, v67, v67 row_ror:4 row_mask:0xf bank_mask:0xf
    s_nop 1
    v_max_f32_dpp v67, v67, v67 row_ror:8 row_mask:0xf bank_mask:0xf
    v_mov_b32 v32, v67
    v_mov_b32 v33, v67
    s_nop 1
    v_permlane32_swap_b32 v32, v33
    v_max_f32 v67, v32, v33
    v_mov_b32 v32, v67
    v_mov_b32 v33, v67
    s_nop 1
    v_permlane16_swap_b32 v32, v33
    v_max_f32 v67, v32, v33
    v_mov_b32 v60, 0
    v_mov_b32 v61, 0
    v_mov_b32 v62, 0
    v_mov_b32 v63, 0
    v_mov_b32 v64, 0
    v_mov_b32 v65, 0
    v_mov_b32 v66, 0
    v_sub_f32 v36, v112, v67
    v_exp_f32 v36, v36
    v_lshlrev_b32 v32, 16, v40
    v_fmac_f32 v60, v36, v32
    v_and_b32 v32, 0xffff0000, v40
    v_fmac_f32 v61, v36, v32
    v_lshlrev_b32 v32, 16, v41
    v_fmac_f32 v62, v36, v32
    v_and_b32 v32, 0xffff0000, v41
    v_fmac_f32 v63, v36, v32
    v_lshlrev_b32 v32, 16, v42
    v_fmac_f32 v64, v36, v32
    v_and_b32 v32, 0xffff0000, v42
    v_fmac_f32 v65, v36, v32
    v_and_b32 v32, 0xffff0000, v43
    v_fmac_f32 v66, v36, v32
    v_sub_f32 v36, v114, v67
    v_exp_f32 v36, v36
    v_lshlrev_b32 v32, 16, v44
    v_fmac_f32 v60, v36, v32
    v_and_b32 v32, 0xffff0000, v44
    v_fmac_f32 v61, v36, v32
    v_lshlrev_b32 v32, 16, v45
    v_fmac_f32 v62, v36, v32
    v_and_b32 v32, 0xffff0000, v45
    v_fmac_f32 v63, v36, v32
    v_lshlrev_b32 v32, 16, v46
    v_fmac_f32 v64, v36, v32
    v_and_b32 v32, 0xffff0000, v46
    v_fmac_f32 v65, v36, v32
    v_and_b32 v32, 0xffff0000, v47
    v_fmac_f32 v66, v36, v32
    v_sub_f32 v36, v116, v67
    v_exp_f32 v36, v36
    v_lshlrev_b32 v32, 16, v48
    v_fmac_f32 v60, v36, v32
    v_and_b32 v32, 0xffff0000, v48
    v_fmac_f32 v61, v36, v32
    v_lshlrev_b32 v32, 16, v49
    v_fmac_f32 v62, v36, v32
    v_and_b32 v32, 0xffff0000, v49
    v_fmac_f32 v63, v36, v32
    v_lshlrev_b32 v32, 16, v50
    v_fmac_f32 v64, v36, v32
    v_and_b32 v32, 0xffff0000, v50
    v_fmac_f32 v65, v36, v32
    v_and_b32 v32, 0xffff0000, v51
    v_fmac_f32 v66, v36, v32
    v_sub_f32 v36, v118, v67
    v_exp_f32 v36, v36
    v_lshlrev_b32 v32, 16, v52
    v_fmac_f32 v60, v36, v32
    v_and_b32 v32, 0xffff0000, v52
    v_fmac_f32 v61, v36, v32
    v_lshlrev_b32 v32, 16, v53
    v_fmac_f32 v62, v36, v32
    v_and_b32 v32, 0xffff0000, v53
    v_fmac_f32 v63, v36, v32
    v_lshlrev_b32 v32, 16, v54
    v_fmac_f32 v64, v36, v32
    v_and_b32 v32, 0xffff0000, v54
    v_fmac_f32 v65, v36, v32
    v_and_b32 v32, 0xffff0000, v55
    v_fmac_f32 v66, v36, v32
    s_nop 1
    s_branch L_trows
L_fgen:
    s_waitcnt lgkmcnt(0)
    v_max3_f32 v67, v87, v95, v103
    v_max_f32 v67, v67, v111
    v_sub_f32 v32, v87, v67
    v_exp_f32 v32, v32
    s_nop 0
    v_mul_f32 v80, v80, v32
    v_mul_f32 v81, v81, v32
    v_mul_f32 v82, v82, v32
    v_mul_f32 v83, v83, v32
    v_mul_f32 v84, v84, v32
    v_mul_f32 v85, v85, v32
    v_mul_f32 v86, v86, v32
    v_sub_f32 v32, v95, v67
    v_exp_f32 v32, v32
    s_nop 0
    v_mul_f32 v88, v88, v32
    v_mul_f32 v89, v89, v32
    v_mul_f32 v90, v90, v32
    v_mul_f32 v91, v91, v32
    v_mul_f32 v92, v92, v32
    v_mul_f32 v93, v93, v32
    v_mul_f32 v94, v94, v32
    v_sub_f32 v32, v103, v67
    v_exp_f32 v32, v32
    s_nop 0
    v_mul_f32 v96, v96, v32
    v_mul_f32 v97, v97, v32
    v_mul_f32 v98, v98, v32
    v_mul_f32 v99, v99, v32
    v_mul_f32 v100, v100, v32
    v_mul_f32 v101, v101, v32
    v_mul_f32 v102, v102, v32
    v_sub_f32 v32, v111, v67
    v_exp_f32 v32, v32
    s_nop 0
    v_mul_f32 v104, v104, v32
    v_mul_f32 v105, v105, v32
    v_mul_f32 v106, v106, v32
    v_mul_f32 v107, v107, v32
    v_mul_f32 v108, v108, v32
    v_mul_f32 v109, v109, v32
    v_mul_f32 v110, v110, v32
    s_nop 1
    s_branch L_fsum
L_qkprod:
    s_getpc_b64 s[28:29]
    s_mov_b32 s30, 0x1000
    s_mov_b32 s31, 0x20000
    v_lshlrev_b32 v31, 6, v0
    buffer_load_dword v50, v31, s[28:31], 0 offen
    v_and_b32 v28, 15, v0
    v_lshrrev_b32 v29, 4, v0
    v_mov_b32 v30, 0
    v_lshlrev_b32 v47, 4, v0
    v_add_u32 v47, 0, v47
    v_mul_u32_u24 v31, 0x180, v28
    v_and_b32 v32, 1, v29
    v_lshl_add_u32 v31, v32, 3, v31
    v_add_u32 v31, 0x1c00, v31
    v_lshrrev_b32 v32, 1, v29
    v_and_b32 v37, 6, v28
    v_xor_b32 v32, v32, v37
    v_xor_b32 v34, 0, v32
    v_lshl_add_u32 v34, v34, 4, v31
    v_xor_b32 v35, 2, v32
    v_lshl_add_u32 v35, v35, 4, v31
    v_xor_b32 v36, 4, v32
    v_lshl_add_u32 v36, v36, 4, v31
    v_xor_b32 v37, 6, v32
    v_lshl_add_u32 v37, v37, 4, v31
    v_lshrrev_b32 v31, 2, v28
    v_lshl_add_u32 v31, v29, 2, v31
    v_and_b32 v32, 6, v31
    v_mul_u32_u24 v31, 0x180, v31
    v_and_b32 v41, 3, v28
    v_lshl_add_u32 v31, v41, 3, v31
    s_mul_i32 s53, s3, 3
    s_add_u32 s53, s53, 0
    s_and_b32 s40, s53, 3
    s_lshl_b32 s40, s40, 1
    v_xor_b32 v38, s40, v32
    v_lshl_add_u32 v38, v38, 4, v31
    s_lshr_b32 s40, s53, 2
    s_lshl_b32 s40, s40, 7
    s_add_u32 s40, s40, 0x6400
    v_add_u32 v38, s40, v38
    v_add_u32 v41, 0x12000, v38
    s_lshr_b32 s40, s53, 1
    s_lshl_b32 s40, s40, 10
    s_and_b32 s42, s53, 1
    s_lshl_b32 s42, s42, 3
    s_add_u32 s40, s40, s42
    v_add_u32 v44, s40, v47
    s_mul_i32 s53, s3, 3
    s_add_u32 s53, s53, 1
    s_and_b32 s40, s53, 3
    s_lshl_b32 s40, s40, 1
    v_xor_b32 v39, s40, v32
    v_lshl_add_u32 v39, v39, 4, v31
    s_lshr_b32 s40, s53, 2
    s_lshl_b32 s40, s40, 7
    s_add_u32 s40, s40, 0x6400
    v_add_u32 v39, s40, v39
    v_add_u32 v42, 0x12000, v39
    s_lshr_b32 s40, s53, 1
    s_lshl_b32 s40, s40, 10
    s_and_b32 s42, s53, 1
    s_lshl_b32 s42, s42, 3
    s_add_u32 s40, s40, s42
    v_add_u32 v45, s40, v47
    s_mul_i32 s53, s3, 3
    s_add_u32 s53, s53, 2
    s_and_b32 s40, s53, 3
    s_lshl_b32 s40, s40, 1
    v_xor_b32 v40, s40, v32
    v_lshl_add_u32 v40, v40, 4, v31
    s_lshr_b32 s40, s53, 2
    s_lshl_b32 s40, s40, 7
    s_add_u32 s40, s40, 0x6400
    v_add_u32 v40, s40, v40
    v_add_u32 v43, 0x12000, v40
    s_lshr_b32 s40, s53, 1
    s_lshl_b32 s40, s40, 10
    s_and_b32 s42, s53, 1
    s_lshl_b32 s42, s42, 3
    s_add_u32 s40, s40, s42
    v_add_u32 v46, s40, v47
    s_nop 1
L_spin70:
    ds_read_b32 v31, v30 offset:6956
    s_waitcnt lgkmcnt(0)
    v_readfirstlane_b32 s40, v31
    s_nop 0
    s_cmp_ge_u32 s40, 1
    s_cbranch_scc1 L_spun71
    s_sleep 1
    s_branch L_spin70
L_spun71:
    ds_read_b64 v[52:53], v34
    ds_read_b64 v[54:55], v35
    ds_read_b64 v[56:57], v36
    ds_read_b64 v[58:59], v37
    ds_read_b64 v[60:61], v34 offset:128
    ds_read_b64 v[62:63], v35 offset:128
    ds_read_b64 v[64:65], v36 offset:128
    ds_read_b64 v[66:67], v37 offset:128
    ds_read_b64 v[68:69], v34 offset:256
    ds_read_b64 v[70:71], v35 offset:256
    ds_read_b64 v[72:73], v36 offset:256
    ds_read_b64 v[74:75], v37 offset:256
    v_mov_b32 v77, 0x3f803f80
    s_waitcnt lgkmcnt(0)
    v_dot2_f32_bf16 v76, v52, v77, 0
    v_dot2_f32_bf16 v76, v53, v77, v76
    v_dot2_f32_bf16 v76, v54, v77, v76
    v_dot2_f32_bf16 v76, v55, v77, v76
    v_dot2_f32_bf16 v76, v56, v77, v76
    v_dot2_f32_bf16 v76, v57, v77, v76
    v_dot2_f32_bf16 v76, v58, v77, v76
    v_dot2_f32_bf16 v76, v59, v77, v76
    v_dot2_f32_bf16 v76, v60, v77, v76
    v_dot2_f32_bf16 v76, v61, v77, v76
    v_dot2_f32_bf16 v76, v62, v77, v76
    v_dot2_f32_bf16 v76, v63, v77, v76
    v_dot2_f32_bf16 v76, v64, v77, v76
    v_dot2_f32_bf16 v76, v65, v77, v76
    v_dot2_f32_bf16 v76, v66, v77, v76
    v_dot2_f32_bf16 v76, v67, v77, v76
    v_dot2_f32_bf16 v76, v68, v77, v76
    v_dot2_f32_bf16 v76, v69, v77, v76
    v_dot2_f32_bf16 v76, v70, v77, v76
    v_dot2_f32_bf16 v76, v71, v77, v76
    v_dot2_f32_bf16 v76, v72, v77, v76
    v_dot2_f32_bf16 v76, v73, v77, v76
    v_dot2_f32_bf16 v76, v74, v77, v76
    v_dot2_f32_bf16 v76, v75, v77, v76
    s_nop 2
    v_mov_b32 v31, v76
    v_mov_b32 v32, v76
    s_nop 1
    v_permlane32_swap_b32 v31, v32
    v_add_f32 v76, v31, v32
    v_mov_b32 v31, v76
    v_mov_b32 v32, v76
    s_nop 1
    v_permlane16_swap_b32 v31, v32
    v_add_f32 v76, v31, v32
    v_mul_f32 v78, s44, v76
    v_mul_f32 v79, s44, v76
    v_lshlrev_b32 v82, 16, v52
    v_and_b32 v83, 0xffff0000, v52
    v_pk_add_f32 v[82:83], v[82:83], v[78:79] neg_lo:[0,1] neg_hi:[0,1]
    v_pk_mul_f32 v[80:81], v[82:83], v[82:83]
    v_lshlrev_b32 v84, 16, v53
    v_and_b32 v85, 0xffff0000, v53
    v_pk_add_f32 v[84:85], v[84:85], v[78:79] neg_lo:[0,1] neg_hi:[0,1]
    v_pk_fma_f32 v[80:81], v[84:85], v[84:85], v[80:81]
    v_lshlrev_b32 v82, 16, v54
    v_and_b32 v83, 0xffff0000, v54
    v_pk_add_f32 v[82:83], v[82:83], v[78:79] neg_lo:[0,1] neg_hi:[0,1]
    v_pk_fma_f32 v[80:81], v[82:83], v[82:83], v[80:81]
    v_lshlrev_b32 v84, 16, v55
    v_and_b32 v85, 0xffff0000, v55
    v_pk_add_f32 v[84:85], v[84:85], v[78:79] neg_lo:[0,1] neg_hi:[0,1]
    v_pk_fma_f32 v[80:81], v[84:85], v[84:85], v[80:81]
    v_lshlrev_b32 v82, 16, v56
    v_and_b32 v83, 0xffff0000, v56
    v_pk_add_f32 v[82:83], v[82:83], v[78:79] neg_lo:[0,1] neg_hi:[0,1]
    v_pk_fma_f32 v[80:81], v[82:83], v[82:83], v[80:81]
    v_lshlrev_b32 v84, 16, v57
    v_and_b32 v85, 0xffff0000, v57
    v_pk_add_f32 v[84:85], v[84:85], v[78:79] neg_lo:[0,1] neg_hi:[0,1]
    v_pk_fma_f32 v[80:81], v[84:85], v[84:85], v[80:81]
    v_lshlrev_b32 v82, 16, v58
    v_and_b32 v83, 0xffff0000, v58
    v_pk_add_f32 v[82:83], v[82:83], v[78:79] neg_lo:[0,1] neg_hi:[0,1]
    v_pk_fma_f32 v[80:81], v[82:83], v[82:83], v[80:81]
    v_lshlrev_b32 v84, 16, v59
    v_and_b32 v85, 0xffff0000, v59
    v_pk_add_f32 v[84:85], v[84:85], v[78:79] neg_lo:[0,1] neg_hi:[0,1]
    v_pk_fma_f32 v[80:81], v[84:85], v[84:85], v[80:81]
    v_lshlrev_b32 v82, 16, v60
    v_and_b32 v83, 0xffff0000, v60
    v_pk_add_f32 v[82:83], v[82:83], v[78:79] neg_lo:[0,1] neg_hi:[0,1]
    v_pk_fma_f32 v[80:81], v[82:83], v[82:83], v[80:81]
    v_lshlrev_b32 v84, 16, v61
    v_and_b32 v85, 0xffff0000, v61
    v_pk_add_f32 v[84:85], v[84:85], v[78:79] neg_lo:[0,1] neg_hi:[0,1]
    v_pk_fma_f32 v[80:81], v[84:85], v[84:85], v[80:81]
    v_lshlrev_b32 v82, 16, v62
    v_and_b32 v83, 0xffff0000, v62
    v_pk_add_f32 v[82:83], v[82:83], v[78:79] neg_lo:[0,1] neg_hi:[0,1]
    v_pk_fma_f32 v[80:81], v[82:83], v[82:83], v[80:81]
    v_lshlrev_b32 v84, 16, v63
    v_and_b32 v85, 0xffff0000, v63
    v_pk_add_f32 v[84:85], v[84:85], v[78:79] neg_lo:[0,1] neg_hi:[0,1]
    v_pk_fma_f32 v[80:81], v[84:85], v[84:85], v[80:81]
    v_lshlrev_b32 v82, 16, v64
    v_and_b32 v83, 0xffff0000, v64
    v_pk_add_f32 v[82:83], v[82:83], v[78:79] neg_lo:[0,1] neg_hi:[0,1]
    v_pk_fma_f32 v[80:81], v[82:83], v[82:83], v[80:81]
    v_lshlrev_b32 v84, 16, v65
    v_and_b32 v85, 0xffff0000, v65
    v_pk_add_f32 v[84:85], v[84:85], v[78:79] neg_lo:[0,1] neg_hi:[0,1]
    v_pk_fma_f32 v[80:81], v[84:85], v[84:85], v[80:81]
    v_lshlrev_b32 v82, 16, v66
    v_and_b32 v83, 0xffff0000, v66
    v_pk_add_f32 v[82:83], v[82:83], v[78:79] neg_lo:[0,1] neg_hi:[0,1]
    v_pk_fma_f32 v[80:81], v[82:83], v[82:83], v[80:81]
    v_lshlrev_b32 v84, 16, v67
    v_and_b32 v85, 0xffff0000, v67
    v_pk_add_f32 v[84:85], v[84:85], v[78:79] neg_lo:[0,1] neg_hi:[0,1]
    v_pk_fma_f32 v[80:81], v[84:85], v[84:85], v[80:81]
    v_lshlrev_b32 v82, 16, v68
    v_and_b32 v83, 0xffff0000, v68
    v_pk_add_f32 v[82:83], v[82:83], v[78:79] neg_lo:[0,1] neg_hi:[0,1]
    v_pk_fma_f32 v[80:81], v[82:83], v[82:83], v[80:81]
    v_lshlrev_b32 v84, 16, v69
    v_and_b32 v85, 0xffff0000, v69
    v_pk_add_f32 v[84:85], v[84:85], v[78:79] neg_lo:[0,1] neg_hi:[0,1]
    v_pk_fma_f32 v[80:81], v[84:85], v[84:85], v[80:81]
    v_lshlrev_b32 v82, 16, v70
    v_and_b32 v83, 0xffff0000, v70
    v_pk_add_f32 v[82:83], v[82:83], v[78:79] neg_lo:[0,1] neg_hi:[0,1]
    v_pk_fma_f32 v[80:81], v[82:83], v[82:83], v[80:81]
    v_lshlrev_b32 v84, 16, v71
    v_and_b32 v85, 0xffff0000, v71
    v_pk_add_f32 v[84:85], v[84:85], v[78:79] neg_lo:[0,1] neg_hi:[0,1]
    v_pk_fma_f32 v[80:81], v[84:85], v[84:85], v[80:81]
    v_lshlrev_b32 v82, 16, v72
    v_and_b32 v83, 0xffff0000, v72
    v_pk_add_f32 v[82:83], v[82:83], v[78:79] neg_lo:[0,1] neg_hi:[0,1]
    v_pk_fma_f32 v[80:81], v[82:83], v[82:83], v[80:81]
    v_lshlrev_b32 v84, 16, v73
    v_and_b32 v85, 0xffff0000, v73
    v_pk_add_f32 v[84:85], v[84:85], v[78:79] neg_lo:[0,1] neg_hi:[0,1]
    v_pk_fma_f32 v[80:81], v[84:85], v[84:85], v[80:81]
    v_lshlrev_b32 v82, 16, v74
    v_and_b32 v83, 0xffff0000, v74
    v_pk_add_f32 v[82:83], v[82:83], v[78:79] neg_lo:[0,1] neg_hi:[0,1]
    v_pk_fma_f32 v[80:81], v[82:83], v[82:83], v[80:81]
    v_lshlrev_b32 v84, 16, v75
    v_and_b32 v85, 0xffff0000, v75
    v_pk_add_f32 v[84:85], v[84:85], v[78:79] neg_lo:[0,1] neg_hi:[0,1]
    v_pk_fma_f32 v[80:81], v[84:85], v[84:85], v[80:81]
    v_add_f32 v80, v80, v81
    v_mov_b32 v31, v80
    v_mov_b32 v32, v80
    s_nop 1
    v_permlane32_swap_b32 v31, v32
    v_add_f32 v80, v31, v32
    v_mov_b32 v31, v80
    v_mov_b32 v32, v80
    s_nop 1
    v_permlane16_swap_b32 v31, v32
    v_add_f32 v80, v31, v32
    v_mul_f32 v80, s44, v80
    v_cvt_pk_bf16_f32 v78, v78, v78
    v_and_b32 v78, 0xffff0000, v78
    v_mov_b32 v79, v78
    v_cvt_pk_bf16_f32 v80, v80, v80
    v_and_b32 v80, 0xffff0000, v80
    v_add_f32 v80, 0x3727c5ac, v80
    v_cvt_pk_bf16_f32 v80, v80, v80
    v_and_b32 v80, 0xffff0000, v80
    v_sqrt_f32 v80, v80
    s_nop 0
    v_cvt_pk_bf16_f32 v80, v80, v80
    v_and_b32 v80, 0xffff0000, v80
    v_rcp_f32 v80, v80
    s_nop 0
    v_mov_b32 v81, v80
    v_lshlrev_b32 v82, 16, v52
    v_and_b32 v83, 0xffff0000, v52
    v_pk_add_f32 v[82:83], v[82:83], v[78:79] neg_lo:[0,1] neg_hi:[0,1]
    v_cvt_pk_bf16_f32 v52, v82, v83
    v_lshlrev_b32 v82, 16, v52
    v_and_b32 v83, 0xffff0000, v52
    v_pk_mul_f32 v[82:83], v[82:83], v[80:81]
    v_cvt_pk_bf16_f32 v52, v82, v83
    v_lshlrev_b32 v84, 16, v53
    v_and_b32 v85, 0xffff0000, v53
    v_pk_add_f32 v[84:85], v[84:85], v[78:79] neg_lo:[0,1] neg_hi:[0,1]
    v_cvt_pk_bf16_f32 v53, v84, v85
    v_lshlrev_b32 v84, 16, v53
    v_and_b32 v85, 0xffff0000, v53
    v_pk_mul_f32 v[84:85], v[84:85], v[80:81]
    v_cvt_pk_bf16_f32 v53, v84, v85
    v_lshlrev_b32 v82, 16, v54
    v_and_b32 v83, 0xffff0000, v54
    v_pk_add_f32 v[82:83], v[82:83], v[78:79] neg_lo:[0,1] neg_hi:[0,1]
    v_cvt_pk_bf16_f32 v54, v82, v83
    v_lshlrev_b32 v82, 16, v54
    v_and_b32 v83, 0xffff0000, v54
    v_pk_mul_f32 v[82:83], v[82:83], v[80:81]
    v_cvt_pk_bf16_f32 v54, v82, v83
    v_lshlrev_b32 v84, 16, v55
    v_and_b32 v85, 0xffff0000, v55
    v_pk_add_f32 v[84:85], v[84:85], v[78:79] neg_lo:[0,1] neg_hi:[0,1]
    v_cvt_pk_bf16_f32 v55, v84, v85
    v_lshlrev_b32 v84, 16, v55
    v_and_b32 v85, 0xffff0000, v55
    v_pk_mul_f32 v[84:85], v[84:85], v[80:81]
    v_cvt_pk_bf16_f32 v55, v84, v85
    v_lshlrev_b32 v82, 16, v56
    v_and_b32 v83, 0xffff0000, v56
    v_pk_add_f32 v[82:83], v[82:83], v[78:79] neg_lo:[0,1] neg_hi:[0,1]
    v_cvt_pk_bf16_f32 v56, v82, v83
    v_lshlrev_b32 v82, 16, v56
    v_and_b32 v83, 0xffff0000, v56
    v_pk_mul_f32 v[82:83], v[82:83], v[80:81]
    v_cvt_pk_bf16_f32 v56, v82, v83
    v_lshlrev_b32 v84, 16, v57
    v_and_b32 v85, 0xffff0000, v57
    v_pk_add_f32 v[84:85], v[84:85], v[78:79] neg_lo:[0,1] neg_hi:[0,1]
    v_cvt_pk_bf16_f32 v57, v84, v85
    v_lshlrev_b32 v84, 16, v57
    v_and_b32 v85, 0xffff0000, v57
    v_pk_mul_f32 v[84:85], v[84:85], v[80:81]
    v_cvt_pk_bf16_f32 v57, v84, v85
    v_lshlrev_b32 v82, 16, v58
    v_and_b32 v83, 0xffff0000, v58
    v_pk_add_f32 v[82:83], v[82:83], v[78:79] neg_lo:[0,1] neg_hi:[0,1]
    v_cvt_pk_bf16_f32 v58, v82, v83
    v_lshlrev_b32 v82, 16, v58
    v_and_b32 v83, 0xffff0000, v58
    v_pk_mul_f32 v[82:83], v[82:83], v[80:81]
    v_cvt_pk_bf16_f32 v58, v82, v83
    v_lshlrev_b32 v84, 16, v59
    v_and_b32 v85, 0xffff0000, v59
    v_pk_add_f32 v[84:85], v[84:85], v[78:79] neg_lo:[0,1] neg_hi:[0,1]
    v_cvt_pk_bf16_f32 v59, v84, v85
    v_lshlrev_b32 v84, 16, v59
    v_and_b32 v85, 0xffff0000, v59
    v_pk_mul_f32 v[84:85], v[84:85], v[80:81]
    v_cvt_pk_bf16_f32 v59, v84, v85
    v_lshlrev_b32 v82, 16, v60
    v_and_b32 v83, 0xffff0000, v60
    v_pk_add_f32 v[82:83], v[82:83], v[78:79] neg_lo:[0,1] neg_hi:[0,1]
    v_cvt_pk_bf16_f32 v60, v82, v83
    v_lshlrev_b32 v82, 16, v60
    v_and_b32 v83, 0xffff0000, v60
    v_pk_mul_f32 v[82:83], v[82:83], v[80:81]
    v_cvt_pk_bf16_f32 v60, v82, v83
    v_lshlrev_b32 v84, 16, v61
    v_and_b32 v85, 0xffff0000, v61
    v_pk_add_f32 v[84:85], v[84:85], v[78:79] neg_lo:[0,1] neg_hi:[0,1]
    v_cvt_pk_bf16_f32 v61, v84, v85
    v_lshlrev_b32 v84, 16, v61
    v_and_b32 v85, 0xffff0000, v61
    v_pk_mul_f32 v[84:85], v[84:85], v[80:81]
    v_cvt_pk_bf16_f32 v61, v84, v85
    v_lshlrev_b32 v82, 16, v62
    v_and_b32 v83, 0xffff0000, v62
    v_pk_add_f32 v[82:83], v[82:83], v[78:79] neg_lo:[0,1] neg_hi:[0,1]
    v_cvt_pk_bf16_f32 v62, v82, v83
    v_lshlrev_b32 v82, 16, v62
    v_and_b32 v83, 0xffff0000, v62
    v_pk_mul_f32 v[82:83], v[82:83], v[80:81]
    v_cvt_pk_bf16_f32 v62, v82, v83
    v_lshlrev_b32 v84, 16, v63
    v_and_b32 v85, 0xffff0000, v63
    v_pk_add_f32 v[84:85], v[84:85], v[78:79] neg_lo:[0,1] neg_hi:[0,1]
    v_cvt_pk_bf16_f32 v63, v84, v85
    v_lshlrev_b32 v84, 16, v63
    v_and_b32 v85, 0xffff0000, v63
    v_pk_mul_f32 v[84:85], v[84:85], v[80:81]
    v_cvt_pk_bf16_f32 v63, v84, v85
    v_lshlrev_b32 v82, 16, v64
    v_and_b32 v83, 0xffff0000, v64
    v_pk_add_f32 v[82:83], v[82:83], v[78:79] neg_lo:[0,1] neg_hi:[0,1]
    v_cvt_pk_bf16_f32 v64, v82, v83
    v_lshlrev_b32 v82, 16, v64
    v_and_b32 v83, 0xffff0000, v64
    v_pk_mul_f32 v[82:83], v[82:83], v[80:81]
    v_cvt_pk_bf16_f32 v64, v82, v83
    v_lshlrev_b32 v84, 16, v65
    v_and_b32 v85, 0xffff0000, v65
    v_pk_add_f32 v[84:85], v[84:85], v[78:79] neg_lo:[0,1] neg_hi:[0,1]
    v_cvt_pk_bf16_f32 v65, v84, v85
    v_lshlrev_b32 v84, 16, v65
    v_and_b32 v85, 0xffff0000, v65
    v_pk_mul_f32 v[84:85], v[84:85], v[80:81]
    v_cvt_pk_bf16_f32 v65, v84, v85
    v_lshlrev_b32 v82, 16, v66
    v_and_b32 v83, 0xffff0000, v66
    v_pk_add_f32 v[82:83], v[82:83], v[78:79] neg_lo:[0,1] neg_hi:[0,1]
    v_cvt_pk_bf16_f32 v66, v82, v83
    v_lshlrev_b32 v82, 16, v66
    v_and_b32 v83, 0xffff0000, v66
    v_pk_mul_f32 v[82:83], v[82:83], v[80:81]
    v_cvt_pk_bf16_f32 v66, v82, v83
    v_lshlrev_b32 v84, 16, v67
    v_and_b32 v85, 0xffff0000, v67
    v_pk_add_f32 v[84:85], v[84:85], v[78:79] neg_lo:[0,1] neg_hi:[0,1]
    v_cvt_pk_bf16_f32 v67, v84, v85
    v_lshlrev_b32 v84, 16, v67
    v_and_b32 v85, 0xffff0000, v67
    v_pk_mul_f32 v[84:85], v[84:85], v[80:81]
    v_cvt_pk_bf16_f32 v67, v84, v85
    v_lshlrev_b32 v82, 16, v68
    v_and_b32 v83, 0xffff0000, v68
    v_pk_add_f32 v[82:83], v[82:83], v[78:79] neg_lo:[0,1] neg_hi:[0,1]
    v_cvt_pk_bf16_f32 v68, v82, v83
    v_lshlrev_b32 v82, 16, v68
    v_and_b32 v83, 0xffff0000, v68
    v_pk_mul_f32 v[82:83], v[82:83], v[80:81]
    v_cvt_pk_bf16_f32 v68, v82, v83
    v_lshlrev_b32 v84, 16, v69
    v_and_b32 v85, 0xffff0000, v69
    v_pk_add_f32 v[84:85], v[84:85], v[78:79] neg_lo:[0,1] neg_hi:[0,1]
    v_cvt_pk_bf16_f32 v69, v84, v85
    v_lshlrev_b32 v84, 16, v69
    v_and_b32 v85, 0xffff0000, v69
    v_pk_mul_f32 v[84:85], v[84:85], v[80:81]
    v_cvt_pk_bf16_f32 v69, v84, v85
    v_lshlrev_b32 v82, 16, v70
    v_and_b32 v83, 0xffff0000, v70
    v_pk_add_f32 v[82:83], v[82:83], v[78:79] neg_lo:[0,1] neg_hi:[0,1]
    v_cvt_pk_bf16_f32 v70, v82, v83
    v_lshlrev_b32 v82, 16, v70
    v_and_b32 v83, 0xffff0000, v70
    v_pk_mul_f32 v[82:83], v[82:83], v[80:81]
    v_cvt_pk_bf16_f32 v70, v82, v83
    v_lshlrev_b32 v84, 16, v71
    v_and_b32 v85, 0xffff0000, v71
    v_pk_add_f32 v[84:85], v[84:85], v[78:79] neg_lo:[0,1] neg_hi:[0,1]
    v_cvt_pk_bf16_f32 v71, v84, v85
    v_lshlrev_b32 v84, 16, v71
    v_and_b32 v85, 0xffff0000, v71
    v_pk_mul_f32 v[84:85], v[84:85], v[80:81]
    v_cvt_pk_bf16_f32 v71, v84, v85
    v_lshlrev_b32 v82, 16, v72
    v_and_b32 v83, 0xffff0000, v72
    v_pk_add_f32 v[82:83], v[82:83], v[78:79] neg_lo:[0,1] neg_hi:[0,1]
    v_cvt_pk_bf16_f32 v72, v82, v83
    v_lshlrev_b32 v82, 16, v72
    v_and_b32 v83, 0xffff0000, v72
    v_pk_mul_f32 v[82:83], v[82:83], v[80:81]
    v_cvt_pk_bf16_f32 v72, v82, v83
    v_lshlrev_b32 v84, 16, v73
    v_and_b32 v85, 0xffff0000, v73
    v_pk_add_f32 v[84:85], v[84:85], v[78:79] neg_lo:[0,1] neg_hi:[0,1]
    v_cvt_pk_bf16_f32 v73, v84, v85
    v_lshlrev_b32 v84, 16, v73
    v_and_b32 v85, 0xffff0000, v73
    v_pk_mul_f32 v[84:85], v[84:85], v[80:81]
    v_cvt_pk_bf16_f32 v73, v84, v85
    v_lshlrev_b32 v82, 16, v74
    v_and_b32 v83, 0xffff0000, v74
    v_pk_add_f32 v[82:83], v[82:83], v[78:79] neg_lo:[0,1] neg_hi:[0,1]
    v_cvt_pk_bf16_f32 v74, v82, v83
    v_lshlrev_b32 v82, 16, v74
    v_and_b32 v83, 0xffff0000, v74
    v_pk_mul_f32 v[82:83], v[82:83], v[80:81]
    v_cvt_pk_bf16_f32 v74, v82, v83
    v_lshlrev_b32 v84, 16, v75
    v_and_b32 v85, 0xffff0000, v75
    v_pk_add_f32 v[84:85], v[84:85], v[78:79] neg_lo:[0,1] neg_hi:[0,1]
    v_cvt_pk_bf16_f32 v75, v84, v85
    v_lshlrev_b32 v84, 16, v75
    v_and_b32 v85, 0xffff0000, v75
    v_pk_mul_f32 v[84:85], v[84:85], v[80:81]
    v_cvt_pk_bf16_f32 v75, v84, v85
    s_nop 1
L_spin72:
    ds_read_b32 v31, v30 offset:6956
    s_waitcnt lgkmcnt(0)
    v_readfirstlane_b32 s40, v31
    s_nop 0
    s_cmp_ge_u32 s40, 2
    s_cbranch_scc1 L_spun73
    s_sleep 1
    s_branch L_spin72
L_spun73:
    s_waitcnt vmcnt(0)
    ds_read_b64_tr_b16 v[100:101], v38
    ds_read_b64_tr_b16 v[102:103], v38 offset:6144
    ds_read_b64_tr_b16 v[104:105], v39
    ds_read_b64_tr_b16 v[106:107], v39 offset:6144
    ds_read_b64_tr_b16 v[108:109], v40
    ds_read_b64_tr_b16 v[110:111], v40 offset:6144
    ds_read_b64_tr_b16 v[112:113], v38 offset:12288
    ds_read_b64_tr_b16 v[114:115], v38 offset:18432
    ds_read_b64_tr_b16 v[116:117], v39 offset:12288
    ds_read_b64_tr_b16 v[118:119], v39 offset:18432
    ds_read_b64_tr_b16 v[120:121], v40 offset:12288
    ds_read_b64_tr_b16 v[122:123], v40 offset:18432
    ds_read_b64_tr_b16 v[124:125], v38 offset:36864
    ds_read_b64_tr_b16 v[126:127], v38 offset:43008
    ds_read_b64_tr_b16 v[128:129], v39 offset:36864
    ds_read_b64_tr_b16 v[130:131], v39 offset:43008
    ds_read_b64_tr_b16 v[132:133], v40 offset:36864
    ds_read_b64_tr_b16 v[134:135], v40 offset:43008
    s_waitcnt lgkmcnt(12)
    v_mfma_f32_16x16x32_bf16 v[88:91], v[100:103], v[52:55], 0
    v_mfma_f32_16x16x32_bf16 v[92:95], v[104:107], v[52:55], 0
    v_mfma_f32_16x16x32_bf16 v[96:99], v[108:111], v[52:55], 0
    ds_read_b64_tr_b16 v[136:137], v38 offset:49152
    ds_read_b64_tr_b16 v[138:139], v38 offset:55296
    ds_read_b64_tr_b16 v[140:141], v39 offset:49152
    ds_read_b64_tr_b16 v[142:143], v39 offset:55296
    ds_read_b64_tr_b16 v[144:145], v40 offset:49152
    ds_read_b64_tr_b16 v[146:147], v40 offset:55296
    s_waitcnt lgkmcnt(12)
    v_mfma_f32_16x16x32_bf16 v[88:91], v[112:115], v[56:59], v[88:91]
    v_mfma_f32_16x16x32_bf16 v[92:95], v[116:119], v[56:59], v[92:95]
    v_mfma_f32_16x16x32_bf16 v[96:99], v[120:123], v[56:59], v[96:99]
    ds_read_b64_tr_b16 v[148:149], v41
    ds_read_b64_tr_b16 v[150:151], v41 offset:6144
    ds_read_b64_tr_b16 v[152:153], v42
    ds_read_b64_tr_b16 v[154:155], v42 offset:6144
    ds_read_b64_tr_b16 v[156:157], v43
    ds_read_b64_tr_b16 v[158:159], v43 offset:6144
    s_waitcnt lgkmcnt(12)
    v_mfma_f32_16x16x32_bf16 v[88:91], v[124:127], v[60:63], v[88:91]
    v_mfma_f32_16x16x32_bf16 v[92:95], v[128:131], v[60:63], v[92:95]
    v_mfma_f32_16x16x32_bf16 v[96:99], v[132:135], v[60:63], v[96:99]
    ds_read_b64_tr_b16 v[160:161], v41 offset:12288
    ds_read_b64_tr_b16 v[162:163], v41 offset:18432
    ds_read_b64_tr_b16 v[164:165], v42 offset:12288
    ds_read_b64_tr_b16 v[166:167], v42 offset:18432
    ds_read_b64_tr_b16 v[168:169], v43 offset:12288
    ds_read_b64_tr_b16 v[170:171], v43 offset:18432
    s_waitcnt lgkmcnt(12)
    v_mfma_f32_16x16x32_bf16 v[88:91], v[136:139], v[64:67], v[88:91]
    v_mfma_f32_16x16x32_bf16 v[92:95], v[140:143], v[64:67], v[92:95]
    v_mfma_f32_16x16x32_bf16 v[96:99], v[144:147], v[64:67], v[96:99]
    s_waitcnt lgkmcnt(6)
    v_mfma_f32_16x16x32_bf16 v[88:91], v[148:151], v[68:71], v[88:91]
    v_mfma_f32_16x16x32_bf16 v[92:95], v[152:155], v[68:71], v[92:95]
    v_mfma_f32_16x16x32_bf16 v[96:99], v[156:159], v[68:71], v[96:99]
    s_waitcnt lgkmcnt(0)
    v_mfma_f32_16x16x32_bf16 v[88:91], v[160:163], v[72:75], v[88:91]
    v_mfma_f32_16x16x32_bf16 v[92:95], v[164:167], v[72:75], v[92:95]
    v_mfma_f32_16x16x32_bf16 v[96:99], v[168:171], v[72:75], v[96:99]
    s_nop 5
    v_cvt_pk_bf16_f32 v76, v88, v89
    v_cvt_pk_bf16_f32 v77, v90, v91
    ds_write_b64 v44, v[76:77]
    v_cvt_pk_bf16_f32 v78, v92, v93
    v_cvt_pk_bf16_f32 v79, v94, v95
    ds_write_b64 v45, v[78:79]
    v_cvt_pk_bf16_f32 v80, v96, v97
    v_cvt_pk_bf16_f32 v81, v98, v99
    ds_write_b64 v46, v[80:81]
    v_mov_b32 v31, 1
    s_mov_b64 exec, 1
    ds_add_u32 v30, v31 offset:6948
    s_mov_b64 exec, -1
    s_cmp_ge_u32 s3, 2
    s_cbranch_scc1 L_qkp_done
L_spin74:
    ds_read_b32 v31, v30 offset:6956
    s_waitcnt lgkmcnt(0)
    v_readfirstlane_b32 s40, v31
    s_nop 0
    s_cmp_ge_u32 s40, 3
    s_cbranch_scc1 L_spun75
    s_sleep 1
    s_branch L_spin74
L_spun75:
    s_mul_i32 s40, s3, 0x3000
    s_add_u32 s40, s40, 0x1f800
    v_add_u32 v34, s40, v34
    v_add_u32 v35, s40, v35
    v_add_u32 v36, s40, v36
    v_add_u32 v37, s40, v37
    ds_read_b64 v[100:101], v34
    ds_read_b64 v[102:103], v35
    ds_read_b64 v[104:105], v36
    ds_read_b64 v[106:107], v37
    ds_read_b64 v[108:109], v34 offset:128
    ds_read_b64 v[110:111], v35 offset:128
    ds_read_b64 v[112:113], v36 offset:128
    ds_read_b64 v[114:115], v37 offset:128
    ds_read_b64 v[116:117], v34 offset:256
    ds_read_b64 v[118:119], v35 offset:256
    ds_read_b64 v[120:121], v36 offset:256
    ds_read_b64 v[122:123], v37 offset:256
    ds_read_b64 v[124:125], v34 offset:6144
    ds_read_b64 v[126:127], v35 offset:6144
    ds_read_b64 v[128:129], v36 offset:6144
    ds_read_b64 v[130:131], v37 offset:6144
    ds_read_b64 v[132:133], v34 offset:6272
    ds_read_b64 v[134:135], v35 offset:6272
    ds_read_b64 v[136:137], v36 offset:6272
    ds_read_b64 v[138:139], v37 offset:6272
    ds_read_b64 v[140:141], v34 offset:6400
    ds_read_b64 v[142:143], v35 offset:6400
    ds_read_b64 v[144:145], v36 offset:6400
    ds_read_b64 v[146:147], v37 offset:6400
L_spin76:
    ds_read_b32 v31, v30 offset:6948
    s_waitcnt lgkmcnt(0)
    v_readfirstlane_b32 s40, v31
    s_nop 0
    s_cmp_ge_u32 s40, 4
    s_cbranch_scc1 L_spun77
    s_sleep 1
    s_branch L_spin76
L_spun77:
    ds_read_b128 v[52:55], v47
    ds_read_b128 v[56:59], v47 offset:1024
    ds_read_b128 v[60:63], v47 offset:2048
    ds_read_b128 v[64:67], v47 offset:3072
    ds_read_b128 v[68:71], v47 offset:4096
    ds_read_b128 v[72:75], v47 offset:5120
    s_lshl_b32 s42, s2, 1
    s_add_u32 s42, s42, s3
    s_lshl_b32 s42, s42, 10
    s_add_u32 s42, s42, 0x500000
    v_lshlrev_b32 v33, 4, v0
    s_waitcnt lgkmcnt(5)
    v_mfma_f32_16x16x32_bf16 v[88:91], v[100:103], v[52:55], 0
    v_mfma_f32_16x16x32_bf16 v[92:95], v[124:127], v[52:55], 0
    s_waitcnt lgkmcnt(4)
    v_mfma_f32_16x16x32_bf16 v[88:91], v[104:107], v[56:59], v[88:91]
    v_mfma_f32_16x16x32_bf16 v[92:95], v[128:131], v[56:59], v[92:95]
    s_waitcnt lgkmcnt(3)
    v_mfma_f32_16x16x32_bf16 v[88:91], v[108:111], v[60:63], v[88:91]
    v_mfma_f32_16x16x32_bf16 v[92:95], v[132:135], v[60:63], v[92:95]
    s_waitcnt lgkmcnt(2)
    v_mfma_f32_16x16x32_bf16 v[88:91], v[112:115], v[64:67], v[88:91]
    v_mfma_f32_16x16x32_bf16 v[92:95], v[136:139], v[64:67], v[92:95]
    s_waitcnt lgkmcnt(1)
    v_mfma_f32_16x16x32_bf16 v[88:91], v[116:119], v[68:71], v[88:91]
    v_mfma_f32_16x16x32_bf16 v[92:95], v[140:143], v[68:71], v[92:95]
    s_waitcnt lgkmcnt(0)
    v_mfma_f32_16x16x32_bf16 v[88:91], v[120:123], v[72:75], v[88:91]
    v_mfma_f32_16x16x32_bf16 v[92:95], v[144:147], v[72:75], v[92:95]
    s_nop 7
L_spin78:
    ds_read_b32 v31, v30 offset:6960
    s_waitcnt lgkmcnt(0)
    v_readfirstlane_b32 s40, v31
    s_nop 0
    s_cmp_ge_u32 s40, 1
    s_cbranch_scc1 L_spun79
    s_sleep 1
    s_branch L_spin78
L_spun79:
    s_mov_b32 s40, 0x3dd53b95
    v_mul_f32 v88, s40, v88
    v_mul_f32 v89, s40, v89
    v_mul_f32 v90, s40, v90
    v_mul_f32 v91, s40, v91
    v_cvt_pk_bf16_f32 v76, v88, v89
    v_cvt_pk_bf16_f32 v77, v90, v91
    v_mul_f32 v92, s40, v92
    v_mul_f32 v93, s40, v93
    v_mul_f32 v94, s40, v94
    v_mul_f32 v95, s40, v95
    v_cvt_pk_bf16_f32 v78, v92, v93
    v_cvt_pk_bf16_f32 v79, v94, v95
    v_min_u32 v76, -2, v76
    v_min_u32 v77, -2, v77
    v_min_u32 v78, -2, v78
    v_min_u32 v79, -2, v79
    buffer_store_dwordx4 v[76:79], v33, s[32:35], s42 offen sc1
    s_nop 1
L_qkp_done:
    v_mov_b32 v31, 1
    s_mov_b64 exec, 1
    ds_add_u32 v30, v31 offset:6952
    s_mov_b64 exec, -1
    s_waitcnt lgkmcnt(0)
    s_branch L_c_start
L_wvprod:
    s_getpc_b64 s[28:29]
    s_mov_b32 s30, 0x1000
    s_mov_b32 s31, 0x20000
    v_lshlrev_b32 v148, 6, v0
    buffer_load_dword v156, v148, s[28:31], 0 offen
    v_mov_b32 v150, 0
    v_add_u32 v152, 0x6400, v244
    v_add_u32 v153, 0x6400, v245
    v_add_u32 v154, 0x18400, v244
    v_add_u32 v155, 0x18400, v245
    v_lshrrev_b32 v148, 4, v0
    v_bfe_u32 v149, v0, 2, 2
    v_lshl_add_u32 v148, v148, 3, v149
    v_and_b32 v149, 3, v0
    v_lshlrev_b32 v149, 3, v149
    v_lshl_add_u32 v151, v148, 7, v149
    s_lshl_b32 s40, s3, 5
    s_add_u32 s40, s40, 0x21400
    v_add_u32 v151, s40, v151
    s_nop 1
L_spin80:
    ds_read_b32 v148, v150 offset:6956
    s_waitcnt lgkmcnt(0)
    v_readfirstlane_b32 s40, v148
    s_nop 0
    s_cmp_ge_u32 s40, 1
    s_cbranch_scc1 L_spun81
    s_sleep 1
    s_branch L_spin80
L_spun81:
    ds_read_b64_tr_b16 v[28:29], v151
    ds_read_b64_tr_b16 v[30:31], v151 offset:512
    ds_read_b64_tr_b16 v[32:33], v151 offset:4096
    ds_read_b64_tr_b16 v[34:35], v151 offset:4608
    ds_read_b64_tr_b16 v[36:37], v151 offset:8192
    ds_read_b64_tr_b16 v[38:39], v151 offset:8704
    ds_read_b64_tr_b16 v[40:41], v151 offset:12288
    ds_read_b64_tr_b16 v[42:43], v151 offset:12800
    ds_read_b64_tr_b16 v[44:45], v151 offset:16384
    ds_read_b64_tr_b16 v[46:47], v151 offset:16896
    ds_read_b64_tr_b16 v[48:49], v151 offset:20480
    ds_read_b64_tr_b16 v[50:51], v151 offset:20992
L_spin82:
    ds_read_b32 v148, v150 offset:6956
    s_waitcnt lgkmcnt(0)
    v_readfirstlane_b32 s40, v148
    s_nop 0
    s_cmp_ge_u32 s40, 2
    s_cbranch_scc1 L_spun83
    s_sleep 1
    s_branch L_spin82
L_spun83:
    s_waitcnt vmcnt(0)
    ds_read_b128 v[100:103], v152
    ds_read_b128 v[104:107], v153
    ds_read_b128 v[108:111], v152 offset:128
    ds_read_b128 v[112:115], v153 offset:128
    ds_read_b128 v[116:119], v152 offset:256
    ds_read_b128 v[120:123], v153 offset:256
    s_waitcnt lgkmcnt(5)
    v_mfma_f32_16x16x32_bf16 v[52:55], v[100:103], v[28:31], 0
    ds_read_b128 v[124:127], v152 offset:6144
    s_waitcnt lgkmcnt(5)
    v_mfma_f32_16x16x32_bf16 v[52:55], v[104:107], v[32:35], v[52:55]
    ds_read_b128 v[128:131], v153 offset:6144
    s_waitcnt lgkmcnt(5)
    v_mfma_f32_16x16x32_bf16 v[52:55], v[108:111], v[36:39], v[52:55]
    ds_read_b128 v[132:135], v152 offset:6272
    s_waitcnt lgkmcnt(5)
    v_mfma_f32_16x16x32_bf16 v[52:55], v[112:115], v[40:43], v[52:55]
    ds_read_b128 v[136:139], v153 offset:6272
    s_waitcnt lgkmcnt(5)
    v_mfma_f32_16x16x32_bf16 v[52:55], v[116:119], v[44:47], v[52:55]
    ds_read_b128 v[140:143], v152 offset:6400
    s_waitcnt lgkmcnt(5)
    v_mfma_f32_16x16x32_bf16 v[52:55], v[120:123], v[48:51], v[52:55]
    ds_read_b128 v[144:147], v153 offset:6400
    s_waitcnt lgkmcnt(5)
    v_mfma_f32_16x16x32_bf16 v[56:59], v[124:127], v[28:31], 0
    ds_read_b128 v[100:103], v152 offset:12288
    s_waitcnt lgkmcnt(5)
    v_mfma_f32_16x16x32_bf16 v[56:59], v[128:131], v[32:35], v[56:59]
    ds_read_b128 v[104:107], v153 offset:12288
    s_waitcnt lgkmcnt(5)
    v_mfma_f32_16x16x32_bf16 v[56:59], v[132:135], v[36:39], v[56:59]
    ds_read_b128 v[108:111], v152 offset:12416
    s_waitcnt lgkmcnt(5)
    v_mfma_f32_16x16x32_bf16 v[56:59], v[136:139], v[40:43], v[56:59]
    ds_read_b128 v[112:115], v153 offset:12416
    s_waitcnt lgkmcnt(5)
    v_mfma_f32_16x16x32_bf16 v[56:59], v[140:143], v[44:47], v[56:59]
    ds_read_b128 v[116:119], v152 offset:12544
    s_waitcnt lgkmcnt(5)
    v_mfma_f32_16x16x32_bf16 v[56:59], v[144:147], v[48:51], v[56:59]
    ds_read_b128 v[120:123], v153 offset:12544
    s_waitcnt lgkmcnt(5)
    v_mfma_f32_16x16x32_bf16 v[60:63], v[100:103], v[28:31], 0
    ds_read_b128 v[124:127], v152 offset:18432
    s_waitcnt lgkmcnt(5)
    v_mfma_f32_16x16x32_bf16 v[60:63], v[104:107], v[32:35], v[60:63]
    ds_read_b128 v[128:131], v153 offset:18432
    s_waitcnt lgkmcnt(5)
    v_mfma_f32_16x16x32_bf16 v[60:63], v[108:111], v[36:39], v[60:63]
    ds_read_b128 v[132:135], v152 offset:18560
    s_waitcnt lgkmcnt(5)
    v_mfma_f32_16x16x32_bf16 v[60:63], v[112:115], v[40:43], v[60:63]
    ds_read_b128 v[136:139], v153 offset:18560
    s_waitcnt lgkmcnt(5)
    v_mfma_f32_16x16x32_bf16 v[60:63], v[116:119], v[44:47], v[60:63]
    ds_read_b128 v[140:143], v152 offset:18688
    s_waitcnt lgkmcnt(5)
    v_mfma_f32_16x16x32_bf16 v[60:63], v[120:123], v[48:51], v[60:63]
    ds_read_b128 v[144:147], v153 offset:18688
    s_waitcnt lgkmcnt(5)
    v_mfma_f32_16x16x32_bf16 v[64:67], v[124:127], v[28:31], 0
    ds_read_b128 v[100:103], v152 offset:36864
    s_waitcnt lgkmcnt(5)
    v_mfma_f32_16x16x32_bf16 v[64:67], v[128:131], v[32:35], v[64:67]
    ds_read_b128 v[104:107], v153 offset:36864
    s_waitcnt lgkmcnt(5)
    v_mfma_f32_16x16x32_bf16 v[64:67], v[132:135], v[36:39], v[64:67]
    ds_read_b128 v[108:111], v152 offset:36992
    s_waitcnt lgkmcnt(5)
    v_mfma_f32_16x16x32_bf16 v[64:67], v[136:139], v[40:43], v[64:67]
    ds_read_b128 v[112:115], v153 offset:36992
    s_waitcnt lgkmcnt(5)
    v_mfma_f32_16x16x32_bf16 v[64:67], v[140:143], v[44:47], v[64:67]
    ds_read_b128 v[116:119], v152 offset:37120
    s_waitcnt lgkmcnt(5)
    v_mfma_f32_16x16x32_bf16 v[64:67], v[144:147], v[48:51], v[64:67]
    ds_read_b128 v[120:123], v153 offset:37120
    s_waitcnt lgkmcnt(5)
    v_mfma_f32_16x16x32_bf16 v[68:71], v[100:103], v[28:31], 0
    ds_read_b128 v[124:127], v152 offset:43008
    s_waitcnt lgkmcnt(5)
    v_mfma_f32_16x16x32_bf16 v[68:71], v[104:107], v[32:35], v[68:71]
    ds_read_b128 v[128:131], v153 offset:43008
    s_waitcnt lgkmcnt(5)
    v_mfma_f32_16x16x32_bf16 v[68:71], v[108:111], v[36:39], v[68:71]
    ds_read_b128 v[132:135], v152 offset:43136
    s_waitcnt lgkmcnt(5)
    v_mfma_f32_16x16x32_bf16 v[68:71], v[112:115], v[40:43], v[68:71]
    ds_read_b128 v[136:139], v153 offset:43136
    s_waitcnt lgkmcnt(5)
    v_mfma_f32_16x16x32_bf16 v[68:71], v[116:119], v[44:47], v[68:71]
    ds_read_b128 v[140:143], v152 offset:43264
    s_waitcnt lgkmcnt(5)
    v_mfma_f32_16x16x32_bf16 v[68:71], v[120:123], v[48:51], v[68:71]
    ds_read_b128 v[144:147], v153 offset:43264
    s_waitcnt lgkmcnt(5)
    v_mfma_f32_16x16x32_bf16 v[72:75], v[124:127], v[28:31], 0
    ds_read_b128 v[100:103], v152 offset:49152
    s_waitcnt lgkmcnt(5)
    v_mfma_f32_16x16x32_bf16 v[72:75], v[128:131], v[32:35], v[72:75]
    ds_read_b128 v[104:107], v153 offset:49152
    s_waitcnt lgkmcnt(5)
    v_mfma_f32_16x16x32_bf16 v[72:75], v[132:135], v[36:39], v[72:75]
    ds_read_b128 v[108:111], v152 offset:49280
    s_waitcnt lgkmcnt(5)
    v_mfma_f32_16x16x32_bf16 v[72:75], v[136:139], v[40:43], v[72:75]
    ds_read_b128 v[112:115], v153 offset:49280
    s_waitcnt lgkmcnt(5)
    v_mfma_f32_16x16x32_bf16 v[72:75], v[140:143], v[44:47], v[72:75]
    ds_read_b128 v[116:119], v152 offset:49408
    s_waitcnt lgkmcnt(5)
    v_mfma_f32_16x16x32_bf16 v[72:75], v[144:147], v[48:51], v[72:75]
    ds_read_b128 v[120:123], v153 offset:49408
    s_waitcnt lgkmcnt(5)
    v_mfma_f32_16x16x32_bf16 v[76:79], v[100:103], v[28:31], 0
    ds_read_b128 v[124:127], v152 offset:55296
    s_waitcnt lgkmcnt(5)
    v_mfma_f32_16x16x32_bf16 v[76:79], v[104:107], v[32:35], v[76:79]
    ds_read_b128 v[128:131], v153 offset:55296
    s_waitcnt lgkmcnt(5)
    v_mfma_f32_16x16x32_bf16 v[76:79], v[108:111], v[36:39], v[76:79]
    ds_read_b128 v[132:135], v152 offset:55424
    s_waitcnt lgkmcnt(5)
    v_mfma_f32_16x16x32_bf16 v[76:79], v[112:115], v[40:43], v[76:79]
    ds_read_b128 v[136:139], v153 offset:55424
    s_waitcnt lgkmcnt(5)
    v_mfma_f32_16x16x32_bf16 v[76:79], v[116:119], v[44:47], v[76:79]
    ds_read_b128 v[140:143], v152 offset:55552
    s_waitcnt lgkmcnt(5)
    v_mfma_f32_16x16x32_bf16 v[76:79], v[120:123], v[48:51], v[76:79]
    ds_read_b128 v[144:147], v153 offset:55552
    s_nop 6
L_spin84:
    ds_read_b32 v148, v150 offset:6956
    s_waitcnt lgkmcnt(0)
    v_readfirstlane_b32 s40, v148
    s_nop 0
    s_cmp_ge_u32 s40, 3
    s_cbranch_scc1 L_spun85
    s_sleep 1
    s_branch L_spin84
L_spun85:
    s_waitcnt lgkmcnt(5)
    v_mfma_f32_16x16x32_bf16 v[80:83], v[124:127], v[28:31], 0
    ds_read_b128 v[100:103], v154
    s_waitcnt lgkmcnt(5)
    v_mfma_f32_16x16x32_bf16 v[80:83], v[128:131], v[32:35], v[80:83]
    ds_read_b128 v[104:107], v155
    s_waitcnt lgkmcnt(5)
    v_mfma_f32_16x16x32_bf16 v[80:83], v[132:135], v[36:39], v[80:83]
    ds_read_b128 v[108:111], v154 offset:128
    s_waitcnt lgkmcnt(5)
    v_mfma_f32_16x16x32_bf16 v[80:83], v[136:139], v[40:43], v[80:83]
    ds_read_b128 v[112:115], v155 offset:128
    s_waitcnt lgkmcnt(5)
    v_mfma_f32_16x16x32_bf16 v[80:83], v[140:143], v[44:47], v[80:83]
    ds_read_b128 v[116:119], v154 offset:256
    s_waitcnt lgkmcnt(5)
    v_mfma_f32_16x16x32_bf16 v[80:83], v[144:147], v[48:51], v[80:83]
    ds_read_b128 v[120:123], v155 offset:256
    s_waitcnt lgkmcnt(5)
    v_mfma_f32_16x16x32_bf16 v[84:87], v[100:103], v[28:31], 0
    ds_read_b128 v[124:127], v154 offset:6144
    s_waitcnt lgkmcnt(5)
    v_mfma_f32_16x16x32_bf16 v[84:87], v[104:107], v[32:35], v[84:87]
    ds_read_b128 v[128:131], v155 offset:6144
    s_waitcnt lgkmcnt(5)
    v_mfma_f32_16x16x32_bf16 v[84:87], v[108:111], v[36:39], v[84:87]
    ds_read_b128 v[132:135], v154 offset:6272
    s_waitcnt lgkmcnt(5)
    v_mfma_f32_16x16x32_bf16 v[84:87], v[112:115], v[40:43], v[84:87]
    ds_read_b128 v[136:139], v155 offset:6272
    s_waitcnt lgkmcnt(5)
    v_mfma_f32_16x16x32_bf16 v[84:87], v[116:119], v[44:47], v[84:87]
    ds_read_b128 v[140:143], v154 offset:6400
    s_waitcnt lgkmcnt(5)
    v_mfma_f32_16x16x32_bf16 v[84:87], v[120:123], v[48:51], v[84:87]
    ds_read_b128 v[144:147], v155 offset:6400
    s_waitcnt lgkmcnt(5)
    v_mfma_f32_16x16x32_bf16 v[88:91], v[124:127], v[28:31], 0
    ds_read_b128 v[100:103], v154 offset:12288
    s_waitcnt lgkmcnt(5)
    v_mfma_f32_16x16x32_bf16 v[88:91], v[128:131], v[32:35], v[88:91]
    ds_read_b128 v[104:107], v155 offset:12288
    s_waitcnt lgkmcnt(5)
    v_mfma_f32_16x16x32_bf16 v[88:91], v[132:135], v[36:39], v[88:91]
    ds_read_b128 v[108:111], v154 offset:12416
    s_waitcnt lgkmcnt(5)
    v_mfma_f32_16x16x32_bf16 v[88:91], v[136:139], v[40:43], v[88:91]
    ds_read_b128 v[112:115], v155 offset:12416
    s_waitcnt lgkmcnt(5)
    v_mfma_f32_16x16x32_bf16 v[88:91], v[140:143], v[44:47], v[88:91]
    ds_read_b128 v[116:119], v154 offset:12544
    s_waitcnt lgkmcnt(5)
    v_mfma_f32_16x16x32_bf16 v[88:91], v[144:147], v[48:51], v[88:91]
    ds_read_b128 v[120:123], v155 offset:12544
    s_waitcnt lgkmcnt(5)
    v_mfma_f32_16x16x32_bf16 v[92:95], v[100:103], v[28:31], 0
    ds_read_b128 v[124:127], v154 offset:18432
    s_waitcnt lgkmcnt(5)
    v_mfma_f32_16x16x32_bf16 v[92:95], v[104:107], v[32:35], v[92:95]
    ds_read_b128 v[128:131], v155 offset:18432
    s_waitcnt lgkmcnt(5)
    v_mfma_f32_16x16x32_bf16 v[92:95], v[108:111], v[36:39], v[92:95]
    ds_read_b128 v[132:135], v154 offset:18560
    s_waitcnt lgkmcnt(5)
    v_mfma_f32_16x16x32_bf16 v[92:95], v[112:115], v[40:43], v[92:95]
    ds_read_b128 v[136:139], v155 offset:18560
    s_waitcnt lgkmcnt(5)
    v_mfma_f32_16x16x32_bf16 v[92:95], v[116:119], v[44:47], v[92:95]
    ds_read_b128 v[140:143], v154 offset:18688
    s_waitcnt lgkmcnt(5)
    v_mfma_f32_16x16x32_bf16 v[92:95], v[120:123], v[48:51], v[92:95]
    ds_read_b128 v[144:147], v155 offset:18688
    s_waitcnt lgkmcnt(5)
    v_mfma_f32_16x16x32_bf16 v[96:99], v[124:127], v[28:31], 0
    s_waitcnt lgkmcnt(4)
    s_waitcnt lgkmcnt(5)
    v_mfma_f32_16x16x32_bf16 v[96:99], v[128:131], v[32:35], v[96:99]
    s_waitcnt lgkmcnt(3)
    s_waitcnt lgkmcnt(5)
    v_mfma_f32_16x16x32_bf16 v[96:99], v[132:135], v[36:39], v[96:99]
    s_waitcnt lgkmcnt(2)
    s_waitcnt lgkmcnt(5)
    v_mfma_f32_16x16x32_bf16 v[96:99], v[136:139], v[40:43], v[96:99]
    s_waitcnt lgkmcnt(1)
    s_waitcnt lgkmcnt(5)
    v_mfma_f32_16x16x32_bf16 v[96:99], v[140:143], v[44:47], v[96:99]
    s_waitcnt lgkmcnt(0)
    s_waitcnt lgkmcnt(5)
    v_mfma_f32_16x16x32_bf16 v[96:99], v[144:147], v[48:51], v[96:99]
    v_mov_b32 v148, 1
    s_mov_b64 exec, 1
    ds_add_u32 v150, v148 offset:6952
    s_mov_b64 exec, -1
    v_pk_add_f32 v[158:159], v[52:53], v[56:57]
    v_pk_add_f32 v[160:161], v[54:55], v[58:59]
    v_pk_add_f32 v[158:159], v[158:159], v[60:61]
    v_pk_add_f32 v[160:161], v[160:161], v[62:63]
    v_pk_add_f32 v[158:159], v[158:159], v[64:65]
    v_pk_add_f32 v[160:161], v[160:161], v[66:67]
    v_pk_add_f32 v[158:159], v[158:159], v[68:69]
    v_pk_add_f32 v[160:161], v[160:161], v[70:71]
    v_pk_add_f32 v[158:159], v[158:159], v[72:73]
    v_pk_add_f32 v[160:161], v[160:161], v[74:75]
    v_pk_add_f32 v[158:159], v[158:159], v[76:77]
    v_pk_add_f32 v[160:161], v[160:161], v[78:79]
    v_pk_add_f32 v[158:159], v[158:159], v[80:81]
    v_pk_add_f32 v[160:161], v[160:161], v[82:83]
    v_pk_add_f32 v[158:159], v[158:159], v[84:85]
    v_pk_add_f32 v[160:161], v[160:161], v[86:87]
    v_pk_add_f32 v[158:159], v[158:159], v[88:89]
    v_pk_add_f32 v[160:161], v[160:161], v[90:91]
    v_pk_add_f32 v[158:159], v[158:159], v[92:93]
    v_pk_add_f32 v[160:161], v[160:161], v[94:95]
    v_pk_add_f32 v[158:159], v[158:159], v[96:97]
    v_pk_add_f32 v[160:161], v[160:161], v[98:99]
    v_pk_add_f32 v[158:159], v[158:159], v[160:161]
    v_add_f32 v158, v158, v159
    v_mov_b32 v148, v158
    v_mov_b32 v149, v158
    s_nop 1
    v_permlane32_swap_b32 v148, v149
    v_add_f32 v158, v148, v149
    v_mov_b32 v148, v158
    v_mov_b32 v149, v158
    s_nop 1
    v_permlane16_swap_b32 v148, v149
    v_add_f32 v158, v148, v149
    v_mul_f32 v158, s44, v158
    s_sub_u32 s40, s2, 3
    s_lshl_b32 s40, s40, 2
    s_add_u32 s40, s40, s3
    s_mul_i32 s40, s40, 0x1800
    s_add_u32 s40, s40, 0x540000
    v_lshlrev_b32 v148, 4, v0
    v_pk_add_f32 v[52:53], v[52:53], v[158:159] op_sel_hi:[1,0] neg_lo:[0,1] neg_hi:[0,1]
    v_cvt_pk_bf16_f32 v164, v52, v53
    v_pk_add_f32 v[54:55], v[54:55], v[158:159] op_sel_hi:[1,0] neg_lo:[0,1] neg_hi:[0,1]
    v_cvt_pk_bf16_f32 v165, v54, v55
    v_pk_add_f32 v[56:57], v[56:57], v[158:159] op_sel_hi:[1,0] neg_lo:[0,1] neg_hi:[0,1]
    v_cvt_pk_bf16_f32 v166, v56, v57
    v_pk_add_f32 v[58:59], v[58:59], v[158:159] op_sel_hi:[1,0] neg_lo:[0,1] neg_hi:[0,1]
    v_cvt_pk_bf16_f32 v167, v58, v59
    s_add_u32 s42, s40, 0
    buffer_store_dwordx4 v[164:167], v148, s[32:35], s42 offen sc1
    v_pk_add_f32 v[60:61], v[60:61], v[158:159] op_sel_hi:[1,0] neg_lo:[0,1] neg_hi:[0,1]
    v_cvt_pk_bf16_f32 v168, v60, v61
    v_pk_add_f32 v[62:63], v[62:63], v[158:159] op_sel_hi:[1,0] neg_lo:[0,1] neg_hi:[0,1]
    v_cvt_pk_bf16_f32 v169, v62, v63
    v_pk_add_f32 v[64:65], v[64:65], v[158:159] op_sel_hi:[1,0] neg_lo:[0,1] neg_hi:[0,1]
    v_cvt_pk_bf16_f32 v170, v64, v65
    v_pk_add_f32 v[66:67], v[66:67], v[158:159] op_sel_hi:[1,0] neg_lo:[0,1] neg_hi:[0,1]
    v_cvt_pk_bf16_f32 v171, v66, v67
    s_add_u32 s42, s40, 0x400
    buffer_store_dwordx4 v[168:171], v148, s[32:35], s42 offen sc1
    v_pk_add_f32 v[68:69], v[68:69], v[158:159] op_sel_hi:[1,0] neg_lo:[0,1] neg_hi:[0,1]
    v_cvt_pk_bf16_f32 v172, v68, v69
    v_pk_add_f32 v[70:71], v[70:71], v[158:159] op_sel_hi:[1,0] neg_lo:[0,1] neg_hi:[0,1]
    v_cvt_pk_bf16_f32 v173, v70, v71
    v_pk_add_f32 v[72:73], v[72:73], v[158:159] op_sel_hi:[1,0] neg_lo:[0,1] neg_hi:[0,1]
    v_cvt_pk_bf16_f32 v174, v72, v73
    v_pk_add_f32 v[74:75], v[74:75], v[158:159] op_sel_hi:[1,0] neg_lo:[0,1] neg_hi:[0,1]
    v_cvt_pk_bf16_f32 v175, v74, v75
    s_add_u32 s42, s40, 0x800
    buffer_store_dwordx4 v[172:175], v148, s[32:35], s42 offen sc1
    v_pk_add_f32 v[76:77], v[76:77], v[158:159] op_sel_hi:[1,0] neg_lo:[0,1] neg_hi:[0,1]
    v_cvt_pk_bf16_f32 v176, v76, v77
    v_pk_add_f32 v[78:79], v[78:79], v[158:159] op_sel_hi:[1,0] neg_lo:[0,1] neg_hi:[0,1]
    v_cvt_pk_bf16_f32 v177, v78, v79
    v_pk_add_f32 v[80:81], v[80:81], v[158:159] op_sel_hi:[1,0] neg_lo:[0,1] neg_hi:[0,1]
    v_cvt_pk_bf16_f32 v178, v80, v81
    v_pk_add_f32 v[82:83], v[82:83], v[158:159] op_sel_hi:[1,0] neg_lo:[0,1] neg_hi:[0,1]
    v_cvt_pk_bf16_f32 v179, v82, v83
    s_add_u32 s42, s40, 0xc00
    buffer_store_dwordx4 v[176:179], v148, s[32:35], s42 offen sc1
    v_pk_add_f32 v[84:85], v[84:85], v[158:159] op_sel_hi:[1,0] neg_lo:[0,1] neg_hi:[0,1]
    v_cvt_pk_bf16_f32 v180, v84, v85
    v_pk_add_f32 v[86:87], v[86:87], v[158:159] op_sel_hi:[1,0] neg_lo:[0,1] neg_hi:[0,1]
    v_cvt_pk_bf16_f32 v181, v86, v87
    v_pk_add_f32 v[88:89], v[88:89], v[158:159] op_sel_hi:[1,0] neg_lo:[0,1] neg_hi:[0,1]
    v_cvt_pk_bf16_f32 v182, v88, v89
    v_pk_add_f32 v[90:91], v[90:91], v[158:159] op_sel_hi:[1,0] neg_lo:[0,1] neg_hi:[0,1]
    v_cvt_pk_bf16_f32 v183, v90, v91
    s_add_u32 s42, s40, 0x1000
    buffer_store_dwordx4 v[180:183], v148, s[32:35], s42 offen sc1
    v_pk_add_f32 v[92:93], v[92:93], v[158:159] op_sel_hi:[1,0] neg_lo:[0,1] neg_hi:[0,1]
    v_cvt_pk_bf16_f32 v184, v92, v93
    v_pk_add_f32 v[94:95], v[94:95], v[158:159] op_sel_hi:[1,0] neg_lo:[0,1] neg_hi:[0,1]
    v_cvt_pk_bf16_f32 v185, v94, v95
    v_pk_add_f32 v[96:97], v[96:97], v[158:159] op_sel_hi:[1,0] neg_lo:[0,1] neg_hi:[0,1]
    v_cvt_pk_bf16_f32 v186, v96, v97
    v_pk_add_f32 v[98:99], v[98:99], v[158:159] op_sel_hi:[1,0] neg_lo:[0,1] neg_hi:[0,1]
    v_cvt_pk_bf16_f32 v187, v98, v99
    s_add_u32 s42, s40, 0x1400
    buffer_store_dwordx4 v[184:187], v148, s[32:35], s42 offen sc1
    s_waitcnt lgkmcnt(0)
    s_nop 1
    s_branch L_c_start
L_aux:
    s_sub_u32 s36, s3, 5
    v_mov_b32 v11, 0
    v_and_b32 v1, 15, v0
    v_lshrrev_b32 v2, 4, v0
    v_lshlrev_b32 v12, 4, v0
    v_mov_b32 v16, -1
    v_mov_b32 v17, -1
    v_mov_b32 v18, -1
    v_mov_b32 v19, -1
    s_waitcnt lgkmcnt(0)
    s_mov_b32 s32, s22
    s_mov_b32 s33, s23
    s_mov_b32 s34, 0x1000000
    s_mov_b32 s35, 0x20000
    s_cmp_ge_u32 s2, 3
    s_cbranch_scc1 L_aux_noinv0
    s_cmp_lg_u32 s36, 1
    s_cbranch_scc1 L_aux_noinv0
    s_lshl_b32 s38, s2, 11
    s_add_u32 s38, s38, 0x500000
    buffer_store_dwordx4 v[16:19], v12, s[32:35], s38 offen sc1
    buffer_store_dwordx4 v[16:19], v12, s[32:35], s38 offen offset:1024 sc1
    s_memrealtime s[52:53]
    s_waitcnt lgkmcnt(0)
    s_mul_i32 s54, s52, 0x9e3779b1
    s_mov_b32 s55, s53
    s_lshr_b64 s[56:57], s[54:55], 0
    s_lshl_b32 s39, s56, 1
    s_and_b32 s39, s39, 0xfffe
    v_mov_b32 v20, s39
    s_lshr_b64 s[56:57], s[54:55], 15
    s_lshl_b32 s39, s56, 1
    s_and_b32 s39, s39, 0xfffe
    v_mov_b32 v21, s39
    s_lshr_b64 s[56:57], s[54:55], 30
    s_lshl_b32 s39, s56, 1
    s_and_b32 s39, s39, 0xfffe
    v_mov_b32 v22, s39
    s_mul_i32 s39, s54, 0x85ebca6b
    s_lshr_b32 s39, s39, 16
    s_and_b32 s39, s39, 0xfffe
    v_mov_b32 v23, s39
    s_lshl_b32 s38, s2, 7
    s_add_u32 s38, s38, 0x501800
    s_mov_b64 exec, 1
    buffer_store_dwordx4 v[20:23], v11, s[32:35], s38 offen sc1
    s_mov_b64 exec, -1
L_aux_noinv0:
    s_barrier
    s_mov_b32 s44, s20
    s_mov_b32 s45, s21
    s_mov_b32 s46, 0x100
    s_mov_b32 s47, 0x20000
    s_cmp_ge_u32 s2, 3
    s_cbranch_scc1 L_aux_noinv
    s_cmp_lg_u32 s36, 1
    s_cbranch_scc1 L_aux_noinv
    v_mov_b32 v14, 1
    s_lshl_b32 s38, s2, 5
    s_waitcnt vmcnt(0)
    ds_write_b32 v11, v14 offset:6960
    s_mov_b64 exec, 1
    buffer_store_dword v14, v11, s[44:47], s38 offen sc1
    s_mov_b64 exec, -1
    s_nop 2
L_aux_noinv:
    s_cmp_lt_u32 s2, 3
    s_cselect_b32 s39, 40, 0
    v_mov_b32 v15, s39
    s_cmp_lg_u32 s36, 0
    s_cbranch_scc1 L_aux_w
    v_mul_u32_u24 v14, 0x180, v1
    v_and_b32 v16, 1, v2
    v_lshl_add_u32 v14, v16, 3, v14
    v_lshrrev_b32 v16, 1, v2
    v_and_b32 v13, 6, v1
    v_xor_b32 v16, v16, v13
    v_xor_b32 v13, 0, v16
    v_lshl_add_u32 v232, v13, 4, v14
    v_xor_b32 v13, 2, v16
    v_lshl_add_u32 v233, v13, 4, v14
    v_xor_b32 v13, 4, v16
    v_lshl_add_u32 v234, v13, 4, v14
    v_xor_b32 v13, 6, v16
    v_lshl_add_u32 v235, v13, 4, v14
    v_lshlrev_b32 v13, 5, v0
    s_cmp_lt_u32 s2, 6
    s_cselect_b32 s38, 1, 3
L_spin86:
    ds_read_b32 v14, v15 offset:6912
    s_waitcnt lgkmcnt(0)
    v_readfirstlane_b32 s37, v14
    s_nop 0
    s_cmp_ge_u32 s37, s38
    s_cbranch_scc1 L_spun87
    s_sleep 4
    s_branch L_spin86
L_spun87:
    s_mov_b64 exec, 7
L_qpoll:
    buffer_load_dword v14, v13, s[44:47], 0 offen sc1
    s_waitcnt vmcnt(0)
    v_cmp_eq_u32 vcc, 0, v14
    s_cbranch_vccz L_qpolled
    s_sleep 8
    s_branch L_qpoll
L_qpolled:
    s_mov_b64 exec, -1
    s_cmp_lt_u32 s2, 6
    s_cselect_b32 s38, 3, 6
    s_cmp_lt_u32 s2, 3
    s_cselect_b32 s38, 4, s38
L_spin88:
    ds_read_b32 v14, v15 offset:6912
    s_waitcnt lgkmcnt(0)
    v_readfirstlane_b32 s37, v14
    s_nop 0
    s_cmp_ge_u32 s37, s38
    s_cbranch_scc1 L_spun89
    s_sleep 2
    s_branch L_spin88
L_spun89:
    s_mov_b32 s38, 0x501800
    buffer_load_dwordx4 v[236:239], v11, s[32:35], s38 offen sc1
L_qdata:
    s_mov_b32 s38, 0x500000
    buffer_load_dwordx4 v[208:211], v12, s[32:35], s38 offen sc1
    s_mov_b32 s38, 0x500400
    buffer_load_dwordx4 v[212:215], v12, s[32:35], s38 offen sc1
    s_mov_b32 s38, 0x500800
    buffer_load_dwordx4 v[216:219], v12, s[32:35], s38 offen sc1
    s_mov_b32 s38, 0x500c00
    buffer_load_dwordx4 v[220:223], v12, s[32:35], s38 offen sc1
    s_mov_b32 s38, 0x501000
    buffer_load_dwordx4 v[224:227], v12, s[32:35], s38 offen sc1
    s_mov_b32 s38, 0x501400
    buffer_load_dwordx4 v[228:231], v12, s[32:35], s38 offen sc1
    s_waitcnt vmcnt(0)
    v_max3_u32 v14, v208, v209, v210
    v_max3_u32 v14, v14, v211, v212
    v_max3_u32 v14, v14, v213, v214
    v_max3_u32 v14, v14, v215, v216
    v_max3_u32 v14, v14, v217, v218
    v_max3_u32 v14, v14, v219, v220
    v_max3_u32 v14, v14, v221, v222
    v_max3_u32 v14, v14, v223, v224
    v_max3_u32 v14, v14, v225, v226
    v_max3_u32 v14, v14, v227, v228
    v_max3_u32 v14, v14, v229, v230
    v_max_u32 v14, v14, v231
    v_cmp_eq_u32 vcc, -1, v14
    s_cbranch_vccnz L_qdata
    ds_write_b128 v11, v[236:239] offset:7040
    ds_write_b64 v232, v[208:209]
    ds_write_b64 v233, v[210:211]
    ds_write_b64 v234, v[212:213]
    ds_write_b64 v235, v[214:215]
    ds_write_b64 v232, v[216:217] offset:128
    ds_write_b64 v233, v[218:219] offset:128
    ds_write_b64 v234, v[220:221] offset:128
    ds_write_b64 v235, v[222:223] offset:128
    ds_write_b64 v232, v[224:225] offset:256
    ds_write_b64 v233, v[226:227] offset:256
    ds_write_b64 v234, v[228:229] offset:256
    ds_write_b64 v235, v[230:231] offset:256
    v_mov_b32 v14, 1
    ds_write_b32 v11, v14 offset:6944
    s_nop 0
L_aux_w:
    s_cmp_lg_u32 s36, 2
    s_cbranch_scc1 L_aux_wf2
    v_lshlrev_b32 v13, 2, v0
    s_nop 1
L_spin90:
    ds_read_b32 v14, v11 offset:6912
    s_waitcnt lgkmcnt(0)
    v_readfirstlane_b32 s37, v14
    s_nop 0
    s_cmp_ge_u32 s37, 10
    s_cbranch_scc1 L_spun91
    s_sleep 8
    s_branch L_spin90
L_spun91:
L_spin92:
    ds_read_b32 v14, v11 offset:6944
    s_waitcnt lgkmcnt(0)
    v_readfirstlane_b32 s37, v14
    s_nop 0
    s_cmp_ge_u32 s37, 1
    s_cbranch_scc1 L_spun93
    s_sleep 8
    s_branch L_spin92
L_spun93:
    s_mov_b64 exec, 0xfff
L_wpoll:
    buffer_load_dword v14, v13, s[44:47], 0 offen offset:128 sc1
    s_waitcnt vmcnt(0)
    v_cmp_eq_u32 vcc, 0, v14
    s_cbranch_vccz L_wpolled
    s_sleep 16
    s_branch L_wpoll
L_wpolled:
    s_mov_b64 exec, -1
    v_mov_b32 v14, 1
    ds_write_b32 v11, v14 offset:6976
    s_nop 0
L_aux_wf2:
L_spin94:
    ds_read_b32 v14, v11 offset:6976
    s_waitcnt lgkmcnt(0)
    v_readfirstlane_b32 s37, v14
    s_nop 0
    s_cmp_ge_u32 s37, 1
    s_cbranch_scc1 L_spun95
    s_sleep 8
    s_branch L_spin94
L_spun95:
    s_mul_i32 s37, s36, 0x4800
    s_add_u32 s37, s37, 0x540000
    s_add_u32 s38, s37, 0
    buffer_load_dwordx4 v[112:115], v12, s[32:35], s38 offen sc1
    s_add_u32 s38, s37, 0x400
    buffer_load_dwordx4 v[124:127], v12, s[32:35], s38 offen sc1
    s_add_u32 s38, s37, 0x800
    buffer_load_dwordx4 v[136:139], v12, s[32:35], s38 offen sc1
    s_waitcnt vmcnt(0)
    s_add_u32 s38, s37, 0xc00
    buffer_load_dwordx4 v[148:151], v12, s[32:35], s38 offen sc1
    s_add_u32 s38, s37, 0x1000
    buffer_load_dwordx4 v[160:163], v12, s[32:35], s38 offen sc1
    s_add_u32 s38, s37, 0x1400
    buffer_load_dwordx4 v[172:175], v12, s[32:35], s38 offen sc1
    s_waitcnt vmcnt(0)
    s_add_u32 s38, s37, 0x1800
    buffer_load_dwordx4 v[116:119], v12, s[32:35], s38 offen sc1
    s_add_u32 s38, s37, 0x1c00
    buffer_load_dwordx4 v[128:131], v12, s[32:35], s38 offen sc1
    s_add_u32 s38, s37, 0x2000
    buffer_load_dwordx4 v[140:143], v12, s[32:35], s38 offen sc1
    s_waitcnt vmcnt(0)
    s_add_u32 s38, s37, 0x2400
    buffer_load_dwordx4 v[152:155], v12, s[32:35], s38 offen sc1
    s_add_u32 s38, s37, 0x2800
    buffer_load_dwordx4 v[164:167], v12, s[32:35], s38 offen sc1
    s_add_u32 s38, s37, 0x2c00
    buffer_load_dwordx4 v[176:179], v12, s[32:35], s38 offen sc1
    s_waitcnt vmcnt(0)
    s_add_u32 s38, s37, 0x3000
    buffer_load_dwordx4 v[120:123], v12, s[32:35], s38 offen sc1
    s_add_u32 s38, s37, 0x3400
    buffer_load_dwordx4 v[132:135], v12, s[32:35], s38 offen sc1
    s_add_u32 s38, s37, 0x3800
    buffer_load_dwordx4 v[144:147], v12, s[32:35], s38 offen sc1
    s_waitcnt vmcnt(0)
    s_add_u32 s38, s37, 0x3c00
    buffer_load_dwordx4 v[156:159], v12, s[32:35], s38 offen sc1
    s_add_u32 s38, s37, 0x4000
    buffer_load_dwordx4 v[168:171], v12, s[32:35], s38 offen sc1
    s_add_u32 s38, s37, 0x4400
    buffer_load_dwordx4 v[180:183], v12, s[32:35], s38 offen sc1
    s_waitcnt vmcnt(0)
L_tail:
    v_lshlrev_b32 v6, 4, v1
    v_add_u32 v2, 0x3400, v12
    v_add_u32 v3, 0x15400, v12
    v_add_u32 v4, 0x6400, v6
    v_add_u32 v5, 0x18400, v6
    s_lshl_b32 s49, s2, 13
    s_lshl_b32 s38, s36, 11
    s_add_u32 s49, s49, s38
    s_mov_b32 s51, 0x42200000
    v_and_b32 v8, 3, v1
    v_lshlrev_b32 v8, 2, v8
    ds_read_b32 v200, v8 offset:7040
    s_nop 0
L_spin96:
    ds_read_b32 v15, v11 offset:6992
    s_waitcnt lgkmcnt(0)
    v_readfirstlane_b32 s37, v15
    s_nop 0
    s_cmp_ge_u32 s37, 1
    s_cbranch_scc1 L_spun97
    s_sleep 1
    s_branch L_spin96
L_spun97:
    ds_read_b32 v76, v11 offset:6992
    ds_read_b128 v[48:51], v2
    ds_read_b128 v[52:55], v2 offset:1024
    ds_read_b128 v[56:59], v2 offset:2048
    ds_read_b128 v[60:63], v2 offset:3072
    ds_read_b128 v[64:67], v2 offset:4096
    ds_read_b128 v[68:71], v2 offset:5120
    ds_read_b128 v[72:75], v4
    s_waitcnt vmcnt(0)
L_bt98:
    s_waitcnt lgkmcnt(0)
    v_readfirstlane_b32 s37, v76
    s_nop 0
    s_cmp_eq_u32 s37, 1
    s_cbranch_scc1 L_bo99
    s_cmp_eq_u32 s37, 2
    s_cbranch_scc1 L_agen
    ds_read_b32 v76, v11 offset:6992
    ds_read_b128 v[48:51], v2
    ds_read_b128 v[52:55], v2 offset:1024
    ds_read_b128 v[56:59], v2 offset:2048
    ds_read_b128 v[60:63], v2 offset:3072
    ds_read_b128 v[64:67], v2 offset:4096
    ds_read_b128 v[68:71], v2 offset:5120
    ds_read_b128 v[72:75], v4
    s_branch L_bt98
L_bo99:
    v_mfma_f32_16x16x32_bf16 v[16:19], v[112:115], v[48:51], 0
    ds_read_b32 v108, v11 offset:6996
    v_mfma_f32_16x16x32_bf16 v[20:23], v[116:119], v[48:51], 0
    ds_read_b128 v[80:83], v2 offset:36864
    v_mfma_f32_16x16x32_bf16 v[24:27], v[120:123], v[48:51], 0
    ds_read_b128 v[84:87], v2 offset:37888
    v_mfma_f32_16x16x32_bf16 v[16:19], v[124:127], v[52:55], v[16:19]
    ds_read_b128 v[88:91], v2 offset:38912
    v_mfma_f32_16x16x32_bf16 v[20:23], v[128:131], v[52:55], v[20:23]
    ds_read_b128 v[92:95], v2 offset:39936
    v_mfma_f32_16x16x32_bf16 v[24:27], v[132:135], v[52:55], v[24:27]
    ds_read_b128 v[96:99], v2 offset:40960
    v_mfma_f32_16x16x32_bf16 v[16:19], v[136:139], v[56:59], v[16:19]
    ds_read_b128 v[100:103], v2 offset:41984
    v_mfma_f32_16x16x32_bf16 v[20:23], v[140:143], v[56:59], v[20:23]
    ds_read_b128 v[104:107], v4 offset:36864
    v_mfma_f32_16x16x32_bf16 v[24:27], v[144:147], v[56:59], v[24:27]
    v_add_f32 v72, v72, v73
    v_mfma_f32_16x16x32_bf16 v[16:19], v[148:151], v[60:63], v[16:19]
    v_add_f32 v74, v74, v75
    v_mfma_f32_16x16x32_bf16 v[20:23], v[152:155], v[60:63], v[20:23]
    v_add_f32 v7, v72, v74
    v_mfma_f32_16x16x32_bf16 v[24:27], v[156:159], v[60:63], v[24:27]
    v_mfma_f32_16x16x32_bf16 v[16:19], v[160:163], v[64:67], v[16:19]
    v_mfma_f32_16x16x32_bf16 v[20:23], v[164:167], v[64:67], v[20:23]
    v_mfma_f32_16x16x32_bf16 v[24:27], v[168:171], v[64:67], v[24:27]
    v_mfma_f32_16x16x32_bf16 v[16:19], v[172:175], v[68:71], v[16:19]
    v_mfma_f32_16x16x32_bf16 v[20:23], v[176:179], v[68:71], v[20:23]
    v_mfma_f32_16x16x32_bf16 v[24:27], v[180:183], v[68:71], v[24:27]
L_bt100:
    s_waitcnt lgkmcnt(0)
    v_readfirstlane_b32 s37, v108
    s_nop 0
    s_cmp_eq_u32 s37, 1
    s_cbranch_scc1 L_bo101
    s_cmp_eq_u32 s37, 2
    s_cbranch_scc1 L_agen
    ds_read_b32 v108, v11 offset:6996
    ds_read_b128 v[80:83], v2 offset:36864
    ds_read_b128 v[84:87], v2 offset:37888
    ds_read_b128 v[88:91], v2 offset:38912
    ds_read_b128 v[92:95], v2 offset:39936
    ds_read_b128 v[96:99], v2 offset:40960
    ds_read_b128 v[100:103], v2 offset:41984
    ds_read_b128 v[104:107], v4 offset:36864
    s_branch L_bt100
L_bo101:
    v_mfma_f32_16x16x32_bf16 v[16:19], v[112:115], v[80:83], v[16:19]
    ds_read_b32 v76, v11 offset:7000
    v_mfma_f32_16x16x32_bf16 v[20:23], v[116:119], v[80:83], v[20:23]
    ds_read_b128 v[48:51], v3
    v_mfma_f32_16x16x32_bf16 v[24:27], v[120:123], v[80:83], v[24:27]
    ds_read_b128 v[52:55], v3 offset:1024
    v_mfma_f32_16x16x32_bf16 v[16:19], v[124:127], v[84:87], v[16:19]
    ds_read_b128 v[56:59], v3 offset:2048
    v_mfma_f32_16x16x32_bf16 v[20:23], v[128:131], v[84:87], v[20:23]
    ds_read_b128 v[60:63], v3 offset:3072
    v_mfma_f32_16x16x32_bf16 v[24:27], v[132:135], v[84:87], v[24:27]
    ds_read_b128 v[64:67], v3 offset:4096
    v_mfma_f32_16x16x32_bf16 v[16:19], v[136:139], v[88:91], v[16:19]
    ds_read_b128 v[68:71], v3 offset:5120
    v_mfma_f32_16x16x32_bf16 v[20:23], v[140:143], v[88:91], v[20:23]
    ds_read_b128 v[72:75], v5
    v_mfma_f32_16x16x32_bf16 v[24:27], v[144:147], v[88:91], v[24:27]
    v_add_f32 v104, v104, v105
    v_mfma_f32_16x16x32_bf16 v[16:19], v[148:151], v[92:95], v[16:19]
    v_add_f32 v106, v106, v107
    v_mfma_f32_16x16x32_bf16 v[20:23], v[152:155], v[92:95], v[20:23]
    v_add_f32 v104, v104, v106
    v_mfma_f32_16x16x32_bf16 v[24:27], v[156:159], v[92:95], v[24:27]
    v_add_f32 v7, v7, v104
    v_mfma_f32_16x16x32_bf16 v[16:19], v[160:163], v[96:99], v[16:19]
    v_mfma_f32_16x16x32_bf16 v[20:23], v[164:167], v[96:99], v[20:23]
    v_mfma_f32_16x16x32_bf16 v[24:27], v[168:171], v[96:99], v[24:27]
    v_mfma_f32_16x16x32_bf16 v[16:19], v[172:175], v[100:103], v[16:19]
    v_mfma_f32_16x16x32_bf16 v[20:23], v[176:179], v[100:103], v[20:23]
    v_mfma_f32_16x16x32_bf16 v[24:27], v[180:183], v[100:103], v[24:27]
L_bt102:
    s_waitcnt lgkmcnt(0)
    v_readfirstlane_b32 s37, v76
    s_nop 0
    s_cmp_eq_u32 s37, 1
    s_cbranch_scc1 L_bo103
    s_cmp_eq_u32 s37, 2
    s_cbranch_scc1 L_agen
    ds_read_b32 v76, v11 offset:7000
    ds_read_b128 v[48:51], v3
    ds_read_b128 v[52:55], v3 offset:1024
    ds_read_b128 v[56:59], v3 offset:2048
    ds_read_b128 v[60:63], v3 offset:3072
    ds_read_b128 v[64:67], v3 offset:4096
    ds_read_b128 v[68:71], v3 offset:5120
    ds_read_b128 v[72:75], v5
    s_branch L_bt102
L_bo103:
    v_mfma_f32_16x16x32_bf16 v[16:19], v[112:115], v[48:51], v[16:19]
    ds_read_b32 v108, v11 offset:7004
    v_mfma_f32_16x16x32_bf16 v[20:23], v[116:119], v[48:51], v[20:23]
    ds_read_b128 v[80:83], v3 offset:36864
    v_mfma_f32_16x16x32_bf16 v[24:27], v[120:123], v[48:51], v[24:27]
    ds_read_b128 v[84:87], v3 offset:37888
    v_mfma_f32_16x16x32_bf16 v[16:19], v[124:127], v[52:55], v[16:19]
    ds_read_b128 v[88:91], v3 offset:38912
    v_mfma_f32_16x16x32_bf16 v[20:23], v[128:131], v[52:55], v[20:23]
    ds_read_b128 v[92:95], v3 offset:39936
    v_mfma_f32_16x16x32_bf16 v[24:27], v[132:135], v[52:55], v[24:27]
    ds_read_b128 v[96:99], v3 offset:40960
    v_mfma_f32_16x16x32_bf16 v[16:19], v[136:139], v[56:59], v[16:19]
    ds_read_b128 v[100:103], v3 offset:41984
    v_mfma_f32_16x16x32_bf16 v[20:23], v[140:143], v[56:59], v[20:23]
    ds_read_b128 v[104:107], v5 offset:36864
    v_mfma_f32_16x16x32_bf16 v[24:27], v[144:147], v[56:59], v[24:27]
    v_add_f32 v72, v72, v73
    v_mfma_f32_16x16x32_bf16 v[16:19], v[148:151], v[60:63], v[16:19]
    v_add_f32 v74, v74, v75
    v_mfma_f32_16x16x32_bf16 v[20:23], v[152:155], v[60:63], v[20:23]
    v_add_f32 v72, v72, v74
    v_mfma_f32_16x16x32_bf16 v[24:27], v[156:159], v[60:63], v[24:27]
    v_add_f32 v7, v7, v72
    v_mfma_f32_16x16x32_bf16 v[16:19], v[160:163], v[64:67], v[16:19]
    v_mfma_f32_16x16x32_bf16 v[20:23], v[164:167], v[64:67], v[20:23]
    v_mfma_f32_16x16x32_bf16 v[24:27], v[168:171], v[64:67], v[24:27]
    v_mfma_f32_16x16x32_bf16 v[16:19], v[172:175], v[68:71], v[16:19]
    v_mfma_f32_16x16x32_bf16 v[20:23], v[176:179], v[68:71], v[20:23]
    v_mfma_f32_16x16x32_bf16 v[24:27], v[180:183], v[68:71], v[24:27]
L_bt104:
    s_waitcnt lgkmcnt(0)
    v_readfirstlane_b32 s37, v108
    s_nop 0
    s_cmp_eq_u32 s37, 1
    s_cbranch_scc1 L_bo105
    s_cmp_eq_u32 s37, 2
    s_cbranch_scc1 L_agen
    ds_read_b32 v108, v11 offset:7004
    ds_read_b128 v[80:83], v3 offset:36864
    ds_read_b128 v[84:87], v3 offset:37888
    ds_read_b128 v[88:91], v3 offset:38912
    ds_read_b128 v[92:95], v3 offset:39936
    ds_read_b128 v[96:99], v3 offset:40960
    ds_read_b128 v[100:103], v3 offset:41984
    ds_read_b128 v[104:107], v5 offset:36864
    s_branch L_bt104
L_bo105:
    v_mfma_f32_16x16x32_bf16 v[16:19], v[112:115], v[80:83], v[16:19]
    v_add_f32 v104, v104, v105
    v_mfma_f32_16x16x32_bf16 v[20:23], v[116:119], v[80:83], v[20:23]
    v_add_f32 v106, v106, v107
    v_mfma_f32_16x16x32_bf16 v[16:19], v[124:127], v[84:87], v[16:19]
    v_add_f32 v104, v104, v106
    v_mfma_f32_16x16x32_bf16 v[20:23], v[128:131], v[84:87], v[20:23]
    v_add_f32 v7, v7, v104
    v_mfma_f32_16x16x32_bf16 v[16:19], v[136:139], v[88:91], v[16:19]
    v_cvt_pk_bf16_f32 v8, 0, v7
    v_mfma_f32_16x16x32_bf16 v[20:23], v[140:143], v[88:91], v[20:23]
    v_or_b32 v195, v8, v200
    v_mfma_f32_16x16x32_bf16 v[16:19], v[148:151], v[92:95], v[16:19]
    v_or_b32 v199, v8, v200
    v_mfma_f32_16x16x32_bf16 v[20:23], v[152:155], v[92:95], v[20:23]
    v_mfma_f32_16x16x32_bf16 v[16:19], v[160:163], v[96:99], v[16:19]
    v_mfma_f32_16x16x32_bf16 v[20:23], v[164:167], v[96:99], v[20:23]
    v_mfma_f32_16x16x32_bf16 v[16:19], v[172:175], v[100:103], v[16:19]
    v_mfma_f32_16x16x32_bf16 v[20:23], v[176:179], v[100:103], v[20:23]
    v_mfma_f32_16x16x32_bf16 v[24:27], v[120:123], v[80:83], v[24:27]
    v_mfma_f32_16x16x32_bf16 v[24:27], v[132:135], v[84:87], v[24:27]
    v_mfma_f32_16x16x32_bf16 v[24:27], v[144:147], v[88:91], v[24:27]
    s_nop 2
    s_nop 0
    v_cvt_pk_bf16_f32 v192, v16, v17
    v_cvt_pk_bf16_f32 v193, v18, v19
    v_mfma_f32_16x16x32_bf16 v[24:27], v[156:159], v[92:95], v[24:27]
    v_cvt_pk_bf16_f32 v194, v20, v21
    buffer_store_dwordx4 v[192:195], v12, s[32:35], s49 offen sc1
    v_mfma_f32_16x16x32_bf16 v[24:27], v[168:171], v[96:99], v[24:27]
    v_cvt_pk_bf16_f32 v196, v22, v23
    v_mfma_f32_16x16x32_bf16 v[24:27], v[180:183], v[100:103], v[24:27]
    s_nop 7
    v_cvt_pk_bf16_f32 v197, v24, v25
    v_cvt_pk_bf16_f32 v198, v26, v27
    buffer_store_dwordx4 v[196:199], v12, s[32:35], s49 offen offset:1024 sc1
L_aend:
    v_mov_b32 v15, 1
    s_mov_b64 exec, 1
    ds_add_u32 v11, v15 offset:6964
    s_mov_b64 exec, -1
    s_endpgm
L_agen:
L_spin106:
    ds_read_b32 v15, v11 offset:6992
    s_waitcnt lgkmcnt(0)
    v_readfirstlane_b32 s37, v15
    s_nop 0
    s_cmp_ge_u32 s37, 1
    s_cbranch_scc1 L_spun107
    s_sleep 1
    s_branch L_spin106
L_spun107:
    v_add_u32 v3, 0x6400, v6
    ds_read_b32 v205, v3 offset:512
    s_waitcnt lgkmcnt(0)
    v_mov_b32 v9, v205
    s_nop 1
L_spin108:
    ds_read_b32 v15, v11 offset:6996
    s_waitcnt lgkmcnt(0)
    v_readfirstlane_b32 s37, v15
    s_nop 0
    s_cmp_ge_u32 s37, 1
    s_cbranch_scc1 L_spun109
    s_sleep 1
    s_branch L_spin108
L_spun109:
    v_add_u32 v3, 0xf400, v6
    ds_read_b32 v205, v3 offset:512
    s_waitcnt lgkmcnt(0)
    v_max_f32 v9, v9, v205
    s_nop 1
L_spin110:
    ds_read_b32 v15, v11 offset:7000
    s_waitcnt lgkmcnt(0)
    v_readfirstlane_b32 s37, v15
    s_nop 0
    s_cmp_ge_u32 s37, 1
    s_cbranch_scc1 L_spun111
    s_sleep 1
    s_branch L_spin110
L_spun111:
    v_add_u32 v3, 0x18400, v6
    ds_read_b32 v205, v3 offset:512
    s_waitcnt lgkmcnt(0)
    v_max_f32 v9, v9, v205
    s_nop 1
L_spin112:
    ds_read_b32 v15, v11 offset:7004
    s_waitcnt lgkmcnt(0)
    v_readfirstlane_b32 s37, v15
    s_nop 0
    s_cmp_ge_u32 s37, 1
    s_cbranch_scc1 L_spun113
    s_sleep 1
    s_branch L_spin112
L_spun113:
    v_add_u32 v3, 0x21400, v6
    ds_read_b32 v205, v3 offset:512
    s_waitcnt lgkmcnt(0)
    v_max_f32 v9, v9, v205
    v_cmp_nlt_f32_e64 s[56:57], |v9|, s51
    s_nop 1
    v_cndmask_b32 v10, 0, v9, s[56:57]
    v_mov_b32 v7, 0
    v_mov_b32 v16, 0
    v_mov_b32 v17, 0
    v_mov_b32 v18, 0
    v_mov_b32 v19, 0
    v_mov_b32 v20, 0
    v_mov_b32 v21, 0
    v_mov_b32 v22, 0
    v_mov_b32 v23, 0
    v_mov_b32 v24, 0
    v_mov_b32 v25, 0
    v_mov_b32 v26, 0
    v_mov_b32 v27, 0
    s_mov_b32 s58, 0
    s_nop 0
L_agen_w:
    s_mul_i32 s59, s58, 0x9000
    s_add_u32 s59, s59, 0x3400
    v_add_u32 v2, s59, v12
    v_add_u32 v3, s59, v6
    ds_read_b128 v[48:51], v2
    ds_read_b128 v[52:55], v2 offset:1024
    ds_read_b128 v[56:59], v2 offset:2048
    ds_read_b128 v[60:63], v2 offset:3072
    ds_read_b128 v[64:67], v2 offset:4096
    ds_read_b128 v[68:71], v2 offset:5120
    ds_read_b32 v205, v3 offset:12800
    ds_read_b128 v[72:75], v3 offset:12288
    s_waitcnt lgkmcnt(0)
    v_mfma_f32_16x16x32_bf16 v[32:35], v[112:115], v[48:51], 0
    v_mfma_f32_16x16x32_bf16 v[36:39], v[116:119], v[48:51], 0
    v_mfma_f32_16x16x32_bf16 v[40:43], v[120:123], v[48:51], 0
    v_mfma_f32_16x16x32_bf16 v[32:35], v[124:127], v[52:55], v[32:35]
    v_mfma_f32_16x16x32_bf16 v[36:39], v[128:131], v[52:55], v[36:39]
    v_mfma_f32_16x16x32_bf16 v[40:43], v[132:135], v[52:55], v[40:43]
    v_mfma_f32_16x16x32_bf16 v[32:35], v[136:139], v[56:59], v[32:35]
    v_mfma_f32_16x16x32_bf16 v[36:39], v[140:143], v[56:59], v[36:39]
    v_mfma_f32_16x16x32_bf16 v[40:43], v[144:147], v[56:59], v[40:43]
    v_mfma_f32_16x16x32_bf16 v[32:35], v[148:151], v[60:63], v[32:35]
    v_mfma_f32_16x16x32_bf16 v[36:39], v[152:155], v[60:63], v[36:39]
    v_mfma_f32_16x16x32_bf16 v[40:43], v[156:159], v[60:63], v[40:43]
    v_mfma_f32_16x16x32_bf16 v[32:35], v[160:163], v[64:67], v[32:35]
    v_mfma_f32_16x16x32_bf16 v[36:39], v[164:167], v[64:67], v[36:39]
    v_mfma_f32_16x16x32_bf16 v[40:43], v[168:171], v[64:67], v[40:43]
    v_mfma_f32_16x16x32_bf16 v[32:35], v[172:175], v[68:71], v[32:35]
    v_mfma_f32_16x16x32_bf16 v[36:39], v[176:179], v[68:71], v[36:39]
    v_mfma_f32_16x16x32_bf16 v[40:43], v[180:183], v[68:71], v[40:43]
    v_sub_f32 v14, v205, v10
    v_exp_f32 v13, v14
    v_add_f32 v72, v72, v73
    v_add_f32 v74, v74, v75
    v_add_f32 v72, v72, v74
    v_fmac_f32 v7, v13, v72
    v_fmac_f32 v16, v13, v32
    v_fmac_f32 v17, v13, v33
    v_fmac_f32 v18, v13, v34
    v_fmac_f32 v19, v13, v35
    v_fmac_f32 v20, v13, v36
    v_fmac_f32 v21, v13, v37
    v_fmac_f32 v22, v13, v38
    v_fmac_f32 v23, v13, v39
    v_fmac_f32 v24, v13, v40
    v_fmac_f32 v25, v13, v41
    v_fmac_f32 v26, v13, v42
    v_fmac_f32 v27, v13, v43
    s_add_u32 s58, s58, 1
    s_cmp_lt_u32 s58, 4
    s_cbranch_scc1 L_agen_w
    v_cndmask_b32 v14, 0, 1, s[56:57]
    v_or_b32 v200, v200, v14
    ds_read_b64 v[74:75], v11 offset:7040
    v_mov_b32 v72, v10
    v_lshrrev_b32 v14, 1, v6
    s_lshl_b32 s38, s2, 7
    s_add_u32 s38, s38, 0x400000
    s_waitcnt lgkmcnt(0)
    v_lshl_or_b32 v73, v75, 16, v74
    s_mov_b64 exec, 0xffff
    buffer_store_dwordx2 v[72:73], v14, s[32:35], s38 offen sc1
    s_mov_b64 exec, -1
    v_cvt_pk_bf16_f32 v8, 0, v7
    v_or_b32 v195, v8, v200
    v_or_b32 v199, v8, v200
    v_cvt_pk_bf16_f32 v192, v16, v17
    v_cvt_pk_bf16_f32 v193, v18, v19
    v_cvt_pk_bf16_f32 v194, v20, v21
    buffer_store_dwordx4 v[192:195], v12, s[32:35], s49 offen sc1
    v_cvt_pk_bf16_f32 v196, v22, v23
    v_cvt_pk_bf16_f32 v197, v24, v25
    v_cvt_pk_bf16_f32 v198, v26, v27
    buffer_store_dwordx4 v[196:199], v12, s[32:35], s49 offen offset:1024 sc1
    s_nop 1
    s_branch L_aend
L_exit:
    s_endpgm
L_code_end:
.section .rodata,"a"
.p2align 6
.amdhsa_kernel standalone__detection_seg_dino__vision_kernel
  .amdhsa_next_free_vgpr 256
  .amdhsa_next_free_sgpr 96
  .amdhsa_accum_offset 256
  .amdhsa_group_segment_fixed_size 0
  .amdhsa_kernarg_size 80
  .amdhsa_user_sgpr_count 2
  .amdhsa_user_sgpr_kernarg_segment_ptr 1
  .amdhsa_system_sgpr_workgroup_id_x 1
  .amdhsa_float_denorm_mode_32 3
.end_amdhsa_kernel
```

```asm
; @launch grid=(256,1,1) block=(512,1,1) lds=160768
.amdgcn_target "amdgcn-amd-amdhsa--gfx950"
.text
.globl standalone__detection_seg_dino__vision_kernel
.p2align 8
.type standalone__detection_seg_dino__vision_kernel,@function
standalone__detection_seg_dino__vision_kernel:
    s_cmp_ge_u32 s2, 0x100
    s_cbranch_scc1 L_exit
    s_load_dwordx16 s[4:19], s[0:1], 0
    s_load_dwordx4 s[20:23], s[0:1], 64
    v_lshrrev_b32 v1, 6, v0
    v_and_b32 v0, 63, v0
    v_readfirstlane_b32 s3, v1
    s_nop 2
    s_cmp_lt_u32 s3, 4
    s_cbranch_scc1 L_compute
    s_cmp_gt_u32 s3, 4
    s_cbranch_scc1 L_aux0
    s_setprio 3
    v_add_u32 v4, 0, v0
    v_mul_u32_u24 v4, 0xaab, v4
    v_lshrrev_b32 v4, 16, v4
    v_and_b32 v11, 6, v4
    v_xor_b32 v11, v11, v0
    v_lshlrev_b32 v1, 4, v11
    v_add_u32 v5, 64, v0
    v_mul_u32_u24 v5, 0xaab, v5
    v_lshrrev_b32 v5, 16, v5
    v_and_b32 v11, 6, v5
    v_xor_b32 v11, v11, v0
    v_lshlrev_b32 v2, 4, v11
    v_add_u32 v6, 0x80, v0
    v_mul_u32_u24 v6, 0xaab, v6
    v_lshrrev_b32 v6, 16, v6
    v_and_b32 v11, 6, v6
    v_xor_b32 v11, v11, v0
    v_lshlrev_b32 v3, 4, v11
    s_and_b32 s38, s2, 7
    s_lshl_b32 s38, s38, 5
    s_lshr_b32 s45, s2, 3
    s_or_b32 s38, s38, s45
    s_lshl_b32 s38, s38, 2
    s_mov_b32 s27, 0x20000
    s_mov_b32 s26, 0x1800000
    s_mul_i32 s39, s38, 0x1800
    s_mov_b32 s44, 0x3400
    s_cmp_lt_u32 s2, 6
    s_cbranch_scc1 L_ld_prod
    s_waitcnt lgkmcnt(0)
    s_mov_b32 s24, s8
    s_mov_b32 s25, s9
L_ld_first:
    s_mov_b32 m0, s44
    s_add_u32 s46, s39, 0xc00
    buffer_load_dwordx4 v1, s[24:27], s39 offen nt lds
    buffer_load_dwordx4 v2, s[24:27], s39 offen offset:1024 nt lds
    buffer_load_dwordx4 v3, s[24:27], s39 offen offset:2048 nt lds
    s_add_u32 m0, s44, 0xc00
    s_add_u32 s44, s44, 0x9000
    buffer_load_dwordx4 v1, s[24:27], s46 offen nt lds
    buffer_load_dwordx4 v2, s[24:27], s46 offen offset:1024 nt lds
    buffer_load_dwordx4 v3, s[24:27], s46 offen offset:2048 nt lds
    s_add_u32 s39, s39, 0x1800
    s_cmp_lt_u32 s44, 0x27400
    s_cbranch_scc1 L_ld_first
    s_branch L_ld_norm
L_aux0:
    s_getpc_b64 s[24:25]
L_aux_pc:
    s_sub_u32 s24, s24, L_aux_pc-standalone__detection_seg_dino__vision_kernel
    s_subb_u32 s25, s25, 0
    s_mov_b32 s26, L_code_end-standalone__detection_seg_dino__vision_kernel
    s_mov_b32 s27, 0x20000
    s_lshr_b32 s39, s2, 3
    s_mul_i32 s38, s39, 3
    s_add_u32 s38, s38, s3
    s_mul_i32 s38, s38, 0x140
    s_sub_u32 s38, s38, 0x640
    v_lshlrev_b32 v14, 6, v0
    s_mov_b64 exec, 31
    buffer_load_dword v253, v14, s[24:27], s38 offen
    s_mov_b64 exec, -1
    s_and_b32 s38, s2, 7
    s_mul_i32 s37, s3, 3
    s_add_u32 s38, s38, 18
    s_sub_u32 s38, s38, s37
    s_cmp_ge_u32 s38, 3
    s_cbranch_scc1 L_aux
    s_mul_i32 s37, s39, 0x900
    v_mul_u32_u24 v13, 36, v0
    s_mov_b32 s30, 0x12000
    s_mov_b32 s42, 0x12000
    s_mov_b32 s31, s27
    s_mov_b32 s43, s27
    s_cmp_eq_u32 s3, 6
    s_waitcnt lgkmcnt(0)
    s_cselect_b64 s[28:29], s[10:11], s[16:17]
    s_cselect_b64 s[40:41], s[12:13], s[14:15]
    buffer_load_dword v254, v13, s[28:31], s37 offen
    buffer_load_dword v255, v13, s[40:43], s37 offen
    s_branch L_aux
L_ld_prod:
    s_mov_b32 s39, 0
    s_cmp_lt_u32 s2, 3
    s_cbranch_scc0 L_ld_wo0
    s_mov_b32 s26, 0x1800
    s_mov_b32 s44, 0x1c00
    s_mov_b32 s48, 1
    s_waitcnt lgkmcnt(0)
    s_mov_b64 s[24:25], s[4:5]
    s_call_b64 s[54:55], L_ld_tiles
    s_branch L_ld_wq
L_ld_tiles:
    s_mov_b32 m0, s44
    s_add_u32 s46, s39, 0xc00
    buffer_load_dwordx4 v1, s[24:27], s39 offen lds
    buffer_load_dwordx4 v2, s[24:27], s39 offen offset:1024 lds
    buffer_load_dwordx4 v3, s[24:27], s39 offen offset:2048 lds
    s_add_u32 m0, s44, 0xc00
    s_add_u32 s44, s44, 0x1800
    buffer_load_dwordx4 v1, s[24:27], s46 offen lds
    buffer_load_dwordx4 v2, s[24:27], s46 offen offset:1024 lds
    buffer_load_dwordx4 v3, s[24:27], s46 offen offset:2048 lds
    s_add_u32 s39, s39, 0x1800
    s_sub_u32 s48, s48, 1
    s_and_b32 s45, s48, 3
    s_cselect_b32 s45, 0, 0x3000
    s_add_u32 s44, s44, s45
    s_cmp_lg_u32 s48, 0
    s_cbranch_scc1 L_ld_tiles
    s_setpc_b64 s[54:55]
L_ld_wq:
    s_mov_b64 s[24:25], s[10:11]
    s_mov_b32 s26, 0x12000
L_ld_w12:
    s_mov_b32 s39, 0
    s_mov_b32 s44, 0x6400
    s_mov_b32 s48, 4
    s_call_b64 s[54:55], L_ld_tiles
    v_mul_u32_u24 v4, 0x180, v4
    v_add_u32 v4, v4, v1
    v_mul_u32_u24 v5, 0x180, v5
    v_add_u32 v5, v5, v2
    v_mul_u32_u24 v6, 0x180, v6
    v_add_u32 v6, v6, v3
    v_mov_b32 v10, 0
    v_lshlrev_b32 v13, 2, v0
    s_mov_b64 exec, 0xffffffff
    ds_write_b32 v13, v10 offset:6912
    v_mov_b32 v11, 0x3f803f80
    s_mov_b64 exec, 3
    ds_write_b32 v13, v11 offset:7056
    s_mov_b64 exec, -1
    s_mov_b32 s50, 0
    s_mov_b32 s51, 0
    s_mov_b32 s52, 0
    s_mov_b32 s53, 0
    s_mov_b32 s36, 0
    s_mov_b32 s37, 0
    s_mov_b32 s57, 0
    s_waitcnt lgkmcnt(0)
    s_barrier
    s_waitcnt vmcnt(24)
    v_mov_b32 v11, 1
    s_mov_b64 exec, 1
    ds_max_u32 v10, v11 offset:6956
    s_mov_b64 exec, -1
    s_mov_b32 s48, 8
    s_call_b64 s[54:55], L_ld_tiles
    s_cmp_ge_u32 s2, 3
    s_cbranch_scc1 L_ld_w3
    s_mov_b64 s[24:25], s[12:13]
    s_mul_i32 s39, s2, 0x6000
    s_mov_b32 s48, 4
    s_call_b64 s[54:55], L_ld_tiles
L_ld_w3:
    s_waitcnt vmcnt(24)
    v_mov_b32 v11, 2
    s_mov_b64 exec, 1
    ds_max_u32 v10, v11 offset:6956
    s_mov_b64 exec, -1
    s_branch L_ld_stepp
L_ld_wo0:
    s_mov_b32 s26, 0x12000
    v_lshrrev_b32 v11, 3, v0
    v_mul_u32_u24 v11, 0x180, v11
    v_and_b32 v12, 7, v0
    v_lshl_add_u32 v11, v12, 4, v11
    s_sub_u32 s46, s2, 3
    s_lshl_b32 s46, s46, 7
    s_mov_b32 s45, 0x21400
    s_waitcnt lgkmcnt(0)
    s_mov_b64 s[24:25], s[16:17]
L_ld_wo:
    s_mov_b32 m0, s45
    s_add_u32 s45, s45, 0x400
    buffer_load_dwordx4 v11, s[24:27], s46 offen lds
    s_add_u32 s46, s46, 0xc00
    s_cmp_lt_u32 s45, 0x27400
    s_cbranch_scc1 L_ld_wo
    s_mov_b64 s[24:25], s[14:15]
    s_branch L_ld_w12
L_ld_norm:
    v_mul_u32_u24 v4, 0x180, v4
    v_add_u32 v4, v4, v1
    v_mul_u32_u24 v5, 0x180, v5
    v_add_u32 v5, v5, v2
    v_mul_u32_u24 v6, 0x180, v6
    v_add_u32 v6, v6, v3
    v_mov_b32 v10, 0
    v_lshlrev_b32 v13, 2, v0
    s_mov_b64 exec, 0xffffffff
    ds_write_b32 v13, v10 offset:6912
    v_mov_b32 v11, 0x3f803f80
    s_mov_b64 exec, 3
    ds_write_b32 v13, v11 offset:7056
    s_mov_b64 exec, -1
    s_mov_b32 s50, 0
    s_mov_b32 s51, 0
    s_mov_b32 s52, 0
    s_mov_b32 s53, 0
    s_mov_b32 s36, 1
    s_mov_b32 s37, 1
    s_mov_b32 s57, 1
    s_lshr_b32 s45, s38, 4
    s_mul_i32 s40, s45, 0x60000
    s_and_b32 s45, s38, 15
    s_mul_i32 s45, s45, 0x3000
    s_add_u32 s40, s40, s45
    s_add_u32 s38, s38, 0x400
    s_waitcnt lgkmcnt(0)
    s_barrier
L_ld_step:
    s_cmp_lg_u32 s37, 0
    s_cbranch_scc1 L_ld_fine
    s_mul_i32 s39, s38, 0x1800
    s_lshr_b32 s45, s38, 4
    s_mul_i32 s40, s45, 0x60000
    s_and_b32 s45, s38, 15
    s_mul_i32 s45, s45, 0x3000
    s_add_u32 s40, s40, s45
    s_add_u32 s38, s38, 0x400
    s_mov_b32 s24, s8
    s_mov_b32 s25, s9
    s_mov_b32 s26, 0x1800000
    s_mov_b32 s41, s39
    s_mov_b32 s42, 0x1800
    s_mov_b32 s43, 0xc00
    v_mov_b32 v7, v1
    v_mov_b32 v8, v2
    v_mov_b32 v9, v3
    s_branch L_ld_issue
L_ld_fine:
    s_mov_b32 s24, s6
    s_mov_b32 s25, s7
    s_mov_b32 s26, 0x6000000
    s_sub_u32 s45, s37, 1
    s_lshr_b32 s46, s45, 1
    s_mul_i32 s46, s46, 0x30000
    s_and_b32 s45, s45, 1
    s_mul_i32 s45, s45, 0x180
    s_add_u32 s41, s40, s46
    s_add_u32 s41, s41, s45
    s_mov_b32 s42, 0x3000
    s_mov_b32 s43, 0x1800
    v_mov_b32 v7, v4
    v_mov_b32 v8, v5
    v_mov_b32 v9, v6
L_ld_issue:
    s_mul_i32 s44, s57, 0x1800
    s_add_u32 s44, s44, 0x3400
    s_sub_i32 s48, s36, 5
    s_cmp_ge_i32 s50, s48
    s_cbranch_scc1 L_free1
    s_mov_b32 s56, 0
    s_call_b64 s[54:55], L_ld_wait
    s_mov_b32 s50, s45
L_free1:
    s_add_u32 m0, s44, 0
    s_mov_b32 s46, s41
    buffer_load_dwordx4 v7, s[24:27], s46 offen nt lds
    buffer_load_dwordx4 v8, s[24:27], s46 offen offset:1024 nt lds
    buffer_load_dwordx4 v9, s[24:27], s46 offen offset:2048 nt lds
    s_add_u32 m0, s44, 0xc00
    s_add_u32 s46, s41, s43
    buffer_load_dwordx4 v7, s[24:27], s46 offen nt lds
    buffer_load_dwordx4 v8, s[24:27], s46 offen offset:1024 nt lds
    buffer_load_dwordx4 v9, s[24:27], s46 offen offset:2048 nt lds
    s_add_u32 s41, s41, s42
    s_add_i32 s47, s36, 0
    s_max_i32 s47, s47, 0
    s_waitcnt vmcnt(24)
    v_mov_b32 v11, s47
    s_mov_b64 exec, 1
    ds_max_u32 v10, v11 offset:6912
    s_mov_b64 exec, -1
    s_cmp_ge_i32 s51, s48
    s_cbranch_scc1 L_free2
    s_mov_b32 s56, 1
    s_call_b64 s[54:55], L_ld_wait
    s_mov_b32 s51, s45
L_free2:
    s_add_u32 m0, s44, 0x9000
    s_mov_b32 s46, s41
    buffer_load_dwordx4 v7, s[24:27], s46 offen nt lds
    buffer_load_dwordx4 v8, s[24:27], s46 offen offset:1024 nt lds
    buffer_load_dwordx4 v9, s[24:27], s46 offen offset:2048 nt lds
    s_add_u32 m0, s44, 0x9c00
    s_add_u32 s46, s41, s43
    buffer_load_dwordx4 v7, s[24:27], s46 offen nt lds
    buffer_load_dwordx4 v8, s[24:27], s46 offen offset:1024 nt lds
    buffer_load_dwordx4 v9, s[24:27], s46 offen offset:2048 nt lds
    s_add_u32 s41, s41, s42
    s_add_i32 s47, s36, 0
    s_max_i32 s47, s47, 0
    s_waitcnt vmcnt(24)
    v_mov_b32 v11, s47
    s_mov_b64 exec, 1
    ds_max_u32 v10, v11 offset:6916
    s_mov_b64 exec, -1
    s_cmp_ge_i32 s52, s48
    s_cbranch_scc1 L_free3
    s_mov_b32 s56, 2
    s_call_b64 s[54:55], L_ld_wait
    s_mov_b32 s52, s45
L_free3:
    s_add_u32 m0, s44, 0x12000
    s_mov_b32 s46, s41
    buffer_load_dwordx4 v7, s[24:27], s46 offen nt lds
    buffer_load_dwordx4 v8, s[24:27], s46 offen offset:1024 nt lds
    buffer_load_dwordx4 v9, s[24:27], s46 offen offset:2048 nt lds
    s_add_u32 m0, s44, 0x12c00
    s_add_u32 s46, s41, s43
    buffer_load_dwordx4 v7, s[24:27], s46 offen nt lds
    buffer_load_dwordx4 v8, s[24:27], s46 offen offset:1024 nt lds
    buffer_load_dwordx4 v9, s[24:27], s46 offen offset:2048 nt lds
    s_add_u32 s41, s41, s42
    s_add_i32 s47, s36, 0
    s_max_i32 s47, s47, 0
    s_waitcnt vmcnt(24)
    v_mov_b32 v11, s47
    s_mov_b64 exec, 1
    ds_max_u32 v10, v11 offset:6920
    s_mov_b64 exec, -1
    s_cmp_ge_i32 s53, s48
    s_cbranch_scc1 L_free4
    s_mov_b32 s56, 3
    s_call_b64 s[54:55], L_ld_wait
    s_mov_b32 s53, s45
L_free4:
    s_add_u32 m0, s44, 0x1b000
    s_mov_b32 s46, s41
    buffer_load_dwordx4 v7, s[24:27], s46 offen nt lds
    buffer_load_dwordx4 v8, s[24:27], s46 offen offset:1024 nt lds
    buffer_load_dwordx4 v9, s[24:27], s46 offen offset:2048 nt lds
    s_add_u32 m0, s44, 0x1bc00
    s_add_u32 s46, s41, s43
    buffer_load_dwordx4 v7, s[24:27], s46 offen nt lds
    buffer_load_dwordx4 v8, s[24:27], s46 offen offset:1024 nt lds
    buffer_load_dwordx4 v9, s[24:27], s46 offen offset:2048 nt lds
    s_add_u32 s41, s41, s42
    s_add_i32 s47, s36, 0
    s_max_i32 s47, s47, 0
    s_waitcnt vmcnt(24)
    v_mov_b32 v11, s47
    s_mov_b64 exec, 1
    ds_max_u32 v10, v11 offset:6924
    s_mov_b64 exec, -1
    s_add_u32 s37, s37, 1
    s_cmp_eq_u32 s37, 5
    s_cselect_b32 s37, 0, s37
    s_add_u32 s57, s57, 1
    s_cmp_eq_u32 s57, 6
    s_cselect_b32 s57, 0, s57
    s_add_u32 s36, s36, 1
    s_cmp_lt_u32 s36, 20
    s_cbranch_scc1 L_ld_step
    s_mov_b32 s32, s22
    s_mov_b32 s33, s23
    s_mov_b32 s34, 0x1000000
    s_mov_b32 s35, 0x20000
    v_lshlrev_b32 v12, 4, v0
    s_nop 1
L_spin5:
    ds_read_b32 v11, v10 offset:6976
    s_waitcnt lgkmcnt(0)
    v_readfirstlane_b32 s45, v11
    s_nop 0
    s_cmp_ge_u32 s45, 1
    s_cbranch_scc1 L_spun6
    s_sleep 1
    s_branch L_spin5
L_spun6:
    s_mov_b32 s46, 0x54d800
    buffer_load_dwordx4 v[112:115], v12, s[32:35], s46 offen sc1
    s_mov_b32 s46, 0x54dc00
    buffer_load_dwordx4 v[124:127], v12, s[32:35], s46 offen sc1
    s_mov_b32 s46, 0x54e000
    buffer_load_dwordx4 v[136:139], v12, s[32:35], s46 offen sc1
    s_mov_b32 s46, 0x54e400
    buffer_load_dwordx4 v[148:151], v12, s[32:35], s46 offen sc1
    s_mov_b32 s46, 0x54e800
    buffer_load_dwordx4 v[160:163], v12, s[32:35], s46 offen sc1
    s_mov_b32 s46, 0x54ec00
    buffer_load_dwordx4 v[172:175], v12, s[32:35], s46 offen sc1
    s_mov_b32 s46, 0x54f000
    buffer_load_dwordx4 v[116:119], v12, s[32:35], s46 offen sc1
    s_mov_b32 s46, 0x54f400
    buffer_load_dwordx4 v[128:131], v12, s[32:35], s46 offen sc1
    s_mov_b32 s46, 0x54f800
    buffer_load_dwordx4 v[140:143], v12, s[32:35], s46 offen sc1
    s_mov_b32 s46, 0x54fc00
    buffer_load_dwordx4 v[152:155], v12, s[32:35], s46 offen sc1
    s_mov_b32 s46, 0x550000
    buffer_load_dwordx4 v[164:167], v12, s[32:35], s46 offen sc1
    s_mov_b32 s46, 0x550400
    buffer_load_dwordx4 v[176:179], v12, s[32:35], s46 offen sc1
    s_mov_b32 s46, 0x550800
    buffer_load_dwordx4 v[120:123], v12, s[32:35], s46 offen sc1
    s_mov_b32 s46, 0x550c00
    buffer_load_dwordx4 v[132:135], v12, s[32:35], s46 offen sc1
    s_mov_b32 s46, 0x551000
    buffer_load_dwordx4 v[144:147], v12, s[32:35], s46 offen sc1
    s_mov_b32 s46, 0x551400
    buffer_load_dwordx4 v[156:159], v12, s[32:35], s46 offen sc1
    s_mov_b32 s46, 0x551800
    buffer_load_dwordx4 v[168:171], v12, s[32:35], s46 offen sc1
    s_mov_b32 s46, 0x551c00
    buffer_load_dwordx4 v[180:183], v12, s[32:35], s46 offen sc1
    s_waitcnt vmcnt(36)
    v_mov_b32 v11, 20
    s_mov_b64 exec, 1
    ds_max_u32 v10, v11 offset:6912
    s_mov_b64 exec, -1
    s_waitcnt vmcnt(30)
    v_mov_b32 v11, 20
    s_mov_b64 exec, 1
    ds_max_u32 v10, v11 offset:6916
    s_mov_b64 exec, -1
    s_waitcnt vmcnt(24)
    v_mov_b32 v11, 20
    s_mov_b64 exec, 1
    ds_max_u32 v10, v11 offset:6920
    s_mov_b64 exec, -1
    s_waitcnt vmcnt(18)
    v_mov_b32 v11, 20
    s_mov_b64 exec, 1
    ds_max_u32 v10, v11 offset:6924
    s_mov_b64 exec, -1
    s_setprio 0
    s_mov_b32 s36, 3
    v_mov_b32 v11, 0
    v_and_b32 v1, 15, v0
    s_nop 1
    s_branch L_tail
L_ld_stepp:
    s_cmp_lg_u32 s37, 0
    s_cbranch_scc1 L_ld_finep
    s_mul_i32 s39, s38, 0x1800
    s_lshr_b32 s45, s38, 4
    s_mul_i32 s40, s45, 0x60000
    s_and_b32 s45, s38, 15
    s_mul_i32 s45, s45, 0x3000
    s_add_u32 s40, s40, s45
    s_add_u32 s38, s38, 0x400
    s_mov_b32 s24, s8
    s_mov_b32 s25, s9
    s_mov_b32 s26, 0x1800000
    s_mov_b32 s41, s39
    s_mov_b32 s42, 0x1800
    s_mov_b32 s43, 0xc00
    v_mov_b32 v7, v1
    v_mov_b32 v8, v2
    v_mov_b32 v9, v3
    s_branch L_ld_issuep
L_ld_finep:
    s_mov_b32 s24, s6
    s_mov_b32 s25, s7
    s_mov_b32 s26, 0x6000000
    s_sub_u32 s45, s37, 1
    s_lshr_b32 s46, s45, 1
    s_mul_i32 s46, s46, 0x30000
    s_and_b32 s45, s45, 1
    s_mul_i32 s45, s45, 0x180
    s_add_u32 s41, s40, s46
    s_add_u32 s41, s41, s45
    s_mov_b32 s42, 0x3000
    s_mov_b32 s43, 0x1800
    v_mov_b32 v7, v4
    v_mov_b32 v8, v5
    v_mov_b32 v9, v6
L_ld_issuep:
    s_mul_i32 s44, s57, 0x1800
    s_add_u32 s44, s44, 0x3400
    s_sub_i32 s48, s36, 5
    s_cmp_ge_i32 s50, s48
    s_cbranch_scc1 L_free7
    s_mov_b32 s56, 0
    s_call_b64 s[54:55], L_ld_wait
    s_mov_b32 s50, s45
L_free7:
    s_add_u32 m0, s44, 0
    s_mov_b32 s46, s41
    buffer_load_dwordx4 v7, s[24:27], s46 offen nt lds
    buffer_load_dwordx4 v8, s[24:27], s46 offen offset:1024 nt lds
    buffer_load_dwordx4 v9, s[24:27], s46 offen offset:2048 nt lds
    s_add_u32 m0, s44, 0xc00
    s_add_u32 s46, s41, s43
    buffer_load_dwordx4 v7, s[24:27], s46 offen nt lds
    buffer_load_dwordx4 v8, s[24:27], s46 offen offset:1024 nt lds
    buffer_load_dwordx4 v9, s[24:27], s46 offen offset:2048 nt lds
    s_add_u32 s41, s41, s42
    s_add_i32 s47, s36, -1
    s_max_i32 s47, s47, 0
    s_waitcnt vmcnt(36)
    v_mov_b32 v11, s47
    s_mov_b64 exec, 1
    ds_max_u32 v10, v11 offset:6920
    s_mov_b64 exec, -1
    s_cmp_ge_i32 s51, s48
    s_cbranch_scc1 L_free8
    s_mov_b32 s56, 1
    s_call_b64 s[54:55], L_ld_wait
    s_mov_b32 s51, s45
L_free8:
    s_add_u32 m0, s44, 0x9000
    s_mov_b32 s46, s41
    buffer_load_dwordx4 v7, s[24:27], s46 offen nt lds
    buffer_load_dwordx4 v8, s[24:27], s46 offen offset:1024 nt lds
    buffer_load_dwordx4 v9, s[24:27], s46 offen offset:2048 nt lds
    s_add_u32 m0, s44, 0x9c00
    s_add_u32 s46, s41, s43
    buffer_load_dwordx4 v7, s[24:27], s46 offen nt lds
    buffer_load_dwordx4 v8, s[24:27], s46 offen offset:1024 nt lds
    buffer_load_dwordx4 v9, s[24:27], s46 offen offset:2048 nt lds
    s_add_u32 s41, s41, s42
    s_add_i32 s47, s36, -1
    s_max_i32 s47, s47, 0
    s_waitcnt vmcnt(36)
    v_mov_b32 v11, s47
    s_mov_b64 exec, 1
    ds_max_u32 v10, v11 offset:6924
    s_mov_b64 exec, -1
    s_cmp_lg_u32 s36, 0
    s_cbranch_scc1 L_w39
    s_waitcnt vmcnt(12)
    v_mov_b32 v11, 3
    s_mov_b64 exec, 1
    ds_max_u32 v10, v11 offset:6956
    s_mov_b64 exec, -1
L_w39:
    s_cmp_ge_i32 s52, s48
    s_cbranch_scc1 L_free10
    s_mov_b32 s56, 2
    s_call_b64 s[54:55], L_ld_wait
    s_mov_b32 s52, s45
L_free10:
    s_add_u32 m0, s44, 0x12000
    s_mov_b32 s46, s41
    buffer_load_dwordx4 v7, s[24:27], s46 offen nt lds
    buffer_load_dwordx4 v8, s[24:27], s46 offen offset:1024 nt lds
    buffer_load_dwordx4 v9, s[24:27], s46 offen offset:2048 nt lds
    s_add_u32 m0, s44, 0x12c00
    s_add_u32 s46, s41, s43
    buffer_load_dwordx4 v7, s[24:27], s46 offen nt lds
    buffer_load_dwordx4 v8, s[24:27], s46 offen offset:1024 nt lds
    buffer_load_dwordx4 v9, s[24:27], s46 offen offset:2048 nt lds
    s_add_u32 s41, s41, s42
    s_add_i32 s47, s36, 0
    s_max_i32 s47, s47, 0
    s_waitcnt vmcnt(36)
    v_mov_b32 v11, s47
    s_mov_b64 exec, 1
    ds_max_u32 v10, v11 offset:6912
    s_mov_b64 exec, -1
    s_cmp_ge_i32 s53, s48
    s_cbranch_scc1 L_free11
    s_mov_b32 s56, 3
    s_call_b64 s[54:55], L_ld_wait
    s_mov_b32 s53, s45
L_free11:
    s_add_u32 m0, s44, 0x1b000
    s_mov_b32 s46, s41
    buffer_load_dwordx4 v7, s[24:27], s46 offen nt lds
    buffer_load_dwordx4 v8, s[24:27], s46 offen offset:1024 nt lds
    buffer_load_dwordx4 v9, s[24:27], s46 offen offset:2048 nt lds
    s_add_u32 m0, s44, 0x1bc00
    s_add_u32 s46, s41, s43
    buffer_load_dwordx4 v7, s[24:27], s46 offen nt lds
    buffer_load_dwordx4 v8, s[24:27], s46 offen offset:1024 nt lds
    buffer_load_dwordx4 v9, s[24:27], s46 offen offset:2048 nt lds
    s_add_u32 s41, s41, s42
    s_add_i32 s47, s36, 0
    s_max_i32 s47, s47, 0
    s_waitcnt vmcnt(36)
    v_mov_b32 v11, s47
    s_mov_b64 exec, 1
    ds_max_u32 v10, v11 offset:6916
    s_mov_b64 exec, -1
    s_add_u32 s37, s37, 1
    s_cmp_eq_u32 s37, 5
    s_cselect_b32 s37, 0, s37
    s_add_u32 s57, s57, 1
    s_cmp_eq_u32 s57, 6
    s_cselect_b32 s57, 0, s57
    s_cmp_lg_u32 s36, 1
    s_cbranch_scc1 L_ld_noiss
L_spin12:
    ds_read_b32 v11, v10 offset:6952
    s_waitcnt lgkmcnt(0)
    v_readfirstlane_b32 s45, v11
    s_nop 0
    s_cmp_ge_u32 s45, 4
    s_cbranch_scc1 L_spun13
    s_sleep 1
    s_branch L_spin12
L_spun13:
L_ld_noiss:
    s_add_u32 s36, s36, 1
    s_cmp_lt_u32 s36, 20
    s_nop 3
    s_cbranch_scc1 L_ld_stepp
    s_mov_b32 s32, s22
    s_mov_b32 s33, s23
    s_mov_b32 s34, 0x1000000
    s_mov_b32 s35, 0x20000
    v_lshlrev_b32 v12, 4, v0
    s_nop 1
L_spin14:
    ds_read_b32 v11, v10 offset:6976
    s_waitcnt lgkmcnt(0)
    v_readfirstlane_b32 s45, v11
    s_nop 0
    s_cmp_ge_u32 s45, 1
    s_cbranch_scc1 L_spun15
    s_sleep 1
    s_branch L_spin14
L_spun15:
    s_mov_b32 s46, 0x54d800
    buffer_load_dwordx4 v[112:115], v12, s[32:35], s46 offen sc1
    s_mov_b32 s46, 0x54dc00
    buffer_load_dwordx4 v[124:127], v12, s[32:35], s46 offen sc1
    s_mov_b32 s46, 0x54e000
    buffer_load_dwordx4 v[136:139], v12, s[32:35], s46 offen sc1
    s_mov_b32 s46, 0x54e400
    buffer_load_dwordx4 v[148:151], v12, s[32:35], s46 offen sc1
    s_mov_b32 s46, 0x54e800
    buffer_load_dwordx4 v[160:163], v12, s[32:35], s46 offen sc1
    s_mov_b32 s46, 0x54ec00
    buffer_load_dwordx4 v[172:175], v12, s[32:35], s46 offen sc1
    s_mov_b32 s46, 0x54f000
    buffer_load_dwordx4 v[116:119], v12, s[32:35], s46 offen sc1
    s_mov_b32 s46, 0x54f400
    buffer_load_dwordx4 v[128:131], v12, s[32:35], s46 offen sc1
    s_mov_b32 s46, 0x54f800
    buffer_load_dwordx4 v[140:143], v12, s[32:35], s46 offen sc1
    s_mov_b32 s46, 0x54fc00
    buffer_load_dwordx4 v[152:155], v12, s[32:35], s46 offen sc1
    s_mov_b32 s46, 0x550000
    buffer_load_dwordx4 v[164:167], v12, s[32:35], s46 offen sc1
    s_mov_b32 s46, 0x550400
    buffer_load_dwordx4 v[176:179], v12, s[32:35], s46 offen sc1
    s_mov_b32 s46, 0x550800
    buffer_load_dwordx4 v[120:123], v12, s[32:35], s46 offen sc1
    s_mov_b32 s46, 0x550c00
    buffer_load_dwordx4 v[132:135], v12, s[32:35], s46 offen sc1
    s_mov_b32 s46, 0x551000
    buffer_load_dwordx4 v[144:147], v12, s[32:35], s46 offen sc1
    s_mov_b32 s46, 0x551400
    buffer_load_dwordx4 v[156:159], v12, s[32:35], s46 offen sc1
    s_mov_b32 s46, 0x551800
    buffer_load_dwordx4 v[168:171], v12, s[32:35], s46 offen sc1
    s_mov_b32 s46, 0x551c00
    buffer_load_dwordx4 v[180:183], v12, s[32:35], s46 offen sc1
    s_waitcnt vmcnt(48)
    v_mov_b32 v11, 19
    s_mov_b64 exec, 1
    ds_max_u32 v10, v11 offset:6920
    s_mov_b64 exec, -1
    s_waitcnt vmcnt(42)
    v_mov_b32 v11, 19
    s_mov_b64 exec, 1
    ds_max_u32 v10, v11 offset:6924
    s_mov_b64 exec, -1
    s_waitcnt vmcnt(36)
    v_mov_b32 v11, 20
    s_mov_b64 exec, 1
    ds_max_u32 v10, v11 offset:6912
    s_mov_b64 exec, -1
    s_waitcnt vmcnt(30)
    v_mov_b32 v11, 20
    s_mov_b64 exec, 1
    ds_max_u32 v10, v11 offset:6916
    s_mov_b64 exec, -1
    s_waitcnt vmcnt(24)
    v_mov_b32 v11, 20
    s_mov_b64 exec, 1
    ds_max_u32 v10, v11 offset:6920
    s_mov_b64 exec, -1
    s_waitcnt vmcnt(18)
    v_mov_b32 v11, 20
    s_mov_b64 exec, 1
    ds_max_u32 v10, v11 offset:6924
    s_mov_b64 exec, -1
    s_setprio 0
    s_mov_b32 s36, 3
    v_mov_b32 v11, 0
    v_and_b32 v1, 15, v0
    s_nop 1
    s_branch L_tail
L_ld_wait:
    s_lshl_b32 s45, s56, 2
    v_mov_b32 v12, s45
    ds_read_b32 v11, v12 offset:6928
    s_waitcnt lgkmcnt(0)
    v_readfirstlane_b32 s45, v11
    s_nop 0
    s_cmp_ge_i32 s45, s48
    s_cbranch_scc1 L_ld_wait_ret
    s_waitcnt vmcnt(0)
    v_mov_b32 v11, s36
    v_cmp_gt_u32 vcc, s56, v0
    s_nop 1
    v_addc_co_u32 v11, vcc, v11, 0, vcc
    s_mov_b64 exec, 15
    ds_max_u32 v13, v11 offset:6912
    s_mov_b64 exec, -1
    s_nop 1
L_spin16:
    ds_read_b32 v11, v12 offset:6928
    s_waitcnt lgkmcnt(0)
    v_readfirstlane_b32 s45, v11
    s_nop 0
    s_cmp_ge_u32 s45, s48
    s_cbranch_scc1 L_spun17
    s_sleep 1
    s_branch L_spin16
L_spun17:
L_ld_wait_ret:
    s_setpc_b64 s[54:55]
L_compute:
    s_mul_i32 s36, s3, 0x9000
    s_add_u32 s36, s36, 0x3400
    s_setprio 1
    s_barrier
    v_and_b32 v228, 15, v0
    v_lshrrev_b32 v229, 4, v0
    v_and_b32 v230, 6, v228
    v_xor_b32 v230, v230, v229
    v_mul_u32_u24 v231, 0x180, v228
    v_add_u32 v231, s36, v231
    v_lshl_add_u32 v8, v230, 4, v231
    v_xor_b32 v230, 4, v230
    v_lshl_add_u32 v9, v230, 4, v231
    v_lshrrev_b32 v230, 2, v228
    v_and_b32 v231, 3, v228
    v_lshl_add_u32 v232, v229, 2, v230
    v_mul_u32_u24 v233, 0x180, v232
    v_lshl_add_u32 v233, v231, 3, v233
    v_add_u32 v233, s36, v233
    v_and_b32 v234, 6, v232
    v_xor_b32 v235, 0, v234
    v_lshl_add_u32 v10, v235, 4, v233
    v_xor_b32 v235, 2, v234
    v_lshl_add_u32 v11, v235, 4, v233
    v_xor_b32 v235, 4, v234
    v_lshl_add_u32 v12, v235, 4, v233
    v_xor_b32 v235, 6, v234
    v_lshl_add_u32 v13, v235, 4, v233
    v_subrev_u32 v244, s36, v8
    v_subrev_u32 v245, s36, v9
    v_mov_b32 v24, 0x3f803f80
    v_mov_b32 v240, 0
    v_mov_b32 v248, 0
    v_mov_b32 v25, 0x3f803f80
    v_mov_b32 v241, 0
    v_mov_b32 v249, 0
    v_mov_b32 v26, 0x3f803f80
    v_mov_b32 v242, 0
    v_mov_b32 v250, 0
    v_mov_b32 v27, 0x3f803f80
    v_mov_b32 v243, 0
    v_mov_b32 v251, 0
    v_mov_b32 v20, 1.0
    s_mov_b32 s44, 0x3baaaaab
    s_mov_b32 s46, 0x3727c5ac
    s_mov_b32 s58, 0xaaaaaaaa
    s_mov_b32 s60, 0xcccccccc
    s_mov_b32 s45, 0x3baaaaab
    s_mov_b32 s47, 0x3727c5ac
    s_mov_b32 s59, 0xaaaaaaaa
    s_mov_b32 s61, 0xcccccccc
    s_mov_b32 s38, 0xf0000f
    s_mov_b32 s39, 0xf0000f00
    s_mov_b32 s50, 0x42000000
    s_mov_b32 s41, 0
    s_mov_b32 s51, 0
    s_mov_b32 s52, 0
    s_mov_b32 s54, 0
    s_mov_b32 s56, 0x1800
    s_lshl_b32 s40, s3, 2
    v_mov_b32 v1, s40
    s_waitcnt lgkmcnt(0)
    s_mov_b32 s32, s22
    s_mov_b32 s33, s23
    s_mov_b32 s34, 0x1000000
    s_mov_b32 s35, 0x20000
    s_cmp_lt_u32 s2, 3
    s_cbranch_scc1 L_qkprod
    s_cmp_lt_u32 s2, 6
    s_cbranch_scc1 L_wvprod
L_c_start:
    s_add_u32 s51, s51, 1
    s_cmp_ge_u32 s52, s51
    s_cbranch_scc1 L_have18
L_spin19:
    ds_read_b32 v3, v1 offset:6912
    s_waitcnt lgkmcnt(0)
    v_readfirstlane_b32 s52, v3
    s_nop 0
    s_cmp_ge_u32 s52, s51
    s_cbranch_scc1 L_spun20
    s_sleep 1
    s_branch L_spin19
L_spun20:
L_have18:
    ds_read_b128 v[100:103], v8
    ds_read_b128 v[104:107], v9
    ds_read_b128 v[108:111], v8 offset:128
    ds_read_b128 v[112:115], v9 offset:128
    ds_read_b128 v[116:119], v8 offset:256
    ds_read_b128 v[120:123], v9 offset:256
    ds_read_b64_tr_b16 v[152:153], v10
    ds_read_b64_tr_b16 v[158:159], v11
    ds_read_b64_tr_b16 v[164:165], v12
    ds_read_b64_tr_b16 v[170:171], v13
    ds_read_b64_tr_b16 v[176:177], v10 offset:128
    ds_read_b64_tr_b16 v[182:183], v11 offset:128
    s_waitcnt lgkmcnt(11)
    v_mfma_f32_16x16x32_bf16 v[236:239], v[100:103], v[100:103], 0
    v_mfma_f32_16x16x32_bf16 v[224:227], v[100:103], v[24:27], 0
    ds_read_b64_tr_b16 v[188:189], v12 offset:128
    s_waitcnt lgkmcnt(11)
    v_mfma_f32_16x16x32_bf16 v[236:239], v[104:107], v[104:107], v[236:239]
    v_mfma_f32_16x16x32_bf16 v[224:227], v[104:107], v[24:27], v[224:227]
    ds_read_b64_tr_b16 v[194:195], v13 offset:128
    s_waitcnt lgkmcnt(11)
    v_mfma_f32_16x16x32_bf16 v[236:239], v[108:111], v[108:111], v[236:239]
    v_mfma_f32_16x16x32_bf16 v[224:227], v[108:111], v[24:27], v[224:227]
    ds_read_b64_tr_b16 v[200:201], v10 offset:256
    s_waitcnt lgkmcnt(11)
    v_mfma_f32_16x16x32_bf16 v[236:239], v[112:115], v[112:115], v[236:239]
    v_mfma_f32_16x16x32_bf16 v[224:227], v[112:115], v[24:27], v[224:227]
    ds_read_b64_tr_b16 v[206:207], v11 offset:256
    s_waitcnt lgkmcnt(11)
    v_mfma_f32_16x16x32_bf16 v[236:239], v[116:119], v[116:119], v[236:239]
    v_mfma_f32_16x16x32_bf16 v[224:227], v[116:119], v[24:27], v[224:227]
    ds_read_b64_tr_b16 v[212:213], v12 offset:256
    s_waitcnt lgkmcnt(11)
    v_mfma_f32_16x16x32_bf16 v[236:239], v[120:123], v[120:123], v[236:239]
    v_mfma_f32_16x16x32_bf16 v[224:227], v[120:123], v[24:27], v[224:227]
    ds_read_b64_tr_b16 v[218:219], v13 offset:256
    ds_read_b32 v3, v1 offset:6912
    v_mov_b32 v2, s51
    s_add_u32 s54, s54, 1
    s_cmp_eq_u32 s54, 6
    s_cselect_b32 s55, 0xffff8800, s56
    s_cselect_b32 s54, 0, s54
    v_add_u32 v8, s55, v8
    v_add_u32 v9, s55, v9
    v_add_u32 v10, s55, v10
    v_add_u32 v11, s55, v11
    v_add_u32 v12, s55, v12
    v_add_u32 v13, s55, v13
    s_waitcnt lgkmcnt(0)
    ds_write_b32 v1, v2 offset:6928
    v_cndmask_b32 v22, v236, v237, s[58:59]
    v_cndmask_b32 v23, v238, v239, s[58:59]
    v_cndmask_b32 v255, v22, v23, s[60:61]
    s_add_u32 s51, s51, 1
    s_cmp_ge_u32 s52, s51
    s_cbranch_scc1 L_have21
L_spin22:
    ds_read_b32 v3, v1 offset:6912
    s_waitcnt lgkmcnt(0)
    v_readfirstlane_b32 s52, v3
    s_nop 0
    s_cmp_ge_u32 s52, s51
    s_cbranch_scc1 L_spun23
    s_sleep 1
    s_branch L_spin22
L_spun23:
L_have21:
    ds_read_b128 v[124:127], v8
    ds_read_b128 v[128:131], v9
    ds_read_b128 v[132:135], v8 offset:128
    ds_read_b128 v[136:139], v9 offset:128
    ds_read_b128 v[140:143], v8 offset:256
    ds_read_b128 v[144:147], v9 offset:256
    s_waitcnt lgkmcnt(5)
    v_mfma_f32_16x16x32_bf16 v[236:239], v[124:127], v[124:127], 0
    v_mfma_f32_16x16x32_bf16 v[4:7], v[124:127], v[100:103], 0
    ds_read_b64_tr_b16 v[148:149], v10
    s_waitcnt lgkmcnt(5)
    v_mfma_f32_16x16x32_bf16 v[236:239], v[128:131], v[128:131], v[236:239]
    v_mfma_f32_16x16x32_bf16 v[4:7], v[128:131], v[104:107], v[4:7]
    ds_read_b64_tr_b16 v[154:155], v11
    s_waitcnt lgkmcnt(5)
    v_mfma_f32_16x16x32_bf16 v[236:239], v[132:135], v[132:135], v[236:239]
    ds_read_b64_tr_b16 v[160:161], v12
    v_mfma_f32_16x16x32_bf16 v[4:7], v[132:135], v[108:111], v[4:7]
    ds_read_b64_tr_b16 v[166:167], v13
    s_waitcnt lgkmcnt(6)
    v_mfma_f32_16x16x32_bf16 v[236:239], v[136:139], v[136:139], v[236:239]
    ds_read_b64_tr_b16 v[172:173], v10 offset:128
    v_mfma_f32_16x16x32_bf16 v[4:7], v[136:139], v[112:115], v[4:7]
    ds_read_b64_tr_b16 v[178:179], v11 offset:128
    s_waitcnt lgkmcnt(7)
    v_mfma_f32_16x16x32_bf16 v[236:239], v[140:143], v[140:143], v[236:239]
    ds_read_b64_tr_b16 v[184:185], v12 offset:128
    v_mfma_f32_16x16x32_bf16 v[4:7], v[140:143], v[116:119], v[4:7]
    ds_read_b64_tr_b16 v[190:191], v13 offset:128
    s_waitcnt lgkmcnt(8)
    v_mfma_f32_16x16x32_bf16 v[236:239], v[144:147], v[144:147], v[236:239]
    ds_read_b64_tr_b16 v[196:197], v10 offset:256
    v_mfma_f32_16x16x32_bf16 v[4:7], v[144:147], v[120:123], v[4:7]
    ds_read_b64_tr_b16 v[202:203], v11 offset:256
    v_mfma_f32_16x16x32_bf16 v[232:235], v[124:127], v[24:27], v[224:227]
    ds_read_b64_tr_b16 v[208:209], v12 offset:256
    v_mfma_f32_16x16x32_bf16 v[232:235], v[128:131], v[24:27], v[232:235]
    ds_read_b64_tr_b16 v[214:215], v13 offset:256
    s_nop 2
    v_mfma_f32_16x16x32_bf16 v[232:235], v[132:135], v[24:27], v[232:235]
    v_cndmask_b32 v22, v236, v237, s[58:59]
    v_cndmask_b32 v23, v238, v239, s[58:59]
    v_mfma_f32_16x16x32_bf16 v[232:235], v[136:139], v[24:27], v[232:235]
    v_cndmask_b32 v4, v4, v5, s[58:59]
    v_cndmask_b32 v6, v6, v7, s[58:59]
    v_mfma_f32_16x16x32_bf16 v[232:235], v[140:143], v[24:27], v[232:235]
    v_cndmask_b32 v22, v22, v23, s[60:61]
    v_cndmask_b32 v4, v4, v6, s[60:61]
    v_mfma_f32_16x16x32_bf16 v[232:235], v[144:147], v[24:27], v[232:235]
    v_add_f32 v22, v22, v255
    v_fma_f32 v22, v4, 2.0, v22
    v_cndmask_b32 v22, 0, v22, s[38:39]
    s_nop 1
    v_mfma_f32_16x16x4_f32 v[236:239], v22, v20, 0
    ds_read_b32 v3, v1 offset:6912
    v_mov_b32 v2, s51
    s_add_u32 s54, s54, 1
    s_cmp_eq_u32 s54, 6
    s_cselect_b32 s55, 0xffff8800, s56
    s_cselect_b32 s54, 0, s54
    v_add_u32 v8, s55, v8
    v_add_u32 v9, s55, v9
    v_add_u32 v10, s55, v10
    v_add_u32 v11, s55, v11
    v_add_u32 v12, s55, v12
    v_add_u32 v13, s55, v13
    s_waitcnt lgkmcnt(0)
    ds_write_b32 v1, v2 offset:6928
    s_sub_u32 s40, s2, 3
    s_cmp_ge_u32 s40, 3
    s_cbranch_scc1 L_nowf
    s_mov_b32 s24, s20
    s_mov_b32 s25, s21
    s_mov_b32 s26, 0x100
    s_mov_b32 s27, 0x20000
    s_lshl_b32 s40, s40, 4
    v_mov_b32 v22, 1
    s_waitcnt vmcnt(0)
    s_mov_b64 exec, 1
    buffer_store_dword v22, v1, s[24:27], s40 offen offset:80 sc1
    s_mov_b64 exec, -1
L_nowf:
    s_add_u32 s51, s51, 1
    s_cmp_ge_u32 s52, s51
    s_cbranch_scc1 L_have24
L_spin25:
    ds_read_b32 v3, v1 offset:6912
    s_waitcnt lgkmcnt(0)
    v_readfirstlane_b32 s52, v3
    s_nop 0
    s_cmp_ge_u32 s52, s51
    s_cbranch_scc1 L_spun26
    s_sleep 1
    s_branch L_spin25
L_spun26:
L_have24:
    ds_read_b128 v[52:55], v8
    ds_read_b128 v[56:59], v9
    ds_read_b128 v[60:63], v8 offset:128
    ds_read_b128 v[64:67], v9 offset:128
    ds_read_b128 v[68:71], v8 offset:256
    ds_read_b128 v[72:75], v9 offset:256
    s_waitcnt lgkmcnt(5)
    v_mfma_f32_16x16x32_bf16 v[80:83], v[52:55], v[52:55], 0
    v_mfma_f32_16x16x32_bf16 v[4:7], v[52:55], v[100:103], 0
    ds_read_b64_tr_b16 v[150:151], v10
    s_waitcnt lgkmcnt(5)
    v_mfma_f32_16x16x32_bf16 v[80:83], v[56:59], v[56:59], v[80:83]
    v_mfma_f32_16x16x32_bf16 v[4:7], v[56:59], v[104:107], v[4:7]
    ds_read_b64_tr_b16 v[156:157], v11
    s_waitcnt lgkmcnt(5)
    v_mfma_f32_16x16x32_bf16 v[80:83], v[60:63], v[60:63], v[80:83]
    ds_read_b64_tr_b16 v[162:163], v12
    v_mfma_f32_16x16x32_bf16 v[4:7], v[60:63], v[108:111], v[4:7]
    ds_read_b64_tr_b16 v[168:169], v13
    s_waitcnt lgkmcnt(6)
    v_mfma_f32_16x16x32_bf16 v[80:83], v[64:67], v[64:67], v[80:83]
    ds_read_b64_tr_b16 v[174:175], v10 offset:128
    v_mfma_f32_16x16x32_bf16 v[4:7], v[64:67], v[112:115], v[4:7]
    ds_read_b64_tr_b16 v[180:181], v11 offset:128
    s_waitcnt lgkmcnt(7)
    v_mfma_f32_16x16x32_bf16 v[80:83], v[68:71], v[68:71], v[80:83]
    ds_read_b64_tr_b16 v[186:187], v12 offset:128
    v_mfma_f32_16x16x32_bf16 v[4:7], v[68:71], v[116:119], v[4:7]
    ds_read_b64_tr_b16 v[192:193], v13 offset:128
    s_waitcnt lgkmcnt(8)
    v_mfma_f32_16x16x32_bf16 v[80:83], v[72:75], v[72:75], v[80:83]
    ds_read_b64_tr_b16 v[198:199], v10 offset:256
    v_mfma_f32_16x16x32_bf16 v[4:7], v[72:75], v[120:123], v[4:7]
    ds_read_b64_tr_b16 v[204:205], v11 offset:256
    v_mfma_f32_16x16x32_bf16 v[76:79], v[52:55], v[24:27], v[224:227]
    ds_read_b64_tr_b16 v[210:211], v12 offset:256
    v_mfma_f32_16x16x32_bf16 v[76:79], v[56:59], v[24:27], v[76:79]
    ds_read_b64_tr_b16 v[216:217], v13 offset:256
    s_nop 2
    v_mfma_f32_16x16x32_bf16 v[76:79], v[60:63], v[24:27], v[76:79]
    v_cndmask_b32 v22, v80, v81, s[58:59]
    v_cndmask_b32 v23, v82, v83, s[58:59]
    v_mfma_f32_16x16x32_bf16 v[76:79], v[64:67], v[24:27], v[76:79]
    v_cndmask_b32 v4, v4, v5, s[58:59]
    v_cndmask_b32 v6, v6, v7, s[58:59]
    v_mfma_f32_16x16x32_bf16 v[76:79], v[68:71], v[24:27], v[76:79]
    v_cndmask_b32 v22, v22, v23, s[60:61]
    v_cndmask_b32 v4, v4, v6, s[60:61]
    v_mfma_f32_16x16x32_bf16 v[76:79], v[72:75], v[24:27], v[76:79]
    v_add_f32 v22, v22, v255
    v_fma_f32 v22, v4, 2.0, v22
    v_cndmask_b32 v22, 0, v22, s[38:39]
    s_nop 1
    v_mfma_f32_16x16x4_f32 v[80:83], v22, v20, 0
    ds_read_b32 v3, v1 offset:6912
    v_mov_b32 v2, s51
    s_add_u32 s54, s54, 1
    s_cmp_eq_u32 s54, 6
    s_cselect_b32 s55, 0xffff8800, s56
    s_cselect_b32 s54, 0, s54
    v_add_u32 v8, s55, v8
    v_add_u32 v9, s55, v9
    v_add_u32 v10, s55, v10
    v_add_u32 v11, s55, v11
    v_add_u32 v12, s55, v12
    v_add_u32 v13, s55, v13
    s_waitcnt lgkmcnt(0)
    ds_write_b32 v1, v2 offset:6928
    v_pk_mul_f32 v[232:233], v[232:233], s[44:45]
    v_pk_mul_f32 v[234:235], v[234:235], s[44:45]
    v_pk_fma_f32 v[4:5], v[232:233], v[232:233], s[46:47] neg_lo:[1,0,0] neg_hi:[1,0,0]
    v_pk_fma_f32 v[6:7], v[234:235], v[234:235], s[46:47] neg_lo:[1,0,0] neg_hi:[1,0,0]
    v_pk_fma_f32 v[236:237], v[236:237], s[44:45], v[4:5]
    v_pk_fma_f32 v[238:239], v[238:239], s[44:45], v[6:7]
    v_max_f32 v236, s46, v236
    v_max_f32 v237, s46, v237
    v_max_f32 v238, s46, v238
    v_max_f32 v239, s46, v239
    v_rsq_f32 v236, v236
    v_rsq_f32 v237, v237
    v_rsq_f32 v238, v238
    v_rsq_f32 v239, v239
    v_pk_mul_f32 v[76:77], v[76:77], s[44:45]
    v_pk_mul_f32 v[78:79], v[78:79], s[44:45]
    v_pk_fma_f32 v[4:5], v[76:77], v[76:77], s[46:47] neg_lo:[1,0,0] neg_hi:[1,0,0]
    v_pk_fma_f32 v[6:7], v[78:79], v[78:79], s[46:47] neg_lo:[1,0,0] neg_hi:[1,0,0]
    v_pk_fma_f32 v[80:81], v[80:81], s[44:45], v[4:5]
    v_pk_fma_f32 v[82:83], v[82:83], s[44:45], v[6:7]
    v_max_f32 v80, s46, v80
    v_max_f32 v81, s46, v81
    v_max_f32 v82, s46, v82
    v_max_f32 v83, s46, v83
    v_rsq_f32 v80, v80
    v_rsq_f32 v81, v81
    v_rsq_f32 v82, v82
    v_rsq_f32 v83, v83
    s_add_u32 s51, s51, 1
    s_cmp_ge_u32 s52, s51
    s_cbranch_scc1 L_have27
L_spin28:
    ds_read_b32 v3, v1 offset:6912
    s_waitcnt lgkmcnt(0)
    v_readfirstlane_b32 s52, v3
    s_nop 0
    s_cmp_ge_u32 s52, s51
    s_cbranch_scc1 L_spun29
    s_sleep 1
    s_branch L_spin28
L_spun29:
L_have27:
    v_mov_b32 v21, 0
    s_nop 4
L_spin30:
    ds_read_b32 v3, v21 offset:6944
    s_waitcnt lgkmcnt(0)
    v_readfirstlane_b32 s40, v3
    s_nop 0
    s_cmp_ge_u32 s40, 1
    s_cbranch_scc1 L_spun31
    s_sleep 1
    s_branch L_spin30
L_spun31:
    ds_read_b128 v[28:31], v244
    ds_read_b128 v[32:35], v245
    ds_read_b128 v[36:39], v244 offset:128
    ds_read_b128 v[40:43], v245 offset:128
    ds_read_b128 v[44:47], v244 offset:256
    ds_read_b128 v[48:51], v245 offset:256
    s_waitcnt lgkmcnt(5)
    v_mfma_f32_16x16x32_bf16 v[220:223], v[100:103], v[28:31], 0
    s_waitcnt lgkmcnt(4)
    v_mfma_f32_16x16x32_bf16 v[220:223], v[104:107], v[32:35], v[220:223]
    s_waitcnt lgkmcnt(3)
    v_mfma_f32_16x16x32_bf16 v[220:223], v[108:111], v[36:39], v[220:223]
    s_waitcnt lgkmcnt(2)
    v_mfma_f32_16x16x32_bf16 v[220:223], v[112:115], v[40:43], v[220:223]
    s_waitcnt lgkmcnt(1)
    v_mfma_f32_16x16x32_bf16 v[220:223], v[116:119], v[44:47], v[220:223]
    s_waitcnt lgkmcnt(0)
    v_mfma_f32_16x16x32_bf16 v[220:223], v[120:123], v[48:51], v[220:223]
    v_mfma_f32_16x16x32_bf16 v[228:231], v[124:127], v[28:31], v[220:223]
    v_mfma_f32_16x16x32_bf16 v[84:87], v[52:55], v[28:31], v[220:223]
    v_mfma_f32_16x16x32_bf16 v[228:231], v[128:131], v[32:35], v[228:231]
    v_mfma_f32_16x16x32_bf16 v[84:87], v[56:59], v[32:35], v[84:87]
    v_mfma_f32_16x16x32_bf16 v[228:231], v[132:135], v[36:39], v[228:231]
    v_mfma_f32_16x16x32_bf16 v[84:87], v[60:63], v[36:39], v[84:87]
    v_mfma_f32_16x16x32_bf16 v[228:231], v[136:139], v[40:43], v[228:231]
    v_mfma_f32_16x16x32_bf16 v[84:87], v[64:67], v[40:43], v[84:87]
    v_mfma_f32_16x16x32_bf16 v[228:231], v[140:143], v[44:47], v[228:231]
    v_mfma_f32_16x16x32_bf16 v[84:87], v[68:71], v[44:47], v[84:87]
    v_mfma_f32_16x16x32_bf16 v[228:231], v[144:147], v[48:51], v[228:231]
    v_mfma_f32_16x16x32_bf16 v[84:87], v[72:75], v[48:51], v[84:87]
    ds_read_b128 v[124:127], v8
    ds_read_b128 v[128:131], v9
    ds_read_b128 v[132:135], v8 offset:128
    ds_read_b128 v[136:139], v9 offset:128
    ds_read_b128 v[140:143], v8 offset:256
    ds_read_b128 v[144:147], v9 offset:256
    v_dot2_f32_bf16 v16, v28, v24, 0
    v_dot2_f32_bf16 v17, v29, v24, 0
    v_dot2_f32_bf16 v16, v30, v24, v16
    v_dot2_f32_bf16 v17, v31, v24, v17
    v_dot2_f32_bf16 v16, v32, v24, v16
    v_dot2_f32_bf16 v17, v33, v24, v17
    v_dot2_f32_bf16 v16, v34, v24, v16
    v_dot2_f32_bf16 v17, v35, v24, v17
    v_dot2_f32_bf16 v16, v36, v24, v16
    v_dot2_f32_bf16 v17, v37, v24, v17
    v_dot2_f32_bf16 v16, v38, v24, v16
    v_dot2_f32_bf16 v17, v39, v24, v17
    v_dot2_f32_bf16 v16, v40, v24, v16
    v_dot2_f32_bf16 v17, v41, v24, v17
    v_dot2_f32_bf16 v16, v42, v24, v16
    v_dot2_f32_bf16 v17, v43, v24, v17
    v_dot2_f32_bf16 v16, v44, v24, v16
    v_dot2_f32_bf16 v17, v45, v24, v17
    v_dot2_f32_bf16 v16, v46, v24, v16
    v_dot2_f32_bf16 v17, v47, v24, v17
    v_dot2_f32_bf16 v16, v48, v24, v16
    v_dot2_f32_bf16 v17, v49, v24, v17
    v_dot2_f32_bf16 v16, v50, v24, v16
    v_dot2_f32_bf16 v17, v51, v24, v17
    s_nop 2
    v_add_f32 v16, v16, v17
    v_mov_b32 v22, v16
    v_mov_b32 v23, v16
    s_nop 1
    v_permlane32_swap_b32 v22, v23
    v_add_f32 v16, v22, v23
    v_mov_b32 v22, v16
    v_mov_b32 v23, v16
    s_nop 1
    v_permlane16_swap_b32 v22, v23
    v_add_f32 v16, v22, v23
    v_mov_b32 v17, v16
    v_pk_fma_f32 v[228:229], v[232:233], v[16:17], v[228:229] neg_lo:[1,0,0] neg_hi:[1,0,0]
    v_pk_mul_f32 v[228:229], v[228:229], v[236:237]
    v_pk_fma_f32 v[230:231], v[234:235], v[16:17], v[230:231] neg_lo:[1,0,0] neg_hi:[1,0,0]
    v_pk_mul_f32 v[230:231], v[230:231], v[238:239]
    v_pk_fma_f32 v[84:85], v[76:77], v[16:17], v[84:85] neg_lo:[1,0,0] neg_hi:[1,0,0]
    v_pk_mul_f32 v[84:85], v[84:85], v[80:81]
    v_pk_fma_f32 v[86:87], v[78:79], v[16:17], v[86:87] neg_lo:[1,0,0] neg_hi:[1,0,0]
    v_pk_mul_f32 v[86:87], v[86:87], v[82:83]
    v_max3_f32 v254, v228, v229, v230
    v_max3_f32 v21, v231, v84, v85
    v_max3_f32 v254, v254, v86, v87
    v_max_f32 v254, v254, v21
    v_mov_b32 v22, v254
    v_mov_b32 v23, v254
    s_nop 1
    v_permlane32_swap_b32 v22, v23
    v_max_f32 v254, v22, v23
    v_mov_b32 v22, v254
    v_mov_b32 v23, v254
    s_nop 1
    v_permlane16_swap_b32 v22, v23
    v_max_f32 v254, v22, v23
    v_cmp_le_f32_e64 vcc, |v254|, s50
    s_nop 1
    v_cndmask_b32_e64 v254, v254, 0, vcc
    v_sub_f32 v18, 0, v254
    v_sub_f32 v19, 0, v254
    v_pk_add_f32 v[228:229], v[228:229], v[18:19]
    v_pk_add_f32 v[230:231], v[230:231], v[18:19]
    v_exp_f32 v228, v228
    v_exp_f32 v229, v229
    v_exp_f32 v230, v230
    v_exp_f32 v231, v231
    v_pk_add_f32 v[84:85], v[84:85], v[18:19]
    v_pk_add_f32 v[86:87], v[86:87], v[18:19]
    v_exp_f32 v84, v84
    v_exp_f32 v85, v85
    v_exp_f32 v86, v86
    v_exp_f32 v87, v87
    v_pk_add_f32 v[14:15], v[228:229], v[230:231]
    v_pk_add_f32 v[14:15], v[14:15], v[84:85]
    v_pk_add_f32 v[14:15], v[14:15], v[86:87]
    v_pk_mul_f32 v[228:229], v[228:229], v[236:237]
    v_pk_mul_f32 v[230:231], v[230:231], v[238:239]
    v_pk_mul_f32 v[84:85], v[84:85], v[80:81]
    v_pk_mul_f32 v[86:87], v[86:87], v[82:83]
    v_cvt_pk_bf16_f32 v244, v228, v229
    v_cvt_pk_bf16_f32 v245, v230, v231
    v_cvt_pk_bf16_f32 v246, v84, v85
    v_cvt_pk_bf16_f32 v247, v86, v87
    v_pk_add_f32 v[240:241], v[228:229], v[84:85]
    v_pk_add_f32 v[242:243], v[230:231], v[86:87]
    v_pk_mul_f32 v[252:253], v[228:229], v[232:233]
    v_pk_fma_f32 v[252:253], v[230:231], v[234:235], v[252:253]
    v_pk_fma_f32 v[252:253], v[84:85], v[76:77], v[252:253]
    v_pk_fma_f32 v[252:253], v[86:87], v[78:79], v[252:253]
    v_mov_b32 v21, 0
    v_mfma_f32_16x16x32_bf16 v[52:55], v[148:151], v[244:247], 0
    ds_read_b64_tr_b16 v[148:149], v10
    ds_read_b64 v[150:151], v21 offset:7056
    v_mfma_f32_16x16x32_bf16 v[56:59], v[154:157], v[244:247], 0
    ds_read_b64_tr_b16 v[154:155], v11
    ds_read_b64 v[156:157], v21 offset:7056
    v_mfma_f32_16x16x32_bf16 v[60:63], v[160:163], v[244:247], 0
    ds_read_b64_tr_b16 v[160:161], v12
    ds_read_b64 v[162:163], v21 offset:7056
    v_mfma_f32_16x16x32_bf16 v[64:67], v[166:169], v[244:247], 0
    ds_read_b64_tr_b16 v[166:167], v13
    ds_read_b64 v[168:169], v21 offset:7056
    v_mfma_f32_16x16x32_bf16 v[68:71], v[172:175], v[244:247], 0
    ds_read_b64_tr_b16 v[172:173], v10 offset:128
    ds_read_b64 v[174:175], v21 offset:7056
    v_mfma_f32_16x16x32_bf16 v[72:75], v[178:181], v[244:247], 0
    ds_read_b64_tr_b16 v[178:179], v11 offset:128
    ds_read_b64 v[180:181], v21 offset:7056
    v_mfma_f32_16x16x32_bf16 v[76:79], v[184:187], v[244:247], 0
    ds_read_b64_tr_b16 v[184:185], v12 offset:128
    ds_read_b64 v[186:187], v21 offset:7056
    v_mfma_f32_16x16x32_bf16 v[80:83], v[190:193], v[244:247], 0
    ds_read_b64_tr_b16 v[190:191], v13 offset:128
    ds_read_b64 v[192:193], v21 offset:7056
    v_mfma_f32_16x16x32_bf16 v[84:87], v[196:199], v[244:247], 0
    ds_read_b64_tr_b16 v[196:197], v10 offset:256
    ds_read_b64 v[198:199], v21 offset:7056
    v_mfma_f32_16x16x32_bf16 v[88:91], v[202:205], v[244:247], 0
    ds_read_b64_tr_b16 v[202:203], v11 offset:256
    ds_read_b64 v[204:205], v21 offset:7056
    v_mfma_f32_16x16x32_bf16 v[92:95], v[208:211], v[244:247], 0
    ds_read_b64_tr_b16 v[208:209], v12 offset:256
    ds_read_b64 v[210:211], v21 offset:7056
    v_mfma_f32_16x16x32_bf16 v[96:99], v[214:217], v[244:247], 0
    ds_read_b64_tr_b16 v[214:215], v13 offset:256
    ds_read_b64 v[216:217], v21 offset:7056
    s_nop 5
    s_branch L_tile2b
L_rescale:
    s_nop 15
    v_mul_f32 v4, v228, v236
    v_mul_f32 v5, v229, v237
    v_mul_f32 v6, v230, v238
    v_mul_f32 v7, v231, v239
    v_max3_f32 v21, v4, v5, v6
    v_max3_f32 v21, v21, v7, v254
    v_mov_b32 v22, v21
    v_mov_b32 v23, v21
    s_nop 1
    v_permlane32_swap_b32 v22, v23
    v_max_f32 v21, v22, v23
    v_mov_b32 v22, v21
    v_mov_b32 v23, v21
    s_nop 1
    v_permlane16_swap_b32 v22, v23
    v_max_f32 v21, v22, v23
    v_sub_f32 v22, v254, v21
    v_exp_f32 v22, v22
    v_mov_b32 v254, v21
    v_sub_f32 v18, 0, v21
    v_sub_f32 v19, 0, v21
    v_mov_b32 v23, v22
    v_sub_f32 v4, v4, v21
    v_sub_f32 v5, v5, v21
    v_sub_f32 v6, v6, v21
    v_sub_f32 v7, v7, v21
    v_pk_mul_f32 v[14:15], v[14:15], v[22:23]
    v_pk_mul_f32 v[252:253], v[252:253], v[22:23]
    v_pk_mul_f32 v[240:241], v[240:241], v[22:23]
    v_pk_mul_f32 v[242:243], v[242:243], v[22:23]
    v_pk_mul_f32 v[248:249], v[248:249], v[22:23]
    v_pk_mul_f32 v[250:251], v[250:251], v[22:23]
    v_pk_mul_f32 v[52:53], v[52:53], v[22:23]
    v_pk_mul_f32 v[54:55], v[54:55], v[22:23]
    v_pk_mul_f32 v[56:57], v[56:57], v[22:23]
    v_pk_mul_f32 v[58:59], v[58:59], v[22:23]
    v_pk_mul_f32 v[60:61], v[60:61], v[22:23]
    v_pk_mul_f32 v[62:63], v[62:63], v[22:23]
    v_pk_mul_f32 v[64:65], v[64:65], v[22:23]
    v_pk_mul_f32 v[66:67], v[66:67], v[22:23]
    v_pk_mul_f32 v[68:69], v[68:69], v[22:23]
    v_pk_mul_f32 v[70:71], v[70:71], v[22:23]
    v_pk_mul_f32 v[72:73], v[72:73], v[22:23]
    v_pk_mul_f32 v[74:75], v[74:75], v[22:23]
    v_pk_mul_f32 v[76:77], v[76:77], v[22:23]
    v_pk_mul_f32 v[78:79], v[78:79], v[22:23]
    v_pk_mul_f32 v[80:81], v[80:81], v[22:23]
    v_pk_mul_f32 v[82:83], v[82:83], v[22:23]
    v_pk_mul_f32 v[84:85], v[84:85], v[22:23]
    v_pk_mul_f32 v[86:87], v[86:87], v[22:23]
    v_pk_mul_f32 v[88:89], v[88:89], v[22:23]
    v_pk_mul_f32 v[90:91], v[90:91], v[22:23]
    v_pk_mul_f32 v[92:93], v[92:93], v[22:23]
    v_pk_mul_f32 v[94:95], v[94:95], v[22:23]
    v_pk_mul_f32 v[96:97], v[96:97], v[22:23]
    v_pk_mul_f32 v[98:99], v[98:99], v[22:23]
    s_nop 1
    s_setpc_b64 s[48:49]
L_loop:
    s_add_u32 s51, s51, 1
    s_cmp_lg_u32 s57, 0
    s_cbranch_scc1 L_begun32
L_spin33:
    ds_read_b32 v3, v1 offset:6912
    s_waitcnt lgkmcnt(0)
    v_readfirstlane_b32 s52, v3
    s_nop 0
    s_cmp_ge_u32 s52, s51
    s_cbranch_scc1 L_spun34
    s_sleep 1
    s_branch L_spin33
L_spun34:
    ds_read_b128 v[100:103], v8
    ds_read_b128 v[104:107], v9
    ds_read_b128 v[108:111], v8 offset:128
    ds_read_b128 v[112:115], v9 offset:128
    ds_read_b128 v[116:119], v8 offset:256
    ds_read_b128 v[120:123], v9 offset:256
L_begun32:
    v_mfma_f32_16x16x32_bf16 v[52:55], v[150:153], v[244:247], v[52:55]
    ds_read_b64_tr_b16 v[152:153], v10
    v_mfma_f32_16x16x32_bf16 v[56:59], v[156:159], v[244:247], v[56:59]
    ds_read_b64_tr_b16 v[158:159], v11
    v_mfma_f32_16x16x32_bf16 v[60:63], v[162:165], v[244:247], v[60:63]
    ds_read_b64_tr_b16 v[164:165], v12
    v_mfma_f32_16x16x32_bf16 v[64:67], v[168:171], v[244:247], v[64:67]
    ds_read_b64_tr_b16 v[170:171], v13
    v_mfma_f32_16x16x32_bf16 v[68:71], v[174:177], v[244:247], v[68:71]
    ds_read_b64_tr_b16 v[176:177], v10 offset:128
    v_mfma_f32_16x16x32_bf16 v[72:75], v[180:183], v[244:247], v[72:75]
    ds_read_b64_tr_b16 v[182:183], v11 offset:128
    v_mfma_f32_16x16x32_bf16 v[76:79], v[186:189], v[244:247], v[76:79]
    ds_read_b64_tr_b16 v[188:189], v12 offset:128
    v_mfma_f32_16x16x32_bf16 v[80:83], v[192:195], v[244:247], v[80:83]
    ds_read_b64_tr_b16 v[194:195], v13 offset:128
    v_mfma_f32_16x16x32_bf16 v[84:87], v[198:201], v[244:247], v[84:87]
    ds_read_b64_tr_b16 v[200:201], v10 offset:256
    v_mfma_f32_16x16x32_bf16 v[88:91], v[204:207], v[244:247], v[88:91]
    ds_read_b64_tr_b16 v[206:207], v11 offset:256
    v_mfma_f32_16x16x32_bf16 v[92:95], v[210:213], v[244:247], v[92:95]
    ds_read_b64_tr_b16 v[212:213], v12 offset:256
    v_mfma_f32_16x16x32_bf16 v[96:99], v[216:219], v[244:247], v[96:99]
    ds_read_b64_tr_b16 v[218:219], v13 offset:256
    s_waitcnt lgkmcnt(12)
    v_mfma_f32_16x16x32_bf16 v[236:239], v[100:103], v[100:103], 0
    v_mfma_f32_16x16x32_bf16 v[224:227], v[100:103], v[24:27], 0
    v_mfma_f32_16x16x32_bf16 v[236:239], v[104:107], v[104:107], v[236:239]
    v_mfma_f32_16x16x32_bf16 v[224:227], v[104:107], v[24:27], v[224:227]
    v_mfma_f32_16x16x32_bf16 v[236:239], v[108:111], v[108:111], v[236:239]
    v_mfma_f32_16x16x32_bf16 v[224:227], v[108:111], v[24:27], v[224:227]
    v_mfma_f32_16x16x32_bf16 v[236:239], v[112:115], v[112:115], v[236:239]
    v_mfma_f32_16x16x32_bf16 v[224:227], v[112:115], v[24:27], v[224:227]
    v_mfma_f32_16x16x32_bf16 v[236:239], v[116:119], v[116:119], v[236:239]
    v_mfma_f32_16x16x32_bf16 v[224:227], v[116:119], v[24:27], v[224:227]
    v_mfma_f32_16x16x32_bf16 v[236:239], v[120:123], v[120:123], v[236:239]
    v_mfma_f32_16x16x32_bf16 v[224:227], v[120:123], v[24:27], v[224:227]
    v_mfma_f32_16x16x32_bf16 v[220:223], v[100:103], v[28:31], 0
    v_mfma_f32_16x16x32_bf16 v[220:223], v[104:107], v[32:35], v[220:223]
    v_mfma_f32_16x16x32_bf16 v[220:223], v[108:111], v[36:39], v[220:223]
    v_mfma_f32_16x16x32_bf16 v[220:223], v[112:115], v[40:43], v[220:223]
    v_mfma_f32_16x16x32_bf16 v[220:223], v[116:119], v[44:47], v[220:223]
    v_mfma_f32_16x16x32_bf16 v[220:223], v[120:123], v[48:51], v[220:223]
    ds_read_b32 v3, v1 offset:6912
    v_mov_b32 v2, s51
    s_add_u32 s54, s54, 1
    s_cmp_eq_u32 s54, 6
    s_cselect_b32 s55, 0xffff8800, s56
    s_cselect_b32 s54, 0, s54
    v_add_u32 v8, s55, v8
    v_add_u32 v9, s55, v9
    v_add_u32 v10, s55, v10
    v_add_u32 v11, s55, v11
    v_add_u32 v12, s55, v12
    v_add_u32 v13, s55, v13
    s_waitcnt lgkmcnt(0)
    ds_write_b32 v1, v2 offset:6928
    v_readfirstlane_b32 s52, v3
    s_mov_b32 s57, 0
    s_nop 0
    s_cmp_gt_u32 s52, s51
    s_cbranch_scc0 L_early35
    s_mov_b32 s57, 1
    ds_read_b128 v[124:127], v8
    ds_read_b128 v[128:131], v9
    ds_read_b128 v[132:135], v8 offset:128
    ds_read_b128 v[136:139], v9 offset:128
    ds_read_b128 v[140:143], v8 offset:256
    ds_read_b128 v[144:147], v9 offset:256
L_early35:
    v_cndmask_b32 v22, v236, v237, s[58:59]
    v_cndmask_b32 v23, v238, v239, s[58:59]
    v_cndmask_b32 v255, v22, v23, s[60:61]
    s_add_u32 s51, s51, 1
    s_cmp_lg_u32 s57, 0
    s_cbranch_scc1 L_begun36
L_spin37:
    ds_read_b32 v3, v1 offset:6912
    s_waitcnt lgkmcnt(0)
    v_readfirstlane_b32 s52, v3
    s_nop 0
    s_cmp_ge_u32 s52, s51
    s_cbranch_scc1 L_spun38
    s_sleep 1
    s_branch L_spin37
L_spun38:
    ds_read_b128 v[124:127], v8
    ds_read_b128 v[128:131], v9
    ds_read_b128 v[132:135], v8 offset:128
    ds_read_b128 v[136:139], v9 offset:128
    ds_read_b128 v[140:143], v8 offset:256
    ds_read_b128 v[144:147], v9 offset:256
L_begun36:
    s_waitcnt lgkmcnt(5)
    v_mfma_f32_16x16x32_bf16 v[236:239], v[124:127], v[124:127], 0
    v_mfma_f32_16x16x32_bf16 v[4:7], v[124:127], v[100:103], 0
    ds_read_b64_tr_b16 v[148:149], v10
    s_waitcnt lgkmcnt(5)
    v_mfma_f32_16x16x32_bf16 v[236:239], v[128:131], v[128:131], v[236:239]
    v_mfma_f32_16x16x32_bf16 v[4:7], v[128:131], v[104:107], v[4:7]
    ds_read_b64_tr_b16 v[154:155], v11
    s_waitcnt lgkmcnt(5)
    v_mfma_f32_16x16x32_bf16 v[236:239], v[132:135], v[132:135], v[236:239]
    ds_read_b64_tr_b16 v[160:161], v12
    v_mfma_f32_16x16x32_bf16 v[4:7], v[132:135], v[108:111], v[4:7]
    ds_read_b64_tr_b16 v[166:167], v13
    s_waitcnt lgkmcnt(6)
    v_mfma_f32_16x16x32_bf16 v[236:239], v[136:139], v[136:139], v[236:239]
    ds_read_b64_tr_b16 v[172:173], v10 offset:128
    v_mfma_f32_16x16x32_bf16 v[4:7], v[136:139], v[112:115], v[4:7]
    ds_read_b64_tr_b16 v[178:179], v11 offset:128
    s_waitcnt lgkmcnt(7)
    v_mfma_f32_16x16x32_bf16 v[236:239], v[140:143], v[140:143], v[236:239]
    ds_read_b64_tr_b16 v[184:185], v12 offset:128
    v_mfma_f32_16x16x32_bf16 v[4:7], v[140:143], v[116:119], v[4:7]
    ds_read_b64_tr_b16 v[190:191], v13 offset:128
    s_waitcnt lgkmcnt(8)
    v_mfma_f32_16x16x32_bf16 v[236:239], v[144:147], v[144:147], v[236:239]
    ds_read_b64_tr_b16 v[196:197], v10 offset:256
    v_mfma_f32_16x16x32_bf16 v[4:7], v[144:147], v[120:123], v[4:7]
    ds_read_b64_tr_b16 v[202:203], v11 offset:256
    v_mfma_f32_16x16x32_bf16 v[232:235], v[124:127], v[24:27], v[224:227]
    ds_read_b64_tr_b16 v[208:209], v12 offset:256
    v_mfma_f32_16x16x32_bf16 v[232:235], v[128:131], v[24:27], v[232:235]
    ds_read_b64_tr_b16 v[214:215], v13 offset:256
    s_nop 2
    v_mfma_f32_16x16x32_bf16 v[232:235], v[132:135], v[24:27], v[232:235]
    v_cndmask_b32 v22, v236, v237, s[58:59]
    v_cndmask_b32 v23, v238, v239, s[58:59]
    v_mfma_f32_16x16x32_bf16 v[232:235], v[136:139], v[24:27], v[232:235]
    v_cndmask_b32 v4, v4, v5, s[58:59]
    v_cndmask_b32 v6, v6, v7, s[58:59]
    v_mfma_f32_16x16x32_bf16 v[232:235], v[140:143], v[24:27], v[232:235]
    v_cndmask_b32 v22, v22, v23, s[60:61]
    v_cndmask_b32 v4, v4, v6, s[60:61]
    v_mfma_f32_16x16x32_bf16 v[232:235], v[144:147], v[24:27], v[232:235]
    v_add_f32 v22, v22, v255
    v_fma_f32 v22, v4, 2.0, v22
    v_cndmask_b32 v22, 0, v22, s[38:39]
    v_mfma_f32_16x16x32_bf16 v[228:231], v[124:127], v[28:31], v[220:223]
    s_nop 0
    v_mfma_f32_16x16x4_f32 v[236:239], v22, v20, 0
    v_mfma_f32_16x16x32_bf16 v[228:231], v[128:131], v[32:35], v[228:231]
    v_mfma_f32_16x16x32_bf16 v[228:231], v[132:135], v[36:39], v[228:231]
    v_mul_f32 v232, s44, v232
    v_mul_f32 v233, s44, v233
    v_mfma_f32_16x16x32_bf16 v[228:231], v[136:139], v[40:43], v[228:231]
    v_mul_f32 v234, s44, v234
    v_mul_f32 v235, s44, v235
    v_mfma_f32_16x16x32_bf16 v[228:231], v[140:143], v[44:47], v[228:231]
    v_fma_f32 v4, -v232, v232, s46
    v_fma_f32 v5, -v233, v233, s46
    v_mfma_f32_16x16x32_bf16 v[228:231], v[144:147], v[48:51], v[228:231]
    v_fma_f32 v6, -v234, v234, s46
    v_fma_f32 v7, -v235, v235, s46
    ds_read_b32 v3, v1 offset:6912
    v_mov_b32 v2, s51
    s_add_u32 s54, s54, 1
    s_cmp_eq_u32 s54, 6
    s_cselect_b32 s55, 0xffff8800, s56
    s_cselect_b32 s54, 0, s54
    v_add_u32 v8, s55, v8
    v_add_u32 v9, s55, v9
    v_add_u32 v10, s55, v10
    v_add_u32 v11, s55, v11
    v_add_u32 v12, s55, v12
    v_add_u32 v13, s55, v13
    s_waitcnt lgkmcnt(0)
    ds_write_b32 v1, v2 offset:6928
    v_readfirstlane_b32 s52, v3
    s_mov_b32 s57, 0
    s_nop 0
    s_cmp_gt_u32 s52, s51
    s_cbranch_scc0 L_early39
    s_mov_b32 s57, 1
    ds_read_b128 v[124:127], v8
    ds_read_b128 v[128:131], v9
    ds_read_b128 v[132:135], v8 offset:128
    ds_read_b128 v[136:139], v9 offset:128
    ds_read_b128 v[140:143], v8 offset:256
    ds_read_b128 v[144:147], v9 offset:256
L_early39:
    v_fma_f32 v236, v236, s44, v4
    v_fma_f32 v237, v237, s44, v5
    v_fma_f32 v238, v238, s44, v6
    v_fma_f32 v239, v239, s44, v7
    v_max_f32 v236, s46, v236
    v_max_f32 v237, s46, v237
    v_max_f32 v238, s46, v238
    v_max_f32 v239, s46, v239
    v_rsq_f32 v236, v236
    v_rsq_f32 v237, v237
    v_rsq_f32 v238, v238
    v_rsq_f32 v239, v239
    v_pk_fma_f32 v[228:229], v[232:233], v[16:17], v[228:229] neg_lo:[1,0,0] neg_hi:[1,0,0]
    v_pk_fma_f32 v[230:231], v[234:235], v[16:17], v[230:231] neg_lo:[1,0,0] neg_hi:[1,0,0]
    v_pk_fma_f32 v[4:5], v[228:229], v[236:237], v[18:19]
    v_pk_fma_f32 v[6:7], v[230:231], v[238:239], v[18:19]
    v_max3_f32 v21, v4, v5, v6
    v_max_f32 v21, v21, v7
    v_cmp_lt_f32 vcc, s50, v21
    s_cbranch_vccz L_sm40
    s_call_b64 s[48:49], L_rescale
L_sm40:
    v_exp_f32 v4, v4
    v_exp_f32 v5, v5
    v_exp_f32 v6, v6
    v_exp_f32 v7, v7
    v_pk_mul_f32 v[248:249], v[4:5], v[236:237]
    v_pk_add_f32 v[14:15], v[14:15], v[4:5]
    v_pk_mul_f32 v[250:251], v[6:7], v[238:239]
    v_pk_add_f32 v[14:15], v[14:15], v[6:7]
    v_mov_b32 v240, v248
    v_mov_b32 v241, v249
    v_mov_b32 v242, v250
    v_mov_b32 v243, v251
    v_pk_fma_f32 v[252:253], v[248:249], v[232:233], v[252:253]
    v_pk_fma_f32 v[252:253], v[250:251], v[234:235], v[252:253]
    s_add_u32 s51, s51, 1
    s_cmp_lg_u32 s57, 0
    s_cbranch_scc1 L_begun41
L_spin42:
    ds_read_b32 v3, v1 offset:6912
    s_waitcnt lgkmcnt(0)
    v_readfirstlane_b32 s52, v3
    s_nop 0
    s_cmp_ge_u32 s52, s51
    s_cbranch_scc1 L_spun43
    s_sleep 1
    s_branch L_spin42
L_spun43:
    ds_read_b128 v[124:127], v8
    ds_read_b128 v[128:131], v9
    ds_read_b128 v[132:135], v8 offset:128
    ds_read_b128 v[136:139], v9 offset:128
    ds_read_b128 v[140:143], v8 offset:256
    ds_read_b128 v[144:147], v9 offset:256
L_begun41:
    s_waitcnt lgkmcnt(5)
    v_mfma_f32_16x16x32_bf16 v[236:239], v[124:127], v[124:127], 0
    v_mfma_f32_16x16x32_bf16 v[4:7], v[124:127], v[100:103], 0
    ds_read_b64_tr_b16 v[150:151], v10
    s_waitcnt lgkmcnt(5)
    v_mfma_f32_16x16x32_bf16 v[236:239], v[128:131], v[128:131], v[236:239]
    v_mfma_f32_16x16x32_bf16 v[4:7], v[128:131], v[104:107], v[4:7]
    ds_read_b64_tr_b16 v[156:157], v11
    s_waitcnt lgkmcnt(5)
    v_mfma_f32_16x16x32_bf16 v[236:239], v[132:135], v[132:135], v[236:239]
    ds_read_b64_tr_b16 v[162:163], v12
    v_mfma_f32_16x16x32_bf16 v[4:7], v[132:135], v[108:111], v[4:7]
    ds_read_b64_tr_b16 v[168:169], v13
    s_waitcnt lgkmcnt(6)
    v_mfma_f32_16x16x32_bf16 v[236:239], v[136:139], v[136:139], v[236:239]
    ds_read_b64_tr_b16 v[174:175], v10 offset:128
    v_mfma_f32_16x16x32_bf16 v[4:7], v[136:139], v[112:115], v[4:7]
    ds_read_b64_tr_b16 v[180:181], v11 offset:128
    s_waitcnt lgkmcnt(7)
    v_mfma_f32_16x16x32_bf16 v[236:239], v[140:143], v[140:143], v[236:239]
    ds_read_b64_tr_b16 v[186:187], v12 offset:128
    v_mfma_f32_16x16x32_bf16 v[4:7], v[140:143], v[116:119], v[4:7]
    ds_read_b64_tr_b16 v[192:193], v13 offset:128
    s_waitcnt lgkmcnt(8)
    v_mfma_f32_16x16x32_bf16 v[236:239], v[144:147], v[144:147], v[236:239]
    ds_read_b64_tr_b16 v[198:199], v10 offset:256
    v_mfma_f32_16x16x32_bf16 v[4:7], v[144:147], v[120:123], v[4:7]
    ds_read_b64_tr_b16 v[204:205], v11 offset:256
    v_mfma_f32_16x16x32_bf16 v[232:235], v[124:127], v[24:27], v[224:227]
    ds_read_b64_tr_b16 v[210:211], v12 offset:256
    v_mfma_f32_16x16x32_bf16 v[232:235], v[128:131], v[24:27], v[232:235]
    ds_read_b64_tr_b16 v[216:217], v13 offset:256
    s_nop 2
    v_mfma_f32_16x16x32_bf16 v[232:235], v[132:135], v[24:27], v[232:235]
    v_cndmask_b32 v22, v236, v237, s[58:59]
    v_cndmask_b32 v23, v238, v239, s[58:59]
    v_mfma_f32_16x16x32_bf16 v[232:235], v[136:139], v[24:27], v[232:235]
    v_cndmask_b32 v4, v4, v5, s[58:59]
    v_cndmask_b32 v6, v6, v7, s[58:59]
    v_mfma_f32_16x16x32_bf16 v[232:235], v[140:143], v[24:27], v[232:235]
    v_cndmask_b32 v22, v22, v23, s[60:61]
    v_cndmask_b32 v4, v4, v6, s[60:61]
    v_mfma_f32_16x16x32_bf16 v[232:235], v[144:147], v[24:27], v[232:235]
    v_add_f32 v22, v22, v255
    v_fma_f32 v22, v4, 2.0, v22
    v_cndmask_b32 v22, 0, v22, s[38:39]
    v_mfma_f32_16x16x32_bf16 v[228:231], v[124:127], v[28:31], v[220:223]
    s_nop 0
    v_mfma_f32_16x16x4_f32 v[236:239], v22, v20, 0
    v_mfma_f32_16x16x32_bf16 v[228:231], v[128:131], v[32:35], v[228:231]
    v_mfma_f32_16x16x32_bf16 v[228:231], v[132:135], v[36:39], v[228:231]
    v_mul_f32 v232, s44, v232
    v_mul_f32 v233, s44, v233
    v_mfma_f32_16x16x32_bf16 v[228:231], v[136:139], v[40:43], v[228:231]
    v_mul_f32 v234, s44, v234
    v_mul_f32 v235, s44, v235
    v_mfma_f32_16x16x32_bf16 v[228:231], v[140:143], v[44:47], v[228:231]
    v_fma_f32 v4, -v232, v232, s46
    v_fma_f32 v5, -v233, v233, s46
    v_mfma_f32_16x16x32_bf16 v[228:231], v[144:147], v[48:51], v[228:231]
    v_fma_f32 v6, -v234, v234, s46
    v_fma_f32 v7, -v235, v235, s46
    ds_read_b32 v3, v1 offset:6912
    v_mov_b32 v2, s51
    s_add_u32 s54, s54, 1
    s_cmp_eq_u32 s54, 6
    s_cselect_b32 s55, 0xffff8800, s56
    s_cselect_b32 s54, 0, s54
    v_add_u32 v8, s55, v8
    v_add_u32 v9, s55, v9
    v_add_u32 v10, s55, v10
    v_add_u32 v11, s55, v11
    v_add_u32 v12, s55, v12
    v_add_u32 v13, s55, v13
    s_waitcnt lgkmcnt(0)
    ds_write_b32 v1, v2 offset:6928
    v_readfirstlane_b32 s52, v3
    s_mov_b32 s57, 0
    s_nop 0
    s_cmp_gt_u32 s52, s51
    s_cbranch_scc0 L_early44
    s_mov_b32 s57, 1
    ds_read_b128 v[124:127], v8
    ds_read_b128 v[128:131], v9
    ds_read_b128 v[132:135], v8 offset:128
    ds_read_b128 v[136:139], v9 offset:128
    ds_read_b128 v[140:143], v8 offset:256
    ds_read_b128 v[144:147], v9 offset:256
L_early44:
    v_fma_f32 v236, v236, s44, v4
    v_fma_f32 v237, v237, s44, v5
    v_fma_f32 v238, v238, s44, v6
    v_fma_f32 v239, v239, s44, v7
    v_max_f32 v236, s46, v236
    v_max_f32 v237, s46, v237
    v_max_f32 v238, s46, v238
    v_max_f32 v239, s46, v239
    v_rsq_f32 v236, v236
    v_rsq_f32 v237, v237
    v_rsq_f32 v238, v238
    v_rsq_f32 v239, v239
    v_pk_fma_f32 v[228:229], v[232:233], v[16:17], v[228:229] neg_lo:[1,0,0] neg_hi:[1,0,0]
    v_pk_fma_f32 v[230:231], v[234:235], v[16:17], v[230:231] neg_lo:[1,0,0] neg_hi:[1,0,0]
    v_pk_fma_f32 v[4:5], v[228:229], v[236:237], v[18:19]
    v_pk_fma_f32 v[6:7], v[230:231], v[238:239], v[18:19]
    v_max3_f32 v21, v4, v5, v6
    v_max_f32 v21, v21, v7
    v_cmp_lt_f32 vcc, s50, v21
    s_cbranch_vccz L_sm45
    s_call_b64 s[48:49], L_rescale
L_sm45:
    v_exp_f32 v4, v4
    v_exp_f32 v5, v5
    v_exp_f32 v6, v6
    v_exp_f32 v7, v7
    v_pk_mul_f32 v[228:229], v[4:5], v[236:237]
    v_pk_add_f32 v[14:15], v[14:15], v[4:5]
    v_pk_mul_f32 v[230:231], v[6:7], v[238:239]
    v_pk_add_f32 v[14:15], v[14:15], v[6:7]
    v_pk_add_f32 v[240:241], v[240:241], v[228:229]
    v_pk_add_f32 v[242:243], v[242:243], v[230:231]
    v_pk_fma_f32 v[252:253], v[228:229], v[232:233], v[252:253]
    v_pk_fma_f32 v[252:253], v[230:231], v[234:235], v[252:253]
    v_cvt_pk_bf16_f32 v244, v248, v249
    v_cvt_pk_bf16_f32 v245, v250, v251
    v_cvt_pk_bf16_f32 v246, v228, v229
    v_cvt_pk_bf16_f32 v247, v230, v231
    s_add_u32 s51, s51, 1
    s_cmp_lg_u32 s57, 0
    s_cbranch_scc1 L_begun46
L_spin47:
    ds_read_b32 v3, v1 offset:6912
    s_waitcnt lgkmcnt(0)
    v_readfirstlane_b32 s52, v3
    s_nop 0
    s_cmp_ge_u32 s52, s51
    s_cbranch_scc1 L_spun48
    s_sleep 1
    s_branch L_spin47
L_spun48:
    ds_read_b128 v[124:127], v8
    ds_read_b128 v[128:131], v9
    ds_read_b128 v[132:135], v8 offset:128
    ds_read_b128 v[136:139], v9 offset:128
    ds_read_b128 v[140:143], v8 offset:256
    ds_read_b128 v[144:147], v9 offset:256
L_begun46:
    v_mov_b32 v21, 0
    v_mfma_f32_16x16x32_bf16 v[52:55], v[148:151], v[244:247], v[52:55]
    ds_read_b64_tr_b16 v[148:149], v10
    ds_read_b64 v[150:151], v21 offset:7056
    v_mfma_f32_16x16x32_bf16 v[56:59], v[154:157], v[244:247], v[56:59]
    ds_read_b64_tr_b16 v[154:155], v11
    ds_read_b64 v[156:157], v21 offset:7056
    v_mfma_f32_16x16x32_bf16 v[60:63], v[160:163], v[244:247], v[60:63]
    ds_read_b64_tr_b16 v[160:161], v12
    ds_read_b64 v[162:163], v21 offset:7056
    v_mfma_f32_16x16x32_bf16 v[64:67], v[166:169], v[244:247], v[64:67]
    ds_read_b64_tr_b16 v[166:167], v13
    ds_read_b64 v[168:169], v21 offset:7056
    v_mfma_f32_16x16x32_bf16 v[68:71], v[172:175], v[244:247], v[68:71]
    ds_read_b64_tr_b16 v[172:173], v10 offset:128
    ds_read_b64 v[174:175], v21 offset:7056
    v_mfma_f32_16x16x32_bf16 v[72:75], v[178:181], v[244:247], v[72:75]
    ds_read_b64_tr_b16 v[178:179], v11 offset:128
    ds_read_b64 v[180:181], v21 offset:7056
    v_mfma_f32_16x16x32_bf16 v[76:79], v[184:187], v[244:247], v[76:79]
    ds_read_b64_tr_b16 v[184:185], v12 offset:128
    ds_read_b64 v[186:187], v21 offset:7056
    v_mfma_f32_16x16x32_bf16 v[80:83], v[190:193], v[244:247], v[80:83]
    ds_read_b64_tr_b16 v[190:191], v13 offset:128
    ds_read_b64 v[192:193], v21 offset:7056
    v_mfma_f32_16x16x32_bf16 v[84:87], v[196:199], v[244:247], v[84:87]
    ds_read_b64_tr_b16 v[196:197], v10 offset:256
    ds_read_b64 v[198:199], v21 offset:7056
    v_mfma_f32_16x16x32_bf16 v[88:91], v[202:205], v[244:247], v[88:91]
    ds_read_b64_tr_b16 v[202:203], v11 offset:256
    ds_read_b64 v[204:205], v21 offset:7056
    v_mfma_f32_16x16x32_bf16 v[92:95], v[208:211], v[244:247], v[92:95]
    ds_read_b64_tr_b16 v[208:209], v12 offset:256
    ds_read_b64 v[210:211], v21 offset:7056
    v_mfma_f32_16x16x32_bf16 v[96:99], v[214:217], v[244:247], v[96:99]
    ds_read_b64_tr_b16 v[214:215], v13 offset:256
    ds_read_b64 v[216:217], v21 offset:7056
    s_nop 5
L_tile2b:
    s_waitcnt lgkmcnt(15)
    v_mfma_f32_16x16x32_bf16 v[236:239], v[124:127], v[124:127], 0
    v_mfma_f32_16x16x32_bf16 v[4:7], v[124:127], v[100:103], 0
    v_mfma_f32_16x16x32_bf16 v[236:239], v[128:131], v[128:131], v[236:239]
    v_mfma_f32_16x16x32_bf16 v[4:7], v[128:131], v[104:107], v[4:7]
    v_mfma_f32_16x16x32_bf16 v[236:239], v[132:135], v[132:135], v[236:239]
    v_mfma_f32_16x16x32_bf16 v[4:7], v[132:135], v[108:111], v[4:7]
    v_mfma_f32_16x16x32_bf16 v[236:239], v[136:139], v[136:139], v[236:239]
    v_mfma_f32_16x16x32_bf16 v[4:7], v[136:139], v[112:115], v[4:7]
    v_mfma_f32_16x16x32_bf16 v[236:239], v[140:143], v[140:143], v[236:239]
    v_mfma_f32_16x16x32_bf16 v[4:7], v[140:143], v[116:119], v[4:7]
    v_mfma_f32_16x16x32_bf16 v[236:239], v[144:147], v[144:147], v[236:239]
    v_mfma_f32_16x16x32_bf16 v[4:7], v[144:147], v[120:123], v[4:7]
    v_mfma_f32_16x16x32_bf16 v[232:235], v[124:127], v[24:27], v[224:227]
    v_mfma_f32_16x16x32_bf16 v[232:235], v[128:131], v[24:27], v[232:235]
    s_nop 4
    v_mfma_f32_16x16x32_bf16 v[232:235], v[132:135], v[24:27], v[232:235]
    v_cndmask_b32 v22, v236, v237, s[58:59]
    v_cndmask_b32 v23, v238, v239, s[58:59]
    v_mfma_f32_16x16x32_bf16 v[232:235], v[136:139], v[24:27], v[232:235]
    v_cndmask_b32 v4, v4, v5, s[58:59]
    v_cndmask_b32 v6, v6, v7, s[58:59]
    v_mfma_f32_16x16x32_bf16 v[232:235], v[140:143], v[24:27], v[232:235]
    v_cndmask_b32 v22, v22, v23, s[60:61]
    v_cndmask_b32 v4, v4, v6, s[60:61]
    v_mfma_f32_16x16x32_bf16 v[232:235], v[144:147], v[24:27], v[232:235]
    v_add_f32 v22, v22, v255
    v_fma_f32 v22, v4, 2.0, v22
    v_cndmask_b32 v22, 0, v22, s[38:39]
    v_mfma_f32_16x16x32_bf16 v[228:231], v[124:127], v[28:31], v[220:223]
    s_nop 0
    v_mfma_f32_16x16x4_f32 v[236:239], v22, v20, 0
    v_mfma_f32_16x16x32_bf16 v[228:231], v[128:131], v[32:35], v[228:231]
    v_mfma_f32_16x16x32_bf16 v[228:231], v[132:135], v[36:39], v[228:231]
    v_mul_f32 v232, s44, v232
    v_mul_f32 v233, s44, v233
    v_mfma_f32_16x16x32_bf16 v[228:231], v[136:139], v[40:43], v[228:231]
    v_mul_f32 v234, s44, v234
    v_mul_f32 v235, s44, v235
    v_mfma_f32_16x16x32_bf16 v[228:231], v[140:143], v[44:47], v[228:231]
    v_fma_f32 v4, -v232, v232, s46
    v_fma_f32 v5, -v233, v233, s46
    v_mfma_f32_16x16x32_bf16 v[228:231], v[144:147], v[48:51], v[228:231]
    v_fma_f32 v6, -v234, v234, s46
    v_fma_f32 v7, -v235, v235, s46
    ds_read_b32 v3, v1 offset:6912
    v_mov_b32 v2, s51
    s_add_u32 s54, s54, 1
    s_cmp_eq_u32 s54, 6
    s_cselect_b32 s55, 0xffff8800, s56
    s_cselect_b32 s54, 0, s54
    v_add_u32 v8, s55, v8
    v_add_u32 v9, s55, v9
    v_add_u32 v10, s55, v10
    v_add_u32 v11, s55, v11
    v_add_u32 v12, s55, v12
    v_add_u32 v13, s55, v13
    s_waitcnt lgkmcnt(0)
    ds_write_b32 v1, v2 offset:6928
    v_readfirstlane_b32 s52, v3
    s_mov_b32 s57, 0
    s_nop 0
    s_cmp_gt_u32 s52, s51
    s_cbranch_scc0 L_early49
    s_mov_b32 s57, 1
    ds_read_b128 v[124:127], v8
    ds_read_b128 v[128:131], v9
    ds_read_b128 v[132:135], v8 offset:128
    ds_read_b128 v[136:139], v9 offset:128
    ds_read_b128 v[140:143], v8 offset:256
    ds_read_b128 v[144:147], v9 offset:256
L_early49:
    ds_read_b32 v3, v1 offset:6912
    v_fma_f32 v236, v236, s44, v4
    v_fma_f32 v237, v237, s44, v5
    v_fma_f32 v238, v238, s44, v6
    v_fma_f32 v239, v239, s44, v7
    v_max_f32 v236, s46, v236
    v_max_f32 v237, s46, v237
    v_max_f32 v238, s46, v238
    v_max_f32 v239, s46, v239
    v_rsq_f32 v236, v236
    v_rsq_f32 v237, v237
    v_rsq_f32 v238, v238
    v_rsq_f32 v239, v239
    v_pk_fma_f32 v[228:229], v[232:233], v[16:17], v[228:229] neg_lo:[1,0,0] neg_hi:[1,0,0]
    v_pk_fma_f32 v[230:231], v[234:235], v[16:17], v[230:231] neg_lo:[1,0,0] neg_hi:[1,0,0]
    v_pk_fma_f32 v[4:5], v[228:229], v[236:237], v[18:19]
    v_pk_fma_f32 v[6:7], v[230:231], v[238:239], v[18:19]
    v_max3_f32 v21, v4, v5, v6
    v_max_f32 v21, v21, v7
    v_cmp_lt_f32 vcc, s50, v21
    s_cbranch_vccz L_sm50
    s_call_b64 s[48:49], L_rescale
L_sm50:
    v_exp_f32 v4, v4
    v_exp_f32 v5, v5
    v_exp_f32 v6, v6
    v_exp_f32 v7, v7
    v_pk_mul_f32 v[248:249], v[4:5], v[236:237]
    v_pk_add_f32 v[14:15], v[14:15], v[4:5]
    v_pk_mul_f32 v[250:251], v[6:7], v[238:239]
    v_pk_add_f32 v[14:15], v[14:15], v[6:7]
    v_pk_add_f32 v[240:241], v[240:241], v[248:249]
    v_pk_add_f32 v[242:243], v[242:243], v[250:251]
    v_pk_fma_f32 v[252:253], v[248:249], v[232:233], v[252:253]
    v_pk_fma_f32 v[252:253], v[250:251], v[234:235], v[252:253]
    v_cvt_pk_bf16_f32 v244, v248, v249
    v_cvt_pk_bf16_f32 v245, v250, v251
    v_cvt_pk_bf16_f32 v246, -v252, -v253
    v_mov_b32 v247, 0
    s_waitcnt lgkmcnt(0)
    v_readfirstlane_b32 s52, v3
    s_cmp_lg_u32 s57, 0
    s_cbranch_scc1 L_early51
    s_cmp_gt_u32 s52, s51
    s_cbranch_scc0 L_early51
    s_mov_b32 s57, 1
    ds_read_b128 v[124:127], v8
    ds_read_b128 v[128:131], v9
    ds_read_b128 v[132:135], v8 offset:128
    ds_read_b128 v[136:139], v9 offset:128
    ds_read_b128 v[140:143], v8 offset:256
    ds_read_b128 v[144:147], v9 offset:256
L_early51:
    v_mfma_f32_16x16x32_bf16 v[52:55], v[148:151], v[244:247], v[52:55]
    v_mfma_f32_16x16x32_bf16 v[56:59], v[154:157], v[244:247], v[56:59]
    v_mfma_f32_16x16x32_bf16 v[60:63], v[160:163], v[244:247], v[60:63]
    v_mfma_f32_16x16x32_bf16 v[64:67], v[166:169], v[244:247], v[64:67]
    v_mfma_f32_16x16x32_bf16 v[68:71], v[172:175], v[244:247], v[68:71]
    v_mfma_f32_16x16x32_bf16 v[72:75], v[178:181], v[244:247], v[72:75]
    v_mfma_f32_16x16x32_bf16 v[76:79], v[184:187], v[244:247], v[76:79]
    v_mfma_f32_16x16x32_bf16 v[80:83], v[190:193], v[244:247], v[80:83]
    v_mfma_f32_16x16x32_bf16 v[84:87], v[196:199], v[244:247], v[84:87]
    v_mfma_f32_16x16x32_bf16 v[88:91], v[202:205], v[244:247], v[88:91]
    v_mfma_f32_16x16x32_bf16 v[92:95], v[208:211], v[244:247], v[92:95]
    v_mfma_f32_16x16x32_bf16 v[96:99], v[214:217], v[244:247], v[96:99]
    s_cmp_eq_u32 s41, 3
    s_cbranch_scc1 L_last
    s_add_u32 s51, s51, 1
    s_cmp_lg_u32 s57, 0
    s_cbranch_scc1 L_begun52
    s_nop 2
L_spin53:
    ds_read_b32 v3, v1 offset:6912
    s_waitcnt lgkmcnt(0)
    v_readfirstlane_b32 s52, v3
    s_nop 0
    s_cmp_ge_u32 s52, s51
    s_cbranch_scc1 L_spun54
    s_sleep 1
    s_branch L_spin53
L_spun54:
    ds_read_b128 v[124:127], v8
    ds_read_b128 v[128:131], v9
    ds_read_b128 v[132:135], v8 offset:128
    ds_read_b128 v[136:139], v9 offset:128
    ds_read_b128 v[140:143], v8 offset:256
    ds_read_b128 v[144:147], v9 offset:256
L_begun52:
    s_waitcnt lgkmcnt(5)
    v_mfma_f32_16x16x32_bf16 v[236:239], v[124:127], v[124:127], 0
    v_mfma_f32_16x16x32_bf16 v[4:7], v[124:127], v[100:103], 0
    ds_read_b64_tr_b16 v[150:151], v10
    s_waitcnt lgkmcnt(5)
    v_mfma_f32_16x16x32_bf16 v[236:239], v[128:131], v[128:131], v[236:239]
    v_mfma_f32_16x16x32_bf16 v[4:7], v[128:131], v[104:107], v[4:7]
    ds_read_b64_tr_b16 v[156:157], v11
    s_waitcnt lgkmcnt(5)
    v_mfma_f32_16x16x32_bf16 v[236:239], v[132:135], v[132:135], v[236:239]
    ds_read_b64_tr_b16 v[162:163], v12
    v_mfma_f32_16x16x32_bf16 v[4:7], v[132:135], v[108:111], v[4:7]
    ds_read_b64_tr_b16 v[168:169], v13
    s_waitcnt lgkmcnt(6)
    v_mfma_f32_16x16x32_bf16 v[236:239], v[136:139], v[136:139], v[236:239]
    ds_read_b64_tr_b16 v[174:175], v10 offset:128
    v_mfma_f32_16x16x32_bf16 v[4:7], v[136:139], v[112:115], v[4:7]
    ds_read_b64_tr_b16 v[180:181], v11 offset:128
    s_waitcnt lgkmcnt(7)
    v_mfma_f32_16x16x32_bf16 v[236:239], v[140:143], v[140:143], v[236:239]
    ds_read_b64_tr_b16 v[186:187], v12 offset:128
    v_mfma_f32_16x16x32_bf16 v[4:7], v[140:143], v[116:119], v[4:7]
    ds_read_b64_tr_b16 v[192:193], v13 offset:128
    s_waitcnt lgkmcnt(8)
    v_mfma_f32_16x16x32_bf16 v[236:239], v[144:147], v[144:147], v[236:239]
    ds_read_b64_tr_b16 v[198:199], v10 offset:256
    v_mfma_f32_16x16x32_bf16 v[4:7], v[144:147], v[120:123], v[4:7]
    ds_read_b64_tr_b16 v[204:205], v11 offset:256
    v_mfma_f32_16x16x32_bf16 v[232:235], v[124:127], v[24:27], v[224:227]
    ds_read_b64_tr_b16 v[210:211], v12 offset:256
    v_mfma_f32_16x16x32_bf16 v[232:235], v[128:131], v[24:27], v[232:235]
    ds_read_b64_tr_b16 v[216:217], v13 offset:256
    s_nop 2
    v_mfma_f32_16x16x32_bf16 v[232:235], v[132:135], v[24:27], v[232:235]
    v_cndmask_b32 v22, v236, v237, s[58:59]
    v_cndmask_b32 v23, v238, v239, s[58:59]
    v_mfma_f32_16x16x32_bf16 v[232:235], v[136:139], v[24:27], v[232:235]
    v_cndmask_b32 v4, v4, v5, s[58:59]
    v_cndmask_b32 v6, v6, v7, s[58:59]
    v_mfma_f32_16x16x32_bf16 v[232:235], v[140:143], v[24:27], v[232:235]
    v_cndmask_b32 v22, v22, v23, s[60:61]
    v_cndmask_b32 v4, v4, v6, s[60:61]
    v_mfma_f32_16x16x32_bf16 v[232:235], v[144:147], v[24:27], v[232:235]
    v_add_f32 v22, v22, v255
    v_fma_f32 v22, v4, 2.0, v22
    v_cndmask_b32 v22, 0, v22, s[38:39]
    v_mfma_f32_16x16x32_bf16 v[228:231], v[124:127], v[28:31], v[220:223]
    s_nop 0
    v_mfma_f32_16x16x4_f32 v[236:239], v22, v20, 0
    v_mfma_f32_16x16x32_bf16 v[228:231], v[128:131], v[32:35], v[228:231]
    v_mfma_f32_16x16x32_bf16 v[228:231], v[132:135], v[36:39], v[228:231]
    v_mul_f32 v232, s44, v232
    v_mul_f32 v233, s44, v233
    v_mfma_f32_16x16x32_bf16 v[228:231], v[136:139], v[40:43], v[228:231]
    v_mul_f32 v234, s44, v234
    v_mul_f32 v235, s44, v235
    v_mfma_f32_16x16x32_bf16 v[228:231], v[140:143], v[44:47], v[228:231]
    v_fma_f32 v4, -v232, v232, s46
    v_fma_f32 v5, -v233, v233, s46
    v_mfma_f32_16x16x32_bf16 v[228:231], v[144:147], v[48:51], v[228:231]
    v_fma_f32 v6, -v234, v234, s46
    v_fma_f32 v7, -v235, v235, s46
    ds_read_b32 v3, v1 offset:6912
    v_mov_b32 v2, s51
    s_add_u32 s54, s54, 1
    s_cmp_eq_u32 s54, 6
    s_cselect_b32 s55, 0xffff8800, s56
    s_cselect_b32 s54, 0, s54
    v_add_u32 v8, s55, v8
    v_add_u32 v9, s55, v9
    v_add_u32 v10, s55, v10
    v_add_u32 v11, s55, v11
    v_add_u32 v12, s55, v12
    v_add_u32 v13, s55, v13
    s_waitcnt lgkmcnt(0)
    ds_write_b32 v1, v2 offset:6928
    v_readfirstlane_b32 s52, v3
    s_mov_b32 s57, 0
    s_nop 0
    s_cmp_gt_u32 s52, s51
    s_cbranch_scc0 L_early55
    s_mov_b32 s57, 1
    ds_read_b128 v[100:103], v8
    ds_read_b128 v[104:107], v9
    ds_read_b128 v[108:111], v8 offset:128
    ds_read_b128 v[112:115], v9 offset:128
    ds_read_b128 v[116:119], v8 offset:256
    ds_read_b128 v[120:123], v9 offset:256
L_early55:
    v_fma_f32 v236, v236, s44, v4
    v_fma_f32 v237, v237, s44, v5
    v_fma_f32 v238, v238, s44, v6
    v_fma_f32 v239, v239, s44, v7
    v_max_f32 v236, s46, v236
    v_max_f32 v237, s46, v237
    v_max_f32 v238, s46, v238
    v_max_f32 v239, s46, v239
    v_rsq_f32 v236, v236
    v_rsq_f32 v237, v237
    v_rsq_f32 v238, v238
    v_rsq_f32 v239, v239
    v_pk_fma_f32 v[228:229], v[232:233], v[16:17], v[228:229] neg_lo:[1,0,0] neg_hi:[1,0,0]
    v_pk_fma_f32 v[230:231], v[234:235], v[16:17], v[230:231] neg_lo:[1,0,0] neg_hi:[1,0,0]
    v_pk_fma_f32 v[4:5], v[228:229], v[236:237], v[18:19]
    v_pk_fma_f32 v[6:7], v[230:231], v[238:239], v[18:19]
    v_max3_f32 v21, v4, v5, v6
    v_max_f32 v21, v21, v7
    v_cmp_lt_f32 vcc, s50, v21
    s_cbranch_vccz L_sm56
    s_call_b64 s[48:49], L_rescale
L_sm56:
    v_exp_f32 v4, v4
    v_exp_f32 v5, v5
    v_exp_f32 v6, v6
    v_exp_f32 v7, v7
    v_pk_mul_f32 v[228:229], v[4:5], v[236:237]
    v_pk_add_f32 v[14:15], v[14:15], v[4:5]
    v_pk_mul_f32 v[230:231], v[6:7], v[238:239]
    v_pk_add_f32 v[14:15], v[14:15], v[6:7]
    v_pk_add_f32 v[240:241], v[240:241], v[228:229]
    v_pk_add_f32 v[242:243], v[242:243], v[230:231]
    v_pk_mul_f32 v[252:253], v[228:229], v[232:233]
    v_pk_fma_f32 v[252:253], v[230:231], v[234:235], v[252:253]
    v_cvt_pk_bf16_f32 v244, v228, v229
    v_cvt_pk_bf16_f32 v245, v230, v231
    v_cvt_pk_bf16_f32 v246, v240, v241
    v_cvt_pk_bf16_f32 v247, v242, v243
    s_add_u32 s41, s41, 1
    s_nop 0
    s_branch L_loop
L_last:
    s_setprio 2
    v_and_b32 v22, 15, v0
    v_lshrrev_b32 v23, 4, v0
    v_lshlrev_b32 v148, 4, v0
    v_lshlrev_b32 v23, 2, v23
    v_add_u32 v148, s36, v148
    v_lshl_add_u32 v149, v22, 4, v23
    v_add_u32 v149, s36, v149
    s_add_u32 s51, s51, 1
    s_cmp_lg_u32 s57, 0
    s_cbranch_scc1 L_begun57
L_spin58:
    ds_read_b32 v3, v1 offset:6912
    s_waitcnt lgkmcnt(0)
    v_readfirstlane_b32 s52, v3
    s_nop 0
    s_cmp_ge_u32 s52, s51
    s_cbranch_scc0 L_spin58
    ds_read_b128 v[124:127], v8
    ds_read_b128 v[128:131], v9
    ds_read_b128 v[132:135], v8 offset:128
    ds_read_b128 v[136:139], v9 offset:128
    ds_read_b128 v[140:143], v8 offset:256
    ds_read_b128 v[144:147], v9 offset:256
L_begun57:
    s_waitcnt lgkmcnt(5)
    v_mfma_f32_16x16x32_bf16 v[236:239], v[124:127], v[124:127], 0
    v_mfma_f32_16x16x32_bf16 v[4:7], v[124:127], v[100:103], 0
    ds_read_b64_tr_b16 v[150:151], v10
    s_waitcnt lgkmcnt(5)
    v_mfma_f32_16x16x32_bf16 v[236:239], v[128:131], v[128:131], v[236:239]
    v_mfma_f32_16x16x32_bf16 v[4:7], v[128:131], v[104:107], v[4:7]
    ds_read_b64_tr_b16 v[156:157], v11
    s_waitcnt lgkmcnt(5)
    v_mfma_f32_16x16x32_bf16 v[236:239], v[132:135], v[132:135], v[236:239]
    ds_read_b64_tr_b16 v[162:163], v12
    v_mfma_f32_16x16x32_bf16 v[4:7], v[132:135], v[108:111], v[4:7]
    ds_read_b64_tr_b16 v[168:169], v13
    s_waitcnt lgkmcnt(6)
    v_mfma_f32_16x16x32_bf16 v[236:239], v[136:139], v[136:139], v[236:239]
    ds_read_b64_tr_b16 v[174:175], v10 offset:128
    v_mfma_f32_16x16x32_bf16 v[4:7], v[136:139], v[112:115], v[4:7]
    ds_read_b64_tr_b16 v[180:181], v11 offset:128
    s_waitcnt lgkmcnt(7)
    v_mfma_f32_16x16x32_bf16 v[236:239], v[140:143], v[140:143], v[236:239]
    ds_read_b64_tr_b16 v[186:187], v12 offset:128
    v_mfma_f32_16x16x32_bf16 v[4:7], v[140:143], v[116:119], v[4:7]
    ds_read_b64_tr_b16 v[192:193], v13 offset:128
    s_waitcnt lgkmcnt(8)
    v_mfma_f32_16x16x32_bf16 v[236:239], v[144:147], v[144:147], v[236:239]
    ds_read_b64_tr_b16 v[198:199], v10 offset:256
    v_mfma_f32_16x16x32_bf16 v[4:7], v[144:147], v[120:123], v[4:7]
    ds_read_b64_tr_b16 v[204:205], v11 offset:256
    v_mfma_f32_16x16x32_bf16 v[232:235], v[124:127], v[24:27], v[224:227]
    ds_read_b64_tr_b16 v[210:211], v12 offset:256
    v_mfma_f32_16x16x32_bf16 v[232:235], v[128:131], v[24:27], v[232:235]
    ds_read_b64_tr_b16 v[216:217], v13 offset:256
    s_nop 2
    v_mfma_f32_16x16x32_bf16 v[232:235], v[132:135], v[24:27], v[232:235]
    v_cndmask_b32 v22, v236, v237, s[58:59]
    v_cndmask_b32 v23, v238, v239, s[58:59]
    v_mfma_f32_16x16x32_bf16 v[232:235], v[136:139], v[24:27], v[232:235]
    v_cndmask_b32 v4, v4, v5, s[58:59]
    v_cndmask_b32 v6, v6, v7, s[58:59]
    v_mfma_f32_16x16x32_bf16 v[232:235], v[140:143], v[24:27], v[232:235]
    v_cndmask_b32 v22, v22, v23, s[60:61]
    v_cndmask_b32 v4, v4, v6, s[60:61]
    v_mfma_f32_16x16x32_bf16 v[232:235], v[144:147], v[24:27], v[232:235]
    v_add_f32 v22, v22, v255
    v_fma_f32 v22, v4, 2.0, v22
    v_cndmask_b32 v22, 0, v22, s[38:39]
    v_mfma_f32_16x16x32_bf16 v[228:231], v[124:127], v[28:31], v[220:223]
    s_nop 0
    v_mfma_f32_16x16x4_f32 v[236:239], v22, v20, 0
    v_mfma_f32_16x16x32_bf16 v[228:231], v[128:131], v[32:35], v[228:231]
    v_mfma_f32_16x16x32_bf16 v[228:231], v[132:135], v[36:39], v[228:231]
    v_mul_f32 v232, s44, v232
    v_mul_f32 v233, s44, v233
    v_mfma_f32_16x16x32_bf16 v[228:231], v[136:139], v[40:43], v[228:231]
    v_mul_f32 v234, s44, v234
    v_mul_f32 v235, s44, v235
    v_mfma_f32_16x16x32_bf16 v[228:231], v[140:143], v[44:47], v[228:231]
    v_fma_f32 v4, -v232, v232, s46
    v_fma_f32 v5, -v233, v233, s46
    v_mfma_f32_16x16x32_bf16 v[228:231], v[144:147], v[48:51], v[228:231]
    v_fma_f32 v6, -v234, v234, s46
    v_fma_f32 v7, -v235, v235, s46
    s_waitcnt lgkmcnt(0)
    v_fma_f32 v236, v236, s44, v4
    v_fma_f32 v237, v237, s44, v5
    v_fma_f32 v238, v238, s44, v6
    v_fma_f32 v239, v239, s44, v7
    v_max_f32 v236, s46, v236
    v_max_f32 v237, s46, v237
    v_max_f32 v238, s46, v238
    v_max_f32 v239, s46, v239
    v_rsq_f32 v236, v236
    v_rsq_f32 v237, v237
    v_rsq_f32 v238, v238
    v_rsq_f32 v239, v239
    v_pk_fma_f32 v[228:229], v[232:233], v[16:17], v[228:229] neg_lo:[1,0,0] neg_hi:[1,0,0]
    v_pk_fma_f32 v[230:231], v[234:235], v[16:17], v[230:231] neg_lo:[1,0,0] neg_hi:[1,0,0]
    v_pk_fma_f32 v[4:5], v[228:229], v[236:237], v[18:19]
    v_pk_fma_f32 v[6:7], v[230:231], v[238:239], v[18:19]
    v_max3_f32 v21, v4, v5, v6
    v_max_f32 v21, v21, v7
    v_cmp_lt_f32 vcc, s50, v21
    s_cbranch_vccz L_sm60
    s_call_b64 s[48:49], L_rescale
L_sm60:
    v_exp_f32 v4, v4
    v_exp_f32 v5, v5
    v_exp_f32 v6, v6
    v_exp_f32 v7, v7
    v_pk_mul_f32 v[228:229], v[4:5], v[236:237]
    v_pk_mul_f32 v[230:231], v[6:7], v[238:239]
    v_pk_add_f32 v[240:241], v[240:241], v[228:229]
    v_pk_add_f32 v[242:243], v[242:243], v[230:231]
    v_cvt_pk_bf16_f32 v244, v228, v229
    v_cvt_pk_bf16_f32 v245, v230, v231
    v_cvt_pk_bf16_f32 v246, v240, v241
    v_cvt_pk_bf16_f32 v247, v242, v243
    s_nop 1
    v_mfma_f32_16x16x32_bf16 v[52:55], v[150:153], v[244:247], v[52:55]
    v_cmp_neq_f32 vcc, 0, v254
    v_add_f32 v4, v4, v5
    v_add_f32 v6, v6, v7
    v_mfma_f32_16x16x32_bf16 v[56:59], v[156:159], v[244:247], v[56:59]
    v_add_f32 v14, v14, v15
    v_add_f32 v4, v4, v6
    ds_write_b32 v149, v254 offset:12800
    v_mfma_f32_16x16x32_bf16 v[60:63], v[162:165], v[244:247], v[60:63]
    v_add_f32 v14, v14, v4
    s_cmp_eq_u64 vcc, 0
    s_cselect_b32 s40, 1, 2
    v_mov_b32 v154, s40
    ds_write_b32 v149, v14 offset:12288
    v_mfma_f32_16x16x32_bf16 v[64:67], v[168:171], v[244:247], v[64:67]
    v_cvt_pk_bf16_f32 v100, v52, v53
    v_cvt_pk_bf16_f32 v101, v54, v55
    v_mfma_f32_16x16x32_bf16 v[68:71], v[174:177], v[244:247], v[68:71]
    v_cvt_pk_bf16_f32 v102, v56, v57
    v_cvt_pk_bf16_f32 v103, v58, v59
    ds_write_b128 v148, v[100:103]
    v_mfma_f32_16x16x32_bf16 v[72:75], v[180:183], v[244:247], v[72:75]
    v_cvt_pk_bf16_f32 v104, v60, v61
    v_cvt_pk_bf16_f32 v105, v62, v63
    v_mfma_f32_16x16x32_bf16 v[76:79], v[186:189], v[244:247], v[76:79]
    v_cvt_pk_bf16_f32 v106, v64, v65
    v_cvt_pk_bf16_f32 v107, v66, v67
    ds_write_b128 v148, v[104:107] offset:1024
    v_mfma_f32_16x16x32_bf16 v[80:83], v[192:195], v[244:247], v[80:83]
    v_cvt_pk_bf16_f32 v108, v68, v69
    v_cvt_pk_bf16_f32 v109, v70, v71
    v_mfma_f32_16x16x32_bf16 v[84:87], v[198:201], v[244:247], v[84:87]
    v_cvt_pk_bf16_f32 v110, v72, v73
    v_cvt_pk_bf16_f32 v111, v74, v75
    ds_write_b128 v148, v[108:111] offset:2048
    v_mfma_f32_16x16x32_bf16 v[88:91], v[204:207], v[244:247], v[88:91]
    v_cvt_pk_bf16_f32 v112, v76, v77
    v_cvt_pk_bf16_f32 v113, v78, v79
    v_mfma_f32_16x16x32_bf16 v[92:95], v[210:213], v[244:247], v[92:95]
    v_cvt_pk_bf16_f32 v114, v80, v81
    v_cvt_pk_bf16_f32 v115, v82, v83
    ds_write_b128 v148, v[112:115] offset:3072
    v_mfma_f32_16x16x32_bf16 v[96:99], v[216:219], v[244:247], v[96:99]
    v_cvt_pk_bf16_f32 v116, v84, v85
    v_cvt_pk_bf16_f32 v117, v86, v87
    v_cvt_pk_bf16_f32 v118, v88, v89
    v_cvt_pk_bf16_f32 v119, v90, v91
    ds_write_b128 v148, v[116:119] offset:4096
    v_cvt_pk_bf16_f32 v120, v92, v93
    v_cvt_pk_bf16_f32 v121, v94, v95
    s_nop 0
    v_cvt_pk_bf16_f32 v122, v96, v97
    v_cvt_pk_bf16_f32 v123, v98, v99
    ds_write_b128 v148, v[120:123] offset:5120
    ds_write_b32 v1, v154 offset:6992
    s_setprio 0
    s_cmp_lt_u32 s2, 0x80
    s_cbranch_scc1 L_r_end
    s_sub_u32 s53, s2, 0x80
    s_and_b32 s40, s53, 7
    s_lshr_b32 s42, s53, 4
    s_lshl_b32 s42, s42, 3
    s_or_b32 s40, s40, s42
    s_lshl_b32 s40, s40, 1
    s_bfe_u32 s42, s53, 0x10003
    s_or_b32 s53, s40, s42
    s_mov_b32 s24, s4
    s_mov_b32 s25, s5
    s_mov_b32 s26, 0x1800
    s_mov_b32 s27, 0x20000
    s_mov_b32 s28, s18
    s_mov_b32 s29, s19
    s_mov_b32 s30, 0x1800
    s_mov_b32 s31, 0x20000
    v_and_b32 v28, 3, v0
    v_lshrrev_b32 v29, 2, v0
    v_lshlrev_b32 v30, 15, v29
    v_lshl_add_u32 v30, v28, 4, v30
    v_lshlrev_b32 v32, 2, v28
    ds_read_b32 v38, v32 offset:7040
    s_lshl_b32 s40, s3, 19
    s_lshl_b32 s42, s53, 6
    s_add_u32 s40, s40, s42
    s_and_b32 s42, s53, 3
    s_mul_i32 s42, s42, 0x600
    v_mul_u32_u24 v31, 0x180, v28
    v_add_u32 v31, s42, v31
    s_lshr_b32 s42, s53, 5
    s_mul_i32 s6, s42, 0x60
    s_bfe_u32 s42, s53, 0x20002
    s_lshl_b32 s42, s42, 3
    s_add_u32 s6, s6, s42
    s_bitcmp1_b32 s53, 4
    s_cselect_b32 s4, 36, 0
    s_cselect_b32 s5, 64, 4
    s_cselect_b32 s42, 0x44, 32
    s_add_u32 s4, s4, s6
    s_add_u32 s5, s5, s6
    s_add_u32 s6, s6, s42
    buffer_load_dword v56, v31, s[24:27], s4 offen
    buffer_load_dword v57, v31, s[24:27], s5 offen
    buffer_load_dword v58, v31, s[24:27], s6 offen
    v_lshrrev_b32 v32, 4, v0
    v_lshlrev_b32 v34, 7, v32
    v_lshl_add_u32 v34, v28, 5, v34
    s_lshl_b32 s42, s3, 9
    s_add_u32 s42, s42, 0x9400
    v_add_u32 v34, s42, v34
    v_and_b32 v35, 15, v0
    v_lshlrev_b32 v35, 5, v35
    v_mov_b32 v32, 0
    v_mov_b32 v60, 0
    v_mov_b32 v61, 0
    v_mov_b32 v62, 0
    v_mov_b32 v63, 0
    v_mov_b32 v64, 0
    v_mov_b32 v65, 0
    v_mov_b32 v66, 0
    v_mov_b32 v67, 0
    v_mov_b32 v37, 0
    s_mov_b64 s[44:45], -1
    s_mov_b64 s[46:47], -1
    s_mov_b64 s[58:59], -1
    s_mov_b64 s[60:61], -1
    s_mov_b32 s38, 0x3f80
    s_mov_b32 s39, 0x3f800000
    s_waitcnt vmcnt(0) lgkmcnt(0)
    v_lshlrev_b32 v120, 16, v56
    v_and_b32 v121, 0xffff0000, v56
    v_lshlrev_b32 v122, 16, v57
    v_and_b32 v123, 0xffff0000, v57
    v_lshlrev_b32 v124, 16, v58
    v_and_b32 v125, 0xffff0000, v58
    s_nop 1
L_spin61:
    ds_read_b32 v33, v32 offset:6964
    s_waitcnt lgkmcnt(0)
    v_readfirstlane_b32 s42, v33
    s_nop 0
    s_cmp_ge_u32 s42, 4
    s_cbranch_scc1 L_spun62
    s_sleep 1
    s_branch L_spin61
L_spun62:
    s_mov_b64 exec, 0x1111
L_tpre:
    buffer_load_dword v32, v30, s[32:35], s40 offen offset:12 sc1
    s_waitcnt vmcnt(0)
    v_xor_b32 v32, v32, v38
    v_and_b32 v32, 0xfffe, v32
    v_cmp_ne_u32 vcc, 0, v32
    s_cbranch_vccnz L_tpre
    s_mov_b64 exec, -1
    s_nop 2
L_tpoll:
    s_add_u32 s42, s40, 0
    s_cmp_eq_u64 s[44:45], 0
    s_cbranch_scc1 L_tskip63
    s_mov_b64 exec, s[44:45]
    buffer_load_dwordx4 v[40:43], v30, s[32:35], s42 offen sc1
L_tskip63:
    s_add_u32 s42, s40, 0x2000
    s_cmp_eq_u64 s[46:47], 0
    s_cbranch_scc1 L_tskip64
    s_mov_b64 exec, s[46:47]
    buffer_load_dwordx4 v[44:47], v30, s[32:35], s42 offen sc1
L_tskip64:
    s_add_u32 s42, s40, 0x4000
    s_cmp_eq_u64 s[58:59], 0
    s_cbranch_scc1 L_tskip65
    s_mov_b64 exec, s[58:59]
    buffer_load_dwordx4 v[48:51], v30, s[32:35], s42 offen sc1
L_tskip65:
    s_add_u32 s42, s40, 0x6000
    s_cmp_eq_u64 s[60:61], 0
    s_cbranch_scc1 L_tskip66
    s_mov_b64 exec, s[60:61]
    buffer_load_dwordx4 v[52:55], v30, s[32:35], s42 offen sc1
L_tskip66:
    s_waitcnt vmcnt(0)
    s_cmp_eq_u64 s[44:45], 0
    s_cbranch_scc1 L_tchk67
    s_mov_b64 exec, s[44:45]
    v_xor_b32 v36, v43, v38
    v_and_b32 v32, 0xfffe, v36
    v_and_b32 v33, 0xffff0000, v43
    s_nop 2
    v_or_b32_dpp v32, v32, v32 quad_perm:[1,0,3,2] row_mask:0xf bank_mask:0xf
    s_nop 2
    v_or_b32_dpp v32, v32, v32 quad_perm:[2,3,0,1] row_mask:0xf bank_mask:0xf
    v_cmp_eq_u32 vcc, 0, v32
    s_nop 0
    s_andn2_b64 s[44:45], s[44:45], vcc
    s_and_b64 exec, vcc, vcc
    s_cbranch_scc0 L_tchk67
    v_dot2_f32_bf16 v60, v40, s38, v60
    v_dot2_f32_bf16 v61, v40, s39, v61
    v_dot2_f32_bf16 v62, v41, s38, v62
    v_dot2_f32_bf16 v63, v41, s39, v63
    v_dot2_f32_bf16 v64, v42, s38, v64
    v_dot2_f32_bf16 v65, v42, s39, v65
    v_add_f32 v66, v66, v33
    v_or_b32 v37, v37, v36
L_tchk67:
    s_cmp_eq_u64 s[46:47], 0
    s_cbranch_scc1 L_tchk68
    s_mov_b64 exec, s[46:47]
    v_xor_b32 v36, v47, v38
    v_and_b32 v32, 0xfffe, v36
    v_and_b32 v33, 0xffff0000, v47
    s_nop 2
    v_or_b32_dpp v32, v32, v32 quad_perm:[1,0,3,2] row_mask:0xf bank_mask:0xf
    s_nop 2
    v_or_b32_dpp v32, v32, v32 quad_perm:[2,3,0,1] row_mask:0xf bank_mask:0xf
    v_cmp_eq_u32 vcc, 0, v32
    s_nop 0
    s_andn2_b64 s[46:47], s[46:47], vcc
    s_and_b64 exec, vcc, vcc
    s_cbranch_scc0 L_tchk68
    v_dot2_f32_bf16 v60, v44, s38, v60
    v_dot2_f32_bf16 v61, v44, s39, v61
    v_dot2_f32_bf16 v62, v45, s38, v62
    v_dot2_f32_bf16 v63, v45, s39, v63
    v_dot2_f32_bf16 v64, v46, s38, v64
    v_dot2_f32_bf16 v65, v46, s39, v65
    v_add_f32 v66, v66, v33
    v_or_b32 v37, v37, v36
L_tchk68:
    s_cmp_eq_u64 s[58:59], 0
    s_cbranch_scc1 L_tchk69
    s_mov_b64 exec, s[58:59]
    v_xor_b32 v36, v51, v38
    v_and_b32 v32, 0xfffe, v36
    v_and_b32 v33, 0xffff0000, v51
    s_nop 2
    v_or_b32_dpp v32, v32, v32 quad_perm:[1,0,3,2] row_mask:0xf bank_mask:0xf
    s_nop 2
    v_or_b32_dpp v32, v32, v32 quad_perm:[2,3,0,1] row_mask:0xf bank_mask:0xf
    v_cmp_eq_u32 vcc, 0, v32
    s_nop 0
    s_andn2_b64 s[58:59], s[58:59], vcc
    s_and_b64 exec, vcc, vcc
    s_cbranch_scc0 L_tchk69
    v_dot2_f32_bf16 v60, v48, s38, v60
    v_dot2_f32_bf16 v61, v48, s39, v61
    v_dot2_f32_bf16 v62, v49, s38, v62
    v_dot2_f32_bf16 v63, v49, s39, v63
    v_dot2_f32_bf16 v64, v50, s38, v64
    v_dot2_f32_bf16 v65, v50, s39, v65
    v_add_f32 v66, v66, v33
    v_or_b32 v37, v37, v36
L_tchk69:
    s_cmp_eq_u64 s[60:61], 0
    s_cbranch_scc1 L_tchk70
    s_mov_b64 exec, s[60:61]
    v_xor_b32 v36, v55, v38
    v_and_b32 v32, 0xfffe, v36
    v_and_b32 v33, 0xffff0000, v55
    s_nop 2
    v_or_b32_dpp v32, v32, v32 quad_perm:[1,0,3,2] row_mask:0xf bank_mask:0xf
    s_nop 2
    v_or_b32_dpp v32, v32, v32 quad_perm:[2,3,0,1] row_mask:0xf bank_mask:0xf
    v_cmp_eq_u32 vcc, 0, v32
    s_nop 0
    s_andn2_b64 s[60:61], s[60:61], vcc
    s_and_b64 exec, vcc, vcc
    s_cbranch_scc0 L_tchk70
    v_dot2_f32_bf16 v60, v52, s38, v60
    v_dot2_f32_bf16 v61, v52, s39, v61
    v_dot2_f32_bf16 v62, v53, s38, v62
    v_dot2_f32_bf16 v63, v53, s39, v63
    v_dot2_f32_bf16 v64, v54, s38, v64
    v_dot2_f32_bf16 v65, v54, s39, v65
    v_add_f32 v66, v66, v33
    v_or_b32 v37, v37, v36
L_tchk70:
    s_mov_b64 exec, -1
    s_or_b64 s[56:57], s[44:45], s[46:47]
    s_or_b64 vcc, s[58:59], s[60:61]
    s_or_b64 s[56:57], s[56:57], vcc
    s_cbranch_scc0 L_tfull
    s_mov_b32 s54, 0
    s_bcnt1_i32_b64 s42, s[60:61]
    s_cselect_b32 s55, 0x6000, s55
    s_cselect_b64 s[56:57], s[60:61], s[56:57]
    s_add_u32 s54, s54, s42
    s_bcnt1_i32_b64 s42, s[58:59]
    s_cselect_b32 s55, 0x4000, s55
    s_cselect_b64 s[56:57], s[58:59], s[56:57]
    s_add_u32 s54, s54, s42
    s_bcnt1_i32_b64 s42, s[46:47]
    s_cselect_b32 s55, 0x2000, s55
    s_cselect_b64 s[56:57], s[46:47], s[56:57]
    s_add_u32 s54, s54, s42
    s_bcnt1_i32_b64 s42, s[44:45]
    s_cselect_b32 s55, 0, s55
    s_cselect_b64 s[56:57], s[44:45], s[56:57]
    s_add_u32 s54, s54, s42
    s_cmp_le_u32 s54, 32
    s_cbranch_scc1 L_tpoll
    s_ff1_i32_b64 s42, s[56:57]
    s_lshl_b64 exec, 1, s42
    s_add_u32 s55, s55, s40
L_tprobe:
    buffer_load_dword v32, v30, s[32:35], s55 offen offset:12 sc1
    s_waitcnt vmcnt(0)
    v_xor_b32 v32, v32, v38
    v_and_b32 v32, 0xfffe, v32
    v_cmp_ne_u32 vcc, 0, v32
    s_cbranch_vccnz L_tprobe
    s_mov_b64 exec, -1
    s_branch L_tpoll
    s_nop 1
L_tfull:
    v_and_b32 v32, 1, v37
    v_cmp_ne_u32 vcc, 0, v32
    s_cbranch_vccnz L_tgen
    s_nop 3
L_trows:
    v_add_f32_dpp v60, v60, v60 row_ror:4 row_mask:0xf bank_mask:0xf
    v_add_f32_dpp v61, v61, v61 row_ror:4 row_mask:0xf bank_mask:0xf
    v_add_f32_dpp v62, v62, v62 row_ror:4 row_mask:0xf bank_mask:0xf
    v_add_f32_dpp v63, v63, v63 row_ror:4 row_mask:0xf bank_mask:0xf
    v_add_f32_dpp v64, v64, v64 row_ror:4 row_mask:0xf bank_mask:0xf
    v_add_f32_dpp v65, v65, v65 row_ror:4 row_mask:0xf bank_mask:0xf
    v_add_f32_dpp v66, v66, v66 row_ror:4 row_mask:0xf bank_mask:0xf
    v_add_f32_dpp v60, v60, v60 row_ror:8 row_mask:0xf bank_mask:0xf
    v_add_f32_dpp v61, v61, v61 row_ror:8 row_mask:0xf bank_mask:0xf
    v_add_f32_dpp v62, v62, v62 row_ror:8 row_mask:0xf bank_mask:0xf
    v_add_f32_dpp v63, v63, v63 row_ror:8 row_mask:0xf bank_mask:0xf
    v_add_f32_dpp v64, v64, v64 row_ror:8 row_mask:0xf bank_mask:0xf
    v_add_f32_dpp v65, v65, v65 row_ror:8 row_mask:0xf bank_mask:0xf
    v_add_f32_dpp v66, v66, v66 row_ror:8 row_mask:0xf bank_mask:0xf
    s_mov_b32 s46, 0xf000f
    s_mov_b32 s47, 0xf000f
    s_mov_b64 exec, s[46:47]
    ds_write_b128 v34, v[60:63]
    ds_write_b128 v34, v[64:67] offset:16
    s_mov_b64 exec, -1
    s_waitcnt lgkmcnt(0)
    s_barrier
    s_cmp_lg_u32 s3, 0
    s_cbranch_scc1 L_r_end
    ds_read_b128 v[84:87], v35 offset:37904
    ds_read_b128 v[92:95], v35 offset:38416
    ds_read_b128 v[100:103], v35 offset:38928
    ds_read_b128 v[108:111], v35 offset:39440
    ds_read_b128 v[80:83], v35 offset:37888
    ds_read_b128 v[88:91], v35 offset:38400
    ds_read_b128 v[96:99], v35 offset:38912
    ds_read_b128 v[104:107], v35 offset:39424
    s_waitcnt lgkmcnt(4)
    v_or3_b32 v32, v87, v95, v103
    v_or_b32 v32, v32, v111
    v_cmp_ne_u32 vcc, 0, v32
    s_cbranch_vccnz L_fgen
    s_nop 3
L_fsum:
    v_pk_add_f32 v[66:67], v[86:87], v[94:95]
    v_pk_add_f32 v[102:103], v[102:103], v[110:111]
    v_pk_add_f32 v[64:65], v[84:85], v[92:93]
    v_pk_add_f32 v[100:101], v[100:101], v[108:109]
    s_waitcnt lgkmcnt(0)
    v_pk_add_f32 v[60:61], v[80:81], v[88:89]
    v_pk_add_f32 v[96:97], v[96:97], v[104:105]
    v_pk_add_f32 v[62:63], v[82:83], v[90:91]
    v_pk_add_f32 v[98:99], v[98:99], v[106:107]
    v_pk_add_f32 v[66:67], v[66:67], v[102:103]
    v_pk_add_f32 v[64:65], v[64:65], v[100:101]
    v_pk_add_f32 v[60:61], v[60:61], v[96:97]
    v_pk_add_f32 v[62:63], v[62:63], v[98:99]
    v_add_f32_dpp v66, v66, v66 row_ror:4 row_mask:0xf bank_mask:0xf
    v_add_f32_dpp v60, v60, v60 row_ror:4 row_mask:0xf bank_mask:0xf
    v_add_f32_dpp v61, v61, v61 row_ror:4 row_mask:0xf bank_mask:0xf
    v_add_f32_dpp v62, v62, v62 row_ror:4 row_mask:0xf bank_mask:0xf
    v_add_f32_dpp v63, v63, v63 row_ror:4 row_mask:0xf bank_mask:0xf
    v_add_f32_dpp v64, v64, v64 row_ror:4 row_mask:0xf bank_mask:0xf
    v_add_f32_dpp v65, v65, v65 row_ror:4 row_mask:0xf bank_mask:0xf
    v_add_f32_dpp v66, v66, v66 row_ror:8 row_mask:0xf bank_mask:0xf
    v_add_f32_dpp v60, v60, v60 row_ror:8 row_mask:0xf bank_mask:0xf
    v_add_f32_dpp v61, v61, v61 row_ror:8 row_mask:0xf bank_mask:0xf
    v_rcp_f32 v66, v66
    v_add_f32_dpp v62, v62, v62 row_ror:8 row_mask:0xf bank_mask:0xf
    v_add_f32_dpp v63, v63, v63 row_ror:8 row_mask:0xf bank_mask:0xf
    v_add_f32_dpp v64, v64, v64 row_ror:8 row_mask:0xf bank_mask:0xf
    v_add_f32_dpp v65, v65, v65 row_ror:8 row_mask:0xf bank_mask:0xf
    v_pk_mul_f32 v[60:61], v[60:61], v[66:67] op_sel_hi:[1,0]
    v_pk_mul_f32 v[62:63], v[62:63], v[66:67] op_sel_hi:[1,0]
    v_pk_mul_f32 v[64:65], v[64:65], v[66:67] op_sel_hi:[1,0]
    v_cvt_pk_bf16_f32 v56, v60, v61
    v_cvt_pk_bf16_f32 v57, v62, v63
    v_cvt_pk_bf16_f32 v58, v64, v65
    v_lshlrev_b32 v60, 16, v56
    v_and_b32 v61, 0xffff0000, v56
    v_lshlrev_b32 v62, 16, v57
    v_and_b32 v63, 0xffff0000, v57
    v_lshlrev_b32 v64, 16, v58
    v_and_b32 v65, 0xffff0000, v58
    v_pk_add_f32 v[60:61], v[60:61], v[120:121]
    v_pk_add_f32 v[62:63], v[62:63], v[122:123]
    v_pk_add_f32 v[64:65], v[64:65], v[124:125]
    s_mov_b64 exec, 15
    v_cvt_pk_bf16_f32 v56, v60, v61
    buffer_store_dword v56, v31, s[28:31], s4 offen
    v_cvt_pk_bf16_f32 v57, v62, v63
    buffer_store_dword v57, v31, s[28:31], s5 offen
    v_cvt_pk_bf16_f32 v58, v64, v65
    buffer_store_dword v58, v31, s[28:31], s6 offen
    s_mov_b64 exec, -1
L_r_end:
    s_endpgm
L_tgen:
    s_nop 3
    v_mov_b32 v32, 0
    ds_read_b64 v[72:73], v32 offset:7040
    v_lshlrev_b32 v71, 9, v29
    v_lshl_add_u32 v71, v28, 3, v71
    s_and_b32 s42, s53, 3
    s_lshl_b32 s42, s42, 5
    s_lshl_b32 s55, s3, 13
    s_add_u32 s55, s55, s42
    s_add_u32 s55, s55, 0x400000
    s_waitcnt lgkmcnt(0)
    v_lshl_or_b32 v70, v73, 16, v72
    v_mov_b32 v112, 0
    v_and_b32 v32, 1, v43
    v_cmp_ne_u32 vcc, 0, v32
    s_nop 0
    s_and_b64 exec, vcc, vcc
    s_cbranch_scc0 L_tg0e
    s_nop 1
L_tg0:
    buffer_load_dwordx2 v[112:113], v71, s[32:35], s55 offen sc1
    s_waitcnt vmcnt(0)
    v_cmp_ne_u32 vcc, v113, v70
    s_cbranch_vccnz L_tg0
L_tg0e:
    s_mov_b64 exec, -1
    v_mov_b32 v114, 0
    v_and_b32 v32, 1, v47
    v_cmp_ne_u32 vcc, 0, v32
    s_nop 0
    s_and_b64 exec, vcc, vcc
    s_cbranch_scc0 L_tg1e
    s_nop 1
L_tg1:
    buffer_load_dwordx2 v[114:115], v71, s[32:35], s55 offen offset:128 sc1
    s_waitcnt vmcnt(0)
    v_cmp_ne_u32 vcc, v115, v70
    s_cbranch_vccnz L_tg1
L_tg1e:
    s_mov_b64 exec, -1
    v_mov_b32 v116, 0
    v_and_b32 v32, 1, v51
    v_cmp_ne_u32 vcc, 0, v32
    s_nop 0
    s_and_b64 exec, vcc, vcc
    s_cbranch_scc0 L_tg2e
    s_nop 1
L_tg2:
    buffer_load_dwordx2 v[116:117], v71, s[32:35], s55 offen offset:256 sc1
    s_waitcnt vmcnt(0)
    v_cmp_ne_u32 vcc, v117, v70
    s_cbranch_vccnz L_tg2
L_tg2e:
    s_mov_b64 exec, -1
    v_mov_b32 v118, 0
    v_and_b32 v32, 1, v55
    v_cmp_ne_u32 vcc, 0, v32
    s_nop 0
    s_and_b64 exec, vcc, vcc
    s_cbranch_scc0 L_tg3e
    s_nop 1
L_tg3:
    buffer_load_dwordx2 v[118:119], v71, s[32:35], s55 offen offset:384 sc1
    s_waitcnt vmcnt(0)
    v_cmp_ne_u32 vcc, v119, v70
    s_cbranch_vccnz L_tg3
L_tg3e:
    s_mov_b64 exec, -1
    v_max3_f32 v67, v112, v114, v116
    v_max_f32 v67, v67, v118
    s_nop 1
    v_max_f32_dpp v67, v67, v67 row_ror:4 row_mask:0xf bank_mask:0xf
    s_nop 1
    v_max_f32_dpp v67, v67, v67 row_ror:8 row_mask:0xf bank_mask:0xf
    v_mov_b32 v32, v67
    v_mov_b32 v33, v67
    s_nop 1
    v_permlane32_swap_b32 v32, v33
    v_max_f32 v67, v32, v33
    v_mov_b32 v32, v67
    v_mov_b32 v33, v67
    s_nop 1
    v_permlane16_swap_b32 v32, v33
    v_max_f32 v67, v32, v33
    v_mov_b32 v60, 0
    v_mov_b32 v61, 0
    v_mov_b32 v62, 0
    v_mov_b32 v63, 0
    v_mov_b32 v64, 0
    v_mov_b32 v65, 0
    v_mov_b32 v66, 0
    v_sub_f32 v36, v112, v67
    v_exp_f32 v36, v36
    v_lshlrev_b32 v32, 16, v40
    v_fmac_f32 v60, v36, v32
    v_and_b32 v32, 0xffff0000, v40
    v_fmac_f32 v61, v36, v32
    v_lshlrev_b32 v32, 16, v41
    v_fmac_f32 v62, v36, v32
    v_and_b32 v32, 0xffff0000, v41
    v_fmac_f32 v63, v36, v32
    v_lshlrev_b32 v32, 16, v42
    v_fmac_f32 v64, v36, v32
    v_and_b32 v32, 0xffff0000, v42
    v_fmac_f32 v65, v36, v32
    v_and_b32 v32, 0xffff0000, v43
    v_fmac_f32 v66, v36, v32
    v_sub_f32 v36, v114, v67
    v_exp_f32 v36, v36
    v_lshlrev_b32 v32, 16, v44
    v_fmac_f32 v60, v36, v32
    v_and_b32 v32, 0xffff0000, v44
    v_fmac_f32 v61, v36, v32
    v_lshlrev_b32 v32, 16, v45
    v_fmac_f32 v62, v36, v32
    v_and_b32 v32, 0xffff0000, v45
    v_fmac_f32 v63, v36, v32
    v_lshlrev_b32 v32, 16, v46
    v_fmac_f32 v64, v36, v32
    v_and_b32 v32, 0xffff0000, v46
    v_fmac_f32 v65, v36, v32
    v_and_b32 v32, 0xffff0000, v47
    v_fmac_f32 v66, v36, v32
    v_sub_f32 v36, v116, v67
    v_exp_f32 v36, v36
    v_lshlrev_b32 v32, 16, v48
    v_fmac_f32 v60, v36, v32
    v_and_b32 v32, 0xffff0000, v48
    v_fmac_f32 v61, v36, v32
    v_lshlrev_b32 v32, 16, v49
    v_fmac_f32 v62, v36, v32
    v_and_b32 v32, 0xffff0000, v49
    v_fmac_f32 v63, v36, v32
    v_lshlrev_b32 v32, 16, v50
    v_fmac_f32 v64, v36, v32
    v_and_b32 v32, 0xffff0000, v50
    v_fmac_f32 v65, v36, v32
    v_and_b32 v32, 0xffff0000, v51
    v_fmac_f32 v66, v36, v32
    v_sub_f32 v36, v118, v67
    v_exp_f32 v36, v36
    v_lshlrev_b32 v32, 16, v52
    v_fmac_f32 v60, v36, v32
    v_and_b32 v32, 0xffff0000, v52
    v_fmac_f32 v61, v36, v32
    v_lshlrev_b32 v32, 16, v53
    v_fmac_f32 v62, v36, v32
    v_and_b32 v32, 0xffff0000, v53
    v_fmac_f32 v63, v36, v32
    v_lshlrev_b32 v32, 16, v54
    v_fmac_f32 v64, v36, v32
    v_and_b32 v32, 0xffff0000, v54
    v_fmac_f32 v65, v36, v32
    v_and_b32 v32, 0xffff0000, v55
    v_fmac_f32 v66, v36, v32
    s_nop 1
    s_branch L_trows
L_fgen:
    s_waitcnt lgkmcnt(0)
    v_max3_f32 v67, v87, v95, v103
    v_max_f32 v67, v67, v111
    v_sub_f32 v32, v87, v67
    v_exp_f32 v32, v32
    s_nop 0
    v_mul_f32 v80, v80, v32
    v_mul_f32 v81, v81, v32
    v_mul_f32 v82, v82, v32
    v_mul_f32 v83, v83, v32
    v_mul_f32 v84, v84, v32
    v_mul_f32 v85, v85, v32
    v_mul_f32 v86, v86, v32
    v_sub_f32 v32, v95, v67
    v_exp_f32 v32, v32
    s_nop 0
    v_mul_f32 v88, v88, v32
    v_mul_f32 v89, v89, v32
    v_mul_f32 v90, v90, v32
    v_mul_f32 v91, v91, v32
    v_mul_f32 v92, v92, v32
    v_mul_f32 v93, v93, v32
    v_mul_f32 v94, v94, v32
    v_sub_f32 v32, v103, v67
    v_exp_f32 v32, v32
    s_nop 0
    v_mul_f32 v96, v96, v32
    v_mul_f32 v97, v97, v32
    v_mul_f32 v98, v98, v32
    v_mul_f32 v99, v99, v32
    v_mul_f32 v100, v100, v32
    v_mul_f32 v101, v101, v32
    v_mul_f32 v102, v102, v32
    v_sub_f32 v32, v111, v67
    v_exp_f32 v32, v32
    s_nop 0
    v_mul_f32 v104, v104, v32
    v_mul_f32 v105, v105, v32
    v_mul_f32 v106, v106, v32
    v_mul_f32 v107, v107, v32
    v_mul_f32 v108, v108, v32
    v_mul_f32 v109, v109, v32
    v_mul_f32 v110, v110, v32
    s_nop 1
    s_branch L_fsum
L_qkprod:
    s_getpc_b64 s[28:29]
    s_mov_b32 s30, 0x1000
    s_mov_b32 s31, 0x20000
    v_lshlrev_b32 v31, 6, v0
    buffer_load_dword v50, v31, s[28:31], 0 offen
    v_and_b32 v28, 15, v0
    v_lshrrev_b32 v29, 4, v0
    v_mov_b32 v30, 0
    v_lshlrev_b32 v47, 4, v0
    v_add_u32 v47, 0, v47
    v_mul_u32_u24 v31, 0x180, v28
    v_and_b32 v32, 1, v29
    v_lshl_add_u32 v31, v32, 3, v31
    v_add_u32 v31, 0x1c00, v31
    v_lshrrev_b32 v32, 1, v29
    v_and_b32 v37, 6, v28
    v_xor_b32 v32, v32, v37
    v_xor_b32 v34, 0, v32
    v_lshl_add_u32 v34, v34, 4, v31
    v_xor_b32 v35, 2, v32
    v_lshl_add_u32 v35, v35, 4, v31
    v_xor_b32 v36, 4, v32
    v_lshl_add_u32 v36, v36, 4, v31
    v_xor_b32 v37, 6, v32
    v_lshl_add_u32 v37, v37, 4, v31
    v_lshrrev_b32 v31, 2, v28
    v_lshl_add_u32 v31, v29, 2, v31
    v_and_b32 v32, 6, v31
    v_mul_u32_u24 v31, 0x180, v31
    v_and_b32 v41, 3, v28
    v_lshl_add_u32 v31, v41, 3, v31
    s_mul_i32 s53, s3, 3
    s_add_u32 s53, s53, 0
    s_and_b32 s40, s53, 3
    s_lshl_b32 s40, s40, 1
    v_xor_b32 v38, s40, v32
    v_lshl_add_u32 v38, v38, 4, v31
    s_lshr_b32 s40, s53, 2
    s_lshl_b32 s40, s40, 7
    s_add_u32 s40, s40, 0x6400
    v_add_u32 v38, s40, v38
    v_add_u32 v41, 0x12000, v38
    s_lshr_b32 s40, s53, 1
    s_lshl_b32 s40, s40, 10
    s_and_b32 s42, s53, 1
    s_lshl_b32 s42, s42, 3
    s_add_u32 s40, s40, s42
    v_add_u32 v44, s40, v47
    s_mul_i32 s53, s3, 3
    s_add_u32 s53, s53, 1
    s_and_b32 s40, s53, 3
    s_lshl_b32 s40, s40, 1
    v_xor_b32 v39, s40, v32
    v_lshl_add_u32 v39, v39, 4, v31
    s_lshr_b32 s40, s53, 2
    s_lshl_b32 s40, s40, 7
    s_add_u32 s40, s40, 0x6400
    v_add_u32 v39, s40, v39
    v_add_u32 v42, 0x12000, v39
    s_lshr_b32 s40, s53, 1
    s_lshl_b32 s40, s40, 10
    s_and_b32 s42, s53, 1
    s_lshl_b32 s42, s42, 3
    s_add_u32 s40, s40, s42
    v_add_u32 v45, s40, v47
    s_mul_i32 s53, s3, 3
    s_add_u32 s53, s53, 2
    s_and_b32 s40, s53, 3
    s_lshl_b32 s40, s40, 1
    v_xor_b32 v40, s40, v32
    v_lshl_add_u32 v40, v40, 4, v31
    s_lshr_b32 s40, s53, 2
    s_lshl_b32 s40, s40, 7
    s_add_u32 s40, s40, 0x6400
    v_add_u32 v40, s40, v40
    v_add_u32 v43, 0x12000, v40
    s_lshr_b32 s40, s53, 1
    s_lshl_b32 s40, s40, 10
    s_and_b32 s42, s53, 1
    s_lshl_b32 s42, s42, 3
    s_add_u32 s40, s40, s42
    v_add_u32 v46, s40, v47
    s_nop 1
L_spin71:
    ds_read_b32 v31, v30 offset:6956
    s_waitcnt lgkmcnt(0)
    v_readfirstlane_b32 s40, v31
    s_nop 0
    s_cmp_ge_u32 s40, 1
    s_cbranch_scc1 L_spun72
    s_sleep 1
    s_branch L_spin71
L_spun72:
    ds_read_b64 v[52:53], v34
    ds_read_b64 v[54:55], v35
    ds_read_b64 v[56:57], v36
    ds_read_b64 v[58:59], v37
    ds_read_b64 v[60:61], v34 offset:128
    ds_read_b64 v[62:63], v35 offset:128
    ds_read_b64 v[64:65], v36 offset:128
    ds_read_b64 v[66:67], v37 offset:128
    ds_read_b64 v[68:69], v34 offset:256
    ds_read_b64 v[70:71], v35 offset:256
    ds_read_b64 v[72:73], v36 offset:256
    ds_read_b64 v[74:75], v37 offset:256
    v_mov_b32 v77, 0x3f803f80
    s_waitcnt lgkmcnt(0)
    v_dot2_f32_bf16 v76, v52, v77, 0
    v_dot2_f32_bf16 v80, v52, v52, 0
    v_dot2_f32_bf16 v76, v53, v77, v76
    v_dot2_f32_bf16 v80, v53, v53, v80
    v_dot2_f32_bf16 v76, v54, v77, v76
    v_dot2_f32_bf16 v80, v54, v54, v80
    v_dot2_f32_bf16 v76, v55, v77, v76
    v_dot2_f32_bf16 v80, v55, v55, v80
    v_dot2_f32_bf16 v76, v56, v77, v76
    v_dot2_f32_bf16 v80, v56, v56, v80
    v_dot2_f32_bf16 v76, v57, v77, v76
    v_dot2_f32_bf16 v80, v57, v57, v80
    v_dot2_f32_bf16 v76, v58, v77, v76
    v_dot2_f32_bf16 v80, v58, v58, v80
    v_dot2_f32_bf16 v76, v59, v77, v76
    v_dot2_f32_bf16 v80, v59, v59, v80
    v_dot2_f32_bf16 v76, v60, v77, v76
    v_dot2_f32_bf16 v80, v60, v60, v80
    v_dot2_f32_bf16 v76, v61, v77, v76
    v_dot2_f32_bf16 v80, v61, v61, v80
    v_dot2_f32_bf16 v76, v62, v77, v76
    v_dot2_f32_bf16 v80, v62, v62, v80
    v_dot2_f32_bf16 v76, v63, v77, v76
    v_dot2_f32_bf16 v80, v63, v63, v80
    v_dot2_f32_bf16 v76, v64, v77, v76
    v_dot2_f32_bf16 v80, v64, v64, v80
    v_dot2_f32_bf16 v76, v65, v77, v76
    v_dot2_f32_bf16 v80, v65, v65, v80
    v_dot2_f32_bf16 v76, v66, v77, v76
    v_dot2_f32_bf16 v80, v66, v66, v80
    v_dot2_f32_bf16 v76, v67, v77, v76
    v_dot2_f32_bf16 v80, v67, v67, v80
    v_dot2_f32_bf16 v76, v68, v77, v76
    v_dot2_f32_bf16 v80, v68, v68, v80
    v_dot2_f32_bf16 v76, v69, v77, v76
    v_dot2_f32_bf16 v80, v69, v69, v80
    v_dot2_f32_bf16 v76, v70, v77, v76
    v_dot2_f32_bf16 v80, v70, v70, v80
    v_dot2_f32_bf16 v76, v71, v77, v76
    v_dot2_f32_bf16 v80, v71, v71, v80
    v_dot2_f32_bf16 v76, v72, v77, v76
    v_dot2_f32_bf16 v80, v72, v72, v80
    v_dot2_f32_bf16 v76, v73, v77, v76
    v_dot2_f32_bf16 v80, v73, v73, v80
    v_dot2_f32_bf16 v76, v74, v77, v76
    v_dot2_f32_bf16 v80, v74, v74, v80
    v_dot2_f32_bf16 v76, v75, v77, v76
    v_dot2_f32_bf16 v80, v75, v75, v80
    s_nop 1
    v_mov_b32 v31, v76
    v_mov_b32 v32, v76
    v_mov_b32 v82, v80
    v_mov_b32 v83, v80
    v_permlane32_swap_b32 v31, v32
    s_nop 0
    v_permlane32_swap_b32 v82, v83
    v_add_f32 v76, v31, v32
    v_add_f32 v80, v82, v83
    v_mov_b32 v31, v76
    v_mov_b32 v32, v76
    v_mov_b32 v82, v80
    v_mov_b32 v83, v80
    v_permlane16_swap_b32 v31, v32
    s_nop 0
    v_permlane16_swap_b32 v82, v83
    v_add_f32 v76, v31, v32
    v_add_f32 v80, v82, v83
    v_mul_f32 v78, s44, v76
    v_mul_f32 v80, s44, v80
    v_fma_f32 v80, -v78, v78, v80
    v_max_f32 v80, 0, v80
    v_cvt_pk_bf16_f32 v78, v78, v78
    v_and_b32 v78, 0xffff0000, v78
    v_mov_b32 v79, v78
    v_cvt_pk_bf16_f32 v80, v80, v80
    v_and_b32 v80, 0xffff0000, v80
    v_add_f32 v80, 0x3727c5ac, v80
    v_cvt_pk_bf16_f32 v80, v80, v80
    v_and_b32 v80, 0xffff0000, v80
    v_sqrt_f32 v80, v80
    s_nop 0
    v_cvt_pk_bf16_f32 v80, v80, v80
    v_and_b32 v80, 0xffff0000, v80
    v_rcp_f32 v80, v80
    s_nop 0
    v_mov_b32 v81, v80
    v_lshlrev_b32 v82, 16, v52
    v_and_b32 v83, 0xffff0000, v52
    v_pk_add_f32 v[82:83], v[82:83], v[78:79] neg_lo:[0,1] neg_hi:[0,1]
    v_cvt_pk_bf16_f32 v52, v82, v83
    v_lshlrev_b32 v82, 16, v52
    v_and_b32 v83, 0xffff0000, v52
    v_pk_mul_f32 v[82:83], v[82:83], v[80:81]
    v_cvt_pk_bf16_f32 v52, v82, v83
    v_lshlrev_b32 v84, 16, v53
    v_and_b32 v85, 0xffff0000, v53
    v_pk_add_f32 v[84:85], v[84:85], v[78:79] neg_lo:[0,1] neg_hi:[0,1]
    v_cvt_pk_bf16_f32 v53, v84, v85
    v_lshlrev_b32 v84, 16, v53
    v_and_b32 v85, 0xffff0000, v53
    v_pk_mul_f32 v[84:85], v[84:85], v[80:81]
    v_cvt_pk_bf16_f32 v53, v84, v85
    v_lshlrev_b32 v82, 16, v54
    v_and_b32 v83, 0xffff0000, v54
    v_pk_add_f32 v[82:83], v[82:83], v[78:79] neg_lo:[0,1] neg_hi:[0,1]
    v_cvt_pk_bf16_f32 v54, v82, v83
    v_lshlrev_b32 v82, 16, v54
    v_and_b32 v83, 0xffff0000, v54
    v_pk_mul_f32 v[82:83], v[82:83], v[80:81]
    v_cvt_pk_bf16_f32 v54, v82, v83
    v_lshlrev_b32 v84, 16, v55
    v_and_b32 v85, 0xffff0000, v55
    v_pk_add_f32 v[84:85], v[84:85], v[78:79] neg_lo:[0,1] neg_hi:[0,1]
    v_cvt_pk_bf16_f32 v55, v84, v85
    v_lshlrev_b32 v84, 16, v55
    v_and_b32 v85, 0xffff0000, v55
    v_pk_mul_f32 v[84:85], v[84:85], v[80:81]
    v_cvt_pk_bf16_f32 v55, v84, v85
    v_lshlrev_b32 v82, 16, v56
    v_and_b32 v83, 0xffff0000, v56
    v_pk_add_f32 v[82:83], v[82:83], v[78:79] neg_lo:[0,1] neg_hi:[0,1]
    v_cvt_pk_bf16_f32 v56, v82, v83
    v_lshlrev_b32 v82, 16, v56
    v_and_b32 v83, 0xffff0000, v56
    v_pk_mul_f32 v[82:83], v[82:83], v[80:81]
    v_cvt_pk_bf16_f32 v56, v82, v83
    v_lshlrev_b32 v84, 16, v57
    v_and_b32 v85, 0xffff0000, v57
    v_pk_add_f32 v[84:85], v[84:85], v[78:79] neg_lo:[0,1] neg_hi:[0,1]
    v_cvt_pk_bf16_f32 v57, v84, v85
    v_lshlrev_b32 v84, 16, v57
    v_and_b32 v85, 0xffff0000, v57
    v_pk_mul_f32 v[84:85], v[84:85], v[80:81]
    v_cvt_pk_bf16_f32 v57, v84, v85
    v_lshlrev_b32 v82, 16, v58
    v_and_b32 v83, 0xffff0000, v58
    v_pk_add_f32 v[82:83], v[82:83], v[78:79] neg_lo:[0,1] neg_hi:[0,1]
    v_cvt_pk_bf16_f32 v58, v82, v83
    v_lshlrev_b32 v82, 16, v58
    v_and_b32 v83, 0xffff0000, v58
    v_pk_mul_f32 v[82:83], v[82:83], v[80:81]
    v_cvt_pk_bf16_f32 v58, v82, v83
    v_lshlrev_b32 v84, 16, v59
    v_and_b32 v85, 0xffff0000, v59
    v_pk_add_f32 v[84:85], v[84:85], v[78:79] neg_lo:[0,1] neg_hi:[0,1]
    v_cvt_pk_bf16_f32 v59, v84, v85
    v_lshlrev_b32 v84, 16, v59
    v_and_b32 v85, 0xffff0000, v59
    v_pk_mul_f32 v[84:85], v[84:85], v[80:81]
    v_cvt_pk_bf16_f32 v59, v84, v85
    v_lshlrev_b32 v82, 16, v60
    v_and_b32 v83, 0xffff0000, v60
    v_pk_add_f32 v[82:83], v[82:83], v[78:79] neg_lo:[0,1] neg_hi:[0,1]
    v_cvt_pk_bf16_f32 v60, v82, v83
    v_lshlrev_b32 v82, 16, v60
    v_and_b32 v83, 0xffff0000, v60
    v_pk_mul_f32 v[82:83], v[82:83], v[80:81]
    v_cvt_pk_bf16_f32 v60, v82, v83
    v_lshlrev_b32 v84, 16, v61
    v_and_b32 v85, 0xffff0000, v61
    v_pk_add_f32 v[84:85], v[84:85], v[78:79] neg_lo:[0,1] neg_hi:[0,1]
    v_cvt_pk_bf16_f32 v61, v84, v85
    v_lshlrev_b32 v84, 16, v61
    v_and_b32 v85, 0xffff0000, v61
    v_pk_mul_f32 v[84:85], v[84:85], v[80:81]
    v_cvt_pk_bf16_f32 v61, v84, v85
    v_lshlrev_b32 v82, 16, v62
    v_and_b32 v83, 0xffff0000, v62
    v_pk_add_f32 v[82:83], v[82:83], v[78:79] neg_lo:[0,1] neg_hi:[0,1]
    v_cvt_pk_bf16_f32 v62, v82, v83
    v_lshlrev_b32 v82, 16, v62
    v_and_b32 v83, 0xffff0000, v62
    v_pk_mul_f32 v[82:83], v[82:83], v[80:81]
    v_cvt_pk_bf16_f32 v62, v82, v83
    v_lshlrev_b32 v84, 16, v63
    v_and_b32 v85, 0xffff0000, v63
    v_pk_add_f32 v[84:85], v[84:85], v[78:79] neg_lo:[0,1] neg_hi:[0,1]
    v_cvt_pk_bf16_f32 v63, v84, v85
    v_lshlrev_b32 v84, 16, v63
    v_and_b32 v85, 0xffff0000, v63
    v_pk_mul_f32 v[84:85], v[84:85], v[80:81]
    v_cvt_pk_bf16_f32 v63, v84, v85
    v_lshlrev_b32 v82, 16, v64
    v_and_b32 v83, 0xffff0000, v64
    v_pk_add_f32 v[82:83], v[82:83], v[78:79] neg_lo:[0,1] neg_hi:[0,1]
    v_cvt_pk_bf16_f32 v64, v82, v83
    v_lshlrev_b32 v82, 16, v64
    v_and_b32 v83, 0xffff0000, v64
    v_pk_mul_f32 v[82:83], v[82:83], v[80:81]
    v_cvt_pk_bf16_f32 v64, v82, v83
    v_lshlrev_b32 v84, 16, v65
    v_and_b32 v85, 0xffff0000, v65
    v_pk_add_f32 v[84:85], v[84:85], v[78:79] neg_lo:[0,1] neg_hi:[0,1]
    v_cvt_pk_bf16_f32 v65, v84, v85
    v_lshlrev_b32 v84, 16, v65
    v_and_b32 v85, 0xffff0000, v65
    v_pk_mul_f32 v[84:85], v[84:85], v[80:81]
    v_cvt_pk_bf16_f32 v65, v84, v85
    v_lshlrev_b32 v82, 16, v66
    v_and_b32 v83, 0xffff0000, v66
    v_pk_add_f32 v[82:83], v[82:83], v[78:79] neg_lo:[0,1] neg_hi:[0,1]
    v_cvt_pk_bf16_f32 v66, v82, v83
    v_lshlrev_b32 v82, 16, v66
    v_and_b32 v83, 0xffff0000, v66
    v_pk_mul_f32 v[82:83], v[82:83], v[80:81]
    v_cvt_pk_bf16_f32 v66, v82, v83
    v_lshlrev_b32 v84, 16, v67
    v_and_b32 v85, 0xffff0000, v67
    v_pk_add_f32 v[84:85], v[84:85], v[78:79] neg_lo:[0,1] neg_hi:[0,1]
    v_cvt_pk_bf16_f32 v67, v84, v85
    v_lshlrev_b32 v84, 16, v67
    v_and_b32 v85, 0xffff0000, v67
    v_pk_mul_f32 v[84:85], v[84:85], v[80:81]
    v_cvt_pk_bf16_f32 v67, v84, v85
    v_lshlrev_b32 v82, 16, v68
    v_and_b32 v83, 0xffff0000, v68
    v_pk_add_f32 v[82:83], v[82:83], v[78:79] neg_lo:[0,1] neg_hi:[0,1]
    v_cvt_pk_bf16_f32 v68, v82, v83
    v_lshlrev_b32 v82, 16, v68
    v_and_b32 v83, 0xffff0000, v68
    v_pk_mul_f32 v[82:83], v[82:83], v[80:81]
    v_cvt_pk_bf16_f32 v68, v82, v83
    v_lshlrev_b32 v84, 16, v69
    v_and_b32 v85, 0xffff0000, v69
    v_pk_add_f32 v[84:85], v[84:85], v[78:79] neg_lo:[0,1] neg_hi:[0,1]
    v_cvt_pk_bf16_f32 v69, v84, v85
    v_lshlrev_b32 v84, 16, v69
    v_and_b32 v85, 0xffff0000, v69
    v_pk_mul_f32 v[84:85], v[84:85], v[80:81]
    v_cvt_pk_bf16_f32 v69, v84, v85
    v_lshlrev_b32 v82, 16, v70
    v_and_b32 v83, 0xffff0000, v70
    v_pk_add_f32 v[82:83], v[82:83], v[78:79] neg_lo:[0,1] neg_hi:[0,1]
    v_cvt_pk_bf16_f32 v70, v82, v83
    v_lshlrev_b32 v82, 16, v70
    v_and_b32 v83, 0xffff0000, v70
    v_pk_mul_f32 v[82:83], v[82:83], v[80:81]
    v_cvt_pk_bf16_f32 v70, v82, v83
    v_lshlrev_b32 v84, 16, v71
    v_and_b32 v85, 0xffff0000, v71
    v_pk_add_f32 v[84:85], v[84:85], v[78:79] neg_lo:[0,1] neg_hi:[0,1]
    v_cvt_pk_bf16_f32 v71, v84, v85
    v_lshlrev_b32 v84, 16, v71
    v_and_b32 v85, 0xffff0000, v71
    v_pk_mul_f32 v[84:85], v[84:85], v[80:81]
    v_cvt_pk_bf16_f32 v71, v84, v85
    v_lshlrev_b32 v82, 16, v72
    v_and_b32 v83, 0xffff0000, v72
    v_pk_add_f32 v[82:83], v[82:83], v[78:79] neg_lo:[0,1] neg_hi:[0,1]
    v_cvt_pk_bf16_f32 v72, v82, v83
    v_lshlrev_b32 v82, 16, v72
    v_and_b32 v83, 0xffff0000, v72
    v_pk_mul_f32 v[82:83], v[82:83], v[80:81]
    v_cvt_pk_bf16_f32 v72, v82, v83
    v_lshlrev_b32 v84, 16, v73
    v_and_b32 v85, 0xffff0000, v73
    v_pk_add_f32 v[84:85], v[84:85], v[78:79] neg_lo:[0,1] neg_hi:[0,1]
    v_cvt_pk_bf16_f32 v73, v84, v85
    v_lshlrev_b32 v84, 16, v73
    v_and_b32 v85, 0xffff0000, v73
    v_pk_mul_f32 v[84:85], v[84:85], v[80:81]
    v_cvt_pk_bf16_f32 v73, v84, v85
    v_lshlrev_b32 v82, 16, v74
    v_and_b32 v83, 0xffff0000, v74
    v_pk_add_f32 v[82:83], v[82:83], v[78:79] neg_lo:[0,1] neg_hi:[0,1]
    v_cvt_pk_bf16_f32 v74, v82, v83
    v_lshlrev_b32 v82, 16, v74
    v_and_b32 v83, 0xffff0000, v74
    v_pk_mul_f32 v[82:83], v[82:83], v[80:81]
    v_cvt_pk_bf16_f32 v74, v82, v83
    v_lshlrev_b32 v84, 16, v75
    v_and_b32 v85, 0xffff0000, v75
    v_pk_add_f32 v[84:85], v[84:85], v[78:79] neg_lo:[0,1] neg_hi:[0,1]
    v_cvt_pk_bf16_f32 v75, v84, v85
    v_lshlrev_b32 v84, 16, v75
    v_and_b32 v85, 0xffff0000, v75
    v_pk_mul_f32 v[84:85], v[84:85], v[80:81]
    v_cvt_pk_bf16_f32 v75, v84, v85
    s_nop 1
L_spin73:
    ds_read_b32 v31, v30 offset:6956
    s_waitcnt lgkmcnt(0)
    v_readfirstlane_b32 s40, v31
    s_nop 0
    s_cmp_ge_u32 s40, 2
    s_cbranch_scc1 L_spun74
    s_sleep 1
    s_branch L_spin73
L_spun74:
    s_waitcnt vmcnt(0)
    ds_read_b64_tr_b16 v[100:101], v38
    ds_read_b64_tr_b16 v[102:103], v38 offset:6144
    ds_read_b64_tr_b16 v[104:105], v39
    ds_read_b64_tr_b16 v[106:107], v39 offset:6144
    ds_read_b64_tr_b16 v[108:109], v40
    ds_read_b64_tr_b16 v[110:111], v40 offset:6144
    ds_read_b64_tr_b16 v[112:113], v38 offset:12288
    ds_read_b64_tr_b16 v[114:115], v38 offset:18432
    ds_read_b64_tr_b16 v[116:117], v39 offset:12288
    ds_read_b64_tr_b16 v[118:119], v39 offset:18432
    ds_read_b64_tr_b16 v[120:121], v40 offset:12288
    ds_read_b64_tr_b16 v[122:123], v40 offset:18432
    ds_read_b64_tr_b16 v[124:125], v38 offset:36864
    ds_read_b64_tr_b16 v[126:127], v38 offset:43008
    ds_read_b64_tr_b16 v[128:129], v39 offset:36864
    ds_read_b64_tr_b16 v[130:131], v39 offset:43008
    ds_read_b64_tr_b16 v[132:133], v40 offset:36864
    ds_read_b64_tr_b16 v[134:135], v40 offset:43008
    s_waitcnt lgkmcnt(12)
    v_mfma_f32_16x16x32_bf16 v[88:91], v[100:103], v[52:55], 0
    v_mfma_f32_16x16x32_bf16 v[92:95], v[104:107], v[52:55], 0
    v_mfma_f32_16x16x32_bf16 v[96:99], v[108:111], v[52:55], 0
    ds_read_b64_tr_b16 v[136:137], v38 offset:49152
    ds_read_b64_tr_b16 v[138:139], v38 offset:55296
    ds_read_b64_tr_b16 v[140:141], v39 offset:49152
    ds_read_b64_tr_b16 v[142:143], v39 offset:55296
    ds_read_b64_tr_b16 v[144:145], v40 offset:49152
    ds_read_b64_tr_b16 v[146:147], v40 offset:55296
    s_waitcnt lgkmcnt(12)
    v_mfma_f32_16x16x32_bf16 v[88:91], v[112:115], v[56:59], v[88:91]
    v_mfma_f32_16x16x32_bf16 v[92:95], v[116:119], v[56:59], v[92:95]
    v_mfma_f32_16x16x32_bf16 v[96:99], v[120:123], v[56:59], v[96:99]
    ds_read_b64_tr_b16 v[148:149], v41
    ds_read_b64_tr_b16 v[150:151], v41 offset:6144
    ds_read_b64_tr_b16 v[152:153], v42
    ds_read_b64_tr_b16 v[154:155], v42 offset:6144
    ds_read_b64_tr_b16 v[156:157], v43
    ds_read_b64_tr_b16 v[158:159], v43 offset:6144
    s_waitcnt lgkmcnt(12)
    v_mfma_f32_16x16x32_bf16 v[88:91], v[124:127], v[60:63], v[88:91]
    v_mfma_f32_16x16x32_bf16 v[92:95], v[128:131], v[60:63], v[92:95]
    v_mfma_f32_16x16x32_bf16 v[96:99], v[132:135], v[60:63], v[96:99]
    ds_read_b64_tr_b16 v[160:161], v41 offset:12288
    ds_read_b64_tr_b16 v[162:163], v41 offset:18432
    ds_read_b64_tr_b16 v[164:165], v42 offset:12288
    ds_read_b64_tr_b16 v[166:167], v42 offset:18432
    ds_read_b64_tr_b16 v[168:169], v43 offset:12288
    ds_read_b64_tr_b16 v[170:171], v43 offset:18432
    s_waitcnt lgkmcnt(12)
    v_mfma_f32_16x16x32_bf16 v[88:91], v[136:139], v[64:67], v[88:91]
    v_mfma_f32_16x16x32_bf16 v[92:95], v[140:143], v[64:67], v[92:95]
    v_mfma_f32_16x16x32_bf16 v[96:99], v[144:147], v[64:67], v[96:99]
    s_waitcnt lgkmcnt(6)
    v_mfma_f32_16x16x32_bf16 v[88:91], v[148:151], v[68:71], v[88:91]
    v_mfma_f32_16x16x32_bf16 v[92:95], v[152:155], v[68:71], v[92:95]
    v_mfma_f32_16x16x32_bf16 v[96:99], v[156:159], v[68:71], v[96:99]
    s_waitcnt lgkmcnt(0)
    v_mfma_f32_16x16x32_bf16 v[88:91], v[160:163], v[72:75], v[88:91]
    v_mfma_f32_16x16x32_bf16 v[92:95], v[164:167], v[72:75], v[92:95]
    v_mfma_f32_16x16x32_bf16 v[96:99], v[168:171], v[72:75], v[96:99]
    s_nop 5
    v_cvt_pk_bf16_f32 v76, v88, v89
    v_cvt_pk_bf16_f32 v77, v90, v91
    ds_write_b64 v44, v[76:77]
    v_cvt_pk_bf16_f32 v78, v92, v93
    v_cvt_pk_bf16_f32 v79, v94, v95
    ds_write_b64 v45, v[78:79]
    v_cvt_pk_bf16_f32 v80, v96, v97
    v_cvt_pk_bf16_f32 v81, v98, v99
    ds_write_b64 v46, v[80:81]
    v_mov_b32 v31, 1
    s_mov_b64 exec, 1
    ds_add_u32 v30, v31 offset:6948
    s_mov_b64 exec, -1
    s_cmp_ge_u32 s3, 2
    s_cbranch_scc1 L_qkp_done
L_spin75:
    ds_read_b32 v31, v30 offset:6956
    s_waitcnt lgkmcnt(0)
    v_readfirstlane_b32 s40, v31
    s_nop 0
    s_cmp_ge_u32 s40, 3
    s_cbranch_scc1 L_spun76
    s_sleep 1
    s_branch L_spin75
L_spun76:
    s_mul_i32 s40, s3, 0x3000
    s_add_u32 s40, s40, 0x1f800
    v_add_u32 v34, s40, v34
    v_add_u32 v35, s40, v35
    v_add_u32 v36, s40, v36
    v_add_u32 v37, s40, v37
    ds_read_b64 v[100:101], v34
    ds_read_b64 v[102:103], v35
    ds_read_b64 v[104:105], v36
    ds_read_b64 v[106:107], v37
    ds_read_b64 v[108:109], v34 offset:128
    ds_read_b64 v[110:111], v35 offset:128
    ds_read_b64 v[112:113], v36 offset:128
    ds_read_b64 v[114:115], v37 offset:128
    ds_read_b64 v[116:117], v34 offset:256
    ds_read_b64 v[118:119], v35 offset:256
    ds_read_b64 v[120:121], v36 offset:256
    ds_read_b64 v[122:123], v37 offset:256
    ds_read_b64 v[124:125], v34 offset:6144
    ds_read_b64 v[126:127], v35 offset:6144
    ds_read_b64 v[128:129], v36 offset:6144
    ds_read_b64 v[130:131], v37 offset:6144
    ds_read_b64 v[132:133], v34 offset:6272
    ds_read_b64 v[134:135], v35 offset:6272
    ds_read_b64 v[136:137], v36 offset:6272
    ds_read_b64 v[138:139], v37 offset:6272
    ds_read_b64 v[140:141], v34 offset:6400
    ds_read_b64 v[142:143], v35 offset:6400
    ds_read_b64 v[144:145], v36 offset:6400
    ds_read_b64 v[146:147], v37 offset:6400
L_spin77:
    ds_read_b32 v31, v30 offset:6948
    s_waitcnt lgkmcnt(0)
    v_readfirstlane_b32 s40, v31
    s_nop 0
    s_cmp_ge_u32 s40, 4
    s_cbranch_scc1 L_spun78
    s_sleep 1
    s_branch L_spin77
L_spun78:
    ds_read_b128 v[52:55], v47
    ds_read_b128 v[56:59], v47 offset:1024
    ds_read_b128 v[60:63], v47 offset:2048
    ds_read_b128 v[64:67], v47 offset:3072
    ds_read_b128 v[68:71], v47 offset:4096
    ds_read_b128 v[72:75], v47 offset:5120
    s_lshl_b32 s42, s2, 1
    s_add_u32 s42, s42, s3
    s_lshl_b32 s42, s42, 10
    s_add_u32 s42, s42, 0x500000
    v_lshlrev_b32 v33, 4, v0
    s_waitcnt lgkmcnt(5)
    v_mfma_f32_16x16x32_bf16 v[88:91], v[100:103], v[52:55], 0
    v_mfma_f32_16x16x32_bf16 v[92:95], v[124:127], v[52:55], 0
    s_waitcnt lgkmcnt(4)
    v_mfma_f32_16x16x32_bf16 v[88:91], v[104:107], v[56:59], v[88:91]
    v_mfma_f32_16x16x32_bf16 v[92:95], v[128:131], v[56:59], v[92:95]
    s_waitcnt lgkmcnt(3)
    v_mfma_f32_16x16x32_bf16 v[88:91], v[108:111], v[60:63], v[88:91]
    v_mfma_f32_16x16x32_bf16 v[92:95], v[132:135], v[60:63], v[92:95]
    s_waitcnt lgkmcnt(2)
    v_mfma_f32_16x16x32_bf16 v[88:91], v[112:115], v[64:67], v[88:91]
    v_mfma_f32_16x16x32_bf16 v[92:95], v[136:139], v[64:67], v[92:95]
    s_waitcnt lgkmcnt(1)
    v_mfma_f32_16x16x32_bf16 v[88:91], v[116:119], v[68:71], v[88:91]
    v_mfma_f32_16x16x32_bf16 v[92:95], v[140:143], v[68:71], v[92:95]
    s_waitcnt lgkmcnt(0)
    v_mfma_f32_16x16x32_bf16 v[88:91], v[120:123], v[72:75], v[88:91]
    v_mfma_f32_16x16x32_bf16 v[92:95], v[144:147], v[72:75], v[92:95]
    s_nop 7
L_spin79:
    ds_read_b32 v31, v30 offset:6960
    s_waitcnt lgkmcnt(0)
    v_readfirstlane_b32 s40, v31
    s_nop 0
    s_cmp_ge_u32 s40, 1
    s_cbranch_scc1 L_spun80
    s_sleep 1
    s_branch L_spin79
L_spun80:
    s_mov_b32 s40, 0x3dd53b95
    v_mul_f32 v88, s40, v88
    v_mul_f32 v89, s40, v89
    v_mul_f32 v90, s40, v90
    v_mul_f32 v91, s40, v91
    v_cvt_pk_bf16_f32 v76, v88, v89
    v_cvt_pk_bf16_f32 v77, v90, v91
    v_mul_f32 v92, s40, v92
    v_mul_f32 v93, s40, v93
    v_mul_f32 v94, s40, v94
    v_mul_f32 v95, s40, v95
    v_cvt_pk_bf16_f32 v78, v92, v93
    v_cvt_pk_bf16_f32 v79, v94, v95
    v_min_u32 v76, -2, v76
    v_min_u32 v77, -2, v77
    v_min_u32 v78, -2, v78
    v_min_u32 v79, -2, v79
    buffer_store_dwordx4 v[76:79], v33, s[32:35], s42 offen sc1
    s_nop 1
L_qkp_done:
    v_mov_b32 v31, 1
    s_mov_b64 exec, 1
    ds_add_u32 v30, v31 offset:6952
    s_mov_b64 exec, -1
    s_waitcnt lgkmcnt(0)
    s_branch L_c_start
L_wvprod:
    s_getpc_b64 s[28:29]
    s_mov_b32 s30, 0x1000
    s_mov_b32 s31, 0x20000
    v_lshlrev_b32 v148, 6, v0
    buffer_load_dword v156, v148, s[28:31], 0 offen
    v_mov_b32 v150, 0
    v_add_u32 v152, 0x6400, v244
    v_add_u32 v153, 0x6400, v245
    v_add_u32 v154, 0x18400, v244
    v_add_u32 v155, 0x18400, v245
    v_lshrrev_b32 v148, 4, v0
    v_bfe_u32 v149, v0, 2, 2
    v_lshl_add_u32 v148, v148, 3, v149
    v_and_b32 v149, 3, v0
    v_lshlrev_b32 v149, 3, v149
    v_lshl_add_u32 v151, v148, 7, v149
    s_lshl_b32 s40, s3, 5
    s_add_u32 s40, s40, 0x21400
    v_add_u32 v151, s40, v151
    s_nop 1
L_spin81:
    ds_read_b32 v148, v150 offset:6956
    s_waitcnt lgkmcnt(0)
    v_readfirstlane_b32 s40, v148
    s_nop 0
    s_cmp_ge_u32 s40, 1
    s_cbranch_scc1 L_spun82
    s_sleep 1
    s_branch L_spin81
L_spun82:
    ds_read_b64_tr_b16 v[28:29], v151
    ds_read_b64_tr_b16 v[30:31], v151 offset:512
    ds_read_b64_tr_b16 v[32:33], v151 offset:4096
    ds_read_b64_tr_b16 v[34:35], v151 offset:4608
    ds_read_b64_tr_b16 v[36:37], v151 offset:8192
    ds_read_b64_tr_b16 v[38:39], v151 offset:8704
    ds_read_b64_tr_b16 v[40:41], v151 offset:12288
    ds_read_b64_tr_b16 v[42:43], v151 offset:12800
    ds_read_b64_tr_b16 v[44:45], v151 offset:16384
    ds_read_b64_tr_b16 v[46:47], v151 offset:16896
    ds_read_b64_tr_b16 v[48:49], v151 offset:20480
    ds_read_b64_tr_b16 v[50:51], v151 offset:20992
L_spin83:
    ds_read_b32 v148, v150 offset:6956
    s_waitcnt lgkmcnt(0)
    v_readfirstlane_b32 s40, v148
    s_nop 0
    s_cmp_ge_u32 s40, 2
    s_cbranch_scc1 L_spun84
    s_sleep 1
    s_branch L_spin83
L_spun84:
    s_waitcnt vmcnt(0)
    ds_read_b128 v[100:103], v152
    ds_read_b128 v[104:107], v153
    ds_read_b128 v[108:111], v152 offset:128
    ds_read_b128 v[112:115], v153 offset:128
    ds_read_b128 v[116:119], v152 offset:256
    ds_read_b128 v[120:123], v153 offset:256
    s_waitcnt lgkmcnt(5)
    v_mfma_f32_16x16x32_bf16 v[52:55], v[100:103], v[28:31], 0
    ds_read_b128 v[124:127], v152 offset:6144
    s_waitcnt lgkmcnt(5)
    v_mfma_f32_16x16x32_bf16 v[52:55], v[104:107], v[32:35], v[52:55]
    ds_read_b128 v[128:131], v153 offset:6144
    s_waitcnt lgkmcnt(5)
    v_mfma_f32_16x16x32_bf16 v[52:55], v[108:111], v[36:39], v[52:55]
    ds_read_b128 v[132:135], v152 offset:6272
    s_waitcnt lgkmcnt(5)
    v_mfma_f32_16x16x32_bf16 v[52:55], v[112:115], v[40:43], v[52:55]
    ds_read_b128 v[136:139], v153 offset:6272
    s_waitcnt lgkmcnt(5)
    v_mfma_f32_16x16x32_bf16 v[52:55], v[116:119], v[44:47], v[52:55]
    ds_read_b128 v[140:143], v152 offset:6400
    s_waitcnt lgkmcnt(5)
    v_mfma_f32_16x16x32_bf16 v[52:55], v[120:123], v[48:51], v[52:55]
    ds_read_b128 v[144:147], v153 offset:6400
    s_waitcnt lgkmcnt(5)
    v_mfma_f32_16x16x32_bf16 v[56:59], v[124:127], v[28:31], 0
    ds_read_b128 v[100:103], v152 offset:12288
    s_waitcnt lgkmcnt(5)
    v_mfma_f32_16x16x32_bf16 v[56:59], v[128:131], v[32:35], v[56:59]
    ds_read_b128 v[104:107], v153 offset:12288
    s_waitcnt lgkmcnt(5)
    v_mfma_f32_16x16x32_bf16 v[56:59], v[132:135], v[36:39], v[56:59]
    ds_read_b128 v[108:111], v152 offset:12416
    s_waitcnt lgkmcnt(5)
    v_mfma_f32_16x16x32_bf16 v[56:59], v[136:139], v[40:43], v[56:59]
    ds_read_b128 v[112:115], v153 offset:12416
    s_waitcnt lgkmcnt(5)
    v_mfma_f32_16x16x32_bf16 v[56:59], v[140:143], v[44:47], v[56:59]
    ds_read_b128 v[116:119], v152 offset:12544
    s_waitcnt lgkmcnt(5)
    v_mfma_f32_16x16x32_bf16 v[56:59], v[144:147], v[48:51], v[56:59]
    ds_read_b128 v[120:123], v153 offset:12544
    s_waitcnt lgkmcnt(5)
    v_mfma_f32_16x16x32_bf16 v[60:63], v[100:103], v[28:31], 0
    ds_read_b128 v[124:127], v152 offset:18432
    s_waitcnt lgkmcnt(5)
    v_mfma_f32_16x16x32_bf16 v[60:63], v[104:107], v[32:35], v[60:63]
    ds_read_b128 v[128:131], v153 offset:18432
    s_waitcnt lgkmcnt(5)
    v_mfma_f32_16x16x32_bf16 v[60:63], v[108:111], v[36:39], v[60:63]
    ds_read_b128 v[132:135], v152 offset:18560
    s_waitcnt lgkmcnt(5)
    v_mfma_f32_16x16x32_bf16 v[60:63], v[112:115], v[40:43], v[60:63]
    ds_read_b128 v[136:139], v153 offset:18560
    s_waitcnt lgkmcnt(5)
    v_mfma_f32_16x16x32_bf16 v[60:63], v[116:119], v[44:47], v[60:63]
    ds_read_b128 v[140:143], v152 offset:18688
    s_waitcnt lgkmcnt(5)
    v_mfma_f32_16x16x32_bf16 v[60:63], v[120:123], v[48:51], v[60:63]
    ds_read_b128 v[144:147], v153 offset:18688
    s_waitcnt lgkmcnt(5)
    v_mfma_f32_16x16x32_bf16 v[64:67], v[124:127], v[28:31], 0
    ds_read_b128 v[100:103], v152 offset:36864
    s_waitcnt lgkmcnt(5)
    v_mfma_f32_16x16x32_bf16 v[64:67], v[128:131], v[32:35], v[64:67]
    ds_read_b128 v[104:107], v153 offset:36864
    s_waitcnt lgkmcnt(5)
    v_mfma_f32_16x16x32_bf16 v[64:67], v[132:135], v[36:39], v[64:67]
    ds_read_b128 v[108:111], v152 offset:36992
    s_waitcnt lgkmcnt(5)
    v_mfma_f32_16x16x32_bf16 v[64:67], v[136:139], v[40:43], v[64:67]
    ds_read_b128 v[112:115], v153 offset:36992
    s_waitcnt lgkmcnt(5)
    v_mfma_f32_16x16x32_bf16 v[64:67], v[140:143], v[44:47], v[64:67]
    ds_read_b128 v[116:119], v152 offset:37120
    s_waitcnt lgkmcnt(5)
    v_mfma_f32_16x16x32_bf16 v[64:67], v[144:147], v[48:51], v[64:67]
    ds_read_b128 v[120:123], v153 offset:37120
    s_waitcnt lgkmcnt(5)
    v_mfma_f32_16x16x32_bf16 v[68:71], v[100:103], v[28:31], 0
    ds_read_b128 v[124:127], v152 offset:43008
    s_waitcnt lgkmcnt(5)
    v_mfma_f32_16x16x32_bf16 v[68:71], v[104:107], v[32:35], v[68:71]
    ds_read_b128 v[128:131], v153 offset:43008
    s_waitcnt lgkmcnt(5)
    v_mfma_f32_16x16x32_bf16 v[68:71], v[108:111], v[36:39], v[68:71]
    ds_read_b128 v[132:135], v152 offset:43136
    s_waitcnt lgkmcnt(5)
    v_mfma_f32_16x16x32_bf16 v[68:71], v[112:115], v[40:43], v[68:71]
    ds_read_b128 v[136:139], v153 offset:43136
    s_waitcnt lgkmcnt(5)
    v_mfma_f32_16x16x32_bf16 v[68:71], v[116:119], v[44:47], v[68:71]
    ds_read_b128 v[140:143], v152 offset:43264
    s_waitcnt lgkmcnt(5)
    v_mfma_f32_16x16x32_bf16 v[68:71], v[120:123], v[48:51], v[68:71]
    ds_read_b128 v[144:147], v153 offset:43264
    s_waitcnt lgkmcnt(5)
    v_mfma_f32_16x16x32_bf16 v[72:75], v[124:127], v[28:31], 0
    ds_read_b128 v[100:103], v152 offset:49152
    s_waitcnt lgkmcnt(5)
    v_mfma_f32_16x16x32_bf16 v[72:75], v[128:131], v[32:35], v[72:75]
    ds_read_b128 v[104:107], v153 offset:49152
    s_waitcnt lgkmcnt(5)
    v_mfma_f32_16x16x32_bf16 v[72:75], v[132:135], v[36:39], v[72:75]
    ds_read_b128 v[108:111], v152 offset:49280
    s_waitcnt lgkmcnt(5)
    v_mfma_f32_16x16x32_bf16 v[72:75], v[136:139], v[40:43], v[72:75]
    ds_read_b128 v[112:115], v153 offset:49280
    s_waitcnt lgkmcnt(5)
    v_mfma_f32_16x16x32_bf16 v[72:75], v[140:143], v[44:47], v[72:75]
    ds_read_b128 v[116:119], v152 offset:49408
    s_waitcnt lgkmcnt(5)
    v_mfma_f32_16x16x32_bf16 v[72:75], v[144:147], v[48:51], v[72:75]
    ds_read_b128 v[120:123], v153 offset:49408
    s_waitcnt lgkmcnt(5)
    v_mfma_f32_16x16x32_bf16 v[76:79], v[100:103], v[28:31], 0
    ds_read_b128 v[124:127], v152 offset:55296
    s_waitcnt lgkmcnt(5)
    v_mfma_f32_16x16x32_bf16 v[76:79], v[104:107], v[32:35], v[76:79]
    ds_read_b128 v[128:131], v153 offset:55296
    s_waitcnt lgkmcnt(5)
    v_mfma_f32_16x16x32_bf16 v[76:79], v[108:111], v[36:39], v[76:79]
    ds_read_b128 v[132:135], v152 offset:55424
    s_waitcnt lgkmcnt(5)
    v_mfma_f32_16x16x32_bf16 v[76:79], v[112:115], v[40:43], v[76:79]
    ds_read_b128 v[136:139], v153 offset:55424
    s_waitcnt lgkmcnt(5)
    v_mfma_f32_16x16x32_bf16 v[76:79], v[116:119], v[44:47], v[76:79]
    ds_read_b128 v[140:143], v152 offset:55552
    s_waitcnt lgkmcnt(5)
    v_mfma_f32_16x16x32_bf16 v[76:79], v[120:123], v[48:51], v[76:79]
    ds_read_b128 v[144:147], v153 offset:55552
    s_nop 6
L_spin85:
    ds_read_b32 v148, v150 offset:6956
    s_waitcnt lgkmcnt(0)
    v_readfirstlane_b32 s40, v148
    s_nop 0
    s_cmp_ge_u32 s40, 3
    s_cbranch_scc1 L_spun86
    s_sleep 1
    s_branch L_spin85
L_spun86:
    s_waitcnt lgkmcnt(5)
    v_mfma_f32_16x16x32_bf16 v[80:83], v[124:127], v[28:31], 0
    ds_read_b128 v[100:103], v154
    s_waitcnt lgkmcnt(5)
    v_mfma_f32_16x16x32_bf16 v[80:83], v[128:131], v[32:35], v[80:83]
    ds_read_b128 v[104:107], v155
    s_waitcnt lgkmcnt(5)
    v_mfma_f32_16x16x32_bf16 v[80:83], v[132:135], v[36:39], v[80:83]
    ds_read_b128 v[108:111], v154 offset:128
    s_waitcnt lgkmcnt(5)
    v_mfma_f32_16x16x32_bf16 v[80:83], v[136:139], v[40:43], v[80:83]
    ds_read_b128 v[112:115], v155 offset:128
    s_waitcnt lgkmcnt(5)
    v_mfma_f32_16x16x32_bf16 v[80:83], v[140:143], v[44:47], v[80:83]
    ds_read_b128 v[116:119], v154 offset:256
    s_waitcnt lgkmcnt(5)
    v_mfma_f32_16x16x32_bf16 v[80:83], v[144:147], v[48:51], v[80:83]
    ds_read_b128 v[120:123], v155 offset:256
    s_waitcnt lgkmcnt(5)
    v_mfma_f32_16x16x32_bf16 v[84:87], v[100:103], v[28:31], 0
    ds_read_b128 v[124:127], v154 offset:6144
    s_waitcnt lgkmcnt(5)
    v_mfma_f32_16x16x32_bf16 v[84:87], v[104:107], v[32:35], v[84:87]
    ds_read_b128 v[128:131], v155 offset:6144
    s_waitcnt lgkmcnt(5)
    v_mfma_f32_16x16x32_bf16 v[84:87], v[108:111], v[36:39], v[84:87]
    ds_read_b128 v[132:135], v154 offset:6272
    s_waitcnt lgkmcnt(5)
    v_mfma_f32_16x16x32_bf16 v[84:87], v[112:115], v[40:43], v[84:87]
    ds_read_b128 v[136:139], v155 offset:6272
    s_waitcnt lgkmcnt(5)
    v_mfma_f32_16x16x32_bf16 v[84:87], v[116:119], v[44:47], v[84:87]
    ds_read_b128 v[140:143], v154 offset:6400
    s_waitcnt lgkmcnt(5)
    v_mfma_f32_16x16x32_bf16 v[84:87], v[120:123], v[48:51], v[84:87]
    ds_read_b128 v[144:147], v155 offset:6400
    s_waitcnt lgkmcnt(5)
    v_mfma_f32_16x16x32_bf16 v[88:91], v[124:127], v[28:31], 0
    ds_read_b128 v[100:103], v154 offset:12288
    s_waitcnt lgkmcnt(5)
    v_mfma_f32_16x16x32_bf16 v[88:91], v[128:131], v[32:35], v[88:91]
    ds_read_b128 v[104:107], v155 offset:12288
    s_waitcnt lgkmcnt(5)
    v_mfma_f32_16x16x32_bf16 v[88:91], v[132:135], v[36:39], v[88:91]
    ds_read_b128 v[108:111], v154 offset:12416
    s_waitcnt lgkmcnt(5)
    v_mfma_f32_16x16x32_bf16 v[88:91], v[136:139], v[40:43], v[88:91]
    ds_read_b128 v[112:115], v155 offset:12416
    s_waitcnt lgkmcnt(5)
    v_mfma_f32_16x16x32_bf16 v[88:91], v[140:143], v[44:47], v[88:91]
    ds_read_b128 v[116:119], v154 offset:12544
    s_waitcnt lgkmcnt(5)
    v_mfma_f32_16x16x32_bf16 v[88:91], v[144:147], v[48:51], v[88:91]
    ds_read_b128 v[120:123], v155 offset:12544
    s_waitcnt lgkmcnt(5)
    v_mfma_f32_16x16x32_bf16 v[92:95], v[100:103], v[28:31], 0
    ds_read_b128 v[124:127], v154 offset:18432
    s_waitcnt lgkmcnt(5)
    v_mfma_f32_16x16x32_bf16 v[92:95], v[104:107], v[32:35], v[92:95]
    ds_read_b128 v[128:131], v155 offset:18432
    s_waitcnt lgkmcnt(5)
    v_mfma_f32_16x16x32_bf16 v[92:95], v[108:111], v[36:39], v[92:95]
    ds_read_b128 v[132:135], v154 offset:18560
    s_waitcnt lgkmcnt(5)
    v_mfma_f32_16x16x32_bf16 v[92:95], v[112:115], v[40:43], v[92:95]
    ds_read_b128 v[136:139], v155 offset:18560
    s_waitcnt lgkmcnt(5)
    v_mfma_f32_16x16x32_bf16 v[92:95], v[116:119], v[44:47], v[92:95]
    ds_read_b128 v[140:143], v154 offset:18688
    s_waitcnt lgkmcnt(5)
    v_mfma_f32_16x16x32_bf16 v[92:95], v[120:123], v[48:51], v[92:95]
    ds_read_b128 v[144:147], v155 offset:18688
    s_waitcnt lgkmcnt(5)
    v_mfma_f32_16x16x32_bf16 v[96:99], v[124:127], v[28:31], 0
    s_waitcnt lgkmcnt(4)
    s_waitcnt lgkmcnt(5)
    v_mfma_f32_16x16x32_bf16 v[96:99], v[128:131], v[32:35], v[96:99]
    s_waitcnt lgkmcnt(3)
    s_waitcnt lgkmcnt(5)
    v_mfma_f32_16x16x32_bf16 v[96:99], v[132:135], v[36:39], v[96:99]
    s_waitcnt lgkmcnt(2)
    s_waitcnt lgkmcnt(5)
    v_mfma_f32_16x16x32_bf16 v[96:99], v[136:139], v[40:43], v[96:99]
    s_waitcnt lgkmcnt(1)
    s_waitcnt lgkmcnt(5)
    v_mfma_f32_16x16x32_bf16 v[96:99], v[140:143], v[44:47], v[96:99]
    s_waitcnt lgkmcnt(0)
    s_waitcnt lgkmcnt(5)
    v_mfma_f32_16x16x32_bf16 v[96:99], v[144:147], v[48:51], v[96:99]
    v_mov_b32 v148, 1
    s_mov_b64 exec, 1
    ds_add_u32 v150, v148 offset:6952
    s_mov_b64 exec, -1
    v_pk_add_f32 v[158:159], v[52:53], v[56:57]
    v_pk_add_f32 v[160:161], v[54:55], v[58:59]
    v_pk_add_f32 v[158:159], v[158:159], v[60:61]
    v_pk_add_f32 v[160:161], v[160:161], v[62:63]
    v_pk_add_f32 v[158:159], v[158:159], v[64:65]
    v_pk_add_f32 v[160:161], v[160:161], v[66:67]
    v_pk_add_f32 v[158:159], v[158:159], v[68:69]
    v_pk_add_f32 v[160:161], v[160:161], v[70:71]
    v_pk_add_f32 v[158:159], v[158:159], v[72:73]
    v_pk_add_f32 v[160:161], v[160:161], v[74:75]
    v_pk_add_f32 v[158:159], v[158:159], v[76:77]
    v_pk_add_f32 v[160:161], v[160:161], v[78:79]
    v_pk_add_f32 v[158:159], v[158:159], v[80:81]
    v_pk_add_f32 v[160:161], v[160:161], v[82:83]
    v_pk_add_f32 v[158:159], v[158:159], v[84:85]
    v_pk_add_f32 v[160:161], v[160:161], v[86:87]
    v_pk_add_f32 v[158:159], v[158:159], v[88:89]
    v_pk_add_f32 v[160:161], v[160:161], v[90:91]
    v_pk_add_f32 v[158:159], v[158:159], v[92:93]
    v_pk_add_f32 v[160:161], v[160:161], v[94:95]
    v_pk_add_f32 v[158:159], v[158:159], v[96:97]
    v_pk_add_f32 v[160:161], v[160:161], v[98:99]
    v_pk_add_f32 v[158:159], v[158:159], v[160:161]
    v_add_f32 v158, v158, v159
    v_mov_b32 v148, v158
    v_mov_b32 v149, v158
    s_nop 1
    v_permlane32_swap_b32 v148, v149
    v_add_f32 v158, v148, v149
    v_mov_b32 v148, v158
    v_mov_b32 v149, v158
    s_nop 1
    v_permlane16_swap_b32 v148, v149
    v_add_f32 v158, v148, v149
    v_mul_f32 v158, s44, v158
    s_sub_u32 s40, s2, 3
    s_lshl_b32 s40, s40, 2
    s_add_u32 s40, s40, s3
    s_mul_i32 s40, s40, 0x1800
    s_add_u32 s40, s40, 0x540000
    v_lshlrev_b32 v148, 4, v0
    v_pk_add_f32 v[52:53], v[52:53], v[158:159] op_sel_hi:[1,0] neg_lo:[0,1] neg_hi:[0,1]
    v_cvt_pk_bf16_f32 v164, v52, v53
    v_pk_add_f32 v[54:55], v[54:55], v[158:159] op_sel_hi:[1,0] neg_lo:[0,1] neg_hi:[0,1]
    v_cvt_pk_bf16_f32 v165, v54, v55
    v_pk_add_f32 v[56:57], v[56:57], v[158:159] op_sel_hi:[1,0] neg_lo:[0,1] neg_hi:[0,1]
    v_cvt_pk_bf16_f32 v166, v56, v57
    v_pk_add_f32 v[58:59], v[58:59], v[158:159] op_sel_hi:[1,0] neg_lo:[0,1] neg_hi:[0,1]
    v_cvt_pk_bf16_f32 v167, v58, v59
    s_add_u32 s42, s40, 0
    buffer_store_dwordx4 v[164:167], v148, s[32:35], s42 offen sc1
    v_pk_add_f32 v[60:61], v[60:61], v[158:159] op_sel_hi:[1,0] neg_lo:[0,1] neg_hi:[0,1]
    v_cvt_pk_bf16_f32 v168, v60, v61
    v_pk_add_f32 v[62:63], v[62:63], v[158:159] op_sel_hi:[1,0] neg_lo:[0,1] neg_hi:[0,1]
    v_cvt_pk_bf16_f32 v169, v62, v63
    v_pk_add_f32 v[64:65], v[64:65], v[158:159] op_sel_hi:[1,0] neg_lo:[0,1] neg_hi:[0,1]
    v_cvt_pk_bf16_f32 v170, v64, v65
    v_pk_add_f32 v[66:67], v[66:67], v[158:159] op_sel_hi:[1,0] neg_lo:[0,1] neg_hi:[0,1]
    v_cvt_pk_bf16_f32 v171, v66, v67
    s_add_u32 s42, s40, 0x400
    buffer_store_dwordx4 v[168:171], v148, s[32:35], s42 offen sc1
    v_pk_add_f32 v[68:69], v[68:69], v[158:159] op_sel_hi:[1,0] neg_lo:[0,1] neg_hi:[0,1]
    v_cvt_pk_bf16_f32 v172, v68, v69
    v_pk_add_f32 v[70:71], v[70:71], v[158:159] op_sel_hi:[1,0] neg_lo:[0,1] neg_hi:[0,1]
    v_cvt_pk_bf16_f32 v173, v70, v71
    v_pk_add_f32 v[72:73], v[72:73], v[158:159] op_sel_hi:[1,0] neg_lo:[0,1] neg_hi:[0,1]
    v_cvt_pk_bf16_f32 v174, v72, v73
    v_pk_add_f32 v[74:75], v[74:75], v[158:159] op_sel_hi:[1,0] neg_lo:[0,1] neg_hi:[0,1]
    v_cvt_pk_bf16_f32 v175, v74, v75
    s_add_u32 s42, s40, 0x800
    buffer_store_dwordx4 v[172:175], v148, s[32:35], s42 offen sc1
    v_pk_add_f32 v[76:77], v[76:77], v[158:159] op_sel_hi:[1,0] neg_lo:[0,1] neg_hi:[0,1]
    v_cvt_pk_bf16_f32 v176, v76, v77
    v_pk_add_f32 v[78:79], v[78:79], v[158:159] op_sel_hi:[1,0] neg_lo:[0,1] neg_hi:[0,1]
    v_cvt_pk_bf16_f32 v177, v78, v79
    v_pk_add_f32 v[80:81], v[80:81], v[158:159] op_sel_hi:[1,0] neg_lo:[0,1] neg_hi:[0,1]
    v_cvt_pk_bf16_f32 v178, v80, v81
    v_pk_add_f32 v[82:83], v[82:83], v[158:159] op_sel_hi:[1,0] neg_lo:[0,1] neg_hi:[0,1]
    v_cvt_pk_bf16_f32 v179, v82, v83
    s_add_u32 s42, s40, 0xc00
    buffer_store_dwordx4 v[176:179], v148, s[32:35], s42 offen sc1
    v_pk_add_f32 v[84:85], v[84:85], v[158:159] op_sel_hi:[1,0] neg_lo:[0,1] neg_hi:[0,1]
    v_cvt_pk_bf16_f32 v180, v84, v85
    v_pk_add_f32 v[86:87], v[86:87], v[158:159] op_sel_hi:[1,0] neg_lo:[0,1] neg_hi:[0,1]
    v_cvt_pk_bf16_f32 v181, v86, v87
    v_pk_add_f32 v[88:89], v[88:89], v[158:159] op_sel_hi:[1,0] neg_lo:[0,1] neg_hi:[0,1]
    v_cvt_pk_bf16_f32 v182, v88, v89
    v_pk_add_f32 v[90:91], v[90:91], v[158:159] op_sel_hi:[1,0] neg_lo:[0,1] neg_hi:[0,1]
    v_cvt_pk_bf16_f32 v183, v90, v91
    s_add_u32 s42, s40, 0x1000
    buffer_store_dwordx4 v[180:183], v148, s[32:35], s42 offen sc1
    v_pk_add_f32 v[92:93], v[92:93], v[158:159] op_sel_hi:[1,0] neg_lo:[0,1] neg_hi:[0,1]
    v_cvt_pk_bf16_f32 v184, v92, v93
    v_pk_add_f32 v[94:95], v[94:95], v[158:159] op_sel_hi:[1,0] neg_lo:[0,1] neg_hi:[0,1]
    v_cvt_pk_bf16_f32 v185, v94, v95
    v_pk_add_f32 v[96:97], v[96:97], v[158:159] op_sel_hi:[1,0] neg_lo:[0,1] neg_hi:[0,1]
    v_cvt_pk_bf16_f32 v186, v96, v97
    v_pk_add_f32 v[98:99], v[98:99], v[158:159] op_sel_hi:[1,0] neg_lo:[0,1] neg_hi:[0,1]
    v_cvt_pk_bf16_f32 v187, v98, v99
    s_add_u32 s42, s40, 0x1400
    buffer_store_dwordx4 v[184:187], v148, s[32:35], s42 offen sc1
    s_waitcnt lgkmcnt(0)
    s_nop 1
    s_branch L_c_start
L_aux:
    s_sub_u32 s36, s3, 5
    v_mov_b32 v11, 0
    v_and_b32 v1, 15, v0
    v_lshrrev_b32 v2, 4, v0
    v_lshlrev_b32 v12, 4, v0
    v_mov_b32 v16, -1
    v_mov_b32 v17, -1
    v_mov_b32 v18, -1
    v_mov_b32 v19, -1
    s_waitcnt lgkmcnt(0)
    s_mov_b32 s32, s22
    s_mov_b32 s33, s23
    s_mov_b32 s34, 0x1000000
    s_mov_b32 s35, 0x20000
    s_cmp_ge_u32 s2, 3
    s_cbranch_scc1 L_aux_noinv0
    s_cmp_lg_u32 s36, 1
    s_cbranch_scc1 L_aux_noinv0
    s_lshl_b32 s38, s2, 11
    s_add_u32 s38, s38, 0x500000
    buffer_store_dwordx4 v[16:19], v12, s[32:35], s38 offen sc1
    buffer_store_dwordx4 v[16:19], v12, s[32:35], s38 offen offset:1024 sc1
    s_memrealtime s[52:53]
    s_waitcnt lgkmcnt(0)
    s_mul_i32 s54, s52, 0x9e3779b1
    s_mov_b32 s55, s53
    s_lshr_b64 s[56:57], s[54:55], 0
    s_lshl_b32 s39, s56, 1
    s_and_b32 s39, s39, 0xfffe
    v_mov_b32 v20, s39
    s_lshr_b64 s[56:57], s[54:55], 15
    s_lshl_b32 s39, s56, 1
    s_and_b32 s39, s39, 0xfffe
    v_mov_b32 v21, s39
    s_lshr_b64 s[56:57], s[54:55], 30
    s_lshl_b32 s39, s56, 1
    s_and_b32 s39, s39, 0xfffe
    v_mov_b32 v22, s39
    s_mul_i32 s39, s54, 0x85ebca6b
    s_lshr_b32 s39, s39, 16
    s_and_b32 s39, s39, 0xfffe
    v_mov_b32 v23, s39
    s_lshl_b32 s38, s2, 7
    s_add_u32 s38, s38, 0x501800
    s_mov_b64 exec, 1
    buffer_store_dwordx4 v[20:23], v11, s[32:35], s38 offen sc1
    s_mov_b64 exec, -1
L_aux_noinv0:
    s_barrier
    s_mov_b32 s44, s20
    s_mov_b32 s45, s21
    s_mov_b32 s46, 0x100
    s_mov_b32 s47, 0x20000
    s_cmp_ge_u32 s2, 3
    s_cbranch_scc1 L_aux_noinv
    s_cmp_lg_u32 s36, 1
    s_cbranch_scc1 L_aux_noinv
    v_mov_b32 v14, 1
    s_lshl_b32 s38, s2, 5
    s_waitcnt vmcnt(0)
    ds_write_b32 v11, v14 offset:6960
    s_mov_b64 exec, 1
    buffer_store_dword v14, v11, s[44:47], s38 offen sc1
    s_mov_b64 exec, -1
    s_nop 2
L_aux_noinv:
    s_cmp_lt_u32 s2, 3
    s_cselect_b32 s39, 40, 0
    v_mov_b32 v15, s39
    s_cmp_lg_u32 s36, 0
    s_cbranch_scc1 L_aux_w
    v_mul_u32_u24 v14, 0x180, v1
    v_and_b32 v16, 1, v2
    v_lshl_add_u32 v14, v16, 3, v14
    v_lshrrev_b32 v16, 1, v2
    v_and_b32 v13, 6, v1
    v_xor_b32 v16, v16, v13
    v_xor_b32 v13, 0, v16
    v_lshl_add_u32 v232, v13, 4, v14
    v_xor_b32 v13, 2, v16
    v_lshl_add_u32 v233, v13, 4, v14
    v_xor_b32 v13, 4, v16
    v_lshl_add_u32 v234, v13, 4, v14
    v_xor_b32 v13, 6, v16
    v_lshl_add_u32 v235, v13, 4, v14
    v_lshlrev_b32 v13, 5, v0
    s_cmp_lt_u32 s2, 6
    s_cselect_b32 s38, 1, 3
L_spin87:
    ds_read_b32 v14, v15 offset:6912
    s_waitcnt lgkmcnt(0)
    v_readfirstlane_b32 s37, v14
    s_nop 0
    s_cmp_ge_u32 s37, s38
    s_cbranch_scc1 L_spun88
    s_sleep 4
    s_branch L_spin87
L_spun88:
    s_mov_b64 exec, 7
L_qpoll:
    buffer_load_dword v14, v13, s[44:47], 0 offen sc1
    s_waitcnt vmcnt(0)
    v_cmp_eq_u32 vcc, 0, v14
    s_cbranch_vccz L_qpolled
    s_sleep 8
    s_branch L_qpoll
L_qpolled:
    s_mov_b64 exec, -1
    s_cmp_lt_u32 s2, 6
    s_cselect_b32 s38, 3, 6
    s_cmp_lt_u32 s2, 3
    s_cselect_b32 s38, 4, s38
L_spin89:
    ds_read_b32 v14, v15 offset:6912
    s_waitcnt lgkmcnt(0)
    v_readfirstlane_b32 s37, v14
    s_nop 0
    s_cmp_ge_u32 s37, s38
    s_cbranch_scc1 L_spun90
    s_sleep 2
    s_branch L_spin89
L_spun90:
    s_mov_b32 s38, 0x501800
    buffer_load_dwordx4 v[236:239], v11, s[32:35], s38 offen sc1
L_qdata:
    s_mov_b32 s38, 0x500000
    buffer_load_dwordx4 v[208:211], v12, s[32:35], s38 offen sc1
    s_mov_b32 s38, 0x500400
    buffer_load_dwordx4 v[212:215], v12, s[32:35], s38 offen sc1
    s_mov_b32 s38, 0x500800
    buffer_load_dwordx4 v[216:219], v12, s[32:35], s38 offen sc1
    s_mov_b32 s38, 0x500c00
    buffer_load_dwordx4 v[220:223], v12, s[32:35], s38 offen sc1
    s_mov_b32 s38, 0x501000
    buffer_load_dwordx4 v[224:227], v12, s[32:35], s38 offen sc1
    s_mov_b32 s38, 0x501400
    buffer_load_dwordx4 v[228:231], v12, s[32:35], s38 offen sc1
    s_waitcnt vmcnt(0)
    v_max3_u32 v14, v208, v209, v210
    v_max3_u32 v14, v14, v211, v212
    v_max3_u32 v14, v14, v213, v214
    v_max3_u32 v14, v14, v215, v216
    v_max3_u32 v14, v14, v217, v218
    v_max3_u32 v14, v14, v219, v220
    v_max3_u32 v14, v14, v221, v222
    v_max3_u32 v14, v14, v223, v224
    v_max3_u32 v14, v14, v225, v226
    v_max3_u32 v14, v14, v227, v228
    v_max3_u32 v14, v14, v229, v230
    v_max_u32 v14, v14, v231
    v_cmp_eq_u32 vcc, -1, v14
    s_cbranch_vccnz L_qdata
    ds_write_b128 v11, v[236:239] offset:7040
    ds_write_b64 v232, v[208:209]
    ds_write_b64 v233, v[210:211]
    ds_write_b64 v234, v[212:213]
    ds_write_b64 v235, v[214:215]
    ds_write_b64 v232, v[216:217] offset:128
    ds_write_b64 v233, v[218:219] offset:128
    ds_write_b64 v234, v[220:221] offset:128
    ds_write_b64 v235, v[222:223] offset:128
    ds_write_b64 v232, v[224:225] offset:256
    ds_write_b64 v233, v[226:227] offset:256
    ds_write_b64 v234, v[228:229] offset:256
    ds_write_b64 v235, v[230:231] offset:256
    v_mov_b32 v14, 1
    ds_write_b32 v11, v14 offset:6944
    s_nop 0
L_aux_w:
    s_cmp_lg_u32 s36, 2
    s_cbranch_scc1 L_aux_wf2
    v_lshlrev_b32 v13, 2, v0
    s_nop 1
L_spin91:
    ds_read_b32 v14, v11 offset:6912
    s_waitcnt lgkmcnt(0)
    v_readfirstlane_b32 s37, v14
    s_nop 0
    s_cmp_ge_u32 s37, 10
    s_cbranch_scc1 L_spun92
    s_sleep 8
    s_branch L_spin91
L_spun92:
L_spin93:
    ds_read_b32 v14, v11 offset:6944
    s_waitcnt lgkmcnt(0)
    v_readfirstlane_b32 s37, v14
    s_nop 0
    s_cmp_ge_u32 s37, 1
    s_cbranch_scc1 L_spun94
    s_sleep 8
    s_branch L_spin93
L_spun94:
    s_mov_b64 exec, 0xfff
L_wpoll:
    buffer_load_dword v14, v13, s[44:47], 0 offen offset:80 sc1
    s_waitcnt vmcnt(0)
    v_cmp_eq_u32 vcc, 0, v14
    s_cbranch_vccz L_wpolled
    s_sleep 16
    s_branch L_wpoll
L_wpolled:
    s_mov_b64 exec, -1
    v_mov_b32 v14, 1
    ds_write_b32 v11, v14 offset:6976
    s_nop 0
L_aux_wf2:
L_spin95:
    ds_read_b32 v14, v11 offset:6976
    s_waitcnt lgkmcnt(0)
    v_readfirstlane_b32 s37, v14
    s_nop 0
    s_cmp_ge_u32 s37, 1
    s_cbranch_scc1 L_spun96
    s_sleep 8
    s_branch L_spin95
L_spun96:
    s_mul_i32 s37, s36, 0x4800
    s_add_u32 s37, s37, 0x540000
    s_add_u32 s38, s37, 0
    buffer_load_dwordx4 v[112:115], v12, s[32:35], s38 offen sc1
    s_add_u32 s38, s37, 0x400
    buffer_load_dwordx4 v[124:127], v12, s[32:35], s38 offen sc1
    s_add_u32 s38, s37, 0x800
    buffer_load_dwordx4 v[136:139], v12, s[32:35], s38 offen sc1
    s_waitcnt vmcnt(0)
    s_add_u32 s38, s37, 0xc00
    buffer_load_dwordx4 v[148:151], v12, s[32:35], s38 offen sc1
    s_add_u32 s38, s37, 0x1000
    buffer_load_dwordx4 v[160:163], v12, s[32:35], s38 offen sc1
    s_add_u32 s38, s37, 0x1400
    buffer_load_dwordx4 v[172:175], v12, s[32:35], s38 offen sc1
    s_waitcnt vmcnt(0)
    s_add_u32 s38, s37, 0x1800
    buffer_load_dwordx4 v[116:119], v12, s[32:35], s38 offen sc1
    s_add_u32 s38, s37, 0x1c00
    buffer_load_dwordx4 v[128:131], v12, s[32:35], s38 offen sc1
    s_add_u32 s38, s37, 0x2000
    buffer_load_dwordx4 v[140:143], v12, s[32:35], s38 offen sc1
    s_waitcnt vmcnt(0)
    s_add_u32 s38, s37, 0x2400
    buffer_load_dwordx4 v[152:155], v12, s[32:35], s38 offen sc1
    s_add_u32 s38, s37, 0x2800
    buffer_load_dwordx4 v[164:167], v12, s[32:35], s38 offen sc1
    s_add_u32 s38, s37, 0x2c00
    buffer_load_dwordx4 v[176:179], v12, s[32:35], s38 offen sc1
    s_waitcnt vmcnt(0)
    s_add_u32 s38, s37, 0x3000
    buffer_load_dwordx4 v[120:123], v12, s[32:35], s38 offen sc1
    s_add_u32 s38, s37, 0x3400
    buffer_load_dwordx4 v[132:135], v12, s[32:35], s38 offen sc1
    s_add_u32 s38, s37, 0x3800
    buffer_load_dwordx4 v[144:147], v12, s[32:35], s38 offen sc1
    s_waitcnt vmcnt(0)
    s_add_u32 s38, s37, 0x3c00
    buffer_load_dwordx4 v[156:159], v12, s[32:35], s38 offen sc1
    s_add_u32 s38, s37, 0x4000
    buffer_load_dwordx4 v[168:171], v12, s[32:35], s38 offen sc1
    s_add_u32 s38, s37, 0x4400
    buffer_load_dwordx4 v[180:183], v12, s[32:35], s38 offen sc1
    s_waitcnt vmcnt(0)
L_tail:
    v_lshlrev_b32 v6, 4, v1
    v_add_u32 v2, 0x3400, v12
    v_add_u32 v3, 0x15400, v12
    v_add_u32 v4, 0x6400, v6
    v_add_u32 v5, 0x18400, v6
    s_lshl_b32 s49, s2, 13
    s_lshl_b32 s38, s36, 11
    s_add_u32 s49, s49, s38
    s_mov_b32 s51, 0x42200000
    v_and_b32 v8, 3, v1
    v_lshlrev_b32 v8, 2, v8
    ds_read_b32 v200, v8 offset:7040
    s_nop 0
L_spin97:
    ds_read_b32 v15, v11 offset:6992
    s_waitcnt lgkmcnt(0)
    v_readfirstlane_b32 s37, v15
    s_nop 0
    s_cmp_ge_u32 s37, 1
    s_cbranch_scc1 L_spun98
    s_sleep 1
    s_branch L_spin97
L_spun98:
    ds_read_b32 v76, v11 offset:6992
    ds_read_b128 v[48:51], v2
    ds_read_b128 v[52:55], v2 offset:1024
    ds_read_b128 v[56:59], v2 offset:2048
    ds_read_b128 v[60:63], v2 offset:3072
    ds_read_b128 v[64:67], v2 offset:4096
    ds_read_b128 v[68:71], v2 offset:5120
    ds_read_b128 v[72:75], v4
    s_waitcnt vmcnt(0)
L_bt99:
    s_waitcnt lgkmcnt(0)
    v_readfirstlane_b32 s37, v76
    s_nop 0
    s_cmp_eq_u32 s37, 1
    s_cbranch_scc1 L_bo100
    s_cmp_eq_u32 s37, 2
    s_cbranch_scc1 L_agen
    ds_read_b32 v76, v11 offset:6992
    ds_read_b128 v[48:51], v2
    ds_read_b128 v[52:55], v2 offset:1024
    ds_read_b128 v[56:59], v2 offset:2048
    ds_read_b128 v[60:63], v2 offset:3072
    ds_read_b128 v[64:67], v2 offset:4096
    ds_read_b128 v[68:71], v2 offset:5120
    ds_read_b128 v[72:75], v4
    s_branch L_bt99
L_bo100:
    v_mfma_f32_16x16x32_bf16 v[16:19], v[112:115], v[48:51], 0
    ds_read_b32 v108, v11 offset:6996
    v_mfma_f32_16x16x32_bf16 v[20:23], v[116:119], v[48:51], 0
    ds_read_b128 v[80:83], v2 offset:36864
    v_mfma_f32_16x16x32_bf16 v[24:27], v[120:123], v[48:51], 0
    ds_read_b128 v[84:87], v2 offset:37888
    v_mfma_f32_16x16x32_bf16 v[16:19], v[124:127], v[52:55], v[16:19]
    ds_read_b128 v[88:91], v2 offset:38912
    v_mfma_f32_16x16x32_bf16 v[20:23], v[128:131], v[52:55], v[20:23]
    ds_read_b128 v[92:95], v2 offset:39936
    v_mfma_f32_16x16x32_bf16 v[24:27], v[132:135], v[52:55], v[24:27]
    ds_read_b128 v[96:99], v2 offset:40960
    v_mfma_f32_16x16x32_bf16 v[16:19], v[136:139], v[56:59], v[16:19]
    ds_read_b128 v[100:103], v2 offset:41984
    v_mfma_f32_16x16x32_bf16 v[20:23], v[140:143], v[56:59], v[20:23]
    ds_read_b128 v[104:107], v4 offset:36864
    v_mfma_f32_16x16x32_bf16 v[24:27], v[144:147], v[56:59], v[24:27]
    v_add_f32 v72, v72, v73
    v_mfma_f32_16x16x32_bf16 v[16:19], v[148:151], v[60:63], v[16:19]
    v_add_f32 v74, v74, v75
    v_mfma_f32_16x16x32_bf16 v[20:23], v[152:155], v[60:63], v[20:23]
    v_add_f32 v7, v72, v74
    v_mfma_f32_16x16x32_bf16 v[24:27], v[156:159], v[60:63], v[24:27]
    v_mfma_f32_16x16x32_bf16 v[16:19], v[160:163], v[64:67], v[16:19]
    v_mfma_f32_16x16x32_bf16 v[20:23], v[164:167], v[64:67], v[20:23]
    v_mfma_f32_16x16x32_bf16 v[24:27], v[168:171], v[64:67], v[24:27]
    v_mfma_f32_16x16x32_bf16 v[16:19], v[172:175], v[68:71], v[16:19]
    v_mfma_f32_16x16x32_bf16 v[20:23], v[176:179], v[68:71], v[20:23]
    v_mfma_f32_16x16x32_bf16 v[24:27], v[180:183], v[68:71], v[24:27]
L_bt101:
    s_waitcnt lgkmcnt(0)
    v_readfirstlane_b32 s37, v108
    s_nop 0
    s_cmp_eq_u32 s37, 1
    s_cbranch_scc1 L_bo102
    s_cmp_eq_u32 s37, 2
    s_cbranch_scc1 L_agen
    ds_read_b32 v108, v11 offset:6996
    ds_read_b128 v[80:83], v2 offset:36864
    ds_read_b128 v[84:87], v2 offset:37888
    ds_read_b128 v[88:91], v2 offset:38912
    ds_read_b128 v[92:95], v2 offset:39936
    ds_read_b128 v[96:99], v2 offset:40960
    ds_read_b128 v[100:103], v2 offset:41984
    ds_read_b128 v[104:107], v4 offset:36864
    s_branch L_bt101
L_bo102:
    v_mfma_f32_16x16x32_bf16 v[16:19], v[112:115], v[80:83], v[16:19]
    ds_read_b32 v76, v11 offset:7000
    v_mfma_f32_16x16x32_bf16 v[20:23], v[116:119], v[80:83], v[20:23]
    ds_read_b128 v[48:51], v3
    v_mfma_f32_16x16x32_bf16 v[24:27], v[120:123], v[80:83], v[24:27]
    ds_read_b128 v[52:55], v3 offset:1024
    v_mfma_f32_16x16x32_bf16 v[16:19], v[124:127], v[84:87], v[16:19]
    ds_read_b128 v[56:59], v3 offset:2048
    v_mfma_f32_16x16x32_bf16 v[20:23], v[128:131], v[84:87], v[20:23]
    ds_read_b128 v[60:63], v3 offset:3072
    v_mfma_f32_16x16x32_bf16 v[24:27], v[132:135], v[84:87], v[24:27]
    ds_read_b128 v[64:67], v3 offset:4096
    v_mfma_f32_16x16x32_bf16 v[16:19], v[136:139], v[88:91], v[16:19]
    ds_read_b128 v[68:71], v3 offset:5120
    v_mfma_f32_16x16x32_bf16 v[20:23], v[140:143], v[88:91], v[20:23]
    ds_read_b128 v[72:75], v5
    v_mfma_f32_16x16x32_bf16 v[24:27], v[144:147], v[88:91], v[24:27]
    v_add_f32 v104, v104, v105
    v_mfma_f32_16x16x32_bf16 v[16:19], v[148:151], v[92:95], v[16:19]
    v_add_f32 v106, v106, v107
    v_mfma_f32_16x16x32_bf16 v[20:23], v[152:155], v[92:95], v[20:23]
    v_add_f32 v104, v104, v106
    v_mfma_f32_16x16x32_bf16 v[24:27], v[156:159], v[92:95], v[24:27]
    v_add_f32 v7, v7, v104
    v_mfma_f32_16x16x32_bf16 v[16:19], v[160:163], v[96:99], v[16:19]
    v_mfma_f32_16x16x32_bf16 v[20:23], v[164:167], v[96:99], v[20:23]
    v_mfma_f32_16x16x32_bf16 v[24:27], v[168:171], v[96:99], v[24:27]
    v_mfma_f32_16x16x32_bf16 v[16:19], v[172:175], v[100:103], v[16:19]
    v_mfma_f32_16x16x32_bf16 v[20:23], v[176:179], v[100:103], v[20:23]
    v_mfma_f32_16x16x32_bf16 v[24:27], v[180:183], v[100:103], v[24:27]
L_bt103:
    s_waitcnt lgkmcnt(0)
    v_readfirstlane_b32 s37, v76
    s_nop 0
    s_cmp_eq_u32 s37, 1
    s_cbranch_scc1 L_bo104
    s_cmp_eq_u32 s37, 2
    s_cbranch_scc1 L_agen
    ds_read_b32 v76, v11 offset:7000
    ds_read_b128 v[48:51], v3
    ds_read_b128 v[52:55], v3 offset:1024
    ds_read_b128 v[56:59], v3 offset:2048
    ds_read_b128 v[60:63], v3 offset:3072
    ds_read_b128 v[64:67], v3 offset:4096
    ds_read_b128 v[68:71], v3 offset:5120
    ds_read_b128 v[72:75], v5
    s_branch L_bt103
L_bo104:
    v_mfma_f32_16x16x32_bf16 v[16:19], v[112:115], v[48:51], v[16:19]
    ds_read_b32 v108, v11 offset:7004
    v_mfma_f32_16x16x32_bf16 v[20:23], v[116:119], v[48:51], v[20:23]
    ds_read_b128 v[80:83], v3 offset:36864
    v_mfma_f32_16x16x32_bf16 v[24:27], v[120:123], v[48:51], v[24:27]
    ds_read_b128 v[84:87], v3 offset:37888
    v_mfma_f32_16x16x32_bf16 v[16:19], v[124:127], v[52:55], v[16:19]
    ds_read_b128 v[88:91], v3 offset:38912
    v_mfma_f32_16x16x32_bf16 v[20:23], v[128:131], v[52:55], v[20:23]
    ds_read_b128 v[92:95], v3 offset:39936
    v_mfma_f32_16x16x32_bf16 v[24:27], v[132:135], v[52:55], v[24:27]
    ds_read_b128 v[96:99], v3 offset:40960
    v_mfma_f32_16x16x32_bf16 v[16:19], v[136:139], v[56:59], v[16:19]
    ds_read_b128 v[100:103], v3 offset:41984
    v_mfma_f32_16x16x32_bf16 v[20:23], v[140:143], v[56:59], v[20:23]
    ds_read_b128 v[104:107], v5 offset:36864
    v_mfma_f32_16x16x32_bf16 v[24:27], v[144:147], v[56:59], v[24:27]
    v_add_f32 v72, v72, v73
    v_mfma_f32_16x16x32_bf16 v[16:19], v[148:151], v[60:63], v[16:19]
    v_add_f32 v74, v74, v75
    v_mfma_f32_16x16x32_bf16 v[20:23], v[152:155], v[60:63], v[20:23]
    v_add_f32 v72, v72, v74
    v_mfma_f32_16x16x32_bf16 v[24:27], v[156:159], v[60:63], v[24:27]
    v_add_f32 v7, v7, v72
    v_mfma_f32_16x16x32_bf16 v[16:19], v[160:163], v[64:67], v[16:19]
    v_mfma_f32_16x16x32_bf16 v[20:23], v[164:167], v[64:67], v[20:23]
    v_mfma_f32_16x16x32_bf16 v[24:27], v[168:171], v[64:67], v[24:27]
    v_mfma_f32_16x16x32_bf16 v[16:19], v[172:175], v[68:71], v[16:19]
    v_mfma_f32_16x16x32_bf16 v[20:23], v[176:179], v[68:71], v[20:23]
    v_mfma_f32_16x16x32_bf16 v[24:27], v[180:183], v[68:71], v[24:27]
L_bt105:
    s_waitcnt lgkmcnt(0)
    v_readfirstlane_b32 s37, v108
    s_nop 0
    s_cmp_eq_u32 s37, 1
    s_cbranch_scc1 L_bo106
    s_cmp_eq_u32 s37, 2
    s_cbranch_scc1 L_agen
    ds_read_b32 v108, v11 offset:7004
    ds_read_b128 v[80:83], v3 offset:36864
    ds_read_b128 v[84:87], v3 offset:37888
    ds_read_b128 v[88:91], v3 offset:38912
    ds_read_b128 v[92:95], v3 offset:39936
    ds_read_b128 v[96:99], v3 offset:40960
    ds_read_b128 v[100:103], v3 offset:41984
    ds_read_b128 v[104:107], v5 offset:36864
    s_branch L_bt105
L_bo106:
    v_mfma_f32_16x16x32_bf16 v[16:19], v[112:115], v[80:83], v[16:19]
    v_add_f32 v104, v104, v105
    v_mfma_f32_16x16x32_bf16 v[20:23], v[116:119], v[80:83], v[20:23]
    v_add_f32 v106, v106, v107
    v_mfma_f32_16x16x32_bf16 v[16:19], v[124:127], v[84:87], v[16:19]
    v_add_f32 v104, v104, v106
    v_mfma_f32_16x16x32_bf16 v[20:23], v[128:131], v[84:87], v[20:23]
    v_add_f32 v7, v7, v104
    v_mfma_f32_16x16x32_bf16 v[16:19], v[136:139], v[88:91], v[16:19]
    v_cvt_pk_bf16_f32 v8, 0, v7
    v_mfma_f32_16x16x32_bf16 v[20:23], v[140:143], v[88:91], v[20:23]
    v_or_b32 v195, v8, v200
    v_mfma_f32_16x16x32_bf16 v[16:19], v[148:151], v[92:95], v[16:19]
    v_or_b32 v199, v8, v200
    v_mfma_f32_16x16x32_bf16 v[20:23], v[152:155], v[92:95], v[20:23]
    v_mfma_f32_16x16x32_bf16 v[16:19], v[160:163], v[96:99], v[16:19]
    v_mfma_f32_16x16x32_bf16 v[20:23], v[164:167], v[96:99], v[20:23]
    v_mfma_f32_16x16x32_bf16 v[16:19], v[172:175], v[100:103], v[16:19]
    v_mfma_f32_16x16x32_bf16 v[20:23], v[176:179], v[100:103], v[20:23]
    v_mfma_f32_16x16x32_bf16 v[24:27], v[120:123], v[80:83], v[24:27]
    v_mfma_f32_16x16x32_bf16 v[24:27], v[132:135], v[84:87], v[24:27]
    v_mfma_f32_16x16x32_bf16 v[24:27], v[144:147], v[88:91], v[24:27]
    s_nop 2
    s_nop 0
    v_cvt_pk_bf16_f32 v192, v16, v17
    v_cvt_pk_bf16_f32 v193, v18, v19
    v_mfma_f32_16x16x32_bf16 v[24:27], v[156:159], v[92:95], v[24:27]
    v_cvt_pk_bf16_f32 v194, v20, v21
    buffer_store_dwordx4 v[192:195], v12, s[32:35], s49 offen sc1
    v_mfma_f32_16x16x32_bf16 v[24:27], v[168:171], v[96:99], v[24:27]
    v_cvt_pk_bf16_f32 v196, v22, v23
    v_mfma_f32_16x16x32_bf16 v[24:27], v[180:183], v[100:103], v[24:27]
    s_nop 7
    v_cvt_pk_bf16_f32 v197, v24, v25
    v_cvt_pk_bf16_f32 v198, v26, v27
    buffer_store_dwordx4 v[196:199], v12, s[32:35], s49 offen offset:1024 sc1
L_aend:
    v_mov_b32 v15, 1
    s_mov_b64 exec, 1
    ds_add_u32 v11, v15 offset:6964
    s_mov_b64 exec, -1
    s_endpgm
L_agen:
L_spin107:
    ds_read_b32 v15, v11 offset:6992
    s_waitcnt lgkmcnt(0)
    v_readfirstlane_b32 s37, v15
    s_nop 0
    s_cmp_ge_u32 s37, 1
    s_cbranch_scc1 L_spun108
    s_sleep 1
    s_branch L_spin107
L_spun108:
    v_add_u32 v3, 0x6400, v6
    ds_read_b32 v205, v3 offset:512
    s_waitcnt lgkmcnt(0)
    v_mov_b32 v9, v205
    s_nop 1
L_spin109:
    ds_read_b32 v15, v11 offset:6996
    s_waitcnt lgkmcnt(0)
    v_readfirstlane_b32 s37, v15
    s_nop 0
    s_cmp_ge_u32 s37, 1
    s_cbranch_scc1 L_spun110
    s_sleep 1
    s_branch L_spin109
L_spun110:
    v_add_u32 v3, 0xf400, v6
    ds_read_b32 v205, v3 offset:512
    s_waitcnt lgkmcnt(0)
    v_max_f32 v9, v9, v205
    s_nop 1
L_spin111:
    ds_read_b32 v15, v11 offset:7000
    s_waitcnt lgkmcnt(0)
    v_readfirstlane_b32 s37, v15
    s_nop 0
    s_cmp_ge_u32 s37, 1
    s_cbranch_scc1 L_spun112
    s_sleep 1
    s_branch L_spin111
L_spun112:
    v_add_u32 v3, 0x18400, v6
    ds_read_b32 v205, v3 offset:512
    s_waitcnt lgkmcnt(0)
    v_max_f32 v9, v9, v205
    s_nop 1
L_spin113:
    ds_read_b32 v15, v11 offset:7004
    s_waitcnt lgkmcnt(0)
    v_readfirstlane_b32 s37, v15
    s_nop 0
    s_cmp_ge_u32 s37, 1
    s_cbranch_scc1 L_spun114
    s_sleep 1
    s_branch L_spin113
L_spun114:
    v_add_u32 v3, 0x21400, v6
    ds_read_b32 v205, v3 offset:512
    s_waitcnt lgkmcnt(0)
    v_max_f32 v9, v9, v205
    v_cmp_nlt_f32_e64 s[56:57], |v9|, s51
    s_nop 1
    v_cndmask_b32 v10, 0, v9, s[56:57]
    v_mov_b32 v7, 0
    v_mov_b32 v16, 0
    v_mov_b32 v17, 0
    v_mov_b32 v18, 0
    v_mov_b32 v19, 0
    v_mov_b32 v20, 0
    v_mov_b32 v21, 0
    v_mov_b32 v22, 0
    v_mov_b32 v23, 0
    v_mov_b32 v24, 0
    v_mov_b32 v25, 0
    v_mov_b32 v26, 0
    v_mov_b32 v27, 0
    s_mov_b32 s58, 0
    s_nop 0
L_agen_w:
    s_mul_i32 s59, s58, 0x9000
    s_add_u32 s59, s59, 0x3400
    v_add_u32 v2, s59, v12
    v_add_u32 v3, s59, v6
    ds_read_b128 v[48:51], v2
    ds_read_b128 v[52:55], v2 offset:1024
    ds_read_b128 v[56:59], v2 offset:2048
    ds_read_b128 v[60:63], v2 offset:3072
    ds_read_b128 v[64:67], v2 offset:4096
    ds_read_b128 v[68:71], v2 offset:5120
    ds_read_b32 v205, v3 offset:12800
    ds_read_b128 v[72:75], v3 offset:12288
    s_waitcnt lgkmcnt(0)
    v_mfma_f32_16x16x32_bf16 v[32:35], v[112:115], v[48:51], 0
    v_mfma_f32_16x16x32_bf16 v[36:39], v[116:119], v[48:51], 0
    v_mfma_f32_16x16x32_bf16 v[40:43], v[120:123], v[48:51], 0
    v_mfma_f32_16x16x32_bf16 v[32:35], v[124:127], v[52:55], v[32:35]
    v_mfma_f32_16x16x32_bf16 v[36:39], v[128:131], v[52:55], v[36:39]
    v_mfma_f32_16x16x32_bf16 v[40:43], v[132:135], v[52:55], v[40:43]
    v_mfma_f32_16x16x32_bf16 v[32:35], v[136:139], v[56:59], v[32:35]
    v_mfma_f32_16x16x32_bf16 v[36:39], v[140:143], v[56:59], v[36:39]
    v_mfma_f32_16x16x32_bf16 v[40:43], v[144:147], v[56:59], v[40:43]
    v_mfma_f32_16x16x32_bf16 v[32:35], v[148:151], v[60:63], v[32:35]
    v_mfma_f32_16x16x32_bf16 v[36:39], v[152:155], v[60:63], v[36:39]
    v_mfma_f32_16x16x32_bf16 v[40:43], v[156:159], v[60:63], v[40:43]
    v_mfma_f32_16x16x32_bf16 v[32:35], v[160:163], v[64:67], v[32:35]
    v_mfma_f32_16x16x32_bf16 v[36:39], v[164:167], v[64:67], v[36:39]
    v_mfma_f32_16x16x32_bf16 v[40:43], v[168:171], v[64:67], v[40:43]
    v_mfma_f32_16x16x32_bf16 v[32:35], v[172:175], v[68:71], v[32:35]
    v_mfma_f32_16x16x32_bf16 v[36:39], v[176:179], v[68:71], v[36:39]
    v_mfma_f32_16x16x32_bf16 v[40:43], v[180:183], v[68:71], v[40:43]
    v_sub_f32 v14, v205, v10
    v_exp_f32 v13, v14
    v_add_f32 v72, v72, v73
    v_add_f32 v74, v74, v75
    v_add_f32 v72, v72, v74
    v_fmac_f32 v7, v13, v72
    v_fmac_f32 v16, v13, v32
    v_fmac_f32 v17, v13, v33
    v_fmac_f32 v18, v13, v34
    v_fmac_f32 v19, v13, v35
    v_fmac_f32 v20, v13, v36
    v_fmac_f32 v21, v13, v37
    v_fmac_f32 v22, v13, v38
    v_fmac_f32 v23, v13, v39
    v_fmac_f32 v24, v13, v40
    v_fmac_f32 v25, v13, v41
    v_fmac_f32 v26, v13, v42
    v_fmac_f32 v27, v13, v43
    s_add_u32 s58, s58, 1
    s_cmp_lt_u32 s58, 4
    s_cbranch_scc1 L_agen_w
    v_cndmask_b32 v14, 0, 1, s[56:57]
    v_or_b32 v200, v200, v14
    ds_read_b64 v[74:75], v11 offset:7040
    v_mov_b32 v72, v10
    v_lshrrev_b32 v14, 1, v6
    s_lshl_b32 s38, s2, 7
    s_add_u32 s38, s38, 0x400000
    s_waitcnt lgkmcnt(0)
    v_lshl_or_b32 v73, v75, 16, v74
    s_mov_b64 exec, 0xffff
    buffer_store_dwordx2 v[72:73], v14, s[32:35], s38 offen sc1
    s_mov_b64 exec, -1
    v_cvt_pk_bf16_f32 v8, 0, v7
    v_or_b32 v195, v8, v200
    v_or_b32 v199, v8, v200
    v_cvt_pk_bf16_f32 v192, v16, v17
    v_cvt_pk_bf16_f32 v193, v18, v19
    v_cvt_pk_bf16_f32 v194, v20, v21
    buffer_store_dwordx4 v[192:195], v12, s[32:35], s49 offen sc1
    v_cvt_pk_bf16_f32 v196, v22, v23
    v_cvt_pk_bf16_f32 v197, v24, v25
    v_cvt_pk_bf16_f32 v198, v26, v27
    buffer_store_dwordx4 v[196:199], v12, s[32:35], s49 offen offset:1024 sc1
    s_nop 1
    s_branch L_aend
L_exit:
    s_endpgm
L_code_end:
.section .rodata,"a"
.p2align 6
.amdhsa_kernel standalone__detection_seg_dino__vision_kernel
  .amdhsa_next_free_vgpr 256
  .amdhsa_next_free_sgpr 96
  .amdhsa_accum_offset 256
  .amdhsa_group_segment_fixed_size 0
  .amdhsa_kernarg_size 80
  .amdhsa_user_sgpr_count 2
  .amdhsa_user_sgpr_kernarg_segment_ptr 1
  .amdhsa_system_sgpr_workgroup_id_x 1
  .amdhsa_float_denorm_mode_32 3
.end_amdhsa_kernel
```

```asm
; @launch grid=(256,1,1) block=(512,1,1) lds=160768
.amdgcn_target "amdgcn-amd-amdhsa--gfx950"
.text
.globl standalone__detection_seg_dino__vision_kernel
.p2align 8
.type standalone__detection_seg_dino__vision_kernel,@function
standalone__detection_seg_dino__vision_kernel:
    s_cmp_ge_u32 s2, 0x100
    s_cbranch_scc1 L_exit
    s_load_dwordx16 s[4:19], s[0:1], 0
    s_load_dwordx4 s[20:23], s[0:1], 64
    v_lshrrev_b32 v1, 6, v0
    v_and_b32 v0, 63, v0
    v_readfirstlane_b32 s3, v1
    s_nop 2
    s_cmp_lt_u32 s3, 4
    s_cbranch_scc1 L_compute
    s_cmp_gt_u32 s3, 4
    s_cbranch_scc1 L_aux0
    s_setprio 3
    v_add_u32 v4, 0, v0
    v_mul_u32_u24 v4, 0xaab, v4
    v_lshrrev_b32 v4, 16, v4
    v_and_b32 v11, 6, v4
    v_xor_b32 v11, v11, v0
    v_lshlrev_b32 v1, 4, v11
    v_add_u32 v5, 64, v0
    v_mul_u32_u24 v5, 0xaab, v5
    v_lshrrev_b32 v5, 16, v5
    v_and_b32 v11, 6, v5
    v_xor_b32 v11, v11, v0
    v_lshlrev_b32 v2, 4, v11
    v_add_u32 v6, 0x80, v0
    v_mul_u32_u24 v6, 0xaab, v6
    v_lshrrev_b32 v6, 16, v6
    v_and_b32 v11, 6, v6
    v_xor_b32 v11, v11, v0
    v_lshlrev_b32 v3, 4, v11
    s_and_b32 s38, s2, 7
    s_lshl_b32 s38, s38, 5
    s_lshr_b32 s45, s2, 3
    s_or_b32 s38, s38, s45
    s_lshl_b32 s38, s38, 2
    s_mov_b32 s27, 0x20000
    s_mov_b32 s26, 0x1800000
    s_mul_i32 s39, s38, 0x1800
    s_mov_b32 s44, 0x3400
    s_cmp_lt_u32 s2, 6
    s_cbranch_scc1 L_ld_prod
    s_waitcnt lgkmcnt(0)
    s_mov_b32 s24, s8
    s_mov_b32 s25, s9
L_ld_first:
    s_mov_b32 m0, s44
    s_add_u32 s46, s39, 0xc00
    buffer_load_dwordx4 v1, s[24:27], s39 offen nt lds
    buffer_load_dwordx4 v2, s[24:27], s39 offen offset:1024 nt lds
    buffer_load_dwordx4 v3, s[24:27], s39 offen offset:2048 nt lds
    s_add_u32 m0, s44, 0xc00
    s_add_u32 s44, s44, 0x9000
    buffer_load_dwordx4 v1, s[24:27], s46 offen nt lds
    buffer_load_dwordx4 v2, s[24:27], s46 offen offset:1024 nt lds
    buffer_load_dwordx4 v3, s[24:27], s46 offen offset:2048 nt lds
    s_add_u32 s39, s39, 0x1800
    s_cmp_lt_u32 s44, 0x27400
    s_cbranch_scc1 L_ld_first
    s_branch L_ld_norm
L_aux0:
    s_getpc_b64 s[24:25]
L_aux_pc:
    s_sub_u32 s24, s24, L_aux_pc-standalone__detection_seg_dino__vision_kernel
    s_subb_u32 s25, s25, 0
    s_mov_b32 s26, L_code_end-standalone__detection_seg_dino__vision_kernel
    s_mov_b32 s27, 0x20000
    s_lshr_b32 s39, s2, 3
    s_mul_i32 s38, s39, 3
    s_add_u32 s38, s38, s3
    s_mul_i32 s38, s38, 0x140
    s_sub_u32 s38, s38, 0x640
    v_lshlrev_b32 v14, 6, v0
    s_mov_b64 exec, 31
    buffer_load_dword v253, v14, s[24:27], s38 offen
    s_mov_b64 exec, -1
    s_and_b32 s38, s2, 7
    s_mul_i32 s37, s3, 3
    s_add_u32 s38, s38, 18
    s_sub_u32 s38, s38, s37
    s_cmp_ge_u32 s38, 3
    s_cbranch_scc1 L_aux
    s_mul_i32 s37, s39, 0x900
    v_mul_u32_u24 v13, 36, v0
    s_mov_b32 s30, 0x12000
    s_mov_b32 s42, 0x12000
    s_mov_b32 s31, s27
    s_mov_b32 s43, s27
    s_cmp_eq_u32 s3, 6
    s_waitcnt lgkmcnt(0)
    s_cselect_b64 s[28:29], s[10:11], s[16:17]
    s_cselect_b64 s[40:41], s[12:13], s[14:15]
    buffer_load_dword v254, v13, s[28:31], s37 offen
    buffer_load_dword v255, v13, s[40:43], s37 offen
    s_branch L_aux
L_ld_prod:
    s_mov_b32 s39, 0
    s_cmp_lt_u32 s2, 3
    s_cbranch_scc0 L_ld_wo0
    s_mov_b32 s26, 0x1800
    s_mov_b32 s44, 0x1c00
    s_mov_b32 s48, 1
    s_waitcnt lgkmcnt(0)
    s_mov_b64 s[24:25], s[4:5]
    s_call_b64 s[54:55], L_ld_tiles
    s_branch L_ld_wq
L_ld_tiles:
    s_mov_b32 m0, s44
    s_add_u32 s46, s39, 0xc00
    buffer_load_dwordx4 v1, s[24:27], s39 offen lds
    buffer_load_dwordx4 v2, s[24:27], s39 offen offset:1024 lds
    buffer_load_dwordx4 v3, s[24:27], s39 offen offset:2048 lds
    s_add_u32 m0, s44, 0xc00
    s_add_u32 s44, s44, 0x1800
    buffer_load_dwordx4 v1, s[24:27], s46 offen lds
    buffer_load_dwordx4 v2, s[24:27], s46 offen offset:1024 lds
    buffer_load_dwordx4 v3, s[24:27], s46 offen offset:2048 lds
    s_add_u32 s39, s39, 0x1800
    s_sub_u32 s48, s48, 1
    s_and_b32 s45, s48, 3
    s_cselect_b32 s45, 0, 0x3000
    s_add_u32 s44, s44, s45
    s_cmp_lg_u32 s48, 0
    s_cbranch_scc1 L_ld_tiles
    s_setpc_b64 s[54:55]
L_ld_wq:
    s_mov_b64 s[24:25], s[10:11]
    s_mov_b32 s26, 0x12000
L_ld_w12:
    s_mov_b32 s39, 0
    s_mov_b32 s44, 0x6400
    s_mov_b32 s48, 4
    s_call_b64 s[54:55], L_ld_tiles
    v_mul_u32_u24 v4, 0x180, v4
    v_add_u32 v4, v4, v1
    v_mul_u32_u24 v5, 0x180, v5
    v_add_u32 v5, v5, v2
    v_mul_u32_u24 v6, 0x180, v6
    v_add_u32 v6, v6, v3
    v_mov_b32 v10, 0
    v_lshlrev_b32 v13, 2, v0
    s_mov_b64 exec, 0xffffffff
    ds_write_b32 v13, v10 offset:6912
    v_mov_b32 v11, 0x3f803f80
    s_mov_b64 exec, 3
    ds_write_b32 v13, v11 offset:7056
    s_mov_b64 exec, -1
    s_mov_b32 s50, 0
    s_mov_b32 s51, 0
    s_mov_b32 s52, 0
    s_mov_b32 s53, 0
    s_mov_b32 s36, 0
    s_mov_b32 s37, 0
    s_mov_b32 s57, 0
    s_waitcnt lgkmcnt(0)
    s_barrier
    s_waitcnt vmcnt(24)
    v_mov_b32 v11, 1
    s_mov_b64 exec, 1
    ds_max_u32 v10, v11 offset:6956
    s_mov_b64 exec, -1
    s_mov_b32 s48, 8
    s_call_b64 s[54:55], L_ld_tiles
    s_cmp_ge_u32 s2, 3
    s_cbranch_scc1 L_ld_w3
    s_mov_b64 s[24:25], s[12:13]
    s_mul_i32 s39, s2, 0x6000
    s_mov_b32 s48, 4
    s_call_b64 s[54:55], L_ld_tiles
L_ld_w3:
    s_waitcnt vmcnt(24)
    v_mov_b32 v11, 2
    s_mov_b64 exec, 1
    ds_max_u32 v10, v11 offset:6956
    s_mov_b64 exec, -1
    s_branch L_ld_stepp
L_ld_wo0:
    s_mov_b32 s26, 0x12000
    v_lshrrev_b32 v11, 3, v0
    v_mul_u32_u24 v11, 0x180, v11
    v_and_b32 v12, 7, v0
    v_lshl_add_u32 v11, v12, 4, v11
    s_sub_u32 s46, s2, 3
    s_lshl_b32 s46, s46, 7
    s_mov_b32 s45, 0x21400
    s_waitcnt lgkmcnt(0)
    s_mov_b64 s[24:25], s[16:17]
L_ld_wo:
    s_mov_b32 m0, s45
    s_add_u32 s45, s45, 0x400
    buffer_load_dwordx4 v11, s[24:27], s46 offen lds
    s_add_u32 s46, s46, 0xc00
    s_cmp_lt_u32 s45, 0x27400
    s_cbranch_scc1 L_ld_wo
    s_mov_b64 s[24:25], s[14:15]
    s_branch L_ld_w12
L_ld_norm:
    v_mul_u32_u24 v4, 0x180, v4
    v_add_u32 v4, v4, v1
    v_mul_u32_u24 v5, 0x180, v5
    v_add_u32 v5, v5, v2
    v_mul_u32_u24 v6, 0x180, v6
    v_add_u32 v6, v6, v3
    v_mov_b32 v10, 0
    v_lshlrev_b32 v13, 2, v0
    s_mov_b64 exec, 0xffffffff
    ds_write_b32 v13, v10 offset:6912
    v_mov_b32 v11, 0x3f803f80
    s_mov_b64 exec, 3
    ds_write_b32 v13, v11 offset:7056
    s_mov_b64 exec, -1
    s_mov_b32 s50, 0
    s_mov_b32 s51, 0
    s_mov_b32 s52, 0
    s_mov_b32 s53, 0
    s_mov_b32 s36, 1
    s_mov_b32 s37, 1
    s_mov_b32 s57, 1
    s_lshr_b32 s45, s38, 4
    s_mul_i32 s40, s45, 0x60000
    s_and_b32 s45, s38, 15
    s_mul_i32 s45, s45, 0x3000
    s_add_u32 s40, s40, s45
    s_add_u32 s38, s38, 0x400
    s_waitcnt lgkmcnt(0)
    s_barrier
L_ld_step:
    s_cmp_lg_u32 s37, 0
    s_cbranch_scc1 L_ld_fine
    s_mul_i32 s39, s38, 0x1800
    s_lshr_b32 s45, s38, 4
    s_mul_i32 s40, s45, 0x60000
    s_and_b32 s45, s38, 15
    s_mul_i32 s45, s45, 0x3000
    s_add_u32 s40, s40, s45
    s_add_u32 s38, s38, 0x400
    s_mov_b32 s24, s8
    s_mov_b32 s25, s9
    s_mov_b32 s26, 0x1800000
    s_mov_b32 s41, s39
    s_mov_b32 s42, 0x1800
    s_mov_b32 s43, 0xc00
    v_mov_b32 v7, v1
    v_mov_b32 v8, v2
    v_mov_b32 v9, v3
    s_branch L_ld_issue
L_ld_fine:
    s_mov_b32 s24, s6
    s_mov_b32 s25, s7
    s_mov_b32 s26, 0x6000000
    s_sub_u32 s45, s37, 1
    s_lshr_b32 s46, s45, 1
    s_mul_i32 s46, s46, 0x30000
    s_and_b32 s45, s45, 1
    s_mul_i32 s45, s45, 0x180
    s_add_u32 s41, s40, s46
    s_add_u32 s41, s41, s45
    s_mov_b32 s42, 0x3000
    s_mov_b32 s43, 0x1800
    v_mov_b32 v7, v4
    v_mov_b32 v8, v5
    v_mov_b32 v9, v6
L_ld_issue:
    s_mul_i32 s44, s57, 0x1800
    s_add_u32 s44, s44, 0x3400
    s_sub_i32 s48, s36, 5
    s_cmp_ge_i32 s50, s48
    s_cbranch_scc1 L_free1
    s_mov_b32 s56, 0
    s_call_b64 s[54:55], L_ld_wait
    s_mov_b32 s50, s45
L_free1:
    s_add_u32 m0, s44, 0
    s_mov_b32 s46, s41
    buffer_load_dwordx4 v7, s[24:27], s46 offen nt lds
    buffer_load_dwordx4 v8, s[24:27], s46 offen offset:1024 nt lds
    buffer_load_dwordx4 v9, s[24:27], s46 offen offset:2048 nt lds
    s_add_u32 m0, s44, 0xc00
    s_add_u32 s46, s41, s43
    buffer_load_dwordx4 v7, s[24:27], s46 offen nt lds
    buffer_load_dwordx4 v8, s[24:27], s46 offen offset:1024 nt lds
    buffer_load_dwordx4 v9, s[24:27], s46 offen offset:2048 nt lds
    s_add_u32 s41, s41, s42
    s_add_i32 s47, s36, 0
    s_max_i32 s47, s47, 0
    s_waitcnt vmcnt(24)
    v_mov_b32 v11, s47
    s_mov_b64 exec, 1
    ds_max_u32 v10, v11 offset:6912
    s_mov_b64 exec, -1
    s_cmp_ge_i32 s51, s48
    s_cbranch_scc1 L_free2
    s_mov_b32 s56, 1
    s_call_b64 s[54:55], L_ld_wait
    s_mov_b32 s51, s45
L_free2:
    s_add_u32 m0, s44, 0x9000
    s_mov_b32 s46, s41
    buffer_load_dwordx4 v7, s[24:27], s46 offen nt lds
    buffer_load_dwordx4 v8, s[24:27], s46 offen offset:1024 nt lds
    buffer_load_dwordx4 v9, s[24:27], s46 offen offset:2048 nt lds
    s_add_u32 m0, s44, 0x9c00
    s_add_u32 s46, s41, s43
    buffer_load_dwordx4 v7, s[24:27], s46 offen nt lds
    buffer_load_dwordx4 v8, s[24:27], s46 offen offset:1024 nt lds
    buffer_load_dwordx4 v9, s[24:27], s46 offen offset:2048 nt lds
    s_add_u32 s41, s41, s42
    s_add_i32 s47, s36, 0
    s_max_i32 s47, s47, 0
    s_waitcnt vmcnt(24)
    v_mov_b32 v11, s47
    s_mov_b64 exec, 1
    ds_max_u32 v10, v11 offset:6916
    s_mov_b64 exec, -1
    s_cmp_ge_i32 s52, s48
    s_cbranch_scc1 L_free3
    s_mov_b32 s56, 2
    s_call_b64 s[54:55], L_ld_wait
    s_mov_b32 s52, s45
L_free3:
    s_add_u32 m0, s44, 0x12000
    s_mov_b32 s46, s41
    buffer_load_dwordx4 v7, s[24:27], s46 offen nt lds
    buffer_load_dwordx4 v8, s[24:27], s46 offen offset:1024 nt lds
    buffer_load_dwordx4 v9, s[24:27], s46 offen offset:2048 nt lds
    s_add_u32 m0, s44, 0x12c00
    s_add_u32 s46, s41, s43
    buffer_load_dwordx4 v7, s[24:27], s46 offen nt lds
    buffer_load_dwordx4 v8, s[24:27], s46 offen offset:1024 nt lds
    buffer_load_dwordx4 v9, s[24:27], s46 offen offset:2048 nt lds
    s_add_u32 s41, s41, s42
    s_add_i32 s47, s36, 0
    s_max_i32 s47, s47, 0
    s_waitcnt vmcnt(24)
    v_mov_b32 v11, s47
    s_mov_b64 exec, 1
    ds_max_u32 v10, v11 offset:6920
    s_mov_b64 exec, -1
    s_cmp_ge_i32 s53, s48
    s_cbranch_scc1 L_free4
    s_mov_b32 s56, 3
    s_call_b64 s[54:55], L_ld_wait
    s_mov_b32 s53, s45
L_free4:
    s_add_u32 m0, s44, 0x1b000
    s_mov_b32 s46, s41
    buffer_load_dwordx4 v7, s[24:27], s46 offen nt lds
    buffer_load_dwordx4 v8, s[24:27], s46 offen offset:1024 nt lds
    buffer_load_dwordx4 v9, s[24:27], s46 offen offset:2048 nt lds
    s_add_u32 m0, s44, 0x1bc00
    s_add_u32 s46, s41, s43
    buffer_load_dwordx4 v7, s[24:27], s46 offen nt lds
    buffer_load_dwordx4 v8, s[24:27], s46 offen offset:1024 nt lds
    buffer_load_dwordx4 v9, s[24:27], s46 offen offset:2048 nt lds
    s_add_u32 s41, s41, s42
    s_add_i32 s47, s36, 0
    s_max_i32 s47, s47, 0
    s_waitcnt vmcnt(24)
    v_mov_b32 v11, s47
    s_mov_b64 exec, 1
    ds_max_u32 v10, v11 offset:6924
    s_mov_b64 exec, -1
    s_add_u32 s37, s37, 1
    s_cmp_eq_u32 s37, 5
    s_cselect_b32 s37, 0, s37
    s_add_u32 s57, s57, 1
    s_cmp_eq_u32 s57, 6
    s_cselect_b32 s57, 0, s57
    s_add_u32 s36, s36, 1
    s_cmp_lt_u32 s36, 20
    s_cbranch_scc1 L_ld_step
    s_mov_b32 s32, s22
    s_mov_b32 s33, s23
    s_mov_b32 s34, 0x1000000
    s_mov_b32 s35, 0x20000
    v_lshlrev_b32 v12, 4, v0
    s_nop 1
L_spin5:
    ds_read_b32 v11, v10 offset:6976
    s_waitcnt lgkmcnt(0)
    v_readfirstlane_b32 s45, v11
    s_nop 0
    s_cmp_ge_u32 s45, 1
    s_cbranch_scc1 L_spun6
    s_sleep 1
    s_branch L_spin5
L_spun6:
    s_mov_b32 s46, 0x54d800
    buffer_load_dwordx4 v[112:115], v12, s[32:35], s46 offen sc1
    s_mov_b32 s46, 0x54dc00
    buffer_load_dwordx4 v[124:127], v12, s[32:35], s46 offen sc1
    s_mov_b32 s46, 0x54e000
    buffer_load_dwordx4 v[136:139], v12, s[32:35], s46 offen sc1
    s_mov_b32 s46, 0x54e400
    buffer_load_dwordx4 v[148:151], v12, s[32:35], s46 offen sc1
    s_mov_b32 s46, 0x54e800
    buffer_load_dwordx4 v[160:163], v12, s[32:35], s46 offen sc1
    s_mov_b32 s46, 0x54ec00
    buffer_load_dwordx4 v[172:175], v12, s[32:35], s46 offen sc1
    s_mov_b32 s46, 0x54f000
    buffer_load_dwordx4 v[116:119], v12, s[32:35], s46 offen sc1
    s_mov_b32 s46, 0x54f400
    buffer_load_dwordx4 v[128:131], v12, s[32:35], s46 offen sc1
    s_mov_b32 s46, 0x54f800
    buffer_load_dwordx4 v[140:143], v12, s[32:35], s46 offen sc1
    s_mov_b32 s46, 0x54fc00
    buffer_load_dwordx4 v[152:155], v12, s[32:35], s46 offen sc1
    s_mov_b32 s46, 0x550000
    buffer_load_dwordx4 v[164:167], v12, s[32:35], s46 offen sc1
    s_mov_b32 s46, 0x550400
    buffer_load_dwordx4 v[176:179], v12, s[32:35], s46 offen sc1
    s_mov_b32 s46, 0x550800
    buffer_load_dwordx4 v[120:123], v12, s[32:35], s46 offen sc1
    s_mov_b32 s46, 0x550c00
    buffer_load_dwordx4 v[132:135], v12, s[32:35], s46 offen sc1
    s_mov_b32 s46, 0x551000
    buffer_load_dwordx4 v[144:147], v12, s[32:35], s46 offen sc1
    s_mov_b32 s46, 0x551400
    buffer_load_dwordx4 v[156:159], v12, s[32:35], s46 offen sc1
    s_mov_b32 s46, 0x551800
    buffer_load_dwordx4 v[168:171], v12, s[32:35], s46 offen sc1
    s_mov_b32 s46, 0x551c00
    buffer_load_dwordx4 v[180:183], v12, s[32:35], s46 offen sc1
    s_waitcnt vmcnt(36)
    v_mov_b32 v11, 20
    s_mov_b64 exec, 1
    ds_max_u32 v10, v11 offset:6912
    s_mov_b64 exec, -1
    s_waitcnt vmcnt(30)
    v_mov_b32 v11, 20
    s_mov_b64 exec, 1
    ds_max_u32 v10, v11 offset:6916
    s_mov_b64 exec, -1
    s_waitcnt vmcnt(24)
    v_mov_b32 v11, 20
    s_mov_b64 exec, 1
    ds_max_u32 v10, v11 offset:6920
    s_mov_b64 exec, -1
    s_waitcnt vmcnt(18)
    v_mov_b32 v11, 20
    s_mov_b64 exec, 1
    ds_max_u32 v10, v11 offset:6924
    s_mov_b64 exec, -1
    s_setprio 0
    s_mov_b32 s36, 3
    v_mov_b32 v11, 0
    v_and_b32 v1, 15, v0
    s_nop 1
    s_branch L_tail
L_ld_stepp:
    s_cmp_lg_u32 s37, 0
    s_cbranch_scc1 L_ld_finep
    s_mul_i32 s39, s38, 0x1800
    s_lshr_b32 s45, s38, 4
    s_mul_i32 s40, s45, 0x60000
    s_and_b32 s45, s38, 15
    s_mul_i32 s45, s45, 0x3000
    s_add_u32 s40, s40, s45
    s_add_u32 s38, s38, 0x400
    s_mov_b32 s24, s8
    s_mov_b32 s25, s9
    s_mov_b32 s26, 0x1800000
    s_mov_b32 s41, s39
    s_mov_b32 s42, 0x1800
    s_mov_b32 s43, 0xc00
    v_mov_b32 v7, v1
    v_mov_b32 v8, v2
    v_mov_b32 v9, v3
    s_branch L_ld_issuep
L_ld_finep:
    s_mov_b32 s24, s6
    s_mov_b32 s25, s7
    s_mov_b32 s26, 0x6000000
    s_sub_u32 s45, s37, 1
    s_lshr_b32 s46, s45, 1
    s_mul_i32 s46, s46, 0x30000
    s_and_b32 s45, s45, 1
    s_mul_i32 s45, s45, 0x180
    s_add_u32 s41, s40, s46
    s_add_u32 s41, s41, s45
    s_mov_b32 s42, 0x3000
    s_mov_b32 s43, 0x1800
    v_mov_b32 v7, v4
    v_mov_b32 v8, v5
    v_mov_b32 v9, v6
L_ld_issuep:
    s_mul_i32 s44, s57, 0x1800
    s_add_u32 s44, s44, 0x3400
    s_sub_i32 s48, s36, 5
    s_cmp_ge_i32 s50, s48
    s_cbranch_scc1 L_free7
    s_mov_b32 s56, 0
    s_call_b64 s[54:55], L_ld_wait
    s_mov_b32 s50, s45
L_free7:
    s_add_u32 m0, s44, 0
    s_mov_b32 s46, s41
    buffer_load_dwordx4 v7, s[24:27], s46 offen nt lds
    buffer_load_dwordx4 v8, s[24:27], s46 offen offset:1024 nt lds
    buffer_load_dwordx4 v9, s[24:27], s46 offen offset:2048 nt lds
    s_add_u32 m0, s44, 0xc00
    s_add_u32 s46, s41, s43
    buffer_load_dwordx4 v7, s[24:27], s46 offen nt lds
    buffer_load_dwordx4 v8, s[24:27], s46 offen offset:1024 nt lds
    buffer_load_dwordx4 v9, s[24:27], s46 offen offset:2048 nt lds
    s_add_u32 s41, s41, s42
    s_add_i32 s47, s36, -1
    s_max_i32 s47, s47, 0
    s_waitcnt vmcnt(36)
    v_mov_b32 v11, s47
    s_mov_b64 exec, 1
    ds_max_u32 v10, v11 offset:6920
    s_mov_b64 exec, -1
    s_cmp_ge_i32 s51, s48
    s_cbranch_scc1 L_free8
    s_mov_b32 s56, 1
    s_call_b64 s[54:55], L_ld_wait
    s_mov_b32 s51, s45
L_free8:
    s_add_u32 m0, s44, 0x9000
    s_mov_b32 s46, s41
    buffer_load_dwordx4 v7, s[24:27], s46 offen nt lds
    buffer_load_dwordx4 v8, s[24:27], s46 offen offset:1024 nt lds
    buffer_load_dwordx4 v9, s[24:27], s46 offen offset:2048 nt lds
    s_add_u32 m0, s44, 0x9c00
    s_add_u32 s46, s41, s43
    buffer_load_dwordx4 v7, s[24:27], s46 offen nt lds
    buffer_load_dwordx4 v8, s[24:27], s46 offen offset:1024 nt lds
    buffer_load_dwordx4 v9, s[24:27], s46 offen offset:2048 nt lds
    s_add_u32 s41, s41, s42
    s_add_i32 s47, s36, -1
    s_max_i32 s47, s47, 0
    s_waitcnt vmcnt(36)
    v_mov_b32 v11, s47
    s_mov_b64 exec, 1
    ds_max_u32 v10, v11 offset:6924
    s_mov_b64 exec, -1
    s_cmp_lg_u32 s36, 0
    s_cbranch_scc1 L_w39
    s_waitcnt vmcnt(12)
    v_mov_b32 v11, 3
    s_mov_b64 exec, 1
    ds_max_u32 v10, v11 offset:6956
    s_mov_b64 exec, -1
L_w39:
    s_cmp_ge_i32 s52, s48
    s_cbranch_scc1 L_free10
    s_mov_b32 s56, 2
    s_call_b64 s[54:55], L_ld_wait
    s_mov_b32 s52, s45
L_free10:
    s_add_u32 m0, s44, 0x12000
    s_mov_b32 s46, s41
    buffer_load_dwordx4 v7, s[24:27], s46 offen nt lds
    buffer_load_dwordx4 v8, s[24:27], s46 offen offset:1024 nt lds
    buffer_load_dwordx4 v9, s[24:27], s46 offen offset:2048 nt lds
    s_add_u32 m0, s44, 0x12c00
    s_add_u32 s46, s41, s43
    buffer_load_dwordx4 v7, s[24:27], s46 offen nt lds
    buffer_load_dwordx4 v8, s[24:27], s46 offen offset:1024 nt lds
    buffer_load_dwordx4 v9, s[24:27], s46 offen offset:2048 nt lds
    s_add_u32 s41, s41, s42
    s_add_i32 s47, s36, 0
    s_max_i32 s47, s47, 0
    s_waitcnt vmcnt(36)
    v_mov_b32 v11, s47
    s_mov_b64 exec, 1
    ds_max_u32 v10, v11 offset:6912
    s_mov_b64 exec, -1
    s_cmp_ge_i32 s53, s48
    s_cbranch_scc1 L_free11
    s_mov_b32 s56, 3
    s_call_b64 s[54:55], L_ld_wait
    s_mov_b32 s53, s45
L_free11:
    s_add_u32 m0, s44, 0x1b000
    s_mov_b32 s46, s41
    buffer_load_dwordx4 v7, s[24:27], s46 offen nt lds
    buffer_load_dwordx4 v8, s[24:27], s46 offen offset:1024 nt lds
    buffer_load_dwordx4 v9, s[24:27], s46 offen offset:2048 nt lds
    s_add_u32 m0, s44, 0x1bc00
    s_add_u32 s46, s41, s43
    buffer_load_dwordx4 v7, s[24:27], s46 offen nt lds
    buffer_load_dwordx4 v8, s[24:27], s46 offen offset:1024 nt lds
    buffer_load_dwordx4 v9, s[24:27], s46 offen offset:2048 nt lds
    s_add_u32 s41, s41, s42
    s_add_i32 s47, s36, 0
    s_max_i32 s47, s47, 0
    s_waitcnt vmcnt(36)
    v_mov_b32 v11, s47
    s_mov_b64 exec, 1
    ds_max_u32 v10, v11 offset:6916
    s_mov_b64 exec, -1
    s_add_u32 s37, s37, 1
    s_cmp_eq_u32 s37, 5
    s_cselect_b32 s37, 0, s37
    s_add_u32 s57, s57, 1
    s_cmp_eq_u32 s57, 6
    s_cselect_b32 s57, 0, s57
    s_cmp_lg_u32 s36, 1
    s_cbranch_scc1 L_ld_noiss
L_spin12:
    ds_read_b32 v11, v10 offset:6952
    s_waitcnt lgkmcnt(0)
    v_readfirstlane_b32 s45, v11
    s_nop 0
    s_cmp_ge_u32 s45, 4
    s_cbranch_scc1 L_spun13
    s_sleep 1
    s_branch L_spin12
L_spun13:
L_ld_noiss:
    s_add_u32 s36, s36, 1
    s_cmp_lt_u32 s36, 20
    s_nop 3
    s_cbranch_scc1 L_ld_stepp
    s_mov_b32 s32, s22
    s_mov_b32 s33, s23
    s_mov_b32 s34, 0x1000000
    s_mov_b32 s35, 0x20000
    v_lshlrev_b32 v12, 4, v0
    s_nop 1
L_spin14:
    ds_read_b32 v11, v10 offset:6976
    s_waitcnt lgkmcnt(0)
    v_readfirstlane_b32 s45, v11
    s_nop 0
    s_cmp_ge_u32 s45, 1
    s_cbranch_scc1 L_spun15
    s_sleep 1
    s_branch L_spin14
L_spun15:
    s_mov_b32 s46, 0x54d800
    buffer_load_dwordx4 v[112:115], v12, s[32:35], s46 offen sc1
    s_mov_b32 s46, 0x54dc00
    buffer_load_dwordx4 v[124:127], v12, s[32:35], s46 offen sc1
    s_mov_b32 s46, 0x54e000
    buffer_load_dwordx4 v[136:139], v12, s[32:35], s46 offen sc1
    s_mov_b32 s46, 0x54e400
    buffer_load_dwordx4 v[148:151], v12, s[32:35], s46 offen sc1
    s_mov_b32 s46, 0x54e800
    buffer_load_dwordx4 v[160:163], v12, s[32:35], s46 offen sc1
    s_mov_b32 s46, 0x54ec00
    buffer_load_dwordx4 v[172:175], v12, s[32:35], s46 offen sc1
    s_mov_b32 s46, 0x54f000
    buffer_load_dwordx4 v[116:119], v12, s[32:35], s46 offen sc1
    s_mov_b32 s46, 0x54f400
    buffer_load_dwordx4 v[128:131], v12, s[32:35], s46 offen sc1
    s_mov_b32 s46, 0x54f800
    buffer_load_dwordx4 v[140:143], v12, s[32:35], s46 offen sc1
    s_mov_b32 s46, 0x54fc00
    buffer_load_dwordx4 v[152:155], v12, s[32:35], s46 offen sc1
    s_mov_b32 s46, 0x550000
    buffer_load_dwordx4 v[164:167], v12, s[32:35], s46 offen sc1
    s_mov_b32 s46, 0x550400
    buffer_load_dwordx4 v[176:179], v12, s[32:35], s46 offen sc1
    s_mov_b32 s46, 0x550800
    buffer_load_dwordx4 v[120:123], v12, s[32:35], s46 offen sc1
    s_mov_b32 s46, 0x550c00
    buffer_load_dwordx4 v[132:135], v12, s[32:35], s46 offen sc1
    s_mov_b32 s46, 0x551000
    buffer_load_dwordx4 v[144:147], v12, s[32:35], s46 offen sc1
    s_mov_b32 s46, 0x551400
    buffer_load_dwordx4 v[156:159], v12, s[32:35], s46 offen sc1
    s_mov_b32 s46, 0x551800
    buffer_load_dwordx4 v[168:171], v12, s[32:35], s46 offen sc1
    s_mov_b32 s46, 0x551c00
    buffer_load_dwordx4 v[180:183], v12, s[32:35], s46 offen sc1
    s_waitcnt vmcnt(48)
    v_mov_b32 v11, 19
    s_mov_b64 exec, 1
    ds_max_u32 v10, v11 offset:6920
    s_mov_b64 exec, -1
    s_waitcnt vmcnt(42)
    v_mov_b32 v11, 19
    s_mov_b64 exec, 1
    ds_max_u32 v10, v11 offset:6924
    s_mov_b64 exec, -1
    s_waitcnt vmcnt(36)
    v_mov_b32 v11, 20
    s_mov_b64 exec, 1
    ds_max_u32 v10, v11 offset:6912
    s_mov_b64 exec, -1
    s_waitcnt vmcnt(30)
    v_mov_b32 v11, 20
    s_mov_b64 exec, 1
    ds_max_u32 v10, v11 offset:6916
    s_mov_b64 exec, -1
    s_waitcnt vmcnt(24)
    v_mov_b32 v11, 20
    s_mov_b64 exec, 1
    ds_max_u32 v10, v11 offset:6920
    s_mov_b64 exec, -1
    s_waitcnt vmcnt(18)
    v_mov_b32 v11, 20
    s_mov_b64 exec, 1
    ds_max_u32 v10, v11 offset:6924
    s_mov_b64 exec, -1
    s_setprio 0
    s_mov_b32 s36, 3
    v_mov_b32 v11, 0
    v_and_b32 v1, 15, v0
    s_nop 1
    s_branch L_tail
L_ld_wait:
    s_lshl_b32 s45, s56, 2
    v_mov_b32 v12, s45
    ds_read_b32 v11, v12 offset:6928
    s_waitcnt lgkmcnt(0)
    v_readfirstlane_b32 s45, v11
    s_nop 0
    s_cmp_ge_i32 s45, s48
    s_cbranch_scc1 L_ld_wait_ret
    s_nop 1
L_spin16:
    ds_read_b32 v11, v12 offset:6928
    s_waitcnt lgkmcnt(0)
    v_readfirstlane_b32 s45, v11
    s_nop 0
    s_cmp_ge_u32 s45, s48
    s_cbranch_scc1 L_spun17
    s_sleep 1
    s_branch L_spin16
L_spun17:
L_ld_wait_ret:
    s_setpc_b64 s[54:55]
L_compute:
    s_mul_i32 s36, s3, 0x9000
    s_add_u32 s36, s36, 0x3400
    s_setprio 1
    s_barrier
    v_and_b32 v228, 15, v0
    v_lshrrev_b32 v229, 4, v0
    v_and_b32 v230, 6, v228
    v_xor_b32 v230, v230, v229
    v_mul_u32_u24 v231, 0x180, v228
    v_add_u32 v231, s36, v231
    v_lshl_add_u32 v8, v230, 4, v231
    v_xor_b32 v230, 4, v230
    v_lshl_add_u32 v9, v230, 4, v231
    v_lshrrev_b32 v230, 2, v228
    v_and_b32 v231, 3, v228
    v_lshl_add_u32 v232, v229, 2, v230
    v_mul_u32_u24 v233, 0x180, v232
    v_lshl_add_u32 v233, v231, 3, v233
    v_add_u32 v233, s36, v233
    v_and_b32 v234, 6, v232
    v_xor_b32 v235, 0, v234
    v_lshl_add_u32 v10, v235, 4, v233
    v_xor_b32 v235, 2, v234
    v_lshl_add_u32 v11, v235, 4, v233
    v_xor_b32 v235, 4, v234
    v_lshl_add_u32 v12, v235, 4, v233
    v_xor_b32 v235, 6, v234
    v_lshl_add_u32 v13, v235, 4, v233
    v_subrev_u32 v244, s36, v8
    v_subrev_u32 v245, s36, v9
    v_mov_b32 v24, 0x3f803f80
    v_mov_b32 v240, 0
    v_mov_b32 v248, 0
    v_mov_b32 v25, 0x3f803f80
    v_mov_b32 v241, 0
    v_mov_b32 v249, 0
    v_mov_b32 v26, 0x3f803f80
    v_mov_b32 v242, 0
    v_mov_b32 v250, 0
    v_mov_b32 v27, 0x3f803f80
    v_mov_b32 v243, 0
    v_mov_b32 v251, 0
    v_mov_b32 v20, 1.0
    s_mov_b32 s44, 0x3baaaaab
    s_mov_b32 s46, 0x3727c5ac
    s_mov_b32 s58, 0xaaaaaaaa
    s_mov_b32 s60, 0xcccccccc
    s_mov_b32 s45, 0x3baaaaab
    s_mov_b32 s47, 0x3727c5ac
    s_mov_b32 s59, 0xaaaaaaaa
    s_mov_b32 s61, 0xcccccccc
    s_mov_b32 s38, 0xf0000f
    s_mov_b32 s39, 0xf0000f00
    s_mov_b32 s50, 0x42000000
    s_mov_b32 s41, 0
    s_mov_b32 s51, 0
    s_mov_b32 s52, 0
    s_mov_b32 s54, 0
    s_mov_b32 s56, 0x1800
    s_lshl_b32 s40, s3, 2
    v_mov_b32 v1, s40
    s_waitcnt lgkmcnt(0)
    s_mov_b32 s32, s22
    s_mov_b32 s33, s23
    s_mov_b32 s34, 0x1000000
    s_mov_b32 s35, 0x20000
    s_cmp_lt_u32 s2, 3
    s_cbranch_scc1 L_qkprod
    s_cmp_lt_u32 s2, 6
    s_cbranch_scc1 L_wvprod
L_c_start:
    s_add_u32 s51, s51, 1
    s_cmp_ge_u32 s52, s51
    s_cbranch_scc1 L_have18
L_spin19:
    ds_read_b32 v3, v1 offset:6912
    s_waitcnt lgkmcnt(0)
    v_readfirstlane_b32 s52, v3
    s_nop 0
    s_cmp_ge_u32 s52, s51
    s_cbranch_scc1 L_spun20
    s_sleep 1
    s_branch L_spin19
L_spun20:
L_have18:
    ds_read_b128 v[100:103], v8
    ds_read_b128 v[104:107], v9
    ds_read_b128 v[108:111], v8 offset:128
    ds_read_b128 v[112:115], v9 offset:128
    ds_read_b128 v[116:119], v8 offset:256
    ds_read_b128 v[120:123], v9 offset:256
    ds_read_b64_tr_b16 v[152:153], v10
    ds_read_b64_tr_b16 v[158:159], v11
    ds_read_b64_tr_b16 v[164:165], v12
    ds_read_b64_tr_b16 v[170:171], v13
    ds_read_b64_tr_b16 v[176:177], v10 offset:128
    ds_read_b64_tr_b16 v[182:183], v11 offset:128
    s_waitcnt lgkmcnt(11)
    v_mfma_f32_16x16x32_bf16 v[224:227], v[100:103], v[24:27], 0
    ds_read_b64_tr_b16 v[188:189], v12 offset:128
    s_waitcnt lgkmcnt(11)
    v_mfma_f32_16x16x32_bf16 v[224:227], v[104:107], v[24:27], v[224:227]
    ds_read_b64_tr_b16 v[194:195], v13 offset:128
    s_waitcnt lgkmcnt(11)
    v_mfma_f32_16x16x32_bf16 v[224:227], v[108:111], v[24:27], v[224:227]
    ds_read_b64_tr_b16 v[200:201], v10 offset:256
    s_waitcnt lgkmcnt(11)
    v_mfma_f32_16x16x32_bf16 v[224:227], v[112:115], v[24:27], v[224:227]
    ds_read_b64_tr_b16 v[206:207], v11 offset:256
    s_waitcnt lgkmcnt(11)
    v_mfma_f32_16x16x32_bf16 v[224:227], v[116:119], v[24:27], v[224:227]
    ds_read_b64_tr_b16 v[212:213], v12 offset:256
    s_waitcnt lgkmcnt(11)
    v_mfma_f32_16x16x32_bf16 v[224:227], v[120:123], v[24:27], v[224:227]
    ds_read_b64_tr_b16 v[218:219], v13 offset:256
    ds_read_b32 v3, v1 offset:6912
    s_add_u32 s54, s54, 1
    s_cmp_eq_u32 s54, 6
    s_cselect_b32 s55, 0xffff8800, s56
    s_cselect_b32 s54, 0, s54
    v_add_u32 v8, s55, v8
    v_add_u32 v9, s55, v9
    v_mov_b32 v2, s51
    v_add_u32 v10, s55, v10
    v_add_u32 v11, s55, v11
    v_add_u32 v12, s55, v12
    v_add_u32 v13, s55, v13
    s_waitcnt lgkmcnt(0)
    ds_write_b32 v1, v2 offset:6928
    v_dot2_f32_bf16 v22, v100, v100, 0
    v_dot2_f32_bf16 v23, v101, v101, 0
    v_dot2_f32_bf16 v22, v102, v102, v22
    v_dot2_f32_bf16 v23, v103, v103, v23
    v_dot2_f32_bf16 v22, v104, v104, v22
    v_dot2_f32_bf16 v23, v105, v105, v23
    v_dot2_f32_bf16 v22, v106, v106, v22
    v_dot2_f32_bf16 v23, v107, v107, v23
    v_dot2_f32_bf16 v22, v108, v108, v22
    v_dot2_f32_bf16 v23, v109, v109, v23
    v_dot2_f32_bf16 v22, v110, v110, v22
    v_dot2_f32_bf16 v23, v111, v111, v23
    v_dot2_f32_bf16 v22, v112, v112, v22
    v_dot2_f32_bf16 v23, v113, v113, v23
    v_dot2_f32_bf16 v22, v114, v114, v22
    v_dot2_f32_bf16 v23, v115, v115, v23
    v_dot2_f32_bf16 v22, v116, v116, v22
    v_dot2_f32_bf16 v23, v117, v117, v23
    v_dot2_f32_bf16 v22, v118, v118, v22
    v_dot2_f32_bf16 v23, v119, v119, v23
    v_dot2_f32_bf16 v22, v120, v120, v22
    v_dot2_f32_bf16 v23, v121, v121, v23
    v_dot2_f32_bf16 v22, v122, v122, v22
    v_dot2_f32_bf16 v23, v123, v123, v23
    s_nop 2
    v_add_f32 v255, v22, v23
    s_add_u32 s51, s51, 1
    s_cmp_ge_u32 s52, s51
    s_cbranch_scc1 L_have21
L_spin22:
    ds_read_b32 v3, v1 offset:6912
    s_waitcnt lgkmcnt(0)
    v_readfirstlane_b32 s52, v3
    s_nop 0
    s_cmp_ge_u32 s52, s51
    s_cbranch_scc1 L_spun23
    s_sleep 1
    s_branch L_spin22
L_spun23:
L_have21:
    ds_read_b128 v[124:127], v8
    ds_read_b128 v[128:131], v9
    ds_read_b128 v[132:135], v8 offset:128
    ds_read_b128 v[136:139], v9 offset:128
    ds_read_b128 v[140:143], v8 offset:256
    ds_read_b128 v[144:147], v9 offset:256
    s_waitcnt lgkmcnt(5)
    v_mfma_f32_16x16x32_bf16 v[232:235], v[124:127], v[24:27], v[224:227]
    ds_read_b64_tr_b16 v[148:149], v10
    ds_read_b64_tr_b16 v[154:155], v11
    s_waitcnt lgkmcnt(6)
    v_mfma_f32_16x16x32_bf16 v[232:235], v[128:131], v[24:27], v[232:235]
    ds_read_b64_tr_b16 v[160:161], v12
    ds_read_b64_tr_b16 v[166:167], v13
    ds_read_b64_tr_b16 v[172:173], v10 offset:128
    s_waitcnt lgkmcnt(8)
    v_mfma_f32_16x16x32_bf16 v[232:235], v[132:135], v[24:27], v[232:235]
    ds_read_b64_tr_b16 v[178:179], v11 offset:128
    ds_read_b64_tr_b16 v[184:185], v12 offset:128
    ds_read_b64_tr_b16 v[190:191], v13 offset:128
    s_waitcnt lgkmcnt(10)
    v_mfma_f32_16x16x32_bf16 v[232:235], v[136:139], v[24:27], v[232:235]
    ds_read_b64_tr_b16 v[196:197], v10 offset:256
    ds_read_b64_tr_b16 v[202:203], v11 offset:256
    s_waitcnt lgkmcnt(11)
    v_mfma_f32_16x16x32_bf16 v[232:235], v[140:143], v[24:27], v[232:235]
    ds_read_b64_tr_b16 v[208:209], v12 offset:256
    ds_read_b64_tr_b16 v[214:215], v13 offset:256
    s_waitcnt lgkmcnt(12)
    v_mfma_f32_16x16x32_bf16 v[232:235], v[144:147], v[24:27], v[232:235]
    ds_read_b32 v3, v1 offset:6912
    s_add_u32 s54, s54, 1
    s_cmp_eq_u32 s54, 6
    s_cselect_b32 s55, 0xffff8800, s56
    s_cselect_b32 s54, 0, s54
    v_add_u32 v8, s55, v8
    v_add_u32 v9, s55, v9
    v_mov_b32 v2, s51
    v_add_u32 v10, s55, v10
    v_add_u32 v11, s55, v11
    v_add_u32 v12, s55, v12
    v_add_u32 v13, s55, v13
    s_waitcnt lgkmcnt(0)
    ds_write_b32 v1, v2 offset:6928
    v_dot2_f32_bf16 v22, v124, v124, v255
    v_dot2_f32_bf16 v23, v124, v100, 0
    v_dot2_f32_bf16 v22, v125, v125, v22
    v_dot2_f32_bf16 v23, v125, v101, v23
    v_dot2_f32_bf16 v22, v126, v126, v22
    v_dot2_f32_bf16 v23, v126, v102, v23
    v_dot2_f32_bf16 v22, v127, v127, v22
    v_dot2_f32_bf16 v23, v127, v103, v23
    v_dot2_f32_bf16 v22, v128, v128, v22
    v_dot2_f32_bf16 v23, v128, v104, v23
    v_dot2_f32_bf16 v22, v129, v129, v22
    v_dot2_f32_bf16 v23, v129, v105, v23
    v_dot2_f32_bf16 v22, v130, v130, v22
    v_dot2_f32_bf16 v23, v130, v106, v23
    v_dot2_f32_bf16 v22, v131, v131, v22
    v_dot2_f32_bf16 v23, v131, v107, v23
    v_dot2_f32_bf16 v22, v132, v132, v22
    v_dot2_f32_bf16 v23, v132, v108, v23
    v_dot2_f32_bf16 v22, v133, v133, v22
    v_dot2_f32_bf16 v23, v133, v109, v23
    v_dot2_f32_bf16 v22, v134, v134, v22
    v_dot2_f32_bf16 v23, v134, v110, v23
    v_dot2_f32_bf16 v22, v135, v135, v22
    v_dot2_f32_bf16 v23, v135, v111, v23
    v_dot2_f32_bf16 v22, v136, v136, v22
    v_dot2_f32_bf16 v23, v136, v112, v23
    v_dot2_f32_bf16 v22, v137, v137, v22
    v_dot2_f32_bf16 v23, v137, v113, v23
    v_dot2_f32_bf16 v22, v138, v138, v22
    v_dot2_f32_bf16 v23, v138, v114, v23
    v_dot2_f32_bf16 v22, v139, v139, v22
    v_dot2_f32_bf16 v23, v139, v115, v23
    v_dot2_f32_bf16 v22, v140, v140, v22
    v_dot2_f32_bf16 v23, v140, v116, v23
    v_dot2_f32_bf16 v22, v141, v141, v22
    v_dot2_f32_bf16 v23, v141, v117, v23
    v_dot2_f32_bf16 v22, v142, v142, v22
    v_dot2_f32_bf16 v23, v142, v118, v23
    v_dot2_f32_bf16 v22, v143, v143, v22
    v_dot2_f32_bf16 v23, v143, v119, v23
    v_dot2_f32_bf16 v22, v144, v144, v22
    v_dot2_f32_bf16 v23, v144, v120, v23
    v_dot2_f32_bf16 v22, v145, v145, v22
    v_dot2_f32_bf16 v23, v145, v121, v23
    v_dot2_f32_bf16 v22, v146, v146, v22
    v_dot2_f32_bf16 v23, v146, v122, v23
    v_dot2_f32_bf16 v22, v147, v147, v22
    v_dot2_f32_bf16 v23, v147, v123, v23
    s_nop 2
    v_fma_f32 v22, v23, 2.0, v22
    s_nop 1
    v_mfma_f32_16x16x4_f32 v[236:239], v22, v20, 0
    s_sub_u32 s40, s2, 3
    s_cmp_ge_u32 s40, 3
    s_cbranch_scc1 L_nowf
    s_mov_b32 s24, s20
    s_mov_b32 s25, s21
    s_mov_b32 s26, 0x100
    s_mov_b32 s27, 0x20000
    s_lshl_b32 s40, s40, 4
    v_mov_b32 v22, 1
    s_waitcnt vmcnt(0)
    s_mov_b64 exec, 1
    buffer_store_dword v22, v1, s[24:27], s40 offen offset:80 sc1
    s_mov_b64 exec, -1
L_nowf:
    s_add_u32 s51, s51, 1
    s_cmp_ge_u32 s52, s51
    s_cbranch_scc1 L_have24
    s_nop 3
L_spin25:
    ds_read_b32 v3, v1 offset:6912
    s_waitcnt lgkmcnt(0)
    v_readfirstlane_b32 s52, v3
    s_nop 0
    s_cmp_ge_u32 s52, s51
    s_cbranch_scc1 L_spun26
    s_sleep 1
    s_branch L_spin25
L_spun26:
L_have24:
    ds_read_b128 v[52:55], v8
    ds_read_b128 v[56:59], v9
    ds_read_b128 v[60:63], v8 offset:128
    ds_read_b128 v[64:67], v9 offset:128
    ds_read_b128 v[68:71], v8 offset:256
    ds_read_b128 v[72:75], v9 offset:256
    s_waitcnt lgkmcnt(5)
    v_mfma_f32_16x16x32_bf16 v[76:79], v[52:55], v[24:27], v[224:227]
    ds_read_b64_tr_b16 v[150:151], v10
    ds_read_b64_tr_b16 v[156:157], v11
    s_waitcnt lgkmcnt(6)
    v_mfma_f32_16x16x32_bf16 v[76:79], v[56:59], v[24:27], v[76:79]
    ds_read_b64_tr_b16 v[162:163], v12
    ds_read_b64_tr_b16 v[168:169], v13
    ds_read_b64_tr_b16 v[174:175], v10 offset:128
    s_waitcnt lgkmcnt(8)
    v_mfma_f32_16x16x32_bf16 v[76:79], v[60:63], v[24:27], v[76:79]
    ds_read_b64_tr_b16 v[180:181], v11 offset:128
    ds_read_b64_tr_b16 v[186:187], v12 offset:128
    ds_read_b64_tr_b16 v[192:193], v13 offset:128
    s_waitcnt lgkmcnt(10)
    v_mfma_f32_16x16x32_bf16 v[76:79], v[64:67], v[24:27], v[76:79]
    ds_read_b64_tr_b16 v[198:199], v10 offset:256
    ds_read_b64_tr_b16 v[204:205], v11 offset:256
    s_waitcnt lgkmcnt(11)
    v_mfma_f32_16x16x32_bf16 v[76:79], v[68:71], v[24:27], v[76:79]
    ds_read_b64_tr_b16 v[210:211], v12 offset:256
    ds_read_b64_tr_b16 v[216:217], v13 offset:256
    s_waitcnt lgkmcnt(12)
    v_mfma_f32_16x16x32_bf16 v[76:79], v[72:75], v[24:27], v[76:79]
    ds_read_b32 v3, v1 offset:6912
    s_add_u32 s54, s54, 1
    s_cmp_eq_u32 s54, 6
    s_cselect_b32 s55, 0xffff8800, s56
    s_cselect_b32 s54, 0, s54
    v_add_u32 v8, s55, v8
    v_add_u32 v9, s55, v9
    v_mov_b32 v2, s51
    v_add_u32 v10, s55, v10
    v_add_u32 v11, s55, v11
    v_add_u32 v12, s55, v12
    v_add_u32 v13, s55, v13
    s_waitcnt lgkmcnt(0)
    ds_write_b32 v1, v2 offset:6928
    v_dot2_f32_bf16 v22, v52, v52, v255
    v_dot2_f32_bf16 v23, v52, v100, 0
    v_dot2_f32_bf16 v22, v53, v53, v22
    v_dot2_f32_bf16 v23, v53, v101, v23
    v_dot2_f32_bf16 v22, v54, v54, v22
    v_dot2_f32_bf16 v23, v54, v102, v23
    v_dot2_f32_bf16 v22, v55, v55, v22
    v_dot2_f32_bf16 v23, v55, v103, v23
    v_dot2_f32_bf16 v22, v56, v56, v22
    v_dot2_f32_bf16 v23, v56, v104, v23
    v_dot2_f32_bf16 v22, v57, v57, v22
    v_dot2_f32_bf16 v23, v57, v105, v23
    v_dot2_f32_bf16 v22, v58, v58, v22
    v_dot2_f32_bf16 v23, v58, v106, v23
    v_dot2_f32_bf16 v22, v59, v59, v22
    v_dot2_f32_bf16 v23, v59, v107, v23
    v_dot2_f32_bf16 v22, v60, v60, v22
    v_dot2_f32_bf16 v23, v60, v108, v23
    v_dot2_f32_bf16 v22, v61, v61, v22
    v_dot2_f32_bf16 v23, v61, v109, v23
    v_dot2_f32_bf16 v22, v62, v62, v22
    v_dot2_f32_bf16 v23, v62, v110, v23
    v_dot2_f32_bf16 v22, v63, v63, v22
    v_dot2_f32_bf16 v23, v63, v111, v23
    v_dot2_f32_bf16 v22, v64, v64, v22
    v_dot2_f32_bf16 v23, v64, v112, v23
    v_dot2_f32_bf16 v22, v65, v65, v22
    v_dot2_f32_bf16 v23, v65, v113, v23
    v_dot2_f32_bf16 v22, v66, v66, v22
    v_dot2_f32_bf16 v23, v66, v114, v23
    v_dot2_f32_bf16 v22, v67, v67, v22
    v_dot2_f32_bf16 v23, v67, v115, v23
    v_dot2_f32_bf16 v22, v68, v68, v22
    v_dot2_f32_bf16 v23, v68, v116, v23
    v_dot2_f32_bf16 v22, v69, v69, v22
    v_dot2_f32_bf16 v23, v69, v117, v23
    v_dot2_f32_bf16 v22, v70, v70, v22
    v_dot2_f32_bf16 v23, v70, v118, v23
    v_dot2_f32_bf16 v22, v71, v71, v22
    v_dot2_f32_bf16 v23, v71, v119, v23
    v_dot2_f32_bf16 v22, v72, v72, v22
    v_dot2_f32_bf16 v23, v72, v120, v23
    v_dot2_f32_bf16 v22, v73, v73, v22
    v_dot2_f32_bf16 v23, v73, v121, v23
    v_dot2_f32_bf16 v22, v74, v74, v22
    v_dot2_f32_bf16 v23, v74, v122, v23
    v_dot2_f32_bf16 v22, v75, v75, v22
    v_dot2_f32_bf16 v23, v75, v123, v23
    s_nop 2
    v_fma_f32 v22, v23, 2.0, v22
    s_nop 1
    v_mfma_f32_16x16x4_f32 v[80:83], v22, v20, 0
    v_pk_mul_f32 v[232:233], v[232:233], s[44:45]
    v_pk_mul_f32 v[234:235], v[234:235], s[44:45]
    v_pk_fma_f32 v[4:5], v[232:233], v[232:233], s[46:47] neg_lo:[1,0,0] neg_hi:[1,0,0]
    v_pk_fma_f32 v[6:7], v[234:235], v[234:235], s[46:47] neg_lo:[1,0,0] neg_hi:[1,0,0]
    v_pk_fma_f32 v[236:237], v[236:237], s[44:45], v[4:5]
    v_pk_fma_f32 v[238:239], v[238:239], s[44:45], v[6:7]
    v_max_f32 v236, s46, v236
    v_max_f32 v237, s46, v237
    v_max_f32 v238, s46, v238
    v_max_f32 v239, s46, v239
    v_rsq_f32 v236, v236
    v_rsq_f32 v237, v237
    v_rsq_f32 v238, v238
    v_rsq_f32 v239, v239
    v_pk_mul_f32 v[76:77], v[76:77], s[44:45]
    v_pk_mul_f32 v[78:79], v[78:79], s[44:45]
    v_pk_fma_f32 v[4:5], v[76:77], v[76:77], s[46:47] neg_lo:[1,0,0] neg_hi:[1,0,0]
    v_pk_fma_f32 v[6:7], v[78:79], v[78:79], s[46:47] neg_lo:[1,0,0] neg_hi:[1,0,0]
    v_pk_fma_f32 v[80:81], v[80:81], s[44:45], v[4:5]
    v_pk_fma_f32 v[82:83], v[82:83], s[44:45], v[6:7]
    v_max_f32 v80, s46, v80
    v_max_f32 v81, s46, v81
    v_max_f32 v82, s46, v82
    v_max_f32 v83, s46, v83
    v_rsq_f32 v80, v80
    v_rsq_f32 v81, v81
    v_rsq_f32 v82, v82
    v_rsq_f32 v83, v83
    s_add_u32 s51, s51, 1
    s_cmp_ge_u32 s52, s51
    s_cbranch_scc1 L_have27
L_spin28:
    ds_read_b32 v3, v1 offset:6912
    s_waitcnt lgkmcnt(0)
    v_readfirstlane_b32 s52, v3
    s_nop 0
    s_cmp_ge_u32 s52, s51
    s_cbranch_scc1 L_spun29
    s_sleep 1
    s_branch L_spin28
L_spun29:
L_have27:
    v_mov_b32 v21, 0
    s_nop 4
L_spin30:
    ds_read_b32 v3, v21 offset:6944
    s_waitcnt lgkmcnt(0)
    v_readfirstlane_b32 s40, v3
    s_nop 0
    s_cmp_ge_u32 s40, 1
    s_cbranch_scc1 L_spun31
    s_sleep 1
    s_branch L_spin30
L_spun31:
    ds_read_b128 v[28:31], v244
    ds_read_b128 v[32:35], v245
    ds_read_b128 v[36:39], v244 offset:128
    ds_read_b128 v[40:43], v245 offset:128
    ds_read_b128 v[44:47], v244 offset:256
    ds_read_b128 v[48:51], v245 offset:256
    s_waitcnt lgkmcnt(5)
    v_mfma_f32_16x16x32_bf16 v[220:223], v[100:103], v[28:31], 0
    v_mfma_f32_16x16x32_bf16 v[88:91], v[24:27], v[28:31], 0
    s_waitcnt lgkmcnt(4)
    v_mfma_f32_16x16x32_bf16 v[220:223], v[104:107], v[32:35], v[220:223]
    v_mfma_f32_16x16x32_bf16 v[88:91], v[24:27], v[32:35], v[88:91]
    s_waitcnt lgkmcnt(3)
    v_mfma_f32_16x16x32_bf16 v[220:223], v[108:111], v[36:39], v[220:223]
    v_mfma_f32_16x16x32_bf16 v[88:91], v[24:27], v[36:39], v[88:91]
    s_waitcnt lgkmcnt(2)
    v_mfma_f32_16x16x32_bf16 v[220:223], v[112:115], v[40:43], v[220:223]
    v_mfma_f32_16x16x32_bf16 v[88:91], v[24:27], v[40:43], v[88:91]
    s_waitcnt lgkmcnt(1)
    v_mfma_f32_16x16x32_bf16 v[220:223], v[116:119], v[44:47], v[220:223]
    v_mfma_f32_16x16x32_bf16 v[88:91], v[24:27], v[44:47], v[88:91]
    s_waitcnt lgkmcnt(0)
    v_mfma_f32_16x16x32_bf16 v[220:223], v[120:123], v[48:51], v[220:223]
    v_mfma_f32_16x16x32_bf16 v[88:91], v[24:27], v[48:51], v[88:91]
    v_mfma_f32_16x16x32_bf16 v[228:231], v[124:127], v[28:31], v[220:223]
    v_mfma_f32_16x16x32_bf16 v[84:87], v[52:55], v[28:31], v[220:223]
    v_mfma_f32_16x16x32_bf16 v[228:231], v[128:131], v[32:35], v[228:231]
    v_mfma_f32_16x16x32_bf16 v[84:87], v[56:59], v[32:35], v[84:87]
    v_mfma_f32_16x16x32_bf16 v[228:231], v[132:135], v[36:39], v[228:231]
    v_mfma_f32_16x16x32_bf16 v[84:87], v[60:63], v[36:39], v[84:87]
    v_mfma_f32_16x16x32_bf16 v[228:231], v[136:139], v[40:43], v[228:231]
    v_mfma_f32_16x16x32_bf16 v[84:87], v[64:67], v[40:43], v[84:87]
    v_mfma_f32_16x16x32_bf16 v[228:231], v[140:143], v[44:47], v[228:231]
    v_mfma_f32_16x16x32_bf16 v[84:87], v[68:71], v[44:47], v[84:87]
    v_mfma_f32_16x16x32_bf16 v[228:231], v[144:147], v[48:51], v[228:231]
    v_mfma_f32_16x16x32_bf16 v[84:87], v[72:75], v[48:51], v[84:87]
    ds_read_b128 v[124:127], v8
    ds_read_b128 v[128:131], v9
    ds_read_b128 v[132:135], v8 offset:128
    ds_read_b128 v[136:139], v9 offset:128
    ds_read_b128 v[140:143], v8 offset:256
    ds_read_b128 v[144:147], v9 offset:256
    v_mov_b32 v16, v88
    v_mov_b32 v17, v88
    v_pk_fma_f32 v[228:229], v[232:233], v[16:17], v[228:229] neg_lo:[1,0,0] neg_hi:[1,0,0]
    v_pk_mul_f32 v[228:229], v[228:229], v[236:237]
    v_pk_fma_f32 v[230:231], v[234:235], v[16:17], v[230:231] neg_lo:[1,0,0] neg_hi:[1,0,0]
    v_pk_mul_f32 v[230:231], v[230:231], v[238:239]
    v_pk_fma_f32 v[84:85], v[76:77], v[16:17], v[84:85] neg_lo:[1,0,0] neg_hi:[1,0,0]
    v_pk_mul_f32 v[84:85], v[84:85], v[80:81]
    v_pk_fma_f32 v[86:87], v[78:79], v[16:17], v[86:87] neg_lo:[1,0,0] neg_hi:[1,0,0]
    v_pk_mul_f32 v[86:87], v[86:87], v[82:83]
    v_max3_f32 v254, v228, v229, v230
    v_max3_f32 v21, v231, v84, v85
    v_max3_f32 v254, v254, v86, v87
    v_max_f32 v254, v254, v21
    v_mov_b32 v22, v254
    v_mov_b32 v23, v254
    s_nop 1
    v_permlane32_swap_b32 v22, v23
    v_max_f32 v254, v22, v23
    v_mov_b32 v22, v254
    v_mov_b32 v23, v254
    s_nop 1
    v_permlane16_swap_b32 v22, v23
    v_max_f32 v254, v22, v23
    v_cmp_le_f32_e64 vcc, |v254|, s50
    s_nop 1
    v_cndmask_b32_e64 v254, v254, 0, vcc
    v_sub_f32 v18, 0, v254
    v_sub_f32 v19, 0, v254
    v_pk_add_f32 v[228:229], v[228:229], v[18:19]
    v_pk_add_f32 v[230:231], v[230:231], v[18:19]
    v_exp_f32 v228, v228
    v_exp_f32 v229, v229
    v_exp_f32 v230, v230
    v_exp_f32 v231, v231
    v_pk_add_f32 v[84:85], v[84:85], v[18:19]
    v_pk_add_f32 v[86:87], v[86:87], v[18:19]
    v_exp_f32 v84, v84
    v_exp_f32 v85, v85
    v_exp_f32 v86, v86
    v_exp_f32 v87, v87
    v_pk_add_f32 v[14:15], v[228:229], v[230:231]
    v_pk_add_f32 v[14:15], v[14:15], v[84:85]
    v_pk_add_f32 v[14:15], v[14:15], v[86:87]
    v_pk_mul_f32 v[228:229], v[228:229], v[236:237]
    v_pk_mul_f32 v[230:231], v[230:231], v[238:239]
    v_pk_mul_f32 v[84:85], v[84:85], v[80:81]
    v_pk_mul_f32 v[86:87], v[86:87], v[82:83]
    v_cvt_pk_bf16_f32 v244, v228, v229
    v_cvt_pk_bf16_f32 v245, v230, v231
    v_cvt_pk_bf16_f32 v246, v84, v85
    v_cvt_pk_bf16_f32 v247, v86, v87
    v_pk_add_f32 v[240:241], v[228:229], v[84:85]
    v_pk_add_f32 v[242:243], v[230:231], v[86:87]
    v_pk_mul_f32 v[252:253], v[228:229], v[232:233]
    v_pk_fma_f32 v[252:253], v[230:231], v[234:235], v[252:253]
    v_pk_fma_f32 v[252:253], v[84:85], v[76:77], v[252:253]
    v_pk_fma_f32 v[252:253], v[86:87], v[78:79], v[252:253]
    v_mov_b32 v21, 0
    v_mfma_f32_16x16x32_bf16 v[52:55], v[148:151], v[244:247], 0
    ds_read_b64_tr_b16 v[148:149], v10
    ds_read_b64 v[150:151], v21 offset:7056
    v_mfma_f32_16x16x32_bf16 v[56:59], v[154:157], v[244:247], 0
    ds_read_b64_tr_b16 v[154:155], v11
    ds_read_b64 v[156:157], v21 offset:7056
    v_mfma_f32_16x16x32_bf16 v[60:63], v[160:163], v[244:247], 0
    ds_read_b64_tr_b16 v[160:161], v12
    ds_read_b64 v[162:163], v21 offset:7056
    v_mfma_f32_16x16x32_bf16 v[64:67], v[166:169], v[244:247], 0
    ds_read_b64_tr_b16 v[166:167], v13
    ds_read_b64 v[168:169], v21 offset:7056
    v_mfma_f32_16x16x32_bf16 v[68:71], v[172:175], v[244:247], 0
    ds_read_b64_tr_b16 v[172:173], v10 offset:128
    ds_read_b64 v[174:175], v21 offset:7056
    v_mfma_f32_16x16x32_bf16 v[72:75], v[178:181], v[244:247], 0
    ds_read_b64_tr_b16 v[178:179], v11 offset:128
    ds_read_b64 v[180:181], v21 offset:7056
    v_mfma_f32_16x16x32_bf16 v[76:79], v[184:187], v[244:247], 0
    ds_read_b64_tr_b16 v[184:185], v12 offset:128
    ds_read_b64 v[186:187], v21 offset:7056
    v_mfma_f32_16x16x32_bf16 v[80:83], v[190:193], v[244:247], 0
    ds_read_b64_tr_b16 v[190:191], v13 offset:128
    ds_read_b64 v[192:193], v21 offset:7056
    v_mfma_f32_16x16x32_bf16 v[84:87], v[196:199], v[244:247], 0
    ds_read_b64_tr_b16 v[196:197], v10 offset:256
    ds_read_b64 v[198:199], v21 offset:7056
    v_mfma_f32_16x16x32_bf16 v[88:91], v[202:205], v[244:247], 0
    ds_read_b64_tr_b16 v[202:203], v11 offset:256
    ds_read_b64 v[204:205], v21 offset:7056
    v_mfma_f32_16x16x32_bf16 v[92:95], v[208:211], v[244:247], 0
    ds_read_b64_tr_b16 v[208:209], v12 offset:256
    ds_read_b64 v[210:211], v21 offset:7056
    v_mfma_f32_16x16x32_bf16 v[96:99], v[214:217], v[244:247], 0
    ds_read_b64_tr_b16 v[214:215], v13 offset:256
    ds_read_b64 v[216:217], v21 offset:7056
    s_nop 5
    s_branch L_tile2b
L_rescale:
    s_nop 15
    v_mul_f32 v4, v228, v236
    v_mul_f32 v5, v229, v237
    v_mul_f32 v6, v230, v238
    v_mul_f32 v7, v231, v239
    v_max3_f32 v21, v4, v5, v6
    v_max3_f32 v21, v21, v7, v254
    v_mov_b32 v22, v21
    v_mov_b32 v23, v21
    s_nop 1
    v_permlane32_swap_b32 v22, v23
    v_max_f32 v21, v22, v23
    v_mov_b32 v22, v21
    v_mov_b32 v23, v21
    s_nop 1
    v_permlane16_swap_b32 v22, v23
    v_max_f32 v21, v22, v23
    v_sub_f32 v22, v254, v21
    v_exp_f32 v22, v22
    v_mov_b32 v254, v21
    v_sub_f32 v18, 0, v21
    v_sub_f32 v19, 0, v21
    v_mov_b32 v23, v22
    v_sub_f32 v4, v4, v21
    v_sub_f32 v5, v5, v21
    v_sub_f32 v6, v6, v21
    v_sub_f32 v7, v7, v21
    v_exp_f32 v4, v4
    v_exp_f32 v5, v5
    v_exp_f32 v6, v6
    v_exp_f32 v7, v7
    v_pk_mul_f32 v[14:15], v[14:15], v[22:23]
    v_pk_mul_f32 v[252:253], v[252:253], v[22:23]
    v_pk_mul_f32 v[240:241], v[240:241], v[22:23]
    v_pk_mul_f32 v[242:243], v[242:243], v[22:23]
    v_pk_mul_f32 v[248:249], v[248:249], v[22:23]
    v_pk_mul_f32 v[250:251], v[250:251], v[22:23]
    v_pk_mul_f32 v[52:53], v[52:53], v[22:23]
    v_pk_mul_f32 v[54:55], v[54:55], v[22:23]
    v_pk_mul_f32 v[56:57], v[56:57], v[22:23]
    v_pk_mul_f32 v[58:59], v[58:59], v[22:23]
    v_pk_mul_f32 v[60:61], v[60:61], v[22:23]
    v_pk_mul_f32 v[62:63], v[62:63], v[22:23]
    v_pk_mul_f32 v[64:65], v[64:65], v[22:23]
    v_pk_mul_f32 v[66:67], v[66:67], v[22:23]
    v_pk_mul_f32 v[68:69], v[68:69], v[22:23]
    v_pk_mul_f32 v[70:71], v[70:71], v[22:23]
    v_pk_mul_f32 v[72:73], v[72:73], v[22:23]
    v_pk_mul_f32 v[74:75], v[74:75], v[22:23]
    v_pk_mul_f32 v[76:77], v[76:77], v[22:23]
    v_pk_mul_f32 v[78:79], v[78:79], v[22:23]
    v_pk_mul_f32 v[80:81], v[80:81], v[22:23]
    v_pk_mul_f32 v[82:83], v[82:83], v[22:23]
    v_pk_mul_f32 v[84:85], v[84:85], v[22:23]
    v_pk_mul_f32 v[86:87], v[86:87], v[22:23]
    v_pk_mul_f32 v[88:89], v[88:89], v[22:23]
    v_pk_mul_f32 v[90:91], v[90:91], v[22:23]
    v_pk_mul_f32 v[92:93], v[92:93], v[22:23]
    v_pk_mul_f32 v[94:95], v[94:95], v[22:23]
    v_pk_mul_f32 v[96:97], v[96:97], v[22:23]
    v_pk_mul_f32 v[98:99], v[98:99], v[22:23]
    s_nop 1
    s_setpc_b64 s[48:49]
L_loop:
    s_add_u32 s51, s51, 1
    s_cmp_lg_u32 s57, 0
    s_cbranch_scc1 L_begun32
L_spin33:
    ds_read_b32 v3, v1 offset:6912
    s_waitcnt lgkmcnt(0)
    v_readfirstlane_b32 s52, v3
    s_nop 0
    s_cmp_ge_u32 s52, s51
    s_cbranch_scc1 L_spun34
    s_sleep 1
    s_branch L_spin33
L_spun34:
    ds_read_b128 v[100:103], v8
    ds_read_b128 v[104:107], v9
    ds_read_b128 v[108:111], v8 offset:128
    ds_read_b128 v[112:115], v9 offset:128
    ds_read_b128 v[116:119], v8 offset:256
    ds_read_b128 v[120:123], v9 offset:256
L_begun32:
    v_mfma_f32_16x16x32_bf16 v[52:55], v[150:153], v[244:247], v[52:55]
    ds_read_b64_tr_b16 v[152:153], v10
    v_mfma_f32_16x16x32_bf16 v[56:59], v[156:159], v[244:247], v[56:59]
    ds_read_b64_tr_b16 v[158:159], v11
    v_mfma_f32_16x16x32_bf16 v[60:63], v[162:165], v[244:247], v[60:63]
    ds_read_b64_tr_b16 v[164:165], v12
    v_mfma_f32_16x16x32_bf16 v[64:67], v[168:171], v[244:247], v[64:67]
    ds_read_b64_tr_b16 v[170:171], v13
    v_mfma_f32_16x16x32_bf16 v[68:71], v[174:177], v[244:247], v[68:71]
    ds_read_b64_tr_b16 v[176:177], v10 offset:128
    v_mfma_f32_16x16x32_bf16 v[72:75], v[180:183], v[244:247], v[72:75]
    ds_read_b64_tr_b16 v[182:183], v11 offset:128
    v_mfma_f32_16x16x32_bf16 v[76:79], v[186:189], v[244:247], v[76:79]
    ds_read_b64_tr_b16 v[188:189], v12 offset:128
    v_mfma_f32_16x16x32_bf16 v[80:83], v[192:195], v[244:247], v[80:83]
    ds_read_b64_tr_b16 v[194:195], v13 offset:128
    v_mfma_f32_16x16x32_bf16 v[84:87], v[198:201], v[244:247], v[84:87]
    ds_read_b64_tr_b16 v[200:201], v10 offset:256
    v_mfma_f32_16x16x32_bf16 v[88:91], v[204:207], v[244:247], v[88:91]
    ds_read_b64_tr_b16 v[206:207], v11 offset:256
    v_mfma_f32_16x16x32_bf16 v[92:95], v[210:213], v[244:247], v[92:95]
    ds_read_b64_tr_b16 v[212:213], v12 offset:256
    v_mfma_f32_16x16x32_bf16 v[96:99], v[216:219], v[244:247], v[96:99]
    ds_read_b64_tr_b16 v[218:219], v13 offset:256
    s_waitcnt lgkmcnt(12)
    v_mfma_f32_16x16x32_bf16 v[224:227], v[100:103], v[24:27], 0
    v_mfma_f32_16x16x32_bf16 v[224:227], v[104:107], v[24:27], v[224:227]
    v_mfma_f32_16x16x32_bf16 v[224:227], v[108:111], v[24:27], v[224:227]
    v_mfma_f32_16x16x32_bf16 v[224:227], v[112:115], v[24:27], v[224:227]
    v_mfma_f32_16x16x32_bf16 v[224:227], v[116:119], v[24:27], v[224:227]
    v_mfma_f32_16x16x32_bf16 v[224:227], v[120:123], v[24:27], v[224:227]
    s_add_u32 s54, s54, 1
    s_cmp_eq_u32 s54, 6
    s_cselect_b32 s55, 0xffff8800, s56
    s_cselect_b32 s54, 0, s54
    v_mfma_f32_16x16x32_bf16 v[220:223], v[100:103], v[28:31], 0
    v_add_u32 v8, s55, v8
    v_add_u32 v9, s55, v9
    v_mfma_f32_16x16x32_bf16 v[220:223], v[104:107], v[32:35], v[220:223]
    v_mov_b32 v2, s51
    v_add_u32 v10, s55, v10
    v_mfma_f32_16x16x32_bf16 v[220:223], v[108:111], v[36:39], v[220:223]
    v_add_u32 v11, s55, v11
    v_add_u32 v12, s55, v12
    v_mfma_f32_16x16x32_bf16 v[220:223], v[112:115], v[40:43], v[220:223]
    v_add_u32 v13, s55, v13
    ds_read_b32 v3, v1 offset:6912
    v_mfma_f32_16x16x32_bf16 v[220:223], v[116:119], v[44:47], v[220:223]
    v_mfma_f32_16x16x32_bf16 v[220:223], v[120:123], v[48:51], v[220:223]
    s_waitcnt lgkmcnt(0)
    ds_write_b32 v1, v2 offset:6928
    v_readfirstlane_b32 s52, v3
    s_mov_b32 s57, 0
    s_nop 0
    s_cmp_gt_u32 s52, s51
    s_cbranch_scc0 L_early35
    s_mov_b32 s57, 1
    ds_read_b128 v[124:127], v8
    ds_read_b128 v[128:131], v9
    ds_read_b128 v[132:135], v8 offset:128
    ds_read_b128 v[136:139], v9 offset:128
    ds_read_b128 v[140:143], v8 offset:256
    ds_read_b128 v[144:147], v9 offset:256
L_early35:
    v_dot2_f32_bf16 v22, v100, v100, 0
    v_dot2_f32_bf16 v23, v101, v101, 0
    v_dot2_f32_bf16 v22, v102, v102, v22
    v_dot2_f32_bf16 v23, v103, v103, v23
    v_dot2_f32_bf16 v22, v104, v104, v22
    v_dot2_f32_bf16 v23, v105, v105, v23
    v_dot2_f32_bf16 v22, v106, v106, v22
    v_dot2_f32_bf16 v23, v107, v107, v23
    v_dot2_f32_bf16 v22, v108, v108, v22
    v_dot2_f32_bf16 v23, v109, v109, v23
    v_dot2_f32_bf16 v22, v110, v110, v22
    v_dot2_f32_bf16 v23, v111, v111, v23
    v_dot2_f32_bf16 v22, v112, v112, v22
    v_dot2_f32_bf16 v23, v113, v113, v23
    v_dot2_f32_bf16 v22, v114, v114, v22
    v_dot2_f32_bf16 v23, v115, v115, v23
    v_dot2_f32_bf16 v22, v116, v116, v22
    v_dot2_f32_bf16 v23, v117, v117, v23
    v_dot2_f32_bf16 v22, v118, v118, v22
    v_dot2_f32_bf16 v23, v119, v119, v23
    v_dot2_f32_bf16 v22, v120, v120, v22
    v_dot2_f32_bf16 v23, v121, v121, v23
    v_dot2_f32_bf16 v22, v122, v122, v22
    v_dot2_f32_bf16 v23, v123, v123, v23
    s_nop 2
    v_add_f32 v255, v22, v23
    s_add_u32 s51, s51, 1
    s_cmp_lg_u32 s57, 0
    s_cbranch_scc1 L_begun36
L_spin37:
    ds_read_b32 v3, v1 offset:6912
    s_waitcnt lgkmcnt(0)
    v_readfirstlane_b32 s52, v3
    s_nop 0
    s_cmp_ge_u32 s52, s51
    s_cbranch_scc1 L_spun38
    s_sleep 1
    s_branch L_spin37
L_spun38:
    ds_read_b128 v[124:127], v8
    ds_read_b128 v[128:131], v9
    ds_read_b128 v[132:135], v8 offset:128
    ds_read_b128 v[136:139], v9 offset:128
    ds_read_b128 v[140:143], v8 offset:256
    ds_read_b128 v[144:147], v9 offset:256
L_begun36:
    s_waitcnt lgkmcnt(5)
    v_mfma_f32_16x16x32_bf16 v[232:235], v[124:127], v[24:27], v[224:227]
    ds_read_b64_tr_b16 v[148:149], v10
    s_add_u32 s54, s54, 1
    s_cmp_eq_u32 s54, 6
    s_cselect_b32 s55, 0xffff8800, s56
    s_cselect_b32 s54, 0, s54
    v_mfma_f32_16x16x32_bf16 v[228:231], v[124:127], v[28:31], v[220:223]
    ds_read_b64_tr_b16 v[154:155], v11
    v_add_u32 v8, s55, v8
    s_waitcnt lgkmcnt(6)
    v_mfma_f32_16x16x32_bf16 v[232:235], v[128:131], v[24:27], v[232:235]
    ds_read_b64_tr_b16 v[160:161], v12
    ds_read_b64_tr_b16 v[166:167], v13
    v_mfma_f32_16x16x32_bf16 v[228:231], v[128:131], v[32:35], v[228:231]
    ds_read_b64_tr_b16 v[172:173], v10 offset:128
    v_add_u32 v9, s55, v9
    s_waitcnt lgkmcnt(8)
    v_mfma_f32_16x16x32_bf16 v[232:235], v[132:135], v[24:27], v[232:235]
    ds_read_b64_tr_b16 v[178:179], v11 offset:128
    ds_read_b64_tr_b16 v[184:185], v12 offset:128
    v_mfma_f32_16x16x32_bf16 v[228:231], v[132:135], v[36:39], v[228:231]
    ds_read_b64_tr_b16 v[190:191], v13 offset:128
    v_mov_b32 v2, s51
    s_waitcnt lgkmcnt(10)
    v_mfma_f32_16x16x32_bf16 v[232:235], v[136:139], v[24:27], v[232:235]
    ds_read_b64_tr_b16 v[196:197], v10 offset:256
    v_mfma_f32_16x16x32_bf16 v[228:231], v[136:139], v[40:43], v[228:231]
    ds_read_b64_tr_b16 v[202:203], v11 offset:256
    s_waitcnt lgkmcnt(11)
    v_mfma_f32_16x16x32_bf16 v[232:235], v[140:143], v[24:27], v[232:235]
    ds_read_b64_tr_b16 v[208:209], v12 offset:256
    v_mfma_f32_16x16x32_bf16 v[228:231], v[140:143], v[44:47], v[228:231]
    ds_read_b64_tr_b16 v[214:215], v13 offset:256
    ds_read_b32 v3, v1 offset:6912
    s_waitcnt lgkmcnt(13)
    v_mfma_f32_16x16x32_bf16 v[232:235], v[144:147], v[24:27], v[232:235]
    v_add_u32 v10, s55, v10
    v_add_u32 v11, s55, v11
    v_mfma_f32_16x16x32_bf16 v[228:231], v[144:147], v[48:51], v[228:231]
    v_add_u32 v12, s55, v12
    v_add_u32 v13, s55, v13
    s_waitcnt lgkmcnt(0)
    ds_write_b32 v1, v2 offset:6928
    v_dot2_f32_bf16 v22, v124, v124, v255
    v_dot2_f32_bf16 v23, v124, v100, 0
    v_dot2_f32_bf16 v22, v125, v125, v22
    v_dot2_f32_bf16 v23, v125, v101, v23
    v_dot2_f32_bf16 v22, v126, v126, v22
    v_dot2_f32_bf16 v23, v126, v102, v23
    v_dot2_f32_bf16 v22, v127, v127, v22
    v_dot2_f32_bf16 v23, v127, v103, v23
    v_dot2_f32_bf16 v22, v128, v128, v22
    v_dot2_f32_bf16 v23, v128, v104, v23
    v_dot2_f32_bf16 v22, v129, v129, v22
    v_dot2_f32_bf16 v23, v129, v105, v23
    v_dot2_f32_bf16 v22, v130, v130, v22
    v_dot2_f32_bf16 v23, v130, v106, v23
    v_dot2_f32_bf16 v22, v131, v131, v22
    v_dot2_f32_bf16 v23, v131, v107, v23
    v_dot2_f32_bf16 v22, v132, v132, v22
    v_dot2_f32_bf16 v23, v132, v108, v23
    v_dot2_f32_bf16 v22, v133, v133, v22
    v_dot2_f32_bf16 v23, v133, v109, v23
    v_dot2_f32_bf16 v22, v134, v134, v22
    v_dot2_f32_bf16 v23, v134, v110, v23
    v_dot2_f32_bf16 v22, v135, v135, v22
    v_dot2_f32_bf16 v23, v135, v111, v23
    v_dot2_f32_bf16 v22, v136, v136, v22
    v_dot2_f32_bf16 v23, v136, v112, v23
    v_dot2_f32_bf16 v22, v137, v137, v22
    v_dot2_f32_bf16 v23, v137, v113, v23
    v_dot2_f32_bf16 v22, v138, v138, v22
    v_dot2_f32_bf16 v23, v138, v114, v23
    v_dot2_f32_bf16 v22, v139, v139, v22
    v_dot2_f32_bf16 v23, v139, v115, v23
    v_dot2_f32_bf16 v22, v140, v140, v22
    v_dot2_f32_bf16 v23, v140, v116, v23
    v_dot2_f32_bf16 v22, v141, v141, v22
    v_dot2_f32_bf16 v23, v141, v117, v23
    v_dot2_f32_bf16 v22, v142, v142, v22
    v_dot2_f32_bf16 v23, v142, v118, v23
    v_dot2_f32_bf16 v22, v143, v143, v22
    v_dot2_f32_bf16 v23, v143, v119, v23
    v_dot2_f32_bf16 v22, v144, v144, v22
    v_dot2_f32_bf16 v23, v144, v120, v23
    v_dot2_f32_bf16 v22, v145, v145, v22
    v_dot2_f32_bf16 v23, v145, v121, v23
    v_dot2_f32_bf16 v22, v146, v146, v22
    v_dot2_f32_bf16 v23, v146, v122, v23
    v_dot2_f32_bf16 v22, v147, v147, v22
    v_dot2_f32_bf16 v23, v147, v123, v23
    s_nop 2
    v_fma_f32 v22, v23, 2.0, v22
    s_nop 1
    v_mfma_f32_16x16x4_f32 v[236:239], v22, v20, 0
    v_readfirstlane_b32 s52, v3
    s_mov_b32 s57, 0
    s_nop 0
    s_cmp_gt_u32 s52, s51
    s_cbranch_scc0 L_early39
    s_mov_b32 s57, 1
    ds_read_b128 v[124:127], v8
    ds_read_b128 v[128:131], v9
    ds_read_b128 v[132:135], v8 offset:128
    ds_read_b128 v[136:139], v9 offset:128
    ds_read_b128 v[140:143], v8 offset:256
    ds_read_b128 v[144:147], v9 offset:256
L_early39:
    v_pk_mul_f32 v[232:233], v[232:233], s[44:45]
    v_pk_mul_f32 v[234:235], v[234:235], s[44:45]
    v_pk_fma_f32 v[4:5], v[232:233], v[232:233], s[46:47] neg_lo:[1,0,0] neg_hi:[1,0,0]
    v_pk_fma_f32 v[6:7], v[234:235], v[234:235], s[46:47] neg_lo:[1,0,0] neg_hi:[1,0,0]
    s_nop 0
    v_pk_fma_f32 v[236:237], v[236:237], s[44:45], v[4:5]
    v_pk_fma_f32 v[238:239], v[238:239], s[44:45], v[6:7]
    v_max_f32 v236, s46, v236
    v_max_f32 v237, s46, v237
    v_max_f32 v238, s46, v238
    v_max_f32 v239, s46, v239
    v_rsq_f32 v236, v236
    v_rsq_f32 v237, v237
    v_rsq_f32 v238, v238
    v_rsq_f32 v239, v239
    v_pk_fma_f32 v[228:229], v[232:233], v[16:17], v[228:229] neg_lo:[1,0,0] neg_hi:[1,0,0]
    v_pk_fma_f32 v[230:231], v[234:235], v[16:17], v[230:231] neg_lo:[1,0,0] neg_hi:[1,0,0]
    v_pk_fma_f32 v[4:5], v[228:229], v[236:237], v[18:19]
    v_pk_fma_f32 v[6:7], v[230:231], v[238:239], v[18:19]
    v_max3_f32 v21, v4, v5, v6
    v_max_f32 v21, v21, v7
    v_cmp_lt_f32 vcc, s50, v21
    v_exp_f32 v4, v4
    v_exp_f32 v5, v5
    v_exp_f32 v6, v6
    v_exp_f32 v7, v7
    s_cbranch_vccz L_sm40
    s_call_b64 s[48:49], L_rescale
L_sm40:
    v_pk_mul_f32 v[248:249], v[4:5], v[236:237]
    v_pk_add_f32 v[14:15], v[14:15], v[4:5]
    v_pk_mul_f32 v[250:251], v[6:7], v[238:239]
    v_pk_add_f32 v[14:15], v[14:15], v[6:7]
    v_mov_b32 v240, v248
    v_mov_b32 v241, v249
    v_mov_b32 v242, v250
    v_mov_b32 v243, v251
    v_pk_fma_f32 v[252:253], v[248:249], v[232:233], v[252:253]
    v_pk_fma_f32 v[252:253], v[250:251], v[234:235], v[252:253]
    s_add_u32 s51, s51, 1
    s_cmp_lg_u32 s57, 0
    s_cbranch_scc1 L_begun41
L_spin42:
    ds_read_b32 v3, v1 offset:6912
    s_waitcnt lgkmcnt(0)
    v_readfirstlane_b32 s52, v3
    s_nop 0
    s_cmp_ge_u32 s52, s51
    s_cbranch_scc1 L_spun43
    s_sleep 1
    s_branch L_spin42
L_spun43:
    ds_read_b128 v[124:127], v8
    ds_read_b128 v[128:131], v9
    ds_read_b128 v[132:135], v8 offset:128
    ds_read_b128 v[136:139], v9 offset:128
    ds_read_b128 v[140:143], v8 offset:256
    ds_read_b128 v[144:147], v9 offset:256
L_begun41:
    s_waitcnt lgkmcnt(5)
    v_mfma_f32_16x16x32_bf16 v[232:235], v[124:127], v[24:27], v[224:227]
    ds_read_b64_tr_b16 v[150:151], v10
    s_add_u32 s54, s54, 1
    s_cmp_eq_u32 s54, 6
    s_cselect_b32 s55, 0xffff8800, s56
    s_cselect_b32 s54, 0, s54
    v_mfma_f32_16x16x32_bf16 v[228:231], v[124:127], v[28:31], v[220:223]
    ds_read_b64_tr_b16 v[156:157], v11
    v_add_u32 v8, s55, v8
    s_waitcnt lgkmcnt(6)
    v_mfma_f32_16x16x32_bf16 v[232:235], v[128:131], v[24:27], v[232:235]
    ds_read_b64_tr_b16 v[162:163], v12
    ds_read_b64_tr_b16 v[168:169], v13
    v_mfma_f32_16x16x32_bf16 v[228:231], v[128:131], v[32:35], v[228:231]
    ds_read_b64_tr_b16 v[174:175], v10 offset:128
    v_add_u32 v9, s55, v9
    s_waitcnt lgkmcnt(8)
    v_mfma_f32_16x16x32_bf16 v[232:235], v[132:135], v[24:27], v[232:235]
    ds_read_b64_tr_b16 v[180:181], v11 offset:128
    ds_read_b64_tr_b16 v[186:187], v12 offset:128
    v_mfma_f32_16x16x32_bf16 v[228:231], v[132:135], v[36:39], v[228:231]
    ds_read_b64_tr_b16 v[192:193], v13 offset:128
    v_mov_b32 v2, s51
    s_waitcnt lgkmcnt(10)
    v_mfma_f32_16x16x32_bf16 v[232:235], v[136:139], v[24:27], v[232:235]
    ds_read_b64_tr_b16 v[198:199], v10 offset:256
    v_mfma_f32_16x16x32_bf16 v[228:231], v[136:139], v[40:43], v[228:231]
    ds_read_b64_tr_b16 v[204:205], v11 offset:256
    s_waitcnt lgkmcnt(11)
    v_mfma_f32_16x16x32_bf16 v[232:235], v[140:143], v[24:27], v[232:235]
    ds_read_b64_tr_b16 v[210:211], v12 offset:256
    v_mfma_f32_16x16x32_bf16 v[228:231], v[140:143], v[44:47], v[228:231]
    ds_read_b64_tr_b16 v[216:217], v13 offset:256
    ds_read_b32 v3, v1 offset:6912
    s_waitcnt lgkmcnt(13)
    v_mfma_f32_16x16x32_bf16 v[232:235], v[144:147], v[24:27], v[232:235]
    v_add_u32 v10, s55, v10
    v_add_u32 v11, s55, v11
    v_mfma_f32_16x16x32_bf16 v[228:231], v[144:147], v[48:51], v[228:231]
    v_add_u32 v12, s55, v12
    v_add_u32 v13, s55, v13
    s_waitcnt lgkmcnt(0)
    ds_write_b32 v1, v2 offset:6928
    v_dot2_f32_bf16 v22, v124, v124, v255
    v_dot2_f32_bf16 v23, v124, v100, 0
    v_dot2_f32_bf16 v22, v125, v125, v22
    v_dot2_f32_bf16 v23, v125, v101, v23
    v_dot2_f32_bf16 v22, v126, v126, v22
    v_dot2_f32_bf16 v23, v126, v102, v23
    v_dot2_f32_bf16 v22, v127, v127, v22
    v_dot2_f32_bf16 v23, v127, v103, v23
    v_dot2_f32_bf16 v22, v128, v128, v22
    v_dot2_f32_bf16 v23, v128, v104, v23
    v_dot2_f32_bf16 v22, v129, v129, v22
    v_dot2_f32_bf16 v23, v129, v105, v23
    v_dot2_f32_bf16 v22, v130, v130, v22
    v_dot2_f32_bf16 v23, v130, v106, v23
    v_dot2_f32_bf16 v22, v131, v131, v22
    v_dot2_f32_bf16 v23, v131, v107, v23
    v_dot2_f32_bf16 v22, v132, v132, v22
    v_dot2_f32_bf16 v23, v132, v108, v23
    v_dot2_f32_bf16 v22, v133, v133, v22
    v_dot2_f32_bf16 v23, v133, v109, v23
    v_dot2_f32_bf16 v22, v134, v134, v22
    v_dot2_f32_bf16 v23, v134, v110, v23
    v_dot2_f32_bf16 v22, v135, v135, v22
    v_dot2_f32_bf16 v23, v135, v111, v23
    v_dot2_f32_bf16 v22, v136, v136, v22
    v_dot2_f32_bf16 v23, v136, v112, v23
    v_dot2_f32_bf16 v22, v137, v137, v22
    v_dot2_f32_bf16 v23, v137, v113, v23
    v_dot2_f32_bf16 v22, v138, v138, v22
    v_dot2_f32_bf16 v23, v138, v114, v23
    v_dot2_f32_bf16 v22, v139, v139, v22
    v_dot2_f32_bf16 v23, v139, v115, v23
    v_dot2_f32_bf16 v22, v140, v140, v22
    v_dot2_f32_bf16 v23, v140, v116, v23
    v_dot2_f32_bf16 v22, v141, v141, v22
    v_dot2_f32_bf16 v23, v141, v117, v23
    v_dot2_f32_bf16 v22, v142, v142, v22
    v_dot2_f32_bf16 v23, v142, v118, v23
    v_dot2_f32_bf16 v22, v143, v143, v22
    v_dot2_f32_bf16 v23, v143, v119, v23
    v_dot2_f32_bf16 v22, v144, v144, v22
    v_dot2_f32_bf16 v23, v144, v120, v23
    v_dot2_f32_bf16 v22, v145, v145, v22
    v_dot2_f32_bf16 v23, v145, v121, v23
    v_dot2_f32_bf16 v22, v146, v146, v22
    v_dot2_f32_bf16 v23, v146, v122, v23
    v_dot2_f32_bf16 v22, v147, v147, v22
    v_dot2_f32_bf16 v23, v147, v123, v23
    s_nop 2
    v_fma_f32 v22, v23, 2.0, v22
    s_nop 1
    v_mfma_f32_16x16x4_f32 v[236:239], v22, v20, 0
    v_readfirstlane_b32 s52, v3
    s_mov_b32 s57, 0
    s_nop 0
    s_cmp_gt_u32 s52, s51
    s_cbranch_scc0 L_early44
    s_mov_b32 s57, 1
    ds_read_b128 v[124:127], v8
    ds_read_b128 v[128:131], v9
    ds_read_b128 v[132:135], v8 offset:128
    ds_read_b128 v[136:139], v9 offset:128
    ds_read_b128 v[140:143], v8 offset:256
    ds_read_b128 v[144:147], v9 offset:256
L_early44:
    v_pk_mul_f32 v[232:233], v[232:233], s[44:45]
    v_pk_mul_f32 v[234:235], v[234:235], s[44:45]
    v_pk_fma_f32 v[4:5], v[232:233], v[232:233], s[46:47] neg_lo:[1,0,0] neg_hi:[1,0,0]
    v_pk_fma_f32 v[6:7], v[234:235], v[234:235], s[46:47] neg_lo:[1,0,0] neg_hi:[1,0,0]
    s_nop 0
    v_pk_fma_f32 v[236:237], v[236:237], s[44:45], v[4:5]
    v_pk_fma_f32 v[238:239], v[238:239], s[44:45], v[6:7]
    v_max_f32 v236, s46, v236
    v_max_f32 v237, s46, v237
    v_max_f32 v238, s46, v238
    v_max_f32 v239, s46, v239
    v_rsq_f32 v236, v236
    v_rsq_f32 v237, v237
    v_rsq_f32 v238, v238
    v_rsq_f32 v239, v239
    v_pk_fma_f32 v[228:229], v[232:233], v[16:17], v[228:229] neg_lo:[1,0,0] neg_hi:[1,0,0]
    v_pk_fma_f32 v[230:231], v[234:235], v[16:17], v[230:231] neg_lo:[1,0,0] neg_hi:[1,0,0]
    v_pk_fma_f32 v[4:5], v[228:229], v[236:237], v[18:19]
    v_pk_fma_f32 v[6:7], v[230:231], v[238:239], v[18:19]
    v_max3_f32 v21, v4, v5, v6
    v_max_f32 v21, v21, v7
    v_cmp_lt_f32 vcc, s50, v21
    v_exp_f32 v4, v4
    v_exp_f32 v5, v5
    v_exp_f32 v6, v6
    v_exp_f32 v7, v7
    s_cbranch_vccz L_sm45
    s_call_b64 s[48:49], L_rescale
L_sm45:
    v_pk_mul_f32 v[228:229], v[4:5], v[236:237]
    v_pk_add_f32 v[14:15], v[14:15], v[4:5]
    v_pk_mul_f32 v[230:231], v[6:7], v[238:239]
    v_pk_add_f32 v[14:15], v[14:15], v[6:7]
    v_pk_add_f32 v[240:241], v[240:241], v[228:229]
    v_pk_add_f32 v[242:243], v[242:243], v[230:231]
    v_pk_fma_f32 v[252:253], v[228:229], v[232:233], v[252:253]
    v_pk_fma_f32 v[252:253], v[230:231], v[234:235], v[252:253]
    v_cvt_pk_bf16_f32 v244, v248, v249
    v_cvt_pk_bf16_f32 v245, v250, v251
    v_cvt_pk_bf16_f32 v246, v228, v229
    v_cvt_pk_bf16_f32 v247, v230, v231
    s_add_u32 s51, s51, 1
    s_cmp_lg_u32 s57, 0
    s_cbranch_scc1 L_begun46
L_spin47:
    ds_read_b32 v3, v1 offset:6912
    s_waitcnt lgkmcnt(0)
    v_readfirstlane_b32 s52, v3
    s_nop 0
    s_cmp_ge_u32 s52, s51
    s_cbranch_scc1 L_spun48
    s_sleep 1
    s_branch L_spin47
L_spun48:
    ds_read_b128 v[124:127], v8
    ds_read_b128 v[128:131], v9
    ds_read_b128 v[132:135], v8 offset:128
    ds_read_b128 v[136:139], v9 offset:128
    ds_read_b128 v[140:143], v8 offset:256
    ds_read_b128 v[144:147], v9 offset:256
L_begun46:
    v_mov_b32 v21, 0
    v_mfma_f32_16x16x32_bf16 v[52:55], v[148:151], v[244:247], v[52:55]
    ds_read_b64_tr_b16 v[148:149], v10
    ds_read_b64 v[150:151], v21 offset:7056
    v_mfma_f32_16x16x32_bf16 v[56:59], v[154:157], v[244:247], v[56:59]
    ds_read_b64_tr_b16 v[154:155], v11
    ds_read_b64 v[156:157], v21 offset:7056
    v_mfma_f32_16x16x32_bf16 v[60:63], v[160:163], v[244:247], v[60:63]
    ds_read_b64_tr_b16 v[160:161], v12
    ds_read_b64 v[162:163], v21 offset:7056
    v_mfma_f32_16x16x32_bf16 v[64:67], v[166:169], v[244:247], v[64:67]
    ds_read_b64_tr_b16 v[166:167], v13
    ds_read_b64 v[168:169], v21 offset:7056
    v_mfma_f32_16x16x32_bf16 v[68:71], v[172:175], v[244:247], v[68:71]
    ds_read_b64_tr_b16 v[172:173], v10 offset:128
    ds_read_b64 v[174:175], v21 offset:7056
    v_mfma_f32_16x16x32_bf16 v[72:75], v[178:181], v[244:247], v[72:75]
    ds_read_b64_tr_b16 v[178:179], v11 offset:128
    ds_read_b64 v[180:181], v21 offset:7056
    v_mfma_f32_16x16x32_bf16 v[76:79], v[184:187], v[244:247], v[76:79]
    ds_read_b64_tr_b16 v[184:185], v12 offset:128
    ds_read_b64 v[186:187], v21 offset:7056
    v_mfma_f32_16x16x32_bf16 v[80:83], v[190:193], v[244:247], v[80:83]
    ds_read_b64_tr_b16 v[190:191], v13 offset:128
    ds_read_b64 v[192:193], v21 offset:7056
    v_mfma_f32_16x16x32_bf16 v[84:87], v[196:199], v[244:247], v[84:87]
    ds_read_b64_tr_b16 v[196:197], v10 offset:256
    ds_read_b64 v[198:199], v21 offset:7056
    v_mfma_f32_16x16x32_bf16 v[88:91], v[202:205], v[244:247], v[88:91]
    ds_read_b64_tr_b16 v[202:203], v11 offset:256
    ds_read_b64 v[204:205], v21 offset:7056
    v_mfma_f32_16x16x32_bf16 v[92:95], v[208:211], v[244:247], v[92:95]
    ds_read_b64_tr_b16 v[208:209], v12 offset:256
    ds_read_b64 v[210:211], v21 offset:7056
    v_mfma_f32_16x16x32_bf16 v[96:99], v[214:217], v[244:247], v[96:99]
    ds_read_b64_tr_b16 v[214:215], v13 offset:256
    ds_read_b64 v[216:217], v21 offset:7056
    s_nop 5
L_tile2b:
    s_waitcnt lgkmcnt(15)
    v_mfma_f32_16x16x32_bf16 v[232:235], v[124:127], v[24:27], v[224:227]
    s_add_u32 s54, s54, 1
    s_cmp_eq_u32 s54, 6
    s_cselect_b32 s55, 0xffff8800, s56
    s_cselect_b32 s54, 0, s54
    v_mfma_f32_16x16x32_bf16 v[228:231], v[124:127], v[28:31], v[220:223]
    v_add_u32 v8, s55, v8
    v_mfma_f32_16x16x32_bf16 v[232:235], v[128:131], v[24:27], v[232:235]
    v_mfma_f32_16x16x32_bf16 v[228:231], v[128:131], v[32:35], v[228:231]
    v_add_u32 v9, s55, v9
    v_mfma_f32_16x16x32_bf16 v[232:235], v[132:135], v[24:27], v[232:235]
    v_mfma_f32_16x16x32_bf16 v[228:231], v[132:135], v[36:39], v[228:231]
    v_mov_b32 v2, s51
    v_mfma_f32_16x16x32_bf16 v[232:235], v[136:139], v[24:27], v[232:235]
    v_mfma_f32_16x16x32_bf16 v[228:231], v[136:139], v[40:43], v[228:231]
    v_mfma_f32_16x16x32_bf16 v[232:235], v[140:143], v[24:27], v[232:235]
    v_mfma_f32_16x16x32_bf16 v[228:231], v[140:143], v[44:47], v[228:231]
    ds_read_b32 v3, v1 offset:6912
    v_mfma_f32_16x16x32_bf16 v[232:235], v[144:147], v[24:27], v[232:235]
    v_add_u32 v10, s55, v10
    v_add_u32 v11, s55, v11
    v_mfma_f32_16x16x32_bf16 v[228:231], v[144:147], v[48:51], v[228:231]
    v_add_u32 v12, s55, v12
    v_add_u32 v13, s55, v13
    s_waitcnt lgkmcnt(0)
    ds_write_b32 v1, v2 offset:6928
    v_dot2_f32_bf16 v22, v124, v124, v255
    v_dot2_f32_bf16 v23, v124, v100, 0
    v_dot2_f32_bf16 v22, v125, v125, v22
    v_dot2_f32_bf16 v23, v125, v101, v23
    v_dot2_f32_bf16 v22, v126, v126, v22
    v_dot2_f32_bf16 v23, v126, v102, v23
    v_dot2_f32_bf16 v22, v127, v127, v22
    v_dot2_f32_bf16 v23, v127, v103, v23
    v_dot2_f32_bf16 v22, v128, v128, v22
    v_dot2_f32_bf16 v23, v128, v104, v23
    v_dot2_f32_bf16 v22, v129, v129, v22
    v_dot2_f32_bf16 v23, v129, v105, v23
    v_dot2_f32_bf16 v22, v130, v130, v22
    v_dot2_f32_bf16 v23, v130, v106, v23
    v_dot2_f32_bf16 v22, v131, v131, v22
    v_dot2_f32_bf16 v23, v131, v107, v23
    v_dot2_f32_bf16 v22, v132, v132, v22
    v_dot2_f32_bf16 v23, v132, v108, v23
    v_dot2_f32_bf16 v22, v133, v133, v22
    v_dot2_f32_bf16 v23, v133, v109, v23
    v_dot2_f32_bf16 v22, v134, v134, v22
    v_dot2_f32_bf16 v23, v134, v110, v23
    v_dot2_f32_bf16 v22, v135, v135, v22
    v_dot2_f32_bf16 v23, v135, v111, v23
    v_dot2_f32_bf16 v22, v136, v136, v22
    v_dot2_f32_bf16 v23, v136, v112, v23
    v_dot2_f32_bf16 v22, v137, v137, v22
    v_dot2_f32_bf16 v23, v137, v113, v23
    v_dot2_f32_bf16 v22, v138, v138, v22
    v_dot2_f32_bf16 v23, v138, v114, v23
    v_dot2_f32_bf16 v22, v139, v139, v22
    v_dot2_f32_bf16 v23, v139, v115, v23
    v_dot2_f32_bf16 v22, v140, v140, v22
    v_dot2_f32_bf16 v23, v140, v116, v23
    v_dot2_f32_bf16 v22, v141, v141, v22
    v_dot2_f32_bf16 v23, v141, v117, v23
    v_dot2_f32_bf16 v22, v142, v142, v22
    v_dot2_f32_bf16 v23, v142, v118, v23
    v_dot2_f32_bf16 v22, v143, v143, v22
    v_dot2_f32_bf16 v23, v143, v119, v23
    v_dot2_f32_bf16 v22, v144, v144, v22
    v_dot2_f32_bf16 v23, v144, v120, v23
    v_dot2_f32_bf16 v22, v145, v145, v22
    v_dot2_f32_bf16 v23, v145, v121, v23
    v_dot2_f32_bf16 v22, v146, v146, v22
    v_dot2_f32_bf16 v23, v146, v122, v23
    v_dot2_f32_bf16 v22, v147, v147, v22
    v_dot2_f32_bf16 v23, v147, v123, v23
    s_nop 2
    v_fma_f32 v22, v23, 2.0, v22
    s_nop 1
    v_mfma_f32_16x16x4_f32 v[236:239], v22, v20, 0
    v_readfirstlane_b32 s52, v3
    s_mov_b32 s57, 0
    s_nop 0
    s_cmp_gt_u32 s52, s51
    s_cbranch_scc0 L_early49
    s_mov_b32 s57, 1
    ds_read_b128 v[124:127], v8
    ds_read_b128 v[128:131], v9
    ds_read_b128 v[132:135], v8 offset:128
    ds_read_b128 v[136:139], v9 offset:128
    ds_read_b128 v[140:143], v8 offset:256
    ds_read_b128 v[144:147], v9 offset:256
L_early49:
    ds_read_b32 v3, v1 offset:6912
    v_pk_mul_f32 v[232:233], v[232:233], s[44:45]
    v_pk_mul_f32 v[234:235], v[234:235], s[44:45]
    v_pk_fma_f32 v[4:5], v[232:233], v[232:233], s[46:47] neg_lo:[1,0,0] neg_hi:[1,0,0]
    v_pk_fma_f32 v[6:7], v[234:235], v[234:235], s[46:47] neg_lo:[1,0,0] neg_hi:[1,0,0]
    v_pk_fma_f32 v[236:237], v[236:237], s[44:45], v[4:5]
    v_pk_fma_f32 v[238:239], v[238:239], s[44:45], v[6:7]
    v_max_f32 v236, s46, v236
    v_max_f32 v237, s46, v237
    v_max_f32 v238, s46, v238
    v_max_f32 v239, s46, v239
    v_rsq_f32 v236, v236
    v_rsq_f32 v237, v237
    v_rsq_f32 v238, v238
    v_rsq_f32 v239, v239
    v_pk_fma_f32 v[228:229], v[232:233], v[16:17], v[228:229] neg_lo:[1,0,0] neg_hi:[1,0,0]
    v_pk_fma_f32 v[230:231], v[234:235], v[16:17], v[230:231] neg_lo:[1,0,0] neg_hi:[1,0,0]
    v_pk_fma_f32 v[4:5], v[228:229], v[236:237], v[18:19]
    v_pk_fma_f32 v[6:7], v[230:231], v[238:239], v[18:19]
    v_max3_f32 v21, v4, v5, v6
    v_max_f32 v21, v21, v7
    v_cmp_lt_f32 vcc, s50, v21
    v_exp_f32 v4, v4
    v_exp_f32 v5, v5
    v_exp_f32 v6, v6
    v_exp_f32 v7, v7
    s_cbranch_vccz L_sm50
    s_call_b64 s[48:49], L_rescale
L_sm50:
    v_pk_mul_f32 v[248:249], v[4:5], v[236:237]
    v_pk_add_f32 v[14:15], v[14:15], v[4:5]
    v_pk_mul_f32 v[250:251], v[6:7], v[238:239]
    v_pk_add_f32 v[14:15], v[14:15], v[6:7]
    v_pk_add_f32 v[240:241], v[240:241], v[248:249]
    v_pk_add_f32 v[242:243], v[242:243], v[250:251]
    v_pk_fma_f32 v[252:253], v[248:249], v[232:233], v[252:253]
    v_pk_fma_f32 v[252:253], v[250:251], v[234:235], v[252:253]
    v_cvt_pk_bf16_f32 v244, v248, v249
    v_cvt_pk_bf16_f32 v245, v250, v251
    v_cvt_pk_bf16_f32 v246, -v252, -v253
    v_mov_b32 v247, 0
    s_waitcnt lgkmcnt(0)
    v_readfirstlane_b32 s52, v3
    s_cmp_lg_u32 s57, 0
    s_cbranch_scc1 L_early51
    s_cmp_gt_u32 s52, s51
    s_cbranch_scc0 L_early51
    s_mov_b32 s57, 1
    ds_read_b128 v[124:127], v8
    ds_read_b128 v[128:131], v9
    ds_read_b128 v[132:135], v8 offset:128
    ds_read_b128 v[136:139], v9 offset:128
    ds_read_b128 v[140:143], v8 offset:256
    ds_read_b128 v[144:147], v9 offset:256
L_early51:
    v_mfma_f32_16x16x32_bf16 v[52:55], v[148:151], v[244:247], v[52:55]
    v_mfma_f32_16x16x32_bf16 v[56:59], v[154:157], v[244:247], v[56:59]
    v_mfma_f32_16x16x32_bf16 v[60:63], v[160:163], v[244:247], v[60:63]
    v_mfma_f32_16x16x32_bf16 v[64:67], v[166:169], v[244:247], v[64:67]
    v_mfma_f32_16x16x32_bf16 v[68:71], v[172:175], v[244:247], v[68:71]
    v_mfma_f32_16x16x32_bf16 v[72:75], v[178:181], v[244:247], v[72:75]
    v_mfma_f32_16x16x32_bf16 v[76:79], v[184:187], v[244:247], v[76:79]
    v_mfma_f32_16x16x32_bf16 v[80:83], v[190:193], v[244:247], v[80:83]
    v_mfma_f32_16x16x32_bf16 v[84:87], v[196:199], v[244:247], v[84:87]
    v_mfma_f32_16x16x32_bf16 v[88:91], v[202:205], v[244:247], v[88:91]
    v_mfma_f32_16x16x32_bf16 v[92:95], v[208:211], v[244:247], v[92:95]
    v_mfma_f32_16x16x32_bf16 v[96:99], v[214:217], v[244:247], v[96:99]
    s_cmp_eq_u32 s41, 3
    s_cbranch_scc1 L_last
    s_add_u32 s51, s51, 1
    s_cmp_lg_u32 s57, 0
    s_cbranch_scc1 L_begun52
    s_nop 2
L_spin53:
    ds_read_b32 v3, v1 offset:6912
    s_waitcnt lgkmcnt(0)
    v_readfirstlane_b32 s52, v3
    s_nop 0
    s_cmp_ge_u32 s52, s51
    s_cbranch_scc1 L_spun54
    s_sleep 1
    s_branch L_spin53
L_spun54:
    ds_read_b128 v[124:127], v8
    ds_read_b128 v[128:131], v9
    ds_read_b128 v[132:135], v8 offset:128
    ds_read_b128 v[136:139], v9 offset:128
    ds_read_b128 v[140:143], v8 offset:256
    ds_read_b128 v[144:147], v9 offset:256
L_begun52:
    s_waitcnt lgkmcnt(5)
    v_mfma_f32_16x16x32_bf16 v[232:235], v[124:127], v[24:27], v[224:227]
    ds_read_b64_tr_b16 v[150:151], v10
    s_add_u32 s54, s54, 1
    s_cmp_eq_u32 s54, 6
    s_cselect_b32 s55, 0xffff8800, s56
    s_cselect_b32 s54, 0, s54
    v_mfma_f32_16x16x32_bf16 v[228:231], v[124:127], v[28:31], v[220:223]
    ds_read_b64_tr_b16 v[156:157], v11
    v_add_u32 v8, s55, v8
    s_waitcnt lgkmcnt(6)
    v_mfma_f32_16x16x32_bf16 v[232:235], v[128:131], v[24:27], v[232:235]
    ds_read_b64_tr_b16 v[162:163], v12
    ds_read_b64_tr_b16 v[168:169], v13
    v_mfma_f32_16x16x32_bf16 v[228:231], v[128:131], v[32:35], v[228:231]
    ds_read_b64_tr_b16 v[174:175], v10 offset:128
    v_add_u32 v9, s55, v9
    s_waitcnt lgkmcnt(8)
    v_mfma_f32_16x16x32_bf16 v[232:235], v[132:135], v[24:27], v[232:235]
    ds_read_b64_tr_b16 v[180:181], v11 offset:128
    ds_read_b64_tr_b16 v[186:187], v12 offset:128
    v_mfma_f32_16x16x32_bf16 v[228:231], v[132:135], v[36:39], v[228:231]
    ds_read_b64_tr_b16 v[192:193], v13 offset:128
    v_mov_b32 v2, s51
    s_waitcnt lgkmcnt(10)
    v_mfma_f32_16x16x32_bf16 v[232:235], v[136:139], v[24:27], v[232:235]
    ds_read_b64_tr_b16 v[198:199], v10 offset:256
    v_mfma_f32_16x16x32_bf16 v[228:231], v[136:139], v[40:43], v[228:231]
    ds_read_b64_tr_b16 v[204:205], v11 offset:256
    s_waitcnt lgkmcnt(11)
    v_mfma_f32_16x16x32_bf16 v[232:235], v[140:143], v[24:27], v[232:235]
    ds_read_b64_tr_b16 v[210:211], v12 offset:256
    v_mfma_f32_16x16x32_bf16 v[228:231], v[140:143], v[44:47], v[228:231]
    ds_read_b64_tr_b16 v[216:217], v13 offset:256
    ds_read_b32 v3, v1 offset:6912
    s_waitcnt lgkmcnt(13)
    v_mfma_f32_16x16x32_bf16 v[232:235], v[144:147], v[24:27], v[232:235]
    v_add_u32 v10, s55, v10
    v_add_u32 v11, s55, v11
    v_mfma_f32_16x16x32_bf16 v[228:231], v[144:147], v[48:51], v[228:231]
    v_add_u32 v12, s55, v12
    v_add_u32 v13, s55, v13
    s_waitcnt lgkmcnt(0)
    ds_write_b32 v1, v2 offset:6928
    v_dot2_f32_bf16 v22, v124, v124, v255
    v_dot2_f32_bf16 v23, v124, v100, 0
    v_dot2_f32_bf16 v22, v125, v125, v22
    v_dot2_f32_bf16 v23, v125, v101, v23
    v_dot2_f32_bf16 v22, v126, v126, v22
    v_dot2_f32_bf16 v23, v126, v102, v23
    v_dot2_f32_bf16 v22, v127, v127, v22
    v_dot2_f32_bf16 v23, v127, v103, v23
    v_dot2_f32_bf16 v22, v128, v128, v22
    v_dot2_f32_bf16 v23, v128, v104, v23
    v_dot2_f32_bf16 v22, v129, v129, v22
    v_dot2_f32_bf16 v23, v129, v105, v23
    v_dot2_f32_bf16 v22, v130, v130, v22
    v_dot2_f32_bf16 v23, v130, v106, v23
    v_dot2_f32_bf16 v22, v131, v131, v22
    v_dot2_f32_bf16 v23, v131, v107, v23
    v_dot2_f32_bf16 v22, v132, v132, v22
    v_dot2_f32_bf16 v23, v132, v108, v23
    v_dot2_f32_bf16 v22, v133, v133, v22
    v_dot2_f32_bf16 v23, v133, v109, v23
    v_dot2_f32_bf16 v22, v134, v134, v22
    v_dot2_f32_bf16 v23, v134, v110, v23
    v_dot2_f32_bf16 v22, v135, v135, v22
    v_dot2_f32_bf16 v23, v135, v111, v23
    v_dot2_f32_bf16 v22, v136, v136, v22
    v_dot2_f32_bf16 v23, v136, v112, v23
    v_dot2_f32_bf16 v22, v137, v137, v22
    v_dot2_f32_bf16 v23, v137, v113, v23
    v_dot2_f32_bf16 v22, v138, v138, v22
    v_dot2_f32_bf16 v23, v138, v114, v23
    v_dot2_f32_bf16 v22, v139, v139, v22
    v_dot2_f32_bf16 v23, v139, v115, v23
    v_dot2_f32_bf16 v22, v140, v140, v22
    v_dot2_f32_bf16 v23, v140, v116, v23
    v_dot2_f32_bf16 v22, v141, v141, v22
    v_dot2_f32_bf16 v23, v141, v117, v23
    v_dot2_f32_bf16 v22, v142, v142, v22
    v_dot2_f32_bf16 v23, v142, v118, v23
    v_dot2_f32_bf16 v22, v143, v143, v22
    v_dot2_f32_bf16 v23, v143, v119, v23
    v_dot2_f32_bf16 v22, v144, v144, v22
    v_dot2_f32_bf16 v23, v144, v120, v23
    v_dot2_f32_bf16 v22, v145, v145, v22
    v_dot2_f32_bf16 v23, v145, v121, v23
    v_dot2_f32_bf16 v22, v146, v146, v22
    v_dot2_f32_bf16 v23, v146, v122, v23
    v_dot2_f32_bf16 v22, v147, v147, v22
    v_dot2_f32_bf16 v23, v147, v123, v23
    s_nop 2
    v_fma_f32 v22, v23, 2.0, v22
    s_nop 1
    v_mfma_f32_16x16x4_f32 v[236:239], v22, v20, 0
    v_readfirstlane_b32 s52, v3
    s_mov_b32 s57, 0
    s_nop 0
    s_cmp_gt_u32 s52, s51
    s_cbranch_scc0 L_early55
    s_mov_b32 s57, 1
    ds_read_b128 v[100:103], v8
    ds_read_b128 v[104:107], v9
    ds_read_b128 v[108:111], v8 offset:128
    ds_read_b128 v[112:115], v9 offset:128
    ds_read_b128 v[116:119], v8 offset:256
    ds_read_b128 v[120:123], v9 offset:256
L_early55:
    v_pk_mul_f32 v[232:233], v[232:233], s[44:45]
    v_pk_mul_f32 v[234:235], v[234:235], s[44:45]
    v_pk_fma_f32 v[4:5], v[232:233], v[232:233], s[46:47] neg_lo:[1,0,0] neg_hi:[1,0,0]
    v_pk_fma_f32 v[6:7], v[234:235], v[234:235], s[46:47] neg_lo:[1,0,0] neg_hi:[1,0,0]
    s_nop 0
    v_pk_fma_f32 v[236:237], v[236:237], s[44:45], v[4:5]
    v_pk_fma_f32 v[238:239], v[238:239], s[44:45], v[6:7]
    v_max_f32 v236, s46, v236
    v_max_f32 v237, s46, v237
    v_max_f32 v238, s46, v238
    v_max_f32 v239, s46, v239
    v_rsq_f32 v236, v236
    v_rsq_f32 v237, v237
    v_rsq_f32 v238, v238
    v_rsq_f32 v239, v239
    v_pk_fma_f32 v[228:229], v[232:233], v[16:17], v[228:229] neg_lo:[1,0,0] neg_hi:[1,0,0]
    v_pk_fma_f32 v[230:231], v[234:235], v[16:17], v[230:231] neg_lo:[1,0,0] neg_hi:[1,0,0]
    v_pk_fma_f32 v[4:5], v[228:229], v[236:237], v[18:19]
    v_pk_fma_f32 v[6:7], v[230:231], v[238:239], v[18:19]
    v_max3_f32 v21, v4, v5, v6
    v_max_f32 v21, v21, v7
    v_cmp_lt_f32 vcc, s50, v21
    v_exp_f32 v4, v4
    v_exp_f32 v5, v5
    v_exp_f32 v6, v6
    v_exp_f32 v7, v7
    s_cbranch_vccz L_sm56
    s_call_b64 s[48:49], L_rescale
L_sm56:
    v_pk_mul_f32 v[228:229], v[4:5], v[236:237]
    v_pk_add_f32 v[14:15], v[14:15], v[4:5]
    v_pk_mul_f32 v[230:231], v[6:7], v[238:239]
    v_pk_add_f32 v[14:15], v[14:15], v[6:7]
    v_pk_add_f32 v[240:241], v[240:241], v[228:229]
    v_pk_add_f32 v[242:243], v[242:243], v[230:231]
    v_pk_mul_f32 v[252:253], v[228:229], v[232:233]
    v_pk_fma_f32 v[252:253], v[230:231], v[234:235], v[252:253]
    v_cvt_pk_bf16_f32 v244, v228, v229
    v_cvt_pk_bf16_f32 v245, v230, v231
    v_cvt_pk_bf16_f32 v246, v240, v241
    v_cvt_pk_bf16_f32 v247, v242, v243
    s_add_u32 s41, s41, 1
    s_nop 0
    s_branch L_loop
L_last:
    s_setprio 2
    v_and_b32 v22, 15, v0
    v_lshrrev_b32 v23, 4, v0
    v_lshlrev_b32 v148, 4, v0
    v_lshlrev_b32 v23, 2, v23
    v_add_u32 v148, s36, v148
    v_lshl_add_u32 v149, v22, 4, v23
    v_add_u32 v149, s36, v149
    s_add_u32 s51, s51, 1
    s_cmp_lg_u32 s57, 0
    s_cbranch_scc1 L_begun57
L_spin58:
    ds_read_b32 v3, v1 offset:6912
    s_waitcnt lgkmcnt(0)
    v_readfirstlane_b32 s52, v3
    s_nop 0
    s_cmp_ge_u32 s52, s51
    s_cbranch_scc0 L_spin58
    ds_read_b128 v[124:127], v8
    ds_read_b128 v[128:131], v9
    ds_read_b128 v[132:135], v8 offset:128
    ds_read_b128 v[136:139], v9 offset:128
    ds_read_b128 v[140:143], v8 offset:256
    ds_read_b128 v[144:147], v9 offset:256
L_begun57:
    s_waitcnt lgkmcnt(5)
    v_mfma_f32_16x16x32_bf16 v[236:239], v[124:127], v[124:127], 0
    v_mfma_f32_16x16x32_bf16 v[4:7], v[124:127], v[100:103], 0
    ds_read_b64_tr_b16 v[150:151], v10
    s_waitcnt lgkmcnt(5)
    v_mfma_f32_16x16x32_bf16 v[236:239], v[128:131], v[128:131], v[236:239]
    v_mfma_f32_16x16x32_bf16 v[4:7], v[128:131], v[104:107], v[4:7]
    ds_read_b64_tr_b16 v[156:157], v11
    s_waitcnt lgkmcnt(5)
    v_mfma_f32_16x16x32_bf16 v[236:239], v[132:135], v[132:135], v[236:239]
    ds_read_b64_tr_b16 v[162:163], v12
    v_mfma_f32_16x16x32_bf16 v[4:7], v[132:135], v[108:111], v[4:7]
    ds_read_b64_tr_b16 v[168:169], v13
    s_waitcnt lgkmcnt(6)
    v_mfma_f32_16x16x32_bf16 v[236:239], v[136:139], v[136:139], v[236:239]
    ds_read_b64_tr_b16 v[174:175], v10 offset:128
    v_mfma_f32_16x16x32_bf16 v[4:7], v[136:139], v[112:115], v[4:7]
    ds_read_b64_tr_b16 v[180:181], v11 offset:128
    s_waitcnt lgkmcnt(7)
    v_mfma_f32_16x16x32_bf16 v[236:239], v[140:143], v[140:143], v[236:239]
    ds_read_b64_tr_b16 v[186:187], v12 offset:128
    v_mfma_f32_16x16x32_bf16 v[4:7], v[140:143], v[116:119], v[4:7]
    ds_read_b64_tr_b16 v[192:193], v13 offset:128
    s_waitcnt lgkmcnt(8)
    v_mfma_f32_16x16x32_bf16 v[236:239], v[144:147], v[144:147], v[236:239]
    ds_read_b64_tr_b16 v[198:199], v10 offset:256
    v_mfma_f32_16x16x32_bf16 v[4:7], v[144:147], v[120:123], v[4:7]
    ds_read_b64_tr_b16 v[204:205], v11 offset:256
    v_mfma_f32_16x16x32_bf16 v[232:235], v[124:127], v[24:27], v[224:227]
    ds_read_b64_tr_b16 v[210:211], v12 offset:256
    v_mfma_f32_16x16x32_bf16 v[232:235], v[128:131], v[24:27], v[232:235]
    ds_read_b64_tr_b16 v[216:217], v13 offset:256
    s_nop 2
    v_mfma_f32_16x16x32_bf16 v[232:235], v[132:135], v[24:27], v[232:235]
    v_cndmask_b32 v22, v236, v237, s[58:59]
    v_cndmask_b32 v23, v238, v239, s[58:59]
    v_mfma_f32_16x16x32_bf16 v[232:235], v[136:139], v[24:27], v[232:235]
    v_cndmask_b32 v4, v4, v5, s[58:59]
    v_cndmask_b32 v6, v6, v7, s[58:59]
    v_mfma_f32_16x16x32_bf16 v[232:235], v[140:143], v[24:27], v[232:235]
    v_cndmask_b32 v22, v22, v23, s[60:61]
    v_cndmask_b32 v4, v4, v6, s[60:61]
    v_mfma_f32_16x16x32_bf16 v[232:235], v[144:147], v[24:27], v[232:235]
    v_fma_f32 v22, v4, 2.0, v22
    v_cndmask_b32 v22, 0, v22, s[38:39]
    v_add_f32 v22, v22, v255
    v_mfma_f32_16x16x32_bf16 v[228:231], v[124:127], v[28:31], v[220:223]
    s_nop 0
    v_mfma_f32_16x16x4_f32 v[236:239], v22, v20, 0
    v_mfma_f32_16x16x32_bf16 v[228:231], v[128:131], v[32:35], v[228:231]
    v_mfma_f32_16x16x32_bf16 v[228:231], v[132:135], v[36:39], v[228:231]
    v_mul_f32 v232, s44, v232
    v_mul_f32 v233, s44, v233
    v_mfma_f32_16x16x32_bf16 v[228:231], v[136:139], v[40:43], v[228:231]
    v_mul_f32 v234, s44, v234
    v_mul_f32 v235, s44, v235
    v_mfma_f32_16x16x32_bf16 v[228:231], v[140:143], v[44:47], v[228:231]
    v_fma_f32 v4, -v232, v232, s46
    v_fma_f32 v5, -v233, v233, s46
    v_mfma_f32_16x16x32_bf16 v[228:231], v[144:147], v[48:51], v[228:231]
    v_fma_f32 v6, -v234, v234, s46
    v_fma_f32 v7, -v235, v235, s46
    s_waitcnt lgkmcnt(0)
    v_pk_fma_f32 v[236:237], v[236:237], s[44:45], v[4:5]
    v_pk_fma_f32 v[238:239], v[238:239], s[44:45], v[6:7]
    v_max_f32 v236, s46, v236
    v_max_f32 v237, s46, v237
    v_max_f32 v238, s46, v238
    v_max_f32 v239, s46, v239
    v_rsq_f32 v236, v236
    v_rsq_f32 v237, v237
    v_rsq_f32 v238, v238
    v_rsq_f32 v239, v239
    v_pk_fma_f32 v[228:229], v[232:233], v[16:17], v[228:229] neg_lo:[1,0,0] neg_hi:[1,0,0]
    v_pk_fma_f32 v[230:231], v[234:235], v[16:17], v[230:231] neg_lo:[1,0,0] neg_hi:[1,0,0]
    v_pk_fma_f32 v[4:5], v[228:229], v[236:237], v[18:19]
    v_pk_fma_f32 v[6:7], v[230:231], v[238:239], v[18:19]
    v_max3_f32 v21, v4, v5, v6
    v_max_f32 v21, v21, v7
    v_cmp_lt_f32 vcc, s50, v21
    v_exp_f32 v4, v4
    v_exp_f32 v5, v5
    v_exp_f32 v6, v6
    v_exp_f32 v7, v7
    s_cbranch_vccz L_sm60
    s_call_b64 s[48:49], L_rescale
L_sm60:
    v_pk_mul_f32 v[228:229], v[4:5], v[236:237]
    v_pk_mul_f32 v[230:231], v[6:7], v[238:239]
    v_pk_add_f32 v[240:241], v[240:241], v[228:229]
    v_pk_add_f32 v[242:243], v[242:243], v[230:231]
    v_cvt_pk_bf16_f32 v244, v228, v229
    v_cvt_pk_bf16_f32 v245, v230, v231
    v_cvt_pk_bf16_f32 v246, v240, v241
    v_cvt_pk_bf16_f32 v247, v242, v243
    s_nop 1
    v_mfma_f32_16x16x32_bf16 v[52:55], v[150:153], v[244:247], v[52:55]
    v_cmp_neq_f32 vcc, 0, v254
    v_add_f32 v4, v4, v5
    v_add_f32 v6, v6, v7
    v_mfma_f32_16x16x32_bf16 v[56:59], v[156:159], v[244:247], v[56:59]
    v_add_f32 v14, v14, v15
    v_add_f32 v4, v4, v6
    ds_write_b32 v149, v254 offset:12800
    v_mfma_f32_16x16x32_bf16 v[60:63], v[162:165], v[244:247], v[60:63]
    v_add_f32 v14, v14, v4
    s_cmp_eq_u64 vcc, 0
    s_cselect_b32 s40, 1, 2
    v_mov_b32 v154, s40
    ds_write_b32 v149, v14 offset:12288
    v_mfma_f32_16x16x32_bf16 v[64:67], v[168:171], v[244:247], v[64:67]
    v_cvt_pk_bf16_f32 v100, v52, v53
    v_cvt_pk_bf16_f32 v101, v54, v55
    v_mfma_f32_16x16x32_bf16 v[68:71], v[174:177], v[244:247], v[68:71]
    v_cvt_pk_bf16_f32 v102, v56, v57
    v_cvt_pk_bf16_f32 v103, v58, v59
    ds_write_b128 v148, v[100:103]
    v_mfma_f32_16x16x32_bf16 v[72:75], v[180:183], v[244:247], v[72:75]
    v_cvt_pk_bf16_f32 v104, v60, v61
    v_cvt_pk_bf16_f32 v105, v62, v63
    v_mfma_f32_16x16x32_bf16 v[76:79], v[186:189], v[244:247], v[76:79]
    v_cvt_pk_bf16_f32 v106, v64, v65
    v_cvt_pk_bf16_f32 v107, v66, v67
    ds_write_b128 v148, v[104:107] offset:1024
    v_mfma_f32_16x16x32_bf16 v[80:83], v[192:195], v[244:247], v[80:83]
    v_cvt_pk_bf16_f32 v108, v68, v69
    v_cvt_pk_bf16_f32 v109, v70, v71
    v_mfma_f32_16x16x32_bf16 v[84:87], v[198:201], v[244:247], v[84:87]
    v_cvt_pk_bf16_f32 v110, v72, v73
    v_cvt_pk_bf16_f32 v111, v74, v75
    ds_write_b128 v148, v[108:111] offset:2048
    v_mfma_f32_16x16x32_bf16 v[88:91], v[204:207], v[244:247], v[88:91]
    v_cvt_pk_bf16_f32 v112, v76, v77
    v_cvt_pk_bf16_f32 v113, v78, v79
    v_mfma_f32_16x16x32_bf16 v[92:95], v[210:213], v[244:247], v[92:95]
    v_cvt_pk_bf16_f32 v114, v80, v81
    v_cvt_pk_bf16_f32 v115, v82, v83
    ds_write_b128 v148, v[112:115] offset:3072
    v_mfma_f32_16x16x32_bf16 v[96:99], v[216:219], v[244:247], v[96:99]
    v_cvt_pk_bf16_f32 v116, v84, v85
    v_cvt_pk_bf16_f32 v117, v86, v87
    v_cvt_pk_bf16_f32 v118, v88, v89
    v_cvt_pk_bf16_f32 v119, v90, v91
    ds_write_b128 v148, v[116:119] offset:4096
    v_cvt_pk_bf16_f32 v120, v92, v93
    v_cvt_pk_bf16_f32 v121, v94, v95
    s_nop 0
    v_cvt_pk_bf16_f32 v122, v96, v97
    v_cvt_pk_bf16_f32 v123, v98, v99
    ds_write_b128 v148, v[120:123] offset:5120
    ds_write_b32 v1, v154 offset:6992
    s_setprio 0
    s_cmp_lt_u32 s2, 0x80
    s_cbranch_scc1 L_r_end
    s_sub_u32 s53, s2, 0x80
    s_and_b32 s40, s53, 7
    s_lshr_b32 s42, s53, 4
    s_lshl_b32 s42, s42, 3
    s_or_b32 s40, s40, s42
    s_lshl_b32 s40, s40, 1
    s_bfe_u32 s42, s53, 0x10003
    s_or_b32 s53, s40, s42
    s_mov_b32 s24, s4
    s_mov_b32 s25, s5
    s_mov_b32 s26, 0x1800
    s_mov_b32 s27, 0x20000
    s_mov_b32 s28, s18
    s_mov_b32 s29, s19
    s_mov_b32 s30, 0x1800
    s_mov_b32 s31, 0x20000
    v_and_b32 v28, 3, v0
    v_lshrrev_b32 v29, 2, v0
    v_lshlrev_b32 v30, 15, v29
    v_lshl_add_u32 v30, v28, 4, v30
    v_lshlrev_b32 v32, 2, v28
    ds_read_b32 v38, v32 offset:7040
    s_lshl_b32 s40, s3, 19
    s_lshl_b32 s42, s53, 6
    s_add_u32 s40, s40, s42
    s_and_b32 s42, s53, 3
    s_mul_i32 s42, s42, 0x600
    v_mul_u32_u24 v31, 0x180, v28
    v_add_u32 v31, s42, v31
    s_lshr_b32 s42, s53, 5
    s_mul_i32 s6, s42, 0x60
    s_bfe_u32 s42, s53, 0x20002
    s_lshl_b32 s42, s42, 3
    s_add_u32 s6, s6, s42
    s_bitcmp1_b32 s53, 4
    s_cselect_b32 s4, 36, 0
    s_cselect_b32 s5, 64, 4
    s_cselect_b32 s42, 0x44, 32
    s_add_u32 s4, s4, s6
    s_add_u32 s5, s5, s6
    s_add_u32 s6, s6, s42
    buffer_load_dword v56, v31, s[24:27], s4 offen
    buffer_load_dword v57, v31, s[24:27], s5 offen
    buffer_load_dword v58, v31, s[24:27], s6 offen
    v_lshrrev_b32 v32, 4, v0
    v_lshlrev_b32 v34, 7, v32
    v_lshl_add_u32 v34, v28, 5, v34
    s_lshl_b32 s42, s3, 9
    s_add_u32 s42, s42, 0x9400
    v_add_u32 v34, s42, v34
    v_and_b32 v35, 15, v0
    v_lshlrev_b32 v35, 5, v35
    v_mov_b32 v32, 0
    v_mov_b32 v60, 0
    v_mov_b32 v61, 0
    v_mov_b32 v62, 0
    v_mov_b32 v63, 0
    v_mov_b32 v64, 0
    v_mov_b32 v65, 0
    v_mov_b32 v66, 0
    v_mov_b32 v67, 0
    v_mov_b32 v37, 0
    s_mov_b64 s[44:45], -1
    s_mov_b64 s[46:47], -1
    s_mov_b64 s[58:59], -1
    s_mov_b64 s[60:61], -1
    s_mov_b32 s38, 0x3f80
    s_mov_b32 s39, 0x3f800000
    s_waitcnt vmcnt(0) lgkmcnt(0)
    v_lshlrev_b32 v120, 16, v56
    v_and_b32 v121, 0xffff0000, v56
    v_lshlrev_b32 v122, 16, v57
    v_and_b32 v123, 0xffff0000, v57
    v_lshlrev_b32 v124, 16, v58
    v_and_b32 v125, 0xffff0000, v58
    s_nop 1
L_spin61:
    ds_read_b32 v33, v32 offset:6964
    s_waitcnt lgkmcnt(0)
    v_readfirstlane_b32 s42, v33
    s_nop 0
    s_cmp_ge_u32 s42, 4
    s_cbranch_scc1 L_spun62
    s_sleep 1
    s_branch L_spin61
L_spun62:
    s_mov_b64 exec, 0x1111
L_tpre:
    buffer_load_dword v32, v30, s[32:35], s40 offen offset:12 sc1
    s_waitcnt vmcnt(0)
    v_xor_b32 v32, v32, v38
    v_and_b32 v32, 0xfffe, v32
    v_cmp_ne_u32 vcc, 0, v32
    s_cbranch_vccnz L_tpre
    s_mov_b64 exec, -1
    s_nop 2
L_tpoll:
    s_add_u32 s42, s40, 0
    s_cmp_eq_u64 s[44:45], 0
    s_cbranch_scc1 L_tskip63
    s_mov_b64 exec, s[44:45]
    buffer_load_dwordx4 v[40:43], v30, s[32:35], s42 offen sc1
L_tskip63:
    s_add_u32 s42, s40, 0x2000
    s_cmp_eq_u64 s[46:47], 0
    s_cbranch_scc1 L_tskip64
    s_mov_b64 exec, s[46:47]
    buffer_load_dwordx4 v[44:47], v30, s[32:35], s42 offen sc1
L_tskip64:
    s_add_u32 s42, s40, 0x4000
    s_cmp_eq_u64 s[58:59], 0
    s_cbranch_scc1 L_tskip65
    s_mov_b64 exec, s[58:59]
    buffer_load_dwordx4 v[48:51], v30, s[32:35], s42 offen sc1
L_tskip65:
    s_add_u32 s42, s40, 0x6000
    s_cmp_eq_u64 s[60:61], 0
    s_cbranch_scc1 L_tskip66
    s_mov_b64 exec, s[60:61]
    buffer_load_dwordx4 v[52:55], v30, s[32:35], s42 offen sc1
L_tskip66:
    s_waitcnt vmcnt(0)
    s_cmp_eq_u64 s[44:45], 0
    s_cbranch_scc1 L_tchk67
    s_mov_b64 exec, s[44:45]
    v_xor_b32 v36, v43, v38
    v_and_b32 v32, 0xfffe, v36
    v_and_b32 v33, 0xffff0000, v43
    s_nop 2
    v_or_b32_dpp v32, v32, v32 quad_perm:[1,0,3,2] row_mask:0xf bank_mask:0xf
    s_nop 2
    v_or_b32_dpp v32, v32, v32 quad_perm:[2,3,0,1] row_mask:0xf bank_mask:0xf
    v_cmp_eq_u32 vcc, 0, v32
    s_nop 0
    s_andn2_b64 s[44:45], s[44:45], vcc
    s_and_b64 exec, vcc, vcc
    s_cbranch_scc0 L_tchk67
    v_dot2_f32_bf16 v60, v40, s38, v60
    v_dot2_f32_bf16 v61, v40, s39, v61
    v_dot2_f32_bf16 v62, v41, s38, v62
    v_dot2_f32_bf16 v63, v41, s39, v63
    v_dot2_f32_bf16 v64, v42, s38, v64
    v_dot2_f32_bf16 v65, v42, s39, v65
    v_add_f32 v66, v66, v33
    v_or_b32 v37, v37, v36
L_tchk67:
    s_cmp_eq_u64 s[46:47], 0
    s_cbranch_scc1 L_tchk68
    s_mov_b64 exec, s[46:47]
    v_xor_b32 v36, v47, v38
    v_and_b32 v32, 0xfffe, v36
    v_and_b32 v33, 0xffff0000, v47
    s_nop 2
    v_or_b32_dpp v32, v32, v32 quad_perm:[1,0,3,2] row_mask:0xf bank_mask:0xf
    s_nop 2
    v_or_b32_dpp v32, v32, v32 quad_perm:[2,3,0,1] row_mask:0xf bank_mask:0xf
    v_cmp_eq_u32 vcc, 0, v32
    s_nop 0
    s_andn2_b64 s[46:47], s[46:47], vcc
    s_and_b64 exec, vcc, vcc
    s_cbranch_scc0 L_tchk68
    v_dot2_f32_bf16 v60, v44, s38, v60
    v_dot2_f32_bf16 v61, v44, s39, v61
    v_dot2_f32_bf16 v62, v45, s38, v62
    v_dot2_f32_bf16 v63, v45, s39, v63
    v_dot2_f32_bf16 v64, v46, s38, v64
    v_dot2_f32_bf16 v65, v46, s39, v65
    v_add_f32 v66, v66, v33
    v_or_b32 v37, v37, v36
L_tchk68:
    s_cmp_eq_u64 s[58:59], 0
    s_cbranch_scc1 L_tchk69
    s_mov_b64 exec, s[58:59]
    v_xor_b32 v36, v51, v38
    v_and_b32 v32, 0xfffe, v36
    v_and_b32 v33, 0xffff0000, v51
    s_nop 2
    v_or_b32_dpp v32, v32, v32 quad_perm:[1,0,3,2] row_mask:0xf bank_mask:0xf
    s_nop 2
    v_or_b32_dpp v32, v32, v32 quad_perm:[2,3,0,1] row_mask:0xf bank_mask:0xf
    v_cmp_eq_u32 vcc, 0, v32
    s_nop 0
    s_andn2_b64 s[58:59], s[58:59], vcc
    s_and_b64 exec, vcc, vcc
    s_cbranch_scc0 L_tchk69
    v_dot2_f32_bf16 v60, v48, s38, v60
    v_dot2_f32_bf16 v61, v48, s39, v61
    v_dot2_f32_bf16 v62, v49, s38, v62
    v_dot2_f32_bf16 v63, v49, s39, v63
    v_dot2_f32_bf16 v64, v50, s38, v64
    v_dot2_f32_bf16 v65, v50, s39, v65
    v_add_f32 v66, v66, v33
    v_or_b32 v37, v37, v36
L_tchk69:
    s_cmp_eq_u64 s[60:61], 0
    s_cbranch_scc1 L_tchk70
    s_mov_b64 exec, s[60:61]
    v_xor_b32 v36, v55, v38
    v_and_b32 v32, 0xfffe, v36
    v_and_b32 v33, 0xffff0000, v55
    s_nop 2
    v_or_b32_dpp v32, v32, v32 quad_perm:[1,0,3,2] row_mask:0xf bank_mask:0xf
    s_nop 2
    v_or_b32_dpp v32, v32, v32 quad_perm:[2,3,0,1] row_mask:0xf bank_mask:0xf
    v_cmp_eq_u32 vcc, 0, v32
    s_nop 0
    s_andn2_b64 s[60:61], s[60:61], vcc
    s_and_b64 exec, vcc, vcc
    s_cbranch_scc0 L_tchk70
    v_dot2_f32_bf16 v60, v52, s38, v60
    v_dot2_f32_bf16 v61, v52, s39, v61
    v_dot2_f32_bf16 v62, v53, s38, v62
    v_dot2_f32_bf16 v63, v53, s39, v63
    v_dot2_f32_bf16 v64, v54, s38, v64
    v_dot2_f32_bf16 v65, v54, s39, v65
    v_add_f32 v66, v66, v33
    v_or_b32 v37, v37, v36
L_tchk70:
    s_mov_b64 exec, -1
    s_or_b64 s[56:57], s[44:45], s[46:47]
    s_or_b64 vcc, s[58:59], s[60:61]
    s_or_b64 s[56:57], s[56:57], vcc
    s_cbranch_scc0 L_tfull
    s_mov_b32 s54, 0
    s_bcnt1_i32_b64 s42, s[60:61]
    s_cselect_b32 s55, 0x6000, s55
    s_cselect_b64 s[56:57], s[60:61], s[56:57]
    s_add_u32 s54, s54, s42
    s_bcnt1_i32_b64 s42, s[58:59]
    s_cselect_b32 s55, 0x4000, s55
    s_cselect_b64 s[56:57], s[58:59], s[56:57]
    s_add_u32 s54, s54, s42
    s_bcnt1_i32_b64 s42, s[46:47]
    s_cselect_b32 s55, 0x2000, s55
    s_cselect_b64 s[56:57], s[46:47], s[56:57]
    s_add_u32 s54, s54, s42
    s_bcnt1_i32_b64 s42, s[44:45]
    s_cselect_b32 s55, 0, s55
    s_cselect_b64 s[56:57], s[44:45], s[56:57]
    s_add_u32 s54, s54, s42
    s_cmp_le_u32 s54, 32
    s_cbranch_scc1 L_tpoll
    s_ff1_i32_b64 s42, s[56:57]
    s_lshl_b64 exec, 1, s42
    s_add_u32 s55, s55, s40
L_tprobe:
    buffer_load_dword v32, v30, s[32:35], s55 offen offset:12 sc1
    s_waitcnt vmcnt(0)
    v_xor_b32 v32, v32, v38
    v_and_b32 v32, 0xfffe, v32
    v_cmp_ne_u32 vcc, 0, v32
    s_cbranch_vccnz L_tprobe
    s_mov_b64 exec, -1
    s_branch L_tpoll
    s_nop 1
L_tfull:
    v_and_b32 v32, 1, v37
    v_cmp_ne_u32 vcc, 0, v32
    s_cbranch_vccnz L_tgen
    s_nop 3
L_trows:
    v_add_f32_dpp v60, v60, v60 row_ror:4 row_mask:0xf bank_mask:0xf
    v_add_f32_dpp v61, v61, v61 row_ror:4 row_mask:0xf bank_mask:0xf
    v_add_f32_dpp v62, v62, v62 row_ror:4 row_mask:0xf bank_mask:0xf
    v_add_f32_dpp v63, v63, v63 row_ror:4 row_mask:0xf bank_mask:0xf
    v_add_f32_dpp v64, v64, v64 row_ror:4 row_mask:0xf bank_mask:0xf
    v_add_f32_dpp v65, v65, v65 row_ror:4 row_mask:0xf bank_mask:0xf
    v_add_f32_dpp v66, v66, v66 row_ror:4 row_mask:0xf bank_mask:0xf
    v_add_f32_dpp v60, v60, v60 row_ror:8 row_mask:0xf bank_mask:0xf
    v_add_f32_dpp v61, v61, v61 row_ror:8 row_mask:0xf bank_mask:0xf
    v_add_f32_dpp v62, v62, v62 row_ror:8 row_mask:0xf bank_mask:0xf
    v_add_f32_dpp v63, v63, v63 row_ror:8 row_mask:0xf bank_mask:0xf
    v_add_f32_dpp v64, v64, v64 row_ror:8 row_mask:0xf bank_mask:0xf
    v_add_f32_dpp v65, v65, v65 row_ror:8 row_mask:0xf bank_mask:0xf
    v_add_f32_dpp v66, v66, v66 row_ror:8 row_mask:0xf bank_mask:0xf
    s_mov_b32 s46, 0xf000f
    s_mov_b32 s47, 0xf000f
    s_mov_b64 exec, s[46:47]
    ds_write_b128 v34, v[60:63]
    ds_write_b128 v34, v[64:67] offset:16
    s_mov_b64 exec, -1
    s_waitcnt lgkmcnt(0)
    s_barrier
    s_cmp_lg_u32 s3, 0
    s_cbranch_scc1 L_r_end
    ds_read_b128 v[84:87], v35 offset:37904
    ds_read_b128 v[92:95], v35 offset:38416
    ds_read_b128 v[100:103], v35 offset:38928
    ds_read_b128 v[108:111], v35 offset:39440
    ds_read_b128 v[80:83], v35 offset:37888
    ds_read_b128 v[88:91], v35 offset:38400
    ds_read_b128 v[96:99], v35 offset:38912
    ds_read_b128 v[104:107], v35 offset:39424
    s_waitcnt lgkmcnt(4)
    v_or3_b32 v32, v87, v95, v103
    v_or_b32 v32, v32, v111
    v_cmp_ne_u32 vcc, 0, v32
    s_cbranch_vccnz L_fgen
    s_nop 3
L_fsum:
    v_pk_add_f32 v[66:67], v[86:87], v[94:95]
    v_pk_add_f32 v[102:103], v[102:103], v[110:111]
    v_pk_add_f32 v[64:65], v[84:85], v[92:93]
    v_pk_add_f32 v[100:101], v[100:101], v[108:109]
    s_waitcnt lgkmcnt(0)
    v_pk_add_f32 v[60:61], v[80:81], v[88:89]
    v_pk_add_f32 v[96:97], v[96:97], v[104:105]
    v_pk_add_f32 v[62:63], v[82:83], v[90:91]
    v_pk_add_f32 v[98:99], v[98:99], v[106:107]
    v_pk_add_f32 v[66:67], v[66:67], v[102:103]
    v_pk_add_f32 v[64:65], v[64:65], v[100:101]
    v_pk_add_f32 v[60:61], v[60:61], v[96:97]
    v_pk_add_f32 v[62:63], v[62:63], v[98:99]
    v_add_f32_dpp v66, v66, v66 row_ror:4 row_mask:0xf bank_mask:0xf
    v_add_f32_dpp v60, v60, v60 row_ror:4 row_mask:0xf bank_mask:0xf
    v_add_f32_dpp v61, v61, v61 row_ror:4 row_mask:0xf bank_mask:0xf
    v_add_f32_dpp v62, v62, v62 row_ror:4 row_mask:0xf bank_mask:0xf
    v_add_f32_dpp v63, v63, v63 row_ror:4 row_mask:0xf bank_mask:0xf
    v_add_f32_dpp v64, v64, v64 row_ror:4 row_mask:0xf bank_mask:0xf
    v_add_f32_dpp v65, v65, v65 row_ror:4 row_mask:0xf bank_mask:0xf
    v_add_f32_dpp v66, v66, v66 row_ror:8 row_mask:0xf bank_mask:0xf
    v_add_f32_dpp v60, v60, v60 row_ror:8 row_mask:0xf bank_mask:0xf
    v_add_f32_dpp v61, v61, v61 row_ror:8 row_mask:0xf bank_mask:0xf
    v_rcp_f32 v66, v66
    v_add_f32_dpp v62, v62, v62 row_ror:8 row_mask:0xf bank_mask:0xf
    v_add_f32_dpp v63, v63, v63 row_ror:8 row_mask:0xf bank_mask:0xf
    v_add_f32_dpp v64, v64, v64 row_ror:8 row_mask:0xf bank_mask:0xf
    v_add_f32_dpp v65, v65, v65 row_ror:8 row_mask:0xf bank_mask:0xf
    v_pk_mul_f32 v[60:61], v[60:61], v[66:67] op_sel_hi:[1,0]
    v_pk_mul_f32 v[62:63], v[62:63], v[66:67] op_sel_hi:[1,0]
    v_pk_mul_f32 v[64:65], v[64:65], v[66:67] op_sel_hi:[1,0]
    v_cvt_pk_bf16_f32 v56, v60, v61
    v_cvt_pk_bf16_f32 v57, v62, v63
    v_cvt_pk_bf16_f32 v58, v64, v65
    v_lshlrev_b32 v60, 16, v56
    v_and_b32 v61, 0xffff0000, v56
    v_lshlrev_b32 v62, 16, v57
    v_and_b32 v63, 0xffff0000, v57
    v_lshlrev_b32 v64, 16, v58
    v_and_b32 v65, 0xffff0000, v58
    v_pk_add_f32 v[60:61], v[60:61], v[120:121]
    v_pk_add_f32 v[62:63], v[62:63], v[122:123]
    v_pk_add_f32 v[64:65], v[64:65], v[124:125]
    s_mov_b64 exec, 15
    v_cvt_pk_bf16_f32 v56, v60, v61
    buffer_store_dword v56, v31, s[28:31], s4 offen
    v_cvt_pk_bf16_f32 v57, v62, v63
    buffer_store_dword v57, v31, s[28:31], s5 offen
    v_cvt_pk_bf16_f32 v58, v64, v65
    buffer_store_dword v58, v31, s[28:31], s6 offen
    s_mov_b64 exec, -1
L_r_end:
    s_endpgm
L_tgen:
    s_nop 3
    v_mov_b32 v32, 0
    ds_read_b64 v[72:73], v32 offset:7040
    v_lshlrev_b32 v71, 9, v29
    v_lshl_add_u32 v71, v28, 3, v71
    s_and_b32 s42, s53, 3
    s_lshl_b32 s42, s42, 5
    s_lshl_b32 s55, s3, 13
    s_add_u32 s55, s55, s42
    s_add_u32 s55, s55, 0x400000
    s_waitcnt lgkmcnt(0)
    v_lshl_or_b32 v70, v73, 16, v72
    v_mov_b32 v112, 0
    v_and_b32 v32, 1, v43
    v_cmp_ne_u32 vcc, 0, v32
    s_nop 0
    s_and_b64 exec, vcc, vcc
    s_cbranch_scc0 L_tg0e
    s_nop 1
L_tg0:
    buffer_load_dwordx2 v[112:113], v71, s[32:35], s55 offen sc1
    s_waitcnt vmcnt(0)
    v_cmp_ne_u32 vcc, v113, v70
    s_cbranch_vccnz L_tg0
L_tg0e:
    s_mov_b64 exec, -1
    v_mov_b32 v114, 0
    v_and_b32 v32, 1, v47
    v_cmp_ne_u32 vcc, 0, v32
    s_nop 0
    s_and_b64 exec, vcc, vcc
    s_cbranch_scc0 L_tg1e
    s_nop 1
L_tg1:
    buffer_load_dwordx2 v[114:115], v71, s[32:35], s55 offen offset:128 sc1
    s_waitcnt vmcnt(0)
    v_cmp_ne_u32 vcc, v115, v70
    s_cbranch_vccnz L_tg1
L_tg1e:
    s_mov_b64 exec, -1
    v_mov_b32 v116, 0
    v_and_b32 v32, 1, v51
    v_cmp_ne_u32 vcc, 0, v32
    s_nop 0
    s_and_b64 exec, vcc, vcc
    s_cbranch_scc0 L_tg2e
    s_nop 1
L_tg2:
    buffer_load_dwordx2 v[116:117], v71, s[32:35], s55 offen offset:256 sc1
    s_waitcnt vmcnt(0)
    v_cmp_ne_u32 vcc, v117, v70
    s_cbranch_vccnz L_tg2
L_tg2e:
    s_mov_b64 exec, -1
    v_mov_b32 v118, 0
    v_and_b32 v32, 1, v55
    v_cmp_ne_u32 vcc, 0, v32
    s_nop 0
    s_and_b64 exec, vcc, vcc
    s_cbranch_scc0 L_tg3e
    s_nop 1
L_tg3:
    buffer_load_dwordx2 v[118:119], v71, s[32:35], s55 offen offset:384 sc1
    s_waitcnt vmcnt(0)
    v_cmp_ne_u32 vcc, v119, v70
    s_cbranch_vccnz L_tg3
L_tg3e:
    s_mov_b64 exec, -1
    v_max3_f32 v67, v112, v114, v116
    v_max_f32 v67, v67, v118
    s_nop 1
    v_max_f32_dpp v67, v67, v67 row_ror:4 row_mask:0xf bank_mask:0xf
    s_nop 1
    v_max_f32_dpp v67, v67, v67 row_ror:8 row_mask:0xf bank_mask:0xf
    v_mov_b32 v32, v67
    v_mov_b32 v33, v67
    s_nop 1
    v_permlane32_swap_b32 v32, v33
    v_max_f32 v67, v32, v33
    v_mov_b32 v32, v67
    v_mov_b32 v33, v67
    s_nop 1
    v_permlane16_swap_b32 v32, v33
    v_max_f32 v67, v32, v33
    v_mov_b32 v60, 0
    v_mov_b32 v61, 0
    v_mov_b32 v62, 0
    v_mov_b32 v63, 0
    v_mov_b32 v64, 0
    v_mov_b32 v65, 0
    v_mov_b32 v66, 0
    v_sub_f32 v36, v112, v67
    v_exp_f32 v36, v36
    v_lshlrev_b32 v32, 16, v40
    v_fmac_f32 v60, v36, v32
    v_and_b32 v32, 0xffff0000, v40
    v_fmac_f32 v61, v36, v32
    v_lshlrev_b32 v32, 16, v41
    v_fmac_f32 v62, v36, v32
    v_and_b32 v32, 0xffff0000, v41
    v_fmac_f32 v63, v36, v32
    v_lshlrev_b32 v32, 16, v42
    v_fmac_f32 v64, v36, v32
    v_and_b32 v32, 0xffff0000, v42
    v_fmac_f32 v65, v36, v32
    v_and_b32 v32, 0xffff0000, v43
    v_fmac_f32 v66, v36, v32
    v_sub_f32 v36, v114, v67
    v_exp_f32 v36, v36
    v_lshlrev_b32 v32, 16, v44
    v_fmac_f32 v60, v36, v32
    v_and_b32 v32, 0xffff0000, v44
    v_fmac_f32 v61, v36, v32
    v_lshlrev_b32 v32, 16, v45
    v_fmac_f32 v62, v36, v32
    v_and_b32 v32, 0xffff0000, v45
    v_fmac_f32 v63, v36, v32
    v_lshlrev_b32 v32, 16, v46
    v_fmac_f32 v64, v36, v32
    v_and_b32 v32, 0xffff0000, v46
    v_fmac_f32 v65, v36, v32
    v_and_b32 v32, 0xffff0000, v47
    v_fmac_f32 v66, v36, v32
    v_sub_f32 v36, v116, v67
    v_exp_f32 v36, v36
    v_lshlrev_b32 v32, 16, v48
    v_fmac_f32 v60, v36, v32
    v_and_b32 v32, 0xffff0000, v48
    v_fmac_f32 v61, v36, v32
    v_lshlrev_b32 v32, 16, v49
    v_fmac_f32 v62, v36, v32
    v_and_b32 v32, 0xffff0000, v49
    v_fmac_f32 v63, v36, v32
    v_lshlrev_b32 v32, 16, v50
    v_fmac_f32 v64, v36, v32
    v_and_b32 v32, 0xffff0000, v50
    v_fmac_f32 v65, v36, v32
    v_and_b32 v32, 0xffff0000, v51
    v_fmac_f32 v66, v36, v32
    v_sub_f32 v36, v118, v67
    v_exp_f32 v36, v36
    v_lshlrev_b32 v32, 16, v52
    v_fmac_f32 v60, v36, v32
    v_and_b32 v32, 0xffff0000, v52
    v_fmac_f32 v61, v36, v32
    v_lshlrev_b32 v32, 16, v53
    v_fmac_f32 v62, v36, v32
    v_and_b32 v32, 0xffff0000, v53
    v_fmac_f32 v63, v36, v32
    v_lshlrev_b32 v32, 16, v54
    v_fmac_f32 v64, v36, v32
    v_and_b32 v32, 0xffff0000, v54
    v_fmac_f32 v65, v36, v32
    v_and_b32 v32, 0xffff0000, v55
    v_fmac_f32 v66, v36, v32
    s_nop 1
    s_branch L_trows
L_fgen:
    s_waitcnt lgkmcnt(0)
    v_max3_f32 v67, v87, v95, v103
    v_max_f32 v67, v67, v111
    v_sub_f32 v32, v87, v67
    v_exp_f32 v32, v32
    s_nop 0
    v_mul_f32 v80, v80, v32
    v_mul_f32 v81, v81, v32
    v_mul_f32 v82, v82, v32
    v_mul_f32 v83, v83, v32
    v_mul_f32 v84, v84, v32
    v_mul_f32 v85, v85, v32
    v_mul_f32 v86, v86, v32
    v_sub_f32 v32, v95, v67
    v_exp_f32 v32, v32
    s_nop 0
    v_mul_f32 v88, v88, v32
    v_mul_f32 v89, v89, v32
    v_mul_f32 v90, v90, v32
    v_mul_f32 v91, v91, v32
    v_mul_f32 v92, v92, v32
    v_mul_f32 v93, v93, v32
    v_mul_f32 v94, v94, v32
    v_sub_f32 v32, v103, v67
    v_exp_f32 v32, v32
    s_nop 0
    v_mul_f32 v96, v96, v32
    v_mul_f32 v97, v97, v32
    v_mul_f32 v98, v98, v32
    v_mul_f32 v99, v99, v32
    v_mul_f32 v100, v100, v32
    v_mul_f32 v101, v101, v32
    v_mul_f32 v102, v102, v32
    v_sub_f32 v32, v111, v67
    v_exp_f32 v32, v32
    s_nop 0
    v_mul_f32 v104, v104, v32
    v_mul_f32 v105, v105, v32
    v_mul_f32 v106, v106, v32
    v_mul_f32 v107, v107, v32
    v_mul_f32 v108, v108, v32
    v_mul_f32 v109, v109, v32
    v_mul_f32 v110, v110, v32
    s_nop 1
    s_branch L_fsum
L_qkprod:
    s_getpc_b64 s[28:29]
    s_mov_b32 s30, 0x1000
    s_mov_b32 s31, 0x20000
    v_lshlrev_b32 v31, 6, v0
    buffer_load_dword v50, v31, s[28:31], 0 offen
    v_and_b32 v28, 15, v0
    v_lshrrev_b32 v29, 4, v0
    v_mov_b32 v30, 0
    v_lshlrev_b32 v47, 4, v0
    v_add_u32 v47, 0, v47
    v_mul_u32_u24 v31, 0x180, v28
    v_and_b32 v32, 1, v29
    v_lshl_add_u32 v31, v32, 3, v31
    v_add_u32 v31, 0x1c00, v31
    v_lshrrev_b32 v32, 1, v29
    v_and_b32 v37, 6, v28
    v_xor_b32 v32, v32, v37
    v_xor_b32 v34, 0, v32
    v_lshl_add_u32 v34, v34, 4, v31
    v_xor_b32 v35, 2, v32
    v_lshl_add_u32 v35, v35, 4, v31
    v_xor_b32 v36, 4, v32
    v_lshl_add_u32 v36, v36, 4, v31
    v_xor_b32 v37, 6, v32
    v_lshl_add_u32 v37, v37, 4, v31
    v_lshrrev_b32 v31, 2, v28
    v_lshl_add_u32 v31, v29, 2, v31
    v_and_b32 v32, 6, v31
    v_mul_u32_u24 v31, 0x180, v31
    v_and_b32 v41, 3, v28
    v_lshl_add_u32 v31, v41, 3, v31
    s_mul_i32 s53, s3, 3
    s_add_u32 s53, s53, 0
    s_and_b32 s40, s53, 3
    s_lshl_b32 s40, s40, 1
    v_xor_b32 v38, s40, v32
    v_lshl_add_u32 v38, v38, 4, v31
    s_lshr_b32 s40, s53, 2
    s_lshl_b32 s40, s40, 7
    s_add_u32 s40, s40, 0x6400
    v_add_u32 v38, s40, v38
    v_add_u32 v41, 0x12000, v38
    s_lshr_b32 s40, s53, 1
    s_lshl_b32 s40, s40, 10
    s_and_b32 s42, s53, 1
    s_lshl_b32 s42, s42, 3
    s_add_u32 s40, s40, s42
    v_add_u32 v44, s40, v47
    s_mul_i32 s53, s3, 3
    s_add_u32 s53, s53, 1
    s_and_b32 s40, s53, 3
    s_lshl_b32 s40, s40, 1
    v_xor_b32 v39, s40, v32
    v_lshl_add_u32 v39, v39, 4, v31
    s_lshr_b32 s40, s53, 2
    s_lshl_b32 s40, s40, 7
    s_add_u32 s40, s40, 0x6400
    v_add_u32 v39, s40, v39
    v_add_u32 v42, 0x12000, v39
    s_lshr_b32 s40, s53, 1
    s_lshl_b32 s40, s40, 10
    s_and_b32 s42, s53, 1
    s_lshl_b32 s42, s42, 3
    s_add_u32 s40, s40, s42
    v_add_u32 v45, s40, v47
    s_mul_i32 s53, s3, 3
    s_add_u32 s53, s53, 2
    s_and_b32 s40, s53, 3
    s_lshl_b32 s40, s40, 1
    v_xor_b32 v40, s40, v32
    v_lshl_add_u32 v40, v40, 4, v31
    s_lshr_b32 s40, s53, 2
    s_lshl_b32 s40, s40, 7
    s_add_u32 s40, s40, 0x6400
    v_add_u32 v40, s40, v40
    v_add_u32 v43, 0x12000, v40
    s_lshr_b32 s40, s53, 1
    s_lshl_b32 s40, s40, 10
    s_and_b32 s42, s53, 1
    s_lshl_b32 s42, s42, 3
    s_add_u32 s40, s40, s42
    v_add_u32 v46, s40, v47
    s_nop 1
L_spin71:
    ds_read_b32 v31, v30 offset:6956
    s_waitcnt lgkmcnt(0)
    v_readfirstlane_b32 s40, v31
    s_nop 0
    s_cmp_ge_u32 s40, 1
    s_cbranch_scc1 L_spun72
    s_sleep 1
    s_branch L_spin71
L_spun72:
    ds_read_b64 v[52:53], v34
    ds_read_b64 v[54:55], v35
    ds_read_b64 v[56:57], v36
    ds_read_b64 v[58:59], v37
    ds_read_b64 v[60:61], v34 offset:128
    ds_read_b64 v[62:63], v35 offset:128
    ds_read_b64 v[64:65], v36 offset:128
    ds_read_b64 v[66:67], v37 offset:128
    ds_read_b64 v[68:69], v34 offset:256
    ds_read_b64 v[70:71], v35 offset:256
    ds_read_b64 v[72:73], v36 offset:256
    ds_read_b64 v[74:75], v37 offset:256
    v_mov_b32 v77, 0x3f803f80
    s_waitcnt lgkmcnt(0)
    v_dot2_f32_bf16 v76, v52, v77, 0
    v_dot2_f32_bf16 v80, v52, v52, 0
    v_dot2_f32_bf16 v76, v53, v77, v76
    v_dot2_f32_bf16 v80, v53, v53, v80
    v_dot2_f32_bf16 v76, v54, v77, v76
    v_dot2_f32_bf16 v80, v54, v54, v80
    v_dot2_f32_bf16 v76, v55, v77, v76
    v_dot2_f32_bf16 v80, v55, v55, v80
    v_dot2_f32_bf16 v76, v56, v77, v76
    v_dot2_f32_bf16 v80, v56, v56, v80
    v_dot2_f32_bf16 v76, v57, v77, v76
    v_dot2_f32_bf16 v80, v57, v57, v80
    v_dot2_f32_bf16 v76, v58, v77, v76
    v_dot2_f32_bf16 v80, v58, v58, v80
    v_dot2_f32_bf16 v76, v59, v77, v76
    v_dot2_f32_bf16 v80, v59, v59, v80
    v_dot2_f32_bf16 v76, v60, v77, v76
    v_dot2_f32_bf16 v80, v60, v60, v80
    v_dot2_f32_bf16 v76, v61, v77, v76
    v_dot2_f32_bf16 v80, v61, v61, v80
    v_dot2_f32_bf16 v76, v62, v77, v76
    v_dot2_f32_bf16 v80, v62, v62, v80
    v_dot2_f32_bf16 v76, v63, v77, v76
    v_dot2_f32_bf16 v80, v63, v63, v80
    v_dot2_f32_bf16 v76, v64, v77, v76
    v_dot2_f32_bf16 v80, v64, v64, v80
    v_dot2_f32_bf16 v76, v65, v77, v76
    v_dot2_f32_bf16 v80, v65, v65, v80
    v_dot2_f32_bf16 v76, v66, v77, v76
    v_dot2_f32_bf16 v80, v66, v66, v80
    v_dot2_f32_bf16 v76, v67, v77, v76
    v_dot2_f32_bf16 v80, v67, v67, v80
    v_dot2_f32_bf16 v76, v68, v77, v76
    v_dot2_f32_bf16 v80, v68, v68, v80
    v_dot2_f32_bf16 v76, v69, v77, v76
    v_dot2_f32_bf16 v80, v69, v69, v80
    v_dot2_f32_bf16 v76, v70, v77, v76
    v_dot2_f32_bf16 v80, v70, v70, v80
    v_dot2_f32_bf16 v76, v71, v77, v76
    v_dot2_f32_bf16 v80, v71, v71, v80
    v_dot2_f32_bf16 v76, v72, v77, v76
    v_dot2_f32_bf16 v80, v72, v72, v80
    v_dot2_f32_bf16 v76, v73, v77, v76
    v_dot2_f32_bf16 v80, v73, v73, v80
    v_dot2_f32_bf16 v76, v74, v77, v76
    v_dot2_f32_bf16 v80, v74, v74, v80
    v_dot2_f32_bf16 v76, v75, v77, v76
    v_dot2_f32_bf16 v80, v75, v75, v80
    s_nop 1
    v_mov_b32 v31, v76
    v_mov_b32 v32, v76
    v_mov_b32 v82, v80
    v_mov_b32 v83, v80
    v_permlane32_swap_b32 v31, v32
    s_nop 0
    v_permlane32_swap_b32 v82, v83
    v_add_f32 v76, v31, v32
    v_add_f32 v80, v82, v83
    v_mov_b32 v31, v76
    v_mov_b32 v32, v76
    v_mov_b32 v82, v80
    v_mov_b32 v83, v80
    v_permlane16_swap_b32 v31, v32
    s_nop 0
    v_permlane16_swap_b32 v82, v83
    v_add_f32 v76, v31, v32
    v_add_f32 v80, v82, v83
    v_mul_f32 v78, s44, v76
    v_mul_f32 v80, s44, v80
    v_fma_f32 v80, -v78, v78, v80
    v_max_f32 v80, 0, v80
    v_cvt_pk_bf16_f32 v78, v78, v78
    v_and_b32 v78, 0xffff0000, v78
    v_mov_b32 v79, v78
    v_cvt_pk_bf16_f32 v80, v80, v80
    v_and_b32 v80, 0xffff0000, v80
    v_add_f32 v80, 0x3727c5ac, v80
    v_cvt_pk_bf16_f32 v80, v80, v80
    v_and_b32 v80, 0xffff0000, v80
    v_sqrt_f32 v80, v80
    s_nop 0
    v_cvt_pk_bf16_f32 v80, v80, v80
    v_and_b32 v80, 0xffff0000, v80
    v_rcp_f32 v80, v80
    s_nop 0
    v_mov_b32 v81, v80
    v_lshlrev_b32 v82, 16, v52
    v_and_b32 v83, 0xffff0000, v52
    v_pk_add_f32 v[82:83], v[82:83], v[78:79] neg_lo:[0,1] neg_hi:[0,1]
    v_cvt_pk_bf16_f32 v52, v82, v83
    v_lshlrev_b32 v82, 16, v52
    v_and_b32 v83, 0xffff0000, v52
    v_pk_mul_f32 v[82:83], v[82:83], v[80:81]
    v_cvt_pk_bf16_f32 v52, v82, v83
    v_lshlrev_b32 v84, 16, v53
    v_and_b32 v85, 0xffff0000, v53
    v_pk_add_f32 v[84:85], v[84:85], v[78:79] neg_lo:[0,1] neg_hi:[0,1]
    v_cvt_pk_bf16_f32 v53, v84, v85
    v_lshlrev_b32 v84, 16, v53
    v_and_b32 v85, 0xffff0000, v53
    v_pk_mul_f32 v[84:85], v[84:85], v[80:81]
    v_cvt_pk_bf16_f32 v53, v84, v85
    v_lshlrev_b32 v82, 16, v54
    v_and_b32 v83, 0xffff0000, v54
    v_pk_add_f32 v[82:83], v[82:83], v[78:79] neg_lo:[0,1] neg_hi:[0,1]
    v_cvt_pk_bf16_f32 v54, v82, v83
    v_lshlrev_b32 v82, 16, v54
    v_and_b32 v83, 0xffff0000, v54
    v_pk_mul_f32 v[82:83], v[82:83], v[80:81]
    v_cvt_pk_bf16_f32 v54, v82, v83
    v_lshlrev_b32 v84, 16, v55
    v_and_b32 v85, 0xffff0000, v55
    v_pk_add_f32 v[84:85], v[84:85], v[78:79] neg_lo:[0,1] neg_hi:[0,1]
    v_cvt_pk_bf16_f32 v55, v84, v85
    v_lshlrev_b32 v84, 16, v55
    v_and_b32 v85, 0xffff0000, v55
    v_pk_mul_f32 v[84:85], v[84:85], v[80:81]
    v_cvt_pk_bf16_f32 v55, v84, v85
    v_lshlrev_b32 v82, 16, v56
    v_and_b32 v83, 0xffff0000, v56
    v_pk_add_f32 v[82:83], v[82:83], v[78:79] neg_lo:[0,1] neg_hi:[0,1]
    v_cvt_pk_bf16_f32 v56, v82, v83
    v_lshlrev_b32 v82, 16, v56
    v_and_b32 v83, 0xffff0000, v56
    v_pk_mul_f32 v[82:83], v[82:83], v[80:81]
    v_cvt_pk_bf16_f32 v56, v82, v83
    v_lshlrev_b32 v84, 16, v57
    v_and_b32 v85, 0xffff0000, v57
    v_pk_add_f32 v[84:85], v[84:85], v[78:79] neg_lo:[0,1] neg_hi:[0,1]
    v_cvt_pk_bf16_f32 v57, v84, v85
    v_lshlrev_b32 v84, 16, v57
    v_and_b32 v85, 0xffff0000, v57
    v_pk_mul_f32 v[84:85], v[84:85], v[80:81]
    v_cvt_pk_bf16_f32 v57, v84, v85
    v_lshlrev_b32 v82, 16, v58
    v_and_b32 v83, 0xffff0000, v58
    v_pk_add_f32 v[82:83], v[82:83], v[78:79] neg_lo:[0,1] neg_hi:[0,1]
    v_cvt_pk_bf16_f32 v58, v82, v83
    v_lshlrev_b32 v82, 16, v58
    v_and_b32 v83, 0xffff0000, v58
    v_pk_mul_f32 v[82:83], v[82:83], v[80:81]
    v_cvt_pk_bf16_f32 v58, v82, v83
    v_lshlrev_b32 v84, 16, v59
    v_and_b32 v85, 0xffff0000, v59
    v_pk_add_f32 v[84:85], v[84:85], v[78:79] neg_lo:[0,1] neg_hi:[0,1]
    v_cvt_pk_bf16_f32 v59, v84, v85
    v_lshlrev_b32 v84, 16, v59
    v_and_b32 v85, 0xffff0000, v59
    v_pk_mul_f32 v[84:85], v[84:85], v[80:81]
    v_cvt_pk_bf16_f32 v59, v84, v85
    v_lshlrev_b32 v82, 16, v60
    v_and_b32 v83, 0xffff0000, v60
    v_pk_add_f32 v[82:83], v[82:83], v[78:79] neg_lo:[0,1] neg_hi:[0,1]
    v_cvt_pk_bf16_f32 v60, v82, v83
    v_lshlrev_b32 v82, 16, v60
    v_and_b32 v83, 0xffff0000, v60
    v_pk_mul_f32 v[82:83], v[82:83], v[80:81]
    v_cvt_pk_bf16_f32 v60, v82, v83
    v_lshlrev_b32 v84, 16, v61
    v_and_b32 v85, 0xffff0000, v61
    v_pk_add_f32 v[84:85], v[84:85], v[78:79] neg_lo:[0,1] neg_hi:[0,1]
    v_cvt_pk_bf16_f32 v61, v84, v85
    v_lshlrev_b32 v84, 16, v61
    v_and_b32 v85, 0xffff0000, v61
    v_pk_mul_f32 v[84:85], v[84:85], v[80:81]
    v_cvt_pk_bf16_f32 v61, v84, v85
    v_lshlrev_b32 v82, 16, v62
    v_and_b32 v83, 0xffff0000, v62
    v_pk_add_f32 v[82:83], v[82:83], v[78:79] neg_lo:[0,1] neg_hi:[0,1]
    v_cvt_pk_bf16_f32 v62, v82, v83
    v_lshlrev_b32 v82, 16, v62
    v_and_b32 v83, 0xffff0000, v62
    v_pk_mul_f32 v[82:83], v[82:83], v[80:81]
    v_cvt_pk_bf16_f32 v62, v82, v83
    v_lshlrev_b32 v84, 16, v63
    v_and_b32 v85, 0xffff0000, v63
    v_pk_add_f32 v[84:85], v[84:85], v[78:79] neg_lo:[0,1] neg_hi:[0,1]
    v_cvt_pk_bf16_f32 v63, v84, v85
    v_lshlrev_b32 v84, 16, v63
    v_and_b32 v85, 0xffff0000, v63
    v_pk_mul_f32 v[84:85], v[84:85], v[80:81]
    v_cvt_pk_bf16_f32 v63, v84, v85
    v_lshlrev_b32 v82, 16, v64
    v_and_b32 v83, 0xffff0000, v64
    v_pk_add_f32 v[82:83], v[82:83], v[78:79] neg_lo:[0,1] neg_hi:[0,1]
    v_cvt_pk_bf16_f32 v64, v82, v83
    v_lshlrev_b32 v82, 16, v64
    v_and_b32 v83, 0xffff0000, v64
    v_pk_mul_f32 v[82:83], v[82:83], v[80:81]
    v_cvt_pk_bf16_f32 v64, v82, v83
    v_lshlrev_b32 v84, 16, v65
    v_and_b32 v85, 0xffff0000, v65
    v_pk_add_f32 v[84:85], v[84:85], v[78:79] neg_lo:[0,1] neg_hi:[0,1]
    v_cvt_pk_bf16_f32 v65, v84, v85
    v_lshlrev_b32 v84, 16, v65
    v_and_b32 v85, 0xffff0000, v65
    v_pk_mul_f32 v[84:85], v[84:85], v[80:81]
    v_cvt_pk_bf16_f32 v65, v84, v85
    v_lshlrev_b32 v82, 16, v66
    v_and_b32 v83, 0xffff0000, v66
    v_pk_add_f32 v[82:83], v[82:83], v[78:79] neg_lo:[0,1] neg_hi:[0,1]
    v_cvt_pk_bf16_f32 v66, v82, v83
    v_lshlrev_b32 v82, 16, v66
    v_and_b32 v83, 0xffff0000, v66
    v_pk_mul_f32 v[82:83], v[82:83], v[80:81]
    v_cvt_pk_bf16_f32 v66, v82, v83
    v_lshlrev_b32 v84, 16, v67
    v_and_b32 v85, 0xffff0000, v67
    v_pk_add_f32 v[84:85], v[84:85], v[78:79] neg_lo:[0,1] neg_hi:[0,1]
    v_cvt_pk_bf16_f32 v67, v84, v85
    v_lshlrev_b32 v84, 16, v67
    v_and_b32 v85, 0xffff0000, v67
    v_pk_mul_f32 v[84:85], v[84:85], v[80:81]
    v_cvt_pk_bf16_f32 v67, v84, v85
    v_lshlrev_b32 v82, 16, v68
    v_and_b32 v83, 0xffff0000, v68
    v_pk_add_f32 v[82:83], v[82:83], v[78:79] neg_lo:[0,1] neg_hi:[0,1]
    v_cvt_pk_bf16_f32 v68, v82, v83
    v_lshlrev_b32 v82, 16, v68
    v_and_b32 v83, 0xffff0000, v68
    v_pk_mul_f32 v[82:83], v[82:83], v[80:81]
    v_cvt_pk_bf16_f32 v68, v82, v83
    v_lshlrev_b32 v84, 16, v69
    v_and_b32 v85, 0xffff0000, v69
    v_pk_add_f32 v[84:85], v[84:85], v[78:79] neg_lo:[0,1] neg_hi:[0,1]
    v_cvt_pk_bf16_f32 v69, v84, v85
    v_lshlrev_b32 v84, 16, v69
    v_and_b32 v85, 0xffff0000, v69
    v_pk_mul_f32 v[84:85], v[84:85], v[80:81]
    v_cvt_pk_bf16_f32 v69, v84, v85
    v_lshlrev_b32 v82, 16, v70
    v_and_b32 v83, 0xffff0000, v70
    v_pk_add_f32 v[82:83], v[82:83], v[78:79] neg_lo:[0,1] neg_hi:[0,1]
    v_cvt_pk_bf16_f32 v70, v82, v83
    v_lshlrev_b32 v82, 16, v70
    v_and_b32 v83, 0xffff0000, v70
    v_pk_mul_f32 v[82:83], v[82:83], v[80:81]
    v_cvt_pk_bf16_f32 v70, v82, v83
    v_lshlrev_b32 v84, 16, v71
    v_and_b32 v85, 0xffff0000, v71
    v_pk_add_f32 v[84:85], v[84:85], v[78:79] neg_lo:[0,1] neg_hi:[0,1]
    v_cvt_pk_bf16_f32 v71, v84, v85
    v_lshlrev_b32 v84, 16, v71
    v_and_b32 v85, 0xffff0000, v71
    v_pk_mul_f32 v[84:85], v[84:85], v[80:81]
    v_cvt_pk_bf16_f32 v71, v84, v85
    v_lshlrev_b32 v82, 16, v72
    v_and_b32 v83, 0xffff0000, v72
    v_pk_add_f32 v[82:83], v[82:83], v[78:79] neg_lo:[0,1] neg_hi:[0,1]
    v_cvt_pk_bf16_f32 v72, v82, v83
    v_lshlrev_b32 v82, 16, v72
    v_and_b32 v83, 0xffff0000, v72
    v_pk_mul_f32 v[82:83], v[82:83], v[80:81]
    v_cvt_pk_bf16_f32 v72, v82, v83
    v_lshlrev_b32 v84, 16, v73
    v_and_b32 v85, 0xffff0000, v73
    v_pk_add_f32 v[84:85], v[84:85], v[78:79] neg_lo:[0,1] neg_hi:[0,1]
    v_cvt_pk_bf16_f32 v73, v84, v85
    v_lshlrev_b32 v84, 16, v73
    v_and_b32 v85, 0xffff0000, v73
    v_pk_mul_f32 v[84:85], v[84:85], v[80:81]
    v_cvt_pk_bf16_f32 v73, v84, v85
    v_lshlrev_b32 v82, 16, v74
    v_and_b32 v83, 0xffff0000, v74
    v_pk_add_f32 v[82:83], v[82:83], v[78:79] neg_lo:[0,1] neg_hi:[0,1]
    v_cvt_pk_bf16_f32 v74, v82, v83
    v_lshlrev_b32 v82, 16, v74
    v_and_b32 v83, 0xffff0000, v74
    v_pk_mul_f32 v[82:83], v[82:83], v[80:81]
    v_cvt_pk_bf16_f32 v74, v82, v83
    v_lshlrev_b32 v84, 16, v75
    v_and_b32 v85, 0xffff0000, v75
    v_pk_add_f32 v[84:85], v[84:85], v[78:79] neg_lo:[0,1] neg_hi:[0,1]
    v_cvt_pk_bf16_f32 v75, v84, v85
    v_lshlrev_b32 v84, 16, v75
    v_and_b32 v85, 0xffff0000, v75
    v_pk_mul_f32 v[84:85], v[84:85], v[80:81]
    v_cvt_pk_bf16_f32 v75, v84, v85
    s_nop 1
L_spin73:
    ds_read_b32 v31, v30 offset:6956
    s_waitcnt lgkmcnt(0)
    v_readfirstlane_b32 s40, v31
    s_nop 0
    s_cmp_ge_u32 s40, 2
    s_cbranch_scc1 L_spun74
    s_sleep 1
    s_branch L_spin73
L_spun74:
    s_waitcnt vmcnt(0)
    ds_read_b64_tr_b16 v[100:101], v38
    ds_read_b64_tr_b16 v[102:103], v38 offset:6144
    ds_read_b64_tr_b16 v[104:105], v39
    ds_read_b64_tr_b16 v[106:107], v39 offset:6144
    ds_read_b64_tr_b16 v[108:109], v40
    ds_read_b64_tr_b16 v[110:111], v40 offset:6144
    ds_read_b64_tr_b16 v[112:113], v38 offset:12288
    ds_read_b64_tr_b16 v[114:115], v38 offset:18432
    ds_read_b64_tr_b16 v[116:117], v39 offset:12288
    ds_read_b64_tr_b16 v[118:119], v39 offset:18432
    ds_read_b64_tr_b16 v[120:121], v40 offset:12288
    ds_read_b64_tr_b16 v[122:123], v40 offset:18432
    ds_read_b64_tr_b16 v[124:125], v38 offset:36864
    ds_read_b64_tr_b16 v[126:127], v38 offset:43008
    ds_read_b64_tr_b16 v[128:129], v39 offset:36864
    ds_read_b64_tr_b16 v[130:131], v39 offset:43008
    ds_read_b64_tr_b16 v[132:133], v40 offset:36864
    ds_read_b64_tr_b16 v[134:135], v40 offset:43008
    s_waitcnt lgkmcnt(12)
    v_mfma_f32_16x16x32_bf16 v[88:91], v[100:103], v[52:55], 0
    v_mfma_f32_16x16x32_bf16 v[92:95], v[104:107], v[52:55], 0
    v_mfma_f32_16x16x32_bf16 v[96:99], v[108:111], v[52:55], 0
    ds_read_b64_tr_b16 v[136:137], v38 offset:49152
    ds_read_b64_tr_b16 v[138:139], v38 offset:55296
    ds_read_b64_tr_b16 v[140:141], v39 offset:49152
    ds_read_b64_tr_b16 v[142:143], v39 offset:55296
    ds_read_b64_tr_b16 v[144:145], v40 offset:49152
    ds_read_b64_tr_b16 v[146:147], v40 offset:55296
    s_waitcnt lgkmcnt(12)
    v_mfma_f32_16x16x32_bf16 v[88:91], v[112:115], v[56:59], v[88:91]
    v_mfma_f32_16x16x32_bf16 v[92:95], v[116:119], v[56:59], v[92:95]
    v_mfma_f32_16x16x32_bf16 v[96:99], v[120:123], v[56:59], v[96:99]
    ds_read_b64_tr_b16 v[148:149], v41
    ds_read_b64_tr_b16 v[150:151], v41 offset:6144
    ds_read_b64_tr_b16 v[152:153], v42
    ds_read_b64_tr_b16 v[154:155], v42 offset:6144
    ds_read_b64_tr_b16 v[156:157], v43
    ds_read_b64_tr_b16 v[158:159], v43 offset:6144
    s_waitcnt lgkmcnt(12)
    v_mfma_f32_16x16x32_bf16 v[88:91], v[124:127], v[60:63], v[88:91]
    v_mfma_f32_16x16x32_bf16 v[92:95], v[128:131], v[60:63], v[92:95]
    v_mfma_f32_16x16x32_bf16 v[96:99], v[132:135], v[60:63], v[96:99]
    ds_read_b64_tr_b16 v[160:161], v41 offset:12288
    ds_read_b64_tr_b16 v[162:163], v41 offset:18432
    ds_read_b64_tr_b16 v[164:165], v42 offset:12288
    ds_read_b64_tr_b16 v[166:167], v42 offset:18432
    ds_read_b64_tr_b16 v[168:169], v43 offset:12288
    ds_read_b64_tr_b16 v[170:171], v43 offset:18432
    s_waitcnt lgkmcnt(12)
    v_mfma_f32_16x16x32_bf16 v[88:91], v[136:139], v[64:67], v[88:91]
    v_mfma_f32_16x16x32_bf16 v[92:95], v[140:143], v[64:67], v[92:95]
    v_mfma_f32_16x16x32_bf16 v[96:99], v[144:147], v[64:67], v[96:99]
    s_waitcnt lgkmcnt(6)
    v_mfma_f32_16x16x32_bf16 v[88:91], v[148:151], v[68:71], v[88:91]
    v_mfma_f32_16x16x32_bf16 v[92:95], v[152:155], v[68:71], v[92:95]
    v_mfma_f32_16x16x32_bf16 v[96:99], v[156:159], v[68:71], v[96:99]
    s_waitcnt lgkmcnt(0)
    v_mfma_f32_16x16x32_bf16 v[88:91], v[160:163], v[72:75], v[88:91]
    v_mfma_f32_16x16x32_bf16 v[92:95], v[164:167], v[72:75], v[92:95]
    v_mfma_f32_16x16x32_bf16 v[96:99], v[168:171], v[72:75], v[96:99]
    s_nop 5
    v_cvt_pk_bf16_f32 v76, v88, v89
    v_cvt_pk_bf16_f32 v77, v90, v91
    ds_write_b64 v44, v[76:77]
    v_cvt_pk_bf16_f32 v78, v92, v93
    v_cvt_pk_bf16_f32 v79, v94, v95
    ds_write_b64 v45, v[78:79]
    v_cvt_pk_bf16_f32 v80, v96, v97
    v_cvt_pk_bf16_f32 v81, v98, v99
    ds_write_b64 v46, v[80:81]
    v_mov_b32 v31, 1
    s_mov_b64 exec, 1
    ds_add_u32 v30, v31 offset:6948
    s_mov_b64 exec, -1
    s_cmp_ge_u32 s3, 2
    s_cbranch_scc1 L_qkp_done
L_spin75:
    ds_read_b32 v31, v30 offset:6956
    s_waitcnt lgkmcnt(0)
    v_readfirstlane_b32 s40, v31
    s_nop 0
    s_cmp_ge_u32 s40, 3
    s_cbranch_scc1 L_spun76
    s_sleep 1
    s_branch L_spin75
L_spun76:
    s_mul_i32 s40, s3, 0x3000
    s_add_u32 s40, s40, 0x1f800
    v_add_u32 v34, s40, v34
    v_add_u32 v35, s40, v35
    v_add_u32 v36, s40, v36
    v_add_u32 v37, s40, v37
    ds_read_b64 v[100:101], v34
    ds_read_b64 v[102:103], v35
    ds_read_b64 v[104:105], v36
    ds_read_b64 v[106:107], v37
    ds_read_b64 v[108:109], v34 offset:128
    ds_read_b64 v[110:111], v35 offset:128
    ds_read_b64 v[112:113], v36 offset:128
    ds_read_b64 v[114:115], v37 offset:128
    ds_read_b64 v[116:117], v34 offset:256
    ds_read_b64 v[118:119], v35 offset:256
    ds_read_b64 v[120:121], v36 offset:256
    ds_read_b64 v[122:123], v37 offset:256
    ds_read_b64 v[124:125], v34 offset:6144
    ds_read_b64 v[126:127], v35 offset:6144
    ds_read_b64 v[128:129], v36 offset:6144
    ds_read_b64 v[130:131], v37 offset:6144
    ds_read_b64 v[132:133], v34 offset:6272
    ds_read_b64 v[134:135], v35 offset:6272
    ds_read_b64 v[136:137], v36 offset:6272
    ds_read_b64 v[138:139], v37 offset:6272
    ds_read_b64 v[140:141], v34 offset:6400
    ds_read_b64 v[142:143], v35 offset:6400
    ds_read_b64 v[144:145], v36 offset:6400
    ds_read_b64 v[146:147], v37 offset:6400
L_spin77:
    ds_read_b32 v31, v30 offset:6948
    s_waitcnt lgkmcnt(0)
    v_readfirstlane_b32 s40, v31
    s_nop 0
    s_cmp_ge_u32 s40, 4
    s_cbranch_scc1 L_spun78
    s_sleep 1
    s_branch L_spin77
L_spun78:
    ds_read_b128 v[52:55], v47
    ds_read_b128 v[56:59], v47 offset:1024
    ds_read_b128 v[60:63], v47 offset:2048
    ds_read_b128 v[64:67], v47 offset:3072
    ds_read_b128 v[68:71], v47 offset:4096
    ds_read_b128 v[72:75], v47 offset:5120
    s_lshl_b32 s42, s2, 1
    s_add_u32 s42, s42, s3
    s_lshl_b32 s42, s42, 10
    s_add_u32 s42, s42, 0x500000
    v_lshlrev_b32 v33, 4, v0
    s_waitcnt lgkmcnt(5)
    v_mfma_f32_16x16x32_bf16 v[88:91], v[100:103], v[52:55], 0
    v_mfma_f32_16x16x32_bf16 v[92:95], v[124:127], v[52:55], 0
    s_waitcnt lgkmcnt(4)
    v_mfma_f32_16x16x32_bf16 v[88:91], v[104:107], v[56:59], v[88:91]
    v_mfma_f32_16x16x32_bf16 v[92:95], v[128:131], v[56:59], v[92:95]
    s_waitcnt lgkmcnt(3)
    v_mfma_f32_16x16x32_bf16 v[88:91], v[108:111], v[60:63], v[88:91]
    v_mfma_f32_16x16x32_bf16 v[92:95], v[132:135], v[60:63], v[92:95]
    s_waitcnt lgkmcnt(2)
    v_mfma_f32_16x16x32_bf16 v[88:91], v[112:115], v[64:67], v[88:91]
    v_mfma_f32_16x16x32_bf16 v[92:95], v[136:139], v[64:67], v[92:95]
    s_waitcnt lgkmcnt(1)
    v_mfma_f32_16x16x32_bf16 v[88:91], v[116:119], v[68:71], v[88:91]
    v_mfma_f32_16x16x32_bf16 v[92:95], v[140:143], v[68:71], v[92:95]
    s_waitcnt lgkmcnt(0)
    v_mfma_f32_16x16x32_bf16 v[88:91], v[120:123], v[72:75], v[88:91]
    v_mfma_f32_16x16x32_bf16 v[92:95], v[144:147], v[72:75], v[92:95]
    s_nop 7
L_spin79:
    ds_read_b32 v31, v30 offset:6960
    s_waitcnt lgkmcnt(0)
    v_readfirstlane_b32 s40, v31
    s_nop 0
    s_cmp_ge_u32 s40, 1
    s_cbranch_scc1 L_spun80
    s_sleep 1
    s_branch L_spin79
L_spun80:
    s_mov_b32 s40, 0x3dd53b95
    v_mul_f32 v88, s40, v88
    v_mul_f32 v89, s40, v89
    v_mul_f32 v90, s40, v90
    v_mul_f32 v91, s40, v91
    v_cvt_pk_bf16_f32 v76, v88, v89
    v_cvt_pk_bf16_f32 v77, v90, v91
    v_mul_f32 v92, s40, v92
    v_mul_f32 v93, s40, v93
    v_mul_f32 v94, s40, v94
    v_mul_f32 v95, s40, v95
    v_cvt_pk_bf16_f32 v78, v92, v93
    v_cvt_pk_bf16_f32 v79, v94, v95
    v_min_u32 v76, -2, v76
    v_min_u32 v77, -2, v77
    v_min_u32 v78, -2, v78
    v_min_u32 v79, -2, v79
    buffer_store_dwordx4 v[76:79], v33, s[32:35], s42 offen sc1
    s_nop 1
L_qkp_done:
    v_mov_b32 v31, 1
    s_mov_b64 exec, 1
    ds_add_u32 v30, v31 offset:6952
    s_mov_b64 exec, -1
    s_waitcnt lgkmcnt(0)
    s_branch L_c_start
L_wvprod:
    s_getpc_b64 s[28:29]
    s_mov_b32 s30, 0x1000
    s_mov_b32 s31, 0x20000
    v_lshlrev_b32 v148, 6, v0
    buffer_load_dword v156, v148, s[28:31], 0 offen
    v_mov_b32 v150, 0
    v_add_u32 v152, 0x6400, v244
    v_add_u32 v153, 0x6400, v245
    v_add_u32 v154, 0x18400, v244
    v_add_u32 v155, 0x18400, v245
    v_lshrrev_b32 v148, 4, v0
    v_bfe_u32 v149, v0, 2, 2
    v_lshl_add_u32 v148, v148, 3, v149
    v_and_b32 v149, 3, v0
    v_lshlrev_b32 v149, 3, v149
    v_lshl_add_u32 v151, v148, 7, v149
    s_lshl_b32 s40, s3, 5
    s_add_u32 s40, s40, 0x21400
    v_add_u32 v151, s40, v151
    s_nop 1
L_spin81:
    ds_read_b32 v148, v150 offset:6956
    s_waitcnt lgkmcnt(0)
    v_readfirstlane_b32 s40, v148
    s_nop 0
    s_cmp_ge_u32 s40, 1
    s_cbranch_scc1 L_spun82
    s_sleep 1
    s_branch L_spin81
L_spun82:
    ds_read_b64_tr_b16 v[28:29], v151
    ds_read_b64_tr_b16 v[30:31], v151 offset:512
    ds_read_b64_tr_b16 v[32:33], v151 offset:4096
    ds_read_b64_tr_b16 v[34:35], v151 offset:4608
    ds_read_b64_tr_b16 v[36:37], v151 offset:8192
    ds_read_b64_tr_b16 v[38:39], v151 offset:8704
    ds_read_b64_tr_b16 v[40:41], v151 offset:12288
    ds_read_b64_tr_b16 v[42:43], v151 offset:12800
    ds_read_b64_tr_b16 v[44:45], v151 offset:16384
    ds_read_b64_tr_b16 v[46:47], v151 offset:16896
    ds_read_b64_tr_b16 v[48:49], v151 offset:20480
    ds_read_b64_tr_b16 v[50:51], v151 offset:20992
L_spin83:
    ds_read_b32 v148, v150 offset:6956
    s_waitcnt lgkmcnt(0)
    v_readfirstlane_b32 s40, v148
    s_nop 0
    s_cmp_ge_u32 s40, 2
    s_cbranch_scc1 L_spun84
    s_sleep 1
    s_branch L_spin83
L_spun84:
    s_waitcnt vmcnt(0)
    ds_read_b128 v[100:103], v152
    ds_read_b128 v[104:107], v153
    ds_read_b128 v[108:111], v152 offset:128
    ds_read_b128 v[112:115], v153 offset:128
    ds_read_b128 v[116:119], v152 offset:256
    ds_read_b128 v[120:123], v153 offset:256
    s_waitcnt lgkmcnt(5)
    v_mfma_f32_16x16x32_bf16 v[52:55], v[100:103], v[28:31], 0
    ds_read_b128 v[124:127], v152 offset:6144
    s_waitcnt lgkmcnt(5)
    v_mfma_f32_16x16x32_bf16 v[52:55], v[104:107], v[32:35], v[52:55]
    ds_read_b128 v[128:131], v153 offset:6144
    s_waitcnt lgkmcnt(5)
    v_mfma_f32_16x16x32_bf16 v[52:55], v[108:111], v[36:39], v[52:55]
    ds_read_b128 v[132:135], v152 offset:6272
    s_waitcnt lgkmcnt(5)
    v_mfma_f32_16x16x32_bf16 v[52:55], v[112:115], v[40:43], v[52:55]
    ds_read_b128 v[136:139], v153 offset:6272
    s_waitcnt lgkmcnt(5)
    v_mfma_f32_16x16x32_bf16 v[52:55], v[116:119], v[44:47], v[52:55]
    ds_read_b128 v[140:143], v152 offset:6400
    s_waitcnt lgkmcnt(5)
    v_mfma_f32_16x16x32_bf16 v[52:55], v[120:123], v[48:51], v[52:55]
    ds_read_b128 v[144:147], v153 offset:6400
    s_waitcnt lgkmcnt(5)
    v_mfma_f32_16x16x32_bf16 v[56:59], v[124:127], v[28:31], 0
    ds_read_b128 v[100:103], v152 offset:12288
    s_waitcnt lgkmcnt(5)
    v_mfma_f32_16x16x32_bf16 v[56:59], v[128:131], v[32:35], v[56:59]
    ds_read_b128 v[104:107], v153 offset:12288
    s_waitcnt lgkmcnt(5)
    v_mfma_f32_16x16x32_bf16 v[56:59], v[132:135], v[36:39], v[56:59]
    ds_read_b128 v[108:111], v152 offset:12416
    s_waitcnt lgkmcnt(5)
    v_mfma_f32_16x16x32_bf16 v[56:59], v[136:139], v[40:43], v[56:59]
    ds_read_b128 v[112:115], v153 offset:12416
    s_waitcnt lgkmcnt(5)
    v_mfma_f32_16x16x32_bf16 v[56:59], v[140:143], v[44:47], v[56:59]
    ds_read_b128 v[116:119], v152 offset:12544
    s_waitcnt lgkmcnt(5)
    v_mfma_f32_16x16x32_bf16 v[56:59], v[144:147], v[48:51], v[56:59]
    ds_read_b128 v[120:123], v153 offset:12544
    s_waitcnt lgkmcnt(5)
    v_mfma_f32_16x16x32_bf16 v[60:63], v[100:103], v[28:31], 0
    ds_read_b128 v[124:127], v152 offset:18432
    s_waitcnt lgkmcnt(5)
    v_mfma_f32_16x16x32_bf16 v[60:63], v[104:107], v[32:35], v[60:63]
    ds_read_b128 v[128:131], v153 offset:18432
    s_waitcnt lgkmcnt(5)
    v_mfma_f32_16x16x32_bf16 v[60:63], v[108:111], v[36:39], v[60:63]
    ds_read_b128 v[132:135], v152 offset:18560
    s_waitcnt lgkmcnt(5)
    v_mfma_f32_16x16x32_bf16 v[60:63], v[112:115], v[40:43], v[60:63]
    ds_read_b128 v[136:139], v153 offset:18560
    s_waitcnt lgkmcnt(5)
    v_mfma_f32_16x16x32_bf16 v[60:63], v[116:119], v[44:47], v[60:63]
    ds_read_b128 v[140:143], v152 offset:18688
    s_waitcnt lgkmcnt(5)
    v_mfma_f32_16x16x32_bf16 v[60:63], v[120:123], v[48:51], v[60:63]
    ds_read_b128 v[144:147], v153 offset:18688
    s_waitcnt lgkmcnt(5)
    v_mfma_f32_16x16x32_bf16 v[64:67], v[124:127], v[28:31], 0
    ds_read_b128 v[100:103], v152 offset:36864
    s_waitcnt lgkmcnt(5)
    v_mfma_f32_16x16x32_bf16 v[64:67], v[128:131], v[32:35], v[64:67]
    ds_read_b128 v[104:107], v153 offset:36864
    s_waitcnt lgkmcnt(5)
    v_mfma_f32_16x16x32_bf16 v[64:67], v[132:135], v[36:39], v[64:67]
    ds_read_b128 v[108:111], v152 offset:36992
    s_waitcnt lgkmcnt(5)
    v_mfma_f32_16x16x32_bf16 v[64:67], v[136:139], v[40:43], v[64:67]
    ds_read_b128 v[112:115], v153 offset:36992
    s_waitcnt lgkmcnt(5)
    v_mfma_f32_16x16x32_bf16 v[64:67], v[140:143], v[44:47], v[64:67]
    ds_read_b128 v[116:119], v152 offset:37120
    s_waitcnt lgkmcnt(5)
    v_mfma_f32_16x16x32_bf16 v[64:67], v[144:147], v[48:51], v[64:67]
    ds_read_b128 v[120:123], v153 offset:37120
    s_waitcnt lgkmcnt(5)
    v_mfma_f32_16x16x32_bf16 v[68:71], v[100:103], v[28:31], 0
    ds_read_b128 v[124:127], v152 offset:43008
    s_waitcnt lgkmcnt(5)
    v_mfma_f32_16x16x32_bf16 v[68:71], v[104:107], v[32:35], v[68:71]
    ds_read_b128 v[128:131], v153 offset:43008
    s_waitcnt lgkmcnt(5)
    v_mfma_f32_16x16x32_bf16 v[68:71], v[108:111], v[36:39], v[68:71]
    ds_read_b128 v[132:135], v152 offset:43136
    s_waitcnt lgkmcnt(5)
    v_mfma_f32_16x16x32_bf16 v[68:71], v[112:115], v[40:43], v[68:71]
    ds_read_b128 v[136:139], v153 offset:43136
    s_waitcnt lgkmcnt(5)
    v_mfma_f32_16x16x32_bf16 v[68:71], v[116:119], v[44:47], v[68:71]
    ds_read_b128 v[140:143], v152 offset:43264
    s_waitcnt lgkmcnt(5)
    v_mfma_f32_16x16x32_bf16 v[68:71], v[120:123], v[48:51], v[68:71]
    ds_read_b128 v[144:147], v153 offset:43264
    s_waitcnt lgkmcnt(5)
    v_mfma_f32_16x16x32_bf16 v[72:75], v[124:127], v[28:31], 0
    ds_read_b128 v[100:103], v152 offset:49152
    s_waitcnt lgkmcnt(5)
    v_mfma_f32_16x16x32_bf16 v[72:75], v[128:131], v[32:35], v[72:75]
    ds_read_b128 v[104:107], v153 offset:49152
    s_waitcnt lgkmcnt(5)
    v_mfma_f32_16x16x32_bf16 v[72:75], v[132:135], v[36:39], v[72:75]
    ds_read_b128 v[108:111], v152 offset:49280
    s_waitcnt lgkmcnt(5)
    v_mfma_f32_16x16x32_bf16 v[72:75], v[136:139], v[40:43], v[72:75]
    ds_read_b128 v[112:115], v153 offset:49280
    s_waitcnt lgkmcnt(5)
    v_mfma_f32_16x16x32_bf16 v[72:75], v[140:143], v[44:47], v[72:75]
    ds_read_b128 v[116:119], v152 offset:49408
    s_waitcnt lgkmcnt(5)
    v_mfma_f32_16x16x32_bf16 v[72:75], v[144:147], v[48:51], v[72:75]
    ds_read_b128 v[120:123], v153 offset:49408
    s_waitcnt lgkmcnt(5)
    v_mfma_f32_16x16x32_bf16 v[76:79], v[100:103], v[28:31], 0
    ds_read_b128 v[124:127], v152 offset:55296
    s_waitcnt lgkmcnt(5)
    v_mfma_f32_16x16x32_bf16 v[76:79], v[104:107], v[32:35], v[76:79]
    ds_read_b128 v[128:131], v153 offset:55296
    s_waitcnt lgkmcnt(5)
    v_mfma_f32_16x16x32_bf16 v[76:79], v[108:111], v[36:39], v[76:79]
    ds_read_b128 v[132:135], v152 offset:55424
    s_waitcnt lgkmcnt(5)
    v_mfma_f32_16x16x32_bf16 v[76:79], v[112:115], v[40:43], v[76:79]
    ds_read_b128 v[136:139], v153 offset:55424
    s_waitcnt lgkmcnt(5)
    v_mfma_f32_16x16x32_bf16 v[76:79], v[116:119], v[44:47], v[76:79]
    ds_read_b128 v[140:143], v152 offset:55552
    s_waitcnt lgkmcnt(5)
    v_mfma_f32_16x16x32_bf16 v[76:79], v[120:123], v[48:51], v[76:79]
    ds_read_b128 v[144:147], v153 offset:55552
    s_nop 6
L_spin85:
    ds_read_b32 v148, v150 offset:6956
    s_waitcnt lgkmcnt(0)
    v_readfirstlane_b32 s40, v148
    s_nop 0
    s_cmp_ge_u32 s40, 3
    s_cbranch_scc1 L_spun86
    s_sleep 1
    s_branch L_spin85
L_spun86:
    s_waitcnt lgkmcnt(5)
    v_mfma_f32_16x16x32_bf16 v[80:83], v[124:127], v[28:31], 0
    ds_read_b128 v[100:103], v154
    s_waitcnt lgkmcnt(5)
    v_mfma_f32_16x16x32_bf16 v[80:83], v[128:131], v[32:35], v[80:83]
    ds_read_b128 v[104:107], v155
    s_waitcnt lgkmcnt(5)
    v_mfma_f32_16x16x32_bf16 v[80:83], v[132:135], v[36:39], v[80:83]
    ds_read_b128 v[108:111], v154 offset:128
    s_waitcnt lgkmcnt(5)
    v_mfma_f32_16x16x32_bf16 v[80:83], v[136:139], v[40:43], v[80:83]
    ds_read_b128 v[112:115], v155 offset:128
    s_waitcnt lgkmcnt(5)
    v_mfma_f32_16x16x32_bf16 v[80:83], v[140:143], v[44:47], v[80:83]
    ds_read_b128 v[116:119], v154 offset:256
    s_waitcnt lgkmcnt(5)
    v_mfma_f32_16x16x32_bf16 v[80:83], v[144:147], v[48:51], v[80:83]
    ds_read_b128 v[120:123], v155 offset:256
    s_waitcnt lgkmcnt(5)
    v_mfma_f32_16x16x32_bf16 v[84:87], v[100:103], v[28:31], 0
    ds_read_b128 v[124:127], v154 offset:6144
    s_waitcnt lgkmcnt(5)
    v_mfma_f32_16x16x32_bf16 v[84:87], v[104:107], v[32:35], v[84:87]
    ds_read_b128 v[128:131], v155 offset:6144
    s_waitcnt lgkmcnt(5)
    v_mfma_f32_16x16x32_bf16 v[84:87], v[108:111], v[36:39], v[84:87]
    ds_read_b128 v[132:135], v154 offset:6272
    s_waitcnt lgkmcnt(5)
    v_mfma_f32_16x16x32_bf16 v[84:87], v[112:115], v[40:43], v[84:87]
    ds_read_b128 v[136:139], v155 offset:6272
    s_waitcnt lgkmcnt(5)
    v_mfma_f32_16x16x32_bf16 v[84:87], v[116:119], v[44:47], v[84:87]
    ds_read_b128 v[140:143], v154 offset:6400
    s_waitcnt lgkmcnt(5)
    v_mfma_f32_16x16x32_bf16 v[84:87], v[120:123], v[48:51], v[84:87]
    ds_read_b128 v[144:147], v155 offset:6400
    s_waitcnt lgkmcnt(5)
    v_mfma_f32_16x16x32_bf16 v[88:91], v[124:127], v[28:31], 0
    ds_read_b128 v[100:103], v154 offset:12288
    s_waitcnt lgkmcnt(5)
    v_mfma_f32_16x16x32_bf16 v[88:91], v[128:131], v[32:35], v[88:91]
    ds_read_b128 v[104:107], v155 offset:12288
    s_waitcnt lgkmcnt(5)
    v_mfma_f32_16x16x32_bf16 v[88:91], v[132:135], v[36:39], v[88:91]
    ds_read_b128 v[108:111], v154 offset:12416
    s_waitcnt lgkmcnt(5)
    v_mfma_f32_16x16x32_bf16 v[88:91], v[136:139], v[40:43], v[88:91]
    ds_read_b128 v[112:115], v155 offset:12416
    s_waitcnt lgkmcnt(5)
    v_mfma_f32_16x16x32_bf16 v[88:91], v[140:143], v[44:47], v[88:91]
    ds_read_b128 v[116:119], v154 offset:12544
    s_waitcnt lgkmcnt(5)
    v_mfma_f32_16x16x32_bf16 v[88:91], v[144:147], v[48:51], v[88:91]
    ds_read_b128 v[120:123], v155 offset:12544
    s_waitcnt lgkmcnt(5)
    v_mfma_f32_16x16x32_bf16 v[92:95], v[100:103], v[28:31], 0
    ds_read_b128 v[124:127], v154 offset:18432
    s_waitcnt lgkmcnt(5)
    v_mfma_f32_16x16x32_bf16 v[92:95], v[104:107], v[32:35], v[92:95]
    ds_read_b128 v[128:131], v155 offset:18432
    s_waitcnt lgkmcnt(5)
    v_mfma_f32_16x16x32_bf16 v[92:95], v[108:111], v[36:39], v[92:95]
    ds_read_b128 v[132:135], v154 offset:18560
    s_waitcnt lgkmcnt(5)
    v_mfma_f32_16x16x32_bf16 v[92:95], v[112:115], v[40:43], v[92:95]
    ds_read_b128 v[136:139], v155 offset:18560
    s_waitcnt lgkmcnt(5)
    v_mfma_f32_16x16x32_bf16 v[92:95], v[116:119], v[44:47], v[92:95]
    ds_read_b128 v[140:143], v154 offset:18688
    s_waitcnt lgkmcnt(5)
    v_mfma_f32_16x16x32_bf16 v[92:95], v[120:123], v[48:51], v[92:95]
    ds_read_b128 v[144:147], v155 offset:18688
    s_waitcnt lgkmcnt(5)
    v_mfma_f32_16x16x32_bf16 v[96:99], v[124:127], v[28:31], 0
    s_waitcnt lgkmcnt(4)
    s_waitcnt lgkmcnt(5)
    v_mfma_f32_16x16x32_bf16 v[96:99], v[128:131], v[32:35], v[96:99]
    s_waitcnt lgkmcnt(3)
    s_waitcnt lgkmcnt(5)
    v_mfma_f32_16x16x32_bf16 v[96:99], v[132:135], v[36:39], v[96:99]
    s_waitcnt lgkmcnt(2)
    s_waitcnt lgkmcnt(5)
    v_mfma_f32_16x16x32_bf16 v[96:99], v[136:139], v[40:43], v[96:99]
    s_waitcnt lgkmcnt(1)
    s_waitcnt lgkmcnt(5)
    v_mfma_f32_16x16x32_bf16 v[96:99], v[140:143], v[44:47], v[96:99]
    s_waitcnt lgkmcnt(0)
    s_waitcnt lgkmcnt(5)
    v_mfma_f32_16x16x32_bf16 v[96:99], v[144:147], v[48:51], v[96:99]
    v_mov_b32 v148, 1
    s_mov_b64 exec, 1
    ds_add_u32 v150, v148 offset:6952
    s_mov_b64 exec, -1
    v_pk_add_f32 v[158:159], v[52:53], v[56:57]
    v_pk_add_f32 v[160:161], v[54:55], v[58:59]
    v_pk_add_f32 v[158:159], v[158:159], v[60:61]
    v_pk_add_f32 v[160:161], v[160:161], v[62:63]
    v_pk_add_f32 v[158:159], v[158:159], v[64:65]
    v_pk_add_f32 v[160:161], v[160:161], v[66:67]
    v_pk_add_f32 v[158:159], v[158:159], v[68:69]
    v_pk_add_f32 v[160:161], v[160:161], v[70:71]
    v_pk_add_f32 v[158:159], v[158:159], v[72:73]
    v_pk_add_f32 v[160:161], v[160:161], v[74:75]
    v_pk_add_f32 v[158:159], v[158:159], v[76:77]
    v_pk_add_f32 v[160:161], v[160:161], v[78:79]
    v_pk_add_f32 v[158:159], v[158:159], v[80:81]
    v_pk_add_f32 v[160:161], v[160:161], v[82:83]
    v_pk_add_f32 v[158:159], v[158:159], v[84:85]
    v_pk_add_f32 v[160:161], v[160:161], v[86:87]
    v_pk_add_f32 v[158:159], v[158:159], v[88:89]
    v_pk_add_f32 v[160:161], v[160:161], v[90:91]
    v_pk_add_f32 v[158:159], v[158:159], v[92:93]
    v_pk_add_f32 v[160:161], v[160:161], v[94:95]
    v_pk_add_f32 v[158:159], v[158:159], v[96:97]
    v_pk_add_f32 v[160:161], v[160:161], v[98:99]
    v_pk_add_f32 v[158:159], v[158:159], v[160:161]
    v_add_f32 v158, v158, v159
    v_mov_b32 v148, v158
    v_mov_b32 v149, v158
    s_nop 1
    v_permlane32_swap_b32 v148, v149
    v_add_f32 v158, v148, v149
    v_mov_b32 v148, v158
    v_mov_b32 v149, v158
    s_nop 1
    v_permlane16_swap_b32 v148, v149
    v_add_f32 v158, v148, v149
    v_mul_f32 v158, s44, v158
    s_sub_u32 s40, s2, 3
    s_lshl_b32 s40, s40, 2
    s_add_u32 s40, s40, s3
    s_mul_i32 s40, s40, 0x1800
    s_add_u32 s40, s40, 0x540000
    v_lshlrev_b32 v148, 4, v0
    v_pk_add_f32 v[52:53], v[52:53], v[158:159] op_sel_hi:[1,0] neg_lo:[0,1] neg_hi:[0,1]
    v_cvt_pk_bf16_f32 v164, v52, v53
    v_pk_add_f32 v[54:55], v[54:55], v[158:159] op_sel_hi:[1,0] neg_lo:[0,1] neg_hi:[0,1]
    v_cvt_pk_bf16_f32 v165, v54, v55
    v_pk_add_f32 v[56:57], v[56:57], v[158:159] op_sel_hi:[1,0] neg_lo:[0,1] neg_hi:[0,1]
    v_cvt_pk_bf16_f32 v166, v56, v57
    v_pk_add_f32 v[58:59], v[58:59], v[158:159] op_sel_hi:[1,0] neg_lo:[0,1] neg_hi:[0,1]
    v_cvt_pk_bf16_f32 v167, v58, v59
    s_add_u32 s42, s40, 0
    buffer_store_dwordx4 v[164:167], v148, s[32:35], s42 offen sc1
    v_pk_add_f32 v[60:61], v[60:61], v[158:159] op_sel_hi:[1,0] neg_lo:[0,1] neg_hi:[0,1]
    v_cvt_pk_bf16_f32 v168, v60, v61
    v_pk_add_f32 v[62:63], v[62:63], v[158:159] op_sel_hi:[1,0] neg_lo:[0,1] neg_hi:[0,1]
    v_cvt_pk_bf16_f32 v169, v62, v63
    v_pk_add_f32 v[64:65], v[64:65], v[158:159] op_sel_hi:[1,0] neg_lo:[0,1] neg_hi:[0,1]
    v_cvt_pk_bf16_f32 v170, v64, v65
    v_pk_add_f32 v[66:67], v[66:67], v[158:159] op_sel_hi:[1,0] neg_lo:[0,1] neg_hi:[0,1]
    v_cvt_pk_bf16_f32 v171, v66, v67
    s_add_u32 s42, s40, 0x400
    buffer_store_dwordx4 v[168:171], v148, s[32:35], s42 offen sc1
    v_pk_add_f32 v[68:69], v[68:69], v[158:159] op_sel_hi:[1,0] neg_lo:[0,1] neg_hi:[0,1]
    v_cvt_pk_bf16_f32 v172, v68, v69
    v_pk_add_f32 v[70:71], v[70:71], v[158:159] op_sel_hi:[1,0] neg_lo:[0,1] neg_hi:[0,1]
    v_cvt_pk_bf16_f32 v173, v70, v71
    v_pk_add_f32 v[72:73], v[72:73], v[158:159] op_sel_hi:[1,0] neg_lo:[0,1] neg_hi:[0,1]
    v_cvt_pk_bf16_f32 v174, v72, v73
    v_pk_add_f32 v[74:75], v[74:75], v[158:159] op_sel_hi:[1,0] neg_lo:[0,1] neg_hi:[0,1]
    v_cvt_pk_bf16_f32 v175, v74, v75
    s_add_u32 s42, s40, 0x800
    buffer_store_dwordx4 v[172:175], v148, s[32:35], s42 offen sc1
    v_pk_add_f32 v[76:77], v[76:77], v[158:159] op_sel_hi:[1,0] neg_lo:[0,1] neg_hi:[0,1]
    v_cvt_pk_bf16_f32 v176, v76, v77
    v_pk_add_f32 v[78:79], v[78:79], v[158:159] op_sel_hi:[1,0] neg_lo:[0,1] neg_hi:[0,1]
    v_cvt_pk_bf16_f32 v177, v78, v79
    v_pk_add_f32 v[80:81], v[80:81], v[158:159] op_sel_hi:[1,0] neg_lo:[0,1] neg_hi:[0,1]
    v_cvt_pk_bf16_f32 v178, v80, v81
    v_pk_add_f32 v[82:83], v[82:83], v[158:159] op_sel_hi:[1,0] neg_lo:[0,1] neg_hi:[0,1]
    v_cvt_pk_bf16_f32 v179, v82, v83
    s_add_u32 s42, s40, 0xc00
    buffer_store_dwordx4 v[176:179], v148, s[32:35], s42 offen sc1
    v_pk_add_f32 v[84:85], v[84:85], v[158:159] op_sel_hi:[1,0] neg_lo:[0,1] neg_hi:[0,1]
    v_cvt_pk_bf16_f32 v180, v84, v85
    v_pk_add_f32 v[86:87], v[86:87], v[158:159] op_sel_hi:[1,0] neg_lo:[0,1] neg_hi:[0,1]
    v_cvt_pk_bf16_f32 v181, v86, v87
    v_pk_add_f32 v[88:89], v[88:89], v[158:159] op_sel_hi:[1,0] neg_lo:[0,1] neg_hi:[0,1]
    v_cvt_pk_bf16_f32 v182, v88, v89
    v_pk_add_f32 v[90:91], v[90:91], v[158:159] op_sel_hi:[1,0] neg_lo:[0,1] neg_hi:[0,1]
    v_cvt_pk_bf16_f32 v183, v90, v91
    s_add_u32 s42, s40, 0x1000
    buffer_store_dwordx4 v[180:183], v148, s[32:35], s42 offen sc1
    v_pk_add_f32 v[92:93], v[92:93], v[158:159] op_sel_hi:[1,0] neg_lo:[0,1] neg_hi:[0,1]
    v_cvt_pk_bf16_f32 v184, v92, v93
    v_pk_add_f32 v[94:95], v[94:95], v[158:159] op_sel_hi:[1,0] neg_lo:[0,1] neg_hi:[0,1]
    v_cvt_pk_bf16_f32 v185, v94, v95
    v_pk_add_f32 v[96:97], v[96:97], v[158:159] op_sel_hi:[1,0] neg_lo:[0,1] neg_hi:[0,1]
    v_cvt_pk_bf16_f32 v186, v96, v97
    v_pk_add_f32 v[98:99], v[98:99], v[158:159] op_sel_hi:[1,0] neg_lo:[0,1] neg_hi:[0,1]
    v_cvt_pk_bf16_f32 v187, v98, v99
    s_add_u32 s42, s40, 0x1400
    buffer_store_dwordx4 v[184:187], v148, s[32:35], s42 offen sc1
    s_waitcnt lgkmcnt(0)
    s_nop 1
    s_branch L_c_start
L_aux:
    s_sub_u32 s36, s3, 5
    v_mov_b32 v11, 0
    v_and_b32 v1, 15, v0
    v_lshrrev_b32 v2, 4, v0
    v_lshlrev_b32 v12, 4, v0
    v_mov_b32 v16, -1
    v_mov_b32 v17, -1
    v_mov_b32 v18, -1
    v_mov_b32 v19, -1
    s_waitcnt lgkmcnt(0)
    s_mov_b32 s32, s22
    s_mov_b32 s33, s23
    s_mov_b32 s34, 0x1000000
    s_mov_b32 s35, 0x20000
    s_cmp_ge_u32 s2, 3
    s_cbranch_scc1 L_aux_noinv0
    s_cmp_lg_u32 s36, 1
    s_cbranch_scc1 L_aux_noinv0
    s_lshl_b32 s38, s2, 11
    s_add_u32 s38, s38, 0x500000
    buffer_store_dwordx4 v[16:19], v12, s[32:35], s38 offen sc1
    buffer_store_dwordx4 v[16:19], v12, s[32:35], s38 offen offset:1024 sc1
    s_memrealtime s[52:53]
    s_waitcnt lgkmcnt(0)
    s_mul_i32 s54, s52, 0x9e3779b1
    s_mov_b32 s55, s53
    s_lshr_b64 s[56:57], s[54:55], 0
    s_lshl_b32 s39, s56, 1
    s_and_b32 s39, s39, 0xfffe
    v_mov_b32 v20, s39
    s_lshr_b64 s[56:57], s[54:55], 15
    s_lshl_b32 s39, s56, 1
    s_and_b32 s39, s39, 0xfffe
    v_mov_b32 v21, s39
    s_lshr_b64 s[56:57], s[54:55], 30
    s_lshl_b32 s39, s56, 1
    s_and_b32 s39, s39, 0xfffe
    v_mov_b32 v22, s39
    s_mul_i32 s39, s54, 0x85ebca6b
    s_lshr_b32 s39, s39, 16
    s_and_b32 s39, s39, 0xfffe
    v_mov_b32 v23, s39
    s_lshl_b32 s38, s2, 7
    s_add_u32 s38, s38, 0x501800
    s_mov_b64 exec, 1
    buffer_store_dwordx4 v[20:23], v11, s[32:35], s38 offen sc1
    s_mov_b64 exec, -1
L_aux_noinv0:
    s_barrier
    s_mov_b32 s44, s20
    s_mov_b32 s45, s21
    s_mov_b32 s46, 0x100
    s_mov_b32 s47, 0x20000
    s_cmp_ge_u32 s2, 3
    s_cbranch_scc1 L_aux_noinv
    s_cmp_lg_u32 s36, 1
    s_cbranch_scc1 L_aux_noinv
    v_mov_b32 v14, 1
    s_lshl_b32 s38, s2, 5
    s_waitcnt vmcnt(0)
    ds_write_b32 v11, v14 offset:6960
    s_mov_b64 exec, 1
    buffer_store_dword v14, v11, s[44:47], s38 offen sc1
    s_mov_b64 exec, -1
    s_nop 2
L_aux_noinv:
    s_cmp_lt_u32 s2, 3
    s_cselect_b32 s39, 40, 0
    v_mov_b32 v15, s39
    s_cmp_lg_u32 s36, 0
    s_cbranch_scc1 L_aux_w
    v_mul_u32_u24 v14, 0x180, v1
    v_and_b32 v16, 1, v2
    v_lshl_add_u32 v14, v16, 3, v14
    v_lshrrev_b32 v16, 1, v2
    v_and_b32 v13, 6, v1
    v_xor_b32 v16, v16, v13
    v_xor_b32 v13, 0, v16
    v_lshl_add_u32 v232, v13, 4, v14
    v_xor_b32 v13, 2, v16
    v_lshl_add_u32 v233, v13, 4, v14
    v_xor_b32 v13, 4, v16
    v_lshl_add_u32 v234, v13, 4, v14
    v_xor_b32 v13, 6, v16
    v_lshl_add_u32 v235, v13, 4, v14
    v_lshlrev_b32 v13, 5, v0
    s_cmp_lt_u32 s2, 6
    s_cselect_b32 s38, 1, 3
L_spin87:
    ds_read_b32 v14, v15 offset:6912
    s_waitcnt lgkmcnt(0)
    v_readfirstlane_b32 s37, v14
    s_nop 0
    s_cmp_ge_u32 s37, s38
    s_cbranch_scc1 L_spun88
    s_sleep 4
    s_branch L_spin87
L_spun88:
    s_mov_b64 exec, 7
L_qpoll:
    buffer_load_dword v14, v13, s[44:47], 0 offen sc1
    s_waitcnt vmcnt(0)
    v_cmp_eq_u32 vcc, 0, v14
    s_cbranch_vccz L_qpolled
    s_sleep 8
    s_branch L_qpoll
L_qpolled:
    s_mov_b64 exec, -1
    s_cmp_lt_u32 s2, 6
    s_cselect_b32 s38, 3, 6
    s_cmp_lt_u32 s2, 3
    s_cselect_b32 s38, 4, s38
L_spin89:
    ds_read_b32 v14, v15 offset:6912
    s_waitcnt lgkmcnt(0)
    v_readfirstlane_b32 s37, v14
    s_nop 0
    s_cmp_ge_u32 s37, s38
    s_cbranch_scc1 L_spun90
    s_sleep 2
    s_branch L_spin89
L_spun90:
    s_mov_b32 s38, 0x501800
    buffer_load_dwordx4 v[236:239], v11, s[32:35], s38 offen sc1
L_qdata:
    s_mov_b32 s38, 0x500000
    buffer_load_dwordx4 v[208:211], v12, s[32:35], s38 offen sc1
    s_mov_b32 s38, 0x500400
    buffer_load_dwordx4 v[212:215], v12, s[32:35], s38 offen sc1
    s_mov_b32 s38, 0x500800
    buffer_load_dwordx4 v[216:219], v12, s[32:35], s38 offen sc1
    s_mov_b32 s38, 0x500c00
    buffer_load_dwordx4 v[220:223], v12, s[32:35], s38 offen sc1
    s_mov_b32 s38, 0x501000
    buffer_load_dwordx4 v[224:227], v12, s[32:35], s38 offen sc1
    s_mov_b32 s38, 0x501400
    buffer_load_dwordx4 v[228:231], v12, s[32:35], s38 offen sc1
    s_waitcnt vmcnt(0)
    v_max3_u32 v14, v208, v209, v210
    v_max3_u32 v14, v14, v211, v212
    v_max3_u32 v14, v14, v213, v214
    v_max3_u32 v14, v14, v215, v216
    v_max3_u32 v14, v14, v217, v218
    v_max3_u32 v14, v14, v219, v220
    v_max3_u32 v14, v14, v221, v222
    v_max3_u32 v14, v14, v223, v224
    v_max3_u32 v14, v14, v225, v226
    v_max3_u32 v14, v14, v227, v228
    v_max3_u32 v14, v14, v229, v230
    v_max_u32 v14, v14, v231
    v_cmp_eq_u32 vcc, -1, v14
    s_cbranch_vccnz L_qdata
    ds_write_b128 v11, v[236:239] offset:7040
    ds_write_b64 v232, v[208:209]
    ds_write_b64 v233, v[210:211]
    ds_write_b64 v234, v[212:213]
    ds_write_b64 v235, v[214:215]
    ds_write_b64 v232, v[216:217] offset:128
    ds_write_b64 v233, v[218:219] offset:128
    ds_write_b64 v234, v[220:221] offset:128
    ds_write_b64 v235, v[222:223] offset:128
    ds_write_b64 v232, v[224:225] offset:256
    ds_write_b64 v233, v[226:227] offset:256
    ds_write_b64 v234, v[228:229] offset:256
    ds_write_b64 v235, v[230:231] offset:256
    v_mov_b32 v14, 1
    ds_write_b32 v11, v14 offset:6944
    s_nop 0
L_aux_w:
    s_cmp_lg_u32 s36, 2
    s_cbranch_scc1 L_aux_wf2
    v_lshlrev_b32 v13, 2, v0
    s_nop 1
L_spin91:
    ds_read_b32 v14, v11 offset:6912
    s_waitcnt lgkmcnt(0)
    v_readfirstlane_b32 s37, v14
    s_nop 0
    s_cmp_ge_u32 s37, 10
    s_cbranch_scc1 L_spun92
    s_sleep 8
    s_branch L_spin91
L_spun92:
L_spin93:
    ds_read_b32 v14, v11 offset:6944
    s_waitcnt lgkmcnt(0)
    v_readfirstlane_b32 s37, v14
    s_nop 0
    s_cmp_ge_u32 s37, 1
    s_cbranch_scc1 L_spun94
    s_sleep 8
    s_branch L_spin93
L_spun94:
    s_mov_b64 exec, 0xfff
L_wpoll:
    buffer_load_dword v14, v13, s[44:47], 0 offen offset:80 sc1
    s_waitcnt vmcnt(0)
    v_cmp_eq_u32 vcc, 0, v14
    s_cbranch_vccz L_wpolled
    s_sleep 16
    s_branch L_wpoll
L_wpolled:
    s_mov_b64 exec, -1
    v_mov_b32 v14, 1
    ds_write_b32 v11, v14 offset:6976
    s_nop 0
L_aux_wf2:
L_spin95:
    ds_read_b32 v14, v11 offset:6976
    s_waitcnt lgkmcnt(0)
    v_readfirstlane_b32 s37, v14
    s_nop 0
    s_cmp_ge_u32 s37, 1
    s_cbranch_scc1 L_spun96
    s_sleep 8
    s_branch L_spin95
L_spun96:
    s_mul_i32 s37, s36, 0x4800
    s_add_u32 s37, s37, 0x540000
    s_add_u32 s38, s37, 0
    buffer_load_dwordx4 v[112:115], v12, s[32:35], s38 offen sc1
    s_add_u32 s38, s37, 0x400
    buffer_load_dwordx4 v[124:127], v12, s[32:35], s38 offen sc1
    s_add_u32 s38, s37, 0x800
    buffer_load_dwordx4 v[136:139], v12, s[32:35], s38 offen sc1
    s_waitcnt vmcnt(0)
    s_add_u32 s38, s37, 0xc00
    buffer_load_dwordx4 v[148:151], v12, s[32:35], s38 offen sc1
    s_add_u32 s38, s37, 0x1000
    buffer_load_dwordx4 v[160:163], v12, s[32:35], s38 offen sc1
    s_add_u32 s38, s37, 0x1400
    buffer_load_dwordx4 v[172:175], v12, s[32:35], s38 offen sc1
    s_waitcnt vmcnt(0)
    s_add_u32 s38, s37, 0x1800
    buffer_load_dwordx4 v[116:119], v12, s[32:35], s38 offen sc1
    s_add_u32 s38, s37, 0x1c00
    buffer_load_dwordx4 v[128:131], v12, s[32:35], s38 offen sc1
    s_add_u32 s38, s37, 0x2000
    buffer_load_dwordx4 v[140:143], v12, s[32:35], s38 offen sc1
    s_waitcnt vmcnt(0)
    s_add_u32 s38, s37, 0x2400
    buffer_load_dwordx4 v[152:155], v12, s[32:35], s38 offen sc1
    s_add_u32 s38, s37, 0x2800
    buffer_load_dwordx4 v[164:167], v12, s[32:35], s38 offen sc1
    s_add_u32 s38, s37, 0x2c00
    buffer_load_dwordx4 v[176:179], v12, s[32:35], s38 offen sc1
    s_waitcnt vmcnt(0)
    s_add_u32 s38, s37, 0x3000
    buffer_load_dwordx4 v[120:123], v12, s[32:35], s38 offen sc1
    s_add_u32 s38, s37, 0x3400
    buffer_load_dwordx4 v[132:135], v12, s[32:35], s38 offen sc1
    s_add_u32 s38, s37, 0x3800
    buffer_load_dwordx4 v[144:147], v12, s[32:35], s38 offen sc1
    s_waitcnt vmcnt(0)
    s_add_u32 s38, s37, 0x3c00
    buffer_load_dwordx4 v[156:159], v12, s[32:35], s38 offen sc1
    s_add_u32 s38, s37, 0x4000
    buffer_load_dwordx4 v[168:171], v12, s[32:35], s38 offen sc1
    s_add_u32 s38, s37, 0x4400
    buffer_load_dwordx4 v[180:183], v12, s[32:35], s38 offen sc1
    s_waitcnt vmcnt(0)
L_tail:
    v_lshlrev_b32 v6, 4, v1
    v_add_u32 v2, 0x3400, v12
    v_add_u32 v3, 0x15400, v12
    v_add_u32 v4, 0x6400, v6
    v_add_u32 v5, 0x18400, v6
    s_lshl_b32 s49, s2, 13
    s_lshl_b32 s38, s36, 11
    s_add_u32 s49, s49, s38
    s_mov_b32 s51, 0x42200000
    v_and_b32 v8, 3, v1
    v_lshlrev_b32 v8, 2, v8
    ds_read_b32 v200, v8 offset:7040
    s_nop 0
L_spin97:
    ds_read_b32 v15, v11 offset:6992
    s_waitcnt lgkmcnt(0)
    v_readfirstlane_b32 s37, v15
    s_nop 0
    s_cmp_ge_u32 s37, 1
    s_cbranch_scc1 L_spun98
    s_sleep 1
    s_branch L_spin97
L_spun98:
    ds_read_b128 v[48:51], v2
    ds_read_b128 v[52:55], v2 offset:1024
    ds_read_b128 v[56:59], v2 offset:2048
    ds_read_b128 v[60:63], v2 offset:3072
    ds_read_b128 v[64:67], v2 offset:4096
    ds_read_b128 v[68:71], v2 offset:5120
    ds_read_b128 v[72:75], v4
    s_cmp_eq_u32 s37, 2
    s_cbranch_scc1 L_agen
    s_waitcnt vmcnt(0)
    s_waitcnt lgkmcnt(6)
    v_mfma_f32_16x16x32_bf16 v[16:19], v[112:115], v[48:51], 0
    ds_read_b32 v108, v11 offset:6996
    v_mfma_f32_16x16x32_bf16 v[20:23], v[116:119], v[48:51], 0
    ds_read_b128 v[80:83], v2 offset:36864
    v_mfma_f32_16x16x32_bf16 v[24:27], v[120:123], v[48:51], 0
    ds_read_b128 v[84:87], v2 offset:37888
    s_waitcnt lgkmcnt(8)
    v_mfma_f32_16x16x32_bf16 v[16:19], v[124:127], v[52:55], v[16:19]
    ds_read_b128 v[88:91], v2 offset:38912
    v_mfma_f32_16x16x32_bf16 v[20:23], v[128:131], v[52:55], v[20:23]
    ds_read_b128 v[92:95], v2 offset:39936
    v_mfma_f32_16x16x32_bf16 v[24:27], v[132:135], v[52:55], v[24:27]
    ds_read_b128 v[96:99], v2 offset:40960
    s_waitcnt lgkmcnt(6)
    v_mfma_f32_16x16x32_bf16 v[16:19], v[136:139], v[56:59], v[16:19]
    ds_read_b128 v[100:103], v2 offset:41984
    v_mfma_f32_16x16x32_bf16 v[20:23], v[140:143], v[56:59], v[20:23]
    ds_read_b128 v[104:107], v4 offset:36864
    v_mfma_f32_16x16x32_bf16 v[24:27], v[144:147], v[56:59], v[24:27]
    v_add_f32 v72, v72, v73
    v_mfma_f32_16x16x32_bf16 v[16:19], v[148:151], v[60:63], v[16:19]
    v_add_f32 v74, v74, v75
    v_mfma_f32_16x16x32_bf16 v[20:23], v[152:155], v[60:63], v[20:23]
    v_add_f32 v7, v72, v74
    v_mfma_f32_16x16x32_bf16 v[24:27], v[156:159], v[60:63], v[24:27]
    v_mfma_f32_16x16x32_bf16 v[16:19], v[160:163], v[64:67], v[16:19]
    v_mfma_f32_16x16x32_bf16 v[20:23], v[164:167], v[64:67], v[20:23]
    v_mfma_f32_16x16x32_bf16 v[24:27], v[168:171], v[64:67], v[24:27]
    s_waitcnt lgkmcnt(0)
    v_readfirstlane_b32 s37, v108
    v_mfma_f32_16x16x32_bf16 v[16:19], v[172:175], v[68:71], v[16:19]
    v_mfma_f32_16x16x32_bf16 v[20:23], v[176:179], v[68:71], v[20:23]
    s_cmp_eq_u32 s37, 1
    v_mfma_f32_16x16x32_bf16 v[24:27], v[180:183], v[68:71], v[24:27]
    s_cbranch_scc1 L_bo100
    s_branch L_bt99x
L_bt99:
    s_waitcnt lgkmcnt(0)
    v_readfirstlane_b32 s37, v108
    s_nop 0
    s_cmp_eq_u32 s37, 1
    s_cbranch_scc1 L_bo100
L_bt99x:
    s_cmp_eq_u32 s37, 2
    s_cbranch_scc1 L_agen
    ds_read_b32 v108, v11 offset:6996
    ds_read_b128 v[80:83], v2 offset:36864
    ds_read_b128 v[84:87], v2 offset:37888
    ds_read_b128 v[88:91], v2 offset:38912
    ds_read_b128 v[92:95], v2 offset:39936
    ds_read_b128 v[96:99], v2 offset:40960
    ds_read_b128 v[100:103], v2 offset:41984
    ds_read_b128 v[104:107], v4 offset:36864
    s_branch L_bt99
L_bo100:
    v_mfma_f32_16x16x32_bf16 v[16:19], v[112:115], v[80:83], v[16:19]
    ds_read_b32 v76, v11 offset:7000
    v_mfma_f32_16x16x32_bf16 v[20:23], v[116:119], v[80:83], v[20:23]
    ds_read_b128 v[48:51], v3
    v_mfma_f32_16x16x32_bf16 v[24:27], v[120:123], v[80:83], v[24:27]
    ds_read_b128 v[52:55], v3 offset:1024
    v_mfma_f32_16x16x32_bf16 v[16:19], v[124:127], v[84:87], v[16:19]
    ds_read_b128 v[56:59], v3 offset:2048
    v_mfma_f32_16x16x32_bf16 v[20:23], v[128:131], v[84:87], v[20:23]
    ds_read_b128 v[60:63], v3 offset:3072
    v_mfma_f32_16x16x32_bf16 v[24:27], v[132:135], v[84:87], v[24:27]
    ds_read_b128 v[64:67], v3 offset:4096
    v_mfma_f32_16x16x32_bf16 v[16:19], v[136:139], v[88:91], v[16:19]
    ds_read_b128 v[68:71], v3 offset:5120
    v_mfma_f32_16x16x32_bf16 v[20:23], v[140:143], v[88:91], v[20:23]
    ds_read_b128 v[72:75], v5
    v_mfma_f32_16x16x32_bf16 v[24:27], v[144:147], v[88:91], v[24:27]
    v_add_f32 v104, v104, v105
    v_mfma_f32_16x16x32_bf16 v[16:19], v[148:151], v[92:95], v[16:19]
    v_add_f32 v106, v106, v107
    v_mfma_f32_16x16x32_bf16 v[20:23], v[152:155], v[92:95], v[20:23]
    v_add_f32 v104, v104, v106
    v_mfma_f32_16x16x32_bf16 v[24:27], v[156:159], v[92:95], v[24:27]
    v_add_f32 v7, v7, v104
    v_mfma_f32_16x16x32_bf16 v[16:19], v[160:163], v[96:99], v[16:19]
    v_mfma_f32_16x16x32_bf16 v[20:23], v[164:167], v[96:99], v[20:23]
    v_mfma_f32_16x16x32_bf16 v[24:27], v[168:171], v[96:99], v[24:27]
    s_waitcnt lgkmcnt(0)
    v_readfirstlane_b32 s37, v76
    v_mfma_f32_16x16x32_bf16 v[16:19], v[172:175], v[100:103], v[16:19]
    v_mfma_f32_16x16x32_bf16 v[20:23], v[176:179], v[100:103], v[20:23]
    s_cmp_eq_u32 s37, 1
    v_mfma_f32_16x16x32_bf16 v[24:27], v[180:183], v[100:103], v[24:27]
    s_cbranch_scc1 L_bo102
    s_branch L_bt101x
L_bt101:
    s_waitcnt lgkmcnt(0)
    v_readfirstlane_b32 s37, v76
    s_nop 0
    s_cmp_eq_u32 s37, 1
    s_cbranch_scc1 L_bo102
L_bt101x:
    s_cmp_eq_u32 s37, 2
    s_cbranch_scc1 L_agen
    ds_read_b32 v76, v11 offset:7000
    ds_read_b128 v[48:51], v3
    ds_read_b128 v[52:55], v3 offset:1024
    ds_read_b128 v[56:59], v3 offset:2048
    ds_read_b128 v[60:63], v3 offset:3072
    ds_read_b128 v[64:67], v3 offset:4096
    ds_read_b128 v[68:71], v3 offset:5120
    ds_read_b128 v[72:75], v5
    s_branch L_bt101
L_bo102:
    v_mfma_f32_16x16x32_bf16 v[16:19], v[112:115], v[48:51], v[16:19]
    ds_read_b32 v108, v11 offset:7004
    v_mfma_f32_16x16x32_bf16 v[20:23], v[116:119], v[48:51], v[20:23]
    ds_read_b128 v[80:83], v3 offset:36864
    v_mfma_f32_16x16x32_bf16 v[24:27], v[120:123], v[48:51], v[24:27]
    ds_read_b128 v[84:87], v3 offset:37888
    v_mfma_f32_16x16x32_bf16 v[16:19], v[124:127], v[52:55], v[16:19]
    ds_read_b128 v[88:91], v3 offset:38912
    v_mfma_f32_16x16x32_bf16 v[20:23], v[128:131], v[52:55], v[20:23]
    ds_read_b128 v[92:95], v3 offset:39936
    v_mfma_f32_16x16x32_bf16 v[24:27], v[132:135], v[52:55], v[24:27]
    ds_read_b128 v[96:99], v3 offset:40960
    v_mfma_f32_16x16x32_bf16 v[16:19], v[136:139], v[56:59], v[16:19]
    ds_read_b128 v[100:103], v3 offset:41984
    v_mfma_f32_16x16x32_bf16 v[20:23], v[140:143], v[56:59], v[20:23]
    ds_read_b128 v[104:107], v5 offset:36864
    v_mfma_f32_16x16x32_bf16 v[24:27], v[144:147], v[56:59], v[24:27]
    v_add_f32 v72, v72, v73
    v_mfma_f32_16x16x32_bf16 v[16:19], v[148:151], v[60:63], v[16:19]
    v_add_f32 v74, v74, v75
    v_mfma_f32_16x16x32_bf16 v[20:23], v[152:155], v[60:63], v[20:23]
    v_add_f32 v72, v72, v74
    v_mfma_f32_16x16x32_bf16 v[24:27], v[156:159], v[60:63], v[24:27]
    v_add_f32 v7, v7, v72
    v_mfma_f32_16x16x32_bf16 v[16:19], v[160:163], v[64:67], v[16:19]
    v_mfma_f32_16x16x32_bf16 v[20:23], v[164:167], v[64:67], v[20:23]
    v_mfma_f32_16x16x32_bf16 v[24:27], v[168:171], v[64:67], v[24:27]
    s_waitcnt lgkmcnt(0)
    v_readfirstlane_b32 s37, v108
    v_mfma_f32_16x16x32_bf16 v[16:19], v[172:175], v[68:71], v[16:19]
    v_mfma_f32_16x16x32_bf16 v[20:23], v[176:179], v[68:71], v[20:23]
    s_cmp_eq_u32 s37, 1
    v_mfma_f32_16x16x32_bf16 v[24:27], v[180:183], v[68:71], v[24:27]
    s_cbranch_scc1 L_bo104
    s_branch L_bt103x
L_bt103:
    s_waitcnt lgkmcnt(0)
    v_readfirstlane_b32 s37, v108
    s_nop 0
    s_cmp_eq_u32 s37, 1
    s_cbranch_scc1 L_bo104
L_bt103x:
    s_cmp_eq_u32 s37, 2
    s_cbranch_scc1 L_agen
    ds_read_b32 v108, v11 offset:7004
    ds_read_b128 v[80:83], v3 offset:36864
    ds_read_b128 v[84:87], v3 offset:37888
    ds_read_b128 v[88:91], v3 offset:38912
    ds_read_b128 v[92:95], v3 offset:39936
    ds_read_b128 v[96:99], v3 offset:40960
    ds_read_b128 v[100:103], v3 offset:41984
    ds_read_b128 v[104:107], v5 offset:36864
    s_branch L_bt103
L_bo104:
    v_mfma_f32_16x16x32_bf16 v[16:19], v[112:115], v[80:83], v[16:19]
    v_add_f32 v104, v104, v105
    v_mfma_f32_16x16x32_bf16 v[20:23], v[116:119], v[80:83], v[20:23]
    v_add_f32 v106, v106, v107
    v_mfma_f32_16x16x32_bf16 v[16:19], v[124:127], v[84:87], v[16:19]
    v_add_f32 v104, v104, v106
    v_mfma_f32_16x16x32_bf16 v[20:23], v[128:131], v[84:87], v[20:23]
    v_add_f32 v7, v7, v104
    v_mfma_f32_16x16x32_bf16 v[16:19], v[136:139], v[88:91], v[16:19]
    v_cvt_pk_bf16_f32 v8, 0, v7
    v_mfma_f32_16x16x32_bf16 v[20:23], v[140:143], v[88:91], v[20:23]
    v_or_b32 v195, v8, v200
    v_mfma_f32_16x16x32_bf16 v[16:19], v[148:151], v[92:95], v[16:19]
    v_or_b32 v199, v8, v200
    v_mfma_f32_16x16x32_bf16 v[20:23], v[152:155], v[92:95], v[20:23]
    v_mfma_f32_16x16x32_bf16 v[16:19], v[160:163], v[96:99], v[16:19]
    v_mfma_f32_16x16x32_bf16 v[20:23], v[164:167], v[96:99], v[20:23]
    v_mfma_f32_16x16x32_bf16 v[16:19], v[172:175], v[100:103], v[16:19]
    v_mfma_f32_16x16x32_bf16 v[20:23], v[176:179], v[100:103], v[20:23]
    v_mfma_f32_16x16x32_bf16 v[24:27], v[120:123], v[80:83], v[24:27]
    v_mfma_f32_16x16x32_bf16 v[24:27], v[132:135], v[84:87], v[24:27]
    v_mfma_f32_16x16x32_bf16 v[24:27], v[144:147], v[88:91], v[24:27]
    s_nop 2
    s_nop 0
    v_cvt_pk_bf16_f32 v192, v16, v17
    v_cvt_pk_bf16_f32 v193, v18, v19
    v_mfma_f32_16x16x32_bf16 v[24:27], v[156:159], v[92:95], v[24:27]
    v_cvt_pk_bf16_f32 v194, v20, v21
    buffer_store_dwordx4 v[192:195], v12, s[32:35], s49 offen sc1
    v_mfma_f32_16x16x32_bf16 v[24:27], v[168:171], v[96:99], v[24:27]
    v_cvt_pk_bf16_f32 v196, v22, v23
    v_mfma_f32_16x16x32_bf16 v[24:27], v[180:183], v[100:103], v[24:27]
    s_nop 7
    v_cvt_pk_bf16_f32 v197, v24, v25
    v_cvt_pk_bf16_f32 v198, v26, v27
    buffer_store_dwordx4 v[196:199], v12, s[32:35], s49 offen offset:1024 sc1
L_aend:
    v_mov_b32 v15, 1
    s_mov_b64 exec, 1
    ds_add_u32 v11, v15 offset:6964
    s_mov_b64 exec, -1
    s_endpgm
L_agen:
    s_waitcnt vmcnt(0)
L_spin105:
    ds_read_b32 v15, v11 offset:6992
    s_waitcnt lgkmcnt(0)
    v_readfirstlane_b32 s37, v15
    s_nop 0
    s_cmp_ge_u32 s37, 1
    s_cbranch_scc1 L_spun106
    s_sleep 1
    s_branch L_spin105
L_spun106:
    v_add_u32 v3, 0x6400, v6
    ds_read_b32 v205, v3 offset:512
    s_waitcnt lgkmcnt(0)
    v_mov_b32 v9, v205
    s_nop 1
L_spin107:
    ds_read_b32 v15, v11 offset:6996
    s_waitcnt lgkmcnt(0)
    v_readfirstlane_b32 s37, v15
    s_nop 0
    s_cmp_ge_u32 s37, 1
    s_cbranch_scc1 L_spun108
    s_sleep 1
    s_branch L_spin107
L_spun108:
    v_add_u32 v3, 0xf400, v6
    ds_read_b32 v205, v3 offset:512
    s_waitcnt lgkmcnt(0)
    v_max_f32 v9, v9, v205
    s_nop 1
L_spin109:
    ds_read_b32 v15, v11 offset:7000
    s_waitcnt lgkmcnt(0)
    v_readfirstlane_b32 s37, v15
    s_nop 0
    s_cmp_ge_u32 s37, 1
    s_cbranch_scc1 L_spun110
    s_sleep 1
    s_branch L_spin109
L_spun110:
    v_add_u32 v3, 0x18400, v6
    ds_read_b32 v205, v3 offset:512
    s_waitcnt lgkmcnt(0)
    v_max_f32 v9, v9, v205
    s_nop 1
L_spin111:
    ds_read_b32 v15, v11 offset:7004
    s_waitcnt lgkmcnt(0)
    v_readfirstlane_b32 s37, v15
    s_nop 0
    s_cmp_ge_u32 s37, 1
    s_cbranch_scc1 L_spun112
    s_sleep 1
    s_branch L_spin111
L_spun112:
    v_add_u32 v3, 0x21400, v6
    ds_read_b32 v205, v3 offset:512
    s_waitcnt lgkmcnt(0)
    v_max_f32 v9, v9, v205
    v_cmp_nlt_f32_e64 s[56:57], |v9|, s51
    s_nop 1
    v_cndmask_b32 v10, 0, v9, s[56:57]
    v_mov_b32 v7, 0
    v_mov_b32 v16, 0
    v_mov_b32 v17, 0
    v_mov_b32 v18, 0
    v_mov_b32 v19, 0
    v_mov_b32 v20, 0
    v_mov_b32 v21, 0
    v_mov_b32 v22, 0
    v_mov_b32 v23, 0
    v_mov_b32 v24, 0
    v_mov_b32 v25, 0
    v_mov_b32 v26, 0
    v_mov_b32 v27, 0
    s_mov_b32 s58, 0
    s_nop 0
L_agen_w:
    s_mul_i32 s59, s58, 0x9000
    s_add_u32 s59, s59, 0x3400
    v_add_u32 v2, s59, v12
    v_add_u32 v3, s59, v6
    ds_read_b128 v[48:51], v2
    ds_read_b128 v[52:55], v2 offset:1024
    ds_read_b128 v[56:59], v2 offset:2048
    ds_read_b128 v[60:63], v2 offset:3072
    ds_read_b128 v[64:67], v2 offset:4096
    ds_read_b128 v[68:71], v2 offset:5120
    ds_read_b32 v205, v3 offset:12800
    ds_read_b128 v[72:75], v3 offset:12288
    s_waitcnt lgkmcnt(0)
    v_mfma_f32_16x16x32_bf16 v[32:35], v[112:115], v[48:51], 0
    v_mfma_f32_16x16x32_bf16 v[36:39], v[116:119], v[48:51], 0
    v_mfma_f32_16x16x32_bf16 v[40:43], v[120:123], v[48:51], 0
    v_mfma_f32_16x16x32_bf16 v[32:35], v[124:127], v[52:55], v[32:35]
    v_mfma_f32_16x16x32_bf16 v[36:39], v[128:131], v[52:55], v[36:39]
    v_mfma_f32_16x16x32_bf16 v[40:43], v[132:135], v[52:55], v[40:43]
    v_mfma_f32_16x16x32_bf16 v[32:35], v[136:139], v[56:59], v[32:35]
    v_mfma_f32_16x16x32_bf16 v[36:39], v[140:143], v[56:59], v[36:39]
    v_mfma_f32_16x16x32_bf16 v[40:43], v[144:147], v[56:59], v[40:43]
    v_mfma_f32_16x16x32_bf16 v[32:35], v[148:151], v[60:63], v[32:35]
    v_mfma_f32_16x16x32_bf16 v[36:39], v[152:155], v[60:63], v[36:39]
    v_mfma_f32_16x16x32_bf16 v[40:43], v[156:159], v[60:63], v[40:43]
    v_mfma_f32_16x16x32_bf16 v[32:35], v[160:163], v[64:67], v[32:35]
    v_mfma_f32_16x16x32_bf16 v[36:39], v[164:167], v[64:67], v[36:39]
    v_mfma_f32_16x16x32_bf16 v[40:43], v[168:171], v[64:67], v[40:43]
    v_mfma_f32_16x16x32_bf16 v[32:35], v[172:175], v[68:71], v[32:35]
    v_mfma_f32_16x16x32_bf16 v[36:39], v[176:179], v[68:71], v[36:39]
    v_mfma_f32_16x16x32_bf16 v[40:43], v[180:183], v[68:71], v[40:43]
    v_sub_f32 v14, v205, v10
    v_exp_f32 v13, v14
    v_add_f32 v72, v72, v73
    v_add_f32 v74, v74, v75
    v_add_f32 v72, v72, v74
    v_fmac_f32 v7, v13, v72
    v_fmac_f32 v16, v13, v32
    v_fmac_f32 v17, v13, v33
    v_fmac_f32 v18, v13, v34
    v_fmac_f32 v19, v13, v35
    v_fmac_f32 v20, v13, v36
    v_fmac_f32 v21, v13, v37
    v_fmac_f32 v22, v13, v38
    v_fmac_f32 v23, v13, v39
    v_fmac_f32 v24, v13, v40
    v_fmac_f32 v25, v13, v41
    v_fmac_f32 v26, v13, v42
    v_fmac_f32 v27, v13, v43
    s_add_u32 s58, s58, 1
    s_cmp_lt_u32 s58, 4
    s_cbranch_scc1 L_agen_w
    v_cndmask_b32 v14, 0, 1, s[56:57]
    v_or_b32 v200, v200, v14
    ds_read_b64 v[74:75], v11 offset:7040
    v_mov_b32 v72, v10
    v_lshrrev_b32 v14, 1, v6
    s_lshl_b32 s38, s2, 7
    s_add_u32 s38, s38, 0x400000
    s_waitcnt lgkmcnt(0)
    v_lshl_or_b32 v73, v75, 16, v74
    s_mov_b64 exec, 0xffff
    buffer_store_dwordx2 v[72:73], v14, s[32:35], s38 offen sc1
    s_mov_b64 exec, -1
    v_cvt_pk_bf16_f32 v8, 0, v7
    v_or_b32 v195, v8, v200
    v_or_b32 v199, v8, v200
    v_cvt_pk_bf16_f32 v192, v16, v17
    v_cvt_pk_bf16_f32 v193, v18, v19
    v_cvt_pk_bf16_f32 v194, v20, v21
    buffer_store_dwordx4 v[192:195], v12, s[32:35], s49 offen sc1
    v_cvt_pk_bf16_f32 v196, v22, v23
    v_cvt_pk_bf16_f32 v197, v24, v25
    v_cvt_pk_bf16_f32 v198, v26, v27
    buffer_store_dwordx4 v[196:199], v12, s[32:35], s49 offen offset:1024 sc1
    s_nop 1
    s_branch L_aend
L_exit:
    s_endpgm
L_code_end:
.section .rodata,"a"
.p2align 6
.amdhsa_kernel standalone__detection_seg_dino__vision_kernel
  .amdhsa_next_free_vgpr 256
  .amdhsa_next_free_sgpr 96
  .amdhsa_accum_offset 256
  .amdhsa_group_segment_fixed_size 0
  .amdhsa_kernarg_size 80
  .amdhsa_user_sgpr_count 2
  .amdhsa_user_sgpr_kernarg_segment_ptr 1
  .amdhsa_system_sgpr_workgroup_id_x 1
  .amdhsa_float_denorm_mode_32 3
.end_amdhsa_kernel
```

```asm
; @launch grid=(256,1,1) block=(512,1,1) lds=160768
.amdgcn_target "amdgcn-amd-amdhsa--gfx950"
.text
.globl standalone__detection_seg_dino__vision_kernel
.p2align 8
.type standalone__detection_seg_dino__vision_kernel,@function
standalone__detection_seg_dino__vision_kernel:
    s_cmp_ge_u32 s2, 0x100
    s_cbranch_scc1 L_exit
    s_load_dwordx16 s[4:19], s[0:1], 0
    s_load_dwordx4 s[20:23], s[0:1], 64
    v_lshrrev_b32 v1, 6, v0
    v_and_b32 v0, 63, v0
    v_readfirstlane_b32 s3, v1
    s_nop 2
    s_cmp_lt_u32 s3, 4
    s_cbranch_scc1 L_compute
    s_cmp_gt_u32 s3, 4
    s_cbranch_scc1 L_aux0
    s_setprio 3
    v_add_u32 v4, 0, v0
    v_mul_u32_u24 v4, 0xaab, v4
    v_lshrrev_b32 v4, 16, v4
    v_and_b32 v11, 6, v4
    v_xor_b32 v11, v11, v0
    v_lshlrev_b32 v1, 4, v11
    v_add_u32 v5, 64, v0
    v_mul_u32_u24 v5, 0xaab, v5
    v_lshrrev_b32 v5, 16, v5
    v_and_b32 v11, 6, v5
    v_xor_b32 v11, v11, v0
    v_lshlrev_b32 v2, 4, v11
    v_add_u32 v6, 0x80, v0
    v_mul_u32_u24 v6, 0xaab, v6
    v_lshrrev_b32 v6, 16, v6
    v_and_b32 v11, 6, v6
    v_xor_b32 v11, v11, v0
    v_lshlrev_b32 v3, 4, v11
    s_and_b32 s38, s2, 7
    s_lshl_b32 s38, s38, 5
    s_lshr_b32 s45, s2, 3
    s_or_b32 s38, s38, s45
    s_lshl_b32 s38, s38, 2
    s_mov_b32 s27, 0x20000
    s_mov_b32 s26, 0x1800000
    s_mul_i32 s39, s38, 0x1800
    s_mov_b32 s44, 0x3400
    s_cmp_lt_u32 s2, 6
    s_cbranch_scc1 L_ld_prod
    s_waitcnt lgkmcnt(0)
    s_mov_b32 s24, s8
    s_mov_b32 s25, s9
L_ld_first:
    s_mov_b32 m0, s44
    s_add_u32 s46, s39, 0xc00
    buffer_load_dwordx4 v1, s[24:27], s39 offen nt lds
    buffer_load_dwordx4 v2, s[24:27], s39 offen offset:1024 nt lds
    buffer_load_dwordx4 v3, s[24:27], s39 offen offset:2048 nt lds
    s_add_u32 m0, s44, 0xc00
    s_add_u32 s44, s44, 0x9000
    buffer_load_dwordx4 v1, s[24:27], s46 offen nt lds
    buffer_load_dwordx4 v2, s[24:27], s46 offen offset:1024 nt lds
    buffer_load_dwordx4 v3, s[24:27], s46 offen offset:2048 nt lds
    s_add_u32 s39, s39, 0x1800
    s_cmp_lt_u32 s44, 0x27400
    s_cbranch_scc1 L_ld_first
    s_branch L_ld_norm
L_aux0:
    s_getpc_b64 s[24:25]
L_aux_pc:
    s_sub_u32 s24, s24, L_aux_pc-standalone__detection_seg_dino__vision_kernel
    s_subb_u32 s25, s25, 0
    s_mov_b32 s26, L_code_end-standalone__detection_seg_dino__vision_kernel
    s_mov_b32 s27, 0x20000
    s_lshr_b32 s39, s2, 3
    s_mul_i32 s38, s39, 3
    s_add_u32 s38, s38, s3
    s_mul_i32 s38, s38, 0x140
    s_sub_u32 s38, s38, 0x640
    v_lshlrev_b32 v14, 6, v0
    s_mov_b64 exec, 31
    buffer_load_dword v253, v14, s[24:27], s38 offen
    s_mov_b64 exec, -1
    s_and_b32 s38, s2, 7
    s_mul_i32 s37, s3, 3
    s_add_u32 s38, s38, 18
    s_sub_u32 s38, s38, s37
    s_cmp_ge_u32 s38, 3
    s_cbranch_scc1 L_aux
    s_mul_i32 s37, s39, 0x900
    v_mul_u32_u24 v13, 36, v0
    s_mov_b32 s30, 0x12000
    s_mov_b32 s42, 0x12000
    s_mov_b32 s31, s27
    s_mov_b32 s43, s27
    s_cmp_eq_u32 s3, 6
    s_waitcnt lgkmcnt(0)
    s_cselect_b64 s[28:29], s[10:11], s[16:17]
    s_cselect_b64 s[40:41], s[12:13], s[14:15]
    buffer_load_dword v254, v13, s[28:31], s37 offen
    buffer_load_dword v255, v13, s[40:43], s37 offen
    s_branch L_aux
L_ld_prod:
    s_mov_b32 s39, 0
    s_cmp_lt_u32 s2, 3
    s_cbranch_scc0 L_ld_wo0
    s_mov_b32 s26, 0x1800
    s_mov_b32 s44, 0x1c00
    s_mov_b32 s48, 1
    s_waitcnt lgkmcnt(0)
    s_mov_b64 s[24:25], s[4:5]
    s_call_b64 s[54:55], L_ld_tiles
    s_branch L_ld_wq
L_ld_tiles:
    s_mov_b32 m0, s44
    s_add_u32 s46, s39, 0xc00
    buffer_load_dwordx4 v1, s[24:27], s39 offen lds
    buffer_load_dwordx4 v2, s[24:27], s39 offen offset:1024 lds
    buffer_load_dwordx4 v3, s[24:27], s39 offen offset:2048 lds
    s_add_u32 m0, s44, 0xc00
    s_add_u32 s44, s44, 0x1800
    buffer_load_dwordx4 v1, s[24:27], s46 offen lds
    buffer_load_dwordx4 v2, s[24:27], s46 offen offset:1024 lds
    buffer_load_dwordx4 v3, s[24:27], s46 offen offset:2048 lds
    s_add_u32 s39, s39, 0x1800
    s_sub_u32 s48, s48, 1
    s_and_b32 s45, s48, 3
    s_cselect_b32 s45, 0, 0x3000
    s_add_u32 s44, s44, s45
    s_cmp_lg_u32 s48, 0
    s_cbranch_scc1 L_ld_tiles
    s_setpc_b64 s[54:55]
L_ld_wq:
    s_mov_b64 s[24:25], s[10:11]
    s_mov_b32 s26, 0x12000
L_ld_w12:
    s_mov_b32 s39, 0
    s_mov_b32 s44, 0x6400
    s_mov_b32 s48, 4
    s_call_b64 s[54:55], L_ld_tiles
    v_mul_u32_u24 v4, 0x180, v4
    v_add_u32 v4, v4, v1
    v_mul_u32_u24 v5, 0x180, v5
    v_add_u32 v5, v5, v2
    v_mul_u32_u24 v6, 0x180, v6
    v_add_u32 v6, v6, v3
    v_mov_b32 v10, 0
    v_lshlrev_b32 v13, 2, v0
    s_mov_b64 exec, 0xffffffff
    ds_write_b32 v13, v10 offset:6912
    v_mov_b32 v11, 0x3f803f80
    s_mov_b64 exec, 3
    ds_write_b32 v13, v11 offset:7056
    s_mov_b64 exec, -1
    s_mov_b32 s50, 0
    s_mov_b32 s51, 0
    s_mov_b32 s52, 0
    s_mov_b32 s53, 0
    s_mov_b32 s36, 0
    s_mov_b32 s37, 0
    s_mov_b32 s57, 0
    s_waitcnt lgkmcnt(0)
    s_barrier
    s_waitcnt vmcnt(24)
    v_mov_b32 v11, 1
    s_mov_b64 exec, 1
    ds_max_u32 v10, v11 offset:6956
    s_mov_b64 exec, -1
    s_mov_b32 s48, 8
    s_call_b64 s[54:55], L_ld_tiles
    s_cmp_ge_u32 s2, 3
    s_cbranch_scc1 L_ld_w3
    s_mov_b64 s[24:25], s[12:13]
    s_mul_i32 s39, s2, 0x6000
    s_mov_b32 s48, 4
    s_call_b64 s[54:55], L_ld_tiles
L_ld_w3:
    s_waitcnt vmcnt(24)
    v_mov_b32 v11, 2
    s_mov_b64 exec, 1
    ds_max_u32 v10, v11 offset:6956
    s_mov_b64 exec, -1
    s_branch L_ld_stepp
L_ld_wo0:
    s_mov_b32 s26, 0x12000
    v_lshrrev_b32 v11, 3, v0
    v_mul_u32_u24 v11, 0x180, v11
    v_and_b32 v12, 7, v0
    v_lshl_add_u32 v11, v12, 4, v11
    s_sub_u32 s46, s2, 3
    s_lshl_b32 s46, s46, 7
    s_mov_b32 s45, 0x21400
    s_waitcnt lgkmcnt(0)
    s_mov_b64 s[24:25], s[16:17]
L_ld_wo:
    s_mov_b32 m0, s45
    s_add_u32 s45, s45, 0x400
    buffer_load_dwordx4 v11, s[24:27], s46 offen lds
    s_add_u32 s46, s46, 0xc00
    s_cmp_lt_u32 s45, 0x27400
    s_cbranch_scc1 L_ld_wo
    s_mov_b64 s[24:25], s[14:15]
    s_branch L_ld_w12
L_ld_norm:
    v_mul_u32_u24 v4, 0x180, v4
    v_add_u32 v4, v4, v1
    v_mul_u32_u24 v5, 0x180, v5
    v_add_u32 v5, v5, v2
    v_mul_u32_u24 v6, 0x180, v6
    v_add_u32 v6, v6, v3
    v_mov_b32 v10, 0
    v_lshlrev_b32 v13, 2, v0
    s_mov_b64 exec, 0xffffffff
    ds_write_b32 v13, v10 offset:6912
    v_mov_b32 v11, 0x3f803f80
    s_mov_b64 exec, 3
    ds_write_b32 v13, v11 offset:7056
    s_mov_b64 exec, -1
    s_mov_b32 s50, 0
    s_mov_b32 s51, 0
    s_mov_b32 s52, 0
    s_mov_b32 s53, 0
    s_mov_b32 s36, 1
    s_mov_b32 s37, 1
    s_mov_b32 s57, 1
    s_lshr_b32 s45, s38, 4
    s_mul_i32 s40, s45, 0x60000
    s_and_b32 s45, s38, 15
    s_mul_i32 s45, s45, 0x3000
    s_add_u32 s40, s40, s45
    s_add_u32 s38, s38, 0x400
    s_waitcnt lgkmcnt(0)
    s_barrier
L_ld_step:
    s_cmp_lg_u32 s37, 0
    s_cbranch_scc1 L_ld_fine
    s_mul_i32 s39, s38, 0x1800
    s_lshr_b32 s45, s38, 4
    s_mul_i32 s40, s45, 0x60000
    s_and_b32 s45, s38, 15
    s_mul_i32 s45, s45, 0x3000
    s_add_u32 s40, s40, s45
    s_add_u32 s38, s38, 0x400
    s_mov_b32 s24, s8
    s_mov_b32 s25, s9
    s_mov_b32 s26, 0x1800000
    s_mov_b32 s41, s39
    s_mov_b32 s42, 0x1800
    s_mov_b32 s43, 0xc00
    v_mov_b32 v7, v1
    v_mov_b32 v8, v2
    v_mov_b32 v9, v3
    s_branch L_ld_issue
L_ld_fine:
    s_mov_b32 s24, s6
    s_mov_b32 s25, s7
    s_mov_b32 s26, 0x6000000
    s_sub_u32 s45, s37, 1
    s_lshr_b32 s46, s45, 1
    s_mul_i32 s46, s46, 0x30000
    s_and_b32 s45, s45, 1
    s_mul_i32 s45, s45, 0x180
    s_add_u32 s41, s40, s46
    s_add_u32 s41, s41, s45
    s_mov_b32 s42, 0x3000
    s_mov_b32 s43, 0x1800
    v_mov_b32 v7, v4
    v_mov_b32 v8, v5
    v_mov_b32 v9, v6
L_ld_issue:
    s_mul_i32 s44, s57, 0x1800
    s_add_u32 s44, s44, 0x3400
    s_sub_i32 s48, s36, 5
    s_cmp_ge_i32 s50, s48
    s_cbranch_scc1 L_free1
    s_mov_b32 s56, 0
    s_call_b64 s[54:55], L_ld_wait
    s_mov_b32 s50, s45
L_free1:
    s_add_u32 m0, s44, 0
    s_mov_b32 s46, s41
    buffer_load_dwordx4 v7, s[24:27], s46 offen nt lds
    buffer_load_dwordx4 v8, s[24:27], s46 offen offset:1024 nt lds
    buffer_load_dwordx4 v9, s[24:27], s46 offen offset:2048 nt lds
    s_add_u32 m0, s44, 0xc00
    s_add_u32 s46, s41, s43
    buffer_load_dwordx4 v7, s[24:27], s46 offen nt lds
    buffer_load_dwordx4 v8, s[24:27], s46 offen offset:1024 nt lds
    buffer_load_dwordx4 v9, s[24:27], s46 offen offset:2048 nt lds
    s_add_u32 s41, s41, s42
    s_add_i32 s47, s36, 0
    s_max_i32 s47, s47, 0
    s_waitcnt vmcnt(24)
    v_mov_b32 v11, s47
    s_mov_b64 exec, 1
    ds_max_u32 v10, v11 offset:6912
    s_mov_b64 exec, -1
    s_cmp_ge_i32 s51, s48
    s_cbranch_scc1 L_free2
    s_mov_b32 s56, 1
    s_call_b64 s[54:55], L_ld_wait
    s_mov_b32 s51, s45
L_free2:
    s_add_u32 m0, s44, 0x9000
    s_mov_b32 s46, s41
    buffer_load_dwordx4 v7, s[24:27], s46 offen nt lds
    buffer_load_dwordx4 v8, s[24:27], s46 offen offset:1024 nt lds
    buffer_load_dwordx4 v9, s[24:27], s46 offen offset:2048 nt lds
    s_add_u32 m0, s44, 0x9c00
    s_add_u32 s46, s41, s43
    buffer_load_dwordx4 v7, s[24:27], s46 offen nt lds
    buffer_load_dwordx4 v8, s[24:27], s46 offen offset:1024 nt lds
    buffer_load_dwordx4 v9, s[24:27], s46 offen offset:2048 nt lds
    s_add_u32 s41, s41, s42
    s_add_i32 s47, s36, 0
    s_max_i32 s47, s47, 0
    s_waitcnt vmcnt(24)
    v_mov_b32 v11, s47
    s_mov_b64 exec, 1
    ds_max_u32 v10, v11 offset:6916
    s_mov_b64 exec, -1
    s_cmp_ge_i32 s52, s48
    s_cbranch_scc1 L_free3
    s_mov_b32 s56, 2
    s_call_b64 s[54:55], L_ld_wait
    s_mov_b32 s52, s45
L_free3:
    s_add_u32 m0, s44, 0x12000
    s_mov_b32 s46, s41
    buffer_load_dwordx4 v7, s[24:27], s46 offen nt lds
    buffer_load_dwordx4 v8, s[24:27], s46 offen offset:1024 nt lds
    buffer_load_dwordx4 v9, s[24:27], s46 offen offset:2048 nt lds
    s_add_u32 m0, s44, 0x12c00
    s_add_u32 s46, s41, s43
    buffer_load_dwordx4 v7, s[24:27], s46 offen nt lds
    buffer_load_dwordx4 v8, s[24:27], s46 offen offset:1024 nt lds
    buffer_load_dwordx4 v9, s[24:27], s46 offen offset:2048 nt lds
    s_add_u32 s41, s41, s42
    s_add_i32 s47, s36, 0
    s_max_i32 s47, s47, 0
    s_waitcnt vmcnt(24)
    v_mov_b32 v11, s47
    s_mov_b64 exec, 1
    ds_max_u32 v10, v11 offset:6920
    s_mov_b64 exec, -1
    s_cmp_ge_i32 s53, s48
    s_cbranch_scc1 L_free4
    s_mov_b32 s56, 3
    s_call_b64 s[54:55], L_ld_wait
    s_mov_b32 s53, s45
L_free4:
    s_add_u32 m0, s44, 0x1b000
    s_mov_b32 s46, s41
    buffer_load_dwordx4 v7, s[24:27], s46 offen nt lds
    buffer_load_dwordx4 v8, s[24:27], s46 offen offset:1024 nt lds
    buffer_load_dwordx4 v9, s[24:27], s46 offen offset:2048 nt lds
    s_add_u32 m0, s44, 0x1bc00
    s_add_u32 s46, s41, s43
    buffer_load_dwordx4 v7, s[24:27], s46 offen nt lds
    buffer_load_dwordx4 v8, s[24:27], s46 offen offset:1024 nt lds
    buffer_load_dwordx4 v9, s[24:27], s46 offen offset:2048 nt lds
    s_add_u32 s41, s41, s42
    s_add_i32 s47, s36, 0
    s_max_i32 s47, s47, 0
    s_waitcnt vmcnt(24)
    v_mov_b32 v11, s47
    s_mov_b64 exec, 1
    ds_max_u32 v10, v11 offset:6924
    s_mov_b64 exec, -1
    s_add_u32 s37, s37, 1
    s_cmp_eq_u32 s37, 5
    s_cselect_b32 s37, 0, s37
    s_add_u32 s57, s57, 1
    s_cmp_eq_u32 s57, 6
    s_cselect_b32 s57, 0, s57
    s_add_u32 s36, s36, 1
    s_cmp_lt_u32 s36, 20
    s_cbranch_scc1 L_ld_step
    s_mov_b32 s32, s22
    s_mov_b32 s33, s23
    s_mov_b32 s34, 0x1000000
    s_mov_b32 s35, 0x20000
    v_lshlrev_b32 v12, 4, v0
    s_nop 1
L_spin5:
    ds_read_b32 v11, v10 offset:6976
    s_waitcnt lgkmcnt(0)
    v_readfirstlane_b32 s45, v11
    s_nop 0
    s_cmp_ge_u32 s45, 1
    s_cbranch_scc1 L_spun6
    s_sleep 1
    s_branch L_spin5
L_spun6:
    s_mov_b32 s46, 0x1d800
    buffer_load_dwordx4 v[112:115], v12, s[32:35], s46 offen sc1
    s_mov_b32 s46, 0x1dc00
    buffer_load_dwordx4 v[124:127], v12, s[32:35], s46 offen sc1
    s_mov_b32 s46, 0x1e000
    buffer_load_dwordx4 v[136:139], v12, s[32:35], s46 offen sc1
    s_mov_b32 s46, 0x1e400
    buffer_load_dwordx4 v[148:151], v12, s[32:35], s46 offen sc1
    s_mov_b32 s46, 0x1e800
    buffer_load_dwordx4 v[160:163], v12, s[32:35], s46 offen sc1
    s_mov_b32 s46, 0x1ec00
    buffer_load_dwordx4 v[172:175], v12, s[32:35], s46 offen sc1
    s_mov_b32 s46, 0x1f000
    buffer_load_dwordx4 v[116:119], v12, s[32:35], s46 offen sc1
    s_mov_b32 s46, 0x1f400
    buffer_load_dwordx4 v[128:131], v12, s[32:35], s46 offen sc1
    s_mov_b32 s46, 0x1f800
    buffer_load_dwordx4 v[140:143], v12, s[32:35], s46 offen sc1
    s_mov_b32 s46, 0x1fc00
    buffer_load_dwordx4 v[152:155], v12, s[32:35], s46 offen sc1
    s_mov_b32 s46, 0x20000
    buffer_load_dwordx4 v[164:167], v12, s[32:35], s46 offen sc1
    s_mov_b32 s46, 0x20400
    buffer_load_dwordx4 v[176:179], v12, s[32:35], s46 offen sc1
    s_mov_b32 s46, 0x20800
    buffer_load_dwordx4 v[120:123], v12, s[32:35], s46 offen sc1
    s_mov_b32 s46, 0x20c00
    buffer_load_dwordx4 v[132:135], v12, s[32:35], s46 offen sc1
    s_mov_b32 s46, 0x21000
    buffer_load_dwordx4 v[144:147], v12, s[32:35], s46 offen sc1
    s_mov_b32 s46, 0x21400
    buffer_load_dwordx4 v[156:159], v12, s[32:35], s46 offen sc1
    s_mov_b32 s46, 0x21800
    buffer_load_dwordx4 v[168:171], v12, s[32:35], s46 offen sc1
    s_mov_b32 s46, 0x21c00
    buffer_load_dwordx4 v[180:183], v12, s[32:35], s46 offen sc1
    s_waitcnt vmcnt(36)
    v_mov_b32 v11, 20
    s_mov_b64 exec, 1
    ds_max_u32 v10, v11 offset:6912
    s_mov_b64 exec, -1
    s_waitcnt vmcnt(30)
    v_mov_b32 v11, 20
    s_mov_b64 exec, 1
    ds_max_u32 v10, v11 offset:6916
    s_mov_b64 exec, -1
    s_waitcnt vmcnt(24)
    v_mov_b32 v11, 20
    s_mov_b64 exec, 1
    ds_max_u32 v10, v11 offset:6920
    s_mov_b64 exec, -1
    s_waitcnt vmcnt(18)
    v_mov_b32 v11, 20
    s_mov_b64 exec, 1
    ds_max_u32 v10, v11 offset:6924
    s_mov_b64 exec, -1
    s_setprio 0
    s_mov_b32 s36, 3
    v_mov_b32 v11, 0
    v_and_b32 v1, 15, v0
    s_nop 1
    s_branch L_tail
L_ld_stepp:
    s_cmp_lg_u32 s37, 0
    s_cbranch_scc1 L_ld_finep
    s_mul_i32 s39, s38, 0x1800
    s_lshr_b32 s45, s38, 4
    s_mul_i32 s40, s45, 0x60000
    s_and_b32 s45, s38, 15
    s_mul_i32 s45, s45, 0x3000
    s_add_u32 s40, s40, s45
    s_add_u32 s38, s38, 0x400
    s_mov_b32 s24, s8
    s_mov_b32 s25, s9
    s_mov_b32 s26, 0x1800000
    s_mov_b32 s41, s39
    s_mov_b32 s42, 0x1800
    s_mov_b32 s43, 0xc00
    v_mov_b32 v7, v1
    v_mov_b32 v8, v2
    v_mov_b32 v9, v3
    s_branch L_ld_issuep
L_ld_finep:
    s_mov_b32 s24, s6
    s_mov_b32 s25, s7
    s_mov_b32 s26, 0x6000000
    s_sub_u32 s45, s37, 1
    s_lshr_b32 s46, s45, 1
    s_mul_i32 s46, s46, 0x30000
    s_and_b32 s45, s45, 1
    s_mul_i32 s45, s45, 0x180
    s_add_u32 s41, s40, s46
    s_add_u32 s41, s41, s45
    s_mov_b32 s42, 0x3000
    s_mov_b32 s43, 0x1800
    v_mov_b32 v7, v4
    v_mov_b32 v8, v5
    v_mov_b32 v9, v6
L_ld_issuep:
    s_mul_i32 s44, s57, 0x1800
    s_add_u32 s44, s44, 0x3400
    s_sub_i32 s48, s36, 5
    s_cmp_ge_i32 s50, s48
    s_cbranch_scc1 L_free7
    s_mov_b32 s56, 0
    s_call_b64 s[54:55], L_ld_wait
    s_mov_b32 s50, s45
L_free7:
    s_add_u32 m0, s44, 0
    s_mov_b32 s46, s41
    buffer_load_dwordx4 v7, s[24:27], s46 offen nt lds
    buffer_load_dwordx4 v8, s[24:27], s46 offen offset:1024 nt lds
    buffer_load_dwordx4 v9, s[24:27], s46 offen offset:2048 nt lds
    s_add_u32 m0, s44, 0xc00
    s_add_u32 s46, s41, s43
    buffer_load_dwordx4 v7, s[24:27], s46 offen nt lds
    buffer_load_dwordx4 v8, s[24:27], s46 offen offset:1024 nt lds
    buffer_load_dwordx4 v9, s[24:27], s46 offen offset:2048 nt lds
    s_add_u32 s41, s41, s42
    s_add_i32 s47, s36, -1
    s_max_i32 s47, s47, 0
    s_waitcnt vmcnt(36)
    v_mov_b32 v11, s47
    s_mov_b64 exec, 1
    ds_max_u32 v10, v11 offset:6920
    s_mov_b64 exec, -1
    s_cmp_ge_i32 s51, s48
    s_cbranch_scc1 L_free8
    s_mov_b32 s56, 1
    s_call_b64 s[54:55], L_ld_wait
    s_mov_b32 s51, s45
L_free8:
    s_add_u32 m0, s44, 0x9000
    s_mov_b32 s46, s41
    buffer_load_dwordx4 v7, s[24:27], s46 offen nt lds
    buffer_load_dwordx4 v8, s[24:27], s46 offen offset:1024 nt lds
    buffer_load_dwordx4 v9, s[24:27], s46 offen offset:2048 nt lds
    s_add_u32 m0, s44, 0x9c00
    s_add_u32 s46, s41, s43
    buffer_load_dwordx4 v7, s[24:27], s46 offen nt lds
    buffer_load_dwordx4 v8, s[24:27], s46 offen offset:1024 nt lds
    buffer_load_dwordx4 v9, s[24:27], s46 offen offset:2048 nt lds
    s_add_u32 s41, s41, s42
    s_add_i32 s47, s36, -1
    s_max_i32 s47, s47, 0
    s_waitcnt vmcnt(36)
    v_mov_b32 v11, s47
    s_mov_b64 exec, 1
    ds_max_u32 v10, v11 offset:6924
    s_mov_b64 exec, -1
    s_cmp_lg_u32 s36, 0
    s_cbranch_scc1 L_w39
    s_waitcnt vmcnt(12)
    v_mov_b32 v11, 3
    s_mov_b64 exec, 1
    ds_max_u32 v10, v11 offset:6956
    s_mov_b64 exec, -1
L_w39:
    s_cmp_ge_i32 s52, s48
    s_cbranch_scc1 L_free10
    s_mov_b32 s56, 2
    s_call_b64 s[54:55], L_ld_wait
    s_mov_b32 s52, s45
L_free10:
    s_add_u32 m0, s44, 0x12000
    s_mov_b32 s46, s41
    buffer_load_dwordx4 v7, s[24:27], s46 offen nt lds
    buffer_load_dwordx4 v8, s[24:27], s46 offen offset:1024 nt lds
    buffer_load_dwordx4 v9, s[24:27], s46 offen offset:2048 nt lds
    s_add_u32 m0, s44, 0x12c00
    s_add_u32 s46, s41, s43
    buffer_load_dwordx4 v7, s[24:27], s46 offen nt lds
    buffer_load_dwordx4 v8, s[24:27], s46 offen offset:1024 nt lds
    buffer_load_dwordx4 v9, s[24:27], s46 offen offset:2048 nt lds
    s_add_u32 s41, s41, s42
    s_add_i32 s47, s36, 0
    s_max_i32 s47, s47, 0
    s_waitcnt vmcnt(36)
    v_mov_b32 v11, s47
    s_mov_b64 exec, 1
    ds_max_u32 v10, v11 offset:6912
    s_mov_b64 exec, -1
    s_cmp_ge_i32 s53, s48
    s_cbranch_scc1 L_free11
    s_mov_b32 s56, 3
    s_call_b64 s[54:55], L_ld_wait
    s_mov_b32 s53, s45
L_free11:
    s_add_u32 m0, s44, 0x1b000
    s_mov_b32 s46, s41
    buffer_load_dwordx4 v7, s[24:27], s46 offen nt lds
    buffer_load_dwordx4 v8, s[24:27], s46 offen offset:1024 nt lds
    buffer_load_dwordx4 v9, s[24:27], s46 offen offset:2048 nt lds
    s_add_u32 m0, s44, 0x1bc00
    s_add_u32 s46, s41, s43
    buffer_load_dwordx4 v7, s[24:27], s46 offen nt lds
    buffer_load_dwordx4 v8, s[24:27], s46 offen offset:1024 nt lds
    buffer_load_dwordx4 v9, s[24:27], s46 offen offset:2048 nt lds
    s_add_u32 s41, s41, s42
    s_add_i32 s47, s36, 0
    s_max_i32 s47, s47, 0
    s_waitcnt vmcnt(36)
    v_mov_b32 v11, s47
    s_mov_b64 exec, 1
    ds_max_u32 v10, v11 offset:6916
    s_mov_b64 exec, -1
    s_add_u32 s37, s37, 1
    s_cmp_eq_u32 s37, 5
    s_cselect_b32 s37, 0, s37
    s_add_u32 s57, s57, 1
    s_cmp_eq_u32 s57, 6
    s_cselect_b32 s57, 0, s57
    s_cmp_lg_u32 s36, 1
    s_cbranch_scc1 L_ld_noiss
L_spin12:
    ds_read_b32 v11, v10 offset:6952
    s_waitcnt lgkmcnt(0)
    v_readfirstlane_b32 s45, v11
    s_nop 0
    s_cmp_ge_u32 s45, 4
    s_cbranch_scc1 L_spun13
    s_sleep 1
    s_branch L_spin12
L_spun13:
L_ld_noiss:
    s_add_u32 s36, s36, 1
    s_cmp_lt_u32 s36, 20
    s_nop 3
    s_cbranch_scc1 L_ld_stepp
    s_mov_b32 s32, s22
    s_mov_b32 s33, s23
    s_mov_b32 s34, 0x1000000
    s_mov_b32 s35, 0x20000
    v_lshlrev_b32 v12, 4, v0
    s_nop 1
L_spin14:
    ds_read_b32 v11, v10 offset:6976
    s_waitcnt lgkmcnt(0)
    v_readfirstlane_b32 s45, v11
    s_nop 0
    s_cmp_ge_u32 s45, 1
    s_cbranch_scc1 L_spun15
    s_sleep 1
    s_branch L_spin14
L_spun15:
    s_mov_b32 s46, 0x1d800
    buffer_load_dwordx4 v[112:115], v12, s[32:35], s46 offen sc1
    s_mov_b32 s46, 0x1dc00
    buffer_load_dwordx4 v[124:127], v12, s[32:35], s46 offen sc1
    s_mov_b32 s46, 0x1e000
    buffer_load_dwordx4 v[136:139], v12, s[32:35], s46 offen sc1
    s_mov_b32 s46, 0x1e400
    buffer_load_dwordx4 v[148:151], v12, s[32:35], s46 offen sc1
    s_mov_b32 s46, 0x1e800
    buffer_load_dwordx4 v[160:163], v12, s[32:35], s46 offen sc1
    s_mov_b32 s46, 0x1ec00
    buffer_load_dwordx4 v[172:175], v12, s[32:35], s46 offen sc1
    s_mov_b32 s46, 0x1f000
    buffer_load_dwordx4 v[116:119], v12, s[32:35], s46 offen sc1
    s_mov_b32 s46, 0x1f400
    buffer_load_dwordx4 v[128:131], v12, s[32:35], s46 offen sc1
    s_mov_b32 s46, 0x1f800
    buffer_load_dwordx4 v[140:143], v12, s[32:35], s46 offen sc1
    s_mov_b32 s46, 0x1fc00
    buffer_load_dwordx4 v[152:155], v12, s[32:35], s46 offen sc1
    s_mov_b32 s46, 0x20000
    buffer_load_dwordx4 v[164:167], v12, s[32:35], s46 offen sc1
    s_mov_b32 s46, 0x20400
    buffer_load_dwordx4 v[176:179], v12, s[32:35], s46 offen sc1
    s_mov_b32 s46, 0x20800
    buffer_load_dwordx4 v[120:123], v12, s[32:35], s46 offen sc1
    s_mov_b32 s46, 0x20c00
    buffer_load_dwordx4 v[132:135], v12, s[32:35], s46 offen sc1
    s_mov_b32 s46, 0x21000
    buffer_load_dwordx4 v[144:147], v12, s[32:35], s46 offen sc1
    s_mov_b32 s46, 0x21400
    buffer_load_dwordx4 v[156:159], v12, s[32:35], s46 offen sc1
    s_mov_b32 s46, 0x21800
    buffer_load_dwordx4 v[168:171], v12, s[32:35], s46 offen sc1
    s_mov_b32 s46, 0x21c00
    buffer_load_dwordx4 v[180:183], v12, s[32:35], s46 offen sc1
    s_waitcnt vmcnt(48)
    v_mov_b32 v11, 19
    s_mov_b64 exec, 1
    ds_max_u32 v10, v11 offset:6920
    s_mov_b64 exec, -1
    s_waitcnt vmcnt(42)
    v_mov_b32 v11, 19
    s_mov_b64 exec, 1
    ds_max_u32 v10, v11 offset:6924
    s_mov_b64 exec, -1
    s_waitcnt vmcnt(36)
    v_mov_b32 v11, 20
    s_mov_b64 exec, 1
    ds_max_u32 v10, v11 offset:6912
    s_mov_b64 exec, -1
    s_waitcnt vmcnt(30)
    v_mov_b32 v11, 20
    s_mov_b64 exec, 1
    ds_max_u32 v10, v11 offset:6916
    s_mov_b64 exec, -1
    s_waitcnt vmcnt(24)
    v_mov_b32 v11, 20
    s_mov_b64 exec, 1
    ds_max_u32 v10, v11 offset:6920
    s_mov_b64 exec, -1
    s_waitcnt vmcnt(18)
    v_mov_b32 v11, 20
    s_mov_b64 exec, 1
    ds_max_u32 v10, v11 offset:6924
    s_mov_b64 exec, -1
    s_setprio 0
    s_mov_b32 s36, 3
    v_mov_b32 v11, 0
    v_and_b32 v1, 15, v0
    s_nop 1
    s_branch L_tail
L_ld_wait:
    s_lshl_b32 s45, s56, 2
    v_mov_b32 v12, s45
    ds_read_b32 v11, v12 offset:6928
    s_waitcnt lgkmcnt(0)
    v_readfirstlane_b32 s45, v11
    s_nop 0
    s_cmp_ge_i32 s45, s48
    s_cbranch_scc1 L_ld_wait_ret
    s_nop 1
L_spin16:
    ds_read_b32 v11, v12 offset:6928
    s_waitcnt lgkmcnt(0)
    v_readfirstlane_b32 s45, v11
    s_nop 0
    s_cmp_ge_u32 s45, s48
    s_cbranch_scc1 L_spun17
    s_sleep 1
    s_branch L_spin16
L_spun17:
L_ld_wait_ret:
    s_setpc_b64 s[54:55]
L_compute:
    s_mul_i32 s36, s3, 0x9000
    s_add_u32 s36, s36, 0x3400
    s_setprio 1
    s_barrier
    v_and_b32 v228, 15, v0
    v_lshrrev_b32 v229, 4, v0
    v_and_b32 v230, 6, v228
    v_xor_b32 v230, v230, v229
    v_mul_u32_u24 v231, 0x180, v228
    v_add_u32 v231, s36, v231
    v_lshl_add_u32 v8, v230, 4, v231
    v_xor_b32 v230, 4, v230
    v_lshl_add_u32 v9, v230, 4, v231
    v_lshrrev_b32 v230, 2, v228
    v_and_b32 v231, 3, v228
    v_lshl_add_u32 v232, v229, 2, v230
    v_mul_u32_u24 v233, 0x180, v232
    v_lshl_add_u32 v233, v231, 3, v233
    v_add_u32 v233, s36, v233
    v_and_b32 v234, 6, v232
    v_xor_b32 v235, 0, v234
    v_lshl_add_u32 v10, v235, 4, v233
    v_xor_b32 v235, 2, v234
    v_lshl_add_u32 v11, v235, 4, v233
    v_xor_b32 v235, 4, v234
    v_lshl_add_u32 v12, v235, 4, v233
    v_xor_b32 v235, 6, v234
    v_lshl_add_u32 v13, v235, 4, v233
    v_subrev_u32 v244, s36, v8
    v_subrev_u32 v245, s36, v9
    v_mov_b32 v24, 0x3f803f80
    v_mov_b32 v240, 0
    v_mov_b32 v248, 0
    v_mov_b32 v25, 0x3f803f80
    v_mov_b32 v241, 0
    v_mov_b32 v249, 0
    v_mov_b32 v26, 0x3f803f80
    v_mov_b32 v242, 0
    v_mov_b32 v250, 0
    v_mov_b32 v27, 0x3f803f80
    v_mov_b32 v243, 0
    v_mov_b32 v251, 0
    v_mov_b32 v20, 1.0
    s_mov_b32 s44, 0x3baaaaab
    s_mov_b32 s46, 0x3727c5ac
    s_mov_b32 s58, 0xaaaaaaaa
    s_mov_b32 s60, 0xcccccccc
    s_mov_b32 s45, 0x3baaaaab
    s_mov_b32 s47, 0x3727c5ac
    s_mov_b32 s59, 0xaaaaaaaa
    s_mov_b32 s61, 0xcccccccc
    s_mov_b32 s38, 0xf0000f
    s_mov_b32 s39, 0xf0000f00
    s_mov_b32 s50, 0x42000000
    s_mov_b32 s41, 0
    s_mov_b32 s51, 0
    s_mov_b32 s52, 0
    s_mov_b32 s54, 0
    s_mov_b32 s56, 0x1800
    s_lshl_b32 s40, s3, 2
    v_mov_b32 v1, s40
    s_waitcnt lgkmcnt(0)
    s_mov_b32 s32, s22
    s_mov_b32 s33, s23
    s_mov_b32 s34, 0x1000000
    s_mov_b32 s35, 0x20000
    s_cmp_lt_u32 s2, 3
    s_cbranch_scc1 L_qkprod
    s_cmp_lt_u32 s2, 6
    s_cbranch_scc1 L_wvprod
L_c_start:
    s_add_u32 s51, s51, 1
    s_cmp_ge_u32 s52, s51
    s_cbranch_scc1 L_have18
L_spin19:
    ds_read_b32 v3, v1 offset:6912
    s_waitcnt lgkmcnt(0)
    v_readfirstlane_b32 s52, v3
    s_nop 0
    s_cmp_ge_u32 s52, s51
    s_cbranch_scc1 L_spun20
    s_sleep 1
    s_branch L_spin19
L_spun20:
L_have18:
    ds_read_b128 v[100:103], v8
    ds_read_b128 v[104:107], v9
    ds_read_b128 v[108:111], v8 offset:128
    ds_read_b128 v[112:115], v9 offset:128
    ds_read_b128 v[116:119], v8 offset:256
    ds_read_b128 v[120:123], v9 offset:256
    ds_read_b64_tr_b16 v[152:153], v10
    ds_read_b64_tr_b16 v[158:159], v11
    ds_read_b64_tr_b16 v[164:165], v12
    ds_read_b64_tr_b16 v[170:171], v13
    ds_read_b64_tr_b16 v[176:177], v10 offset:128
    ds_read_b64_tr_b16 v[182:183], v11 offset:128
    s_waitcnt lgkmcnt(11)
    v_mfma_f32_16x16x32_bf16 v[224:227], v[100:103], v[24:27], 0
    ds_read_b64_tr_b16 v[188:189], v12 offset:128
    s_waitcnt lgkmcnt(11)
    v_mfma_f32_16x16x32_bf16 v[224:227], v[104:107], v[24:27], v[224:227]
    ds_read_b64_tr_b16 v[194:195], v13 offset:128
    s_waitcnt lgkmcnt(11)
    v_mfma_f32_16x16x32_bf16 v[224:227], v[108:111], v[24:27], v[224:227]
    ds_read_b64_tr_b16 v[200:201], v10 offset:256
    s_waitcnt lgkmcnt(11)
    v_mfma_f32_16x16x32_bf16 v[224:227], v[112:115], v[24:27], v[224:227]
    ds_read_b64_tr_b16 v[206:207], v11 offset:256
    s_waitcnt lgkmcnt(11)
    v_mfma_f32_16x16x32_bf16 v[224:227], v[116:119], v[24:27], v[224:227]
    ds_read_b64_tr_b16 v[212:213], v12 offset:256
    s_waitcnt lgkmcnt(11)
    v_mfma_f32_16x16x32_bf16 v[224:227], v[120:123], v[24:27], v[224:227]
    ds_read_b64_tr_b16 v[218:219], v13 offset:256
    ds_read_b32 v3, v1 offset:6912
    s_add_u32 s54, s54, 1
    s_cmp_eq_u32 s54, 6
    s_cselect_b32 s55, 0xffff8800, s56
    s_cselect_b32 s54, 0, s54
    v_add_u32 v8, s55, v8
    v_add_u32 v9, s55, v9
    v_mov_b32 v2, s51
    v_add_u32 v10, s55, v10
    v_add_u32 v11, s55, v11
    v_add_u32 v12, s55, v12
    v_add_u32 v13, s55, v13
    s_waitcnt lgkmcnt(0)
    ds_write_b32 v1, v2 offset:6928
    v_dot2_f32_bf16 v22, v100, v100, 0
    v_dot2_f32_bf16 v23, v101, v101, 0
    v_dot2_f32_bf16 v22, v102, v102, v22
    v_dot2_f32_bf16 v23, v103, v103, v23
    v_dot2_f32_bf16 v22, v104, v104, v22
    v_dot2_f32_bf16 v23, v105, v105, v23
    v_dot2_f32_bf16 v22, v106, v106, v22
    v_dot2_f32_bf16 v23, v107, v107, v23
    v_dot2_f32_bf16 v22, v108, v108, v22
    v_dot2_f32_bf16 v23, v109, v109, v23
    v_dot2_f32_bf16 v22, v110, v110, v22
    v_dot2_f32_bf16 v23, v111, v111, v23
    v_dot2_f32_bf16 v22, v112, v112, v22
    v_dot2_f32_bf16 v23, v113, v113, v23
    v_dot2_f32_bf16 v22, v114, v114, v22
    v_dot2_f32_bf16 v23, v115, v115, v23
    v_dot2_f32_bf16 v22, v116, v116, v22
    v_dot2_f32_bf16 v23, v117, v117, v23
    v_dot2_f32_bf16 v22, v118, v118, v22
    v_dot2_f32_bf16 v23, v119, v119, v23
    v_dot2_f32_bf16 v22, v120, v120, v22
    v_dot2_f32_bf16 v23, v121, v121, v23
    v_dot2_f32_bf16 v22, v122, v122, v22
    v_dot2_f32_bf16 v23, v123, v123, v23
    s_nop 2
    v_add_f32 v255, v22, v23
    s_add_u32 s51, s51, 1
    s_cmp_ge_u32 s52, s51
    s_cbranch_scc1 L_have21
L_spin22:
    ds_read_b32 v3, v1 offset:6912
    s_waitcnt lgkmcnt(0)
    v_readfirstlane_b32 s52, v3
    s_nop 0
    s_cmp_ge_u32 s52, s51
    s_cbranch_scc1 L_spun23
    s_sleep 1
    s_branch L_spin22
L_spun23:
L_have21:
    ds_read_b128 v[124:127], v8
    ds_read_b128 v[128:131], v9
    ds_read_b128 v[132:135], v8 offset:128
    ds_read_b128 v[136:139], v9 offset:128
    ds_read_b128 v[140:143], v8 offset:256
    ds_read_b128 v[144:147], v9 offset:256
    s_waitcnt lgkmcnt(5)
    v_mfma_f32_16x16x32_bf16 v[232:235], v[124:127], v[24:27], v[224:227]
    ds_read_b64_tr_b16 v[148:149], v10
    ds_read_b64_tr_b16 v[154:155], v11
    s_waitcnt lgkmcnt(6)
    v_mfma_f32_16x16x32_bf16 v[232:235], v[128:131], v[24:27], v[232:235]
    ds_read_b64_tr_b16 v[160:161], v12
    ds_read_b64_tr_b16 v[166:167], v13
    ds_read_b64_tr_b16 v[172:173], v10 offset:128
    s_waitcnt lgkmcnt(8)
    v_mfma_f32_16x16x32_bf16 v[232:235], v[132:135], v[24:27], v[232:235]
    ds_read_b64_tr_b16 v[178:179], v11 offset:128
    ds_read_b64_tr_b16 v[184:185], v12 offset:128
    ds_read_b64_tr_b16 v[190:191], v13 offset:128
    s_waitcnt lgkmcnt(10)
    v_mfma_f32_16x16x32_bf16 v[232:235], v[136:139], v[24:27], v[232:235]
    ds_read_b64_tr_b16 v[196:197], v10 offset:256
    ds_read_b64_tr_b16 v[202:203], v11 offset:256
    s_waitcnt lgkmcnt(11)
    v_mfma_f32_16x16x32_bf16 v[232:235], v[140:143], v[24:27], v[232:235]
    ds_read_b64_tr_b16 v[208:209], v12 offset:256
    ds_read_b64_tr_b16 v[214:215], v13 offset:256
    s_waitcnt lgkmcnt(12)
    v_mfma_f32_16x16x32_bf16 v[232:235], v[144:147], v[24:27], v[232:235]
    ds_read_b32 v3, v1 offset:6912
    s_add_u32 s54, s54, 1
    s_cmp_eq_u32 s54, 6
    s_cselect_b32 s55, 0xffff8800, s56
    s_cselect_b32 s54, 0, s54
    v_add_u32 v8, s55, v8
    v_add_u32 v9, s55, v9
    v_mov_b32 v2, s51
    v_add_u32 v10, s55, v10
    v_add_u32 v11, s55, v11
    v_add_u32 v12, s55, v12
    v_add_u32 v13, s55, v13
    s_waitcnt lgkmcnt(0)
    ds_write_b32 v1, v2 offset:6928
    v_dot2_f32_bf16 v22, v124, v124, v255
    v_dot2_f32_bf16 v23, v124, v100, 0
    v_dot2_f32_bf16 v22, v125, v125, v22
    v_dot2_f32_bf16 v23, v125, v101, v23
    v_dot2_f32_bf16 v22, v126, v126, v22
    v_dot2_f32_bf16 v23, v126, v102, v23
    v_dot2_f32_bf16 v22, v127, v127, v22
    v_dot2_f32_bf16 v23, v127, v103, v23
    v_dot2_f32_bf16 v22, v128, v128, v22
    v_dot2_f32_bf16 v23, v128, v104, v23
    v_dot2_f32_bf16 v22, v129, v129, v22
    v_dot2_f32_bf16 v23, v129, v105, v23
    v_dot2_f32_bf16 v22, v130, v130, v22
    v_dot2_f32_bf16 v23, v130, v106, v23
    v_dot2_f32_bf16 v22, v131, v131, v22
    v_dot2_f32_bf16 v23, v131, v107, v23
    v_dot2_f32_bf16 v22, v132, v132, v22
    v_dot2_f32_bf16 v23, v132, v108, v23
    v_dot2_f32_bf16 v22, v133, v133, v22
    v_dot2_f32_bf16 v23, v133, v109, v23
    v_dot2_f32_bf16 v22, v134, v134, v22
    v_dot2_f32_bf16 v23, v134, v110, v23
    v_dot2_f32_bf16 v22, v135, v135, v22
    v_dot2_f32_bf16 v23, v135, v111, v23
    v_dot2_f32_bf16 v22, v136, v136, v22
    v_dot2_f32_bf16 v23, v136, v112, v23
    v_dot2_f32_bf16 v22, v137, v137, v22
    v_dot2_f32_bf16 v23, v137, v113, v23
    v_dot2_f32_bf16 v22, v138, v138, v22
    v_dot2_f32_bf16 v23, v138, v114, v23
    v_dot2_f32_bf16 v22, v139, v139, v22
    v_dot2_f32_bf16 v23, v139, v115, v23
    v_dot2_f32_bf16 v22, v140, v140, v22
    v_dot2_f32_bf16 v23, v140, v116, v23
    v_dot2_f32_bf16 v22, v141, v141, v22
    v_dot2_f32_bf16 v23, v141, v117, v23
    v_dot2_f32_bf16 v22, v142, v142, v22
    v_dot2_f32_bf16 v23, v142, v118, v23
    v_dot2_f32_bf16 v22, v143, v143, v22
    v_dot2_f32_bf16 v23, v143, v119, v23
    v_dot2_f32_bf16 v22, v144, v144, v22
    v_dot2_f32_bf16 v23, v144, v120, v23
    v_dot2_f32_bf16 v22, v145, v145, v22
    v_dot2_f32_bf16 v23, v145, v121, v23
    v_dot2_f32_bf16 v22, v146, v146, v22
    v_dot2_f32_bf16 v23, v146, v122, v23
    v_dot2_f32_bf16 v22, v147, v147, v22
    v_dot2_f32_bf16 v23, v147, v123, v23
    s_nop 2
    v_fma_f32 v22, v23, 2.0, v22
    s_nop 1
    v_mfma_f32_16x16x4_f32 v[236:239], v22, v20, 0
    s_sub_u32 s40, s2, 3
    s_cmp_ge_u32 s40, 3
    s_cbranch_scc1 L_nowf
    s_mov_b32 s24, s20
    s_mov_b32 s25, s21
    s_mov_b32 s26, 0x100
    s_mov_b32 s27, 0x20000
    s_lshl_b32 s40, s40, 4
    v_mov_b32 v22, 1
    s_waitcnt vmcnt(0)
    s_mov_b64 exec, 1
    buffer_store_dword v22, v1, s[24:27], s40 offen offset:128 sc1
    s_mov_b64 exec, -1
L_nowf:
    s_add_u32 s51, s51, 1
    s_cmp_ge_u32 s52, s51
    s_cbranch_scc1 L_have24
    s_nop 3
L_spin25:
    ds_read_b32 v3, v1 offset:6912
    s_waitcnt lgkmcnt(0)
    v_readfirstlane_b32 s52, v3
    s_nop 0
    s_cmp_ge_u32 s52, s51
    s_cbranch_scc1 L_spun26
    s_sleep 1
    s_branch L_spin25
L_spun26:
L_have24:
    ds_read_b128 v[52:55], v8
    ds_read_b128 v[56:59], v9
    ds_read_b128 v[60:63], v8 offset:128
    ds_read_b128 v[64:67], v9 offset:128
    ds_read_b128 v[68:71], v8 offset:256
    ds_read_b128 v[72:75], v9 offset:256
    s_waitcnt lgkmcnt(5)
    v_mfma_f32_16x16x32_bf16 v[76:79], v[52:55], v[24:27], v[224:227]
    ds_read_b64_tr_b16 v[150:151], v10
    ds_read_b64_tr_b16 v[156:157], v11
    s_waitcnt lgkmcnt(6)
    v_mfma_f32_16x16x32_bf16 v[76:79], v[56:59], v[24:27], v[76:79]
    ds_read_b64_tr_b16 v[162:163], v12
    ds_read_b64_tr_b16 v[168:169], v13
    ds_read_b64_tr_b16 v[174:175], v10 offset:128
    s_waitcnt lgkmcnt(8)
    v_mfma_f32_16x16x32_bf16 v[76:79], v[60:63], v[24:27], v[76:79]
    ds_read_b64_tr_b16 v[180:181], v11 offset:128
    ds_read_b64_tr_b16 v[186:187], v12 offset:128
    ds_read_b64_tr_b16 v[192:193], v13 offset:128
    s_waitcnt lgkmcnt(10)
    v_mfma_f32_16x16x32_bf16 v[76:79], v[64:67], v[24:27], v[76:79]
    ds_read_b64_tr_b16 v[198:199], v10 offset:256
    ds_read_b64_tr_b16 v[204:205], v11 offset:256
    s_waitcnt lgkmcnt(11)
    v_mfma_f32_16x16x32_bf16 v[76:79], v[68:71], v[24:27], v[76:79]
    ds_read_b64_tr_b16 v[210:211], v12 offset:256
    ds_read_b64_tr_b16 v[216:217], v13 offset:256
    s_waitcnt lgkmcnt(12)
    v_mfma_f32_16x16x32_bf16 v[76:79], v[72:75], v[24:27], v[76:79]
    ds_read_b32 v3, v1 offset:6912
    s_add_u32 s54, s54, 1
    s_cmp_eq_u32 s54, 6
    s_cselect_b32 s55, 0xffff8800, s56
    s_cselect_b32 s54, 0, s54
    v_add_u32 v8, s55, v8
    v_add_u32 v9, s55, v9
    v_mov_b32 v2, s51
    v_add_u32 v10, s55, v10
    v_add_u32 v11, s55, v11
    v_add_u32 v12, s55, v12
    v_add_u32 v13, s55, v13
    s_waitcnt lgkmcnt(0)
    ds_write_b32 v1, v2 offset:6928
    v_dot2_f32_bf16 v22, v52, v52, v255
    v_dot2_f32_bf16 v23, v52, v100, 0
    v_dot2_f32_bf16 v22, v53, v53, v22
    v_dot2_f32_bf16 v23, v53, v101, v23
    v_dot2_f32_bf16 v22, v54, v54, v22
    v_dot2_f32_bf16 v23, v54, v102, v23
    v_dot2_f32_bf16 v22, v55, v55, v22
    v_dot2_f32_bf16 v23, v55, v103, v23
    v_dot2_f32_bf16 v22, v56, v56, v22
    v_dot2_f32_bf16 v23, v56, v104, v23
    v_dot2_f32_bf16 v22, v57, v57, v22
    v_dot2_f32_bf16 v23, v57, v105, v23
    v_dot2_f32_bf16 v22, v58, v58, v22
    v_dot2_f32_bf16 v23, v58, v106, v23
    v_dot2_f32_bf16 v22, v59, v59, v22
    v_dot2_f32_bf16 v23, v59, v107, v23
    v_dot2_f32_bf16 v22, v60, v60, v22
    v_dot2_f32_bf16 v23, v60, v108, v23
    v_dot2_f32_bf16 v22, v61, v61, v22
    v_dot2_f32_bf16 v23, v61, v109, v23
    v_dot2_f32_bf16 v22, v62, v62, v22
    v_dot2_f32_bf16 v23, v62, v110, v23
    v_dot2_f32_bf16 v22, v63, v63, v22
    v_dot2_f32_bf16 v23, v63, v111, v23
    v_dot2_f32_bf16 v22, v64, v64, v22
    v_dot2_f32_bf16 v23, v64, v112, v23
    v_dot2_f32_bf16 v22, v65, v65, v22
    v_dot2_f32_bf16 v23, v65, v113, v23
    v_dot2_f32_bf16 v22, v66, v66, v22
    v_dot2_f32_bf16 v23, v66, v114, v23
    v_dot2_f32_bf16 v22, v67, v67, v22
    v_dot2_f32_bf16 v23, v67, v115, v23
    v_dot2_f32_bf16 v22, v68, v68, v22
    v_dot2_f32_bf16 v23, v68, v116, v23
    v_dot2_f32_bf16 v22, v69, v69, v22
    v_dot2_f32_bf16 v23, v69, v117, v23
    v_dot2_f32_bf16 v22, v70, v70, v22
    v_dot2_f32_bf16 v23, v70, v118, v23
    v_dot2_f32_bf16 v22, v71, v71, v22
    v_dot2_f32_bf16 v23, v71, v119, v23
    v_dot2_f32_bf16 v22, v72, v72, v22
    v_dot2_f32_bf16 v23, v72, v120, v23
    v_dot2_f32_bf16 v22, v73, v73, v22
    v_dot2_f32_bf16 v23, v73, v121, v23
    v_dot2_f32_bf16 v22, v74, v74, v22
    v_dot2_f32_bf16 v23, v74, v122, v23
    v_dot2_f32_bf16 v22, v75, v75, v22
    v_dot2_f32_bf16 v23, v75, v123, v23
    s_nop 2
    v_fma_f32 v22, v23, 2.0, v22
    s_nop 1
    v_mfma_f32_16x16x4_f32 v[80:83], v22, v20, 0
    v_pk_mul_f32 v[232:233], v[232:233], s[44:45]
    v_pk_mul_f32 v[234:235], v[234:235], s[44:45]
    v_pk_fma_f32 v[4:5], v[232:233], v[232:233], s[46:47] neg_lo:[1,0,0] neg_hi:[1,0,0]
    v_pk_fma_f32 v[6:7], v[234:235], v[234:235], s[46:47] neg_lo:[1,0,0] neg_hi:[1,0,0]
    v_pk_fma_f32 v[236:237], v[236:237], s[44:45], v[4:5]
    v_pk_fma_f32 v[238:239], v[238:239], s[44:45], v[6:7]
    v_max_f32 v236, s46, v236
    v_max_f32 v237, s46, v237
    v_max_f32 v238, s46, v238
    v_max_f32 v239, s46, v239
    v_rsq_f32 v236, v236
    v_rsq_f32 v237, v237
    v_rsq_f32 v238, v238
    v_rsq_f32 v239, v239
    v_pk_mul_f32 v[76:77], v[76:77], s[44:45]
    v_pk_mul_f32 v[78:79], v[78:79], s[44:45]
    v_pk_fma_f32 v[4:5], v[76:77], v[76:77], s[46:47] neg_lo:[1,0,0] neg_hi:[1,0,0]
    v_pk_fma_f32 v[6:7], v[78:79], v[78:79], s[46:47] neg_lo:[1,0,0] neg_hi:[1,0,0]
    v_pk_fma_f32 v[80:81], v[80:81], s[44:45], v[4:5]
    v_pk_fma_f32 v[82:83], v[82:83], s[44:45], v[6:7]
    v_max_f32 v80, s46, v80
    v_max_f32 v81, s46, v81
    v_max_f32 v82, s46, v82
    v_max_f32 v83, s46, v83
    v_rsq_f32 v80, v80
    v_rsq_f32 v81, v81
    v_rsq_f32 v82, v82
    v_rsq_f32 v83, v83
    s_add_u32 s51, s51, 1
    s_cmp_ge_u32 s52, s51
    s_cbranch_scc1 L_have27
L_spin28:
    ds_read_b32 v3, v1 offset:6912
    s_waitcnt lgkmcnt(0)
    v_readfirstlane_b32 s52, v3
    s_nop 0
    s_cmp_ge_u32 s52, s51
    s_cbranch_scc1 L_spun29
    s_sleep 1
    s_branch L_spin28
L_spun29:
L_have27:
    v_mov_b32 v21, 0
    s_nop 4
L_spin30:
    ds_read_b32 v3, v21 offset:6944
    s_waitcnt lgkmcnt(0)
    v_readfirstlane_b32 s40, v3
    s_nop 0
    s_cmp_ge_u32 s40, 1
    s_cbranch_scc1 L_spun31
    s_sleep 1
    s_branch L_spin30
L_spun31:
    ds_read_b128 v[28:31], v244
    ds_read_b128 v[32:35], v245
    ds_read_b128 v[36:39], v244 offset:128
    ds_read_b128 v[40:43], v245 offset:128
    ds_read_b128 v[44:47], v244 offset:256
    ds_read_b128 v[48:51], v245 offset:256
    s_waitcnt lgkmcnt(5)
    v_mfma_f32_16x16x32_bf16 v[220:223], v[100:103], v[28:31], 0
    v_mfma_f32_16x16x32_bf16 v[88:91], v[24:27], v[28:31], 0
    s_waitcnt lgkmcnt(4)
    v_mfma_f32_16x16x32_bf16 v[220:223], v[104:107], v[32:35], v[220:223]
    v_mfma_f32_16x16x32_bf16 v[88:91], v[24:27], v[32:35], v[88:91]
    s_waitcnt lgkmcnt(3)
    v_mfma_f32_16x16x32_bf16 v[220:223], v[108:111], v[36:39], v[220:223]
    v_mfma_f32_16x16x32_bf16 v[88:91], v[24:27], v[36:39], v[88:91]
    s_waitcnt lgkmcnt(2)
    v_mfma_f32_16x16x32_bf16 v[220:223], v[112:115], v[40:43], v[220:223]
    v_mfma_f32_16x16x32_bf16 v[88:91], v[24:27], v[40:43], v[88:91]
    s_waitcnt lgkmcnt(1)
    v_mfma_f32_16x16x32_bf16 v[220:223], v[116:119], v[44:47], v[220:223]
    v_mfma_f32_16x16x32_bf16 v[88:91], v[24:27], v[44:47], v[88:91]
    s_waitcnt lgkmcnt(0)
    v_mfma_f32_16x16x32_bf16 v[220:223], v[120:123], v[48:51], v[220:223]
    v_mfma_f32_16x16x32_bf16 v[88:91], v[24:27], v[48:51], v[88:91]
    v_mfma_f32_16x16x32_bf16 v[228:231], v[124:127], v[28:31], v[220:223]
    v_mfma_f32_16x16x32_bf16 v[84:87], v[52:55], v[28:31], v[220:223]
    v_mfma_f32_16x16x32_bf16 v[228:231], v[128:131], v[32:35], v[228:231]
    v_mfma_f32_16x16x32_bf16 v[84:87], v[56:59], v[32:35], v[84:87]
    v_mfma_f32_16x16x32_bf16 v[228:231], v[132:135], v[36:39], v[228:231]
    v_mfma_f32_16x16x32_bf16 v[84:87], v[60:63], v[36:39], v[84:87]
    v_mfma_f32_16x16x32_bf16 v[228:231], v[136:139], v[40:43], v[228:231]
    v_mfma_f32_16x16x32_bf16 v[84:87], v[64:67], v[40:43], v[84:87]
    v_mfma_f32_16x16x32_bf16 v[228:231], v[140:143], v[44:47], v[228:231]
    v_mfma_f32_16x16x32_bf16 v[84:87], v[68:71], v[44:47], v[84:87]
    v_mfma_f32_16x16x32_bf16 v[228:231], v[144:147], v[48:51], v[228:231]
    v_mfma_f32_16x16x32_bf16 v[84:87], v[72:75], v[48:51], v[84:87]
    ds_read_b128 v[124:127], v8
    ds_read_b128 v[128:131], v9
    ds_read_b128 v[132:135], v8 offset:128
    ds_read_b128 v[136:139], v9 offset:128
    ds_read_b128 v[140:143], v8 offset:256
    ds_read_b128 v[144:147], v9 offset:256
    v_mov_b32 v16, v88
    v_mov_b32 v17, v88
    v_pk_fma_f32 v[228:229], v[232:233], v[16:17], v[228:229] neg_lo:[1,0,0] neg_hi:[1,0,0]
    v_pk_mul_f32 v[228:229], v[228:229], v[236:237]
    v_pk_fma_f32 v[230:231], v[234:235], v[16:17], v[230:231] neg_lo:[1,0,0] neg_hi:[1,0,0]
    v_pk_mul_f32 v[230:231], v[230:231], v[238:239]
    v_pk_fma_f32 v[84:85], v[76:77], v[16:17], v[84:85] neg_lo:[1,0,0] neg_hi:[1,0,0]
    v_pk_mul_f32 v[84:85], v[84:85], v[80:81]
    v_pk_fma_f32 v[86:87], v[78:79], v[16:17], v[86:87] neg_lo:[1,0,0] neg_hi:[1,0,0]
    v_pk_mul_f32 v[86:87], v[86:87], v[82:83]
    v_max3_f32 v254, v228, v229, v230
    v_max3_f32 v21, v231, v84, v85
    v_max3_f32 v254, v254, v86, v87
    v_max_f32 v254, v254, v21
    v_mov_b32 v22, v254
    v_mov_b32 v23, v254
    s_nop 1
    v_permlane32_swap_b32 v22, v23
    v_max_f32 v254, v22, v23
    v_mov_b32 v22, v254
    v_mov_b32 v23, v254
    s_nop 1
    v_permlane16_swap_b32 v22, v23
    v_max_f32 v254, v22, v23
    v_cmp_le_f32_e64 vcc, |v254|, s50
    s_nop 1
    v_cndmask_b32_e64 v254, v254, 0, vcc
    v_sub_f32 v18, 0, v254
    v_sub_f32 v19, 0, v254
    v_pk_add_f32 v[228:229], v[228:229], v[18:19]
    v_pk_add_f32 v[230:231], v[230:231], v[18:19]
    v_exp_f32 v228, v228
    v_exp_f32 v229, v229
    v_exp_f32 v230, v230
    v_exp_f32 v231, v231
    v_pk_add_f32 v[84:85], v[84:85], v[18:19]
    v_pk_add_f32 v[86:87], v[86:87], v[18:19]
    v_exp_f32 v84, v84
    v_exp_f32 v85, v85
    v_exp_f32 v86, v86
    v_exp_f32 v87, v87
    v_pk_add_f32 v[14:15], v[228:229], v[230:231]
    v_pk_add_f32 v[14:15], v[14:15], v[84:85]
    v_pk_add_f32 v[14:15], v[14:15], v[86:87]
    v_pk_mul_f32 v[228:229], v[228:229], v[236:237]
    v_pk_mul_f32 v[230:231], v[230:231], v[238:239]
    v_pk_mul_f32 v[84:85], v[84:85], v[80:81]
    v_pk_mul_f32 v[86:87], v[86:87], v[82:83]
    v_cvt_pk_bf16_f32 v244, v228, v229
    v_cvt_pk_bf16_f32 v245, v230, v231
    v_cvt_pk_bf16_f32 v246, v84, v85
    v_cvt_pk_bf16_f32 v247, v86, v87
    v_pk_add_f32 v[240:241], v[228:229], v[84:85]
    v_pk_add_f32 v[242:243], v[230:231], v[86:87]
    v_pk_mul_f32 v[252:253], v[228:229], v[232:233]
    v_pk_fma_f32 v[252:253], v[230:231], v[234:235], v[252:253]
    v_pk_fma_f32 v[252:253], v[84:85], v[76:77], v[252:253]
    v_pk_fma_f32 v[252:253], v[86:87], v[78:79], v[252:253]
    v_mov_b32 v21, 0
    v_mfma_f32_16x16x32_bf16 v[52:55], v[148:151], v[244:247], 0
    ds_read_b64_tr_b16 v[148:149], v10
    ds_read_b64 v[150:151], v21 offset:7056
    v_mfma_f32_16x16x32_bf16 v[56:59], v[154:157], v[244:247], 0
    ds_read_b64_tr_b16 v[154:155], v11
    ds_read_b64 v[156:157], v21 offset:7056
    v_mfma_f32_16x16x32_bf16 v[60:63], v[160:163], v[244:247], 0
    ds_read_b64_tr_b16 v[160:161], v12
    ds_read_b64 v[162:163], v21 offset:7056
    v_mfma_f32_16x16x32_bf16 v[64:67], v[166:169], v[244:247], 0
    ds_read_b64_tr_b16 v[166:167], v13
    ds_read_b64 v[168:169], v21 offset:7056
    v_mfma_f32_16x16x32_bf16 v[68:71], v[172:175], v[244:247], 0
    ds_read_b64_tr_b16 v[172:173], v10 offset:128
    ds_read_b64 v[174:175], v21 offset:7056
    v_mfma_f32_16x16x32_bf16 v[72:75], v[178:181], v[244:247], 0
    ds_read_b64_tr_b16 v[178:179], v11 offset:128
    ds_read_b64 v[180:181], v21 offset:7056
    v_mfma_f32_16x16x32_bf16 v[76:79], v[184:187], v[244:247], 0
    ds_read_b64_tr_b16 v[184:185], v12 offset:128
    ds_read_b64 v[186:187], v21 offset:7056
    v_mfma_f32_16x16x32_bf16 v[80:83], v[190:193], v[244:247], 0
    ds_read_b64_tr_b16 v[190:191], v13 offset:128
    ds_read_b64 v[192:193], v21 offset:7056
    v_mfma_f32_16x16x32_bf16 v[84:87], v[196:199], v[244:247], 0
    ds_read_b64_tr_b16 v[196:197], v10 offset:256
    ds_read_b64 v[198:199], v21 offset:7056
    v_mfma_f32_16x16x32_bf16 v[88:91], v[202:205], v[244:247], 0
    ds_read_b64_tr_b16 v[202:203], v11 offset:256
    ds_read_b64 v[204:205], v21 offset:7056
    v_mfma_f32_16x16x32_bf16 v[92:95], v[208:211], v[244:247], 0
    ds_read_b64_tr_b16 v[208:209], v12 offset:256
    ds_read_b64 v[210:211], v21 offset:7056
    v_mfma_f32_16x16x32_bf16 v[96:99], v[214:217], v[244:247], 0
    ds_read_b64_tr_b16 v[214:215], v13 offset:256
    ds_read_b64 v[216:217], v21 offset:7056
    s_nop 5
    s_branch L_tile2b
L_rescale:
    s_nop 15
    v_mul_f32 v4, v228, v236
    v_mul_f32 v5, v229, v237
    v_mul_f32 v6, v230, v238
    v_mul_f32 v7, v231, v239
    v_max3_f32 v21, v4, v5, v6
    v_max3_f32 v21, v21, v7, v254
    v_mov_b32 v22, v21
    v_mov_b32 v23, v21
    s_nop 1
    v_permlane32_swap_b32 v22, v23
    v_max_f32 v21, v22, v23
    v_mov_b32 v22, v21
    v_mov_b32 v23, v21
    s_nop 1
    v_permlane16_swap_b32 v22, v23
    v_max_f32 v21, v22, v23
    v_sub_f32 v22, v254, v21
    v_exp_f32 v22, v22
    v_mov_b32 v254, v21
    v_sub_f32 v18, 0, v21
    v_sub_f32 v19, 0, v21
    v_mov_b32 v23, v22
    v_sub_f32 v4, v4, v21
    v_sub_f32 v5, v5, v21
    v_sub_f32 v6, v6, v21
    v_sub_f32 v7, v7, v21
    v_exp_f32 v4, v4
    v_exp_f32 v5, v5
    v_exp_f32 v6, v6
    v_exp_f32 v7, v7
    v_pk_mul_f32 v[14:15], v[14:15], v[22:23]
    v_pk_mul_f32 v[252:253], v[252:253], v[22:23]
    v_pk_mul_f32 v[240:241], v[240:241], v[22:23]
    v_pk_mul_f32 v[242:243], v[242:243], v[22:23]
    v_pk_mul_f32 v[248:249], v[248:249], v[22:23]
    v_pk_mul_f32 v[250:251], v[250:251], v[22:23]
    v_pk_mul_f32 v[52:53], v[52:53], v[22:23]
    v_pk_mul_f32 v[54:55], v[54:55], v[22:23]
    v_pk_mul_f32 v[56:57], v[56:57], v[22:23]
    v_pk_mul_f32 v[58:59], v[58:59], v[22:23]
    v_pk_mul_f32 v[60:61], v[60:61], v[22:23]
    v_pk_mul_f32 v[62:63], v[62:63], v[22:23]
    v_pk_mul_f32 v[64:65], v[64:65], v[22:23]
    v_pk_mul_f32 v[66:67], v[66:67], v[22:23]
    v_pk_mul_f32 v[68:69], v[68:69], v[22:23]
    v_pk_mul_f32 v[70:71], v[70:71], v[22:23]
    v_pk_mul_f32 v[72:73], v[72:73], v[22:23]
    v_pk_mul_f32 v[74:75], v[74:75], v[22:23]
    v_pk_mul_f32 v[76:77], v[76:77], v[22:23]
    v_pk_mul_f32 v[78:79], v[78:79], v[22:23]
    v_pk_mul_f32 v[80:81], v[80:81], v[22:23]
    v_pk_mul_f32 v[82:83], v[82:83], v[22:23]
    v_pk_mul_f32 v[84:85], v[84:85], v[22:23]
    v_pk_mul_f32 v[86:87], v[86:87], v[22:23]
    v_pk_mul_f32 v[88:89], v[88:89], v[22:23]
    v_pk_mul_f32 v[90:91], v[90:91], v[22:23]
    v_pk_mul_f32 v[92:93], v[92:93], v[22:23]
    v_pk_mul_f32 v[94:95], v[94:95], v[22:23]
    v_pk_mul_f32 v[96:97], v[96:97], v[22:23]
    v_pk_mul_f32 v[98:99], v[98:99], v[22:23]
    s_nop 1
    s_setpc_b64 s[48:49]
L_loop:
    s_add_u32 s51, s51, 1
    s_cmp_lg_u32 s57, 0
    s_cbranch_scc1 L_begun32
L_spin33:
    ds_read_b32 v3, v1 offset:6912
    s_waitcnt lgkmcnt(0)
    v_readfirstlane_b32 s52, v3
    s_nop 0
    s_cmp_ge_u32 s52, s51
    s_cbranch_scc1 L_spun34
    s_sleep 1
    s_branch L_spin33
L_spun34:
    ds_read_b128 v[100:103], v8
    ds_read_b128 v[104:107], v9
    ds_read_b128 v[108:111], v8 offset:128
    ds_read_b128 v[112:115], v9 offset:128
    ds_read_b128 v[116:119], v8 offset:256
    ds_read_b128 v[120:123], v9 offset:256
L_begun32:
    v_mfma_f32_16x16x32_bf16 v[52:55], v[150:153], v[244:247], v[52:55]
    ds_read_b64_tr_b16 v[152:153], v10
    v_mfma_f32_16x16x32_bf16 v[56:59], v[156:159], v[244:247], v[56:59]
    ds_read_b64_tr_b16 v[158:159], v11
    v_mfma_f32_16x16x32_bf16 v[60:63], v[162:165], v[244:247], v[60:63]
    ds_read_b64_tr_b16 v[164:165], v12
    v_mfma_f32_16x16x32_bf16 v[64:67], v[168:171], v[244:247], v[64:67]
    ds_read_b64_tr_b16 v[170:171], v13
    v_mfma_f32_16x16x32_bf16 v[68:71], v[174:177], v[244:247], v[68:71]
    ds_read_b64_tr_b16 v[176:177], v10 offset:128
    v_mfma_f32_16x16x32_bf16 v[72:75], v[180:183], v[244:247], v[72:75]
    ds_read_b64_tr_b16 v[182:183], v11 offset:128
    v_mfma_f32_16x16x32_bf16 v[76:79], v[186:189], v[244:247], v[76:79]
    ds_read_b64_tr_b16 v[188:189], v12 offset:128
    v_mfma_f32_16x16x32_bf16 v[80:83], v[192:195], v[244:247], v[80:83]
    ds_read_b64_tr_b16 v[194:195], v13 offset:128
    v_mfma_f32_16x16x32_bf16 v[84:87], v[198:201], v[244:247], v[84:87]
    ds_read_b64_tr_b16 v[200:201], v10 offset:256
    v_mfma_f32_16x16x32_bf16 v[88:91], v[204:207], v[244:247], v[88:91]
    ds_read_b64_tr_b16 v[206:207], v11 offset:256
    v_mfma_f32_16x16x32_bf16 v[92:95], v[210:213], v[244:247], v[92:95]
    ds_read_b64_tr_b16 v[212:213], v12 offset:256
    v_mfma_f32_16x16x32_bf16 v[96:99], v[216:219], v[244:247], v[96:99]
    ds_read_b64_tr_b16 v[218:219], v13 offset:256
    s_waitcnt lgkmcnt(12)
    v_mfma_f32_16x16x32_bf16 v[224:227], v[100:103], v[24:27], 0
    v_mfma_f32_16x16x32_bf16 v[224:227], v[104:107], v[24:27], v[224:227]
    v_mfma_f32_16x16x32_bf16 v[224:227], v[108:111], v[24:27], v[224:227]
    v_mfma_f32_16x16x32_bf16 v[224:227], v[112:115], v[24:27], v[224:227]
    v_mfma_f32_16x16x32_bf16 v[224:227], v[116:119], v[24:27], v[224:227]
    v_mfma_f32_16x16x32_bf16 v[224:227], v[120:123], v[24:27], v[224:227]
    s_add_u32 s54, s54, 1
    s_cmp_eq_u32 s54, 6
    s_cselect_b32 s55, 0xffff8800, s56
    s_cselect_b32 s54, 0, s54
    v_mfma_f32_16x16x32_bf16 v[220:223], v[100:103], v[28:31], 0
    v_add_u32 v8, s55, v8
    v_add_u32 v9, s55, v9
    v_mfma_f32_16x16x32_bf16 v[220:223], v[104:107], v[32:35], v[220:223]
    v_mov_b32 v2, s51
    v_add_u32 v10, s55, v10
    v_mfma_f32_16x16x32_bf16 v[220:223], v[108:111], v[36:39], v[220:223]
    v_add_u32 v11, s55, v11
    v_add_u32 v12, s55, v12
    v_mfma_f32_16x16x32_bf16 v[220:223], v[112:115], v[40:43], v[220:223]
    v_add_u32 v13, s55, v13
    ds_read_b32 v3, v1 offset:6912
    v_mfma_f32_16x16x32_bf16 v[220:223], v[116:119], v[44:47], v[220:223]
    v_mfma_f32_16x16x32_bf16 v[220:223], v[120:123], v[48:51], v[220:223]
    s_waitcnt lgkmcnt(0)
    ds_write_b32 v1, v2 offset:6928
    v_readfirstlane_b32 s52, v3
    s_mov_b32 s57, 0
    s_nop 0
    s_cmp_gt_u32 s52, s51
    s_cbranch_scc0 L_early35
    s_mov_b32 s57, 1
    ds_read_b128 v[124:127], v8
    ds_read_b128 v[128:131], v9
    ds_read_b128 v[132:135], v8 offset:128
    ds_read_b128 v[136:139], v9 offset:128
    ds_read_b128 v[140:143], v8 offset:256
    ds_read_b128 v[144:147], v9 offset:256
L_early35:
    v_dot2_f32_bf16 v22, v100, v100, 0
    v_dot2_f32_bf16 v23, v101, v101, 0
    v_dot2_f32_bf16 v22, v102, v102, v22
    v_dot2_f32_bf16 v23, v103, v103, v23
    v_dot2_f32_bf16 v22, v104, v104, v22
    v_dot2_f32_bf16 v23, v105, v105, v23
    v_dot2_f32_bf16 v22, v106, v106, v22
    v_dot2_f32_bf16 v23, v107, v107, v23
    v_dot2_f32_bf16 v22, v108, v108, v22
    v_dot2_f32_bf16 v23, v109, v109, v23
    v_dot2_f32_bf16 v22, v110, v110, v22
    v_dot2_f32_bf16 v23, v111, v111, v23
    v_dot2_f32_bf16 v22, v112, v112, v22
    v_dot2_f32_bf16 v23, v113, v113, v23
    v_dot2_f32_bf16 v22, v114, v114, v22
    v_dot2_f32_bf16 v23, v115, v115, v23
    v_dot2_f32_bf16 v22, v116, v116, v22
    v_dot2_f32_bf16 v23, v117, v117, v23
    v_dot2_f32_bf16 v22, v118, v118, v22
    v_dot2_f32_bf16 v23, v119, v119, v23
    v_dot2_f32_bf16 v22, v120, v120, v22
    v_dot2_f32_bf16 v23, v121, v121, v23
    v_dot2_f32_bf16 v22, v122, v122, v22
    v_dot2_f32_bf16 v23, v123, v123, v23
    s_nop 2
    v_add_f32 v255, v22, v23
    s_add_u32 s51, s51, 1
    s_cmp_lg_u32 s57, 0
    s_cbranch_scc1 L_begun36
L_spin37:
    ds_read_b32 v3, v1 offset:6912
    s_waitcnt lgkmcnt(0)
    v_readfirstlane_b32 s52, v3
    s_nop 0
    s_cmp_ge_u32 s52, s51
    s_cbranch_scc1 L_spun38
    s_sleep 1
    s_branch L_spin37
L_spun38:
    ds_read_b128 v[124:127], v8
    ds_read_b128 v[128:131], v9
    ds_read_b128 v[132:135], v8 offset:128
    ds_read_b128 v[136:139], v9 offset:128
    ds_read_b128 v[140:143], v8 offset:256
    ds_read_b128 v[144:147], v9 offset:256
L_begun36:
    s_waitcnt lgkmcnt(5)
    v_mfma_f32_16x16x32_bf16 v[232:235], v[124:127], v[24:27], v[224:227]
    ds_read_b64_tr_b16 v[148:149], v10
    s_add_u32 s54, s54, 1
    s_cmp_eq_u32 s54, 6
    s_cselect_b32 s55, 0xffff8800, s56
    s_cselect_b32 s54, 0, s54
    v_mfma_f32_16x16x32_bf16 v[228:231], v[124:127], v[28:31], v[220:223]
    ds_read_b64_tr_b16 v[154:155], v11
    v_add_u32 v8, s55, v8
    s_waitcnt lgkmcnt(6)
    v_mfma_f32_16x16x32_bf16 v[232:235], v[128:131], v[24:27], v[232:235]
    ds_read_b64_tr_b16 v[160:161], v12
    ds_read_b64_tr_b16 v[166:167], v13
    v_mfma_f32_16x16x32_bf16 v[228:231], v[128:131], v[32:35], v[228:231]
    ds_read_b64_tr_b16 v[172:173], v10 offset:128
    v_add_u32 v9, s55, v9
    s_waitcnt lgkmcnt(8)
    v_mfma_f32_16x16x32_bf16 v[232:235], v[132:135], v[24:27], v[232:235]
    ds_read_b64_tr_b16 v[178:179], v11 offset:128
    ds_read_b64_tr_b16 v[184:185], v12 offset:128
    v_mfma_f32_16x16x32_bf16 v[228:231], v[132:135], v[36:39], v[228:231]
    ds_read_b64_tr_b16 v[190:191], v13 offset:128
    v_mov_b32 v2, s51
    s_waitcnt lgkmcnt(10)
    v_mfma_f32_16x16x32_bf16 v[232:235], v[136:139], v[24:27], v[232:235]
    ds_read_b64_tr_b16 v[196:197], v10 offset:256
    v_mfma_f32_16x16x32_bf16 v[228:231], v[136:139], v[40:43], v[228:231]
    ds_read_b64_tr_b16 v[202:203], v11 offset:256
    s_waitcnt lgkmcnt(11)
    v_mfma_f32_16x16x32_bf16 v[232:235], v[140:143], v[24:27], v[232:235]
    ds_read_b64_tr_b16 v[208:209], v12 offset:256
    v_mfma_f32_16x16x32_bf16 v[228:231], v[140:143], v[44:47], v[228:231]
    ds_read_b64_tr_b16 v[214:215], v13 offset:256
    ds_read_b32 v3, v1 offset:6912
    s_waitcnt lgkmcnt(13)
    v_mfma_f32_16x16x32_bf16 v[232:235], v[144:147], v[24:27], v[232:235]
    v_add_u32 v10, s55, v10
    v_add_u32 v11, s55, v11
    v_mfma_f32_16x16x32_bf16 v[228:231], v[144:147], v[48:51], v[228:231]
    v_add_u32 v12, s55, v12
    v_add_u32 v13, s55, v13
    s_waitcnt lgkmcnt(0)
    ds_write_b32 v1, v2 offset:6928
    v_dot2_f32_bf16 v22, v124, v124, v255
    v_dot2_f32_bf16 v23, v124, v100, 0
    v_dot2_f32_bf16 v22, v125, v125, v22
    v_dot2_f32_bf16 v23, v125, v101, v23
    v_dot2_f32_bf16 v22, v126, v126, v22
    v_dot2_f32_bf16 v23, v126, v102, v23
    v_dot2_f32_bf16 v22, v127, v127, v22
    v_dot2_f32_bf16 v23, v127, v103, v23
    v_dot2_f32_bf16 v22, v128, v128, v22
    v_dot2_f32_bf16 v23, v128, v104, v23
    v_dot2_f32_bf16 v22, v129, v129, v22
    v_dot2_f32_bf16 v23, v129, v105, v23
    v_dot2_f32_bf16 v22, v130, v130, v22
    v_dot2_f32_bf16 v23, v130, v106, v23
    v_dot2_f32_bf16 v22, v131, v131, v22
    v_dot2_f32_bf16 v23, v131, v107, v23
    v_dot2_f32_bf16 v22, v132, v132, v22
    v_dot2_f32_bf16 v23, v132, v108, v23
    v_dot2_f32_bf16 v22, v133, v133, v22
    v_dot2_f32_bf16 v23, v133, v109, v23
    v_dot2_f32_bf16 v22, v134, v134, v22
    v_dot2_f32_bf16 v23, v134, v110, v23
    v_dot2_f32_bf16 v22, v135, v135, v22
    v_dot2_f32_bf16 v23, v135, v111, v23
    v_dot2_f32_bf16 v22, v136, v136, v22
    v_dot2_f32_bf16 v23, v136, v112, v23
    v_dot2_f32_bf16 v22, v137, v137, v22
    v_dot2_f32_bf16 v23, v137, v113, v23
    v_dot2_f32_bf16 v22, v138, v138, v22
    v_dot2_f32_bf16 v23, v138, v114, v23
    v_dot2_f32_bf16 v22, v139, v139, v22
    v_dot2_f32_bf16 v23, v139, v115, v23
    v_dot2_f32_bf16 v22, v140, v140, v22
    v_dot2_f32_bf16 v23, v140, v116, v23
    v_dot2_f32_bf16 v22, v141, v141, v22
    v_dot2_f32_bf16 v23, v141, v117, v23
    v_dot2_f32_bf16 v22, v142, v142, v22
    v_dot2_f32_bf16 v23, v142, v118, v23
    v_dot2_f32_bf16 v22, v143, v143, v22
    v_dot2_f32_bf16 v23, v143, v119, v23
    v_dot2_f32_bf16 v22, v144, v144, v22
    v_dot2_f32_bf16 v23, v144, v120, v23
    v_dot2_f32_bf16 v22, v145, v145, v22
    v_dot2_f32_bf16 v23, v145, v121, v23
    v_dot2_f32_bf16 v22, v146, v146, v22
    v_dot2_f32_bf16 v23, v146, v122, v23
    v_dot2_f32_bf16 v22, v147, v147, v22
    v_dot2_f32_bf16 v23, v147, v123, v23
    s_nop 2
    v_fma_f32 v22, v23, 2.0, v22
    s_nop 1
    v_mfma_f32_16x16x4_f32 v[236:239], v22, v20, 0
    v_readfirstlane_b32 s52, v3
    s_mov_b32 s57, 0
    s_nop 0
    s_cmp_gt_u32 s52, s51
    s_cbranch_scc0 L_early39
    s_mov_b32 s57, 1
    ds_read_b128 v[124:127], v8
    ds_read_b128 v[128:131], v9
    ds_read_b128 v[132:135], v8 offset:128
    ds_read_b128 v[136:139], v9 offset:128
    ds_read_b128 v[140:143], v8 offset:256
    ds_read_b128 v[144:147], v9 offset:256
L_early39:
    v_pk_mul_f32 v[232:233], v[232:233], s[44:45]
    v_pk_mul_f32 v[234:235], v[234:235], s[44:45]
    v_pk_fma_f32 v[4:5], v[232:233], v[232:233], s[46:47] neg_lo:[1,0,0] neg_hi:[1,0,0]
    v_pk_fma_f32 v[6:7], v[234:235], v[234:235], s[46:47] neg_lo:[1,0,0] neg_hi:[1,0,0]
    s_nop 0
    v_pk_fma_f32 v[236:237], v[236:237], s[44:45], v[4:5]
    v_pk_fma_f32 v[238:239], v[238:239], s[44:45], v[6:7]
    v_max_f32 v236, s46, v236
    v_max_f32 v237, s46, v237
    v_max_f32 v238, s46, v238
    v_max_f32 v239, s46, v239
    v_rsq_f32 v236, v236
    v_rsq_f32 v237, v237
    v_rsq_f32 v238, v238
    v_rsq_f32 v239, v239
    v_pk_fma_f32 v[228:229], v[232:233], v[16:17], v[228:229] neg_lo:[1,0,0] neg_hi:[1,0,0]
    v_pk_fma_f32 v[230:231], v[234:235], v[16:17], v[230:231] neg_lo:[1,0,0] neg_hi:[1,0,0]
    v_pk_fma_f32 v[4:5], v[228:229], v[236:237], v[18:19]
    v_pk_fma_f32 v[6:7], v[230:231], v[238:239], v[18:19]
    v_max3_f32 v21, v4, v5, v6
    v_max_f32 v21, v21, v7
    v_cmp_lt_f32 vcc, s50, v21
    v_exp_f32 v4, v4
    v_exp_f32 v5, v5
    v_exp_f32 v6, v6
    v_exp_f32 v7, v7
    s_cbranch_vccz L_sm40
    s_call_b64 s[48:49], L_rescale
L_sm40:
    v_pk_mul_f32 v[248:249], v[4:5], v[236:237]
    v_pk_add_f32 v[14:15], v[14:15], v[4:5]
    v_pk_mul_f32 v[250:251], v[6:7], v[238:239]
    v_pk_add_f32 v[14:15], v[14:15], v[6:7]
    v_mov_b32 v240, v248
    v_mov_b32 v241, v249
    v_mov_b32 v242, v250
    v_mov_b32 v243, v251
    v_pk_fma_f32 v[252:253], v[248:249], v[232:233], v[252:253]
    v_pk_fma_f32 v[252:253], v[250:251], v[234:235], v[252:253]
    s_add_u32 s51, s51, 1
    s_cmp_lg_u32 s57, 0
    s_cbranch_scc1 L_begun41
L_spin42:
    ds_read_b32 v3, v1 offset:6912
    s_waitcnt lgkmcnt(0)
    v_readfirstlane_b32 s52, v3
    s_nop 0
    s_cmp_ge_u32 s52, s51
    s_cbranch_scc1 L_spun43
    s_sleep 1
    s_branch L_spin42
L_spun43:
    ds_read_b128 v[124:127], v8
    ds_read_b128 v[128:131], v9
    ds_read_b128 v[132:135], v8 offset:128
    ds_read_b128 v[136:139], v9 offset:128
    ds_read_b128 v[140:143], v8 offset:256
    ds_read_b128 v[144:147], v9 offset:256
L_begun41:
    s_waitcnt lgkmcnt(5)
    v_mfma_f32_16x16x32_bf16 v[232:235], v[124:127], v[24:27], v[224:227]
    ds_read_b64_tr_b16 v[150:151], v10
    s_add_u32 s54, s54, 1
    s_cmp_eq_u32 s54, 6
    s_cselect_b32 s55, 0xffff8800, s56
    s_cselect_b32 s54, 0, s54
    v_mfma_f32_16x16x32_bf16 v[228:231], v[124:127], v[28:31], v[220:223]
    ds_read_b64_tr_b16 v[156:157], v11
    v_add_u32 v8, s55, v8
    s_waitcnt lgkmcnt(6)
    v_mfma_f32_16x16x32_bf16 v[232:235], v[128:131], v[24:27], v[232:235]
    ds_read_b64_tr_b16 v[162:163], v12
    ds_read_b64_tr_b16 v[168:169], v13
    v_mfma_f32_16x16x32_bf16 v[228:231], v[128:131], v[32:35], v[228:231]
    ds_read_b64_tr_b16 v[174:175], v10 offset:128
    v_add_u32 v9, s55, v9
    s_waitcnt lgkmcnt(8)
    v_mfma_f32_16x16x32_bf16 v[232:235], v[132:135], v[24:27], v[232:235]
    ds_read_b64_tr_b16 v[180:181], v11 offset:128
    ds_read_b64_tr_b16 v[186:187], v12 offset:128
    v_mfma_f32_16x16x32_bf16 v[228:231], v[132:135], v[36:39], v[228:231]
    ds_read_b64_tr_b16 v[192:193], v13 offset:128
    v_mov_b32 v2, s51
    s_waitcnt lgkmcnt(10)
    v_mfma_f32_16x16x32_bf16 v[232:235], v[136:139], v[24:27], v[232:235]
    ds_read_b64_tr_b16 v[198:199], v10 offset:256
    v_mfma_f32_16x16x32_bf16 v[228:231], v[136:139], v[40:43], v[228:231]
    ds_read_b64_tr_b16 v[204:205], v11 offset:256
    s_waitcnt lgkmcnt(11)
    v_mfma_f32_16x16x32_bf16 v[232:235], v[140:143], v[24:27], v[232:235]
    ds_read_b64_tr_b16 v[210:211], v12 offset:256
    v_mfma_f32_16x16x32_bf16 v[228:231], v[140:143], v[44:47], v[228:231]
    ds_read_b64_tr_b16 v[216:217], v13 offset:256
    ds_read_b32 v3, v1 offset:6912
    s_waitcnt lgkmcnt(13)
    v_mfma_f32_16x16x32_bf16 v[232:235], v[144:147], v[24:27], v[232:235]
    v_add_u32 v10, s55, v10
    v_add_u32 v11, s55, v11
    v_mfma_f32_16x16x32_bf16 v[228:231], v[144:147], v[48:51], v[228:231]
    v_add_u32 v12, s55, v12
    v_add_u32 v13, s55, v13
    s_waitcnt lgkmcnt(0)
    ds_write_b32 v1, v2 offset:6928
    v_dot2_f32_bf16 v22, v124, v124, v255
    v_dot2_f32_bf16 v23, v124, v100, 0
    v_dot2_f32_bf16 v22, v125, v125, v22
    v_dot2_f32_bf16 v23, v125, v101, v23
    v_dot2_f32_bf16 v22, v126, v126, v22
    v_dot2_f32_bf16 v23, v126, v102, v23
    v_dot2_f32_bf16 v22, v127, v127, v22
    v_dot2_f32_bf16 v23, v127, v103, v23
    v_dot2_f32_bf16 v22, v128, v128, v22
    v_dot2_f32_bf16 v23, v128, v104, v23
    v_dot2_f32_bf16 v22, v129, v129, v22
    v_dot2_f32_bf16 v23, v129, v105, v23
    v_dot2_f32_bf16 v22, v130, v130, v22
    v_dot2_f32_bf16 v23, v130, v106, v23
    v_dot2_f32_bf16 v22, v131, v131, v22
    v_dot2_f32_bf16 v23, v131, v107, v23
    v_dot2_f32_bf16 v22, v132, v132, v22
    v_dot2_f32_bf16 v23, v132, v108, v23
    v_dot2_f32_bf16 v22, v133, v133, v22
    v_dot2_f32_bf16 v23, v133, v109, v23
    v_dot2_f32_bf16 v22, v134, v134, v22
    v_dot2_f32_bf16 v23, v134, v110, v23
    v_dot2_f32_bf16 v22, v135, v135, v22
    v_dot2_f32_bf16 v23, v135, v111, v23
    v_dot2_f32_bf16 v22, v136, v136, v22
    v_dot2_f32_bf16 v23, v136, v112, v23
    v_dot2_f32_bf16 v22, v137, v137, v22
    v_dot2_f32_bf16 v23, v137, v113, v23
    v_dot2_f32_bf16 v22, v138, v138, v22
    v_dot2_f32_bf16 v23, v138, v114, v23
    v_dot2_f32_bf16 v22, v139, v139, v22
    v_dot2_f32_bf16 v23, v139, v115, v23
    v_dot2_f32_bf16 v22, v140, v140, v22
    v_dot2_f32_bf16 v23, v140, v116, v23
    v_dot2_f32_bf16 v22, v141, v141, v22
    v_dot2_f32_bf16 v23, v141, v117, v23
    v_dot2_f32_bf16 v22, v142, v142, v22
    v_dot2_f32_bf16 v23, v142, v118, v23
    v_dot2_f32_bf16 v22, v143, v143, v22
    v_dot2_f32_bf16 v23, v143, v119, v23
    v_dot2_f32_bf16 v22, v144, v144, v22
    v_dot2_f32_bf16 v23, v144, v120, v23
    v_dot2_f32_bf16 v22, v145, v145, v22
    v_dot2_f32_bf16 v23, v145, v121, v23
    v_dot2_f32_bf16 v22, v146, v146, v22
    v_dot2_f32_bf16 v23, v146, v122, v23
    v_dot2_f32_bf16 v22, v147, v147, v22
    v_dot2_f32_bf16 v23, v147, v123, v23
    s_nop 2
    v_fma_f32 v22, v23, 2.0, v22
    s_nop 1
    v_mfma_f32_16x16x4_f32 v[236:239], v22, v20, 0
    v_readfirstlane_b32 s52, v3
    s_mov_b32 s57, 0
    s_nop 0
    s_cmp_gt_u32 s52, s51
    s_cbranch_scc0 L_early44
    s_mov_b32 s57, 1
    ds_read_b128 v[124:127], v8
    ds_read_b128 v[128:131], v9
    ds_read_b128 v[132:135], v8 offset:128
    ds_read_b128 v[136:139], v9 offset:128
    ds_read_b128 v[140:143], v8 offset:256
    ds_read_b128 v[144:147], v9 offset:256
L_early44:
    v_pk_mul_f32 v[232:233], v[232:233], s[44:45]
    v_pk_mul_f32 v[234:235], v[234:235], s[44:45]
    v_pk_fma_f32 v[4:5], v[232:233], v[232:233], s[46:47] neg_lo:[1,0,0] neg_hi:[1,0,0]
    v_pk_fma_f32 v[6:7], v[234:235], v[234:235], s[46:47] neg_lo:[1,0,0] neg_hi:[1,0,0]
    s_nop 0
    v_pk_fma_f32 v[236:237], v[236:237], s[44:45], v[4:5]
    v_pk_fma_f32 v[238:239], v[238:239], s[44:45], v[6:7]
    v_max_f32 v236, s46, v236
    v_max_f32 v237, s46, v237
    v_max_f32 v238, s46, v238
    v_max_f32 v239, s46, v239
    v_rsq_f32 v236, v236
    v_rsq_f32 v237, v237
    v_rsq_f32 v238, v238
    v_rsq_f32 v239, v239
    v_pk_fma_f32 v[228:229], v[232:233], v[16:17], v[228:229] neg_lo:[1,0,0] neg_hi:[1,0,0]
    v_pk_fma_f32 v[230:231], v[234:235], v[16:17], v[230:231] neg_lo:[1,0,0] neg_hi:[1,0,0]
    v_pk_fma_f32 v[4:5], v[228:229], v[236:237], v[18:19]
    v_pk_fma_f32 v[6:7], v[230:231], v[238:239], v[18:19]
    v_max3_f32 v21, v4, v5, v6
    v_max_f32 v21, v21, v7
    v_cmp_lt_f32 vcc, s50, v21
    v_exp_f32 v4, v4
    v_exp_f32 v5, v5
    v_exp_f32 v6, v6
    v_exp_f32 v7, v7
    s_cbranch_vccz L_sm45
    s_call_b64 s[48:49], L_rescale
L_sm45:
    v_pk_mul_f32 v[228:229], v[4:5], v[236:237]
    v_pk_add_f32 v[14:15], v[14:15], v[4:5]
    v_pk_mul_f32 v[230:231], v[6:7], v[238:239]
    v_pk_add_f32 v[14:15], v[14:15], v[6:7]
    v_pk_add_f32 v[240:241], v[240:241], v[228:229]
    v_pk_add_f32 v[242:243], v[242:243], v[230:231]
    v_pk_fma_f32 v[252:253], v[228:229], v[232:233], v[252:253]
    v_pk_fma_f32 v[252:253], v[230:231], v[234:235], v[252:253]
    v_cvt_pk_bf16_f32 v244, v248, v249
    v_cvt_pk_bf16_f32 v245, v250, v251
    v_cvt_pk_bf16_f32 v246, v228, v229
    v_cvt_pk_bf16_f32 v247, v230, v231
    s_add_u32 s51, s51, 1
    s_cmp_lg_u32 s57, 0
    s_cbranch_scc1 L_begun46
L_spin47:
    ds_read_b32 v3, v1 offset:6912
    s_waitcnt lgkmcnt(0)
    v_readfirstlane_b32 s52, v3
    s_nop 0
    s_cmp_ge_u32 s52, s51
    s_cbranch_scc1 L_spun48
    s_sleep 1
    s_branch L_spin47
L_spun48:
    ds_read_b128 v[124:127], v8
    ds_read_b128 v[128:131], v9
    ds_read_b128 v[132:135], v8 offset:128
    ds_read_b128 v[136:139], v9 offset:128
    ds_read_b128 v[140:143], v8 offset:256
    ds_read_b128 v[144:147], v9 offset:256
L_begun46:
    v_mov_b32 v21, 0
    v_mfma_f32_16x16x32_bf16 v[52:55], v[148:151], v[244:247], v[52:55]
    ds_read_b64_tr_b16 v[148:149], v10
    ds_read_b64 v[150:151], v21 offset:7056
    v_mfma_f32_16x16x32_bf16 v[56:59], v[154:157], v[244:247], v[56:59]
    ds_read_b64_tr_b16 v[154:155], v11
    ds_read_b64 v[156:157], v21 offset:7056
    v_mfma_f32_16x16x32_bf16 v[60:63], v[160:163], v[244:247], v[60:63]
    ds_read_b64_tr_b16 v[160:161], v12
    ds_read_b64 v[162:163], v21 offset:7056
    v_mfma_f32_16x16x32_bf16 v[64:67], v[166:169], v[244:247], v[64:67]
    ds_read_b64_tr_b16 v[166:167], v13
    ds_read_b64 v[168:169], v21 offset:7056
    v_mfma_f32_16x16x32_bf16 v[68:71], v[172:175], v[244:247], v[68:71]
    ds_read_b64_tr_b16 v[172:173], v10 offset:128
    ds_read_b64 v[174:175], v21 offset:7056
    v_mfma_f32_16x16x32_bf16 v[72:75], v[178:181], v[244:247], v[72:75]
    ds_read_b64_tr_b16 v[178:179], v11 offset:128
    ds_read_b64 v[180:181], v21 offset:7056
    v_mfma_f32_16x16x32_bf16 v[76:79], v[184:187], v[244:247], v[76:79]
    ds_read_b64_tr_b16 v[184:185], v12 offset:128
    ds_read_b64 v[186:187], v21 offset:7056
    v_mfma_f32_16x16x32_bf16 v[80:83], v[190:193], v[244:247], v[80:83]
    ds_read_b64_tr_b16 v[190:191], v13 offset:128
    ds_read_b64 v[192:193], v21 offset:7056
    v_mfma_f32_16x16x32_bf16 v[84:87], v[196:199], v[244:247], v[84:87]
    ds_read_b64_tr_b16 v[196:197], v10 offset:256
    ds_read_b64 v[198:199], v21 offset:7056
    v_mfma_f32_16x16x32_bf16 v[88:91], v[202:205], v[244:247], v[88:91]
    ds_read_b64_tr_b16 v[202:203], v11 offset:256
    ds_read_b64 v[204:205], v21 offset:7056
    v_mfma_f32_16x16x32_bf16 v[92:95], v[208:211], v[244:247], v[92:95]
    ds_read_b64_tr_b16 v[208:209], v12 offset:256
    ds_read_b64 v[210:211], v21 offset:7056
    v_mfma_f32_16x16x32_bf16 v[96:99], v[214:217], v[244:247], v[96:99]
    ds_read_b64_tr_b16 v[214:215], v13 offset:256
    ds_read_b64 v[216:217], v21 offset:7056
    s_nop 5
L_tile2b:
    s_waitcnt lgkmcnt(15)
    v_mfma_f32_16x16x32_bf16 v[232:235], v[124:127], v[24:27], v[224:227]
    s_add_u32 s54, s54, 1
    s_cmp_eq_u32 s54, 6
    s_cselect_b32 s55, 0xffff8800, s56
    s_cselect_b32 s54, 0, s54
    v_mfma_f32_16x16x32_bf16 v[228:231], v[124:127], v[28:31], v[220:223]
    v_add_u32 v8, s55, v8
    v_mfma_f32_16x16x32_bf16 v[232:235], v[128:131], v[24:27], v[232:235]
    v_mfma_f32_16x16x32_bf16 v[228:231], v[128:131], v[32:35], v[228:231]
    v_add_u32 v9, s55, v9
    v_mfma_f32_16x16x32_bf16 v[232:235], v[132:135], v[24:27], v[232:235]
    v_mfma_f32_16x16x32_bf16 v[228:231], v[132:135], v[36:39], v[228:231]
    v_mov_b32 v2, s51
    v_mfma_f32_16x16x32_bf16 v[232:235], v[136:139], v[24:27], v[232:235]
    v_mfma_f32_16x16x32_bf16 v[228:231], v[136:139], v[40:43], v[228:231]
    v_mfma_f32_16x16x32_bf16 v[232:235], v[140:143], v[24:27], v[232:235]
    v_mfma_f32_16x16x32_bf16 v[228:231], v[140:143], v[44:47], v[228:231]
    ds_read_b32 v3, v1 offset:6912
    v_mfma_f32_16x16x32_bf16 v[232:235], v[144:147], v[24:27], v[232:235]
    v_add_u32 v10, s55, v10
    v_add_u32 v11, s55, v11
    v_mfma_f32_16x16x32_bf16 v[228:231], v[144:147], v[48:51], v[228:231]
    v_add_u32 v12, s55, v12
    v_add_u32 v13, s55, v13
    s_waitcnt lgkmcnt(0)
    ds_write_b32 v1, v2 offset:6928
    v_dot2_f32_bf16 v22, v124, v124, v255
    v_dot2_f32_bf16 v23, v124, v100, 0
    v_dot2_f32_bf16 v22, v125, v125, v22
    v_dot2_f32_bf16 v23, v125, v101, v23
    v_dot2_f32_bf16 v22, v126, v126, v22
    v_dot2_f32_bf16 v23, v126, v102, v23
    v_dot2_f32_bf16 v22, v127, v127, v22
    v_dot2_f32_bf16 v23, v127, v103, v23
    v_dot2_f32_bf16 v22, v128, v128, v22
    v_dot2_f32_bf16 v23, v128, v104, v23
    v_dot2_f32_bf16 v22, v129, v129, v22
    v_dot2_f32_bf16 v23, v129, v105, v23
    v_dot2_f32_bf16 v22, v130, v130, v22
    v_dot2_f32_bf16 v23, v130, v106, v23
    v_dot2_f32_bf16 v22, v131, v131, v22
    v_dot2_f32_bf16 v23, v131, v107, v23
    v_dot2_f32_bf16 v22, v132, v132, v22
    v_dot2_f32_bf16 v23, v132, v108, v23
    v_dot2_f32_bf16 v22, v133, v133, v22
    v_dot2_f32_bf16 v23, v133, v109, v23
    v_dot2_f32_bf16 v22, v134, v134, v22
    v_dot2_f32_bf16 v23, v134, v110, v23
    v_dot2_f32_bf16 v22, v135, v135, v22
    v_dot2_f32_bf16 v23, v135, v111, v23
    v_dot2_f32_bf16 v22, v136, v136, v22
    v_dot2_f32_bf16 v23, v136, v112, v23
    v_dot2_f32_bf16 v22, v137, v137, v22
    v_dot2_f32_bf16 v23, v137, v113, v23
    v_dot2_f32_bf16 v22, v138, v138, v22
    v_dot2_f32_bf16 v23, v138, v114, v23
    v_dot2_f32_bf16 v22, v139, v139, v22
    v_dot2_f32_bf16 v23, v139, v115, v23
    v_dot2_f32_bf16 v22, v140, v140, v22
    v_dot2_f32_bf16 v23, v140, v116, v23
    v_dot2_f32_bf16 v22, v141, v141, v22
    v_dot2_f32_bf16 v23, v141, v117, v23
    v_dot2_f32_bf16 v22, v142, v142, v22
    v_dot2_f32_bf16 v23, v142, v118, v23
    v_dot2_f32_bf16 v22, v143, v143, v22
    v_dot2_f32_bf16 v23, v143, v119, v23
    v_dot2_f32_bf16 v22, v144, v144, v22
    v_dot2_f32_bf16 v23, v144, v120, v23
    v_dot2_f32_bf16 v22, v145, v145, v22
    v_dot2_f32_bf16 v23, v145, v121, v23
    v_dot2_f32_bf16 v22, v146, v146, v22
    v_dot2_f32_bf16 v23, v146, v122, v23
    v_dot2_f32_bf16 v22, v147, v147, v22
    v_dot2_f32_bf16 v23, v147, v123, v23
    s_nop 2
    v_fma_f32 v22, v23, 2.0, v22
    s_nop 1
    v_mfma_f32_16x16x4_f32 v[236:239], v22, v20, 0
    v_readfirstlane_b32 s52, v3
    s_mov_b32 s57, 0
    s_nop 0
    s_cmp_gt_u32 s52, s51
    s_cbranch_scc0 L_early49
    s_mov_b32 s57, 1
    ds_read_b128 v[124:127], v8
    ds_read_b128 v[128:131], v9
    ds_read_b128 v[132:135], v8 offset:128
    ds_read_b128 v[136:139], v9 offset:128
    ds_read_b128 v[140:143], v8 offset:256
    ds_read_b128 v[144:147], v9 offset:256
L_early49:
    ds_read_b32 v3, v1 offset:6912
    v_pk_mul_f32 v[232:233], v[232:233], s[44:45]
    v_pk_mul_f32 v[234:235], v[234:235], s[44:45]
    v_pk_fma_f32 v[4:5], v[232:233], v[232:233], s[46:47] neg_lo:[1,0,0] neg_hi:[1,0,0]
    v_pk_fma_f32 v[6:7], v[234:235], v[234:235], s[46:47] neg_lo:[1,0,0] neg_hi:[1,0,0]
    v_pk_fma_f32 v[236:237], v[236:237], s[44:45], v[4:5]
    v_pk_fma_f32 v[238:239], v[238:239], s[44:45], v[6:7]
    v_max_f32 v236, s46, v236
    v_max_f32 v237, s46, v237
    v_max_f32 v238, s46, v238
    v_max_f32 v239, s46, v239
    v_rsq_f32 v236, v236
    v_rsq_f32 v237, v237
    v_rsq_f32 v238, v238
    v_rsq_f32 v239, v239
    v_pk_fma_f32 v[228:229], v[232:233], v[16:17], v[228:229] neg_lo:[1,0,0] neg_hi:[1,0,0]
    v_pk_fma_f32 v[230:231], v[234:235], v[16:17], v[230:231] neg_lo:[1,0,0] neg_hi:[1,0,0]
    v_pk_fma_f32 v[4:5], v[228:229], v[236:237], v[18:19]
    v_pk_fma_f32 v[6:7], v[230:231], v[238:239], v[18:19]
    v_max3_f32 v21, v4, v5, v6
    v_max_f32 v21, v21, v7
    v_cmp_lt_f32 vcc, s50, v21
    v_exp_f32 v4, v4
    v_exp_f32 v5, v5
    v_exp_f32 v6, v6
    v_exp_f32 v7, v7
    s_cbranch_vccz L_sm50
    s_call_b64 s[48:49], L_rescale
L_sm50:
    v_pk_mul_f32 v[248:249], v[4:5], v[236:237]
    v_pk_add_f32 v[14:15], v[14:15], v[4:5]
    v_pk_mul_f32 v[250:251], v[6:7], v[238:239]
    v_pk_add_f32 v[14:15], v[14:15], v[6:7]
    v_pk_add_f32 v[240:241], v[240:241], v[248:249]
    v_pk_add_f32 v[242:243], v[242:243], v[250:251]
    v_pk_fma_f32 v[252:253], v[248:249], v[232:233], v[252:253]
    v_pk_fma_f32 v[252:253], v[250:251], v[234:235], v[252:253]
    v_cvt_pk_bf16_f32 v244, v248, v249
    v_cvt_pk_bf16_f32 v245, v250, v251
    v_cvt_pk_bf16_f32 v246, -v252, -v253
    v_mov_b32 v247, 0
    s_waitcnt lgkmcnt(0)
    v_readfirstlane_b32 s52, v3
    s_cmp_lg_u32 s57, 0
    s_cbranch_scc1 L_early51
    s_cmp_gt_u32 s52, s51
    s_cbranch_scc0 L_early51
    s_mov_b32 s57, 1
    ds_read_b128 v[124:127], v8
    ds_read_b128 v[128:131], v9
    ds_read_b128 v[132:135], v8 offset:128
    ds_read_b128 v[136:139], v9 offset:128
    ds_read_b128 v[140:143], v8 offset:256
    ds_read_b128 v[144:147], v9 offset:256
L_early51:
    v_mfma_f32_16x16x32_bf16 v[52:55], v[148:151], v[244:247], v[52:55]
    v_mfma_f32_16x16x32_bf16 v[56:59], v[154:157], v[244:247], v[56:59]
    v_mfma_f32_16x16x32_bf16 v[60:63], v[160:163], v[244:247], v[60:63]
    v_mfma_f32_16x16x32_bf16 v[64:67], v[166:169], v[244:247], v[64:67]
    v_mfma_f32_16x16x32_bf16 v[68:71], v[172:175], v[244:247], v[68:71]
    v_mfma_f32_16x16x32_bf16 v[72:75], v[178:181], v[244:247], v[72:75]
    v_mfma_f32_16x16x32_bf16 v[76:79], v[184:187], v[244:247], v[76:79]
    v_mfma_f32_16x16x32_bf16 v[80:83], v[190:193], v[244:247], v[80:83]
    v_mfma_f32_16x16x32_bf16 v[84:87], v[196:199], v[244:247], v[84:87]
    v_mfma_f32_16x16x32_bf16 v[88:91], v[202:205], v[244:247], v[88:91]
    v_mfma_f32_16x16x32_bf16 v[92:95], v[208:211], v[244:247], v[92:95]
    v_mfma_f32_16x16x32_bf16 v[96:99], v[214:217], v[244:247], v[96:99]
    s_cmp_eq_u32 s41, 3
    s_cbranch_scc1 L_last
    s_add_u32 s51, s51, 1
    s_cmp_lg_u32 s57, 0
    s_cbranch_scc1 L_begun52
    s_nop 2
L_spin53:
    ds_read_b32 v3, v1 offset:6912
    s_waitcnt lgkmcnt(0)
    v_readfirstlane_b32 s52, v3
    s_nop 0
    s_cmp_ge_u32 s52, s51
    s_cbranch_scc1 L_spun54
    s_sleep 1
    s_branch L_spin53
L_spun54:
    ds_read_b128 v[124:127], v8
    ds_read_b128 v[128:131], v9
    ds_read_b128 v[132:135], v8 offset:128
    ds_read_b128 v[136:139], v9 offset:128
    ds_read_b128 v[140:143], v8 offset:256
    ds_read_b128 v[144:147], v9 offset:256
L_begun52:
    s_waitcnt lgkmcnt(5)
    v_mfma_f32_16x16x32_bf16 v[232:235], v[124:127], v[24:27], v[224:227]
    ds_read_b64_tr_b16 v[150:151], v10
    s_add_u32 s54, s54, 1
    s_cmp_eq_u32 s54, 6
    s_cselect_b32 s55, 0xffff8800, s56
    s_cselect_b32 s54, 0, s54
    v_mfma_f32_16x16x32_bf16 v[228:231], v[124:127], v[28:31], v[220:223]
    ds_read_b64_tr_b16 v[156:157], v11
    v_add_u32 v8, s55, v8
    s_waitcnt lgkmcnt(6)
    v_mfma_f32_16x16x32_bf16 v[232:235], v[128:131], v[24:27], v[232:235]
    ds_read_b64_tr_b16 v[162:163], v12
    ds_read_b64_tr_b16 v[168:169], v13
    v_mfma_f32_16x16x32_bf16 v[228:231], v[128:131], v[32:35], v[228:231]
    ds_read_b64_tr_b16 v[174:175], v10 offset:128
    v_add_u32 v9, s55, v9
    s_waitcnt lgkmcnt(8)
    v_mfma_f32_16x16x32_bf16 v[232:235], v[132:135], v[24:27], v[232:235]
    ds_read_b64_tr_b16 v[180:181], v11 offset:128
    ds_read_b64_tr_b16 v[186:187], v12 offset:128
    v_mfma_f32_16x16x32_bf16 v[228:231], v[132:135], v[36:39], v[228:231]
    ds_read_b64_tr_b16 v[192:193], v13 offset:128
    v_mov_b32 v2, s51
    s_waitcnt lgkmcnt(10)
    v_mfma_f32_16x16x32_bf16 v[232:235], v[136:139], v[24:27], v[232:235]
    ds_read_b64_tr_b16 v[198:199], v10 offset:256
    v_mfma_f32_16x16x32_bf16 v[228:231], v[136:139], v[40:43], v[228:231]
    ds_read_b64_tr_b16 v[204:205], v11 offset:256
    s_waitcnt lgkmcnt(11)
    v_mfma_f32_16x16x32_bf16 v[232:235], v[140:143], v[24:27], v[232:235]
    ds_read_b64_tr_b16 v[210:211], v12 offset:256
    v_mfma_f32_16x16x32_bf16 v[228:231], v[140:143], v[44:47], v[228:231]
    ds_read_b64_tr_b16 v[216:217], v13 offset:256
    ds_read_b32 v3, v1 offset:6912
    s_waitcnt lgkmcnt(13)
    v_mfma_f32_16x16x32_bf16 v[232:235], v[144:147], v[24:27], v[232:235]
    v_add_u32 v10, s55, v10
    v_add_u32 v11, s55, v11
    v_mfma_f32_16x16x32_bf16 v[228:231], v[144:147], v[48:51], v[228:231]
    v_add_u32 v12, s55, v12
    v_add_u32 v13, s55, v13
    s_waitcnt lgkmcnt(0)
    ds_write_b32 v1, v2 offset:6928
    v_dot2_f32_bf16 v22, v124, v124, v255
    v_dot2_f32_bf16 v23, v124, v100, 0
    v_dot2_f32_bf16 v22, v125, v125, v22
    v_dot2_f32_bf16 v23, v125, v101, v23
    v_dot2_f32_bf16 v22, v126, v126, v22
    v_dot2_f32_bf16 v23, v126, v102, v23
    v_dot2_f32_bf16 v22, v127, v127, v22
    v_dot2_f32_bf16 v23, v127, v103, v23
    v_dot2_f32_bf16 v22, v128, v128, v22
    v_dot2_f32_bf16 v23, v128, v104, v23
    v_dot2_f32_bf16 v22, v129, v129, v22
    v_dot2_f32_bf16 v23, v129, v105, v23
    v_dot2_f32_bf16 v22, v130, v130, v22
    v_dot2_f32_bf16 v23, v130, v106, v23
    v_dot2_f32_bf16 v22, v131, v131, v22
    v_dot2_f32_bf16 v23, v131, v107, v23
    v_dot2_f32_bf16 v22, v132, v132, v22
    v_dot2_f32_bf16 v23, v132, v108, v23
    v_dot2_f32_bf16 v22, v133, v133, v22
    v_dot2_f32_bf16 v23, v133, v109, v23
    v_dot2_f32_bf16 v22, v134, v134, v22
    v_dot2_f32_bf16 v23, v134, v110, v23
    v_dot2_f32_bf16 v22, v135, v135, v22
    v_dot2_f32_bf16 v23, v135, v111, v23
    v_dot2_f32_bf16 v22, v136, v136, v22
    v_dot2_f32_bf16 v23, v136, v112, v23
    v_dot2_f32_bf16 v22, v137, v137, v22
    v_dot2_f32_bf16 v23, v137, v113, v23
    v_dot2_f32_bf16 v22, v138, v138, v22
    v_dot2_f32_bf16 v23, v138, v114, v23
    v_dot2_f32_bf16 v22, v139, v139, v22
    v_dot2_f32_bf16 v23, v139, v115, v23
    v_dot2_f32_bf16 v22, v140, v140, v22
    v_dot2_f32_bf16 v23, v140, v116, v23
    v_dot2_f32_bf16 v22, v141, v141, v22
    v_dot2_f32_bf16 v23, v141, v117, v23
    v_dot2_f32_bf16 v22, v142, v142, v22
    v_dot2_f32_bf16 v23, v142, v118, v23
    v_dot2_f32_bf16 v22, v143, v143, v22
    v_dot2_f32_bf16 v23, v143, v119, v23
    v_dot2_f32_bf16 v22, v144, v144, v22
    v_dot2_f32_bf16 v23, v144, v120, v23
    v_dot2_f32_bf16 v22, v145, v145, v22
    v_dot2_f32_bf16 v23, v145, v121, v23
    v_dot2_f32_bf16 v22, v146, v146, v22
    v_dot2_f32_bf16 v23, v146, v122, v23
    v_dot2_f32_bf16 v22, v147, v147, v22
    v_dot2_f32_bf16 v23, v147, v123, v23
    s_nop 2
    v_fma_f32 v22, v23, 2.0, v22
    s_nop 1
    v_mfma_f32_16x16x4_f32 v[236:239], v22, v20, 0
    v_readfirstlane_b32 s52, v3
    s_mov_b32 s57, 0
    s_nop 0
    s_cmp_gt_u32 s52, s51
    s_cbranch_scc0 L_early55
    s_mov_b32 s57, 1
    ds_read_b128 v[100:103], v8
    ds_read_b128 v[104:107], v9
    ds_read_b128 v[108:111], v8 offset:128
    ds_read_b128 v[112:115], v9 offset:128
    ds_read_b128 v[116:119], v8 offset:256
    ds_read_b128 v[120:123], v9 offset:256
L_early55:
    v_pk_mul_f32 v[232:233], v[232:233], s[44:45]
    v_pk_mul_f32 v[234:235], v[234:235], s[44:45]
    v_pk_fma_f32 v[4:5], v[232:233], v[232:233], s[46:47] neg_lo:[1,0,0] neg_hi:[1,0,0]
    v_pk_fma_f32 v[6:7], v[234:235], v[234:235], s[46:47] neg_lo:[1,0,0] neg_hi:[1,0,0]
    s_nop 0
    v_pk_fma_f32 v[236:237], v[236:237], s[44:45], v[4:5]
    v_pk_fma_f32 v[238:239], v[238:239], s[44:45], v[6:7]
    v_max_f32 v236, s46, v236
    v_max_f32 v237, s46, v237
    v_max_f32 v238, s46, v238
    v_max_f32 v239, s46, v239
    v_rsq_f32 v236, v236
    v_rsq_f32 v237, v237
    v_rsq_f32 v238, v238
    v_rsq_f32 v239, v239
    v_pk_fma_f32 v[228:229], v[232:233], v[16:17], v[228:229] neg_lo:[1,0,0] neg_hi:[1,0,0]
    v_pk_fma_f32 v[230:231], v[234:235], v[16:17], v[230:231] neg_lo:[1,0,0] neg_hi:[1,0,0]
    v_pk_fma_f32 v[4:5], v[228:229], v[236:237], v[18:19]
    v_pk_fma_f32 v[6:7], v[230:231], v[238:239], v[18:19]
    v_max3_f32 v21, v4, v5, v6
    v_max_f32 v21, v21, v7
    v_cmp_lt_f32 vcc, s50, v21
    v_exp_f32 v4, v4
    v_exp_f32 v5, v5
    v_exp_f32 v6, v6
    v_exp_f32 v7, v7
    s_cbranch_vccz L_sm56
    s_call_b64 s[48:49], L_rescale
L_sm56:
    v_pk_mul_f32 v[228:229], v[4:5], v[236:237]
    v_pk_add_f32 v[14:15], v[14:15], v[4:5]
    v_pk_mul_f32 v[230:231], v[6:7], v[238:239]
    v_pk_add_f32 v[14:15], v[14:15], v[6:7]
    v_pk_add_f32 v[240:241], v[240:241], v[228:229]
    v_pk_add_f32 v[242:243], v[242:243], v[230:231]
    v_pk_mul_f32 v[252:253], v[228:229], v[232:233]
    v_pk_fma_f32 v[252:253], v[230:231], v[234:235], v[252:253]
    v_cvt_pk_bf16_f32 v244, v228, v229
    v_cvt_pk_bf16_f32 v245, v230, v231
    v_cvt_pk_bf16_f32 v246, v240, v241
    v_cvt_pk_bf16_f32 v247, v242, v243
    s_add_u32 s41, s41, 1
    s_nop 0
    s_branch L_loop
L_last:
    s_setprio 2
    v_and_b32 v22, 15, v0
    v_lshrrev_b32 v23, 4, v0
    v_lshlrev_b32 v148, 4, v0
    v_lshlrev_b32 v23, 2, v23
    v_add_u32 v148, s36, v148
    v_lshl_add_u32 v149, v22, 4, v23
    v_add_u32 v149, s36, v149
    s_add_u32 s51, s51, 1
    s_cmp_lg_u32 s57, 0
    s_cbranch_scc1 L_begun57
L_spin58:
    ds_read_b32 v3, v1 offset:6912
    s_waitcnt lgkmcnt(0)
    v_readfirstlane_b32 s52, v3
    s_nop 0
    s_cmp_ge_u32 s52, s51
    s_cbranch_scc0 L_spin58
    ds_read_b128 v[124:127], v8
    ds_read_b128 v[128:131], v9
    ds_read_b128 v[132:135], v8 offset:128
    ds_read_b128 v[136:139], v9 offset:128
    ds_read_b128 v[140:143], v8 offset:256
    ds_read_b128 v[144:147], v9 offset:256
L_begun57:
    s_waitcnt lgkmcnt(5)
    v_mfma_f32_16x16x32_bf16 v[236:239], v[124:127], v[124:127], 0
    v_mfma_f32_16x16x32_bf16 v[4:7], v[124:127], v[100:103], 0
    ds_read_b64_tr_b16 v[150:151], v10
    s_waitcnt lgkmcnt(5)
    v_mfma_f32_16x16x32_bf16 v[236:239], v[128:131], v[128:131], v[236:239]
    v_mfma_f32_16x16x32_bf16 v[4:7], v[128:131], v[104:107], v[4:7]
    ds_read_b64_tr_b16 v[156:157], v11
    s_waitcnt lgkmcnt(5)
    v_mfma_f32_16x16x32_bf16 v[236:239], v[132:135], v[132:135], v[236:239]
    ds_read_b64_tr_b16 v[162:163], v12
    v_mfma_f32_16x16x32_bf16 v[4:7], v[132:135], v[108:111], v[4:7]
    ds_read_b64_tr_b16 v[168:169], v13
    s_waitcnt lgkmcnt(6)
    v_mfma_f32_16x16x32_bf16 v[236:239], v[136:139], v[136:139], v[236:239]
    ds_read_b64_tr_b16 v[174:175], v10 offset:128
    v_mfma_f32_16x16x32_bf16 v[4:7], v[136:139], v[112:115], v[4:7]
    ds_read_b64_tr_b16 v[180:181], v11 offset:128
    s_waitcnt lgkmcnt(7)
    v_mfma_f32_16x16x32_bf16 v[236:239], v[140:143], v[140:143], v[236:239]
    ds_read_b64_tr_b16 v[186:187], v12 offset:128
    v_mfma_f32_16x16x32_bf16 v[4:7], v[140:143], v[116:119], v[4:7]
    ds_read_b64_tr_b16 v[192:193], v13 offset:128
    s_waitcnt lgkmcnt(8)
    v_mfma_f32_16x16x32_bf16 v[236:239], v[144:147], v[144:147], v[236:239]
    ds_read_b64_tr_b16 v[198:199], v10 offset:256
    v_mfma_f32_16x16x32_bf16 v[4:7], v[144:147], v[120:123], v[4:7]
    ds_read_b64_tr_b16 v[204:205], v11 offset:256
    v_mfma_f32_16x16x32_bf16 v[232:235], v[124:127], v[24:27], v[224:227]
    ds_read_b64_tr_b16 v[210:211], v12 offset:256
    v_mfma_f32_16x16x32_bf16 v[232:235], v[128:131], v[24:27], v[232:235]
    ds_read_b64_tr_b16 v[216:217], v13 offset:256
    s_nop 2
    v_mfma_f32_16x16x32_bf16 v[232:235], v[132:135], v[24:27], v[232:235]
    v_cndmask_b32 v22, v236, v237, s[58:59]
    v_cndmask_b32 v23, v238, v239, s[58:59]
    v_mfma_f32_16x16x32_bf16 v[232:235], v[136:139], v[24:27], v[232:235]
    v_cndmask_b32 v4, v4, v5, s[58:59]
    v_cndmask_b32 v6, v6, v7, s[58:59]
    v_mfma_f32_16x16x32_bf16 v[232:235], v[140:143], v[24:27], v[232:235]
    v_cndmask_b32 v22, v22, v23, s[60:61]
    v_cndmask_b32 v4, v4, v6, s[60:61]
    v_mfma_f32_16x16x32_bf16 v[232:235], v[144:147], v[24:27], v[232:235]
    v_fma_f32 v22, v4, 2.0, v22
    v_cndmask_b32 v22, 0, v22, s[38:39]
    v_add_f32 v22, v22, v255
    v_mfma_f32_16x16x32_bf16 v[228:231], v[124:127], v[28:31], v[220:223]
    s_nop 0
    v_mfma_f32_16x16x4_f32 v[236:239], v22, v20, 0
    v_mfma_f32_16x16x32_bf16 v[228:231], v[128:131], v[32:35], v[228:231]
    v_mfma_f32_16x16x32_bf16 v[228:231], v[132:135], v[36:39], v[228:231]
    v_mul_f32 v232, s44, v232
    v_mul_f32 v233, s44, v233
    v_mfma_f32_16x16x32_bf16 v[228:231], v[136:139], v[40:43], v[228:231]
    v_mul_f32 v234, s44, v234
    v_mul_f32 v235, s44, v235
    v_mfma_f32_16x16x32_bf16 v[228:231], v[140:143], v[44:47], v[228:231]
    v_fma_f32 v4, -v232, v232, s46
    v_fma_f32 v5, -v233, v233, s46
    v_mfma_f32_16x16x32_bf16 v[228:231], v[144:147], v[48:51], v[228:231]
    v_fma_f32 v6, -v234, v234, s46
    v_fma_f32 v7, -v235, v235, s46
    s_waitcnt lgkmcnt(0)
    v_pk_fma_f32 v[236:237], v[236:237], s[44:45], v[4:5]
    v_pk_fma_f32 v[238:239], v[238:239], s[44:45], v[6:7]
    v_max_f32 v236, s46, v236
    v_max_f32 v237, s46, v237
    v_max_f32 v238, s46, v238
    v_max_f32 v239, s46, v239
    v_rsq_f32 v236, v236
    v_rsq_f32 v237, v237
    v_rsq_f32 v238, v238
    v_rsq_f32 v239, v239
    v_pk_fma_f32 v[228:229], v[232:233], v[16:17], v[228:229] neg_lo:[1,0,0] neg_hi:[1,0,0]
    v_pk_fma_f32 v[230:231], v[234:235], v[16:17], v[230:231] neg_lo:[1,0,0] neg_hi:[1,0,0]
    v_pk_fma_f32 v[4:5], v[228:229], v[236:237], v[18:19]
    v_pk_fma_f32 v[6:7], v[230:231], v[238:239], v[18:19]
    v_max3_f32 v21, v4, v5, v6
    v_max_f32 v21, v21, v7
    v_cmp_lt_f32 vcc, s50, v21
    v_exp_f32 v4, v4
    v_exp_f32 v5, v5
    v_exp_f32 v6, v6
    v_exp_f32 v7, v7
    s_cbranch_vccz L_sm60
    s_call_b64 s[48:49], L_rescale
L_sm60:
    v_pk_mul_f32 v[228:229], v[4:5], v[236:237]
    v_pk_mul_f32 v[230:231], v[6:7], v[238:239]
    v_pk_add_f32 v[240:241], v[240:241], v[228:229]
    v_pk_add_f32 v[242:243], v[242:243], v[230:231]
    v_cvt_pk_bf16_f32 v244, v228, v229
    v_cvt_pk_bf16_f32 v245, v230, v231
    v_cvt_pk_bf16_f32 v246, v240, v241
    v_cvt_pk_bf16_f32 v247, v242, v243
    s_nop 1
    v_mfma_f32_16x16x32_bf16 v[52:55], v[150:153], v[244:247], v[52:55]
    v_cmp_neq_f32 vcc, 0, v254
    v_add_f32 v4, v4, v5
    v_add_f32 v6, v6, v7
    v_mfma_f32_16x16x32_bf16 v[56:59], v[156:159], v[244:247], v[56:59]
    v_add_f32 v14, v14, v15
    v_add_f32 v4, v4, v6
    ds_write_b32 v149, v254 offset:12800
    v_mfma_f32_16x16x32_bf16 v[60:63], v[162:165], v[244:247], v[60:63]
    v_add_f32 v14, v14, v4
    s_cmp_eq_u64 vcc, 0
    s_cselect_b32 s40, 1, 2
    v_mov_b32 v154, s40
    ds_write_b32 v149, v14 offset:12288
    v_mfma_f32_16x16x32_bf16 v[64:67], v[168:171], v[244:247], v[64:67]
    v_cvt_pk_bf16_f32 v100, v52, v53
    v_cvt_pk_bf16_f32 v101, v54, v55
    v_mfma_f32_16x16x32_bf16 v[68:71], v[174:177], v[244:247], v[68:71]
    v_cvt_pk_bf16_f32 v102, v56, v57
    v_cvt_pk_bf16_f32 v103, v58, v59
    ds_write_b128 v148, v[100:103]
    v_mfma_f32_16x16x32_bf16 v[72:75], v[180:183], v[244:247], v[72:75]
    v_cvt_pk_bf16_f32 v104, v60, v61
    v_cvt_pk_bf16_f32 v105, v62, v63
    v_mfma_f32_16x16x32_bf16 v[76:79], v[186:189], v[244:247], v[76:79]
    v_cvt_pk_bf16_f32 v106, v64, v65
    v_cvt_pk_bf16_f32 v107, v66, v67
    ds_write_b128 v148, v[104:107] offset:1024
    v_mfma_f32_16x16x32_bf16 v[80:83], v[192:195], v[244:247], v[80:83]
    v_cvt_pk_bf16_f32 v108, v68, v69
    v_cvt_pk_bf16_f32 v109, v70, v71
    v_mfma_f32_16x16x32_bf16 v[84:87], v[198:201], v[244:247], v[84:87]
    v_cvt_pk_bf16_f32 v110, v72, v73
    v_cvt_pk_bf16_f32 v111, v74, v75
    ds_write_b128 v148, v[108:111] offset:2048
    v_mfma_f32_16x16x32_bf16 v[88:91], v[204:207], v[244:247], v[88:91]
    v_cvt_pk_bf16_f32 v112, v76, v77
    v_cvt_pk_bf16_f32 v113, v78, v79
    v_mfma_f32_16x16x32_bf16 v[92:95], v[210:213], v[244:247], v[92:95]
    v_cvt_pk_bf16_f32 v114, v80, v81
    v_cvt_pk_bf16_f32 v115, v82, v83
    ds_write_b128 v148, v[112:115] offset:3072
    v_mfma_f32_16x16x32_bf16 v[96:99], v[216:219], v[244:247], v[96:99]
    v_cvt_pk_bf16_f32 v116, v84, v85
    v_cvt_pk_bf16_f32 v117, v86, v87
    v_cvt_pk_bf16_f32 v118, v88, v89
    v_cvt_pk_bf16_f32 v119, v90, v91
    ds_write_b128 v148, v[116:119] offset:4096
    v_cvt_pk_bf16_f32 v120, v92, v93
    v_cvt_pk_bf16_f32 v121, v94, v95
    s_nop 0
    v_cvt_pk_bf16_f32 v122, v96, v97
    v_cvt_pk_bf16_f32 v123, v98, v99
    ds_write_b128 v148, v[120:123] offset:5120
    ds_write_b32 v1, v154 offset:6992
    s_setprio 0
    s_cmp_lt_u32 s2, 0x80
    s_cbranch_scc1 L_r_end
    s_sub_u32 s53, s2, 0x80
    s_and_b32 s40, s53, 7
    s_lshr_b32 s42, s53, 4
    s_lshl_b32 s42, s42, 3
    s_or_b32 s40, s40, s42
    s_lshl_b32 s40, s40, 1
    s_bfe_u32 s42, s53, 0x10003
    s_or_b32 s53, s40, s42
    s_mov_b32 s24, s4
    s_mov_b32 s25, s5
    s_mov_b32 s26, 0x1800
    s_mov_b32 s27, 0x20000
    s_mov_b32 s28, s18
    s_mov_b32 s29, s19
    s_mov_b32 s30, 0x1800
    s_mov_b32 s31, 0x20000
    v_and_b32 v28, 3, v0
    v_lshrrev_b32 v29, 2, v0
    v_lshlrev_b32 v30, 15, v29
    v_lshl_add_u32 v30, v28, 4, v30
    v_lshlrev_b32 v32, 2, v28
    ds_read_b32 v38, v32 offset:7040
    s_lshl_b32 s40, s3, 19
    s_lshl_b32 s42, s53, 6
    s_add_u32 s40, s40, s42
    s_add_u32 s40, s40, 0x80000
    s_and_b32 s42, s53, 3
    s_mul_i32 s42, s42, 0x600
    v_mul_u32_u24 v31, 0x180, v28
    v_add_u32 v31, s42, v31
    s_lshr_b32 s42, s53, 5
    s_mul_i32 s6, s42, 0x60
    s_bfe_u32 s42, s53, 0x20002
    s_lshl_b32 s42, s42, 3
    s_add_u32 s6, s6, s42
    s_bitcmp1_b32 s53, 4
    s_cselect_b32 s4, 36, 0
    s_cselect_b32 s5, 64, 4
    s_cselect_b32 s42, 0x44, 32
    s_add_u32 s4, s4, s6
    s_add_u32 s5, s5, s6
    s_add_u32 s6, s6, s42
    buffer_load_dword v56, v31, s[24:27], s4 offen
    buffer_load_dword v57, v31, s[24:27], s5 offen
    buffer_load_dword v58, v31, s[24:27], s6 offen
    v_lshrrev_b32 v32, 4, v0
    v_lshlrev_b32 v34, 7, v32
    v_lshl_add_u32 v34, v28, 5, v34
    s_lshl_b32 s42, s3, 9
    s_add_u32 s42, s42, 0x9400
    v_add_u32 v34, s42, v34
    v_and_b32 v35, 15, v0
    v_lshlrev_b32 v35, 5, v35
    v_mov_b32 v32, 0
    v_mov_b32 v60, 0
    v_mov_b32 v61, 0
    v_mov_b32 v62, 0
    v_mov_b32 v63, 0
    v_mov_b32 v64, 0
    v_mov_b32 v65, 0
    v_mov_b32 v66, 0
    v_mov_b32 v67, 0
    v_mov_b32 v37, 0
    s_mov_b64 s[44:45], -1
    s_mov_b64 s[46:47], -1
    s_mov_b64 s[58:59], -1
    s_mov_b64 s[60:61], -1
    s_mov_b32 s38, 0x3f80
    s_mov_b32 s39, 0x3f800000
    s_waitcnt vmcnt(0) lgkmcnt(0)
    v_lshlrev_b32 v120, 16, v56
    v_and_b32 v121, 0xffff0000, v56
    v_lshlrev_b32 v122, 16, v57
    v_and_b32 v123, 0xffff0000, v57
    v_lshlrev_b32 v124, 16, v58
    v_and_b32 v125, 0xffff0000, v58
    s_nop 1
L_spin61:
    ds_read_b32 v33, v32 offset:6964
    s_waitcnt lgkmcnt(0)
    v_readfirstlane_b32 s42, v33
    s_nop 0
    s_cmp_ge_u32 s42, 4
    s_cbranch_scc1 L_spun62
    s_sleep 1
    s_branch L_spin61
L_spun62:
    s_mov_b64 exec, 0x1111
L_tpre:
    buffer_load_dword v32, v30, s[32:35], s40 offen offset:12 sc1
    s_waitcnt vmcnt(0)
    v_xor_b32 v32, v32, v38
    v_and_b32 v32, 0xfffe, v32
    v_cmp_ne_u32 vcc, 0, v32
    s_cbranch_vccnz L_tpre
    s_mov_b64 exec, -1
    s_nop 2
L_tpoll:
    s_add_u32 s42, s40, 0
    s_cmp_eq_u64 s[44:45], 0
    s_cbranch_scc1 L_tskip63
    s_mov_b64 exec, s[44:45]
    buffer_load_dwordx4 v[40:43], v30, s[32:35], s42 offen sc1
L_tskip63:
    s_add_u32 s42, s40, 0x2000
    s_cmp_eq_u64 s[46:47], 0
    s_cbranch_scc1 L_tskip64
    s_mov_b64 exec, s[46:47]
    buffer_load_dwordx4 v[44:47], v30, s[32:35], s42 offen sc1
L_tskip64:
    s_add_u32 s42, s40, 0x4000
    s_cmp_eq_u64 s[58:59], 0
    s_cbranch_scc1 L_tskip65
    s_mov_b64 exec, s[58:59]
    buffer_load_dwordx4 v[48:51], v30, s[32:35], s42 offen sc1
L_tskip65:
    s_add_u32 s42, s40, 0x6000
    s_cmp_eq_u64 s[60:61], 0
    s_cbranch_scc1 L_tskip66
    s_mov_b64 exec, s[60:61]
    buffer_load_dwordx4 v[52:55], v30, s[32:35], s42 offen sc1
L_tskip66:
    s_waitcnt vmcnt(0)
    s_cmp_eq_u64 s[44:45], 0
    s_cbranch_scc1 L_tchk67
    s_mov_b64 exec, s[44:45]
    v_xor_b32 v36, v43, v38
    v_and_b32 v32, 0xfffe, v36
    v_and_b32 v33, 0xffff0000, v43
    s_nop 2
    v_or_b32_dpp v32, v32, v32 quad_perm:[1,0,3,2] row_mask:0xf bank_mask:0xf
    s_nop 2
    v_or_b32_dpp v32, v32, v32 quad_perm:[2,3,0,1] row_mask:0xf bank_mask:0xf
    v_cmp_eq_u32 vcc, 0, v32
    s_nop 0
    s_andn2_b64 s[44:45], s[44:45], vcc
    s_and_b64 exec, vcc, vcc
    s_cbranch_scc0 L_tchk67
    v_dot2_f32_bf16 v60, v40, s38, v60
    v_dot2_f32_bf16 v61, v40, s39, v61
    v_dot2_f32_bf16 v62, v41, s38, v62
    v_dot2_f32_bf16 v63, v41, s39, v63
    v_dot2_f32_bf16 v64, v42, s38, v64
    v_dot2_f32_bf16 v65, v42, s39, v65
    v_add_f32 v66, v66, v33
    v_or_b32 v37, v37, v36
L_tchk67:
    s_cmp_eq_u64 s[46:47], 0
    s_cbranch_scc1 L_tchk68
    s_mov_b64 exec, s[46:47]
    v_xor_b32 v36, v47, v38
    v_and_b32 v32, 0xfffe, v36
    v_and_b32 v33, 0xffff0000, v47
    s_nop 2
    v_or_b32_dpp v32, v32, v32 quad_perm:[1,0,3,2] row_mask:0xf bank_mask:0xf
    s_nop 2
    v_or_b32_dpp v32, v32, v32 quad_perm:[2,3,0,1] row_mask:0xf bank_mask:0xf
    v_cmp_eq_u32 vcc, 0, v32
    s_nop 0
    s_andn2_b64 s[46:47], s[46:47], vcc
    s_and_b64 exec, vcc, vcc
    s_cbranch_scc0 L_tchk68
    v_dot2_f32_bf16 v60, v44, s38, v60
    v_dot2_f32_bf16 v61, v44, s39, v61
    v_dot2_f32_bf16 v62, v45, s38, v62
    v_dot2_f32_bf16 v63, v45, s39, v63
    v_dot2_f32_bf16 v64, v46, s38, v64
    v_dot2_f32_bf16 v65, v46, s39, v65
    v_add_f32 v66, v66, v33
    v_or_b32 v37, v37, v36
L_tchk68:
    s_cmp_eq_u64 s[58:59], 0
    s_cbranch_scc1 L_tchk69
    s_mov_b64 exec, s[58:59]
    v_xor_b32 v36, v51, v38
    v_and_b32 v32, 0xfffe, v36
    v_and_b32 v33, 0xffff0000, v51
    s_nop 2
    v_or_b32_dpp v32, v32, v32 quad_perm:[1,0,3,2] row_mask:0xf bank_mask:0xf
    s_nop 2
    v_or_b32_dpp v32, v32, v32 quad_perm:[2,3,0,1] row_mask:0xf bank_mask:0xf
    v_cmp_eq_u32 vcc, 0, v32
    s_nop 0
    s_andn2_b64 s[58:59], s[58:59], vcc
    s_and_b64 exec, vcc, vcc
    s_cbranch_scc0 L_tchk69
    v_dot2_f32_bf16 v60, v48, s38, v60
    v_dot2_f32_bf16 v61, v48, s39, v61
    v_dot2_f32_bf16 v62, v49, s38, v62
    v_dot2_f32_bf16 v63, v49, s39, v63
    v_dot2_f32_bf16 v64, v50, s38, v64
    v_dot2_f32_bf16 v65, v50, s39, v65
    v_add_f32 v66, v66, v33
    v_or_b32 v37, v37, v36
L_tchk69:
    s_cmp_eq_u64 s[60:61], 0
    s_cbranch_scc1 L_tchk70
    s_mov_b64 exec, s[60:61]
    v_xor_b32 v36, v55, v38
    v_and_b32 v32, 0xfffe, v36
    v_and_b32 v33, 0xffff0000, v55
    s_nop 2
    v_or_b32_dpp v32, v32, v32 quad_perm:[1,0,3,2] row_mask:0xf bank_mask:0xf
    s_nop 2
    v_or_b32_dpp v32, v32, v32 quad_perm:[2,3,0,1] row_mask:0xf bank_mask:0xf
    v_cmp_eq_u32 vcc, 0, v32
    s_nop 0
    s_andn2_b64 s[60:61], s[60:61], vcc
    s_and_b64 exec, vcc, vcc
    s_cbranch_scc0 L_tchk70
    v_dot2_f32_bf16 v60, v52, s38, v60
    v_dot2_f32_bf16 v61, v52, s39, v61
    v_dot2_f32_bf16 v62, v53, s38, v62
    v_dot2_f32_bf16 v63, v53, s39, v63
    v_dot2_f32_bf16 v64, v54, s38, v64
    v_dot2_f32_bf16 v65, v54, s39, v65
    v_add_f32 v66, v66, v33
    v_or_b32 v37, v37, v36
L_tchk70:
    s_mov_b64 exec, -1
    s_or_b64 s[56:57], s[44:45], s[46:47]
    s_or_b64 vcc, s[58:59], s[60:61]
    s_or_b64 s[56:57], s[56:57], vcc
    s_cbranch_scc0 L_tfull
    s_mov_b32 s54, 0
    s_bcnt1_i32_b64 s42, s[60:61]
    s_cselect_b32 s55, 0x6000, s55
    s_cselect_b64 s[56:57], s[60:61], s[56:57]
    s_add_u32 s54, s54, s42
    s_bcnt1_i32_b64 s42, s[58:59]
    s_cselect_b32 s55, 0x4000, s55
    s_cselect_b64 s[56:57], s[58:59], s[56:57]
    s_add_u32 s54, s54, s42
    s_bcnt1_i32_b64 s42, s[46:47]
    s_cselect_b32 s55, 0x2000, s55
    s_cselect_b64 s[56:57], s[46:47], s[56:57]
    s_add_u32 s54, s54, s42
    s_bcnt1_i32_b64 s42, s[44:45]
    s_cselect_b32 s55, 0, s55
    s_cselect_b64 s[56:57], s[44:45], s[56:57]
    s_add_u32 s54, s54, s42
    s_cmp_le_u32 s54, 32
    s_cbranch_scc1 L_tpoll
    s_ff1_i32_b64 s42, s[56:57]
    s_lshl_b64 exec, 1, s42
    s_add_u32 s55, s55, s40
L_tprobe:
    buffer_load_dword v32, v30, s[32:35], s55 offen offset:12 sc1
    s_waitcnt vmcnt(0)
    v_xor_b32 v32, v32, v38
    v_and_b32 v32, 0xfffe, v32
    v_cmp_ne_u32 vcc, 0, v32
    s_cbranch_vccnz L_tprobe
    s_mov_b64 exec, -1
    s_branch L_tpoll
    s_nop 1
L_tfull:
    v_and_b32 v32, 1, v37
    v_cmp_ne_u32 vcc, 0, v32
    s_cbranch_vccnz L_tgen
    s_nop 3
L_trows:
    v_add_f32_dpp v60, v60, v60 row_ror:4 row_mask:0xf bank_mask:0xf
    v_add_f32_dpp v61, v61, v61 row_ror:4 row_mask:0xf bank_mask:0xf
    v_add_f32_dpp v62, v62, v62 row_ror:4 row_mask:0xf bank_mask:0xf
    v_add_f32_dpp v63, v63, v63 row_ror:4 row_mask:0xf bank_mask:0xf
    v_add_f32_dpp v64, v64, v64 row_ror:4 row_mask:0xf bank_mask:0xf
    v_add_f32_dpp v65, v65, v65 row_ror:4 row_mask:0xf bank_mask:0xf
    v_add_f32_dpp v66, v66, v66 row_ror:4 row_mask:0xf bank_mask:0xf
    v_add_f32_dpp v60, v60, v60 row_ror:8 row_mask:0xf bank_mask:0xf
    v_add_f32_dpp v61, v61, v61 row_ror:8 row_mask:0xf bank_mask:0xf
    v_add_f32_dpp v62, v62, v62 row_ror:8 row_mask:0xf bank_mask:0xf
    v_add_f32_dpp v63, v63, v63 row_ror:8 row_mask:0xf bank_mask:0xf
    v_add_f32_dpp v64, v64, v64 row_ror:8 row_mask:0xf bank_mask:0xf
    v_add_f32_dpp v65, v65, v65 row_ror:8 row_mask:0xf bank_mask:0xf
    v_add_f32_dpp v66, v66, v66 row_ror:8 row_mask:0xf bank_mask:0xf
    s_mov_b32 s46, 0xf000f
    s_mov_b32 s47, 0xf000f
    s_mov_b64 exec, s[46:47]
    ds_write_b128 v34, v[60:63]
    ds_write_b128 v34, v[64:67] offset:16
    s_mov_b64 exec, -1
    s_waitcnt lgkmcnt(0)
    s_barrier
    s_cmp_lg_u32 s3, 0
    s_cbranch_scc1 L_r_end
    ds_read_b128 v[84:87], v35 offset:37904
    ds_read_b128 v[92:95], v35 offset:38416
    ds_read_b128 v[100:103], v35 offset:38928
    ds_read_b128 v[108:111], v35 offset:39440
    ds_read_b128 v[80:83], v35 offset:37888
    ds_read_b128 v[88:91], v35 offset:38400
    ds_read_b128 v[96:99], v35 offset:38912
    ds_read_b128 v[104:107], v35 offset:39424
    s_waitcnt lgkmcnt(4)
    v_or3_b32 v32, v87, v95, v103
    v_or_b32 v32, v32, v111
    v_cmp_ne_u32 vcc, 0, v32
    s_cbranch_vccnz L_fgen
    s_nop 3
L_fsum:
    v_pk_add_f32 v[66:67], v[86:87], v[94:95]
    v_pk_add_f32 v[102:103], v[102:103], v[110:111]
    v_pk_add_f32 v[64:65], v[84:85], v[92:93]
    v_pk_add_f32 v[100:101], v[100:101], v[108:109]
    s_waitcnt lgkmcnt(0)
    v_pk_add_f32 v[60:61], v[80:81], v[88:89]
    v_pk_add_f32 v[96:97], v[96:97], v[104:105]
    v_pk_add_f32 v[62:63], v[82:83], v[90:91]
    v_pk_add_f32 v[98:99], v[98:99], v[106:107]
    v_pk_add_f32 v[66:67], v[66:67], v[102:103]
    v_pk_add_f32 v[64:65], v[64:65], v[100:101]
    v_pk_add_f32 v[60:61], v[60:61], v[96:97]
    v_pk_add_f32 v[62:63], v[62:63], v[98:99]
    v_add_f32_dpp v66, v66, v66 row_ror:4 row_mask:0xf bank_mask:0xf
    v_add_f32_dpp v60, v60, v60 row_ror:4 row_mask:0xf bank_mask:0xf
    v_add_f32_dpp v61, v61, v61 row_ror:4 row_mask:0xf bank_mask:0xf
    v_add_f32_dpp v62, v62, v62 row_ror:4 row_mask:0xf bank_mask:0xf
    v_add_f32_dpp v63, v63, v63 row_ror:4 row_mask:0xf bank_mask:0xf
    v_add_f32_dpp v64, v64, v64 row_ror:4 row_mask:0xf bank_mask:0xf
    v_add_f32_dpp v65, v65, v65 row_ror:4 row_mask:0xf bank_mask:0xf
    v_add_f32_dpp v66, v66, v66 row_ror:8 row_mask:0xf bank_mask:0xf
    v_add_f32_dpp v60, v60, v60 row_ror:8 row_mask:0xf bank_mask:0xf
    v_add_f32_dpp v61, v61, v61 row_ror:8 row_mask:0xf bank_mask:0xf
    v_rcp_f32 v66, v66
    v_add_f32_dpp v62, v62, v62 row_ror:8 row_mask:0xf bank_mask:0xf
    v_add_f32_dpp v63, v63, v63 row_ror:8 row_mask:0xf bank_mask:0xf
    v_add_f32_dpp v64, v64, v64 row_ror:8 row_mask:0xf bank_mask:0xf
    v_add_f32_dpp v65, v65, v65 row_ror:8 row_mask:0xf bank_mask:0xf
    v_pk_mul_f32 v[60:61], v[60:61], v[66:67] op_sel_hi:[1,0]
    v_pk_mul_f32 v[62:63], v[62:63], v[66:67] op_sel_hi:[1,0]
    v_pk_mul_f32 v[64:65], v[64:65], v[66:67] op_sel_hi:[1,0]
    v_cvt_pk_bf16_f32 v56, v60, v61
    v_cvt_pk_bf16_f32 v57, v62, v63
    v_cvt_pk_bf16_f32 v58, v64, v65
    v_lshlrev_b32 v60, 16, v56
    v_and_b32 v61, 0xffff0000, v56
    v_lshlrev_b32 v62, 16, v57
    v_and_b32 v63, 0xffff0000, v57
    v_lshlrev_b32 v64, 16, v58
    v_and_b32 v65, 0xffff0000, v58
    v_pk_add_f32 v[60:61], v[60:61], v[120:121]
    v_pk_add_f32 v[62:63], v[62:63], v[122:123]
    v_pk_add_f32 v[64:65], v[64:65], v[124:125]
    s_mov_b64 exec, 15
    v_cvt_pk_bf16_f32 v56, v60, v61
    buffer_store_dword v56, v31, s[28:31], s4 offen
    v_cvt_pk_bf16_f32 v57, v62, v63
    buffer_store_dword v57, v31, s[28:31], s5 offen
    v_cvt_pk_bf16_f32 v58, v64, v65
    buffer_store_dword v58, v31, s[28:31], s6 offen
    s_mov_b64 exec, -1
L_r_end:
    s_endpgm
L_tgen:
    s_nop 3
    v_mov_b32 v32, 0
    ds_read_b64 v[72:73], v32 offset:7040
    v_lshlrev_b32 v71, 9, v29
    v_lshl_add_u32 v71, v28, 3, v71
    s_and_b32 s42, s53, 3
    s_lshl_b32 s42, s42, 5
    s_lshl_b32 s55, s3, 13
    s_add_u32 s55, s55, s42
    s_add_u32 s55, s55, 0x30000
    s_waitcnt lgkmcnt(0)
    v_lshl_or_b32 v70, v73, 16, v72
    v_mov_b32 v112, 0
    v_and_b32 v32, 1, v43
    v_cmp_ne_u32 vcc, 0, v32
    s_nop 0
    s_and_b64 exec, vcc, vcc
    s_cbranch_scc0 L_tg0e
    s_nop 1
L_tg0:
    buffer_load_dwordx2 v[112:113], v71, s[32:35], s55 offen sc1
    s_waitcnt vmcnt(0)
    v_cmp_ne_u32 vcc, v113, v70
    s_cbranch_vccnz L_tg0
L_tg0e:
    s_mov_b64 exec, -1
    v_mov_b32 v114, 0
    v_and_b32 v32, 1, v47
    v_cmp_ne_u32 vcc, 0, v32
    s_nop 0
    s_and_b64 exec, vcc, vcc
    s_cbranch_scc0 L_tg1e
    s_nop 1
L_tg1:
    buffer_load_dwordx2 v[114:115], v71, s[32:35], s55 offen offset:128 sc1
    s_waitcnt vmcnt(0)
    v_cmp_ne_u32 vcc, v115, v70
    s_cbranch_vccnz L_tg1
L_tg1e:
    s_mov_b64 exec, -1
    v_mov_b32 v116, 0
    v_and_b32 v32, 1, v51
    v_cmp_ne_u32 vcc, 0, v32
    s_nop 0
    s_and_b64 exec, vcc, vcc
    s_cbranch_scc0 L_tg2e
    s_nop 1
L_tg2:
    buffer_load_dwordx2 v[116:117], v71, s[32:35], s55 offen offset:256 sc1
    s_waitcnt vmcnt(0)
    v_cmp_ne_u32 vcc, v117, v70
    s_cbranch_vccnz L_tg2
L_tg2e:
    s_mov_b64 exec, -1
    v_mov_b32 v118, 0
    v_and_b32 v32, 1, v55
    v_cmp_ne_u32 vcc, 0, v32
    s_nop 0
    s_and_b64 exec, vcc, vcc
    s_cbranch_scc0 L_tg3e
    s_nop 1
L_tg3:
    buffer_load_dwordx2 v[118:119], v71, s[32:35], s55 offen offset:384 sc1
    s_waitcnt vmcnt(0)
    v_cmp_ne_u32 vcc, v119, v70
    s_cbranch_vccnz L_tg3
L_tg3e:
    s_mov_b64 exec, -1
    v_max3_f32 v67, v112, v114, v116
    v_max_f32 v67, v67, v118
    s_nop 1
    v_max_f32_dpp v67, v67, v67 row_ror:4 row_mask:0xf bank_mask:0xf
    s_nop 1
    v_max_f32_dpp v67, v67, v67 row_ror:8 row_mask:0xf bank_mask:0xf
    v_mov_b32 v32, v67
    v_mov_b32 v33, v67
    s_nop 1
    v_permlane32_swap_b32 v32, v33
    v_max_f32 v67, v32, v33
    v_mov_b32 v32, v67
    v_mov_b32 v33, v67
    s_nop 1
    v_permlane16_swap_b32 v32, v33
    v_max_f32 v67, v32, v33
    v_mov_b32 v60, 0
    v_mov_b32 v61, 0
    v_mov_b32 v62, 0
    v_mov_b32 v63, 0
    v_mov_b32 v64, 0
    v_mov_b32 v65, 0
    v_mov_b32 v66, 0
    v_sub_f32 v36, v112, v67
    v_exp_f32 v36, v36
    v_lshlrev_b32 v32, 16, v40
    v_fmac_f32 v60, v36, v32
    v_and_b32 v32, 0xffff0000, v40
    v_fmac_f32 v61, v36, v32
    v_lshlrev_b32 v32, 16, v41
    v_fmac_f32 v62, v36, v32
    v_and_b32 v32, 0xffff0000, v41
    v_fmac_f32 v63, v36, v32
    v_lshlrev_b32 v32, 16, v42
    v_fmac_f32 v64, v36, v32
    v_and_b32 v32, 0xffff0000, v42
    v_fmac_f32 v65, v36, v32
    v_and_b32 v32, 0xffff0000, v43
    v_fmac_f32 v66, v36, v32
    v_sub_f32 v36, v114, v67
    v_exp_f32 v36, v36
    v_lshlrev_b32 v32, 16, v44
    v_fmac_f32 v60, v36, v32
    v_and_b32 v32, 0xffff0000, v44
    v_fmac_f32 v61, v36, v32
    v_lshlrev_b32 v32, 16, v45
    v_fmac_f32 v62, v36, v32
    v_and_b32 v32, 0xffff0000, v45
    v_fmac_f32 v63, v36, v32
    v_lshlrev_b32 v32, 16, v46
    v_fmac_f32 v64, v36, v32
    v_and_b32 v32, 0xffff0000, v46
    v_fmac_f32 v65, v36, v32
    v_and_b32 v32, 0xffff0000, v47
    v_fmac_f32 v66, v36, v32
    v_sub_f32 v36, v116, v67
    v_exp_f32 v36, v36
    v_lshlrev_b32 v32, 16, v48
    v_fmac_f32 v60, v36, v32
    v_and_b32 v32, 0xffff0000, v48
    v_fmac_f32 v61, v36, v32
    v_lshlrev_b32 v32, 16, v49
    v_fmac_f32 v62, v36, v32
    v_and_b32 v32, 0xffff0000, v49
    v_fmac_f32 v63, v36, v32
    v_lshlrev_b32 v32, 16, v50
    v_fmac_f32 v64, v36, v32
    v_and_b32 v32, 0xffff0000, v50
    v_fmac_f32 v65, v36, v32
    v_and_b32 v32, 0xffff0000, v51
    v_fmac_f32 v66, v36, v32
    v_sub_f32 v36, v118, v67
    v_exp_f32 v36, v36
    v_lshlrev_b32 v32, 16, v52
    v_fmac_f32 v60, v36, v32
    v_and_b32 v32, 0xffff0000, v52
    v_fmac_f32 v61, v36, v32
    v_lshlrev_b32 v32, 16, v53
    v_fmac_f32 v62, v36, v32
    v_and_b32 v32, 0xffff0000, v53
    v_fmac_f32 v63, v36, v32
    v_lshlrev_b32 v32, 16, v54
    v_fmac_f32 v64, v36, v32
    v_and_b32 v32, 0xffff0000, v54
    v_fmac_f32 v65, v36, v32
    v_and_b32 v32, 0xffff0000, v55
    v_fmac_f32 v66, v36, v32
    s_nop 1
    s_branch L_trows
L_fgen:
    s_waitcnt lgkmcnt(0)
    v_max3_f32 v67, v87, v95, v103
    v_max_f32 v67, v67, v111
    v_sub_f32 v32, v87, v67
    v_exp_f32 v32, v32
    s_nop 0
    v_mul_f32 v80, v80, v32
    v_mul_f32 v81, v81, v32
    v_mul_f32 v82, v82, v32
    v_mul_f32 v83, v83, v32
    v_mul_f32 v84, v84, v32
    v_mul_f32 v85, v85, v32
    v_mul_f32 v86, v86, v32
    v_sub_f32 v32, v95, v67
    v_exp_f32 v32, v32
    s_nop 0
    v_mul_f32 v88, v88, v32
    v_mul_f32 v89, v89, v32
    v_mul_f32 v90, v90, v32
    v_mul_f32 v91, v91, v32
    v_mul_f32 v92, v92, v32
    v_mul_f32 v93, v93, v32
    v_mul_f32 v94, v94, v32
    v_sub_f32 v32, v103, v67
    v_exp_f32 v32, v32
    s_nop 0
    v_mul_f32 v96, v96, v32
    v_mul_f32 v97, v97, v32
    v_mul_f32 v98, v98, v32
    v_mul_f32 v99, v99, v32
    v_mul_f32 v100, v100, v32
    v_mul_f32 v101, v101, v32
    v_mul_f32 v102, v102, v32
    v_sub_f32 v32, v111, v67
    v_exp_f32 v32, v32
    s_nop 0
    v_mul_f32 v104, v104, v32
    v_mul_f32 v105, v105, v32
    v_mul_f32 v106, v106, v32
    v_mul_f32 v107, v107, v32
    v_mul_f32 v108, v108, v32
    v_mul_f32 v109, v109, v32
    v_mul_f32 v110, v110, v32
    s_nop 1
    s_branch L_fsum
L_qkprod:
    s_getpc_b64 s[28:29]
    s_mov_b32 s30, 0x1000
    s_mov_b32 s31, 0x20000
    v_lshlrev_b32 v31, 6, v0
    buffer_load_dword v50, v31, s[28:31], 0 offen
    v_and_b32 v28, 15, v0
    v_lshrrev_b32 v29, 4, v0
    v_mov_b32 v30, 0
    v_lshlrev_b32 v47, 4, v0
    v_add_u32 v47, 0, v47
    v_mul_u32_u24 v31, 0x180, v28
    v_and_b32 v32, 1, v29
    v_lshl_add_u32 v31, v32, 3, v31
    v_add_u32 v31, 0x1c00, v31
    v_lshrrev_b32 v32, 1, v29
    v_and_b32 v37, 6, v28
    v_xor_b32 v32, v32, v37
    v_xor_b32 v34, 0, v32
    v_lshl_add_u32 v34, v34, 4, v31
    v_xor_b32 v35, 2, v32
    v_lshl_add_u32 v35, v35, 4, v31
    v_xor_b32 v36, 4, v32
    v_lshl_add_u32 v36, v36, 4, v31
    v_xor_b32 v37, 6, v32
    v_lshl_add_u32 v37, v37, 4, v31
    v_lshrrev_b32 v31, 2, v28
    v_lshl_add_u32 v31, v29, 2, v31
    v_and_b32 v32, 6, v31
    v_mul_u32_u24 v31, 0x180, v31
    v_and_b32 v41, 3, v28
    v_lshl_add_u32 v31, v41, 3, v31
    s_mul_i32 s53, s3, 3
    s_add_u32 s53, s53, 0
    s_and_b32 s40, s53, 3
    s_lshl_b32 s40, s40, 1
    v_xor_b32 v38, s40, v32
    v_lshl_add_u32 v38, v38, 4, v31
    s_lshr_b32 s40, s53, 2
    s_lshl_b32 s40, s40, 7
    s_add_u32 s40, s40, 0x6400
    v_add_u32 v38, s40, v38
    v_add_u32 v41, 0x12000, v38
    s_lshr_b32 s40, s53, 1
    s_lshl_b32 s40, s40, 10
    s_and_b32 s42, s53, 1
    s_lshl_b32 s42, s42, 3
    s_add_u32 s40, s40, s42
    v_add_u32 v44, s40, v47
    s_mul_i32 s53, s3, 3
    s_add_u32 s53, s53, 1
    s_and_b32 s40, s53, 3
    s_lshl_b32 s40, s40, 1
    v_xor_b32 v39, s40, v32
    v_lshl_add_u32 v39, v39, 4, v31
    s_lshr_b32 s40, s53, 2
    s_lshl_b32 s40, s40, 7
    s_add_u32 s40, s40, 0x6400
    v_add_u32 v39, s40, v39
    v_add_u32 v42, 0x12000, v39
    s_lshr_b32 s40, s53, 1
    s_lshl_b32 s40, s40, 10
    s_and_b32 s42, s53, 1
    s_lshl_b32 s42, s42, 3
    s_add_u32 s40, s40, s42
    v_add_u32 v45, s40, v47
    s_mul_i32 s53, s3, 3
    s_add_u32 s53, s53, 2
    s_and_b32 s40, s53, 3
    s_lshl_b32 s40, s40, 1
    v_xor_b32 v40, s40, v32
    v_lshl_add_u32 v40, v40, 4, v31
    s_lshr_b32 s40, s53, 2
    s_lshl_b32 s40, s40, 7
    s_add_u32 s40, s40, 0x6400
    v_add_u32 v40, s40, v40
    v_add_u32 v43, 0x12000, v40
    s_lshr_b32 s40, s53, 1
    s_lshl_b32 s40, s40, 10
    s_and_b32 s42, s53, 1
    s_lshl_b32 s42, s42, 3
    s_add_u32 s40, s40, s42
    v_add_u32 v46, s40, v47
    s_nop 1
L_spin71:
    ds_read_b32 v31, v30 offset:6956
    s_waitcnt lgkmcnt(0)
    v_readfirstlane_b32 s40, v31
    s_nop 0
    s_cmp_ge_u32 s40, 1
    s_cbranch_scc1 L_spun72
    s_sleep 1
    s_branch L_spin71
L_spun72:
    ds_read_b64 v[52:53], v34
    ds_read_b64 v[54:55], v35
    ds_read_b64 v[56:57], v36
    ds_read_b64 v[58:59], v37
    ds_read_b64 v[60:61], v34 offset:128
    ds_read_b64 v[62:63], v35 offset:128
    ds_read_b64 v[64:65], v36 offset:128
    ds_read_b64 v[66:67], v37 offset:128
    ds_read_b64 v[68:69], v34 offset:256
    ds_read_b64 v[70:71], v35 offset:256
    ds_read_b64 v[72:73], v36 offset:256
    ds_read_b64 v[74:75], v37 offset:256
    v_mov_b32 v77, 0x3f803f80
    s_waitcnt lgkmcnt(0)
    v_dot2_f32_bf16 v76, v52, v77, 0
    v_dot2_f32_bf16 v80, v52, v52, 0
    v_dot2_f32_bf16 v76, v53, v77, v76
    v_dot2_f32_bf16 v80, v53, v53, v80
    v_dot2_f32_bf16 v76, v54, v77, v76
    v_dot2_f32_bf16 v80, v54, v54, v80
    v_dot2_f32_bf16 v76, v55, v77, v76
    v_dot2_f32_bf16 v80, v55, v55, v80
    v_dot2_f32_bf16 v76, v56, v77, v76
    v_dot2_f32_bf16 v80, v56, v56, v80
    v_dot2_f32_bf16 v76, v57, v77, v76
    v_dot2_f32_bf16 v80, v57, v57, v80
    v_dot2_f32_bf16 v76, v58, v77, v76
    v_dot2_f32_bf16 v80, v58, v58, v80
    v_dot2_f32_bf16 v76, v59, v77, v76
    v_dot2_f32_bf16 v80, v59, v59, v80
    v_dot2_f32_bf16 v76, v60, v77, v76
    v_dot2_f32_bf16 v80, v60, v60, v80
    v_dot2_f32_bf16 v76, v61, v77, v76
    v_dot2_f32_bf16 v80, v61, v61, v80
    v_dot2_f32_bf16 v76, v62, v77, v76
    v_dot2_f32_bf16 v80, v62, v62, v80
    v_dot2_f32_bf16 v76, v63, v77, v76
    v_dot2_f32_bf16 v80, v63, v63, v80
    v_dot2_f32_bf16 v76, v64, v77, v76
    v_dot2_f32_bf16 v80, v64, v64, v80
    v_dot2_f32_bf16 v76, v65, v77, v76
    v_dot2_f32_bf16 v80, v65, v65, v80
    v_dot2_f32_bf16 v76, v66, v77, v76
    v_dot2_f32_bf16 v80, v66, v66, v80
    v_dot2_f32_bf16 v76, v67, v77, v76
    v_dot2_f32_bf16 v80, v67, v67, v80
    v_dot2_f32_bf16 v76, v68, v77, v76
    v_dot2_f32_bf16 v80, v68, v68, v80
    v_dot2_f32_bf16 v76, v69, v77, v76
    v_dot2_f32_bf16 v80, v69, v69, v80
    v_dot2_f32_bf16 v76, v70, v77, v76
    v_dot2_f32_bf16 v80, v70, v70, v80
    v_dot2_f32_bf16 v76, v71, v77, v76
    v_dot2_f32_bf16 v80, v71, v71, v80
    v_dot2_f32_bf16 v76, v72, v77, v76
    v_dot2_f32_bf16 v80, v72, v72, v80
    v_dot2_f32_bf16 v76, v73, v77, v76
    v_dot2_f32_bf16 v80, v73, v73, v80
    v_dot2_f32_bf16 v76, v74, v77, v76
    v_dot2_f32_bf16 v80, v74, v74, v80
    v_dot2_f32_bf16 v76, v75, v77, v76
    v_dot2_f32_bf16 v80, v75, v75, v80
    s_nop 1
    v_mov_b32 v31, v76
    v_mov_b32 v32, v76
    v_mov_b32 v82, v80
    v_mov_b32 v83, v80
    v_permlane32_swap_b32 v31, v32
    s_nop 0
    v_permlane32_swap_b32 v82, v83
    v_add_f32 v76, v31, v32
    v_add_f32 v80, v82, v83
    v_mov_b32 v31, v76
    v_mov_b32 v32, v76
    v_mov_b32 v82, v80
    v_mov_b32 v83, v80
    v_permlane16_swap_b32 v31, v32
    s_nop 0
    v_permlane16_swap_b32 v82, v83
    v_add_f32 v76, v31, v32
    v_add_f32 v80, v82, v83
    v_mul_f32 v78, s44, v76
    v_mul_f32 v80, s44, v80
    v_fma_f32 v80, -v78, v78, v80
    v_max_f32 v80, 0, v80
    v_cvt_pk_bf16_f32 v78, v78, v78
    v_and_b32 v78, 0xffff0000, v78
    v_mov_b32 v79, v78
    v_cvt_pk_bf16_f32 v80, v80, v80
    v_and_b32 v80, 0xffff0000, v80
    v_add_f32 v80, 0x3727c5ac, v80
    v_cvt_pk_bf16_f32 v80, v80, v80
    v_and_b32 v80, 0xffff0000, v80
    v_sqrt_f32 v80, v80
    s_nop 0
    v_cvt_pk_bf16_f32 v80, v80, v80
    v_and_b32 v80, 0xffff0000, v80
    v_rcp_f32 v80, v80
    s_nop 0
    v_mov_b32 v81, v80
    v_lshlrev_b32 v82, 16, v52
    v_and_b32 v83, 0xffff0000, v52
    v_pk_add_f32 v[82:83], v[82:83], v[78:79] neg_lo:[0,1] neg_hi:[0,1]
    v_cvt_pk_bf16_f32 v52, v82, v83
    v_lshlrev_b32 v82, 16, v52
    v_and_b32 v83, 0xffff0000, v52
    v_pk_mul_f32 v[82:83], v[82:83], v[80:81]
    v_cvt_pk_bf16_f32 v52, v82, v83
    v_lshlrev_b32 v84, 16, v53
    v_and_b32 v85, 0xffff0000, v53
    v_pk_add_f32 v[84:85], v[84:85], v[78:79] neg_lo:[0,1] neg_hi:[0,1]
    v_cvt_pk_bf16_f32 v53, v84, v85
    v_lshlrev_b32 v84, 16, v53
    v_and_b32 v85, 0xffff0000, v53
    v_pk_mul_f32 v[84:85], v[84:85], v[80:81]
    v_cvt_pk_bf16_f32 v53, v84, v85
    v_lshlrev_b32 v82, 16, v54
    v_and_b32 v83, 0xffff0000, v54
    v_pk_add_f32 v[82:83], v[82:83], v[78:79] neg_lo:[0,1] neg_hi:[0,1]
    v_cvt_pk_bf16_f32 v54, v82, v83
    v_lshlrev_b32 v82, 16, v54
    v_and_b32 v83, 0xffff0000, v54
    v_pk_mul_f32 v[82:83], v[82:83], v[80:81]
    v_cvt_pk_bf16_f32 v54, v82, v83
    v_lshlrev_b32 v84, 16, v55
    v_and_b32 v85, 0xffff0000, v55
    v_pk_add_f32 v[84:85], v[84:85], v[78:79] neg_lo:[0,1] neg_hi:[0,1]
    v_cvt_pk_bf16_f32 v55, v84, v85
    v_lshlrev_b32 v84, 16, v55
    v_and_b32 v85, 0xffff0000, v55
    v_pk_mul_f32 v[84:85], v[84:85], v[80:81]
    v_cvt_pk_bf16_f32 v55, v84, v85
    v_lshlrev_b32 v82, 16, v56
    v_and_b32 v83, 0xffff0000, v56
    v_pk_add_f32 v[82:83], v[82:83], v[78:79] neg_lo:[0,1] neg_hi:[0,1]
    v_cvt_pk_bf16_f32 v56, v82, v83
    v_lshlrev_b32 v82, 16, v56
    v_and_b32 v83, 0xffff0000, v56
    v_pk_mul_f32 v[82:83], v[82:83], v[80:81]
    v_cvt_pk_bf16_f32 v56, v82, v83
    v_lshlrev_b32 v84, 16, v57
    v_and_b32 v85, 0xffff0000, v57
    v_pk_add_f32 v[84:85], v[84:85], v[78:79] neg_lo:[0,1] neg_hi:[0,1]
    v_cvt_pk_bf16_f32 v57, v84, v85
    v_lshlrev_b32 v84, 16, v57
    v_and_b32 v85, 0xffff0000, v57
    v_pk_mul_f32 v[84:85], v[84:85], v[80:81]
    v_cvt_pk_bf16_f32 v57, v84, v85
    v_lshlrev_b32 v82, 16, v58
    v_and_b32 v83, 0xffff0000, v58
    v_pk_add_f32 v[82:83], v[82:83], v[78:79] neg_lo:[0,1] neg_hi:[0,1]
    v_cvt_pk_bf16_f32 v58, v82, v83
    v_lshlrev_b32 v82, 16, v58
    v_and_b32 v83, 0xffff0000, v58
    v_pk_mul_f32 v[82:83], v[82:83], v[80:81]
    v_cvt_pk_bf16_f32 v58, v82, v83
    v_lshlrev_b32 v84, 16, v59
    v_and_b32 v85, 0xffff0000, v59
    v_pk_add_f32 v[84:85], v[84:85], v[78:79] neg_lo:[0,1] neg_hi:[0,1]
    v_cvt_pk_bf16_f32 v59, v84, v85
    v_lshlrev_b32 v84, 16, v59
    v_and_b32 v85, 0xffff0000, v59
    v_pk_mul_f32 v[84:85], v[84:85], v[80:81]
    v_cvt_pk_bf16_f32 v59, v84, v85
    v_lshlrev_b32 v82, 16, v60
    v_and_b32 v83, 0xffff0000, v60
    v_pk_add_f32 v[82:83], v[82:83], v[78:79] neg_lo:[0,1] neg_hi:[0,1]
    v_cvt_pk_bf16_f32 v60, v82, v83
    v_lshlrev_b32 v82, 16, v60
    v_and_b32 v83, 0xffff0000, v60
    v_pk_mul_f32 v[82:83], v[82:83], v[80:81]
    v_cvt_pk_bf16_f32 v60, v82, v83
    v_lshlrev_b32 v84, 16, v61
    v_and_b32 v85, 0xffff0000, v61
    v_pk_add_f32 v[84:85], v[84:85], v[78:79] neg_lo:[0,1] neg_hi:[0,1]
    v_cvt_pk_bf16_f32 v61, v84, v85
    v_lshlrev_b32 v84, 16, v61
    v_and_b32 v85, 0xffff0000, v61
    v_pk_mul_f32 v[84:85], v[84:85], v[80:81]
    v_cvt_pk_bf16_f32 v61, v84, v85
    v_lshlrev_b32 v82, 16, v62
    v_and_b32 v83, 0xffff0000, v62
    v_pk_add_f32 v[82:83], v[82:83], v[78:79] neg_lo:[0,1] neg_hi:[0,1]
    v_cvt_pk_bf16_f32 v62, v82, v83
    v_lshlrev_b32 v82, 16, v62
    v_and_b32 v83, 0xffff0000, v62
    v_pk_mul_f32 v[82:83], v[82:83], v[80:81]
    v_cvt_pk_bf16_f32 v62, v82, v83
    v_lshlrev_b32 v84, 16, v63
    v_and_b32 v85, 0xffff0000, v63
    v_pk_add_f32 v[84:85], v[84:85], v[78:79] neg_lo:[0,1] neg_hi:[0,1]
    v_cvt_pk_bf16_f32 v63, v84, v85
    v_lshlrev_b32 v84, 16, v63
    v_and_b32 v85, 0xffff0000, v63
    v_pk_mul_f32 v[84:85], v[84:85], v[80:81]
    v_cvt_pk_bf16_f32 v63, v84, v85
    v_lshlrev_b32 v82, 16, v64
    v_and_b32 v83, 0xffff0000, v64
    v_pk_add_f32 v[82:83], v[82:83], v[78:79] neg_lo:[0,1] neg_hi:[0,1]
    v_cvt_pk_bf16_f32 v64, v82, v83
    v_lshlrev_b32 v82, 16, v64
    v_and_b32 v83, 0xffff0000, v64
    v_pk_mul_f32 v[82:83], v[82:83], v[80:81]
    v_cvt_pk_bf16_f32 v64, v82, v83
    v_lshlrev_b32 v84, 16, v65
    v_and_b32 v85, 0xffff0000, v65
    v_pk_add_f32 v[84:85], v[84:85], v[78:79] neg_lo:[0,1] neg_hi:[0,1]
    v_cvt_pk_bf16_f32 v65, v84, v85
    v_lshlrev_b32 v84, 16, v65
    v_and_b32 v85, 0xffff0000, v65
    v_pk_mul_f32 v[84:85], v[84:85], v[80:81]
    v_cvt_pk_bf16_f32 v65, v84, v85
    v_lshlrev_b32 v82, 16, v66
    v_and_b32 v83, 0xffff0000, v66
    v_pk_add_f32 v[82:83], v[82:83], v[78:79] neg_lo:[0,1] neg_hi:[0,1]
    v_cvt_pk_bf16_f32 v66, v82, v83
    v_lshlrev_b32 v82, 16, v66
    v_and_b32 v83, 0xffff0000, v66
    v_pk_mul_f32 v[82:83], v[82:83], v[80:81]
    v_cvt_pk_bf16_f32 v66, v82, v83
    v_lshlrev_b32 v84, 16, v67
    v_and_b32 v85, 0xffff0000, v67
    v_pk_add_f32 v[84:85], v[84:85], v[78:79] neg_lo:[0,1] neg_hi:[0,1]
    v_cvt_pk_bf16_f32 v67, v84, v85
    v_lshlrev_b32 v84, 16, v67
    v_and_b32 v85, 0xffff0000, v67
    v_pk_mul_f32 v[84:85], v[84:85], v[80:81]
    v_cvt_pk_bf16_f32 v67, v84, v85
    v_lshlrev_b32 v82, 16, v68
    v_and_b32 v83, 0xffff0000, v68
    v_pk_add_f32 v[82:83], v[82:83], v[78:79] neg_lo:[0,1] neg_hi:[0,1]
    v_cvt_pk_bf16_f32 v68, v82, v83
    v_lshlrev_b32 v82, 16, v68
    v_and_b32 v83, 0xffff0000, v68
    v_pk_mul_f32 v[82:83], v[82:83], v[80:81]
    v_cvt_pk_bf16_f32 v68, v82, v83
    v_lshlrev_b32 v84, 16, v69
    v_and_b32 v85, 0xffff0000, v69
    v_pk_add_f32 v[84:85], v[84:85], v[78:79] neg_lo:[0,1] neg_hi:[0,1]
    v_cvt_pk_bf16_f32 v69, v84, v85
    v_lshlrev_b32 v84, 16, v69
    v_and_b32 v85, 0xffff0000, v69
    v_pk_mul_f32 v[84:85], v[84:85], v[80:81]
    v_cvt_pk_bf16_f32 v69, v84, v85
    v_lshlrev_b32 v82, 16, v70
    v_and_b32 v83, 0xffff0000, v70
    v_pk_add_f32 v[82:83], v[82:83], v[78:79] neg_lo:[0,1] neg_hi:[0,1]
    v_cvt_pk_bf16_f32 v70, v82, v83
    v_lshlrev_b32 v82, 16, v70
    v_and_b32 v83, 0xffff0000, v70
    v_pk_mul_f32 v[82:83], v[82:83], v[80:81]
    v_cvt_pk_bf16_f32 v70, v82, v83
    v_lshlrev_b32 v84, 16, v71
    v_and_b32 v85, 0xffff0000, v71
    v_pk_add_f32 v[84:85], v[84:85], v[78:79] neg_lo:[0,1] neg_hi:[0,1]
    v_cvt_pk_bf16_f32 v71, v84, v85
    v_lshlrev_b32 v84, 16, v71
    v_and_b32 v85, 0xffff0000, v71
    v_pk_mul_f32 v[84:85], v[84:85], v[80:81]
    v_cvt_pk_bf16_f32 v71, v84, v85
    v_lshlrev_b32 v82, 16, v72
    v_and_b32 v83, 0xffff0000, v72
    v_pk_add_f32 v[82:83], v[82:83], v[78:79] neg_lo:[0,1] neg_hi:[0,1]
    v_cvt_pk_bf16_f32 v72, v82, v83
    v_lshlrev_b32 v82, 16, v72
    v_and_b32 v83, 0xffff0000, v72
    v_pk_mul_f32 v[82:83], v[82:83], v[80:81]
    v_cvt_pk_bf16_f32 v72, v82, v83
    v_lshlrev_b32 v84, 16, v73
    v_and_b32 v85, 0xffff0000, v73
    v_pk_add_f32 v[84:85], v[84:85], v[78:79] neg_lo:[0,1] neg_hi:[0,1]
    v_cvt_pk_bf16_f32 v73, v84, v85
    v_lshlrev_b32 v84, 16, v73
    v_and_b32 v85, 0xffff0000, v73
    v_pk_mul_f32 v[84:85], v[84:85], v[80:81]
    v_cvt_pk_bf16_f32 v73, v84, v85
    v_lshlrev_b32 v82, 16, v74
    v_and_b32 v83, 0xffff0000, v74
    v_pk_add_f32 v[82:83], v[82:83], v[78:79] neg_lo:[0,1] neg_hi:[0,1]
    v_cvt_pk_bf16_f32 v74, v82, v83
    v_lshlrev_b32 v82, 16, v74
    v_and_b32 v83, 0xffff0000, v74
    v_pk_mul_f32 v[82:83], v[82:83], v[80:81]
    v_cvt_pk_bf16_f32 v74, v82, v83
    v_lshlrev_b32 v84, 16, v75
    v_and_b32 v85, 0xffff0000, v75
    v_pk_add_f32 v[84:85], v[84:85], v[78:79] neg_lo:[0,1] neg_hi:[0,1]
    v_cvt_pk_bf16_f32 v75, v84, v85
    v_lshlrev_b32 v84, 16, v75
    v_and_b32 v85, 0xffff0000, v75
    v_pk_mul_f32 v[84:85], v[84:85], v[80:81]
    v_cvt_pk_bf16_f32 v75, v84, v85
    s_nop 1
L_spin73:
    ds_read_b32 v31, v30 offset:6956
    s_waitcnt lgkmcnt(0)
    v_readfirstlane_b32 s40, v31
    s_nop 0
    s_cmp_ge_u32 s40, 2
    s_cbranch_scc1 L_spun74
    s_sleep 1
    s_branch L_spin73
L_spun74:
    s_waitcnt vmcnt(0)
    ds_read_b64_tr_b16 v[100:101], v38
    ds_read_b64_tr_b16 v[102:103], v38 offset:6144
    ds_read_b64_tr_b16 v[104:105], v39
    ds_read_b64_tr_b16 v[106:107], v39 offset:6144
    ds_read_b64_tr_b16 v[108:109], v40
    ds_read_b64_tr_b16 v[110:111], v40 offset:6144
    ds_read_b64_tr_b16 v[112:113], v38 offset:12288
    ds_read_b64_tr_b16 v[114:115], v38 offset:18432
    ds_read_b64_tr_b16 v[116:117], v39 offset:12288
    ds_read_b64_tr_b16 v[118:119], v39 offset:18432
    ds_read_b64_tr_b16 v[120:121], v40 offset:12288
    ds_read_b64_tr_b16 v[122:123], v40 offset:18432
    ds_read_b64_tr_b16 v[124:125], v38 offset:36864
    ds_read_b64_tr_b16 v[126:127], v38 offset:43008
    ds_read_b64_tr_b16 v[128:129], v39 offset:36864
    ds_read_b64_tr_b16 v[130:131], v39 offset:43008
    ds_read_b64_tr_b16 v[132:133], v40 offset:36864
    ds_read_b64_tr_b16 v[134:135], v40 offset:43008
    s_waitcnt lgkmcnt(12)
    v_mfma_f32_16x16x32_bf16 v[88:91], v[100:103], v[52:55], 0
    v_mfma_f32_16x16x32_bf16 v[92:95], v[104:107], v[52:55], 0
    v_mfma_f32_16x16x32_bf16 v[96:99], v[108:111], v[52:55], 0
    ds_read_b64_tr_b16 v[136:137], v38 offset:49152
    ds_read_b64_tr_b16 v[138:139], v38 offset:55296
    ds_read_b64_tr_b16 v[140:141], v39 offset:49152
    ds_read_b64_tr_b16 v[142:143], v39 offset:55296
    ds_read_b64_tr_b16 v[144:145], v40 offset:49152
    ds_read_b64_tr_b16 v[146:147], v40 offset:55296
    s_waitcnt lgkmcnt(12)
    v_mfma_f32_16x16x32_bf16 v[88:91], v[112:115], v[56:59], v[88:91]
    v_mfma_f32_16x16x32_bf16 v[92:95], v[116:119], v[56:59], v[92:95]
    v_mfma_f32_16x16x32_bf16 v[96:99], v[120:123], v[56:59], v[96:99]
    ds_read_b64_tr_b16 v[148:149], v41
    ds_read_b64_tr_b16 v[150:151], v41 offset:6144
    ds_read_b64_tr_b16 v[152:153], v42
    ds_read_b64_tr_b16 v[154:155], v42 offset:6144
    ds_read_b64_tr_b16 v[156:157], v43
    ds_read_b64_tr_b16 v[158:159], v43 offset:6144
    s_waitcnt lgkmcnt(12)
    v_mfma_f32_16x16x32_bf16 v[88:91], v[124:127], v[60:63], v[88:91]
    v_mfma_f32_16x16x32_bf16 v[92:95], v[128:131], v[60:63], v[92:95]
    v_mfma_f32_16x16x32_bf16 v[96:99], v[132:135], v[60:63], v[96:99]
    ds_read_b64_tr_b16 v[160:161], v41 offset:12288
    ds_read_b64_tr_b16 v[162:163], v41 offset:18432
    ds_read_b64_tr_b16 v[164:165], v42 offset:12288
    ds_read_b64_tr_b16 v[166:167], v42 offset:18432
    ds_read_b64_tr_b16 v[168:169], v43 offset:12288
    ds_read_b64_tr_b16 v[170:171], v43 offset:18432
    s_waitcnt lgkmcnt(12)
    v_mfma_f32_16x16x32_bf16 v[88:91], v[136:139], v[64:67], v[88:91]
    v_mfma_f32_16x16x32_bf16 v[92:95], v[140:143], v[64:67], v[92:95]
    v_mfma_f32_16x16x32_bf16 v[96:99], v[144:147], v[64:67], v[96:99]
    s_waitcnt lgkmcnt(6)
    v_mfma_f32_16x16x32_bf16 v[88:91], v[148:151], v[68:71], v[88:91]
    v_mfma_f32_16x16x32_bf16 v[92:95], v[152:155], v[68:71], v[92:95]
    v_mfma_f32_16x16x32_bf16 v[96:99], v[156:159], v[68:71], v[96:99]
    s_waitcnt lgkmcnt(0)
    v_mfma_f32_16x16x32_bf16 v[88:91], v[160:163], v[72:75], v[88:91]
    v_mfma_f32_16x16x32_bf16 v[92:95], v[164:167], v[72:75], v[92:95]
    v_mfma_f32_16x16x32_bf16 v[96:99], v[168:171], v[72:75], v[96:99]
    s_nop 5
    v_cvt_pk_bf16_f32 v76, v88, v89
    v_cvt_pk_bf16_f32 v77, v90, v91
    ds_write_b64 v44, v[76:77]
    v_cvt_pk_bf16_f32 v78, v92, v93
    v_cvt_pk_bf16_f32 v79, v94, v95
    ds_write_b64 v45, v[78:79]
    v_cvt_pk_bf16_f32 v80, v96, v97
    v_cvt_pk_bf16_f32 v81, v98, v99
    ds_write_b64 v46, v[80:81]
    v_mov_b32 v31, 1
    s_mov_b64 exec, 1
    ds_add_u32 v30, v31 offset:6948
    s_mov_b64 exec, -1
    s_cmp_ge_u32 s3, 2
    s_cbranch_scc1 L_qkp_done
L_spin75:
    ds_read_b32 v31, v30 offset:6956
    s_waitcnt lgkmcnt(0)
    v_readfirstlane_b32 s40, v31
    s_nop 0
    s_cmp_ge_u32 s40, 3
    s_cbranch_scc1 L_spun76
    s_sleep 1
    s_branch L_spin75
L_spun76:
    s_mul_i32 s40, s3, 0x3000
    s_add_u32 s40, s40, 0x1f800
    v_add_u32 v34, s40, v34
    v_add_u32 v35, s40, v35
    v_add_u32 v36, s40, v36
    v_add_u32 v37, s40, v37
    ds_read_b64 v[100:101], v34
    ds_read_b64 v[102:103], v35
    ds_read_b64 v[104:105], v36
    ds_read_b64 v[106:107], v37
    ds_read_b64 v[108:109], v34 offset:128
    ds_read_b64 v[110:111], v35 offset:128
    ds_read_b64 v[112:113], v36 offset:128
    ds_read_b64 v[114:115], v37 offset:128
    ds_read_b64 v[116:117], v34 offset:256
    ds_read_b64 v[118:119], v35 offset:256
    ds_read_b64 v[120:121], v36 offset:256
    ds_read_b64 v[122:123], v37 offset:256
    ds_read_b64 v[124:125], v34 offset:6144
    ds_read_b64 v[126:127], v35 offset:6144
    ds_read_b64 v[128:129], v36 offset:6144
    ds_read_b64 v[130:131], v37 offset:6144
    ds_read_b64 v[132:133], v34 offset:6272
    ds_read_b64 v[134:135], v35 offset:6272
    ds_read_b64 v[136:137], v36 offset:6272
    ds_read_b64 v[138:139], v37 offset:6272
    ds_read_b64 v[140:141], v34 offset:6400
    ds_read_b64 v[142:143], v35 offset:6400
    ds_read_b64 v[144:145], v36 offset:6400
    ds_read_b64 v[146:147], v37 offset:6400
L_spin77:
    ds_read_b32 v31, v30 offset:6948
    s_waitcnt lgkmcnt(0)
    v_readfirstlane_b32 s40, v31
    s_nop 0
    s_cmp_ge_u32 s40, 4
    s_cbranch_scc1 L_spun78
    s_sleep 1
    s_branch L_spin77
L_spun78:
    ds_read_b128 v[52:55], v47
    ds_read_b128 v[56:59], v47 offset:1024
    ds_read_b128 v[60:63], v47 offset:2048
    ds_read_b128 v[64:67], v47 offset:3072
    ds_read_b128 v[68:71], v47 offset:4096
    ds_read_b128 v[72:75], v47 offset:5120
    s_lshl_b32 s42, s2, 1
    s_add_u32 s42, s42, s3
    s_lshl_b32 s42, s42, 10
    s_add_u32 s42, s42, 0
    v_lshlrev_b32 v33, 4, v0
    s_waitcnt lgkmcnt(5)
    v_mfma_f32_16x16x32_bf16 v[88:91], v[100:103], v[52:55], 0
    v_mfma_f32_16x16x32_bf16 v[92:95], v[124:127], v[52:55], 0
    s_waitcnt lgkmcnt(4)
    v_mfma_f32_16x16x32_bf16 v[88:91], v[104:107], v[56:59], v[88:91]
    v_mfma_f32_16x16x32_bf16 v[92:95], v[128:131], v[56:59], v[92:95]
    s_waitcnt lgkmcnt(3)
    v_mfma_f32_16x16x32_bf16 v[88:91], v[108:111], v[60:63], v[88:91]
    v_mfma_f32_16x16x32_bf16 v[92:95], v[132:135], v[60:63], v[92:95]
    s_waitcnt lgkmcnt(2)
    v_mfma_f32_16x16x32_bf16 v[88:91], v[112:115], v[64:67], v[88:91]
    v_mfma_f32_16x16x32_bf16 v[92:95], v[136:139], v[64:67], v[92:95]
    s_waitcnt lgkmcnt(1)
    v_mfma_f32_16x16x32_bf16 v[88:91], v[116:119], v[68:71], v[88:91]
    v_mfma_f32_16x16x32_bf16 v[92:95], v[140:143], v[68:71], v[92:95]
    s_waitcnt lgkmcnt(0)
    v_mfma_f32_16x16x32_bf16 v[88:91], v[120:123], v[72:75], v[88:91]
    v_mfma_f32_16x16x32_bf16 v[92:95], v[144:147], v[72:75], v[92:95]
    s_nop 7
L_spin79:
    ds_read_b32 v31, v30 offset:6960
    s_waitcnt lgkmcnt(0)
    v_readfirstlane_b32 s40, v31
    s_nop 0
    s_cmp_ge_u32 s40, 1
    s_cbranch_scc1 L_spun80
    s_sleep 1
    s_branch L_spin79
L_spun80:
    s_mov_b32 s40, 0x3dd53b95
    v_mul_f32 v88, s40, v88
    v_mul_f32 v89, s40, v89
    v_mul_f32 v90, s40, v90
    v_mul_f32 v91, s40, v91
    v_cvt_pk_bf16_f32 v76, v88, v89
    v_cvt_pk_bf16_f32 v77, v90, v91
    v_mul_f32 v92, s40, v92
    v_mul_f32 v93, s40, v93
    v_mul_f32 v94, s40, v94
    v_mul_f32 v95, s40, v95
    v_cvt_pk_bf16_f32 v78, v92, v93
    v_cvt_pk_bf16_f32 v79, v94, v95
    v_min_u32 v76, -2, v76
    v_min_u32 v77, -2, v77
    v_min_u32 v78, -2, v78
    v_min_u32 v79, -2, v79
    buffer_store_dwordx4 v[76:79], v33, s[32:35], s42 offen sc1
    s_nop 1
L_qkp_done:
    v_mov_b32 v31, 1
    s_mov_b64 exec, 1
    ds_add_u32 v30, v31 offset:6952
    s_mov_b64 exec, -1
    s_waitcnt lgkmcnt(0)
    s_branch L_c_start
L_wvprod:
    s_getpc_b64 s[28:29]
    s_mov_b32 s30, 0x1000
    s_mov_b32 s31, 0x20000
    v_lshlrev_b32 v148, 6, v0
    buffer_load_dword v156, v148, s[28:31], 0 offen
    v_mov_b32 v150, 0
    v_add_u32 v152, 0x6400, v244
    v_add_u32 v153, 0x6400, v245
    v_add_u32 v154, 0x18400, v244
    v_add_u32 v155, 0x18400, v245
    v_lshrrev_b32 v148, 4, v0
    v_bfe_u32 v149, v0, 2, 2
    v_lshl_add_u32 v148, v148, 3, v149
    v_and_b32 v149, 3, v0
    v_lshlrev_b32 v149, 3, v149
    v_lshl_add_u32 v151, v148, 7, v149
    s_lshl_b32 s40, s3, 5
    s_add_u32 s40, s40, 0x21400
    v_add_u32 v151, s40, v151
    s_nop 1
L_spin81:
    ds_read_b32 v148, v150 offset:6956
    s_waitcnt lgkmcnt(0)
    v_readfirstlane_b32 s40, v148
    s_nop 0
    s_cmp_ge_u32 s40, 1
    s_cbranch_scc1 L_spun82
    s_sleep 1
    s_branch L_spin81
L_spun82:
    ds_read_b64_tr_b16 v[28:29], v151
    ds_read_b64_tr_b16 v[30:31], v151 offset:512
    ds_read_b64_tr_b16 v[32:33], v151 offset:4096
    ds_read_b64_tr_b16 v[34:35], v151 offset:4608
    ds_read_b64_tr_b16 v[36:37], v151 offset:8192
    ds_read_b64_tr_b16 v[38:39], v151 offset:8704
    ds_read_b64_tr_b16 v[40:41], v151 offset:12288
    ds_read_b64_tr_b16 v[42:43], v151 offset:12800
    ds_read_b64_tr_b16 v[44:45], v151 offset:16384
    ds_read_b64_tr_b16 v[46:47], v151 offset:16896
    ds_read_b64_tr_b16 v[48:49], v151 offset:20480
    ds_read_b64_tr_b16 v[50:51], v151 offset:20992
L_spin83:
    ds_read_b32 v148, v150 offset:6956
    s_waitcnt lgkmcnt(0)
    v_readfirstlane_b32 s40, v148
    s_nop 0
    s_cmp_ge_u32 s40, 2
    s_cbranch_scc1 L_spun84
    s_sleep 1
    s_branch L_spin83
L_spun84:
    s_waitcnt vmcnt(0)
    ds_read_b128 v[100:103], v152
    ds_read_b128 v[104:107], v153
    ds_read_b128 v[108:111], v152 offset:128
    ds_read_b128 v[112:115], v153 offset:128
    ds_read_b128 v[116:119], v152 offset:256
    ds_read_b128 v[120:123], v153 offset:256
    s_waitcnt lgkmcnt(5)
    v_mfma_f32_16x16x32_bf16 v[52:55], v[100:103], v[28:31], 0
    ds_read_b128 v[124:127], v152 offset:6144
    s_waitcnt lgkmcnt(5)
    v_mfma_f32_16x16x32_bf16 v[52:55], v[104:107], v[32:35], v[52:55]
    ds_read_b128 v[128:131], v153 offset:6144
    s_waitcnt lgkmcnt(5)
    v_mfma_f32_16x16x32_bf16 v[52:55], v[108:111], v[36:39], v[52:55]
    ds_read_b128 v[132:135], v152 offset:6272
    s_waitcnt lgkmcnt(5)
    v_mfma_f32_16x16x32_bf16 v[52:55], v[112:115], v[40:43], v[52:55]
    ds_read_b128 v[136:139], v153 offset:6272
    s_waitcnt lgkmcnt(5)
    v_mfma_f32_16x16x32_bf16 v[52:55], v[116:119], v[44:47], v[52:55]
    ds_read_b128 v[140:143], v152 offset:6400
    s_waitcnt lgkmcnt(5)
    v_mfma_f32_16x16x32_bf16 v[52:55], v[120:123], v[48:51], v[52:55]
    ds_read_b128 v[144:147], v153 offset:6400
    s_waitcnt lgkmcnt(5)
    v_mfma_f32_16x16x32_bf16 v[56:59], v[124:127], v[28:31], 0
    ds_read_b128 v[100:103], v152 offset:12288
    s_waitcnt lgkmcnt(5)
    v_mfma_f32_16x16x32_bf16 v[56:59], v[128:131], v[32:35], v[56:59]
    ds_read_b128 v[104:107], v153 offset:12288
    s_waitcnt lgkmcnt(5)
    v_mfma_f32_16x16x32_bf16 v[56:59], v[132:135], v[36:39], v[56:59]
    ds_read_b128 v[108:111], v152 offset:12416
    s_waitcnt lgkmcnt(5)
    v_mfma_f32_16x16x32_bf16 v[56:59], v[136:139], v[40:43], v[56:59]
    ds_read_b128 v[112:115], v153 offset:12416
    s_waitcnt lgkmcnt(5)
    v_mfma_f32_16x16x32_bf16 v[56:59], v[140:143], v[44:47], v[56:59]
    ds_read_b128 v[116:119], v152 offset:12544
    s_waitcnt lgkmcnt(5)
    v_mfma_f32_16x16x32_bf16 v[56:59], v[144:147], v[48:51], v[56:59]
    ds_read_b128 v[120:123], v153 offset:12544
    s_waitcnt lgkmcnt(5)
    v_mfma_f32_16x16x32_bf16 v[60:63], v[100:103], v[28:31], 0
    ds_read_b128 v[124:127], v152 offset:18432
    s_waitcnt lgkmcnt(5)
    v_mfma_f32_16x16x32_bf16 v[60:63], v[104:107], v[32:35], v[60:63]
    ds_read_b128 v[128:131], v153 offset:18432
    s_waitcnt lgkmcnt(5)
    v_mfma_f32_16x16x32_bf16 v[60:63], v[108:111], v[36:39], v[60:63]
    ds_read_b128 v[132:135], v152 offset:18560
    s_waitcnt lgkmcnt(5)
    v_mfma_f32_16x16x32_bf16 v[60:63], v[112:115], v[40:43], v[60:63]
    ds_read_b128 v[136:139], v153 offset:18560
    s_waitcnt lgkmcnt(5)
    v_mfma_f32_16x16x32_bf16 v[60:63], v[116:119], v[44:47], v[60:63]
    ds_read_b128 v[140:143], v152 offset:18688
    s_waitcnt lgkmcnt(5)
    v_mfma_f32_16x16x32_bf16 v[60:63], v[120:123], v[48:51], v[60:63]
    ds_read_b128 v[144:147], v153 offset:18688
    s_waitcnt lgkmcnt(5)
    v_mfma_f32_16x16x32_bf16 v[64:67], v[124:127], v[28:31], 0
    ds_read_b128 v[100:103], v152 offset:36864
    s_waitcnt lgkmcnt(5)
    v_mfma_f32_16x16x32_bf16 v[64:67], v[128:131], v[32:35], v[64:67]
    ds_read_b128 v[104:107], v153 offset:36864
    s_waitcnt lgkmcnt(5)
    v_mfma_f32_16x16x32_bf16 v[64:67], v[132:135], v[36:39], v[64:67]
    ds_read_b128 v[108:111], v152 offset:36992
    s_waitcnt lgkmcnt(5)
    v_mfma_f32_16x16x32_bf16 v[64:67], v[136:139], v[40:43], v[64:67]
    ds_read_b128 v[112:115], v153 offset:36992
    s_waitcnt lgkmcnt(5)
    v_mfma_f32_16x16x32_bf16 v[64:67], v[140:143], v[44:47], v[64:67]
    ds_read_b128 v[116:119], v152 offset:37120
    s_waitcnt lgkmcnt(5)
    v_mfma_f32_16x16x32_bf16 v[64:67], v[144:147], v[48:51], v[64:67]
    ds_read_b128 v[120:123], v153 offset:37120
    s_waitcnt lgkmcnt(5)
    v_mfma_f32_16x16x32_bf16 v[68:71], v[100:103], v[28:31], 0
    ds_read_b128 v[124:127], v152 offset:43008
    s_waitcnt lgkmcnt(5)
    v_mfma_f32_16x16x32_bf16 v[68:71], v[104:107], v[32:35], v[68:71]
    ds_read_b128 v[128:131], v153 offset:43008
    s_waitcnt lgkmcnt(5)
    v_mfma_f32_16x16x32_bf16 v[68:71], v[108:111], v[36:39], v[68:71]
    ds_read_b128 v[132:135], v152 offset:43136
    s_waitcnt lgkmcnt(5)
    v_mfma_f32_16x16x32_bf16 v[68:71], v[112:115], v[40:43], v[68:71]
    ds_read_b128 v[136:139], v153 offset:43136
    s_waitcnt lgkmcnt(5)
    v_mfma_f32_16x16x32_bf16 v[68:71], v[116:119], v[44:47], v[68:71]
    ds_read_b128 v[140:143], v152 offset:43264
    s_waitcnt lgkmcnt(5)
    v_mfma_f32_16x16x32_bf16 v[68:71], v[120:123], v[48:51], v[68:71]
    ds_read_b128 v[144:147], v153 offset:43264
    s_waitcnt lgkmcnt(5)
    v_mfma_f32_16x16x32_bf16 v[72:75], v[124:127], v[28:31], 0
    ds_read_b128 v[100:103], v152 offset:49152
    s_waitcnt lgkmcnt(5)
    v_mfma_f32_16x16x32_bf16 v[72:75], v[128:131], v[32:35], v[72:75]
    ds_read_b128 v[104:107], v153 offset:49152
    s_waitcnt lgkmcnt(5)
    v_mfma_f32_16x16x32_bf16 v[72:75], v[132:135], v[36:39], v[72:75]
    ds_read_b128 v[108:111], v152 offset:49280
    s_waitcnt lgkmcnt(5)
    v_mfma_f32_16x16x32_bf16 v[72:75], v[136:139], v[40:43], v[72:75]
    ds_read_b128 v[112:115], v153 offset:49280
    s_waitcnt lgkmcnt(5)
    v_mfma_f32_16x16x32_bf16 v[72:75], v[140:143], v[44:47], v[72:75]
    ds_read_b128 v[116:119], v152 offset:49408
    s_waitcnt lgkmcnt(5)
    v_mfma_f32_16x16x32_bf16 v[72:75], v[144:147], v[48:51], v[72:75]
    ds_read_b128 v[120:123], v153 offset:49408
    s_waitcnt lgkmcnt(5)
    v_mfma_f32_16x16x32_bf16 v[76:79], v[100:103], v[28:31], 0
    ds_read_b128 v[124:127], v152 offset:55296
    s_waitcnt lgkmcnt(5)
    v_mfma_f32_16x16x32_bf16 v[76:79], v[104:107], v[32:35], v[76:79]
    ds_read_b128 v[128:131], v153 offset:55296
    s_waitcnt lgkmcnt(5)
    v_mfma_f32_16x16x32_bf16 v[76:79], v[108:111], v[36:39], v[76:79]
    ds_read_b128 v[132:135], v152 offset:55424
    s_waitcnt lgkmcnt(5)
    v_mfma_f32_16x16x32_bf16 v[76:79], v[112:115], v[40:43], v[76:79]
    ds_read_b128 v[136:139], v153 offset:55424
    s_waitcnt lgkmcnt(5)
    v_mfma_f32_16x16x32_bf16 v[76:79], v[116:119], v[44:47], v[76:79]
    ds_read_b128 v[140:143], v152 offset:55552
    s_waitcnt lgkmcnt(5)
    v_mfma_f32_16x16x32_bf16 v[76:79], v[120:123], v[48:51], v[76:79]
    ds_read_b128 v[144:147], v153 offset:55552
    s_nop 6
L_spin85:
    ds_read_b32 v148, v150 offset:6956
    s_waitcnt lgkmcnt(0)
    v_readfirstlane_b32 s40, v148
    s_nop 0
    s_cmp_ge_u32 s40, 3
    s_cbranch_scc1 L_spun86
    s_sleep 1
    s_branch L_spin85
L_spun86:
    s_waitcnt lgkmcnt(5)
    v_mfma_f32_16x16x32_bf16 v[80:83], v[124:127], v[28:31], 0
    ds_read_b128 v[100:103], v154
    s_waitcnt lgkmcnt(5)
    v_mfma_f32_16x16x32_bf16 v[80:83], v[128:131], v[32:35], v[80:83]
    ds_read_b128 v[104:107], v155
    s_waitcnt lgkmcnt(5)
    v_mfma_f32_16x16x32_bf16 v[80:83], v[132:135], v[36:39], v[80:83]
    ds_read_b128 v[108:111], v154 offset:128
    s_waitcnt lgkmcnt(5)
    v_mfma_f32_16x16x32_bf16 v[80:83], v[136:139], v[40:43], v[80:83]
    ds_read_b128 v[112:115], v155 offset:128
    s_waitcnt lgkmcnt(5)
    v_mfma_f32_16x16x32_bf16 v[80:83], v[140:143], v[44:47], v[80:83]
    ds_read_b128 v[116:119], v154 offset:256
    s_waitcnt lgkmcnt(5)
    v_mfma_f32_16x16x32_bf16 v[80:83], v[144:147], v[48:51], v[80:83]
    ds_read_b128 v[120:123], v155 offset:256
    s_waitcnt lgkmcnt(5)
    v_mfma_f32_16x16x32_bf16 v[84:87], v[100:103], v[28:31], 0
    ds_read_b128 v[124:127], v154 offset:6144
    s_waitcnt lgkmcnt(5)
    v_mfma_f32_16x16x32_bf16 v[84:87], v[104:107], v[32:35], v[84:87]
    ds_read_b128 v[128:131], v155 offset:6144
    s_waitcnt lgkmcnt(5)
    v_mfma_f32_16x16x32_bf16 v[84:87], v[108:111], v[36:39], v[84:87]
    ds_read_b128 v[132:135], v154 offset:6272
    s_waitcnt lgkmcnt(5)
    v_mfma_f32_16x16x32_bf16 v[84:87], v[112:115], v[40:43], v[84:87]
    ds_read_b128 v[136:139], v155 offset:6272
    s_waitcnt lgkmcnt(5)
    v_mfma_f32_16x16x32_bf16 v[84:87], v[116:119], v[44:47], v[84:87]
    ds_read_b128 v[140:143], v154 offset:6400
    s_waitcnt lgkmcnt(5)
    v_mfma_f32_16x16x32_bf16 v[84:87], v[120:123], v[48:51], v[84:87]
    ds_read_b128 v[144:147], v155 offset:6400
    s_waitcnt lgkmcnt(5)
    v_mfma_f32_16x16x32_bf16 v[88:91], v[124:127], v[28:31], 0
    ds_read_b128 v[100:103], v154 offset:12288
    s_waitcnt lgkmcnt(5)
    v_mfma_f32_16x16x32_bf16 v[88:91], v[128:131], v[32:35], v[88:91]
    ds_read_b128 v[104:107], v155 offset:12288
    s_waitcnt lgkmcnt(5)
    v_mfma_f32_16x16x32_bf16 v[88:91], v[132:135], v[36:39], v[88:91]
    ds_read_b128 v[108:111], v154 offset:12416
    s_waitcnt lgkmcnt(5)
    v_mfma_f32_16x16x32_bf16 v[88:91], v[136:139], v[40:43], v[88:91]
    ds_read_b128 v[112:115], v155 offset:12416
    s_waitcnt lgkmcnt(5)
    v_mfma_f32_16x16x32_bf16 v[88:91], v[140:143], v[44:47], v[88:91]
    ds_read_b128 v[116:119], v154 offset:12544
    s_waitcnt lgkmcnt(5)
    v_mfma_f32_16x16x32_bf16 v[88:91], v[144:147], v[48:51], v[88:91]
    ds_read_b128 v[120:123], v155 offset:12544
    s_waitcnt lgkmcnt(5)
    v_mfma_f32_16x16x32_bf16 v[92:95], v[100:103], v[28:31], 0
    ds_read_b128 v[124:127], v154 offset:18432
    s_waitcnt lgkmcnt(5)
    v_mfma_f32_16x16x32_bf16 v[92:95], v[104:107], v[32:35], v[92:95]
    ds_read_b128 v[128:131], v155 offset:18432
    s_waitcnt lgkmcnt(5)
    v_mfma_f32_16x16x32_bf16 v[92:95], v[108:111], v[36:39], v[92:95]
    ds_read_b128 v[132:135], v154 offset:18560
    s_waitcnt lgkmcnt(5)
    v_mfma_f32_16x16x32_bf16 v[92:95], v[112:115], v[40:43], v[92:95]
    ds_read_b128 v[136:139], v155 offset:18560
    s_waitcnt lgkmcnt(5)
    v_mfma_f32_16x16x32_bf16 v[92:95], v[116:119], v[44:47], v[92:95]
    ds_read_b128 v[140:143], v154 offset:18688
    s_waitcnt lgkmcnt(5)
    v_mfma_f32_16x16x32_bf16 v[92:95], v[120:123], v[48:51], v[92:95]
    ds_read_b128 v[144:147], v155 offset:18688
    s_waitcnt lgkmcnt(5)
    v_mfma_f32_16x16x32_bf16 v[96:99], v[124:127], v[28:31], 0
    s_waitcnt lgkmcnt(4)
    s_waitcnt lgkmcnt(5)
    v_mfma_f32_16x16x32_bf16 v[96:99], v[128:131], v[32:35], v[96:99]
    s_waitcnt lgkmcnt(3)
    s_waitcnt lgkmcnt(5)
    v_mfma_f32_16x16x32_bf16 v[96:99], v[132:135], v[36:39], v[96:99]
    s_waitcnt lgkmcnt(2)
    s_waitcnt lgkmcnt(5)
    v_mfma_f32_16x16x32_bf16 v[96:99], v[136:139], v[40:43], v[96:99]
    s_waitcnt lgkmcnt(1)
    s_waitcnt lgkmcnt(5)
    v_mfma_f32_16x16x32_bf16 v[96:99], v[140:143], v[44:47], v[96:99]
    s_waitcnt lgkmcnt(0)
    s_waitcnt lgkmcnt(5)
    v_mfma_f32_16x16x32_bf16 v[96:99], v[144:147], v[48:51], v[96:99]
    v_mov_b32 v148, 1
    s_mov_b64 exec, 1
    ds_add_u32 v150, v148 offset:6952
    s_mov_b64 exec, -1
    v_pk_add_f32 v[158:159], v[52:53], v[56:57]
    v_pk_add_f32 v[160:161], v[54:55], v[58:59]
    v_pk_add_f32 v[158:159], v[158:159], v[60:61]
    v_pk_add_f32 v[160:161], v[160:161], v[62:63]
    v_pk_add_f32 v[158:159], v[158:159], v[64:65]
    v_pk_add_f32 v[160:161], v[160:161], v[66:67]
    v_pk_add_f32 v[158:159], v[158:159], v[68:69]
    v_pk_add_f32 v[160:161], v[160:161], v[70:71]
    v_pk_add_f32 v[158:159], v[158:159], v[72:73]
    v_pk_add_f32 v[160:161], v[160:161], v[74:75]
    v_pk_add_f32 v[158:159], v[158:159], v[76:77]
    v_pk_add_f32 v[160:161], v[160:161], v[78:79]
    v_pk_add_f32 v[158:159], v[158:159], v[80:81]
    v_pk_add_f32 v[160:161], v[160:161], v[82:83]
    v_pk_add_f32 v[158:159], v[158:159], v[84:85]
    v_pk_add_f32 v[160:161], v[160:161], v[86:87]
    v_pk_add_f32 v[158:159], v[158:159], v[88:89]
    v_pk_add_f32 v[160:161], v[160:161], v[90:91]
    v_pk_add_f32 v[158:159], v[158:159], v[92:93]
    v_pk_add_f32 v[160:161], v[160:161], v[94:95]
    v_pk_add_f32 v[158:159], v[158:159], v[96:97]
    v_pk_add_f32 v[160:161], v[160:161], v[98:99]
    v_pk_add_f32 v[158:159], v[158:159], v[160:161]
    v_add_f32 v158, v158, v159
    v_mov_b32 v148, v158
    v_mov_b32 v149, v158
    s_nop 1
    v_permlane32_swap_b32 v148, v149
    v_add_f32 v158, v148, v149
    v_mov_b32 v148, v158
    v_mov_b32 v149, v158
    s_nop 1
    v_permlane16_swap_b32 v148, v149
    v_add_f32 v158, v148, v149
    v_mul_f32 v158, s44, v158
    s_sub_u32 s40, s2, 3
    s_lshl_b32 s40, s40, 2
    s_add_u32 s40, s40, s3
    s_mul_i32 s40, s40, 0x1800
    s_add_u32 s40, s40, 0x10000
    v_lshlrev_b32 v148, 4, v0
    v_pk_add_f32 v[52:53], v[52:53], v[158:159] op_sel_hi:[1,0] neg_lo:[0,1] neg_hi:[0,1]
    v_cvt_pk_bf16_f32 v164, v52, v53
    v_pk_add_f32 v[54:55], v[54:55], v[158:159] op_sel_hi:[1,0] neg_lo:[0,1] neg_hi:[0,1]
    v_cvt_pk_bf16_f32 v165, v54, v55
    v_pk_add_f32 v[56:57], v[56:57], v[158:159] op_sel_hi:[1,0] neg_lo:[0,1] neg_hi:[0,1]
    v_cvt_pk_bf16_f32 v166, v56, v57
    v_pk_add_f32 v[58:59], v[58:59], v[158:159] op_sel_hi:[1,0] neg_lo:[0,1] neg_hi:[0,1]
    v_cvt_pk_bf16_f32 v167, v58, v59
    s_add_u32 s42, s40, 0
    buffer_store_dwordx4 v[164:167], v148, s[32:35], s42 offen sc1
    v_pk_add_f32 v[60:61], v[60:61], v[158:159] op_sel_hi:[1,0] neg_lo:[0,1] neg_hi:[0,1]
    v_cvt_pk_bf16_f32 v168, v60, v61
    v_pk_add_f32 v[62:63], v[62:63], v[158:159] op_sel_hi:[1,0] neg_lo:[0,1] neg_hi:[0,1]
    v_cvt_pk_bf16_f32 v169, v62, v63
    v_pk_add_f32 v[64:65], v[64:65], v[158:159] op_sel_hi:[1,0] neg_lo:[0,1] neg_hi:[0,1]
    v_cvt_pk_bf16_f32 v170, v64, v65
    v_pk_add_f32 v[66:67], v[66:67], v[158:159] op_sel_hi:[1,0] neg_lo:[0,1] neg_hi:[0,1]
    v_cvt_pk_bf16_f32 v171, v66, v67
    s_add_u32 s42, s40, 0x400
    buffer_store_dwordx4 v[168:171], v148, s[32:35], s42 offen sc1
    v_pk_add_f32 v[68:69], v[68:69], v[158:159] op_sel_hi:[1,0] neg_lo:[0,1] neg_hi:[0,1]
    v_cvt_pk_bf16_f32 v172, v68, v69
    v_pk_add_f32 v[70:71], v[70:71], v[158:159] op_sel_hi:[1,0] neg_lo:[0,1] neg_hi:[0,1]
    v_cvt_pk_bf16_f32 v173, v70, v71
    v_pk_add_f32 v[72:73], v[72:73], v[158:159] op_sel_hi:[1,0] neg_lo:[0,1] neg_hi:[0,1]
    v_cvt_pk_bf16_f32 v174, v72, v73
    v_pk_add_f32 v[74:75], v[74:75], v[158:159] op_sel_hi:[1,0] neg_lo:[0,1] neg_hi:[0,1]
    v_cvt_pk_bf16_f32 v175, v74, v75
    s_add_u32 s42, s40, 0x800
    buffer_store_dwordx4 v[172:175], v148, s[32:35], s42 offen sc1
    v_pk_add_f32 v[76:77], v[76:77], v[158:159] op_sel_hi:[1,0] neg_lo:[0,1] neg_hi:[0,1]
    v_cvt_pk_bf16_f32 v176, v76, v77
    v_pk_add_f32 v[78:79], v[78:79], v[158:159] op_sel_hi:[1,0] neg_lo:[0,1] neg_hi:[0,1]
    v_cvt_pk_bf16_f32 v177, v78, v79
    v_pk_add_f32 v[80:81], v[80:81], v[158:159] op_sel_hi:[1,0] neg_lo:[0,1] neg_hi:[0,1]
    v_cvt_pk_bf16_f32 v178, v80, v81
    v_pk_add_f32 v[82:83], v[82:83], v[158:159] op_sel_hi:[1,0] neg_lo:[0,1] neg_hi:[0,1]
    v_cvt_pk_bf16_f32 v179, v82, v83
    s_add_u32 s42, s40, 0xc00
    buffer_store_dwordx4 v[176:179], v148, s[32:35], s42 offen sc1
    v_pk_add_f32 v[84:85], v[84:85], v[158:159] op_sel_hi:[1,0] neg_lo:[0,1] neg_hi:[0,1]
    v_cvt_pk_bf16_f32 v180, v84, v85
    v_pk_add_f32 v[86:87], v[86:87], v[158:159] op_sel_hi:[1,0] neg_lo:[0,1] neg_hi:[0,1]
    v_cvt_pk_bf16_f32 v181, v86, v87
    v_pk_add_f32 v[88:89], v[88:89], v[158:159] op_sel_hi:[1,0] neg_lo:[0,1] neg_hi:[0,1]
    v_cvt_pk_bf16_f32 v182, v88, v89
    v_pk_add_f32 v[90:91], v[90:91], v[158:159] op_sel_hi:[1,0] neg_lo:[0,1] neg_hi:[0,1]
    v_cvt_pk_bf16_f32 v183, v90, v91
    s_add_u32 s42, s40, 0x1000
    buffer_store_dwordx4 v[180:183], v148, s[32:35], s42 offen sc1
    v_pk_add_f32 v[92:93], v[92:93], v[158:159] op_sel_hi:[1,0] neg_lo:[0,1] neg_hi:[0,1]
    v_cvt_pk_bf16_f32 v184, v92, v93
    v_pk_add_f32 v[94:95], v[94:95], v[158:159] op_sel_hi:[1,0] neg_lo:[0,1] neg_hi:[0,1]
    v_cvt_pk_bf16_f32 v185, v94, v95
    v_pk_add_f32 v[96:97], v[96:97], v[158:159] op_sel_hi:[1,0] neg_lo:[0,1] neg_hi:[0,1]
    v_cvt_pk_bf16_f32 v186, v96, v97
    v_pk_add_f32 v[98:99], v[98:99], v[158:159] op_sel_hi:[1,0] neg_lo:[0,1] neg_hi:[0,1]
    v_cvt_pk_bf16_f32 v187, v98, v99
    s_add_u32 s42, s40, 0x1400
    buffer_store_dwordx4 v[184:187], v148, s[32:35], s42 offen sc1
    s_waitcnt lgkmcnt(0)
    s_nop 1
    s_branch L_c_start
L_aux:
    s_sub_u32 s36, s3, 5
    v_mov_b32 v11, 0
    v_and_b32 v1, 15, v0
    v_lshrrev_b32 v2, 4, v0
    v_lshlrev_b32 v12, 4, v0
    v_mov_b32 v16, -1
    v_mov_b32 v17, -1
    v_mov_b32 v18, -1
    v_mov_b32 v19, -1
    s_waitcnt lgkmcnt(0)
    s_mov_b32 s32, s22
    s_mov_b32 s33, s23
    s_mov_b32 s34, 0x1000000
    s_mov_b32 s35, 0x20000
    s_cmp_ge_u32 s2, 3
    s_cbranch_scc1 L_aux_noinv0
    s_cmp_lg_u32 s36, 1
    s_cbranch_scc1 L_aux_noinv0
    s_lshl_b32 s38, s2, 11
    s_add_u32 s38, s38, 0
    buffer_store_dwordx4 v[16:19], v12, s[32:35], s38 offen sc1
    buffer_store_dwordx4 v[16:19], v12, s[32:35], s38 offen offset:1024 sc1
    s_memrealtime s[52:53]
    s_waitcnt lgkmcnt(0)
    s_mul_i32 s54, s52, 0x9e3779b1
    s_mov_b32 s55, s53
    s_lshr_b64 s[56:57], s[54:55], 0
    s_lshl_b32 s39, s56, 1
    s_and_b32 s39, s39, 0xfffe
    v_mov_b32 v20, s39
    s_lshr_b64 s[56:57], s[54:55], 15
    s_lshl_b32 s39, s56, 1
    s_and_b32 s39, s39, 0xfffe
    v_mov_b32 v21, s39
    s_lshr_b64 s[56:57], s[54:55], 30
    s_lshl_b32 s39, s56, 1
    s_and_b32 s39, s39, 0xfffe
    v_mov_b32 v22, s39
    s_mul_i32 s39, s54, 0x85ebca6b
    s_lshr_b32 s39, s39, 16
    s_and_b32 s39, s39, 0xfffe
    v_mov_b32 v23, s39
    s_lshl_b32 s38, s2, 7
    s_add_u32 s38, s38, 0x1800
    s_mov_b64 exec, 1
    buffer_store_dwordx4 v[20:23], v11, s[32:35], s38 offen sc1
    s_mov_b64 exec, -1
L_aux_noinv0:
    s_barrier
    s_mov_b32 s44, s20
    s_mov_b32 s45, s21
    s_mov_b32 s46, 0x100
    s_mov_b32 s47, 0x20000
    s_cmp_ge_u32 s2, 3
    s_cbranch_scc1 L_aux_noinv
    s_cmp_lg_u32 s36, 1
    s_cbranch_scc1 L_aux_noinv
    v_mov_b32 v14, 1
    s_lshl_b32 s38, s2, 5
    s_waitcnt vmcnt(0)
    ds_write_b32 v11, v14 offset:6960
    s_mov_b64 exec, 1
    buffer_store_dword v14, v11, s[44:47], s38 offen sc1
    s_mov_b64 exec, -1
    s_nop 2
L_aux_noinv:
    s_cmp_lt_u32 s2, 3
    s_cselect_b32 s39, 40, 0
    v_mov_b32 v15, s39
    s_cmp_lg_u32 s36, 0
    s_cbranch_scc1 L_aux_w
    v_mul_u32_u24 v14, 0x180, v1
    v_and_b32 v16, 1, v2
    v_lshl_add_u32 v14, v16, 3, v14
    v_lshrrev_b32 v16, 1, v2
    v_and_b32 v13, 6, v1
    v_xor_b32 v16, v16, v13
    v_xor_b32 v13, 0, v16
    v_lshl_add_u32 v232, v13, 4, v14
    v_xor_b32 v13, 2, v16
    v_lshl_add_u32 v233, v13, 4, v14
    v_xor_b32 v13, 4, v16
    v_lshl_add_u32 v234, v13, 4, v14
    v_xor_b32 v13, 6, v16
    v_lshl_add_u32 v235, v13, 4, v14
    v_lshlrev_b32 v13, 5, v0
    s_cmp_lt_u32 s2, 6
    s_cselect_b32 s38, 1, 3
L_spin87:
    ds_read_b32 v14, v15 offset:6912
    s_waitcnt lgkmcnt(0)
    v_readfirstlane_b32 s37, v14
    s_nop 0
    s_cmp_ge_u32 s37, s38
    s_cbranch_scc1 L_spun88
    s_sleep 4
    s_branch L_spin87
L_spun88:
    s_mov_b64 exec, 7
L_qpoll:
    buffer_load_dword v14, v13, s[44:47], 0 offen sc1
    s_waitcnt vmcnt(0)
    v_cmp_eq_u32 vcc, 0, v14
    s_cbranch_vccz L_qpolled
    s_sleep 8
    s_branch L_qpoll
L_qpolled:
    s_mov_b64 exec, -1
    s_cmp_lt_u32 s2, 6
    s_cselect_b32 s38, 3, 6
    s_cmp_lt_u32 s2, 3
    s_cselect_b32 s38, 4, s38
L_spin89:
    ds_read_b32 v14, v15 offset:6912
    s_waitcnt lgkmcnt(0)
    v_readfirstlane_b32 s37, v14
    s_nop 0
    s_cmp_ge_u32 s37, s38
    s_cbranch_scc1 L_spun90
    s_sleep 2
    s_branch L_spin89
L_spun90:
    s_mov_b32 s38, 0x1800
    buffer_load_dwordx4 v[236:239], v11, s[32:35], s38 offen sc1
L_qdata:
    s_mov_b32 s38, 0
    buffer_load_dwordx4 v[208:211], v12, s[32:35], s38 offen sc1
    s_mov_b32 s38, 0x400
    buffer_load_dwordx4 v[212:215], v12, s[32:35], s38 offen sc1
    s_mov_b32 s38, 0x800
    buffer_load_dwordx4 v[216:219], v12, s[32:35], s38 offen sc1
    s_mov_b32 s38, 0xc00
    buffer_load_dwordx4 v[220:223], v12, s[32:35], s38 offen sc1
    s_mov_b32 s38, 0x1000
    buffer_load_dwordx4 v[224:227], v12, s[32:35], s38 offen sc1
    s_mov_b32 s38, 0x1400
    buffer_load_dwordx4 v[228:231], v12, s[32:35], s38 offen sc1
    s_waitcnt vmcnt(0)
    v_max3_u32 v14, v208, v209, v210
    v_max3_u32 v14, v14, v211, v212
    v_max3_u32 v14, v14, v213, v214
    v_max3_u32 v14, v14, v215, v216
    v_max3_u32 v14, v14, v217, v218
    v_max3_u32 v14, v14, v219, v220
    v_max3_u32 v14, v14, v221, v222
    v_max3_u32 v14, v14, v223, v224
    v_max3_u32 v14, v14, v225, v226
    v_max3_u32 v14, v14, v227, v228
    v_max3_u32 v14, v14, v229, v230
    v_max_u32 v14, v14, v231
    v_cmp_eq_u32 vcc, -1, v14
    s_cbranch_vccnz L_qdata
    ds_write_b128 v11, v[236:239] offset:7040
    ds_write_b64 v232, v[208:209]
    ds_write_b64 v233, v[210:211]
    ds_write_b64 v234, v[212:213]
    ds_write_b64 v235, v[214:215]
    ds_write_b64 v232, v[216:217] offset:128
    ds_write_b64 v233, v[218:219] offset:128
    ds_write_b64 v234, v[220:221] offset:128
    ds_write_b64 v235, v[222:223] offset:128
    ds_write_b64 v232, v[224:225] offset:256
    ds_write_b64 v233, v[226:227] offset:256
    ds_write_b64 v234, v[228:229] offset:256
    ds_write_b64 v235, v[230:231] offset:256
    v_mov_b32 v14, 1
    ds_write_b32 v11, v14 offset:6944
    s_nop 0
L_aux_w:
    s_cmp_lg_u32 s36, 2
    s_cbranch_scc1 L_aux_wf2
    v_lshlrev_b32 v13, 2, v0
    s_nop 1
L_spin91:
    ds_read_b32 v14, v11 offset:6912
    s_waitcnt lgkmcnt(0)
    v_readfirstlane_b32 s37, v14
    s_nop 0
    s_cmp_ge_u32 s37, 10
    s_cbranch_scc1 L_spun92
    s_sleep 8
    s_branch L_spin91
L_spun92:
L_spin93:
    ds_read_b32 v14, v11 offset:6944
    s_waitcnt lgkmcnt(0)
    v_readfirstlane_b32 s37, v14
    s_nop 0
    s_cmp_ge_u32 s37, 1
    s_cbranch_scc1 L_spun94
    s_sleep 8
    s_branch L_spin93
L_spun94:
    s_mov_b64 exec, 0xfff
L_wpoll:
    buffer_load_dword v14, v13, s[44:47], 0 offen offset:128 sc1
    s_waitcnt vmcnt(0)
    v_cmp_eq_u32 vcc, 0, v14
    s_cbranch_vccz L_wpolled
    s_sleep 16
    s_branch L_wpoll
L_wpolled:
    s_mov_b64 exec, -1
    v_mov_b32 v14, 1
    ds_write_b32 v11, v14 offset:6976
    s_nop 0
L_aux_wf2:
L_spin95:
    ds_read_b32 v14, v11 offset:6976
    s_waitcnt lgkmcnt(0)
    v_readfirstlane_b32 s37, v14
    s_nop 0
    s_cmp_ge_u32 s37, 1
    s_cbranch_scc1 L_spun96
    s_sleep 8
    s_branch L_spin95
L_spun96:
    s_mul_i32 s37, s36, 0x4800
    s_add_u32 s37, s37, 0x10000
    s_add_u32 s38, s37, 0
    buffer_load_dwordx4 v[112:115], v12, s[32:35], s38 offen sc1
    s_add_u32 s38, s37, 0x400
    buffer_load_dwordx4 v[124:127], v12, s[32:35], s38 offen sc1
    s_add_u32 s38, s37, 0x800
    buffer_load_dwordx4 v[136:139], v12, s[32:35], s38 offen sc1
    s_waitcnt vmcnt(0)
    s_add_u32 s38, s37, 0xc00
    buffer_load_dwordx4 v[148:151], v12, s[32:35], s38 offen sc1
    s_add_u32 s38, s37, 0x1000
    buffer_load_dwordx4 v[160:163], v12, s[32:35], s38 offen sc1
    s_add_u32 s38, s37, 0x1400
    buffer_load_dwordx4 v[172:175], v12, s[32:35], s38 offen sc1
    s_waitcnt vmcnt(0)
    s_add_u32 s38, s37, 0x1800
    buffer_load_dwordx4 v[116:119], v12, s[32:35], s38 offen sc1
    s_add_u32 s38, s37, 0x1c00
    buffer_load_dwordx4 v[128:131], v12, s[32:35], s38 offen sc1
    s_add_u32 s38, s37, 0x2000
    buffer_load_dwordx4 v[140:143], v12, s[32:35], s38 offen sc1
    s_waitcnt vmcnt(0)
    s_add_u32 s38, s37, 0x2400
    buffer_load_dwordx4 v[152:155], v12, s[32:35], s38 offen sc1
    s_add_u32 s38, s37, 0x2800
    buffer_load_dwordx4 v[164:167], v12, s[32:35], s38 offen sc1
    s_add_u32 s38, s37, 0x2c00
    buffer_load_dwordx4 v[176:179], v12, s[32:35], s38 offen sc1
    s_waitcnt vmcnt(0)
    s_add_u32 s38, s37, 0x3000
    buffer_load_dwordx4 v[120:123], v12, s[32:35], s38 offen sc1
    s_add_u32 s38, s37, 0x3400
    buffer_load_dwordx4 v[132:135], v12, s[32:35], s38 offen sc1
    s_add_u32 s38, s37, 0x3800
    buffer_load_dwordx4 v[144:147], v12, s[32:35], s38 offen sc1
    s_waitcnt vmcnt(0)
    s_add_u32 s38, s37, 0x3c00
    buffer_load_dwordx4 v[156:159], v12, s[32:35], s38 offen sc1
    s_add_u32 s38, s37, 0x4000
    buffer_load_dwordx4 v[168:171], v12, s[32:35], s38 offen sc1
    s_add_u32 s38, s37, 0x4400
    buffer_load_dwordx4 v[180:183], v12, s[32:35], s38 offen sc1
    s_waitcnt vmcnt(0)
L_tail:
    v_lshlrev_b32 v6, 4, v1
    v_add_u32 v2, 0x3400, v12
    v_add_u32 v3, 0x15400, v12
    v_add_u32 v4, 0x6400, v6
    v_add_u32 v5, 0x18400, v6
    s_lshl_b32 s49, s2, 13
    s_lshl_b32 s38, s36, 11
    s_add_u32 s49, s49, s38
    s_add_u32 s49, s49, 0x80000
    s_mov_b32 s51, 0x42200000
    v_and_b32 v8, 3, v1
    v_lshlrev_b32 v8, 2, v8
    ds_read_b32 v200, v8 offset:7040
    s_nop 0
L_spin97:
    ds_read_b32 v15, v11 offset:6992
    s_waitcnt lgkmcnt(0)
    v_readfirstlane_b32 s37, v15
    s_nop 0
    s_cmp_ge_u32 s37, 1
    s_cbranch_scc1 L_spun98
    s_sleep 1
    s_branch L_spin97
L_spun98:
    ds_read_b128 v[48:51], v2
    ds_read_b128 v[52:55], v2 offset:1024
    ds_read_b128 v[56:59], v2 offset:2048
    ds_read_b128 v[60:63], v2 offset:3072
    ds_read_b128 v[64:67], v2 offset:4096
    ds_read_b128 v[68:71], v2 offset:5120
    ds_read_b128 v[72:75], v4
    s_cmp_eq_u32 s37, 2
    s_cbranch_scc1 L_agen
    s_waitcnt vmcnt(0)
    s_waitcnt lgkmcnt(6)
    v_mfma_f32_16x16x32_bf16 v[16:19], v[112:115], v[48:51], 0
    ds_read_b32 v108, v11 offset:6996
    v_mfma_f32_16x16x32_bf16 v[20:23], v[116:119], v[48:51], 0
    ds_read_b128 v[80:83], v2 offset:36864
    v_mfma_f32_16x16x32_bf16 v[24:27], v[120:123], v[48:51], 0
    ds_read_b128 v[84:87], v2 offset:37888
    s_waitcnt lgkmcnt(8)
    v_mfma_f32_16x16x32_bf16 v[16:19], v[124:127], v[52:55], v[16:19]
    ds_read_b128 v[88:91], v2 offset:38912
    v_mfma_f32_16x16x32_bf16 v[20:23], v[128:131], v[52:55], v[20:23]
    ds_read_b128 v[92:95], v2 offset:39936
    v_mfma_f32_16x16x32_bf16 v[24:27], v[132:135], v[52:55], v[24:27]
    ds_read_b128 v[96:99], v2 offset:40960
    s_waitcnt lgkmcnt(6)
    v_mfma_f32_16x16x32_bf16 v[16:19], v[136:139], v[56:59], v[16:19]
    ds_read_b128 v[100:103], v2 offset:41984
    v_mfma_f32_16x16x32_bf16 v[20:23], v[140:143], v[56:59], v[20:23]
    ds_read_b128 v[104:107], v4 offset:36864
    v_mfma_f32_16x16x32_bf16 v[24:27], v[144:147], v[56:59], v[24:27]
    v_add_f32 v72, v72, v73
    v_mfma_f32_16x16x32_bf16 v[16:19], v[148:151], v[60:63], v[16:19]
    v_add_f32 v74, v74, v75
    v_mfma_f32_16x16x32_bf16 v[20:23], v[152:155], v[60:63], v[20:23]
    v_add_f32 v7, v72, v74
    v_mfma_f32_16x16x32_bf16 v[24:27], v[156:159], v[60:63], v[24:27]
    v_mfma_f32_16x16x32_bf16 v[16:19], v[160:163], v[64:67], v[16:19]
    v_mfma_f32_16x16x32_bf16 v[20:23], v[164:167], v[64:67], v[20:23]
    v_mfma_f32_16x16x32_bf16 v[24:27], v[168:171], v[64:67], v[24:27]
    s_waitcnt lgkmcnt(0)
    v_readfirstlane_b32 s37, v108
    v_mfma_f32_16x16x32_bf16 v[16:19], v[172:175], v[68:71], v[16:19]
    v_mfma_f32_16x16x32_bf16 v[20:23], v[176:179], v[68:71], v[20:23]
    s_cmp_eq_u32 s37, 1
    v_mfma_f32_16x16x32_bf16 v[24:27], v[180:183], v[68:71], v[24:27]
    s_cbranch_scc1 L_bo100
    s_branch L_bt99x
L_bt99:
    s_waitcnt lgkmcnt(0)
    v_readfirstlane_b32 s37, v108
    s_nop 0
    s_cmp_eq_u32 s37, 1
    s_cbranch_scc1 L_bo100
L_bt99x:
    s_cmp_eq_u32 s37, 2
    s_cbranch_scc1 L_agen
    ds_read_b32 v108, v11 offset:6996
    ds_read_b128 v[80:83], v2 offset:36864
    ds_read_b128 v[84:87], v2 offset:37888
    ds_read_b128 v[88:91], v2 offset:38912
    ds_read_b128 v[92:95], v2 offset:39936
    ds_read_b128 v[96:99], v2 offset:40960
    ds_read_b128 v[100:103], v2 offset:41984
    ds_read_b128 v[104:107], v4 offset:36864
    s_branch L_bt99
L_bo100:
    v_mfma_f32_16x16x32_bf16 v[16:19], v[112:115], v[80:83], v[16:19]
    ds_read_b32 v76, v11 offset:7000
    v_mfma_f32_16x16x32_bf16 v[20:23], v[116:119], v[80:83], v[20:23]
    ds_read_b128 v[48:51], v3
    v_mfma_f32_16x16x32_bf16 v[24:27], v[120:123], v[80:83], v[24:27]
    ds_read_b128 v[52:55], v3 offset:1024
    v_mfma_f32_16x16x32_bf16 v[16:19], v[124:127], v[84:87], v[16:19]
    ds_read_b128 v[56:59], v3 offset:2048
    v_mfma_f32_16x16x32_bf16 v[20:23], v[128:131], v[84:87], v[20:23]
    ds_read_b128 v[60:63], v3 offset:3072
    v_mfma_f32_16x16x32_bf16 v[24:27], v[132:135], v[84:87], v[24:27]
    ds_read_b128 v[64:67], v3 offset:4096
    v_mfma_f32_16x16x32_bf16 v[16:19], v[136:139], v[88:91], v[16:19]
    ds_read_b128 v[68:71], v3 offset:5120
    v_mfma_f32_16x16x32_bf16 v[20:23], v[140:143], v[88:91], v[20:23]
    ds_read_b128 v[72:75], v5
    v_mfma_f32_16x16x32_bf16 v[24:27], v[144:147], v[88:91], v[24:27]
    v_add_f32 v104, v104, v105
    v_mfma_f32_16x16x32_bf16 v[16:19], v[148:151], v[92:95], v[16:19]
    v_add_f32 v106, v106, v107
    v_mfma_f32_16x16x32_bf16 v[20:23], v[152:155], v[92:95], v[20:23]
    v_add_f32 v104, v104, v106
    v_mfma_f32_16x16x32_bf16 v[24:27], v[156:159], v[92:95], v[24:27]
    v_add_f32 v7, v7, v104
    v_mfma_f32_16x16x32_bf16 v[16:19], v[160:163], v[96:99], v[16:19]
    v_mfma_f32_16x16x32_bf16 v[20:23], v[164:167], v[96:99], v[20:23]
    v_mfma_f32_16x16x32_bf16 v[24:27], v[168:171], v[96:99], v[24:27]
    s_waitcnt lgkmcnt(0)
    v_readfirstlane_b32 s37, v76
    v_mfma_f32_16x16x32_bf16 v[16:19], v[172:175], v[100:103], v[16:19]
    v_mfma_f32_16x16x32_bf16 v[20:23], v[176:179], v[100:103], v[20:23]
    s_cmp_eq_u32 s37, 1
    v_mfma_f32_16x16x32_bf16 v[24:27], v[180:183], v[100:103], v[24:27]
    s_cbranch_scc1 L_bo102
    s_branch L_bt101x
L_bt101:
    s_waitcnt lgkmcnt(0)
    v_readfirstlane_b32 s37, v76
    s_nop 0
    s_cmp_eq_u32 s37, 1
    s_cbranch_scc1 L_bo102
L_bt101x:
    s_cmp_eq_u32 s37, 2
    s_cbranch_scc1 L_agen
    ds_read_b32 v76, v11 offset:7000
    ds_read_b128 v[48:51], v3
    ds_read_b128 v[52:55], v3 offset:1024
    ds_read_b128 v[56:59], v3 offset:2048
    ds_read_b128 v[60:63], v3 offset:3072
    ds_read_b128 v[64:67], v3 offset:4096
    ds_read_b128 v[68:71], v3 offset:5120
    ds_read_b128 v[72:75], v5
    s_branch L_bt101
L_bo102:
    v_mfma_f32_16x16x32_bf16 v[16:19], v[112:115], v[48:51], v[16:19]
    ds_read_b32 v108, v11 offset:7004
    v_mfma_f32_16x16x32_bf16 v[20:23], v[116:119], v[48:51], v[20:23]
    ds_read_b128 v[80:83], v3 offset:36864
    v_mfma_f32_16x16x32_bf16 v[24:27], v[120:123], v[48:51], v[24:27]
    ds_read_b128 v[84:87], v3 offset:37888
    v_mfma_f32_16x16x32_bf16 v[16:19], v[124:127], v[52:55], v[16:19]
    ds_read_b128 v[88:91], v3 offset:38912
    v_mfma_f32_16x16x32_bf16 v[20:23], v[128:131], v[52:55], v[20:23]
    ds_read_b128 v[92:95], v3 offset:39936
    v_mfma_f32_16x16x32_bf16 v[24:27], v[132:135], v[52:55], v[24:27]
    ds_read_b128 v[96:99], v3 offset:40960
    v_mfma_f32_16x16x32_bf16 v[16:19], v[136:139], v[56:59], v[16:19]
    ds_read_b128 v[100:103], v3 offset:41984
    v_mfma_f32_16x16x32_bf16 v[20:23], v[140:143], v[56:59], v[20:23]
    ds_read_b128 v[104:107], v5 offset:36864
    v_mfma_f32_16x16x32_bf16 v[24:27], v[144:147], v[56:59], v[24:27]
    v_add_f32 v72, v72, v73
    v_mfma_f32_16x16x32_bf16 v[16:19], v[148:151], v[60:63], v[16:19]
    v_add_f32 v74, v74, v75
    v_mfma_f32_16x16x32_bf16 v[20:23], v[152:155], v[60:63], v[20:23]
    v_add_f32 v72, v72, v74
    v_mfma_f32_16x16x32_bf16 v[24:27], v[156:159], v[60:63], v[24:27]
    v_add_f32 v7, v7, v72
    v_mfma_f32_16x16x32_bf16 v[16:19], v[160:163], v[64:67], v[16:19]
    v_mfma_f32_16x16x32_bf16 v[20:23], v[164:167], v[64:67], v[20:23]
    v_mfma_f32_16x16x32_bf16 v[24:27], v[168:171], v[64:67], v[24:27]
    s_waitcnt lgkmcnt(0)
    v_readfirstlane_b32 s37, v108
    v_mfma_f32_16x16x32_bf16 v[16:19], v[172:175], v[68:71], v[16:19]
    v_mfma_f32_16x16x32_bf16 v[20:23], v[176:179], v[68:71], v[20:23]
    s_cmp_eq_u32 s37, 1
    v_mfma_f32_16x16x32_bf16 v[24:27], v[180:183], v[68:71], v[24:27]
    s_cbranch_scc1 L_bo104
    s_branch L_bt103x
L_bt103:
    s_waitcnt lgkmcnt(0)
    v_readfirstlane_b32 s37, v108
    s_nop 0
    s_cmp_eq_u32 s37, 1
    s_cbranch_scc1 L_bo104
L_bt103x:
    s_cmp_eq_u32 s37, 2
    s_cbranch_scc1 L_agen
    ds_read_b32 v108, v11 offset:7004
    ds_read_b128 v[80:83], v3 offset:36864
    ds_read_b128 v[84:87], v3 offset:37888
    ds_read_b128 v[88:91], v3 offset:38912
    ds_read_b128 v[92:95], v3 offset:39936
    ds_read_b128 v[96:99], v3 offset:40960
    ds_read_b128 v[100:103], v3 offset:41984
    ds_read_b128 v[104:107], v5 offset:36864
    s_branch L_bt103
L_bo104:
    v_mfma_f32_16x16x32_bf16 v[16:19], v[112:115], v[80:83], v[16:19]
    v_add_f32 v104, v104, v105
    v_mfma_f32_16x16x32_bf16 v[20:23], v[116:119], v[80:83], v[20:23]
    v_add_f32 v106, v106, v107
    v_mfma_f32_16x16x32_bf16 v[16:19], v[124:127], v[84:87], v[16:19]
    v_add_f32 v104, v104, v106
    v_mfma_f32_16x16x32_bf16 v[20:23], v[128:131], v[84:87], v[20:23]
    v_add_f32 v7, v7, v104
    v_mfma_f32_16x16x32_bf16 v[16:19], v[136:139], v[88:91], v[16:19]
    v_cvt_pk_bf16_f32 v8, 0, v7
    v_mfma_f32_16x16x32_bf16 v[20:23], v[140:143], v[88:91], v[20:23]
    v_or_b32 v195, v8, v200
    v_mfma_f32_16x16x32_bf16 v[16:19], v[148:151], v[92:95], v[16:19]
    v_or_b32 v199, v8, v200
    v_mfma_f32_16x16x32_bf16 v[20:23], v[152:155], v[92:95], v[20:23]
    v_mfma_f32_16x16x32_bf16 v[16:19], v[160:163], v[96:99], v[16:19]
    v_mfma_f32_16x16x32_bf16 v[20:23], v[164:167], v[96:99], v[20:23]
    v_mfma_f32_16x16x32_bf16 v[16:19], v[172:175], v[100:103], v[16:19]
    v_mfma_f32_16x16x32_bf16 v[20:23], v[176:179], v[100:103], v[20:23]
    v_mfma_f32_16x16x32_bf16 v[24:27], v[120:123], v[80:83], v[24:27]
    v_mfma_f32_16x16x32_bf16 v[24:27], v[132:135], v[84:87], v[24:27]
    v_mfma_f32_16x16x32_bf16 v[24:27], v[144:147], v[88:91], v[24:27]
    s_nop 2
    s_nop 0
    v_cvt_pk_bf16_f32 v192, v16, v17
    v_cvt_pk_bf16_f32 v193, v18, v19
    v_mfma_f32_16x16x32_bf16 v[24:27], v[156:159], v[92:95], v[24:27]
    v_cvt_pk_bf16_f32 v194, v20, v21
    buffer_store_dwordx4 v[192:195], v12, s[32:35], s49 offen sc1
    v_mfma_f32_16x16x32_bf16 v[24:27], v[168:171], v[96:99], v[24:27]
    v_cvt_pk_bf16_f32 v196, v22, v23
    v_mfma_f32_16x16x32_bf16 v[24:27], v[180:183], v[100:103], v[24:27]
    s_nop 7
    v_cvt_pk_bf16_f32 v197, v24, v25
    v_cvt_pk_bf16_f32 v198, v26, v27
    buffer_store_dwordx4 v[196:199], v12, s[32:35], s49 offen offset:1024 sc1
L_aend:
    v_mov_b32 v15, 1
    s_mov_b64 exec, 1
    ds_add_u32 v11, v15 offset:6964
    s_mov_b64 exec, -1
    s_endpgm
L_agen:
    s_waitcnt vmcnt(0)
L_spin105:
    ds_read_b32 v15, v11 offset:6992
    s_waitcnt lgkmcnt(0)
    v_readfirstlane_b32 s37, v15
    s_nop 0
    s_cmp_ge_u32 s37, 1
    s_cbranch_scc1 L_spun106
    s_sleep 1
    s_branch L_spin105
L_spun106:
    v_add_u32 v3, 0x6400, v6
    ds_read_b32 v205, v3 offset:512
    s_waitcnt lgkmcnt(0)
    v_mov_b32 v9, v205
    s_nop 1
L_spin107:
    ds_read_b32 v15, v11 offset:6996
    s_waitcnt lgkmcnt(0)
    v_readfirstlane_b32 s37, v15
    s_nop 0
    s_cmp_ge_u32 s37, 1
    s_cbranch_scc1 L_spun108
    s_sleep 1
    s_branch L_spin107
L_spun108:
    v_add_u32 v3, 0xf400, v6
    ds_read_b32 v205, v3 offset:512
    s_waitcnt lgkmcnt(0)
    v_max_f32 v9, v9, v205
    s_nop 1
L_spin109:
    ds_read_b32 v15, v11 offset:7000
    s_waitcnt lgkmcnt(0)
    v_readfirstlane_b32 s37, v15
    s_nop 0
    s_cmp_ge_u32 s37, 1
    s_cbranch_scc1 L_spun110
    s_sleep 1
    s_branch L_spin109
L_spun110:
    v_add_u32 v3, 0x18400, v6
    ds_read_b32 v205, v3 offset:512
    s_waitcnt lgkmcnt(0)
    v_max_f32 v9, v9, v205
    s_nop 1
L_spin111:
    ds_read_b32 v15, v11 offset:7004
    s_waitcnt lgkmcnt(0)
    v_readfirstlane_b32 s37, v15
    s_nop 0
    s_cmp_ge_u32 s37, 1
    s_cbranch_scc1 L_spun112
    s_sleep 1
    s_branch L_spin111
L_spun112:
    v_add_u32 v3, 0x21400, v6
    ds_read_b32 v205, v3 offset:512
    s_waitcnt lgkmcnt(0)
    v_max_f32 v9, v9, v205
    v_cmp_nlt_f32_e64 s[56:57], |v9|, s51
    s_nop 1
    v_cndmask_b32 v10, 0, v9, s[56:57]
    v_mov_b32 v7, 0
    v_mov_b32 v16, 0
    v_mov_b32 v17, 0
    v_mov_b32 v18, 0
    v_mov_b32 v19, 0
    v_mov_b32 v20, 0
    v_mov_b32 v21, 0
    v_mov_b32 v22, 0
    v_mov_b32 v23, 0
    v_mov_b32 v24, 0
    v_mov_b32 v25, 0
    v_mov_b32 v26, 0
    v_mov_b32 v27, 0
    s_mov_b32 s58, 0
    s_nop 0
L_agen_w:
    s_mul_i32 s59, s58, 0x9000
    s_add_u32 s59, s59, 0x3400
    v_add_u32 v2, s59, v12
    v_add_u32 v3, s59, v6
    ds_read_b128 v[48:51], v2
    ds_read_b128 v[52:55], v2 offset:1024
    ds_read_b128 v[56:59], v2 offset:2048
    ds_read_b128 v[60:63], v2 offset:3072
    ds_read_b128 v[64:67], v2 offset:4096
    ds_read_b128 v[68:71], v2 offset:5120
    ds_read_b32 v205, v3 offset:12800
    ds_read_b128 v[72:75], v3 offset:12288
    s_waitcnt lgkmcnt(0)
    v_mfma_f32_16x16x32_bf16 v[32:35], v[112:115], v[48:51], 0
    v_mfma_f32_16x16x32_bf16 v[36:39], v[116:119], v[48:51], 0
    v_mfma_f32_16x16x32_bf16 v[40:43], v[120:123], v[48:51], 0
    v_mfma_f32_16x16x32_bf16 v[32:35], v[124:127], v[52:55], v[32:35]
    v_mfma_f32_16x16x32_bf16 v[36:39], v[128:131], v[52:55], v[36:39]
    v_mfma_f32_16x16x32_bf16 v[40:43], v[132:135], v[52:55], v[40:43]
    v_mfma_f32_16x16x32_bf16 v[32:35], v[136:139], v[56:59], v[32:35]
    v_mfma_f32_16x16x32_bf16 v[36:39], v[140:143], v[56:59], v[36:39]
    v_mfma_f32_16x16x32_bf16 v[40:43], v[144:147], v[56:59], v[40:43]
    v_mfma_f32_16x16x32_bf16 v[32:35], v[148:151], v[60:63], v[32:35]
    v_mfma_f32_16x16x32_bf16 v[36:39], v[152:155], v[60:63], v[36:39]
    v_mfma_f32_16x16x32_bf16 v[40:43], v[156:159], v[60:63], v[40:43]
    v_mfma_f32_16x16x32_bf16 v[32:35], v[160:163], v[64:67], v[32:35]
    v_mfma_f32_16x16x32_bf16 v[36:39], v[164:167], v[64:67], v[36:39]
    v_mfma_f32_16x16x32_bf16 v[40:43], v[168:171], v[64:67], v[40:43]
    v_mfma_f32_16x16x32_bf16 v[32:35], v[172:175], v[68:71], v[32:35]
    v_mfma_f32_16x16x32_bf16 v[36:39], v[176:179], v[68:71], v[36:39]
    v_mfma_f32_16x16x32_bf16 v[40:43], v[180:183], v[68:71], v[40:43]
    v_sub_f32 v14, v205, v10
    v_exp_f32 v13, v14
    v_add_f32 v72, v72, v73
    v_add_f32 v74, v74, v75
    v_add_f32 v72, v72, v74
    v_fmac_f32 v7, v13, v72
    v_fmac_f32 v16, v13, v32
    v_fmac_f32 v17, v13, v33
    v_fmac_f32 v18, v13, v34
    v_fmac_f32 v19, v13, v35
    v_fmac_f32 v20, v13, v36
    v_fmac_f32 v21, v13, v37
    v_fmac_f32 v22, v13, v38
    v_fmac_f32 v23, v13, v39
    v_fmac_f32 v24, v13, v40
    v_fmac_f32 v25, v13, v41
    v_fmac_f32 v26, v13, v42
    v_fmac_f32 v27, v13, v43
    s_add_u32 s58, s58, 1
    s_cmp_lt_u32 s58, 4
    s_cbranch_scc1 L_agen_w
    v_cndmask_b32 v14, 0, 1, s[56:57]
    v_or_b32 v200, v200, v14
    ds_read_b64 v[74:75], v11 offset:7040
    v_mov_b32 v72, v10
    v_lshrrev_b32 v14, 1, v6
    s_lshl_b32 s38, s2, 7
    s_add_u32 s38, s38, 0x30000
    s_waitcnt lgkmcnt(0)
    v_lshl_or_b32 v73, v75, 16, v74
    s_mov_b64 exec, 0xffff
    buffer_store_dwordx2 v[72:73], v14, s[32:35], s38 offen sc1
    s_mov_b64 exec, -1
    v_cvt_pk_bf16_f32 v8, 0, v7
    v_or_b32 v195, v8, v200
    v_or_b32 v199, v8, v200
    v_cvt_pk_bf16_f32 v192, v16, v17
    v_cvt_pk_bf16_f32 v193, v18, v19
    v_cvt_pk_bf16_f32 v194, v20, v21
    buffer_store_dwordx4 v[192:195], v12, s[32:35], s49 offen sc1
    v_cvt_pk_bf16_f32 v196, v22, v23
    v_cvt_pk_bf16_f32 v197, v24, v25
    v_cvt_pk_bf16_f32 v198, v26, v27
    buffer_store_dwordx4 v[196:199], v12, s[32:35], s49 offen offset:1024 sc1
    s_nop 1
    s_branch L_aend
L_exit:
    s_endpgm
L_code_end:
.section .rodata,"a"
.p2align 6
.amdhsa_kernel standalone__detection_seg_dino__vision_kernel
  .amdhsa_next_free_vgpr 256
  .amdhsa_next_free_sgpr 96
  .amdhsa_accum_offset 256
  .amdhsa_group_segment_fixed_size 0
  .amdhsa_kernarg_size 80
  .amdhsa_user_sgpr_count 2
  .amdhsa_user_sgpr_kernarg_segment_ptr 1
  .amdhsa_system_sgpr_workgroup_id_x 1
  .amdhsa_float_denorm_mode_32 3
.end_amdhsa_kernel
```

```asm
; @launch grid=(256,1,1) block=(512,1,1) lds=160768
.amdgcn_target "amdgcn-amd-amdhsa--gfx950"
.text
.globl standalone__detection_seg_dino__vision_kernel
.p2align 8
.type standalone__detection_seg_dino__vision_kernel,@function
standalone__detection_seg_dino__vision_kernel:
    s_cmp_ge_u32 s2, 0x100
    s_cbranch_scc1 L_exit
    s_load_dwordx16 s[4:19], s[0:1], 0
    s_load_dwordx4 s[20:23], s[0:1], 64
    v_lshrrev_b32 v1, 6, v0
    v_and_b32 v0, 63, v0
    v_readfirstlane_b32 s3, v1
    s_nop 2
    s_cmp_lt_u32 s3, 4
    s_cbranch_scc1 L_compute
    s_cmp_gt_u32 s3, 4
    s_cbranch_scc1 L_aux0
    s_setprio 3
    v_add_u32 v4, 0, v0
    v_mul_u32_u24 v4, 0xaab, v4
    v_lshrrev_b32 v4, 16, v4
    v_and_b32 v11, 6, v4
    v_xor_b32 v11, v11, v0
    v_lshlrev_b32 v1, 4, v11
    v_add_u32 v5, 64, v0
    v_mul_u32_u24 v5, 0xaab, v5
    v_lshrrev_b32 v5, 16, v5
    v_and_b32 v11, 6, v5
    v_xor_b32 v11, v11, v0
    v_lshlrev_b32 v2, 4, v11
    v_add_u32 v6, 0x80, v0
    v_mul_u32_u24 v6, 0xaab, v6
    v_lshrrev_b32 v6, 16, v6
    v_and_b32 v11, 6, v6
    v_xor_b32 v11, v11, v0
    v_lshlrev_b32 v3, 4, v11
    s_and_b32 s38, s2, 7
    s_lshl_b32 s38, s38, 5
    s_lshr_b32 s45, s2, 3
    s_or_b32 s38, s38, s45
    s_lshl_b32 s38, s38, 2
    s_mov_b32 s27, 0x20000
    s_mov_b32 s26, 0x1800000
    s_mul_i32 s39, s38, 0x1800
    s_mov_b32 s44, 0x3400
    s_cmp_lt_u32 s2, 6
    s_cbranch_scc1 L_ld_prod
    s_waitcnt lgkmcnt(0)
    s_mov_b32 s24, s8
    s_mov_b32 s25, s9
L_ld_first:
    s_mov_b32 m0, s44
    s_add_u32 s46, s39, 0xc00
    buffer_load_dwordx4 v1, s[24:27], s39 offen nt lds
    buffer_load_dwordx4 v2, s[24:27], s39 offen offset:1024 nt lds
    buffer_load_dwordx4 v3, s[24:27], s39 offen offset:2048 nt lds
    s_add_u32 m0, s44, 0xc00
    s_add_u32 s44, s44, 0x9000
    buffer_load_dwordx4 v1, s[24:27], s46 offen nt lds
    buffer_load_dwordx4 v2, s[24:27], s46 offen offset:1024 nt lds
    buffer_load_dwordx4 v3, s[24:27], s46 offen offset:2048 nt lds
    s_add_u32 s39, s39, 0x1800
    s_cmp_lt_u32 s44, 0x27400
    s_cbranch_scc1 L_ld_first
    s_branch L_ld_norm
L_aux0:
    s_getpc_b64 s[24:25]
L_aux_pc:
    s_sub_u32 s24, s24, L_aux_pc-standalone__detection_seg_dino__vision_kernel
    s_subb_u32 s25, s25, 0
    s_mov_b32 s26, L_code_end-standalone__detection_seg_dino__vision_kernel
    s_mov_b32 s27, 0x20000
    s_lshr_b32 s39, s2, 3
    s_mul_i32 s38, s39, 3
    s_add_u32 s38, s38, s3
    s_mul_i32 s38, s38, 0x140
    s_sub_u32 s38, s38, 0x640
    v_lshlrev_b32 v14, 6, v0
    s_mov_b64 exec, 31
    buffer_load_dword v253, v14, s[24:27], s38 offen
    s_mov_b64 exec, -1
    s_and_b32 s38, s2, 7
    s_mul_i32 s37, s3, 3
    s_add_u32 s38, s38, 18
    s_sub_u32 s38, s38, s37
    s_cmp_ge_u32 s38, 3
    s_cbranch_scc1 L_aux
    s_mul_i32 s37, s39, 0x900
    v_mul_u32_u24 v13, 36, v0
    s_mov_b32 s30, 0x12000
    s_mov_b32 s42, 0x12000
    s_mov_b32 s31, s27
    s_mov_b32 s43, s27
    s_cmp_eq_u32 s3, 6
    s_waitcnt lgkmcnt(0)
    s_cselect_b64 s[28:29], s[10:11], s[16:17]
    s_cselect_b64 s[40:41], s[12:13], s[14:15]
    buffer_load_dword v254, v13, s[28:31], s37 offen
    buffer_load_dword v255, v13, s[40:43], s37 offen
    s_branch L_aux
L_ld_prod:
    s_mov_b32 s39, 0
    s_cmp_lt_u32 s2, 3
    s_cbranch_scc0 L_ld_wo0
    s_mov_b32 s26, 0x1800
    s_mov_b32 s44, 0x1c00
    s_mov_b32 s48, 1
    s_waitcnt lgkmcnt(0)
    s_mov_b64 s[24:25], s[4:5]
    s_call_b64 s[54:55], L_ld_tiles
    s_branch L_ld_wq
L_ld_tiles:
    s_mov_b32 m0, s44
    s_add_u32 s46, s39, 0xc00
    buffer_load_dwordx4 v1, s[24:27], s39 offen lds
    buffer_load_dwordx4 v2, s[24:27], s39 offen offset:1024 lds
    buffer_load_dwordx4 v3, s[24:27], s39 offen offset:2048 lds
    s_add_u32 m0, s44, 0xc00
    s_add_u32 s44, s44, 0x1800
    buffer_load_dwordx4 v1, s[24:27], s46 offen lds
    buffer_load_dwordx4 v2, s[24:27], s46 offen offset:1024 lds
    buffer_load_dwordx4 v3, s[24:27], s46 offen offset:2048 lds
    s_add_u32 s39, s39, 0x1800
    s_sub_u32 s48, s48, 1
    s_and_b32 s45, s48, 3
    s_cselect_b32 s45, 0, 0x3000
    s_add_u32 s44, s44, s45
    s_cmp_lg_u32 s48, 0
    s_cbranch_scc1 L_ld_tiles
    s_setpc_b64 s[54:55]
L_ld_wq:
    s_mov_b64 s[24:25], s[10:11]
    s_mov_b32 s26, 0x12000
L_ld_w12:
    s_mov_b32 s39, 0
    s_mov_b32 s44, 0x6400
    s_mov_b32 s48, 4
    s_call_b64 s[54:55], L_ld_tiles
    v_mul_u32_u24 v4, 0x180, v4
    v_add_u32 v4, v4, v1
    v_mul_u32_u24 v5, 0x180, v5
    v_add_u32 v5, v5, v2
    v_mul_u32_u24 v6, 0x180, v6
    v_add_u32 v6, v6, v3
    v_mov_b32 v10, 0
    v_lshlrev_b32 v13, 2, v0
    s_mov_b64 exec, 0xffffffff
    ds_write_b32 v13, v10 offset:6912
    v_mov_b32 v11, 0x3f803f80
    s_mov_b64 exec, 3
    ds_write_b32 v13, v11 offset:7056
    s_mov_b64 exec, -1
    s_mov_b32 s50, 0
    s_mov_b32 s51, 0
    s_mov_b32 s52, 0
    s_mov_b32 s53, 0
    s_mov_b32 s36, 0
    s_mov_b32 s37, 0
    s_mov_b32 s57, 0
    s_waitcnt lgkmcnt(0)
    s_barrier
    s_waitcnt vmcnt(24)
    v_mov_b32 v11, 1
    s_mov_b64 exec, 1
    ds_max_u32 v10, v11 offset:6956
    s_mov_b64 exec, -1
    s_mov_b32 s48, 8
    s_call_b64 s[54:55], L_ld_tiles
    s_cmp_ge_u32 s2, 3
    s_cbranch_scc1 L_ld_w3
    s_mov_b64 s[24:25], s[12:13]
    s_mul_i32 s39, s2, 0x6000
    s_mov_b32 s48, 4
    s_call_b64 s[54:55], L_ld_tiles
L_ld_w3:
    s_waitcnt vmcnt(24)
    v_mov_b32 v11, 2
    s_mov_b64 exec, 1
    ds_max_u32 v10, v11 offset:6956
    s_mov_b64 exec, -1
    s_branch L_ld_stepp
L_ld_wo0:
    s_mov_b32 s26, 0x12000
    v_lshrrev_b32 v11, 3, v0
    v_mul_u32_u24 v11, 0x180, v11
    v_and_b32 v12, 7, v0
    v_lshl_add_u32 v11, v12, 4, v11
    s_sub_u32 s46, s2, 3
    s_lshl_b32 s46, s46, 7
    s_mov_b32 s45, 0x21400
    s_waitcnt lgkmcnt(0)
    s_mov_b64 s[24:25], s[16:17]
L_ld_wo:
    s_mov_b32 m0, s45
    s_add_u32 s45, s45, 0x400
    buffer_load_dwordx4 v11, s[24:27], s46 offen lds
    s_add_u32 s46, s46, 0xc00
    s_cmp_lt_u32 s45, 0x27400
    s_cbranch_scc1 L_ld_wo
    s_mov_b64 s[24:25], s[14:15]
    s_branch L_ld_w12
L_ld_norm:
    v_mul_u32_u24 v4, 0x180, v4
    v_add_u32 v4, v4, v1
    v_mul_u32_u24 v5, 0x180, v5
    v_add_u32 v5, v5, v2
    v_mul_u32_u24 v6, 0x180, v6
    v_add_u32 v6, v6, v3
    v_mov_b32 v10, 0
    v_lshlrev_b32 v13, 2, v0
    s_mov_b64 exec, 0xffffffff
    ds_write_b32 v13, v10 offset:6912
    v_mov_b32 v11, 0x3f803f80
    s_mov_b64 exec, 3
    ds_write_b32 v13, v11 offset:7056
    s_mov_b64 exec, -1
    s_mov_b32 s50, 0
    s_mov_b32 s51, 0
    s_mov_b32 s52, 0
    s_mov_b32 s53, 0
    s_mov_b32 s36, 1
    s_mov_b32 s37, 1
    s_mov_b32 s57, 1
    s_lshr_b32 s45, s38, 4
    s_mul_i32 s40, s45, 0x60000
    s_and_b32 s45, s38, 15
    s_mul_i32 s45, s45, 0x3000
    s_add_u32 s40, s40, s45
    s_add_u32 s38, s38, 0x400
    s_waitcnt lgkmcnt(0)
    s_barrier
L_ld_step:
    s_cmp_lg_u32 s37, 0
    s_cbranch_scc1 L_ld_fine
    s_mul_i32 s39, s38, 0x1800
    s_lshr_b32 s45, s38, 4
    s_mul_i32 s40, s45, 0x60000
    s_and_b32 s45, s38, 15
    s_mul_i32 s45, s45, 0x3000
    s_add_u32 s40, s40, s45
    s_add_u32 s38, s38, 0x400
    s_mov_b32 s24, s8
    s_mov_b32 s25, s9
    s_mov_b32 s26, 0x1800000
    s_mov_b32 s41, s39
    s_mov_b32 s42, 0x1800
    s_mov_b32 s43, 0xc00
    v_mov_b32 v7, v1
    v_mov_b32 v8, v2
    v_mov_b32 v9, v3
    s_branch L_ld_issue
L_ld_fine:
    s_mov_b32 s24, s6
    s_mov_b32 s25, s7
    s_mov_b32 s26, 0x6000000
    s_sub_u32 s45, s37, 1
    s_lshr_b32 s46, s45, 1
    s_mul_i32 s46, s46, 0x30000
    s_and_b32 s45, s45, 1
    s_mul_i32 s45, s45, 0x180
    s_add_u32 s41, s40, s46
    s_add_u32 s41, s41, s45
    s_mov_b32 s42, 0x3000
    s_mov_b32 s43, 0x1800
    v_mov_b32 v7, v4
    v_mov_b32 v8, v5
    v_mov_b32 v9, v6
L_ld_issue:
    s_mul_i32 s44, s57, 0x1800
    s_add_u32 s44, s44, 0x3400
    s_sub_i32 s48, s36, 5
    s_cmp_ge_i32 s50, s48
    s_cbranch_scc1 L_free1
    s_mov_b32 s56, 0
    s_call_b64 s[54:55], L_ld_wait
    s_mov_b32 s50, s45
L_free1:
    s_add_u32 m0, s44, 0
    s_mov_b32 s46, s41
    buffer_load_dwordx4 v7, s[24:27], s46 offen nt lds
    buffer_load_dwordx4 v8, s[24:27], s46 offen offset:1024 nt lds
    buffer_load_dwordx4 v9, s[24:27], s46 offen offset:2048 nt lds
    s_add_u32 m0, s44, 0xc00
    s_add_u32 s46, s41, s43
    buffer_load_dwordx4 v7, s[24:27], s46 offen nt lds
    buffer_load_dwordx4 v8, s[24:27], s46 offen offset:1024 nt lds
    buffer_load_dwordx4 v9, s[24:27], s46 offen offset:2048 nt lds
    s_add_u32 s41, s41, s42
    s_add_i32 s47, s36, 0
    s_max_i32 s47, s47, 0
    s_waitcnt vmcnt(24)
    v_mov_b32 v11, s47
    s_mov_b64 exec, 1
    ds_max_u32 v10, v11 offset:6912
    s_mov_b64 exec, -1
    s_cmp_ge_i32 s51, s48
    s_cbranch_scc1 L_free2
    s_mov_b32 s56, 1
    s_call_b64 s[54:55], L_ld_wait
    s_mov_b32 s51, s45
L_free2:
    s_add_u32 m0, s44, 0x9000
    s_mov_b32 s46, s41
    buffer_load_dwordx4 v7, s[24:27], s46 offen nt lds
    buffer_load_dwordx4 v8, s[24:27], s46 offen offset:1024 nt lds
    buffer_load_dwordx4 v9, s[24:27], s46 offen offset:2048 nt lds
    s_add_u32 m0, s44, 0x9c00
    s_add_u32 s46, s41, s43
    buffer_load_dwordx4 v7, s[24:27], s46 offen nt lds
    buffer_load_dwordx4 v8, s[24:27], s46 offen offset:1024 nt lds
    buffer_load_dwordx4 v9, s[24:27], s46 offen offset:2048 nt lds
    s_add_u32 s41, s41, s42
    s_add_i32 s47, s36, 0
    s_max_i32 s47, s47, 0
    s_waitcnt vmcnt(24)
    v_mov_b32 v11, s47
    s_mov_b64 exec, 1
    ds_max_u32 v10, v11 offset:6916
    s_mov_b64 exec, -1
    s_cmp_ge_i32 s52, s48
    s_cbranch_scc1 L_free3
    s_mov_b32 s56, 2
    s_call_b64 s[54:55], L_ld_wait
    s_mov_b32 s52, s45
L_free3:
    s_add_u32 m0, s44, 0x12000
    s_mov_b32 s46, s41
    buffer_load_dwordx4 v7, s[24:27], s46 offen nt lds
    buffer_load_dwordx4 v8, s[24:27], s46 offen offset:1024 nt lds
    buffer_load_dwordx4 v9, s[24:27], s46 offen offset:2048 nt lds
    s_add_u32 m0, s44, 0x12c00
    s_add_u32 s46, s41, s43
    buffer_load_dwordx4 v7, s[24:27], s46 offen nt lds
    buffer_load_dwordx4 v8, s[24:27], s46 offen offset:1024 nt lds
    buffer_load_dwordx4 v9, s[24:27], s46 offen offset:2048 nt lds
    s_add_u32 s41, s41, s42
    s_add_i32 s47, s36, 0
    s_max_i32 s47, s47, 0
    s_waitcnt vmcnt(24)
    v_mov_b32 v11, s47
    s_mov_b64 exec, 1
    ds_max_u32 v10, v11 offset:6920
    s_mov_b64 exec, -1
    s_cmp_ge_i32 s53, s48
    s_cbranch_scc1 L_free4
    s_mov_b32 s56, 3
    s_call_b64 s[54:55], L_ld_wait
    s_mov_b32 s53, s45
L_free4:
    s_add_u32 m0, s44, 0x1b000
    s_mov_b32 s46, s41
    buffer_load_dwordx4 v7, s[24:27], s46 offen nt lds
    buffer_load_dwordx4 v8, s[24:27], s46 offen offset:1024 nt lds
    buffer_load_dwordx4 v9, s[24:27], s46 offen offset:2048 nt lds
    s_add_u32 m0, s44, 0x1bc00
    s_add_u32 s46, s41, s43
    buffer_load_dwordx4 v7, s[24:27], s46 offen nt lds
    buffer_load_dwordx4 v8, s[24:27], s46 offen offset:1024 nt lds
    buffer_load_dwordx4 v9, s[24:27], s46 offen offset:2048 nt lds
    s_add_u32 s41, s41, s42
    s_add_i32 s47, s36, 0
    s_max_i32 s47, s47, 0
    s_waitcnt vmcnt(24)
    v_mov_b32 v11, s47
    s_mov_b64 exec, 1
    ds_max_u32 v10, v11 offset:6924
    s_mov_b64 exec, -1
    s_add_u32 s37, s37, 1
    s_cmp_eq_u32 s37, 5
    s_cselect_b32 s37, 0, s37
    s_add_u32 s57, s57, 1
    s_cmp_eq_u32 s57, 6
    s_cselect_b32 s57, 0, s57
    s_add_u32 s36, s36, 1
    s_cmp_lt_u32 s36, 20
    s_cbranch_scc1 L_ld_step
    s_mov_b32 s32, s22
    s_mov_b32 s33, s23
    s_mov_b32 s34, 0x1000000
    s_mov_b32 s35, 0x20000
    v_lshlrev_b32 v12, 4, v0
    s_nop 1
L_spin5:
    ds_read_b32 v11, v10 offset:6976
    s_waitcnt lgkmcnt(0)
    v_readfirstlane_b32 s45, v11
    s_nop 0
    s_cmp_ge_u32 s45, 1
    s_cbranch_scc1 L_spun6
    s_sleep 1
    s_branch L_spin5
L_spun6:
    s_mov_b32 s46, 0x1d800
    buffer_load_dwordx4 v[112:115], v12, s[32:35], s46 offen sc1
    s_mov_b32 s46, 0x1dc00
    buffer_load_dwordx4 v[124:127], v12, s[32:35], s46 offen sc1
    s_mov_b32 s46, 0x1e000
    buffer_load_dwordx4 v[136:139], v12, s[32:35], s46 offen sc1
    s_mov_b32 s46, 0x1e400
    buffer_load_dwordx4 v[148:151], v12, s[32:35], s46 offen sc1
    s_mov_b32 s46, 0x1e800
    buffer_load_dwordx4 v[160:163], v12, s[32:35], s46 offen sc1
    s_mov_b32 s46, 0x1ec00
    buffer_load_dwordx4 v[172:175], v12, s[32:35], s46 offen sc1
    s_mov_b32 s46, 0x1f000
    buffer_load_dwordx4 v[116:119], v12, s[32:35], s46 offen sc1
    s_mov_b32 s46, 0x1f400
    buffer_load_dwordx4 v[128:131], v12, s[32:35], s46 offen sc1
    s_mov_b32 s46, 0x1f800
    buffer_load_dwordx4 v[140:143], v12, s[32:35], s46 offen sc1
    s_mov_b32 s46, 0x1fc00
    buffer_load_dwordx4 v[152:155], v12, s[32:35], s46 offen sc1
    s_mov_b32 s46, 0x20000
    buffer_load_dwordx4 v[164:167], v12, s[32:35], s46 offen sc1
    s_mov_b32 s46, 0x20400
    buffer_load_dwordx4 v[176:179], v12, s[32:35], s46 offen sc1
    s_mov_b32 s46, 0x20800
    buffer_load_dwordx4 v[120:123], v12, s[32:35], s46 offen sc1
    s_mov_b32 s46, 0x20c00
    buffer_load_dwordx4 v[132:135], v12, s[32:35], s46 offen sc1
    s_mov_b32 s46, 0x21000
    buffer_load_dwordx4 v[144:147], v12, s[32:35], s46 offen sc1
    s_mov_b32 s46, 0x21400
    buffer_load_dwordx4 v[156:159], v12, s[32:35], s46 offen sc1
    s_mov_b32 s46, 0x21800
    buffer_load_dwordx4 v[168:171], v12, s[32:35], s46 offen sc1
    s_mov_b32 s46, 0x21c00
    buffer_load_dwordx4 v[180:183], v12, s[32:35], s46 offen sc1
    v_mov_b32 v11, 20
    v_mov_b32 v16, 19
    s_mov_b64 exec, 1
    s_waitcnt vmcnt(36)
    ds_write_b32 v10, v11 offset:6912
    s_waitcnt vmcnt(30)
    ds_write_b32 v10, v11 offset:6916
    s_waitcnt vmcnt(24)
    ds_write_b32 v10, v11 offset:6920
    s_waitcnt vmcnt(18)
    ds_write_b32 v10, v11 offset:6924
    s_mov_b64 exec, -1
    s_setprio 0
    s_mov_b32 s36, 3
    v_mov_b32 v11, 0
    v_and_b32 v1, 15, v0
    s_nop 1
    s_branch L_tail
L_ld_stepp:
    s_cmp_lg_u32 s37, 0
    s_cbranch_scc1 L_ld_finep
    s_mul_i32 s39, s38, 0x1800
    s_lshr_b32 s45, s38, 4
    s_mul_i32 s40, s45, 0x60000
    s_and_b32 s45, s38, 15
    s_mul_i32 s45, s45, 0x3000
    s_add_u32 s40, s40, s45
    s_add_u32 s38, s38, 0x400
    s_mov_b32 s24, s8
    s_mov_b32 s25, s9
    s_mov_b32 s26, 0x1800000
    s_mov_b32 s41, s39
    s_mov_b32 s42, 0x1800
    s_mov_b32 s43, 0xc00
    v_mov_b32 v7, v1
    v_mov_b32 v8, v2
    v_mov_b32 v9, v3
    s_branch L_ld_issuep
L_ld_finep:
    s_mov_b32 s24, s6
    s_mov_b32 s25, s7
    s_mov_b32 s26, 0x6000000
    s_sub_u32 s45, s37, 1
    s_lshr_b32 s46, s45, 1
    s_mul_i32 s46, s46, 0x30000
    s_and_b32 s45, s45, 1
    s_mul_i32 s45, s45, 0x180
    s_add_u32 s41, s40, s46
    s_add_u32 s41, s41, s45
    s_mov_b32 s42, 0x3000
    s_mov_b32 s43, 0x1800
    v_mov_b32 v7, v4
    v_mov_b32 v8, v5
    v_mov_b32 v9, v6
L_ld_issuep:
    s_mul_i32 s44, s57, 0x1800
    s_add_u32 s44, s44, 0x3400
    s_sub_i32 s48, s36, 5
    s_cmp_ge_i32 s50, s48
    s_cbranch_scc1 L_free7
    s_mov_b32 s56, 0
    s_call_b64 s[54:55], L_ld_wait
    s_mov_b32 s50, s45
L_free7:
    s_add_u32 m0, s44, 0
    s_mov_b32 s46, s41
    buffer_load_dwordx4 v7, s[24:27], s46 offen nt lds
    buffer_load_dwordx4 v8, s[24:27], s46 offen offset:1024 nt lds
    buffer_load_dwordx4 v9, s[24:27], s46 offen offset:2048 nt lds
    s_add_u32 m0, s44, 0xc00
    s_add_u32 s46, s41, s43
    buffer_load_dwordx4 v7, s[24:27], s46 offen nt lds
    buffer_load_dwordx4 v8, s[24:27], s46 offen offset:1024 nt lds
    buffer_load_dwordx4 v9, s[24:27], s46 offen offset:2048 nt lds
    s_add_u32 s41, s41, s42
    s_add_i32 s47, s36, -1
    s_max_i32 s47, s47, 0
    s_waitcnt vmcnt(36)
    v_mov_b32 v11, s47
    s_mov_b64 exec, 1
    ds_max_u32 v10, v11 offset:6920
    s_mov_b64 exec, -1
    s_cmp_ge_i32 s51, s48
    s_cbranch_scc1 L_free8
    s_mov_b32 s56, 1
    s_call_b64 s[54:55], L_ld_wait
    s_mov_b32 s51, s45
L_free8:
    s_add_u32 m0, s44, 0x9000
    s_mov_b32 s46, s41
    buffer_load_dwordx4 v7, s[24:27], s46 offen nt lds
    buffer_load_dwordx4 v8, s[24:27], s46 offen offset:1024 nt lds
    buffer_load_dwordx4 v9, s[24:27], s46 offen offset:2048 nt lds
    s_add_u32 m0, s44, 0x9c00
    s_add_u32 s46, s41, s43
    buffer_load_dwordx4 v7, s[24:27], s46 offen nt lds
    buffer_load_dwordx4 v8, s[24:27], s46 offen offset:1024 nt lds
    buffer_load_dwordx4 v9, s[24:27], s46 offen offset:2048 nt lds
    s_add_u32 s41, s41, s42
    s_add_i32 s47, s36, -1
    s_max_i32 s47, s47, 0
    s_waitcnt vmcnt(36)
    v_mov_b32 v11, s47
    s_mov_b64 exec, 1
    ds_max_u32 v10, v11 offset:6924
    s_mov_b64 exec, -1
    s_cmp_lg_u32 s36, 0
    s_cbranch_scc1 L_w39
    s_waitcnt vmcnt(12)
    v_mov_b32 v11, 3
    s_mov_b64 exec, 1
    ds_max_u32 v10, v11 offset:6956
    s_mov_b64 exec, -1
L_w39:
    s_cmp_ge_i32 s52, s48
    s_cbranch_scc1 L_free10
    s_mov_b32 s56, 2
    s_call_b64 s[54:55], L_ld_wait
    s_mov_b32 s52, s45
L_free10:
    s_add_u32 m0, s44, 0x12000
    s_mov_b32 s46, s41
    buffer_load_dwordx4 v7, s[24:27], s46 offen nt lds
    buffer_load_dwordx4 v8, s[24:27], s46 offen offset:1024 nt lds
    buffer_load_dwordx4 v9, s[24:27], s46 offen offset:2048 nt lds
    s_add_u32 m0, s44, 0x12c00
    s_add_u32 s46, s41, s43
    buffer_load_dwordx4 v7, s[24:27], s46 offen nt lds
    buffer_load_dwordx4 v8, s[24:27], s46 offen offset:1024 nt lds
    buffer_load_dwordx4 v9, s[24:27], s46 offen offset:2048 nt lds
    s_add_u32 s41, s41, s42
    s_add_i32 s47, s36, 0
    s_max_i32 s47, s47, 0
    s_waitcnt vmcnt(36)
    v_mov_b32 v11, s47
    s_mov_b64 exec, 1
    ds_max_u32 v10, v11 offset:6912
    s_mov_b64 exec, -1
    s_cmp_ge_i32 s53, s48
    s_cbranch_scc1 L_free11
    s_mov_b32 s56, 3
    s_call_b64 s[54:55], L_ld_wait
    s_mov_b32 s53, s45
L_free11:
    s_add_u32 m0, s44, 0x1b000
    s_mov_b32 s46, s41
    buffer_load_dwordx4 v7, s[24:27], s46 offen nt lds
    buffer_load_dwordx4 v8, s[24:27], s46 offen offset:1024 nt lds
    buffer_load_dwordx4 v9, s[24:27], s46 offen offset:2048 nt lds
    s_add_u32 m0, s44, 0x1bc00
    s_add_u32 s46, s41, s43
    buffer_load_dwordx4 v7, s[24:27], s46 offen nt lds
    buffer_load_dwordx4 v8, s[24:27], s46 offen offset:1024 nt lds
    buffer_load_dwordx4 v9, s[24:27], s46 offen offset:2048 nt lds
    s_add_u32 s41, s41, s42
    s_add_i32 s47, s36, 0
    s_max_i32 s47, s47, 0
    s_waitcnt vmcnt(36)
    v_mov_b32 v11, s47
    s_mov_b64 exec, 1
    ds_max_u32 v10, v11 offset:6916
    s_mov_b64 exec, -1
    s_add_u32 s37, s37, 1
    s_cmp_eq_u32 s37, 5
    s_cselect_b32 s37, 0, s37
    s_add_u32 s57, s57, 1
    s_cmp_eq_u32 s57, 6
    s_cselect_b32 s57, 0, s57
    s_cmp_lg_u32 s36, 1
    s_cbranch_scc1 L_ld_noiss
L_spin12:
    ds_read_b32 v11, v10 offset:6952
    s_waitcnt lgkmcnt(0)
    v_readfirstlane_b32 s45, v11
    s_nop 0
    s_cmp_ge_u32 s45, 4
    s_cbranch_scc1 L_spun13
    s_sleep 1
    s_branch L_spin12
L_spun13:
L_ld_noiss:
    s_add_u32 s36, s36, 1
    s_cmp_lt_u32 s36, 20
    s_nop 3
    s_cbranch_scc1 L_ld_stepp
    s_mov_b32 s32, s22
    s_mov_b32 s33, s23
    s_mov_b32 s34, 0x1000000
    s_mov_b32 s35, 0x20000
    v_lshlrev_b32 v12, 4, v0
    s_nop 1
L_spin14:
    ds_read_b32 v11, v10 offset:6976
    s_waitcnt lgkmcnt(0)
    v_readfirstlane_b32 s45, v11
    s_nop 0
    s_cmp_ge_u32 s45, 1
    s_cbranch_scc1 L_spun15
    s_sleep 1
    s_branch L_spin14
L_spun15:
    s_mov_b32 s46, 0x1d800
    buffer_load_dwordx4 v[112:115], v12, s[32:35], s46 offen sc1
    s_mov_b32 s46, 0x1dc00
    buffer_load_dwordx4 v[124:127], v12, s[32:35], s46 offen sc1
    s_mov_b32 s46, 0x1e000
    buffer_load_dwordx4 v[136:139], v12, s[32:35], s46 offen sc1
    s_mov_b32 s46, 0x1e400
    buffer_load_dwordx4 v[148:151], v12, s[32:35], s46 offen sc1
    s_mov_b32 s46, 0x1e800
    buffer_load_dwordx4 v[160:163], v12, s[32:35], s46 offen sc1
    s_mov_b32 s46, 0x1ec00
    buffer_load_dwordx4 v[172:175], v12, s[32:35], s46 offen sc1
    s_mov_b32 s46, 0x1f000
    buffer_load_dwordx4 v[116:119], v12, s[32:35], s46 offen sc1
    s_mov_b32 s46, 0x1f400
    buffer_load_dwordx4 v[128:131], v12, s[32:35], s46 offen sc1
    s_mov_b32 s46, 0x1f800
    buffer_load_dwordx4 v[140:143], v12, s[32:35], s46 offen sc1
    s_mov_b32 s46, 0x1fc00
    buffer_load_dwordx4 v[152:155], v12, s[32:35], s46 offen sc1
    s_mov_b32 s46, 0x20000
    buffer_load_dwordx4 v[164:167], v12, s[32:35], s46 offen sc1
    s_mov_b32 s46, 0x20400
    buffer_load_dwordx4 v[176:179], v12, s[32:35], s46 offen sc1
    s_mov_b32 s46, 0x20800
    buffer_load_dwordx4 v[120:123], v12, s[32:35], s46 offen sc1
    s_mov_b32 s46, 0x20c00
    buffer_load_dwordx4 v[132:135], v12, s[32:35], s46 offen sc1
    s_mov_b32 s46, 0x21000
    buffer_load_dwordx4 v[144:147], v12, s[32:35], s46 offen sc1
    s_mov_b32 s46, 0x21400
    buffer_load_dwordx4 v[156:159], v12, s[32:35], s46 offen sc1
    s_mov_b32 s46, 0x21800
    buffer_load_dwordx4 v[168:171], v12, s[32:35], s46 offen sc1
    s_mov_b32 s46, 0x21c00
    buffer_load_dwordx4 v[180:183], v12, s[32:35], s46 offen sc1
    v_mov_b32 v11, 20
    v_mov_b32 v16, 19
    s_mov_b64 exec, 1
    s_waitcnt vmcnt(48)
    ds_write_b32 v10, v16 offset:6920
    s_waitcnt vmcnt(42)
    ds_write_b32 v10, v16 offset:6924
    s_waitcnt vmcnt(36)
    ds_write_b32 v10, v11 offset:6912
    s_waitcnt vmcnt(30)
    ds_write_b32 v10, v11 offset:6916
    s_waitcnt vmcnt(24)
    ds_write_b32 v10, v11 offset:6920
    s_waitcnt vmcnt(18)
    ds_write_b32 v10, v11 offset:6924
    s_mov_b64 exec, -1
    s_setprio 0
    s_mov_b32 s36, 3
    v_mov_b32 v11, 0
    v_and_b32 v1, 15, v0
    s_nop 1
    s_branch L_tail
L_ld_wait:
    s_lshl_b32 s45, s56, 2
    v_mov_b32 v12, s45
    ds_read_b32 v11, v12 offset:6928
    s_waitcnt lgkmcnt(0)
    v_readfirstlane_b32 s45, v11
    s_nop 0
    s_cmp_ge_i32 s45, s48
    s_cbranch_scc1 L_ld_wait_ret
    s_nop 1
L_spin16:
    ds_read_b32 v11, v12 offset:6928
    s_waitcnt lgkmcnt(0)
    v_readfirstlane_b32 s45, v11
    s_nop 0
    s_cmp_ge_u32 s45, s48
    s_cbranch_scc1 L_spun17
    s_sleep 1
    s_branch L_spin16
L_spun17:
L_ld_wait_ret:
    s_setpc_b64 s[54:55]
L_compute:
    s_mul_i32 s36, s3, 0x9000
    s_add_u32 s36, s36, 0x3400
    s_setprio 1
    s_barrier
    v_and_b32 v228, 15, v0
    v_lshrrev_b32 v229, 4, v0
    v_and_b32 v230, 6, v228
    v_xor_b32 v230, v230, v229
    v_mul_u32_u24 v231, 0x180, v228
    v_add_u32 v231, s36, v231
    v_lshl_add_u32 v8, v230, 4, v231
    v_xor_b32 v230, 4, v230
    v_lshl_add_u32 v9, v230, 4, v231
    v_lshrrev_b32 v230, 2, v228
    v_and_b32 v231, 3, v228
    v_lshl_add_u32 v232, v229, 2, v230
    v_mul_u32_u24 v233, 0x180, v232
    v_lshl_add_u32 v233, v231, 3, v233
    v_add_u32 v233, s36, v233
    v_and_b32 v234, 6, v232
    v_xor_b32 v235, 0, v234
    v_lshl_add_u32 v10, v235, 4, v233
    v_xor_b32 v235, 2, v234
    v_lshl_add_u32 v11, v235, 4, v233
    v_xor_b32 v235, 4, v234
    v_lshl_add_u32 v12, v235, 4, v233
    v_xor_b32 v235, 6, v234
    v_lshl_add_u32 v13, v235, 4, v233
    v_subrev_u32 v244, s36, v8
    v_subrev_u32 v245, s36, v9
    v_mov_b32 v24, 0x3f803f80
    v_mov_b32 v240, 0
    v_mov_b32 v248, 0
    v_mov_b32 v25, 0x3f803f80
    v_mov_b32 v241, 0
    v_mov_b32 v249, 0
    v_mov_b32 v26, 0x3f803f80
    v_mov_b32 v242, 0
    v_mov_b32 v250, 0
    v_mov_b32 v27, 0x3f803f80
    v_mov_b32 v243, 0
    v_mov_b32 v251, 0
    v_mov_b32 v20, 1.0
    s_mov_b32 s44, 0x3baaaaab
    s_mov_b32 s46, 0x3727c5ac
    s_mov_b32 s58, 0xaaaaaaaa
    s_mov_b32 s60, 0xcccccccc
    s_mov_b32 s45, 0x3baaaaab
    s_mov_b32 s47, 0x3727c5ac
    s_mov_b32 s59, 0xaaaaaaaa
    s_mov_b32 s61, 0xcccccccc
    s_mov_b32 s38, 0xf0000f
    s_mov_b32 s39, 0xf0000f00
    s_mov_b32 s50, 0x42000000
    s_mov_b32 s41, 0
    s_mov_b32 s51, 0
    s_mov_b32 s52, 0
    s_mov_b32 s54, 0
    s_mov_b32 s56, 0x1800
    s_lshl_b32 s40, s3, 2
    v_mov_b32 v1, s40
    s_waitcnt lgkmcnt(0)
    s_mov_b32 s32, s22
    s_mov_b32 s33, s23
    s_mov_b32 s34, 0x1000000
    s_mov_b32 s35, 0x20000
    s_cmp_lt_u32 s2, 3
    s_cbranch_scc1 L_qkprod
    s_cmp_lt_u32 s2, 6
    s_cbranch_scc1 L_wvprod
L_c_start:
    s_add_u32 s51, s51, 1
    s_cmp_ge_u32 s52, s51
    s_cbranch_scc1 L_have18
L_spin19:
    ds_read_b32 v3, v1 offset:6912
    s_waitcnt lgkmcnt(0)
    v_readfirstlane_b32 s52, v3
    s_nop 0
    s_cmp_ge_u32 s52, s51
    s_cbranch_scc1 L_spun20
    s_sleep 1
    s_branch L_spin19
L_spun20:
L_have18:
    ds_read_b128 v[100:103], v8
    ds_read_b128 v[104:107], v9
    ds_read_b128 v[108:111], v8 offset:128
    ds_read_b128 v[112:115], v9 offset:128
    ds_read_b128 v[116:119], v8 offset:256
    ds_read_b128 v[120:123], v9 offset:256
    ds_read_b64_tr_b16 v[152:153], v10
    ds_read_b64_tr_b16 v[158:159], v11
    ds_read_b64_tr_b16 v[164:165], v12
    ds_read_b64_tr_b16 v[170:171], v13
    ds_read_b64_tr_b16 v[176:177], v10 offset:128
    ds_read_b64_tr_b16 v[182:183], v11 offset:128
    s_waitcnt lgkmcnt(11)
    v_mfma_f32_16x16x32_bf16 v[224:227], v[100:103], v[24:27], 0
    ds_read_b64_tr_b16 v[188:189], v12 offset:128
    s_waitcnt lgkmcnt(11)
    v_mfma_f32_16x16x32_bf16 v[224:227], v[104:107], v[24:27], v[224:227]
    ds_read_b64_tr_b16 v[194:195], v13 offset:128
    s_waitcnt lgkmcnt(11)
    v_mfma_f32_16x16x32_bf16 v[224:227], v[108:111], v[24:27], v[224:227]
    ds_read_b64_tr_b16 v[200:201], v10 offset:256
    s_waitcnt lgkmcnt(11)
    v_mfma_f32_16x16x32_bf16 v[224:227], v[112:115], v[24:27], v[224:227]
    ds_read_b64_tr_b16 v[206:207], v11 offset:256
    s_waitcnt lgkmcnt(11)
    v_mfma_f32_16x16x32_bf16 v[224:227], v[116:119], v[24:27], v[224:227]
    ds_read_b64_tr_b16 v[212:213], v12 offset:256
    s_waitcnt lgkmcnt(11)
    v_mfma_f32_16x16x32_bf16 v[224:227], v[120:123], v[24:27], v[224:227]
    ds_read_b64_tr_b16 v[218:219], v13 offset:256
    ds_read_b32 v3, v1 offset:6912
    s_add_u32 s54, s54, 1
    s_cmp_eq_u32 s54, 6
    s_cselect_b32 s55, 0xffff8800, s56
    s_cselect_b32 s54, 0, s54
    v_add_u32 v8, s55, v8
    v_add_u32 v9, s55, v9
    v_mov_b32 v2, s51
    v_add_u32 v10, s55, v10
    v_add_u32 v11, s55, v11
    v_add_u32 v12, s55, v12
    v_add_u32 v13, s55, v13
    s_waitcnt lgkmcnt(0)
    ds_write_b32 v1, v2 offset:6928
    v_dot2_f32_bf16 v22, v100, v100, 0
    v_dot2_f32_bf16 v23, v101, v101, 0
    v_dot2_f32_bf16 v22, v102, v102, v22
    v_dot2_f32_bf16 v23, v103, v103, v23
    v_dot2_f32_bf16 v22, v104, v104, v22
    v_dot2_f32_bf16 v23, v105, v105, v23
    v_dot2_f32_bf16 v22, v106, v106, v22
    v_dot2_f32_bf16 v23, v107, v107, v23
    v_dot2_f32_bf16 v22, v108, v108, v22
    v_dot2_f32_bf16 v23, v109, v109, v23
    v_dot2_f32_bf16 v22, v110, v110, v22
    v_dot2_f32_bf16 v23, v111, v111, v23
    v_dot2_f32_bf16 v22, v112, v112, v22
    v_dot2_f32_bf16 v23, v113, v113, v23
    v_dot2_f32_bf16 v22, v114, v114, v22
    v_dot2_f32_bf16 v23, v115, v115, v23
    v_dot2_f32_bf16 v22, v116, v116, v22
    v_dot2_f32_bf16 v23, v117, v117, v23
    v_dot2_f32_bf16 v22, v118, v118, v22
    v_dot2_f32_bf16 v23, v119, v119, v23
    v_dot2_f32_bf16 v22, v120, v120, v22
    v_dot2_f32_bf16 v23, v121, v121, v23
    v_dot2_f32_bf16 v22, v122, v122, v22
    v_dot2_f32_bf16 v23, v123, v123, v23
    s_nop 2
    v_add_f32 v255, v22, v23
    s_add_u32 s51, s51, 1
    s_cmp_ge_u32 s52, s51
    s_cbranch_scc1 L_have21
L_spin22:
    ds_read_b32 v3, v1 offset:6912
    s_waitcnt lgkmcnt(0)
    v_readfirstlane_b32 s52, v3
    s_nop 0
    s_cmp_ge_u32 s52, s51
    s_cbranch_scc1 L_spun23
    s_sleep 1
    s_branch L_spin22
L_spun23:
L_have21:
    ds_read_b128 v[124:127], v8
    ds_read_b128 v[128:131], v9
    ds_read_b128 v[132:135], v8 offset:128
    ds_read_b128 v[136:139], v9 offset:128
    ds_read_b128 v[140:143], v8 offset:256
    ds_read_b128 v[144:147], v9 offset:256
    s_waitcnt lgkmcnt(5)
    v_mfma_f32_16x16x32_bf16 v[232:235], v[124:127], v[24:27], v[224:227]
    ds_read_b64_tr_b16 v[148:149], v10
    ds_read_b64_tr_b16 v[154:155], v11
    s_waitcnt lgkmcnt(6)
    v_mfma_f32_16x16x32_bf16 v[232:235], v[128:131], v[24:27], v[232:235]
    ds_read_b64_tr_b16 v[160:161], v12
    ds_read_b64_tr_b16 v[166:167], v13
    ds_read_b64_tr_b16 v[172:173], v10 offset:128
    s_waitcnt lgkmcnt(8)
    v_mfma_f32_16x16x32_bf16 v[232:235], v[132:135], v[24:27], v[232:235]
    ds_read_b64_tr_b16 v[178:179], v11 offset:128
    ds_read_b64_tr_b16 v[184:185], v12 offset:128
    ds_read_b64_tr_b16 v[190:191], v13 offset:128
    s_waitcnt lgkmcnt(10)
    v_mfma_f32_16x16x32_bf16 v[232:235], v[136:139], v[24:27], v[232:235]
    ds_read_b64_tr_b16 v[196:197], v10 offset:256
    ds_read_b64_tr_b16 v[202:203], v11 offset:256
    s_waitcnt lgkmcnt(11)
    v_mfma_f32_16x16x32_bf16 v[232:235], v[140:143], v[24:27], v[232:235]
    ds_read_b64_tr_b16 v[208:209], v12 offset:256
    ds_read_b64_tr_b16 v[214:215], v13 offset:256
    s_waitcnt lgkmcnt(12)
    v_mfma_f32_16x16x32_bf16 v[232:235], v[144:147], v[24:27], v[232:235]
    ds_read_b32 v3, v1 offset:6912
    s_add_u32 s54, s54, 1
    s_cmp_eq_u32 s54, 6
    s_cselect_b32 s55, 0xffff8800, s56
    s_cselect_b32 s54, 0, s54
    v_add_u32 v8, s55, v8
    v_add_u32 v9, s55, v9
    v_mov_b32 v2, s51
    v_add_u32 v10, s55, v10
    v_add_u32 v11, s55, v11
    v_add_u32 v12, s55, v12
    v_add_u32 v13, s55, v13
    s_waitcnt lgkmcnt(0)
    ds_write_b32 v1, v2 offset:6928
    v_dot2_f32_bf16 v22, v124, v124, v255
    v_dot2_f32_bf16 v23, v124, v100, 0
    v_dot2_f32_bf16 v22, v125, v125, v22
    v_dot2_f32_bf16 v23, v125, v101, v23
    v_dot2_f32_bf16 v22, v126, v126, v22
    v_dot2_f32_bf16 v23, v126, v102, v23
    v_dot2_f32_bf16 v22, v127, v127, v22
    v_dot2_f32_bf16 v23, v127, v103, v23
    v_dot2_f32_bf16 v22, v128, v128, v22
    v_dot2_f32_bf16 v23, v128, v104, v23
    v_dot2_f32_bf16 v22, v129, v129, v22
    v_dot2_f32_bf16 v23, v129, v105, v23
    v_dot2_f32_bf16 v22, v130, v130, v22
    v_dot2_f32_bf16 v23, v130, v106, v23
    v_dot2_f32_bf16 v22, v131, v131, v22
    v_dot2_f32_bf16 v23, v131, v107, v23
    v_dot2_f32_bf16 v22, v132, v132, v22
    v_dot2_f32_bf16 v23, v132, v108, v23
    v_dot2_f32_bf16 v22, v133, v133, v22
    v_dot2_f32_bf16 v23, v133, v109, v23
    v_dot2_f32_bf16 v22, v134, v134, v22
    v_dot2_f32_bf16 v23, v134, v110, v23
    v_dot2_f32_bf16 v22, v135, v135, v22
    v_dot2_f32_bf16 v23, v135, v111, v23
    v_dot2_f32_bf16 v22, v136, v136, v22
    v_dot2_f32_bf16 v23, v136, v112, v23
    v_dot2_f32_bf16 v22, v137, v137, v22
    v_dot2_f32_bf16 v23, v137, v113, v23
    v_dot2_f32_bf16 v22, v138, v138, v22
    v_dot2_f32_bf16 v23, v138, v114, v23
    v_dot2_f32_bf16 v22, v139, v139, v22
    v_dot2_f32_bf16 v23, v139, v115, v23
    v_dot2_f32_bf16 v22, v140, v140, v22
    v_dot2_f32_bf16 v23, v140, v116, v23
    v_dot2_f32_bf16 v22, v141, v141, v22
    v_dot2_f32_bf16 v23, v141, v117, v23
    v_dot2_f32_bf16 v22, v142, v142, v22
    v_dot2_f32_bf16 v23, v142, v118, v23
    v_dot2_f32_bf16 v22, v143, v143, v22
    v_dot2_f32_bf16 v23, v143, v119, v23
    v_dot2_f32_bf16 v22, v144, v144, v22
    v_dot2_f32_bf16 v23, v144, v120, v23
    v_dot2_f32_bf16 v22, v145, v145, v22
    v_dot2_f32_bf16 v23, v145, v121, v23
    v_dot2_f32_bf16 v22, v146, v146, v22
    v_dot2_f32_bf16 v23, v146, v122, v23
    v_dot2_f32_bf16 v22, v147, v147, v22
    v_dot2_f32_bf16 v23, v147, v123, v23
    s_nop 2
    v_fma_f32 v22, v23, 2.0, v22
    s_nop 1
    v_mfma_f32_16x16x4_f32 v[236:239], v22, v20, 0
    s_sub_u32 s40, s2, 3
    s_cmp_ge_u32 s40, 3
    s_cbranch_scc1 L_nowf
    s_mov_b32 s24, s20
    s_mov_b32 s25, s21
    s_mov_b32 s26, 0x100
    s_mov_b32 s27, 0x20000
    s_lshl_b32 s40, s40, 4
    v_mov_b32 v22, 1
    s_waitcnt vmcnt(0)
    s_mov_b64 exec, 1
    buffer_store_dword v22, v1, s[24:27], s40 offen offset:128 sc1
    s_mov_b64 exec, -1
L_nowf:
    s_add_u32 s51, s51, 1
    s_cmp_ge_u32 s52, s51
    s_cbranch_scc1 L_have24
    s_nop 3
L_spin25:
    ds_read_b32 v3, v1 offset:6912
    s_waitcnt lgkmcnt(0)
    v_readfirstlane_b32 s52, v3
    s_nop 0
    s_cmp_ge_u32 s52, s51
    s_cbranch_scc1 L_spun26
    s_sleep 1
    s_branch L_spin25
L_spun26:
L_have24:
    ds_read_b128 v[52:55], v8
    ds_read_b128 v[56:59], v9
    ds_read_b128 v[60:63], v8 offset:128
    ds_read_b128 v[64:67], v9 offset:128
    ds_read_b128 v[68:71], v8 offset:256
    ds_read_b128 v[72:75], v9 offset:256
    s_waitcnt lgkmcnt(5)
    v_mfma_f32_16x16x32_bf16 v[76:79], v[52:55], v[24:27], v[224:227]
    ds_read_b64_tr_b16 v[150:151], v10
    ds_read_b64_tr_b16 v[156:157], v11
    s_waitcnt lgkmcnt(6)
    v_mfma_f32_16x16x32_bf16 v[76:79], v[56:59], v[24:27], v[76:79]
    ds_read_b64_tr_b16 v[162:163], v12
    ds_read_b64_tr_b16 v[168:169], v13
    ds_read_b64_tr_b16 v[174:175], v10 offset:128
    s_waitcnt lgkmcnt(8)
    v_mfma_f32_16x16x32_bf16 v[76:79], v[60:63], v[24:27], v[76:79]
    ds_read_b64_tr_b16 v[180:181], v11 offset:128
    ds_read_b64_tr_b16 v[186:187], v12 offset:128
    ds_read_b64_tr_b16 v[192:193], v13 offset:128
    s_waitcnt lgkmcnt(10)
    v_mfma_f32_16x16x32_bf16 v[76:79], v[64:67], v[24:27], v[76:79]
    ds_read_b64_tr_b16 v[198:199], v10 offset:256
    ds_read_b64_tr_b16 v[204:205], v11 offset:256
    s_waitcnt lgkmcnt(11)
    v_mfma_f32_16x16x32_bf16 v[76:79], v[68:71], v[24:27], v[76:79]
    ds_read_b64_tr_b16 v[210:211], v12 offset:256
    ds_read_b64_tr_b16 v[216:217], v13 offset:256
    s_waitcnt lgkmcnt(12)
    v_mfma_f32_16x16x32_bf16 v[76:79], v[72:75], v[24:27], v[76:79]
    ds_read_b32 v3, v1 offset:6912
    s_add_u32 s54, s54, 1
    s_cmp_eq_u32 s54, 6
    s_cselect_b32 s55, 0xffff8800, s56
    s_cselect_b32 s54, 0, s54
    v_add_u32 v8, s55, v8
    v_add_u32 v9, s55, v9
    v_mov_b32 v2, s51
    v_add_u32 v10, s55, v10
    v_add_u32 v11, s55, v11
    v_add_u32 v12, s55, v12
    v_add_u32 v13, s55, v13
    s_waitcnt lgkmcnt(0)
    ds_write_b32 v1, v2 offset:6928
    v_dot2_f32_bf16 v22, v52, v52, v255
    v_dot2_f32_bf16 v23, v52, v100, 0
    v_dot2_f32_bf16 v22, v53, v53, v22
    v_dot2_f32_bf16 v23, v53, v101, v23
    v_dot2_f32_bf16 v22, v54, v54, v22
    v_dot2_f32_bf16 v23, v54, v102, v23
    v_dot2_f32_bf16 v22, v55, v55, v22
    v_dot2_f32_bf16 v23, v55, v103, v23
    v_dot2_f32_bf16 v22, v56, v56, v22
    v_dot2_f32_bf16 v23, v56, v104, v23
    v_dot2_f32_bf16 v22, v57, v57, v22
    v_dot2_f32_bf16 v23, v57, v105, v23
    v_dot2_f32_bf16 v22, v58, v58, v22
    v_dot2_f32_bf16 v23, v58, v106, v23
    v_dot2_f32_bf16 v22, v59, v59, v22
    v_dot2_f32_bf16 v23, v59, v107, v23
    v_dot2_f32_bf16 v22, v60, v60, v22
    v_dot2_f32_bf16 v23, v60, v108, v23
    v_dot2_f32_bf16 v22, v61, v61, v22
    v_dot2_f32_bf16 v23, v61, v109, v23
    v_dot2_f32_bf16 v22, v62, v62, v22
    v_dot2_f32_bf16 v23, v62, v110, v23
    v_dot2_f32_bf16 v22, v63, v63, v22
    v_dot2_f32_bf16 v23, v63, v111, v23
    v_dot2_f32_bf16 v22, v64, v64, v22
    v_dot2_f32_bf16 v23, v64, v112, v23
    v_dot2_f32_bf16 v22, v65, v65, v22
    v_dot2_f32_bf16 v23, v65, v113, v23
    v_dot2_f32_bf16 v22, v66, v66, v22
    v_dot2_f32_bf16 v23, v66, v114, v23
    v_dot2_f32_bf16 v22, v67, v67, v22
    v_dot2_f32_bf16 v23, v67, v115, v23
    v_dot2_f32_bf16 v22, v68, v68, v22
    v_dot2_f32_bf16 v23, v68, v116, v23
    v_dot2_f32_bf16 v22, v69, v69, v22
    v_dot2_f32_bf16 v23, v69, v117, v23
    v_dot2_f32_bf16 v22, v70, v70, v22
    v_dot2_f32_bf16 v23, v70, v118, v23
    v_dot2_f32_bf16 v22, v71, v71, v22
    v_dot2_f32_bf16 v23, v71, v119, v23
    v_dot2_f32_bf16 v22, v72, v72, v22
    v_dot2_f32_bf16 v23, v72, v120, v23
    v_dot2_f32_bf16 v22, v73, v73, v22
    v_dot2_f32_bf16 v23, v73, v121, v23
    v_dot2_f32_bf16 v22, v74, v74, v22
    v_dot2_f32_bf16 v23, v74, v122, v23
    v_dot2_f32_bf16 v22, v75, v75, v22
    v_dot2_f32_bf16 v23, v75, v123, v23
    s_nop 2
    v_fma_f32 v22, v23, 2.0, v22
    s_nop 1
    v_mfma_f32_16x16x4_f32 v[80:83], v22, v20, 0
    v_pk_mul_f32 v[232:233], v[232:233], s[44:45]
    v_pk_mul_f32 v[234:235], v[234:235], s[44:45]
    v_pk_fma_f32 v[4:5], v[232:233], v[232:233], s[46:47] neg_lo:[1,0,0] neg_hi:[1,0,0]
    v_pk_fma_f32 v[6:7], v[234:235], v[234:235], s[46:47] neg_lo:[1,0,0] neg_hi:[1,0,0]
    v_pk_fma_f32 v[236:237], v[236:237], s[44:45], v[4:5]
    v_pk_fma_f32 v[238:239], v[238:239], s[44:45], v[6:7]
    v_max_f32 v236, s46, v236
    v_max_f32 v237, s46, v237
    v_max_f32 v238, s46, v238
    v_max_f32 v239, s46, v239
    v_rsq_f32 v236, v236
    v_rsq_f32 v237, v237
    v_rsq_f32 v238, v238
    v_rsq_f32 v239, v239
    v_pk_mul_f32 v[76:77], v[76:77], s[44:45]
    v_pk_mul_f32 v[78:79], v[78:79], s[44:45]
    v_pk_fma_f32 v[4:5], v[76:77], v[76:77], s[46:47] neg_lo:[1,0,0] neg_hi:[1,0,0]
    v_pk_fma_f32 v[6:7], v[78:79], v[78:79], s[46:47] neg_lo:[1,0,0] neg_hi:[1,0,0]
    v_pk_fma_f32 v[80:81], v[80:81], s[44:45], v[4:5]
    v_pk_fma_f32 v[82:83], v[82:83], s[44:45], v[6:7]
    v_max_f32 v80, s46, v80
    v_max_f32 v81, s46, v81
    v_max_f32 v82, s46, v82
    v_max_f32 v83, s46, v83
    v_rsq_f32 v80, v80
    v_rsq_f32 v81, v81
    v_rsq_f32 v82, v82
    v_rsq_f32 v83, v83
    s_add_u32 s51, s51, 1
    s_cmp_ge_u32 s52, s51
    s_cbranch_scc1 L_have27
L_spin28:
    ds_read_b32 v3, v1 offset:6912
    s_waitcnt lgkmcnt(0)
    v_readfirstlane_b32 s52, v3
    s_nop 0
    s_cmp_ge_u32 s52, s51
    s_cbranch_scc1 L_spun29
    s_sleep 1
    s_branch L_spin28
L_spun29:
L_have27:
    v_mov_b32 v21, 0
    s_nop 4
L_spin30:
    ds_read_b32 v3, v21 offset:6944
    s_waitcnt lgkmcnt(0)
    v_readfirstlane_b32 s40, v3
    s_nop 0
    s_cmp_ge_u32 s40, 1
    s_cbranch_scc1 L_spun31
    s_sleep 1
    s_branch L_spin30
L_spun31:
    ds_read_b128 v[28:31], v244
    ds_read_b128 v[32:35], v245
    ds_read_b128 v[36:39], v244 offset:128
    ds_read_b128 v[40:43], v245 offset:128
    ds_read_b128 v[44:47], v244 offset:256
    ds_read_b128 v[48:51], v245 offset:256
    s_waitcnt lgkmcnt(5)
    v_mfma_f32_16x16x32_bf16 v[220:223], v[100:103], v[28:31], 0
    v_mfma_f32_16x16x32_bf16 v[88:91], v[24:27], v[28:31], 0
    s_waitcnt lgkmcnt(4)
    v_mfma_f32_16x16x32_bf16 v[220:223], v[104:107], v[32:35], v[220:223]
    v_mfma_f32_16x16x32_bf16 v[88:91], v[24:27], v[32:35], v[88:91]
    s_waitcnt lgkmcnt(3)
    v_mfma_f32_16x16x32_bf16 v[220:223], v[108:111], v[36:39], v[220:223]
    v_mfma_f32_16x16x32_bf16 v[88:91], v[24:27], v[36:39], v[88:91]
    s_waitcnt lgkmcnt(2)
    v_mfma_f32_16x16x32_bf16 v[220:223], v[112:115], v[40:43], v[220:223]
    v_mfma_f32_16x16x32_bf16 v[88:91], v[24:27], v[40:43], v[88:91]
    s_waitcnt lgkmcnt(1)
    v_mfma_f32_16x16x32_bf16 v[220:223], v[116:119], v[44:47], v[220:223]
    v_mfma_f32_16x16x32_bf16 v[88:91], v[24:27], v[44:47], v[88:91]
    s_waitcnt lgkmcnt(0)
    v_mfma_f32_16x16x32_bf16 v[220:223], v[120:123], v[48:51], v[220:223]
    v_mfma_f32_16x16x32_bf16 v[88:91], v[24:27], v[48:51], v[88:91]
    v_mfma_f32_16x16x32_bf16 v[228:231], v[124:127], v[28:31], v[220:223]
    v_mfma_f32_16x16x32_bf16 v[84:87], v[52:55], v[28:31], v[220:223]
    v_mfma_f32_16x16x32_bf16 v[228:231], v[128:131], v[32:35], v[228:231]
    v_mfma_f32_16x16x32_bf16 v[84:87], v[56:59], v[32:35], v[84:87]
    v_mfma_f32_16x16x32_bf16 v[228:231], v[132:135], v[36:39], v[228:231]
    v_mfma_f32_16x16x32_bf16 v[84:87], v[60:63], v[36:39], v[84:87]
    v_mfma_f32_16x16x32_bf16 v[228:231], v[136:139], v[40:43], v[228:231]
    v_mfma_f32_16x16x32_bf16 v[84:87], v[64:67], v[40:43], v[84:87]
    v_mfma_f32_16x16x32_bf16 v[228:231], v[140:143], v[44:47], v[228:231]
    v_mfma_f32_16x16x32_bf16 v[84:87], v[68:71], v[44:47], v[84:87]
    v_mfma_f32_16x16x32_bf16 v[228:231], v[144:147], v[48:51], v[228:231]
    v_mfma_f32_16x16x32_bf16 v[84:87], v[72:75], v[48:51], v[84:87]
    ds_read_b128 v[124:127], v8
    ds_read_b128 v[128:131], v9
    ds_read_b128 v[132:135], v8 offset:128
    ds_read_b128 v[136:139], v9 offset:128
    ds_read_b128 v[140:143], v8 offset:256
    ds_read_b128 v[144:147], v9 offset:256
    v_mov_b32 v16, v88
    v_mov_b32 v17, v88
    v_pk_fma_f32 v[228:229], v[232:233], v[16:17], v[228:229] neg_lo:[1,0,0] neg_hi:[1,0,0]
    v_pk_mul_f32 v[228:229], v[228:229], v[236:237]
    v_pk_fma_f32 v[230:231], v[234:235], v[16:17], v[230:231] neg_lo:[1,0,0] neg_hi:[1,0,0]
    v_pk_mul_f32 v[230:231], v[230:231], v[238:239]
    v_pk_fma_f32 v[84:85], v[76:77], v[16:17], v[84:85] neg_lo:[1,0,0] neg_hi:[1,0,0]
    v_pk_mul_f32 v[84:85], v[84:85], v[80:81]
    v_pk_fma_f32 v[86:87], v[78:79], v[16:17], v[86:87] neg_lo:[1,0,0] neg_hi:[1,0,0]
    v_pk_mul_f32 v[86:87], v[86:87], v[82:83]
    v_max3_f32 v254, v228, v229, v230
    v_max3_f32 v21, v231, v84, v85
    v_max3_f32 v254, v254, v86, v87
    v_max_f32 v254, v254, v21
    v_mov_b32 v22, v254
    v_mov_b32 v23, v254
    s_nop 1
    v_permlane32_swap_b32 v22, v23
    v_max_f32 v254, v22, v23
    v_mov_b32 v22, v254
    v_mov_b32 v23, v254
    s_nop 1
    v_permlane16_swap_b32 v22, v23
    v_max_f32 v254, v22, v23
    v_cmp_le_f32_e64 vcc, |v254|, s50
    s_nop 1
    v_cndmask_b32_e64 v254, v254, 0, vcc
    v_sub_f32 v18, 0, v254
    v_sub_f32 v19, 0, v254
    v_pk_add_f32 v[228:229], v[228:229], v[18:19]
    v_pk_add_f32 v[230:231], v[230:231], v[18:19]
    v_exp_f32 v228, v228
    v_exp_f32 v229, v229
    v_exp_f32 v230, v230
    v_exp_f32 v231, v231
    v_pk_add_f32 v[84:85], v[84:85], v[18:19]
    v_pk_add_f32 v[86:87], v[86:87], v[18:19]
    v_exp_f32 v84, v84
    v_exp_f32 v85, v85
    v_exp_f32 v86, v86
    v_exp_f32 v87, v87
    v_pk_add_f32 v[14:15], v[228:229], v[230:231]
    v_pk_add_f32 v[14:15], v[14:15], v[84:85]
    v_pk_add_f32 v[14:15], v[14:15], v[86:87]
    v_pk_mul_f32 v[228:229], v[228:229], v[236:237]
    v_pk_mul_f32 v[230:231], v[230:231], v[238:239]
    v_pk_mul_f32 v[84:85], v[84:85], v[80:81]
    v_pk_mul_f32 v[86:87], v[86:87], v[82:83]
    v_cvt_pk_bf16_f32 v244, v228, v229
    v_cvt_pk_bf16_f32 v245, v230, v231
    v_cvt_pk_bf16_f32 v246, v84, v85
    v_cvt_pk_bf16_f32 v247, v86, v87
    v_pk_add_f32 v[240:241], v[228:229], v[84:85]
    v_pk_add_f32 v[242:243], v[230:231], v[86:87]
    v_pk_mul_f32 v[252:253], v[228:229], v[232:233]
    v_pk_fma_f32 v[252:253], v[230:231], v[234:235], v[252:253]
    v_pk_fma_f32 v[252:253], v[84:85], v[76:77], v[252:253]
    v_pk_fma_f32 v[252:253], v[86:87], v[78:79], v[252:253]
    v_mov_b32 v21, 0
    v_mfma_f32_16x16x32_bf16 v[52:55], v[148:151], v[244:247], 0
    ds_read_b64_tr_b16 v[148:149], v10
    ds_read_b64 v[150:151], v21 offset:7056
    v_mfma_f32_16x16x32_bf16 v[56:59], v[154:157], v[244:247], 0
    ds_read_b64_tr_b16 v[154:155], v11
    ds_read_b64 v[156:157], v21 offset:7056
    v_mfma_f32_16x16x32_bf16 v[60:63], v[160:163], v[244:247], 0
    ds_read_b64_tr_b16 v[160:161], v12
    ds_read_b64 v[162:163], v21 offset:7056
    v_mfma_f32_16x16x32_bf16 v[64:67], v[166:169], v[244:247], 0
    ds_read_b64_tr_b16 v[166:167], v13
    ds_read_b64 v[168:169], v21 offset:7056
    v_mfma_f32_16x16x32_bf16 v[68:71], v[172:175], v[244:247], 0
    ds_read_b64_tr_b16 v[172:173], v10 offset:128
    ds_read_b64 v[174:175], v21 offset:7056
    v_mfma_f32_16x16x32_bf16 v[72:75], v[178:181], v[244:247], 0
    ds_read_b64_tr_b16 v[178:179], v11 offset:128
    ds_read_b64 v[180:181], v21 offset:7056
    v_mfma_f32_16x16x32_bf16 v[76:79], v[184:187], v[244:247], 0
    ds_read_b64_tr_b16 v[184:185], v12 offset:128
    ds_read_b64 v[186:187], v21 offset:7056
    v_mfma_f32_16x16x32_bf16 v[80:83], v[190:193], v[244:247], 0
    ds_read_b64_tr_b16 v[190:191], v13 offset:128
    ds_read_b64 v[192:193], v21 offset:7056
    v_mfma_f32_16x16x32_bf16 v[84:87], v[196:199], v[244:247], 0
    ds_read_b64_tr_b16 v[196:197], v10 offset:256
    ds_read_b64 v[198:199], v21 offset:7056
    v_mfma_f32_16x16x32_bf16 v[88:91], v[202:205], v[244:247], 0
    ds_read_b64_tr_b16 v[202:203], v11 offset:256
    ds_read_b64 v[204:205], v21 offset:7056
    v_mfma_f32_16x16x32_bf16 v[92:95], v[208:211], v[244:247], 0
    ds_read_b64_tr_b16 v[208:209], v12 offset:256
    ds_read_b64 v[210:211], v21 offset:7056
    v_mfma_f32_16x16x32_bf16 v[96:99], v[214:217], v[244:247], 0
    ds_read_b64_tr_b16 v[214:215], v13 offset:256
    ds_read_b64 v[216:217], v21 offset:7056
    s_nop 5
    s_branch L_tile2b
L_rescale:
    s_nop 15
    v_mul_f32 v4, v228, v236
    v_mul_f32 v5, v229, v237
    v_mul_f32 v6, v230, v238
    v_mul_f32 v7, v231, v239
    v_max3_f32 v21, v4, v5, v6
    v_max3_f32 v21, v21, v7, v254
    v_mov_b32 v22, v21
    v_mov_b32 v23, v21
    s_nop 1
    v_permlane32_swap_b32 v22, v23
    v_max_f32 v21, v22, v23
    v_mov_b32 v22, v21
    v_mov_b32 v23, v21
    s_nop 1
    v_permlane16_swap_b32 v22, v23
    v_max_f32 v21, v22, v23
    v_sub_f32 v22, v254, v21
    v_exp_f32 v22, v22
    v_mov_b32 v254, v21
    v_sub_f32 v18, 0, v21
    v_sub_f32 v19, 0, v21
    v_mov_b32 v23, v22
    v_sub_f32 v4, v4, v21
    v_sub_f32 v5, v5, v21
    v_sub_f32 v6, v6, v21
    v_sub_f32 v7, v7, v21
    v_exp_f32 v4, v4
    v_exp_f32 v5, v5
    v_exp_f32 v6, v6
    v_exp_f32 v7, v7
    v_pk_mul_f32 v[14:15], v[14:15], v[22:23]
    v_pk_mul_f32 v[252:253], v[252:253], v[22:23]
    v_pk_mul_f32 v[240:241], v[240:241], v[22:23]
    v_pk_mul_f32 v[242:243], v[242:243], v[22:23]
    v_pk_mul_f32 v[248:249], v[248:249], v[22:23]
    v_pk_mul_f32 v[250:251], v[250:251], v[22:23]
    v_pk_mul_f32 v[52:53], v[52:53], v[22:23]
    v_pk_mul_f32 v[54:55], v[54:55], v[22:23]
    v_pk_mul_f32 v[56:57], v[56:57], v[22:23]
    v_pk_mul_f32 v[58:59], v[58:59], v[22:23]
    v_pk_mul_f32 v[60:61], v[60:61], v[22:23]
    v_pk_mul_f32 v[62:63], v[62:63], v[22:23]
    v_pk_mul_f32 v[64:65], v[64:65], v[22:23]
    v_pk_mul_f32 v[66:67], v[66:67], v[22:23]
    v_pk_mul_f32 v[68:69], v[68:69], v[22:23]
    v_pk_mul_f32 v[70:71], v[70:71], v[22:23]
    v_pk_mul_f32 v[72:73], v[72:73], v[22:23]
    v_pk_mul_f32 v[74:75], v[74:75], v[22:23]
    v_pk_mul_f32 v[76:77], v[76:77], v[22:23]
    v_pk_mul_f32 v[78:79], v[78:79], v[22:23]
    v_pk_mul_f32 v[80:81], v[80:81], v[22:23]
    v_pk_mul_f32 v[82:83], v[82:83], v[22:23]
    v_pk_mul_f32 v[84:85], v[84:85], v[22:23]
    v_pk_mul_f32 v[86:87], v[86:87], v[22:23]
    v_pk_mul_f32 v[88:89], v[88:89], v[22:23]
    v_pk_mul_f32 v[90:91], v[90:91], v[22:23]
    v_pk_mul_f32 v[92:93], v[92:93], v[22:23]
    v_pk_mul_f32 v[94:95], v[94:95], v[22:23]
    v_pk_mul_f32 v[96:97], v[96:97], v[22:23]
    v_pk_mul_f32 v[98:99], v[98:99], v[22:23]
    s_nop 1
    s_setpc_b64 s[48:49]
L_loop:
    s_add_u32 s51, s51, 1
    s_cmp_lg_u32 s57, 0
    s_cbranch_scc1 L_begun32
L_spin33:
    ds_read_b32 v3, v1 offset:6912
    s_waitcnt lgkmcnt(0)
    v_readfirstlane_b32 s52, v3
    s_nop 0
    s_cmp_ge_u32 s52, s51
    s_cbranch_scc1 L_spun34
    s_sleep 1
    s_branch L_spin33
L_spun34:
    ds_read_b128 v[100:103], v8
    ds_read_b128 v[104:107], v9
    ds_read_b128 v[108:111], v8 offset:128
    ds_read_b128 v[112:115], v9 offset:128
    ds_read_b128 v[116:119], v8 offset:256
    ds_read_b128 v[120:123], v9 offset:256
L_begun32:
    v_mfma_f32_16x16x32_bf16 v[52:55], v[150:153], v[244:247], v[52:55]
    ds_read_b64_tr_b16 v[152:153], v10
    v_mfma_f32_16x16x32_bf16 v[56:59], v[156:159], v[244:247], v[56:59]
    ds_read_b64_tr_b16 v[158:159], v11
    v_mfma_f32_16x16x32_bf16 v[60:63], v[162:165], v[244:247], v[60:63]
    ds_read_b64_tr_b16 v[164:165], v12
    v_mfma_f32_16x16x32_bf16 v[64:67], v[168:171], v[244:247], v[64:67]
    ds_read_b64_tr_b16 v[170:171], v13
    v_mfma_f32_16x16x32_bf16 v[68:71], v[174:177], v[244:247], v[68:71]
    ds_read_b64_tr_b16 v[176:177], v10 offset:128
    v_mfma_f32_16x16x32_bf16 v[72:75], v[180:183], v[244:247], v[72:75]
    ds_read_b64_tr_b16 v[182:183], v11 offset:128
    v_mfma_f32_16x16x32_bf16 v[76:79], v[186:189], v[244:247], v[76:79]
    ds_read_b64_tr_b16 v[188:189], v12 offset:128
    v_mfma_f32_16x16x32_bf16 v[80:83], v[192:195], v[244:247], v[80:83]
    ds_read_b64_tr_b16 v[194:195], v13 offset:128
    v_mfma_f32_16x16x32_bf16 v[84:87], v[198:201], v[244:247], v[84:87]
    ds_read_b64_tr_b16 v[200:201], v10 offset:256
    v_mfma_f32_16x16x32_bf16 v[88:91], v[204:207], v[244:247], v[88:91]
    ds_read_b64_tr_b16 v[206:207], v11 offset:256
    v_mfma_f32_16x16x32_bf16 v[92:95], v[210:213], v[244:247], v[92:95]
    ds_read_b64_tr_b16 v[212:213], v12 offset:256
    v_mfma_f32_16x16x32_bf16 v[96:99], v[216:219], v[244:247], v[96:99]
    ds_read_b64_tr_b16 v[218:219], v13 offset:256
    s_waitcnt lgkmcnt(12)
    v_mfma_f32_16x16x32_bf16 v[224:227], v[100:103], v[24:27], 0
    v_mfma_f32_16x16x32_bf16 v[224:227], v[104:107], v[24:27], v[224:227]
    v_mfma_f32_16x16x32_bf16 v[224:227], v[108:111], v[24:27], v[224:227]
    v_mfma_f32_16x16x32_bf16 v[224:227], v[112:115], v[24:27], v[224:227]
    v_mfma_f32_16x16x32_bf16 v[224:227], v[116:119], v[24:27], v[224:227]
    v_mfma_f32_16x16x32_bf16 v[224:227], v[120:123], v[24:27], v[224:227]
    s_add_u32 s54, s54, 1
    s_cmp_eq_u32 s54, 6
    s_cselect_b32 s55, 0xffff8800, s56
    s_cselect_b32 s54, 0, s54
    v_mfma_f32_16x16x32_bf16 v[220:223], v[100:103], v[28:31], 0
    v_add_u32 v8, s55, v8
    v_add_u32 v9, s55, v9
    v_mfma_f32_16x16x32_bf16 v[220:223], v[104:107], v[32:35], v[220:223]
    v_mov_b32 v2, s51
    v_add_u32 v10, s55, v10
    v_mfma_f32_16x16x32_bf16 v[220:223], v[108:111], v[36:39], v[220:223]
    v_add_u32 v11, s55, v11
    v_add_u32 v12, s55, v12
    v_mfma_f32_16x16x32_bf16 v[220:223], v[112:115], v[40:43], v[220:223]
    v_add_u32 v13, s55, v13
    ds_read_b32 v3, v1 offset:6912
    v_mfma_f32_16x16x32_bf16 v[220:223], v[116:119], v[44:47], v[220:223]
    v_mfma_f32_16x16x32_bf16 v[220:223], v[120:123], v[48:51], v[220:223]
    s_waitcnt lgkmcnt(0)
    ds_write_b32 v1, v2 offset:6928
    v_readfirstlane_b32 s52, v3
    s_mov_b32 s57, 0
    s_nop 0
    s_cmp_gt_u32 s52, s51
    s_cbranch_scc0 L_early35
    s_mov_b32 s57, 1
    ds_read_b128 v[124:127], v8
    ds_read_b128 v[128:131], v9
    ds_read_b128 v[132:135], v8 offset:128
    ds_read_b128 v[136:139], v9 offset:128
    ds_read_b128 v[140:143], v8 offset:256
    ds_read_b128 v[144:147], v9 offset:256
L_early35:
    v_dot2_f32_bf16 v22, v100, v100, 0
    v_dot2_f32_bf16 v23, v101, v101, 0
    v_dot2_f32_bf16 v22, v102, v102, v22
    v_dot2_f32_bf16 v23, v103, v103, v23
    v_dot2_f32_bf16 v22, v104, v104, v22
    v_dot2_f32_bf16 v23, v105, v105, v23
    v_dot2_f32_bf16 v22, v106, v106, v22
    v_dot2_f32_bf16 v23, v107, v107, v23
    v_dot2_f32_bf16 v22, v108, v108, v22
    v_dot2_f32_bf16 v23, v109, v109, v23
    v_dot2_f32_bf16 v22, v110, v110, v22
    v_dot2_f32_bf16 v23, v111, v111, v23
    v_dot2_f32_bf16 v22, v112, v112, v22
    v_dot2_f32_bf16 v23, v113, v113, v23
    v_dot2_f32_bf16 v22, v114, v114, v22
    v_dot2_f32_bf16 v23, v115, v115, v23
    v_dot2_f32_bf16 v22, v116, v116, v22
    v_dot2_f32_bf16 v23, v117, v117, v23
    v_dot2_f32_bf16 v22, v118, v118, v22
    v_dot2_f32_bf16 v23, v119, v119, v23
    v_dot2_f32_bf16 v22, v120, v120, v22
    v_dot2_f32_bf16 v23, v121, v121, v23
    v_dot2_f32_bf16 v22, v122, v122, v22
    v_dot2_f32_bf16 v23, v123, v123, v23
    s_nop 2
    v_add_f32 v255, v22, v23
    s_add_u32 s51, s51, 1
    s_cmp_lg_u32 s57, 0
    s_cbranch_scc1 L_begun36
L_spin37:
    ds_read_b32 v3, v1 offset:6912
    s_waitcnt lgkmcnt(0)
    v_readfirstlane_b32 s52, v3
    s_nop 0
    s_cmp_ge_u32 s52, s51
    s_cbranch_scc1 L_spun38
    s_sleep 1
    s_branch L_spin37
L_spun38:
    ds_read_b128 v[124:127], v8
    ds_read_b128 v[128:131], v9
    ds_read_b128 v[132:135], v8 offset:128
    ds_read_b128 v[136:139], v9 offset:128
    ds_read_b128 v[140:143], v8 offset:256
    ds_read_b128 v[144:147], v9 offset:256
L_begun36:
    s_waitcnt lgkmcnt(5)
    v_mfma_f32_16x16x32_bf16 v[232:235], v[124:127], v[24:27], v[224:227]
    ds_read_b64_tr_b16 v[148:149], v10
    s_add_u32 s54, s54, 1
    s_cmp_eq_u32 s54, 6
    s_cselect_b32 s55, 0xffff8800, s56
    s_cselect_b32 s54, 0, s54
    v_mfma_f32_16x16x32_bf16 v[228:231], v[124:127], v[28:31], v[220:223]
    ds_read_b64_tr_b16 v[154:155], v11
    v_add_u32 v8, s55, v8
    s_waitcnt lgkmcnt(6)
    v_mfma_f32_16x16x32_bf16 v[232:235], v[128:131], v[24:27], v[232:235]
    ds_read_b64_tr_b16 v[160:161], v12
    ds_read_b64_tr_b16 v[166:167], v13
    v_mfma_f32_16x16x32_bf16 v[228:231], v[128:131], v[32:35], v[228:231]
    ds_read_b64_tr_b16 v[172:173], v10 offset:128
    v_add_u32 v9, s55, v9
    s_waitcnt lgkmcnt(8)
    v_mfma_f32_16x16x32_bf16 v[232:235], v[132:135], v[24:27], v[232:235]
    ds_read_b64_tr_b16 v[178:179], v11 offset:128
    ds_read_b64_tr_b16 v[184:185], v12 offset:128
    v_mfma_f32_16x16x32_bf16 v[228:231], v[132:135], v[36:39], v[228:231]
    ds_read_b64_tr_b16 v[190:191], v13 offset:128
    v_mov_b32 v2, s51
    s_waitcnt lgkmcnt(10)
    v_mfma_f32_16x16x32_bf16 v[232:235], v[136:139], v[24:27], v[232:235]
    ds_read_b64_tr_b16 v[196:197], v10 offset:256
    v_mfma_f32_16x16x32_bf16 v[228:231], v[136:139], v[40:43], v[228:231]
    ds_read_b64_tr_b16 v[202:203], v11 offset:256
    s_waitcnt lgkmcnt(11)
    v_mfma_f32_16x16x32_bf16 v[232:235], v[140:143], v[24:27], v[232:235]
    ds_read_b64_tr_b16 v[208:209], v12 offset:256
    v_mfma_f32_16x16x32_bf16 v[228:231], v[140:143], v[44:47], v[228:231]
    ds_read_b64_tr_b16 v[214:215], v13 offset:256
    ds_read_b32 v3, v1 offset:6912
    s_waitcnt lgkmcnt(13)
    v_mfma_f32_16x16x32_bf16 v[232:235], v[144:147], v[24:27], v[232:235]
    v_add_u32 v10, s55, v10
    v_add_u32 v11, s55, v11
    v_mfma_f32_16x16x32_bf16 v[228:231], v[144:147], v[48:51], v[228:231]
    v_add_u32 v12, s55, v12
    v_add_u32 v13, s55, v13
    s_waitcnt lgkmcnt(0)
    ds_write_b32 v1, v2 offset:6928
    v_dot2_f32_bf16 v22, v124, v124, v255
    v_dot2_f32_bf16 v23, v124, v100, 0
    v_dot2_f32_bf16 v22, v125, v125, v22
    v_dot2_f32_bf16 v23, v125, v101, v23
    v_dot2_f32_bf16 v22, v126, v126, v22
    v_dot2_f32_bf16 v23, v126, v102, v23
    v_dot2_f32_bf16 v22, v127, v127, v22
    v_dot2_f32_bf16 v23, v127, v103, v23
    v_dot2_f32_bf16 v22, v128, v128, v22
    v_dot2_f32_bf16 v23, v128, v104, v23
    v_dot2_f32_bf16 v22, v129, v129, v22
    v_dot2_f32_bf16 v23, v129, v105, v23
    v_dot2_f32_bf16 v22, v130, v130, v22
    v_dot2_f32_bf16 v23, v130, v106, v23
    v_dot2_f32_bf16 v22, v131, v131, v22
    v_dot2_f32_bf16 v23, v131, v107, v23
    v_dot2_f32_bf16 v22, v132, v132, v22
    v_dot2_f32_bf16 v23, v132, v108, v23
    v_dot2_f32_bf16 v22, v133, v133, v22
    v_dot2_f32_bf16 v23, v133, v109, v23
    v_dot2_f32_bf16 v22, v134, v134, v22
    v_dot2_f32_bf16 v23, v134, v110, v23
    v_dot2_f32_bf16 v22, v135, v135, v22
    v_dot2_f32_bf16 v23, v135, v111, v23
    v_dot2_f32_bf16 v22, v136, v136, v22
    v_dot2_f32_bf16 v23, v136, v112, v23
    v_dot2_f32_bf16 v22, v137, v137, v22
    v_dot2_f32_bf16 v23, v137, v113, v23
    v_dot2_f32_bf16 v22, v138, v138, v22
    v_dot2_f32_bf16 v23, v138, v114, v23
    v_dot2_f32_bf16 v22, v139, v139, v22
    v_dot2_f32_bf16 v23, v139, v115, v23
    v_dot2_f32_bf16 v22, v140, v140, v22
    v_dot2_f32_bf16 v23, v140, v116, v23
    v_dot2_f32_bf16 v22, v141, v141, v22
    v_dot2_f32_bf16 v23, v141, v117, v23
    v_dot2_f32_bf16 v22, v142, v142, v22
    v_dot2_f32_bf16 v23, v142, v118, v23
    v_dot2_f32_bf16 v22, v143, v143, v22
    v_dot2_f32_bf16 v23, v143, v119, v23
    v_dot2_f32_bf16 v22, v144, v144, v22
    v_dot2_f32_bf16 v23, v144, v120, v23
    v_dot2_f32_bf16 v22, v145, v145, v22
    v_dot2_f32_bf16 v23, v145, v121, v23
    v_dot2_f32_bf16 v22, v146, v146, v22
    v_dot2_f32_bf16 v23, v146, v122, v23
    v_dot2_f32_bf16 v22, v147, v147, v22
    v_dot2_f32_bf16 v23, v147, v123, v23
    s_nop 2
    v_fma_f32 v22, v23, 2.0, v22
    s_nop 1
    v_mfma_f32_16x16x4_f32 v[236:239], v22, v20, 0
    v_readfirstlane_b32 s52, v3
    s_mov_b32 s57, 0
    s_nop 0
    s_cmp_gt_u32 s52, s51
    s_cbranch_scc0 L_early39
    s_mov_b32 s57, 1
    ds_read_b128 v[124:127], v8
    ds_read_b128 v[128:131], v9
    ds_read_b128 v[132:135], v8 offset:128
    ds_read_b128 v[136:139], v9 offset:128
    ds_read_b128 v[140:143], v8 offset:256
    ds_read_b128 v[144:147], v9 offset:256
L_early39:
    v_pk_mul_f32 v[232:233], v[232:233], s[44:45]
    v_pk_mul_f32 v[234:235], v[234:235], s[44:45]
    v_pk_fma_f32 v[4:5], v[232:233], v[232:233], s[46:47] neg_lo:[1,0,0] neg_hi:[1,0,0]
    v_pk_fma_f32 v[6:7], v[234:235], v[234:235], s[46:47] neg_lo:[1,0,0] neg_hi:[1,0,0]
    s_nop 0
    v_pk_fma_f32 v[236:237], v[236:237], s[44:45], v[4:5]
    v_pk_fma_f32 v[238:239], v[238:239], s[44:45], v[6:7]
    v_max_f32 v236, s46, v236
    v_max_f32 v237, s46, v237
    v_max_f32 v238, s46, v238
    v_max_f32 v239, s46, v239
    v_rsq_f32 v236, v236
    v_rsq_f32 v237, v237
    v_rsq_f32 v238, v238
    v_rsq_f32 v239, v239
    v_pk_fma_f32 v[228:229], v[232:233], v[16:17], v[228:229] neg_lo:[1,0,0] neg_hi:[1,0,0]
    v_pk_fma_f32 v[230:231], v[234:235], v[16:17], v[230:231] neg_lo:[1,0,0] neg_hi:[1,0,0]
    v_pk_fma_f32 v[4:5], v[228:229], v[236:237], v[18:19]
    v_pk_fma_f32 v[6:7], v[230:231], v[238:239], v[18:19]
    v_max3_f32 v21, v4, v5, v6
    v_max_f32 v21, v21, v7
    v_cmp_lt_f32 vcc, s50, v21
    v_exp_f32 v4, v4
    v_exp_f32 v5, v5
    v_exp_f32 v6, v6
    v_exp_f32 v7, v7
    s_cbranch_vccz L_sm40
    s_call_b64 s[48:49], L_rescale
L_sm40:
    v_pk_mul_f32 v[248:249], v[4:5], v[236:237]
    v_pk_add_f32 v[14:15], v[14:15], v[4:5]
    v_pk_mul_f32 v[250:251], v[6:7], v[238:239]
    v_pk_add_f32 v[14:15], v[14:15], v[6:7]
    v_mov_b32 v240, v248
    v_mov_b32 v241, v249
    v_mov_b32 v242, v250
    v_mov_b32 v243, v251
    v_pk_fma_f32 v[252:253], v[248:249], v[232:233], v[252:253]
    v_pk_fma_f32 v[252:253], v[250:251], v[234:235], v[252:253]
    s_add_u32 s51, s51, 1
    s_cmp_lg_u32 s57, 0
    s_cbranch_scc1 L_begun41
L_spin42:
    ds_read_b32 v3, v1 offset:6912
    s_waitcnt lgkmcnt(0)
    v_readfirstlane_b32 s52, v3
    s_nop 0
    s_cmp_ge_u32 s52, s51
    s_cbranch_scc1 L_spun43
    s_sleep 1
    s_branch L_spin42
L_spun43:
    ds_read_b128 v[124:127], v8
    ds_read_b128 v[128:131], v9
    ds_read_b128 v[132:135], v8 offset:128
    ds_read_b128 v[136:139], v9 offset:128
    ds_read_b128 v[140:143], v8 offset:256
    ds_read_b128 v[144:147], v9 offset:256
L_begun41:
    s_waitcnt lgkmcnt(5)
    v_mfma_f32_16x16x32_bf16 v[232:235], v[124:127], v[24:27], v[224:227]
    ds_read_b64_tr_b16 v[150:151], v10
    s_add_u32 s54, s54, 1
    s_cmp_eq_u32 s54, 6
    s_cselect_b32 s55, 0xffff8800, s56
    s_cselect_b32 s54, 0, s54
    v_mfma_f32_16x16x32_bf16 v[228:231], v[124:127], v[28:31], v[220:223]
    ds_read_b64_tr_b16 v[156:157], v11
    v_add_u32 v8, s55, v8
    s_waitcnt lgkmcnt(6)
    v_mfma_f32_16x16x32_bf16 v[232:235], v[128:131], v[24:27], v[232:235]
    ds_read_b64_tr_b16 v[162:163], v12
    ds_read_b64_tr_b16 v[168:169], v13
    v_mfma_f32_16x16x32_bf16 v[228:231], v[128:131], v[32:35], v[228:231]
    ds_read_b64_tr_b16 v[174:175], v10 offset:128
    v_add_u32 v9, s55, v9
    s_waitcnt lgkmcnt(8)
    v_mfma_f32_16x16x32_bf16 v[232:235], v[132:135], v[24:27], v[232:235]
    ds_read_b64_tr_b16 v[180:181], v11 offset:128
    ds_read_b64_tr_b16 v[186:187], v12 offset:128
    v_mfma_f32_16x16x32_bf16 v[228:231], v[132:135], v[36:39], v[228:231]
    ds_read_b64_tr_b16 v[192:193], v13 offset:128
    v_mov_b32 v2, s51
    s_waitcnt lgkmcnt(10)
    v_mfma_f32_16x16x32_bf16 v[232:235], v[136:139], v[24:27], v[232:235]
    ds_read_b64_tr_b16 v[198:199], v10 offset:256
    v_mfma_f32_16x16x32_bf16 v[228:231], v[136:139], v[40:43], v[228:231]
    ds_read_b64_tr_b16 v[204:205], v11 offset:256
    s_waitcnt lgkmcnt(11)
    v_mfma_f32_16x16x32_bf16 v[232:235], v[140:143], v[24:27], v[232:235]
    ds_read_b64_tr_b16 v[210:211], v12 offset:256
    v_mfma_f32_16x16x32_bf16 v[228:231], v[140:143], v[44:47], v[228:231]
    ds_read_b64_tr_b16 v[216:217], v13 offset:256
    ds_read_b32 v3, v1 offset:6912
    s_waitcnt lgkmcnt(13)
    v_mfma_f32_16x16x32_bf16 v[232:235], v[144:147], v[24:27], v[232:235]
    v_add_u32 v10, s55, v10
    v_add_u32 v11, s55, v11
    v_mfma_f32_16x16x32_bf16 v[228:231], v[144:147], v[48:51], v[228:231]
    v_add_u32 v12, s55, v12
    v_add_u32 v13, s55, v13
    s_waitcnt lgkmcnt(0)
    ds_write_b32 v1, v2 offset:6928
    v_dot2_f32_bf16 v22, v124, v124, v255
    v_dot2_f32_bf16 v23, v124, v100, 0
    v_dot2_f32_bf16 v22, v125, v125, v22
    v_dot2_f32_bf16 v23, v125, v101, v23
    v_dot2_f32_bf16 v22, v126, v126, v22
    v_dot2_f32_bf16 v23, v126, v102, v23
    v_dot2_f32_bf16 v22, v127, v127, v22
    v_dot2_f32_bf16 v23, v127, v103, v23
    v_dot2_f32_bf16 v22, v128, v128, v22
    v_dot2_f32_bf16 v23, v128, v104, v23
    v_dot2_f32_bf16 v22, v129, v129, v22
    v_dot2_f32_bf16 v23, v129, v105, v23
    v_dot2_f32_bf16 v22, v130, v130, v22
    v_dot2_f32_bf16 v23, v130, v106, v23
    v_dot2_f32_bf16 v22, v131, v131, v22
    v_dot2_f32_bf16 v23, v131, v107, v23
    v_dot2_f32_bf16 v22, v132, v132, v22
    v_dot2_f32_bf16 v23, v132, v108, v23
    v_dot2_f32_bf16 v22, v133, v133, v22
    v_dot2_f32_bf16 v23, v133, v109, v23
    v_dot2_f32_bf16 v22, v134, v134, v22
    v_dot2_f32_bf16 v23, v134, v110, v23
    v_dot2_f32_bf16 v22, v135, v135, v22
    v_dot2_f32_bf16 v23, v135, v111, v23
    v_dot2_f32_bf16 v22, v136, v136, v22
    v_dot2_f32_bf16 v23, v136, v112, v23
    v_dot2_f32_bf16 v22, v137, v137, v22
    v_dot2_f32_bf16 v23, v137, v113, v23
    v_dot2_f32_bf16 v22, v138, v138, v22
    v_dot2_f32_bf16 v23, v138, v114, v23
    v_dot2_f32_bf16 v22, v139, v139, v22
    v_dot2_f32_bf16 v23, v139, v115, v23
    v_dot2_f32_bf16 v22, v140, v140, v22
    v_dot2_f32_bf16 v23, v140, v116, v23
    v_dot2_f32_bf16 v22, v141, v141, v22
    v_dot2_f32_bf16 v23, v141, v117, v23
    v_dot2_f32_bf16 v22, v142, v142, v22
    v_dot2_f32_bf16 v23, v142, v118, v23
    v_dot2_f32_bf16 v22, v143, v143, v22
    v_dot2_f32_bf16 v23, v143, v119, v23
    v_dot2_f32_bf16 v22, v144, v144, v22
    v_dot2_f32_bf16 v23, v144, v120, v23
    v_dot2_f32_bf16 v22, v145, v145, v22
    v_dot2_f32_bf16 v23, v145, v121, v23
    v_dot2_f32_bf16 v22, v146, v146, v22
    v_dot2_f32_bf16 v23, v146, v122, v23
    v_dot2_f32_bf16 v22, v147, v147, v22
    v_dot2_f32_bf16 v23, v147, v123, v23
    s_nop 2
    v_fma_f32 v22, v23, 2.0, v22
    s_nop 1
    v_mfma_f32_16x16x4_f32 v[236:239], v22, v20, 0
    v_readfirstlane_b32 s52, v3
    s_mov_b32 s57, 0
    s_nop 0
    s_cmp_gt_u32 s52, s51
    s_cbranch_scc0 L_early44
    s_mov_b32 s57, 1
    ds_read_b128 v[124:127], v8
    ds_read_b128 v[128:131], v9
    ds_read_b128 v[132:135], v8 offset:128
    ds_read_b128 v[136:139], v9 offset:128
    ds_read_b128 v[140:143], v8 offset:256
    ds_read_b128 v[144:147], v9 offset:256
L_early44:
    v_pk_mul_f32 v[232:233], v[232:233], s[44:45]
    v_pk_mul_f32 v[234:235], v[234:235], s[44:45]
    v_pk_fma_f32 v[4:5], v[232:233], v[232:233], s[46:47] neg_lo:[1,0,0] neg_hi:[1,0,0]
    v_pk_fma_f32 v[6:7], v[234:235], v[234:235], s[46:47] neg_lo:[1,0,0] neg_hi:[1,0,0]
    s_nop 0
    v_pk_fma_f32 v[236:237], v[236:237], s[44:45], v[4:5]
    v_pk_fma_f32 v[238:239], v[238:239], s[44:45], v[6:7]
    v_max_f32 v236, s46, v236
    v_max_f32 v237, s46, v237
    v_max_f32 v238, s46, v238
    v_max_f32 v239, s46, v239
    v_rsq_f32 v236, v236
    v_rsq_f32 v237, v237
    v_rsq_f32 v238, v238
    v_rsq_f32 v239, v239
    v_pk_fma_f32 v[228:229], v[232:233], v[16:17], v[228:229] neg_lo:[1,0,0] neg_hi:[1,0,0]
    v_pk_fma_f32 v[230:231], v[234:235], v[16:17], v[230:231] neg_lo:[1,0,0] neg_hi:[1,0,0]
    v_pk_fma_f32 v[4:5], v[228:229], v[236:237], v[18:19]
    v_pk_fma_f32 v[6:7], v[230:231], v[238:239], v[18:19]
    v_max3_f32 v21, v4, v5, v6
    v_max_f32 v21, v21, v7
    v_cmp_lt_f32 vcc, s50, v21
    v_exp_f32 v4, v4
    v_exp_f32 v5, v5
    v_exp_f32 v6, v6
    v_exp_f32 v7, v7
    s_cbranch_vccz L_sm45
    s_call_b64 s[48:49], L_rescale
L_sm45:
    v_pk_mul_f32 v[228:229], v[4:5], v[236:237]
    v_pk_add_f32 v[14:15], v[14:15], v[4:5]
    v_pk_mul_f32 v[230:231], v[6:7], v[238:239]
    v_pk_add_f32 v[14:15], v[14:15], v[6:7]
    v_pk_add_f32 v[240:241], v[240:241], v[228:229]
    v_pk_add_f32 v[242:243], v[242:243], v[230:231]
    v_pk_fma_f32 v[252:253], v[228:229], v[232:233], v[252:253]
    v_pk_fma_f32 v[252:253], v[230:231], v[234:235], v[252:253]
    v_cvt_pk_bf16_f32 v244, v248, v249
    v_cvt_pk_bf16_f32 v245, v250, v251
    v_cvt_pk_bf16_f32 v246, v228, v229
    v_cvt_pk_bf16_f32 v247, v230, v231
    s_add_u32 s51, s51, 1
    s_cmp_lg_u32 s57, 0
    s_cbranch_scc1 L_begun46
L_spin47:
    ds_read_b32 v3, v1 offset:6912
    s_waitcnt lgkmcnt(0)
    v_readfirstlane_b32 s52, v3
    s_nop 0
    s_cmp_ge_u32 s52, s51
    s_cbranch_scc1 L_spun48
    s_sleep 1
    s_branch L_spin47
L_spun48:
    ds_read_b128 v[124:127], v8
    ds_read_b128 v[128:131], v9
    ds_read_b128 v[132:135], v8 offset:128
    ds_read_b128 v[136:139], v9 offset:128
    ds_read_b128 v[140:143], v8 offset:256
    ds_read_b128 v[144:147], v9 offset:256
L_begun46:
    v_mov_b32 v21, 0
    v_mfma_f32_16x16x32_bf16 v[52:55], v[148:151], v[244:247], v[52:55]
    ds_read_b64_tr_b16 v[148:149], v10
    ds_read_b64 v[150:151], v21 offset:7056
    v_mfma_f32_16x16x32_bf16 v[56:59], v[154:157], v[244:247], v[56:59]
    ds_read_b64_tr_b16 v[154:155], v11
    ds_read_b64 v[156:157], v21 offset:7056
    v_mfma_f32_16x16x32_bf16 v[60:63], v[160:163], v[244:247], v[60:63]
    ds_read_b64_tr_b16 v[160:161], v12
    ds_read_b64 v[162:163], v21 offset:7056
    v_mfma_f32_16x16x32_bf16 v[64:67], v[166:169], v[244:247], v[64:67]
    ds_read_b64_tr_b16 v[166:167], v13
    ds_read_b64 v[168:169], v21 offset:7056
    v_mfma_f32_16x16x32_bf16 v[68:71], v[172:175], v[244:247], v[68:71]
    ds_read_b64_tr_b16 v[172:173], v10 offset:128
    ds_read_b64 v[174:175], v21 offset:7056
    v_mfma_f32_16x16x32_bf16 v[72:75], v[178:181], v[244:247], v[72:75]
    ds_read_b64_tr_b16 v[178:179], v11 offset:128
    ds_read_b64 v[180:181], v21 offset:7056
    v_mfma_f32_16x16x32_bf16 v[76:79], v[184:187], v[244:247], v[76:79]
    ds_read_b64_tr_b16 v[184:185], v12 offset:128
    ds_read_b64 v[186:187], v21 offset:7056
    v_mfma_f32_16x16x32_bf16 v[80:83], v[190:193], v[244:247], v[80:83]
    ds_read_b64_tr_b16 v[190:191], v13 offset:128
    ds_read_b64 v[192:193], v21 offset:7056
    v_mfma_f32_16x16x32_bf16 v[84:87], v[196:199], v[244:247], v[84:87]
    ds_read_b64_tr_b16 v[196:197], v10 offset:256
    ds_read_b64 v[198:199], v21 offset:7056
    v_mfma_f32_16x16x32_bf16 v[88:91], v[202:205], v[244:247], v[88:91]
    ds_read_b64_tr_b16 v[202:203], v11 offset:256
    ds_read_b64 v[204:205], v21 offset:7056
    v_mfma_f32_16x16x32_bf16 v[92:95], v[208:211], v[244:247], v[92:95]
    ds_read_b64_tr_b16 v[208:209], v12 offset:256
    ds_read_b64 v[210:211], v21 offset:7056
    v_mfma_f32_16x16x32_bf16 v[96:99], v[214:217], v[244:247], v[96:99]
    ds_read_b64_tr_b16 v[214:215], v13 offset:256
    ds_read_b64 v[216:217], v21 offset:7056
    s_nop 5
L_tile2b:
    s_waitcnt lgkmcnt(15)
    v_mfma_f32_16x16x32_bf16 v[232:235], v[124:127], v[24:27], v[224:227]
    s_add_u32 s54, s54, 1
    s_cmp_eq_u32 s54, 6
    s_cselect_b32 s55, 0xffff8800, s56
    s_cselect_b32 s54, 0, s54
    v_mfma_f32_16x16x32_bf16 v[228:231], v[124:127], v[28:31], v[220:223]
    v_add_u32 v8, s55, v8
    v_mfma_f32_16x16x32_bf16 v[232:235], v[128:131], v[24:27], v[232:235]
    v_mfma_f32_16x16x32_bf16 v[228:231], v[128:131], v[32:35], v[228:231]
    v_add_u32 v9, s55, v9
    v_mfma_f32_16x16x32_bf16 v[232:235], v[132:135], v[24:27], v[232:235]
    v_mfma_f32_16x16x32_bf16 v[228:231], v[132:135], v[36:39], v[228:231]
    v_mov_b32 v2, s51
    v_mfma_f32_16x16x32_bf16 v[232:235], v[136:139], v[24:27], v[232:235]
    v_mfma_f32_16x16x32_bf16 v[228:231], v[136:139], v[40:43], v[228:231]
    v_mfma_f32_16x16x32_bf16 v[232:235], v[140:143], v[24:27], v[232:235]
    v_mfma_f32_16x16x32_bf16 v[228:231], v[140:143], v[44:47], v[228:231]
    ds_read_b32 v3, v1 offset:6912
    v_mfma_f32_16x16x32_bf16 v[232:235], v[144:147], v[24:27], v[232:235]
    v_add_u32 v10, s55, v10
    v_add_u32 v11, s55, v11
    v_mfma_f32_16x16x32_bf16 v[228:231], v[144:147], v[48:51], v[228:231]
    v_add_u32 v12, s55, v12
    v_add_u32 v13, s55, v13
    s_waitcnt lgkmcnt(0)
    ds_write_b32 v1, v2 offset:6928
    v_dot2_f32_bf16 v22, v124, v124, v255
    v_dot2_f32_bf16 v23, v124, v100, 0
    v_dot2_f32_bf16 v22, v125, v125, v22
    v_dot2_f32_bf16 v23, v125, v101, v23
    v_dot2_f32_bf16 v22, v126, v126, v22
    v_dot2_f32_bf16 v23, v126, v102, v23
    v_dot2_f32_bf16 v22, v127, v127, v22
    v_dot2_f32_bf16 v23, v127, v103, v23
    v_dot2_f32_bf16 v22, v128, v128, v22
    v_dot2_f32_bf16 v23, v128, v104, v23
    v_dot2_f32_bf16 v22, v129, v129, v22
    v_dot2_f32_bf16 v23, v129, v105, v23
    v_dot2_f32_bf16 v22, v130, v130, v22
    v_dot2_f32_bf16 v23, v130, v106, v23
    v_dot2_f32_bf16 v22, v131, v131, v22
    v_dot2_f32_bf16 v23, v131, v107, v23
    v_dot2_f32_bf16 v22, v132, v132, v22
    v_dot2_f32_bf16 v23, v132, v108, v23
    v_dot2_f32_bf16 v22, v133, v133, v22
    v_dot2_f32_bf16 v23, v133, v109, v23
    v_dot2_f32_bf16 v22, v134, v134, v22
    v_dot2_f32_bf16 v23, v134, v110, v23
    v_dot2_f32_bf16 v22, v135, v135, v22
    v_dot2_f32_bf16 v23, v135, v111, v23
    v_dot2_f32_bf16 v22, v136, v136, v22
    v_dot2_f32_bf16 v23, v136, v112, v23
    v_dot2_f32_bf16 v22, v137, v137, v22
    v_dot2_f32_bf16 v23, v137, v113, v23
    v_dot2_f32_bf16 v22, v138, v138, v22
    v_dot2_f32_bf16 v23, v138, v114, v23
    v_dot2_f32_bf16 v22, v139, v139, v22
    v_dot2_f32_bf16 v23, v139, v115, v23
    v_dot2_f32_bf16 v22, v140, v140, v22
    v_dot2_f32_bf16 v23, v140, v116, v23
    v_dot2_f32_bf16 v22, v141, v141, v22
    v_dot2_f32_bf16 v23, v141, v117, v23
    v_dot2_f32_bf16 v22, v142, v142, v22
    v_dot2_f32_bf16 v23, v142, v118, v23
    v_dot2_f32_bf16 v22, v143, v143, v22
    v_dot2_f32_bf16 v23, v143, v119, v23
    v_dot2_f32_bf16 v22, v144, v144, v22
    v_dot2_f32_bf16 v23, v144, v120, v23
    v_dot2_f32_bf16 v22, v145, v145, v22
    v_dot2_f32_bf16 v23, v145, v121, v23
    v_dot2_f32_bf16 v22, v146, v146, v22
    v_dot2_f32_bf16 v23, v146, v122, v23
    v_dot2_f32_bf16 v22, v147, v147, v22
    v_dot2_f32_bf16 v23, v147, v123, v23
    s_nop 2
    v_fma_f32 v22, v23, 2.0, v22
    s_nop 1
    v_mfma_f32_16x16x4_f32 v[236:239], v22, v20, 0
    v_readfirstlane_b32 s52, v3
    s_mov_b32 s57, 0
    s_nop 0
    s_cmp_gt_u32 s52, s51
    s_cbranch_scc0 L_early49
    s_mov_b32 s57, 1
    ds_read_b128 v[124:127], v8
    ds_read_b128 v[128:131], v9
    ds_read_b128 v[132:135], v8 offset:128
    ds_read_b128 v[136:139], v9 offset:128
    ds_read_b128 v[140:143], v8 offset:256
    ds_read_b128 v[144:147], v9 offset:256
L_early49:
    ds_read_b32 v3, v1 offset:6912
    v_pk_mul_f32 v[232:233], v[232:233], s[44:45]
    v_pk_mul_f32 v[234:235], v[234:235], s[44:45]
    v_pk_fma_f32 v[4:5], v[232:233], v[232:233], s[46:47] neg_lo:[1,0,0] neg_hi:[1,0,0]
    v_pk_fma_f32 v[6:7], v[234:235], v[234:235], s[46:47] neg_lo:[1,0,0] neg_hi:[1,0,0]
    v_pk_fma_f32 v[236:237], v[236:237], s[44:45], v[4:5]
    v_pk_fma_f32 v[238:239], v[238:239], s[44:45], v[6:7]
    v_max_f32 v236, s46, v236
    v_max_f32 v237, s46, v237
    v_max_f32 v238, s46, v238
    v_max_f32 v239, s46, v239
    v_rsq_f32 v236, v236
    v_rsq_f32 v237, v237
    v_rsq_f32 v238, v238
    v_rsq_f32 v239, v239
    v_pk_fma_f32 v[228:229], v[232:233], v[16:17], v[228:229] neg_lo:[1,0,0] neg_hi:[1,0,0]
    v_pk_fma_f32 v[230:231], v[234:235], v[16:17], v[230:231] neg_lo:[1,0,0] neg_hi:[1,0,0]
    v_pk_fma_f32 v[4:5], v[228:229], v[236:237], v[18:19]
    v_pk_fma_f32 v[6:7], v[230:231], v[238:239], v[18:19]
    v_max3_f32 v21, v4, v5, v6
    v_max_f32 v21, v21, v7
    v_cmp_lt_f32 vcc, s50, v21
    v_exp_f32 v4, v4
    v_exp_f32 v5, v5
    v_exp_f32 v6, v6
    v_exp_f32 v7, v7
    s_cbranch_vccz L_sm50
    s_call_b64 s[48:49], L_rescale
L_sm50:
    v_pk_mul_f32 v[248:249], v[4:5], v[236:237]
    v_pk_add_f32 v[14:15], v[14:15], v[4:5]
    v_pk_mul_f32 v[250:251], v[6:7], v[238:239]
    v_pk_add_f32 v[14:15], v[14:15], v[6:7]
    v_pk_add_f32 v[240:241], v[240:241], v[248:249]
    v_pk_add_f32 v[242:243], v[242:243], v[250:251]
    v_pk_fma_f32 v[252:253], v[248:249], v[232:233], v[252:253]
    v_pk_fma_f32 v[252:253], v[250:251], v[234:235], v[252:253]
    v_cvt_pk_bf16_f32 v244, v248, v249
    v_cvt_pk_bf16_f32 v245, v250, v251
    v_cvt_pk_bf16_f32 v246, -v252, -v253
    v_mov_b32 v247, 0
    s_waitcnt lgkmcnt(0)
    v_readfirstlane_b32 s52, v3
    s_cmp_lg_u32 s57, 0
    s_cbranch_scc1 L_early51
    s_cmp_gt_u32 s52, s51
    s_cbranch_scc0 L_early51
    s_mov_b32 s57, 1
    ds_read_b128 v[124:127], v8
    ds_read_b128 v[128:131], v9
    ds_read_b128 v[132:135], v8 offset:128
    ds_read_b128 v[136:139], v9 offset:128
    ds_read_b128 v[140:143], v8 offset:256
    ds_read_b128 v[144:147], v9 offset:256
L_early51:
    v_mfma_f32_16x16x32_bf16 v[52:55], v[148:151], v[244:247], v[52:55]
    v_mfma_f32_16x16x32_bf16 v[56:59], v[154:157], v[244:247], v[56:59]
    v_mfma_f32_16x16x32_bf16 v[60:63], v[160:163], v[244:247], v[60:63]
    v_mfma_f32_16x16x32_bf16 v[64:67], v[166:169], v[244:247], v[64:67]
    v_mfma_f32_16x16x32_bf16 v[68:71], v[172:175], v[244:247], v[68:71]
    v_mfma_f32_16x16x32_bf16 v[72:75], v[178:181], v[244:247], v[72:75]
    v_mfma_f32_16x16x32_bf16 v[76:79], v[184:187], v[244:247], v[76:79]
    v_mfma_f32_16x16x32_bf16 v[80:83], v[190:193], v[244:247], v[80:83]
    v_mfma_f32_16x16x32_bf16 v[84:87], v[196:199], v[244:247], v[84:87]
    v_mfma_f32_16x16x32_bf16 v[88:91], v[202:205], v[244:247], v[88:91]
    v_mfma_f32_16x16x32_bf16 v[92:95], v[208:211], v[244:247], v[92:95]
    v_mfma_f32_16x16x32_bf16 v[96:99], v[214:217], v[244:247], v[96:99]
    s_cmp_eq_u32 s41, 3
    s_cbranch_scc1 L_last
    s_add_u32 s51, s51, 1
    s_cmp_lg_u32 s57, 0
    s_cbranch_scc1 L_begun52
    s_nop 2
L_spin53:
    ds_read_b32 v3, v1 offset:6912
    s_waitcnt lgkmcnt(0)
    v_readfirstlane_b32 s52, v3
    s_nop 0
    s_cmp_ge_u32 s52, s51
    s_cbranch_scc1 L_spun54
    s_sleep 1
    s_branch L_spin53
L_spun54:
    ds_read_b128 v[124:127], v8
    ds_read_b128 v[128:131], v9
    ds_read_b128 v[132:135], v8 offset:128
    ds_read_b128 v[136:139], v9 offset:128
    ds_read_b128 v[140:143], v8 offset:256
    ds_read_b128 v[144:147], v9 offset:256
L_begun52:
    s_waitcnt lgkmcnt(5)
    v_mfma_f32_16x16x32_bf16 v[232:235], v[124:127], v[24:27], v[224:227]
    ds_read_b64_tr_b16 v[150:151], v10
    s_add_u32 s54, s54, 1
    s_cmp_eq_u32 s54, 6
    s_cselect_b32 s55, 0xffff8800, s56
    s_cselect_b32 s54, 0, s54
    v_mfma_f32_16x16x32_bf16 v[228:231], v[124:127], v[28:31], v[220:223]
    ds_read_b64_tr_b16 v[156:157], v11
    v_add_u32 v8, s55, v8
    s_waitcnt lgkmcnt(6)
    v_mfma_f32_16x16x32_bf16 v[232:235], v[128:131], v[24:27], v[232:235]
    ds_read_b64_tr_b16 v[162:163], v12
    ds_read_b64_tr_b16 v[168:169], v13
    v_mfma_f32_16x16x32_bf16 v[228:231], v[128:131], v[32:35], v[228:231]
    ds_read_b64_tr_b16 v[174:175], v10 offset:128
    v_add_u32 v9, s55, v9
    s_waitcnt lgkmcnt(8)
    v_mfma_f32_16x16x32_bf16 v[232:235], v[132:135], v[24:27], v[232:235]
    ds_read_b64_tr_b16 v[180:181], v11 offset:128
    ds_read_b64_tr_b16 v[186:187], v12 offset:128
    v_mfma_f32_16x16x32_bf16 v[228:231], v[132:135], v[36:39], v[228:231]
    ds_read_b64_tr_b16 v[192:193], v13 offset:128
    v_mov_b32 v2, s51
    s_waitcnt lgkmcnt(10)
    v_mfma_f32_16x16x32_bf16 v[232:235], v[136:139], v[24:27], v[232:235]
    ds_read_b64_tr_b16 v[198:199], v10 offset:256
    v_mfma_f32_16x16x32_bf16 v[228:231], v[136:139], v[40:43], v[228:231]
    ds_read_b64_tr_b16 v[204:205], v11 offset:256
    s_waitcnt lgkmcnt(11)
    v_mfma_f32_16x16x32_bf16 v[232:235], v[140:143], v[24:27], v[232:235]
    ds_read_b64_tr_b16 v[210:211], v12 offset:256
    v_mfma_f32_16x16x32_bf16 v[228:231], v[140:143], v[44:47], v[228:231]
    ds_read_b64_tr_b16 v[216:217], v13 offset:256
    ds_read_b32 v3, v1 offset:6912
    s_waitcnt lgkmcnt(13)
    v_mfma_f32_16x16x32_bf16 v[232:235], v[144:147], v[24:27], v[232:235]
    v_add_u32 v10, s55, v10
    v_add_u32 v11, s55, v11
    v_mfma_f32_16x16x32_bf16 v[228:231], v[144:147], v[48:51], v[228:231]
    v_add_u32 v12, s55, v12
    v_add_u32 v13, s55, v13
    s_waitcnt lgkmcnt(0)
    ds_write_b32 v1, v2 offset:6928
    v_dot2_f32_bf16 v22, v124, v124, v255
    v_dot2_f32_bf16 v23, v124, v100, 0
    v_dot2_f32_bf16 v22, v125, v125, v22
    v_dot2_f32_bf16 v23, v125, v101, v23
    v_dot2_f32_bf16 v22, v126, v126, v22
    v_dot2_f32_bf16 v23, v126, v102, v23
    v_dot2_f32_bf16 v22, v127, v127, v22
    v_dot2_f32_bf16 v23, v127, v103, v23
    v_dot2_f32_bf16 v22, v128, v128, v22
    v_dot2_f32_bf16 v23, v128, v104, v23
    v_dot2_f32_bf16 v22, v129, v129, v22
    v_dot2_f32_bf16 v23, v129, v105, v23
    v_dot2_f32_bf16 v22, v130, v130, v22
    v_dot2_f32_bf16 v23, v130, v106, v23
    v_dot2_f32_bf16 v22, v131, v131, v22
    v_dot2_f32_bf16 v23, v131, v107, v23
    v_dot2_f32_bf16 v22, v132, v132, v22
    v_dot2_f32_bf16 v23, v132, v108, v23
    v_dot2_f32_bf16 v22, v133, v133, v22
    v_dot2_f32_bf16 v23, v133, v109, v23
    v_dot2_f32_bf16 v22, v134, v134, v22
    v_dot2_f32_bf16 v23, v134, v110, v23
    v_dot2_f32_bf16 v22, v135, v135, v22
    v_dot2_f32_bf16 v23, v135, v111, v23
    v_dot2_f32_bf16 v22, v136, v136, v22
    v_dot2_f32_bf16 v23, v136, v112, v23
    v_dot2_f32_bf16 v22, v137, v137, v22
    v_dot2_f32_bf16 v23, v137, v113, v23
    v_dot2_f32_bf16 v22, v138, v138, v22
    v_dot2_f32_bf16 v23, v138, v114, v23
    v_dot2_f32_bf16 v22, v139, v139, v22
    v_dot2_f32_bf16 v23, v139, v115, v23
    v_dot2_f32_bf16 v22, v140, v140, v22
    v_dot2_f32_bf16 v23, v140, v116, v23
    v_dot2_f32_bf16 v22, v141, v141, v22
    v_dot2_f32_bf16 v23, v141, v117, v23
    v_dot2_f32_bf16 v22, v142, v142, v22
    v_dot2_f32_bf16 v23, v142, v118, v23
    v_dot2_f32_bf16 v22, v143, v143, v22
    v_dot2_f32_bf16 v23, v143, v119, v23
    v_dot2_f32_bf16 v22, v144, v144, v22
    v_dot2_f32_bf16 v23, v144, v120, v23
    v_dot2_f32_bf16 v22, v145, v145, v22
    v_dot2_f32_bf16 v23, v145, v121, v23
    v_dot2_f32_bf16 v22, v146, v146, v22
    v_dot2_f32_bf16 v23, v146, v122, v23
    v_dot2_f32_bf16 v22, v147, v147, v22
    v_dot2_f32_bf16 v23, v147, v123, v23
    s_nop 2
    v_fma_f32 v22, v23, 2.0, v22
    s_nop 1
    v_mfma_f32_16x16x4_f32 v[236:239], v22, v20, 0
    v_readfirstlane_b32 s52, v3
    s_mov_b32 s57, 0
    s_nop 0
    s_cmp_gt_u32 s52, s51
    s_cbranch_scc0 L_early55
    s_mov_b32 s57, 1
    ds_read_b128 v[100:103], v8
    ds_read_b128 v[104:107], v9
    ds_read_b128 v[108:111], v8 offset:128
    ds_read_b128 v[112:115], v9 offset:128
    ds_read_b128 v[116:119], v8 offset:256
    ds_read_b128 v[120:123], v9 offset:256
L_early55:
    v_pk_mul_f32 v[232:233], v[232:233], s[44:45]
    v_pk_mul_f32 v[234:235], v[234:235], s[44:45]
    v_pk_fma_f32 v[4:5], v[232:233], v[232:233], s[46:47] neg_lo:[1,0,0] neg_hi:[1,0,0]
    v_pk_fma_f32 v[6:7], v[234:235], v[234:235], s[46:47] neg_lo:[1,0,0] neg_hi:[1,0,0]
    s_nop 0
    v_pk_fma_f32 v[236:237], v[236:237], s[44:45], v[4:5]
    v_pk_fma_f32 v[238:239], v[238:239], s[44:45], v[6:7]
    v_max_f32 v236, s46, v236
    v_max_f32 v237, s46, v237
    v_max_f32 v238, s46, v238
    v_max_f32 v239, s46, v239
    v_rsq_f32 v236, v236
    v_rsq_f32 v237, v237
    v_rsq_f32 v238, v238
    v_rsq_f32 v239, v239
    v_pk_fma_f32 v[228:229], v[232:233], v[16:17], v[228:229] neg_lo:[1,0,0] neg_hi:[1,0,0]
    v_pk_fma_f32 v[230:231], v[234:235], v[16:17], v[230:231] neg_lo:[1,0,0] neg_hi:[1,0,0]
    v_pk_fma_f32 v[4:5], v[228:229], v[236:237], v[18:19]
    v_pk_fma_f32 v[6:7], v[230:231], v[238:239], v[18:19]
    v_max3_f32 v21, v4, v5, v6
    v_max_f32 v21, v21, v7
    v_cmp_lt_f32 vcc, s50, v21
    v_exp_f32 v4, v4
    v_exp_f32 v5, v5
    v_exp_f32 v6, v6
    v_exp_f32 v7, v7
    s_cbranch_vccz L_sm56
    s_call_b64 s[48:49], L_rescale
L_sm56:
    v_pk_mul_f32 v[228:229], v[4:5], v[236:237]
    v_pk_add_f32 v[14:15], v[14:15], v[4:5]
    v_pk_mul_f32 v[230:231], v[6:7], v[238:239]
    v_pk_add_f32 v[14:15], v[14:15], v[6:7]
    v_pk_add_f32 v[240:241], v[240:241], v[228:229]
    v_pk_add_f32 v[242:243], v[242:243], v[230:231]
    v_pk_mul_f32 v[252:253], v[228:229], v[232:233]
    v_pk_fma_f32 v[252:253], v[230:231], v[234:235], v[252:253]
    v_cvt_pk_bf16_f32 v244, v228, v229
    v_cvt_pk_bf16_f32 v245, v230, v231
    v_cvt_pk_bf16_f32 v246, v240, v241
    v_cvt_pk_bf16_f32 v247, v242, v243
    s_add_u32 s41, s41, 1
    s_nop 0
    s_branch L_loop
L_last:
    s_setprio 2
    v_and_b32 v22, 15, v0
    v_lshrrev_b32 v23, 4, v0
    v_lshlrev_b32 v148, 4, v0
    v_lshlrev_b32 v23, 2, v23
    v_add_u32 v148, s36, v148
    v_lshl_add_u32 v149, v22, 4, v23
    v_add_u32 v149, s36, v149
    s_cmp_lg_u32 s57, 0
    s_cbranch_scc1 L_lgot
L_lspin:
    ds_read_b32 v3, v1 offset:6912
    ds_read_b128 v[124:127], v8
    ds_read_b128 v[128:131], v9
    ds_read_b128 v[132:135], v8 offset:128
    ds_read_b128 v[136:139], v9 offset:128
    ds_read_b128 v[140:143], v8 offset:256
    ds_read_b128 v[144:147], v9 offset:256
    s_waitcnt lgkmcnt(6)
    v_readfirstlane_b32 s52, v3
    s_nop 0
    s_cmp_ge_u32 s52, 20
    s_cbranch_scc0 L_lspin
L_lgot:
    s_waitcnt lgkmcnt(5)
    v_mfma_f32_16x16x32_bf16 v[236:239], v[124:127], v[124:127], 0
    v_mfma_f32_16x16x32_bf16 v[4:7], v[124:127], v[100:103], 0
    ds_read_b64_tr_b16 v[150:151], v10
    s_waitcnt lgkmcnt(5)
    v_mfma_f32_16x16x32_bf16 v[236:239], v[128:131], v[128:131], v[236:239]
    v_mfma_f32_16x16x32_bf16 v[4:7], v[128:131], v[104:107], v[4:7]
    ds_read_b64_tr_b16 v[156:157], v11
    s_waitcnt lgkmcnt(5)
    v_mfma_f32_16x16x32_bf16 v[236:239], v[132:135], v[132:135], v[236:239]
    ds_read_b64_tr_b16 v[162:163], v12
    v_mfma_f32_16x16x32_bf16 v[4:7], v[132:135], v[108:111], v[4:7]
    ds_read_b64_tr_b16 v[168:169], v13
    s_waitcnt lgkmcnt(6)
    v_mfma_f32_16x16x32_bf16 v[236:239], v[136:139], v[136:139], v[236:239]
    ds_read_b64_tr_b16 v[174:175], v10 offset:128
    v_mfma_f32_16x16x32_bf16 v[4:7], v[136:139], v[112:115], v[4:7]
    ds_read_b64_tr_b16 v[180:181], v11 offset:128
    s_waitcnt lgkmcnt(7)
    v_mfma_f32_16x16x32_bf16 v[236:239], v[140:143], v[140:143], v[236:239]
    ds_read_b64_tr_b16 v[186:187], v12 offset:128
    v_mfma_f32_16x16x32_bf16 v[4:7], v[140:143], v[116:119], v[4:7]
    ds_read_b64_tr_b16 v[192:193], v13 offset:128
    s_waitcnt lgkmcnt(8)
    v_mfma_f32_16x16x32_bf16 v[236:239], v[144:147], v[144:147], v[236:239]
    ds_read_b64_tr_b16 v[198:199], v10 offset:256
    v_mfma_f32_16x16x32_bf16 v[4:7], v[144:147], v[120:123], v[4:7]
    ds_read_b64_tr_b16 v[204:205], v11 offset:256
    v_mfma_f32_16x16x32_bf16 v[232:235], v[124:127], v[24:27], v[224:227]
    ds_read_b64_tr_b16 v[210:211], v12 offset:256
    v_mfma_f32_16x16x32_bf16 v[232:235], v[128:131], v[24:27], v[232:235]
    ds_read_b64_tr_b16 v[216:217], v13 offset:256
    s_nop 2
    v_mfma_f32_16x16x32_bf16 v[232:235], v[132:135], v[24:27], v[232:235]
    v_cndmask_b32 v22, v236, v237, s[58:59]
    v_cndmask_b32 v23, v238, v239, s[58:59]
    v_mfma_f32_16x16x32_bf16 v[232:235], v[136:139], v[24:27], v[232:235]
    v_cndmask_b32 v4, v4, v5, s[58:59]
    v_cndmask_b32 v6, v6, v7, s[58:59]
    v_mfma_f32_16x16x32_bf16 v[232:235], v[140:143], v[24:27], v[232:235]
    v_cndmask_b32 v22, v22, v23, s[60:61]
    v_cndmask_b32 v4, v4, v6, s[60:61]
    v_mfma_f32_16x16x32_bf16 v[232:235], v[144:147], v[24:27], v[232:235]
    v_fma_f32 v22, v4, 2.0, v22
    v_cndmask_b32 v22, 0, v22, s[38:39]
    v_add_f32 v22, v22, v255
    v_mfma_f32_16x16x32_bf16 v[228:231], v[124:127], v[28:31], v[220:223]
    s_nop 0
    v_mfma_f32_16x16x4_f32 v[236:239], v22, v20, 0
    v_mfma_f32_16x16x32_bf16 v[228:231], v[128:131], v[32:35], v[228:231]
    v_mfma_f32_16x16x32_bf16 v[228:231], v[132:135], v[36:39], v[228:231]
    v_mul_f32 v232, s44, v232
    v_mul_f32 v233, s44, v233
    v_mfma_f32_16x16x32_bf16 v[228:231], v[136:139], v[40:43], v[228:231]
    v_mul_f32 v234, s44, v234
    v_mul_f32 v235, s44, v235
    v_mfma_f32_16x16x32_bf16 v[228:231], v[140:143], v[44:47], v[228:231]
    v_fma_f32 v4, -v232, v232, s46
    v_fma_f32 v5, -v233, v233, s46
    v_mfma_f32_16x16x32_bf16 v[228:231], v[144:147], v[48:51], v[228:231]
    v_fma_f32 v6, -v234, v234, s46
    v_fma_f32 v7, -v235, v235, s46
    s_waitcnt lgkmcnt(0)
    v_pk_fma_f32 v[236:237], v[236:237], s[44:45], v[4:5]
    v_pk_fma_f32 v[238:239], v[238:239], s[44:45], v[6:7]
    v_max_f32 v236, s46, v236
    v_max_f32 v237, s46, v237
    v_max_f32 v238, s46, v238
    v_max_f32 v239, s46, v239
    v_rsq_f32 v236, v236
    v_rsq_f32 v237, v237
    v_rsq_f32 v238, v238
    v_rsq_f32 v239, v239
    v_pk_fma_f32 v[228:229], v[232:233], v[16:17], v[228:229] neg_lo:[1,0,0] neg_hi:[1,0,0]
    v_pk_fma_f32 v[230:231], v[234:235], v[16:17], v[230:231] neg_lo:[1,0,0] neg_hi:[1,0,0]
    v_pk_fma_f32 v[4:5], v[228:229], v[236:237], v[18:19]
    v_pk_fma_f32 v[6:7], v[230:231], v[238:239], v[18:19]
    v_max3_f32 v21, v4, v5, v6
    v_max_f32 v21, v21, v7
    v_cmp_lt_f32 vcc, s50, v21
    v_exp_f32 v4, v4
    v_exp_f32 v5, v5
    v_exp_f32 v6, v6
    v_exp_f32 v7, v7
    s_cbranch_vccz L_sm57
    s_call_b64 s[48:49], L_rescale
L_sm57:
    v_pk_mul_f32 v[228:229], v[4:5], v[236:237]
    v_pk_mul_f32 v[230:231], v[6:7], v[238:239]
    v_pk_add_f32 v[240:241], v[240:241], v[228:229]
    v_pk_add_f32 v[242:243], v[242:243], v[230:231]
    v_cvt_pk_bf16_f32 v244, v228, v229
    v_cvt_pk_bf16_f32 v245, v230, v231
    v_cvt_pk_bf16_f32 v246, v240, v241
    v_cvt_pk_bf16_f32 v247, v242, v243
    s_nop 1
    v_mfma_f32_16x16x32_bf16 v[52:55], v[150:153], v[244:247], v[52:55]
    v_cmp_neq_f32 vcc, 0, v254
    v_add_f32 v4, v4, v5
    v_add_f32 v6, v6, v7
    v_mfma_f32_16x16x32_bf16 v[56:59], v[156:159], v[244:247], v[56:59]
    v_add_f32 v14, v14, v15
    v_add_f32 v4, v4, v6
    ds_write_b32 v149, v254 offset:12800
    v_mfma_f32_16x16x32_bf16 v[60:63], v[162:165], v[244:247], v[60:63]
    v_add_f32 v14, v14, v4
    s_cmp_eq_u64 vcc, 0
    s_cselect_b32 s40, 18, 34
    v_mov_b32 v154, s40
    ds_write_b32 v149, v14 offset:12288
    v_mfma_f32_16x16x32_bf16 v[64:67], v[168:171], v[244:247], v[64:67]
    v_cvt_pk_bf16_f32 v100, v52, v53
    v_cvt_pk_bf16_f32 v101, v54, v55
    v_mfma_f32_16x16x32_bf16 v[68:71], v[174:177], v[244:247], v[68:71]
    v_cvt_pk_bf16_f32 v102, v56, v57
    v_cvt_pk_bf16_f32 v103, v58, v59
    ds_write_b128 v148, v[100:103]
    v_mfma_f32_16x16x32_bf16 v[72:75], v[180:183], v[244:247], v[72:75]
    v_cvt_pk_bf16_f32 v104, v60, v61
    v_cvt_pk_bf16_f32 v105, v62, v63
    v_mfma_f32_16x16x32_bf16 v[76:79], v[186:189], v[244:247], v[76:79]
    v_cvt_pk_bf16_f32 v106, v64, v65
    v_cvt_pk_bf16_f32 v107, v66, v67
    ds_write_b128 v148, v[104:107] offset:1024
    ds_write_b32 v1, v154 offset:6992
    v_add_u32 v154, 2, v154
    v_mfma_f32_16x16x32_bf16 v[80:83], v[192:195], v[244:247], v[80:83]
    v_cvt_pk_bf16_f32 v108, v68, v69
    v_cvt_pk_bf16_f32 v109, v70, v71
    v_mfma_f32_16x16x32_bf16 v[84:87], v[198:201], v[244:247], v[84:87]
    v_cvt_pk_bf16_f32 v110, v72, v73
    v_cvt_pk_bf16_f32 v111, v74, v75
    ds_write_b128 v148, v[108:111] offset:2048
    v_mfma_f32_16x16x32_bf16 v[88:91], v[204:207], v[244:247], v[88:91]
    v_cvt_pk_bf16_f32 v112, v76, v77
    v_cvt_pk_bf16_f32 v113, v78, v79
    v_mfma_f32_16x16x32_bf16 v[92:95], v[210:213], v[244:247], v[92:95]
    v_cvt_pk_bf16_f32 v114, v80, v81
    v_cvt_pk_bf16_f32 v115, v82, v83
    ds_write_b128 v148, v[112:115] offset:3072
    ds_write_b32 v1, v154 offset:6992
    v_add_u32 v154, 2, v154
    v_mfma_f32_16x16x32_bf16 v[96:99], v[216:219], v[244:247], v[96:99]
    v_cvt_pk_bf16_f32 v116, v84, v85
    v_cvt_pk_bf16_f32 v117, v86, v87
    v_cvt_pk_bf16_f32 v118, v88, v89
    v_cvt_pk_bf16_f32 v119, v90, v91
    ds_write_b128 v148, v[116:119] offset:4096
    v_cvt_pk_bf16_f32 v120, v92, v93
    v_cvt_pk_bf16_f32 v121, v94, v95
    s_nop 0
    v_cvt_pk_bf16_f32 v122, v96, v97
    v_cvt_pk_bf16_f32 v123, v98, v99
    ds_write_b128 v148, v[120:123] offset:5120
    ds_write_b32 v1, v154 offset:6992
    s_setprio 0
    s_cmp_lt_u32 s2, 0x80
    s_cbranch_scc1 L_r_end
    s_sub_u32 s53, s2, 0x80
    s_and_b32 s40, s53, 7
    s_lshr_b32 s42, s53, 4
    s_lshl_b32 s42, s42, 3
    s_or_b32 s40, s40, s42
    s_lshl_b32 s40, s40, 1
    s_bfe_u32 s42, s53, 0x10003
    s_or_b32 s53, s40, s42
    s_mov_b32 s24, s4
    s_mov_b32 s25, s5
    s_mov_b32 s26, 0x1800
    s_mov_b32 s27, 0x20000
    s_mov_b32 s28, s18
    s_mov_b32 s29, s19
    s_mov_b32 s30, 0x1800
    s_mov_b32 s31, 0x20000
    v_and_b32 v28, 3, v0
    v_lshrrev_b32 v29, 2, v0
    v_lshlrev_b32 v30, 15, v29
    v_lshl_add_u32 v30, v28, 4, v30
    v_lshlrev_b32 v32, 2, v28
    ds_read_b32 v38, v32 offset:7040
    s_lshl_b32 s40, s3, 19
    s_lshl_b32 s42, s53, 6
    s_add_u32 s40, s40, s42
    s_add_u32 s40, s40, 0x80000
    s_and_b32 s42, s53, 3
    s_mul_i32 s42, s42, 0x600
    v_mul_u32_u24 v31, 0x180, v28
    v_add_u32 v31, s42, v31
    s_lshr_b32 s42, s53, 5
    s_mul_i32 s6, s42, 0x60
    s_bfe_u32 s42, s53, 0x20002
    s_lshl_b32 s42, s42, 3
    s_add_u32 s6, s6, s42
    s_bitcmp1_b32 s53, 4
    s_cselect_b32 s4, 36, 0
    s_cselect_b32 s5, 64, 4
    s_cselect_b32 s42, 0x44, 32
    s_add_u32 s4, s4, s6
    s_add_u32 s5, s5, s6
    s_add_u32 s6, s6, s42
    buffer_load_dword v56, v31, s[24:27], s4 offen
    buffer_load_dword v57, v31, s[24:27], s5 offen
    buffer_load_dword v58, v31, s[24:27], s6 offen
    v_lshrrev_b32 v32, 4, v0
    v_lshlrev_b32 v34, 7, v32
    v_lshl_add_u32 v34, v28, 5, v34
    s_lshl_b32 s42, s3, 9
    s_add_u32 s42, s42, 0x9400
    v_add_u32 v34, s42, v34
    v_and_b32 v35, 15, v0
    v_lshlrev_b32 v35, 5, v35
    v_mov_b32 v32, 0
    v_mov_b32 v60, 0
    v_mov_b32 v61, 0
    v_mov_b32 v62, 0
    v_mov_b32 v63, 0
    v_mov_b32 v64, 0
    v_mov_b32 v65, 0
    v_mov_b32 v66, 0
    v_mov_b32 v67, 0
    v_mov_b32 v37, 0
    s_mov_b64 s[44:45], -1
    s_mov_b64 s[46:47], -1
    s_mov_b64 s[58:59], -1
    s_mov_b64 s[60:61], -1
    s_mov_b32 s38, 0x3f80
    s_mov_b32 s39, 0x3f800000
    s_waitcnt vmcnt(0) lgkmcnt(0)
    v_lshlrev_b32 v120, 16, v56
    v_and_b32 v121, 0xffff0000, v56
    v_lshlrev_b32 v122, 16, v57
    v_and_b32 v123, 0xffff0000, v57
    v_lshlrev_b32 v124, 16, v58
    v_and_b32 v125, 0xffff0000, v58
    s_nop 1
L_spin58:
    ds_read_b32 v33, v32 offset:6964
    s_waitcnt lgkmcnt(0)
    v_readfirstlane_b32 s42, v33
    s_nop 0
    s_cmp_ge_u32 s42, 4
    s_cbranch_scc1 L_spun59
    s_sleep 1
    s_branch L_spin58
L_spun59:
    s_mov_b64 exec, 0x1111
L_tpre:
    buffer_load_dword v32, v30, s[32:35], s40 offen offset:12 sc1
    s_waitcnt vmcnt(0)
    v_xor_b32 v32, v32, v38
    v_and_b32 v32, 0xfffe, v32
    v_cmp_ne_u32 vcc, 0, v32
    s_cbranch_vccnz L_tpre
    s_mov_b64 exec, -1
    s_nop 2
L_tpoll:
    s_add_u32 s42, s40, 0
    s_cmp_eq_u64 s[44:45], 0
    s_cbranch_scc1 L_tskip60
    s_mov_b64 exec, s[44:45]
    buffer_load_dwordx4 v[40:43], v30, s[32:35], s42 offen sc1
L_tskip60:
    s_add_u32 s42, s40, 0x2000
    s_cmp_eq_u64 s[46:47], 0
    s_cbranch_scc1 L_tskip61
    s_mov_b64 exec, s[46:47]
    buffer_load_dwordx4 v[44:47], v30, s[32:35], s42 offen sc1
L_tskip61:
    s_add_u32 s42, s40, 0x4000
    s_cmp_eq_u64 s[58:59], 0
    s_cbranch_scc1 L_tskip62
    s_mov_b64 exec, s[58:59]
    buffer_load_dwordx4 v[48:51], v30, s[32:35], s42 offen sc1
L_tskip62:
    s_add_u32 s42, s40, 0x6000
    s_cmp_eq_u64 s[60:61], 0
    s_cbranch_scc1 L_tskip63
    s_mov_b64 exec, s[60:61]
    buffer_load_dwordx4 v[52:55], v30, s[32:35], s42 offen sc1
L_tskip63:
    s_waitcnt vmcnt(0)
    s_cmp_eq_u64 s[44:45], 0
    s_cbranch_scc1 L_tchk64
    s_mov_b64 exec, s[44:45]
    v_xor_b32 v36, v43, v38
    v_and_b32 v32, 0xfffe, v36
    v_and_b32 v33, 0xffff0000, v43
    s_nop 2
    v_or_b32_dpp v32, v32, v32 quad_perm:[1,0,3,2] row_mask:0xf bank_mask:0xf
    s_nop 2
    v_or_b32_dpp v32, v32, v32 quad_perm:[2,3,0,1] row_mask:0xf bank_mask:0xf
    v_cmp_eq_u32 vcc, 0, v32
    s_nop 0
    s_andn2_b64 s[44:45], s[44:45], vcc
    s_and_b64 exec, vcc, vcc
    s_cbranch_scc0 L_tchk64
    v_dot2_f32_bf16 v60, v40, s38, v60
    v_dot2_f32_bf16 v61, v40, s39, v61
    v_dot2_f32_bf16 v62, v41, s38, v62
    v_dot2_f32_bf16 v63, v41, s39, v63
    v_dot2_f32_bf16 v64, v42, s38, v64
    v_dot2_f32_bf16 v65, v42, s39, v65
    v_add_f32 v66, v66, v33
    v_or_b32 v37, v37, v36
L_tchk64:
    s_cmp_eq_u64 s[46:47], 0
    s_cbranch_scc1 L_tchk65
    s_mov_b64 exec, s[46:47]
    v_xor_b32 v36, v47, v38
    v_and_b32 v32, 0xfffe, v36
    v_and_b32 v33, 0xffff0000, v47
    s_nop 2
    v_or_b32_dpp v32, v32, v32 quad_perm:[1,0,3,2] row_mask:0xf bank_mask:0xf
    s_nop 2
    v_or_b32_dpp v32, v32, v32 quad_perm:[2,3,0,1] row_mask:0xf bank_mask:0xf
    v_cmp_eq_u32 vcc, 0, v32
    s_nop 0
    s_andn2_b64 s[46:47], s[46:47], vcc
    s_and_b64 exec, vcc, vcc
    s_cbranch_scc0 L_tchk65
    v_dot2_f32_bf16 v60, v44, s38, v60
    v_dot2_f32_bf16 v61, v44, s39, v61
    v_dot2_f32_bf16 v62, v45, s38, v62
    v_dot2_f32_bf16 v63, v45, s39, v63
    v_dot2_f32_bf16 v64, v46, s38, v64
    v_dot2_f32_bf16 v65, v46, s39, v65
    v_add_f32 v66, v66, v33
    v_or_b32 v37, v37, v36
L_tchk65:
    s_cmp_eq_u64 s[58:59], 0
    s_cbranch_scc1 L_tchk66
    s_mov_b64 exec, s[58:59]
    v_xor_b32 v36, v51, v38
    v_and_b32 v32, 0xfffe, v36
    v_and_b32 v33, 0xffff0000, v51
    s_nop 2
    v_or_b32_dpp v32, v32, v32 quad_perm:[1,0,3,2] row_mask:0xf bank_mask:0xf
    s_nop 2
    v_or_b32_dpp v32, v32, v32 quad_perm:[2,3,0,1] row_mask:0xf bank_mask:0xf
    v_cmp_eq_u32 vcc, 0, v32
    s_nop 0
    s_andn2_b64 s[58:59], s[58:59], vcc
    s_and_b64 exec, vcc, vcc
    s_cbranch_scc0 L_tchk66
    v_dot2_f32_bf16 v60, v48, s38, v60
    v_dot2_f32_bf16 v61, v48, s39, v61
    v_dot2_f32_bf16 v62, v49, s38, v62
    v_dot2_f32_bf16 v63, v49, s39, v63
    v_dot2_f32_bf16 v64, v50, s38, v64
    v_dot2_f32_bf16 v65, v50, s39, v65
    v_add_f32 v66, v66, v33
    v_or_b32 v37, v37, v36
L_tchk66:
    s_cmp_eq_u64 s[60:61], 0
    s_cbranch_scc1 L_tchk67
    s_mov_b64 exec, s[60:61]
    v_xor_b32 v36, v55, v38
    v_and_b32 v32, 0xfffe, v36
    v_and_b32 v33, 0xffff0000, v55
    s_nop 2
    v_or_b32_dpp v32, v32, v32 quad_perm:[1,0,3,2] row_mask:0xf bank_mask:0xf
    s_nop 2
    v_or_b32_dpp v32, v32, v32 quad_perm:[2,3,0,1] row_mask:0xf bank_mask:0xf
    v_cmp_eq_u32 vcc, 0, v32
    s_nop 0
    s_andn2_b64 s[60:61], s[60:61], vcc
    s_and_b64 exec, vcc, vcc
    s_cbranch_scc0 L_tchk67
    v_dot2_f32_bf16 v60, v52, s38, v60
    v_dot2_f32_bf16 v61, v52, s39, v61
    v_dot2_f32_bf16 v62, v53, s38, v62
    v_dot2_f32_bf16 v63, v53, s39, v63
    v_dot2_f32_bf16 v64, v54, s38, v64
    v_dot2_f32_bf16 v65, v54, s39, v65
    v_add_f32 v66, v66, v33
    v_or_b32 v37, v37, v36
L_tchk67:
    s_mov_b64 exec, -1
    s_or_b64 s[56:57], s[44:45], s[46:47]
    s_or_b64 vcc, s[58:59], s[60:61]
    s_or_b64 s[56:57], s[56:57], vcc
    s_cbranch_scc0 L_tfull
    s_mov_b32 s54, 0
    s_bcnt1_i32_b64 s42, s[60:61]
    s_cselect_b32 s55, 0x6000, s55
    s_cselect_b64 s[56:57], s[60:61], s[56:57]
    s_add_u32 s54, s54, s42
    s_bcnt1_i32_b64 s42, s[58:59]
    s_cselect_b32 s55, 0x4000, s55
    s_cselect_b64 s[56:57], s[58:59], s[56:57]
    s_add_u32 s54, s54, s42
    s_bcnt1_i32_b64 s42, s[46:47]
    s_cselect_b32 s55, 0x2000, s55
    s_cselect_b64 s[56:57], s[46:47], s[56:57]
    s_add_u32 s54, s54, s42
    s_bcnt1_i32_b64 s42, s[44:45]
    s_cselect_b32 s55, 0, s55
    s_cselect_b64 s[56:57], s[44:45], s[56:57]
    s_add_u32 s54, s54, s42
    s_cmp_le_u32 s54, 32
    s_cbranch_scc1 L_tpoll
    s_ff1_i32_b64 s42, s[56:57]
    s_lshl_b64 exec, 1, s42
    s_add_u32 s55, s55, s40
L_tprobe:
    buffer_load_dword v32, v30, s[32:35], s55 offen offset:12 sc1
    s_waitcnt vmcnt(0)
    v_xor_b32 v32, v32, v38
    v_and_b32 v32, 0xfffe, v32
    v_cmp_ne_u32 vcc, 0, v32
    s_cbranch_vccnz L_tprobe
    s_mov_b64 exec, -1
    s_branch L_tpoll
    s_nop 1
L_tfull:
    v_and_b32 v32, 1, v37
    v_cmp_ne_u32 vcc, 0, v32
    s_cbranch_vccnz L_tgen
    s_nop 3
L_trows:
    v_add_f32_dpp v60, v60, v60 row_ror:4 row_mask:0xf bank_mask:0xf
    v_add_f32_dpp v61, v61, v61 row_ror:4 row_mask:0xf bank_mask:0xf
    v_add_f32_dpp v62, v62, v62 row_ror:4 row_mask:0xf bank_mask:0xf
    v_add_f32_dpp v63, v63, v63 row_ror:4 row_mask:0xf bank_mask:0xf
    v_add_f32_dpp v64, v64, v64 row_ror:4 row_mask:0xf bank_mask:0xf
    v_add_f32_dpp v65, v65, v65 row_ror:4 row_mask:0xf bank_mask:0xf
    v_add_f32_dpp v66, v66, v66 row_ror:4 row_mask:0xf bank_mask:0xf
    v_add_f32_dpp v60, v60, v60 row_ror:8 row_mask:0xf bank_mask:0xf
    v_add_f32_dpp v61, v61, v61 row_ror:8 row_mask:0xf bank_mask:0xf
    v_add_f32_dpp v62, v62, v62 row_ror:8 row_mask:0xf bank_mask:0xf
    v_add_f32_dpp v63, v63, v63 row_ror:8 row_mask:0xf bank_mask:0xf
    v_add_f32_dpp v64, v64, v64 row_ror:8 row_mask:0xf bank_mask:0xf
    v_add_f32_dpp v65, v65, v65 row_ror:8 row_mask:0xf bank_mask:0xf
    v_add_f32_dpp v66, v66, v66 row_ror:8 row_mask:0xf bank_mask:0xf
    s_mov_b32 s46, 0xf000f
    s_mov_b32 s47, 0xf000f
    s_mov_b64 exec, s[46:47]
    ds_write_b128 v34, v[60:63]
    ds_write_b128 v34, v[64:67] offset:16
    s_mov_b64 exec, -1
    s_waitcnt lgkmcnt(0)
    s_barrier
    s_cmp_lg_u32 s3, 0
    s_cbranch_scc1 L_r_end
    ds_read_b128 v[84:87], v35 offset:37904
    ds_read_b128 v[92:95], v35 offset:38416
    ds_read_b128 v[100:103], v35 offset:38928
    ds_read_b128 v[108:111], v35 offset:39440
    ds_read_b128 v[80:83], v35 offset:37888
    ds_read_b128 v[88:91], v35 offset:38400
    ds_read_b128 v[96:99], v35 offset:38912
    ds_read_b128 v[104:107], v35 offset:39424
    s_waitcnt lgkmcnt(4)
    v_or3_b32 v32, v87, v95, v103
    v_or_b32 v32, v32, v111
    v_cmp_ne_u32 vcc, 0, v32
    s_cbranch_vccnz L_fgen
    s_nop 3
L_fsum:
    v_pk_add_f32 v[66:67], v[86:87], v[94:95]
    v_pk_add_f32 v[102:103], v[102:103], v[110:111]
    v_pk_add_f32 v[64:65], v[84:85], v[92:93]
    v_pk_add_f32 v[100:101], v[100:101], v[108:109]
    s_waitcnt lgkmcnt(0)
    v_pk_add_f32 v[60:61], v[80:81], v[88:89]
    v_pk_add_f32 v[96:97], v[96:97], v[104:105]
    v_pk_add_f32 v[62:63], v[82:83], v[90:91]
    v_pk_add_f32 v[98:99], v[98:99], v[106:107]
    v_pk_add_f32 v[66:67], v[66:67], v[102:103]
    v_pk_add_f32 v[64:65], v[64:65], v[100:101]
    v_pk_add_f32 v[60:61], v[60:61], v[96:97]
    v_pk_add_f32 v[62:63], v[62:63], v[98:99]
    v_add_f32_dpp v66, v66, v66 row_ror:4 row_mask:0xf bank_mask:0xf
    v_add_f32_dpp v60, v60, v60 row_ror:4 row_mask:0xf bank_mask:0xf
    v_add_f32_dpp v61, v61, v61 row_ror:4 row_mask:0xf bank_mask:0xf
    v_add_f32_dpp v62, v62, v62 row_ror:4 row_mask:0xf bank_mask:0xf
    v_add_f32_dpp v63, v63, v63 row_ror:4 row_mask:0xf bank_mask:0xf
    v_add_f32_dpp v64, v64, v64 row_ror:4 row_mask:0xf bank_mask:0xf
    v_add_f32_dpp v65, v65, v65 row_ror:4 row_mask:0xf bank_mask:0xf
    v_add_f32_dpp v66, v66, v66 row_ror:8 row_mask:0xf bank_mask:0xf
    v_add_f32_dpp v60, v60, v60 row_ror:8 row_mask:0xf bank_mask:0xf
    v_add_f32_dpp v61, v61, v61 row_ror:8 row_mask:0xf bank_mask:0xf
    v_rcp_f32 v66, v66
    v_add_f32_dpp v62, v62, v62 row_ror:8 row_mask:0xf bank_mask:0xf
    v_add_f32_dpp v63, v63, v63 row_ror:8 row_mask:0xf bank_mask:0xf
    v_add_f32_dpp v64, v64, v64 row_ror:8 row_mask:0xf bank_mask:0xf
    v_add_f32_dpp v65, v65, v65 row_ror:8 row_mask:0xf bank_mask:0xf
    v_pk_mul_f32 v[60:61], v[60:61], v[66:67] op_sel_hi:[1,0]
    v_pk_mul_f32 v[62:63], v[62:63], v[66:67] op_sel_hi:[1,0]
    v_pk_mul_f32 v[64:65], v[64:65], v[66:67] op_sel_hi:[1,0]
    v_cvt_pk_bf16_f32 v56, v60, v61
    v_cvt_pk_bf16_f32 v57, v62, v63
    v_cvt_pk_bf16_f32 v58, v64, v65
    v_lshlrev_b32 v60, 16, v56
    v_and_b32 v61, 0xffff0000, v56
    v_lshlrev_b32 v62, 16, v57
    v_and_b32 v63, 0xffff0000, v57
    v_lshlrev_b32 v64, 16, v58
    v_and_b32 v65, 0xffff0000, v58
    v_pk_add_f32 v[60:61], v[60:61], v[120:121]
    v_pk_add_f32 v[62:63], v[62:63], v[122:123]
    v_pk_add_f32 v[64:65], v[64:65], v[124:125]
    s_mov_b64 exec, 15
    v_cvt_pk_bf16_f32 v56, v60, v61
    buffer_store_dword v56, v31, s[28:31], s4 offen
    v_cvt_pk_bf16_f32 v57, v62, v63
    buffer_store_dword v57, v31, s[28:31], s5 offen
    v_cvt_pk_bf16_f32 v58, v64, v65
    buffer_store_dword v58, v31, s[28:31], s6 offen
    s_mov_b64 exec, -1
L_r_end:
    s_endpgm
L_tgen:
    s_nop 3
    v_mov_b32 v32, 0
    ds_read_b64 v[72:73], v32 offset:7040
    v_lshlrev_b32 v71, 9, v29
    v_lshl_add_u32 v71, v28, 3, v71
    s_and_b32 s42, s53, 3
    s_lshl_b32 s42, s42, 5
    s_lshl_b32 s55, s3, 13
    s_add_u32 s55, s55, s42
    s_add_u32 s55, s55, 0x30000
    s_waitcnt lgkmcnt(0)
    v_lshl_or_b32 v70, v73, 16, v72
    v_mov_b32 v112, 0
    v_and_b32 v32, 1, v43
    v_cmp_ne_u32 vcc, 0, v32
    s_nop 0
    s_and_b64 exec, vcc, vcc
    s_cbranch_scc0 L_tg0e
    s_nop 1
L_tg0:
    buffer_load_dwordx2 v[112:113], v71, s[32:35], s55 offen sc1
    s_waitcnt vmcnt(0)
    v_cmp_ne_u32 vcc, v113, v70
    s_cbranch_vccnz L_tg0
L_tg0e:
    s_mov_b64 exec, -1
    v_mov_b32 v114, 0
    v_and_b32 v32, 1, v47
    v_cmp_ne_u32 vcc, 0, v32
    s_nop 0
    s_and_b64 exec, vcc, vcc
    s_cbranch_scc0 L_tg1e
    s_nop 1
L_tg1:
    buffer_load_dwordx2 v[114:115], v71, s[32:35], s55 offen offset:128 sc1
    s_waitcnt vmcnt(0)
    v_cmp_ne_u32 vcc, v115, v70
    s_cbranch_vccnz L_tg1
L_tg1e:
    s_mov_b64 exec, -1
    v_mov_b32 v116, 0
    v_and_b32 v32, 1, v51
    v_cmp_ne_u32 vcc, 0, v32
    s_nop 0
    s_and_b64 exec, vcc, vcc
    s_cbranch_scc0 L_tg2e
    s_nop 1
L_tg2:
    buffer_load_dwordx2 v[116:117], v71, s[32:35], s55 offen offset:256 sc1
    s_waitcnt vmcnt(0)
    v_cmp_ne_u32 vcc, v117, v70
    s_cbranch_vccnz L_tg2
L_tg2e:
    s_mov_b64 exec, -1
    v_mov_b32 v118, 0
    v_and_b32 v32, 1, v55
    v_cmp_ne_u32 vcc, 0, v32
    s_nop 0
    s_and_b64 exec, vcc, vcc
    s_cbranch_scc0 L_tg3e
    s_nop 1
L_tg3:
    buffer_load_dwordx2 v[118:119], v71, s[32:35], s55 offen offset:384 sc1
    s_waitcnt vmcnt(0)
    v_cmp_ne_u32 vcc, v119, v70
    s_cbranch_vccnz L_tg3
L_tg3e:
    s_mov_b64 exec, -1
    v_max3_f32 v67, v112, v114, v116
    v_max_f32 v67, v67, v118
    s_nop 1
    v_max_f32_dpp v67, v67, v67 row_ror:4 row_mask:0xf bank_mask:0xf
    s_nop 1
    v_max_f32_dpp v67, v67, v67 row_ror:8 row_mask:0xf bank_mask:0xf
    v_mov_b32 v32, v67
    v_mov_b32 v33, v67
    s_nop 1
    v_permlane32_swap_b32 v32, v33
    v_max_f32 v67, v32, v33
    v_mov_b32 v32, v67
    v_mov_b32 v33, v67
    s_nop 1
    v_permlane16_swap_b32 v32, v33
    v_max_f32 v67, v32, v33
    v_mov_b32 v60, 0
    v_mov_b32 v61, 0
    v_mov_b32 v62, 0
    v_mov_b32 v63, 0
    v_mov_b32 v64, 0
    v_mov_b32 v65, 0
    v_mov_b32 v66, 0
    v_sub_f32 v36, v112, v67
    v_exp_f32 v36, v36
    v_lshlrev_b32 v32, 16, v40
    v_fmac_f32 v60, v36, v32
    v_and_b32 v32, 0xffff0000, v40
    v_fmac_f32 v61, v36, v32
    v_lshlrev_b32 v32, 16, v41
    v_fmac_f32 v62, v36, v32
    v_and_b32 v32, 0xffff0000, v41
    v_fmac_f32 v63, v36, v32
    v_lshlrev_b32 v32, 16, v42
    v_fmac_f32 v64, v36, v32
    v_and_b32 v32, 0xffff0000, v42
    v_fmac_f32 v65, v36, v32
    v_and_b32 v32, 0xffff0000, v43
    v_fmac_f32 v66, v36, v32
    v_sub_f32 v36, v114, v67
    v_exp_f32 v36, v36
    v_lshlrev_b32 v32, 16, v44
    v_fmac_f32 v60, v36, v32
    v_and_b32 v32, 0xffff0000, v44
    v_fmac_f32 v61, v36, v32
    v_lshlrev_b32 v32, 16, v45
    v_fmac_f32 v62, v36, v32
    v_and_b32 v32, 0xffff0000, v45
    v_fmac_f32 v63, v36, v32
    v_lshlrev_b32 v32, 16, v46
    v_fmac_f32 v64, v36, v32
    v_and_b32 v32, 0xffff0000, v46
    v_fmac_f32 v65, v36, v32
    v_and_b32 v32, 0xffff0000, v47
    v_fmac_f32 v66, v36, v32
    v_sub_f32 v36, v116, v67
    v_exp_f32 v36, v36
    v_lshlrev_b32 v32, 16, v48
    v_fmac_f32 v60, v36, v32
    v_and_b32 v32, 0xffff0000, v48
    v_fmac_f32 v61, v36, v32
    v_lshlrev_b32 v32, 16, v49
    v_fmac_f32 v62, v36, v32
    v_and_b32 v32, 0xffff0000, v49
    v_fmac_f32 v63, v36, v32
    v_lshlrev_b32 v32, 16, v50
    v_fmac_f32 v64, v36, v32
    v_and_b32 v32, 0xffff0000, v50
    v_fmac_f32 v65, v36, v32
    v_and_b32 v32, 0xffff0000, v51
    v_fmac_f32 v66, v36, v32
    v_sub_f32 v36, v118, v67
    v_exp_f32 v36, v36
    v_lshlrev_b32 v32, 16, v52
    v_fmac_f32 v60, v36, v32
    v_and_b32 v32, 0xffff0000, v52
    v_fmac_f32 v61, v36, v32
    v_lshlrev_b32 v32, 16, v53
    v_fmac_f32 v62, v36, v32
    v_and_b32 v32, 0xffff0000, v53
    v_fmac_f32 v63, v36, v32
    v_lshlrev_b32 v32, 16, v54
    v_fmac_f32 v64, v36, v32
    v_and_b32 v32, 0xffff0000, v54
    v_fmac_f32 v65, v36, v32
    v_and_b32 v32, 0xffff0000, v55
    v_fmac_f32 v66, v36, v32
    s_nop 1
    s_branch L_trows
L_fgen:
    s_waitcnt lgkmcnt(0)
    v_max3_f32 v67, v87, v95, v103
    v_max_f32 v67, v67, v111
    v_sub_f32 v32, v87, v67
    v_exp_f32 v32, v32
    s_nop 0
    v_mul_f32 v80, v80, v32
    v_mul_f32 v81, v81, v32
    v_mul_f32 v82, v82, v32
    v_mul_f32 v83, v83, v32
    v_mul_f32 v84, v84, v32
    v_mul_f32 v85, v85, v32
    v_mul_f32 v86, v86, v32
    v_sub_f32 v32, v95, v67
    v_exp_f32 v32, v32
    s_nop 0
    v_mul_f32 v88, v88, v32
    v_mul_f32 v89, v89, v32
    v_mul_f32 v90, v90, v32
    v_mul_f32 v91, v91, v32
    v_mul_f32 v92, v92, v32
    v_mul_f32 v93, v93, v32
    v_mul_f32 v94, v94, v32
    v_sub_f32 v32, v103, v67
    v_exp_f32 v32, v32
    s_nop 0
    v_mul_f32 v96, v96, v32
    v_mul_f32 v97, v97, v32
    v_mul_f32 v98, v98, v32
    v_mul_f32 v99, v99, v32
    v_mul_f32 v100, v100, v32
    v_mul_f32 v101, v101, v32
    v_mul_f32 v102, v102, v32
    v_sub_f32 v32, v111, v67
    v_exp_f32 v32, v32
    s_nop 0
    v_mul_f32 v104, v104, v32
    v_mul_f32 v105, v105, v32
    v_mul_f32 v106, v106, v32
    v_mul_f32 v107, v107, v32
    v_mul_f32 v108, v108, v32
    v_mul_f32 v109, v109, v32
    v_mul_f32 v110, v110, v32
    s_nop 1
    s_branch L_fsum
L_qkprod:
    s_getpc_b64 s[28:29]
    s_mov_b32 s30, 0x1000
    s_mov_b32 s31, 0x20000
    v_lshlrev_b32 v31, 6, v0
    buffer_load_dword v50, v31, s[28:31], 0 offen
    v_and_b32 v28, 15, v0
    v_lshrrev_b32 v29, 4, v0
    v_mov_b32 v30, 0
    v_lshlrev_b32 v47, 4, v0
    v_add_u32 v47, 0, v47
    v_mul_u32_u24 v31, 0x180, v28
    v_and_b32 v32, 1, v29
    v_lshl_add_u32 v31, v32, 3, v31
    v_add_u32 v31, 0x1c00, v31
    v_lshrrev_b32 v32, 1, v29
    v_and_b32 v37, 6, v28
    v_xor_b32 v32, v32, v37
    v_xor_b32 v34, 0, v32
    v_lshl_add_u32 v34, v34, 4, v31
    v_xor_b32 v35, 2, v32
    v_lshl_add_u32 v35, v35, 4, v31
    v_xor_b32 v36, 4, v32
    v_lshl_add_u32 v36, v36, 4, v31
    v_xor_b32 v37, 6, v32
    v_lshl_add_u32 v37, v37, 4, v31
    v_lshrrev_b32 v31, 2, v28
    v_lshl_add_u32 v31, v29, 2, v31
    v_and_b32 v32, 6, v31
    v_mul_u32_u24 v31, 0x180, v31
    v_and_b32 v41, 3, v28
    v_lshl_add_u32 v31, v41, 3, v31
    s_mul_i32 s53, s3, 3
    s_add_u32 s53, s53, 0
    s_and_b32 s40, s53, 3
    s_lshl_b32 s40, s40, 1
    v_xor_b32 v38, s40, v32
    v_lshl_add_u32 v38, v38, 4, v31
    s_lshr_b32 s40, s53, 2
    s_lshl_b32 s40, s40, 7
    s_add_u32 s40, s40, 0x6400
    v_add_u32 v38, s40, v38
    v_add_u32 v41, 0x12000, v38
    s_lshr_b32 s40, s53, 1
    s_lshl_b32 s40, s40, 10
    s_and_b32 s42, s53, 1
    s_lshl_b32 s42, s42, 3
    s_add_u32 s40, s40, s42
    v_add_u32 v44, s40, v47
    s_mul_i32 s53, s3, 3
    s_add_u32 s53, s53, 1
    s_and_b32 s40, s53, 3
    s_lshl_b32 s40, s40, 1
    v_xor_b32 v39, s40, v32
    v_lshl_add_u32 v39, v39, 4, v31
    s_lshr_b32 s40, s53, 2
    s_lshl_b32 s40, s40, 7
    s_add_u32 s40, s40, 0x6400
    v_add_u32 v39, s40, v39
    v_add_u32 v42, 0x12000, v39
    s_lshr_b32 s40, s53, 1
    s_lshl_b32 s40, s40, 10
    s_and_b32 s42, s53, 1
    s_lshl_b32 s42, s42, 3
    s_add_u32 s40, s40, s42
    v_add_u32 v45, s40, v47
    s_mul_i32 s53, s3, 3
    s_add_u32 s53, s53, 2
    s_and_b32 s40, s53, 3
    s_lshl_b32 s40, s40, 1
    v_xor_b32 v40, s40, v32
    v_lshl_add_u32 v40, v40, 4, v31
    s_lshr_b32 s40, s53, 2
    s_lshl_b32 s40, s40, 7
    s_add_u32 s40, s40, 0x6400
    v_add_u32 v40, s40, v40
    v_add_u32 v43, 0x12000, v40
    s_lshr_b32 s40, s53, 1
    s_lshl_b32 s40, s40, 10
    s_and_b32 s42, s53, 1
    s_lshl_b32 s42, s42, 3
    s_add_u32 s40, s40, s42
    v_add_u32 v46, s40, v47
    s_nop 1
L_spin68:
    ds_read_b32 v31, v30 offset:6956
    s_waitcnt lgkmcnt(0)
    v_readfirstlane_b32 s40, v31
    s_nop 0
    s_cmp_ge_u32 s40, 1
    s_cbranch_scc1 L_spun69
    s_sleep 1
    s_branch L_spin68
L_spun69:
    ds_read_b64 v[52:53], v34
    ds_read_b64 v[54:55], v35
    ds_read_b64 v[56:57], v36
    ds_read_b64 v[58:59], v37
    ds_read_b64 v[60:61], v34 offset:128
    ds_read_b64 v[62:63], v35 offset:128
    ds_read_b64 v[64:65], v36 offset:128
    ds_read_b64 v[66:67], v37 offset:128
    ds_read_b64 v[68:69], v34 offset:256
    ds_read_b64 v[70:71], v35 offset:256
    ds_read_b64 v[72:73], v36 offset:256
    ds_read_b64 v[74:75], v37 offset:256
    v_mov_b32 v77, 0x3f803f80
    s_waitcnt lgkmcnt(0)
    v_dot2_f32_bf16 v76, v52, v77, 0
    v_dot2_f32_bf16 v80, v52, v52, 0
    v_dot2_f32_bf16 v76, v53, v77, v76
    v_dot2_f32_bf16 v80, v53, v53, v80
    v_dot2_f32_bf16 v76, v54, v77, v76
    v_dot2_f32_bf16 v80, v54, v54, v80
    v_dot2_f32_bf16 v76, v55, v77, v76
    v_dot2_f32_bf16 v80, v55, v55, v80
    v_dot2_f32_bf16 v76, v56, v77, v76
    v_dot2_f32_bf16 v80, v56, v56, v80
    v_dot2_f32_bf16 v76, v57, v77, v76
    v_dot2_f32_bf16 v80, v57, v57, v80
    v_dot2_f32_bf16 v76, v58, v77, v76
    v_dot2_f32_bf16 v80, v58, v58, v80
    v_dot2_f32_bf16 v76, v59, v77, v76
    v_dot2_f32_bf16 v80, v59, v59, v80
    v_dot2_f32_bf16 v76, v60, v77, v76
    v_dot2_f32_bf16 v80, v60, v60, v80
    v_dot2_f32_bf16 v76, v61, v77, v76
    v_dot2_f32_bf16 v80, v61, v61, v80
    v_dot2_f32_bf16 v76, v62, v77, v76
    v_dot2_f32_bf16 v80, v62, v62, v80
    v_dot2_f32_bf16 v76, v63, v77, v76
    v_dot2_f32_bf16 v80, v63, v63, v80
    v_dot2_f32_bf16 v76, v64, v77, v76
    v_dot2_f32_bf16 v80, v64, v64, v80
    v_dot2_f32_bf16 v76, v65, v77, v76
    v_dot2_f32_bf16 v80, v65, v65, v80
    v_dot2_f32_bf16 v76, v66, v77, v76
    v_dot2_f32_bf16 v80, v66, v66, v80
    v_dot2_f32_bf16 v76, v67, v77, v76
    v_dot2_f32_bf16 v80, v67, v67, v80
    v_dot2_f32_bf16 v76, v68, v77, v76
    v_dot2_f32_bf16 v80, v68, v68, v80
    v_dot2_f32_bf16 v76, v69, v77, v76
    v_dot2_f32_bf16 v80, v69, v69, v80
    v_dot2_f32_bf16 v76, v70, v77, v76
    v_dot2_f32_bf16 v80, v70, v70, v80
    v_dot2_f32_bf16 v76, v71, v77, v76
    v_dot2_f32_bf16 v80, v71, v71, v80
    v_dot2_f32_bf16 v76, v72, v77, v76
    v_dot2_f32_bf16 v80, v72, v72, v80
    v_dot2_f32_bf16 v76, v73, v77, v76
    v_dot2_f32_bf16 v80, v73, v73, v80
    v_dot2_f32_bf16 v76, v74, v77, v76
    v_dot2_f32_bf16 v80, v74, v74, v80
    v_dot2_f32_bf16 v76, v75, v77, v76
    v_dot2_f32_bf16 v80, v75, v75, v80
    s_nop 1
    v_mov_b32 v31, v76
    v_mov_b32 v32, v76
    v_mov_b32 v82, v80
    v_mov_b32 v83, v80
    v_permlane32_swap_b32 v31, v32
    s_nop 0
    v_permlane32_swap_b32 v82, v83
    v_add_f32 v76, v31, v32
    v_add_f32 v80, v82, v83
    v_mov_b32 v31, v76
    v_mov_b32 v32, v76
    v_mov_b32 v82, v80
    v_mov_b32 v83, v80
    v_permlane16_swap_b32 v31, v32
    s_nop 0
    v_permlane16_swap_b32 v82, v83
    v_add_f32 v76, v31, v32
    v_add_f32 v80, v82, v83
    v_mul_f32 v78, s44, v76
    v_mul_f32 v80, s44, v80
    v_fma_f32 v80, -v78, v78, v80
    v_max_f32 v80, 0, v80
    v_cvt_pk_bf16_f32 v78, v78, v78
    v_and_b32 v78, 0xffff0000, v78
    v_mov_b32 v79, v78
    v_cvt_pk_bf16_f32 v80, v80, v80
    v_and_b32 v80, 0xffff0000, v80
    v_add_f32 v80, 0x3727c5ac, v80
    v_cvt_pk_bf16_f32 v80, v80, v80
    v_and_b32 v80, 0xffff0000, v80
    v_sqrt_f32 v80, v80
    s_nop 0
    v_cvt_pk_bf16_f32 v80, v80, v80
    v_and_b32 v80, 0xffff0000, v80
    v_rcp_f32 v80, v80
    s_nop 0
    v_mov_b32 v81, v80
    v_lshlrev_b32 v82, 16, v52
    v_and_b32 v83, 0xffff0000, v52
    v_pk_add_f32 v[82:83], v[82:83], v[78:79] neg_lo:[0,1] neg_hi:[0,1]
    v_cvt_pk_bf16_f32 v52, v82, v83
    v_lshlrev_b32 v82, 16, v52
    v_and_b32 v83, 0xffff0000, v52
    v_pk_mul_f32 v[82:83], v[82:83], v[80:81]
    v_cvt_pk_bf16_f32 v52, v82, v83
    v_lshlrev_b32 v84, 16, v53
    v_and_b32 v85, 0xffff0000, v53
    v_pk_add_f32 v[84:85], v[84:85], v[78:79] neg_lo:[0,1] neg_hi:[0,1]
    v_cvt_pk_bf16_f32 v53, v84, v85
    v_lshlrev_b32 v84, 16, v53
    v_and_b32 v85, 0xffff0000, v53
    v_pk_mul_f32 v[84:85], v[84:85], v[80:81]
    v_cvt_pk_bf16_f32 v53, v84, v85
    v_lshlrev_b32 v82, 16, v54
    v_and_b32 v83, 0xffff0000, v54
    v_pk_add_f32 v[82:83], v[82:83], v[78:79] neg_lo:[0,1] neg_hi:[0,1]
    v_cvt_pk_bf16_f32 v54, v82, v83
    v_lshlrev_b32 v82, 16, v54
    v_and_b32 v83, 0xffff0000, v54
    v_pk_mul_f32 v[82:83], v[82:83], v[80:81]
    v_cvt_pk_bf16_f32 v54, v82, v83
    v_lshlrev_b32 v84, 16, v55
    v_and_b32 v85, 0xffff0000, v55
    v_pk_add_f32 v[84:85], v[84:85], v[78:79] neg_lo:[0,1] neg_hi:[0,1]
    v_cvt_pk_bf16_f32 v55, v84, v85
    v_lshlrev_b32 v84, 16, v55
    v_and_b32 v85, 0xffff0000, v55
    v_pk_mul_f32 v[84:85], v[84:85], v[80:81]
    v_cvt_pk_bf16_f32 v55, v84, v85
    v_lshlrev_b32 v82, 16, v56
    v_and_b32 v83, 0xffff0000, v56
    v_pk_add_f32 v[82:83], v[82:83], v[78:79] neg_lo:[0,1] neg_hi:[0,1]
    v_cvt_pk_bf16_f32 v56, v82, v83
    v_lshlrev_b32 v82, 16, v56
    v_and_b32 v83, 0xffff0000, v56
    v_pk_mul_f32 v[82:83], v[82:83], v[80:81]
    v_cvt_pk_bf16_f32 v56, v82, v83
    v_lshlrev_b32 v84, 16, v57
    v_and_b32 v85, 0xffff0000, v57
    v_pk_add_f32 v[84:85], v[84:85], v[78:79] neg_lo:[0,1] neg_hi:[0,1]
    v_cvt_pk_bf16_f32 v57, v84, v85
    v_lshlrev_b32 v84, 16, v57
    v_and_b32 v85, 0xffff0000, v57
    v_pk_mul_f32 v[84:85], v[84:85], v[80:81]
    v_cvt_pk_bf16_f32 v57, v84, v85
    v_lshlrev_b32 v82, 16, v58
    v_and_b32 v83, 0xffff0000, v58
    v_pk_add_f32 v[82:83], v[82:83], v[78:79] neg_lo:[0,1] neg_hi:[0,1]
    v_cvt_pk_bf16_f32 v58, v82, v83
    v_lshlrev_b32 v82, 16, v58
    v_and_b32 v83, 0xffff0000, v58
    v_pk_mul_f32 v[82:83], v[82:83], v[80:81]
    v_cvt_pk_bf16_f32 v58, v82, v83
    v_lshlrev_b32 v84, 16, v59
    v_and_b32 v85, 0xffff0000, v59
    v_pk_add_f32 v[84:85], v[84:85], v[78:79] neg_lo:[0,1] neg_hi:[0,1]
    v_cvt_pk_bf16_f32 v59, v84, v85
    v_lshlrev_b32 v84, 16, v59
    v_and_b32 v85, 0xffff0000, v59
    v_pk_mul_f32 v[84:85], v[84:85], v[80:81]
    v_cvt_pk_bf16_f32 v59, v84, v85
    v_lshlrev_b32 v82, 16, v60
    v_and_b32 v83, 0xffff0000, v60
    v_pk_add_f32 v[82:83], v[82:83], v[78:79] neg_lo:[0,1] neg_hi:[0,1]
    v_cvt_pk_bf16_f32 v60, v82, v83
    v_lshlrev_b32 v82, 16, v60
    v_and_b32 v83, 0xffff0000, v60
    v_pk_mul_f32 v[82:83], v[82:83], v[80:81]
    v_cvt_pk_bf16_f32 v60, v82, v83
    v_lshlrev_b32 v84, 16, v61
    v_and_b32 v85, 0xffff0000, v61
    v_pk_add_f32 v[84:85], v[84:85], v[78:79] neg_lo:[0,1] neg_hi:[0,1]
    v_cvt_pk_bf16_f32 v61, v84, v85
    v_lshlrev_b32 v84, 16, v61
    v_and_b32 v85, 0xffff0000, v61
    v_pk_mul_f32 v[84:85], v[84:85], v[80:81]
    v_cvt_pk_bf16_f32 v61, v84, v85
    v_lshlrev_b32 v82, 16, v62
    v_and_b32 v83, 0xffff0000, v62
    v_pk_add_f32 v[82:83], v[82:83], v[78:79] neg_lo:[0,1] neg_hi:[0,1]
    v_cvt_pk_bf16_f32 v62, v82, v83
    v_lshlrev_b32 v82, 16, v62
    v_and_b32 v83, 0xffff0000, v62
    v_pk_mul_f32 v[82:83], v[82:83], v[80:81]
    v_cvt_pk_bf16_f32 v62, v82, v83
    v_lshlrev_b32 v84, 16, v63
    v_and_b32 v85, 0xffff0000, v63
    v_pk_add_f32 v[84:85], v[84:85], v[78:79] neg_lo:[0,1] neg_hi:[0,1]
    v_cvt_pk_bf16_f32 v63, v84, v85
    v_lshlrev_b32 v84, 16, v63
    v_and_b32 v85, 0xffff0000, v63
    v_pk_mul_f32 v[84:85], v[84:85], v[80:81]
    v_cvt_pk_bf16_f32 v63, v84, v85
    v_lshlrev_b32 v82, 16, v64
    v_and_b32 v83, 0xffff0000, v64
    v_pk_add_f32 v[82:83], v[82:83], v[78:79] neg_lo:[0,1] neg_hi:[0,1]
    v_cvt_pk_bf16_f32 v64, v82, v83
    v_lshlrev_b32 v82, 16, v64
    v_and_b32 v83, 0xffff0000, v64
    v_pk_mul_f32 v[82:83], v[82:83], v[80:81]
    v_cvt_pk_bf16_f32 v64, v82, v83
    v_lshlrev_b32 v84, 16, v65
    v_and_b32 v85, 0xffff0000, v65
    v_pk_add_f32 v[84:85], v[84:85], v[78:79] neg_lo:[0,1] neg_hi:[0,1]
    v_cvt_pk_bf16_f32 v65, v84, v85
    v_lshlrev_b32 v84, 16, v65
    v_and_b32 v85, 0xffff0000, v65
    v_pk_mul_f32 v[84:85], v[84:85], v[80:81]
    v_cvt_pk_bf16_f32 v65, v84, v85
    v_lshlrev_b32 v82, 16, v66
    v_and_b32 v83, 0xffff0000, v66
    v_pk_add_f32 v[82:83], v[82:83], v[78:79] neg_lo:[0,1] neg_hi:[0,1]
    v_cvt_pk_bf16_f32 v66, v82, v83
    v_lshlrev_b32 v82, 16, v66
    v_and_b32 v83, 0xffff0000, v66
    v_pk_mul_f32 v[82:83], v[82:83], v[80:81]
    v_cvt_pk_bf16_f32 v66, v82, v83
    v_lshlrev_b32 v84, 16, v67
    v_and_b32 v85, 0xffff0000, v67
    v_pk_add_f32 v[84:85], v[84:85], v[78:79] neg_lo:[0,1] neg_hi:[0,1]
    v_cvt_pk_bf16_f32 v67, v84, v85
    v_lshlrev_b32 v84, 16, v67
    v_and_b32 v85, 0xffff0000, v67
    v_pk_mul_f32 v[84:85], v[84:85], v[80:81]
    v_cvt_pk_bf16_f32 v67, v84, v85
    v_lshlrev_b32 v82, 16, v68
    v_and_b32 v83, 0xffff0000, v68
    v_pk_add_f32 v[82:83], v[82:83], v[78:79] neg_lo:[0,1] neg_hi:[0,1]
    v_cvt_pk_bf16_f32 v68, v82, v83
    v_lshlrev_b32 v82, 16, v68
    v_and_b32 v83, 0xffff0000, v68
    v_pk_mul_f32 v[82:83], v[82:83], v[80:81]
    v_cvt_pk_bf16_f32 v68, v82, v83
    v_lshlrev_b32 v84, 16, v69
    v_and_b32 v85, 0xffff0000, v69
    v_pk_add_f32 v[84:85], v[84:85], v[78:79] neg_lo:[0,1] neg_hi:[0,1]
    v_cvt_pk_bf16_f32 v69, v84, v85
    v_lshlrev_b32 v84, 16, v69
    v_and_b32 v85, 0xffff0000, v69
    v_pk_mul_f32 v[84:85], v[84:85], v[80:81]
    v_cvt_pk_bf16_f32 v69, v84, v85
    v_lshlrev_b32 v82, 16, v70
    v_and_b32 v83, 0xffff0000, v70
    v_pk_add_f32 v[82:83], v[82:83], v[78:79] neg_lo:[0,1] neg_hi:[0,1]
    v_cvt_pk_bf16_f32 v70, v82, v83
    v_lshlrev_b32 v82, 16, v70
    v_and_b32 v83, 0xffff0000, v70
    v_pk_mul_f32 v[82:83], v[82:83], v[80:81]
    v_cvt_pk_bf16_f32 v70, v82, v83
    v_lshlrev_b32 v84, 16, v71
    v_and_b32 v85, 0xffff0000, v71
    v_pk_add_f32 v[84:85], v[84:85], v[78:79] neg_lo:[0,1] neg_hi:[0,1]
    v_cvt_pk_bf16_f32 v71, v84, v85
    v_lshlrev_b32 v84, 16, v71
    v_and_b32 v85, 0xffff0000, v71
    v_pk_mul_f32 v[84:85], v[84:85], v[80:81]
    v_cvt_pk_bf16_f32 v71, v84, v85
    v_lshlrev_b32 v82, 16, v72
    v_and_b32 v83, 0xffff0000, v72
    v_pk_add_f32 v[82:83], v[82:83], v[78:79] neg_lo:[0,1] neg_hi:[0,1]
    v_cvt_pk_bf16_f32 v72, v82, v83
    v_lshlrev_b32 v82, 16, v72
    v_and_b32 v83, 0xffff0000, v72
    v_pk_mul_f32 v[82:83], v[82:83], v[80:81]
    v_cvt_pk_bf16_f32 v72, v82, v83
    v_lshlrev_b32 v84, 16, v73
    v_and_b32 v85, 0xffff0000, v73
    v_pk_add_f32 v[84:85], v[84:85], v[78:79] neg_lo:[0,1] neg_hi:[0,1]
    v_cvt_pk_bf16_f32 v73, v84, v85
    v_lshlrev_b32 v84, 16, v73
    v_and_b32 v85, 0xffff0000, v73
    v_pk_mul_f32 v[84:85], v[84:85], v[80:81]
    v_cvt_pk_bf16_f32 v73, v84, v85
    v_lshlrev_b32 v82, 16, v74
    v_and_b32 v83, 0xffff0000, v74
    v_pk_add_f32 v[82:83], v[82:83], v[78:79] neg_lo:[0,1] neg_hi:[0,1]
    v_cvt_pk_bf16_f32 v74, v82, v83
    v_lshlrev_b32 v82, 16, v74
    v_and_b32 v83, 0xffff0000, v74
    v_pk_mul_f32 v[82:83], v[82:83], v[80:81]
    v_cvt_pk_bf16_f32 v74, v82, v83
    v_lshlrev_b32 v84, 16, v75
    v_and_b32 v85, 0xffff0000, v75
    v_pk_add_f32 v[84:85], v[84:85], v[78:79] neg_lo:[0,1] neg_hi:[0,1]
    v_cvt_pk_bf16_f32 v75, v84, v85
    v_lshlrev_b32 v84, 16, v75
    v_and_b32 v85, 0xffff0000, v75
    v_pk_mul_f32 v[84:85], v[84:85], v[80:81]
    v_cvt_pk_bf16_f32 v75, v84, v85
    s_nop 1
L_spin70:
    ds_read_b32 v31, v30 offset:6956
    s_waitcnt lgkmcnt(0)
    v_readfirstlane_b32 s40, v31
    s_nop 0
    s_cmp_ge_u32 s40, 2
    s_cbranch_scc1 L_spun71
    s_sleep 1
    s_branch L_spin70
L_spun71:
    s_waitcnt vmcnt(0)
    ds_read_b64_tr_b16 v[100:101], v38
    ds_read_b64_tr_b16 v[102:103], v38 offset:6144
    ds_read_b64_tr_b16 v[104:105], v39
    ds_read_b64_tr_b16 v[106:107], v39 offset:6144
    ds_read_b64_tr_b16 v[108:109], v40
    ds_read_b64_tr_b16 v[110:111], v40 offset:6144
    ds_read_b64_tr_b16 v[112:113], v38 offset:12288
    ds_read_b64_tr_b16 v[114:115], v38 offset:18432
    ds_read_b64_tr_b16 v[116:117], v39 offset:12288
    ds_read_b64_tr_b16 v[118:119], v39 offset:18432
    ds_read_b64_tr_b16 v[120:121], v40 offset:12288
    ds_read_b64_tr_b16 v[122:123], v40 offset:18432
    ds_read_b64_tr_b16 v[124:125], v38 offset:36864
    ds_read_b64_tr_b16 v[126:127], v38 offset:43008
    ds_read_b64_tr_b16 v[128:129], v39 offset:36864
    ds_read_b64_tr_b16 v[130:131], v39 offset:43008
    ds_read_b64_tr_b16 v[132:133], v40 offset:36864
    ds_read_b64_tr_b16 v[134:135], v40 offset:43008
    s_waitcnt lgkmcnt(12)
    v_mfma_f32_16x16x32_bf16 v[88:91], v[100:103], v[52:55], 0
    v_mfma_f32_16x16x32_bf16 v[92:95], v[104:107], v[52:55], 0
    v_mfma_f32_16x16x32_bf16 v[96:99], v[108:111], v[52:55], 0
    ds_read_b64_tr_b16 v[136:137], v38 offset:49152
    ds_read_b64_tr_b16 v[138:139], v38 offset:55296
    ds_read_b64_tr_b16 v[140:141], v39 offset:49152
    ds_read_b64_tr_b16 v[142:143], v39 offset:55296
    ds_read_b64_tr_b16 v[144:145], v40 offset:49152
    ds_read_b64_tr_b16 v[146:147], v40 offset:55296
    s_waitcnt lgkmcnt(12)
    v_mfma_f32_16x16x32_bf16 v[88:91], v[112:115], v[56:59], v[88:91]
    v_mfma_f32_16x16x32_bf16 v[92:95], v[116:119], v[56:59], v[92:95]
    v_mfma_f32_16x16x32_bf16 v[96:99], v[120:123], v[56:59], v[96:99]
    ds_read_b64_tr_b16 v[148:149], v41
    ds_read_b64_tr_b16 v[150:151], v41 offset:6144
    ds_read_b64_tr_b16 v[152:153], v42
    ds_read_b64_tr_b16 v[154:155], v42 offset:6144
    ds_read_b64_tr_b16 v[156:157], v43
    ds_read_b64_tr_b16 v[158:159], v43 offset:6144
    s_waitcnt lgkmcnt(12)
    v_mfma_f32_16x16x32_bf16 v[88:91], v[124:127], v[60:63], v[88:91]
    v_mfma_f32_16x16x32_bf16 v[92:95], v[128:131], v[60:63], v[92:95]
    v_mfma_f32_16x16x32_bf16 v[96:99], v[132:135], v[60:63], v[96:99]
    ds_read_b64_tr_b16 v[160:161], v41 offset:12288
    ds_read_b64_tr_b16 v[162:163], v41 offset:18432
    ds_read_b64_tr_b16 v[164:165], v42 offset:12288
    ds_read_b64_tr_b16 v[166:167], v42 offset:18432
    ds_read_b64_tr_b16 v[168:169], v43 offset:12288
    ds_read_b64_tr_b16 v[170:171], v43 offset:18432
    s_waitcnt lgkmcnt(12)
    v_mfma_f32_16x16x32_bf16 v[88:91], v[136:139], v[64:67], v[88:91]
    v_mfma_f32_16x16x32_bf16 v[92:95], v[140:143], v[64:67], v[92:95]
    v_mfma_f32_16x16x32_bf16 v[96:99], v[144:147], v[64:67], v[96:99]
    s_waitcnt lgkmcnt(6)
    v_mfma_f32_16x16x32_bf16 v[88:91], v[148:151], v[68:71], v[88:91]
    v_mfma_f32_16x16x32_bf16 v[92:95], v[152:155], v[68:71], v[92:95]
    v_mfma_f32_16x16x32_bf16 v[96:99], v[156:159], v[68:71], v[96:99]
    s_waitcnt lgkmcnt(0)
    v_mfma_f32_16x16x32_bf16 v[88:91], v[160:163], v[72:75], v[88:91]
    v_mfma_f32_16x16x32_bf16 v[92:95], v[164:167], v[72:75], v[92:95]
    v_mfma_f32_16x16x32_bf16 v[96:99], v[168:171], v[72:75], v[96:99]
    s_nop 5
    v_cvt_pk_bf16_f32 v76, v88, v89
    v_cvt_pk_bf16_f32 v77, v90, v91
    ds_write_b64 v44, v[76:77]
    v_cvt_pk_bf16_f32 v78, v92, v93
    v_cvt_pk_bf16_f32 v79, v94, v95
    ds_write_b64 v45, v[78:79]
    v_cvt_pk_bf16_f32 v80, v96, v97
    v_cvt_pk_bf16_f32 v81, v98, v99
    ds_write_b64 v46, v[80:81]
    v_mov_b32 v31, 1
    s_mov_b64 exec, 1
    ds_add_u32 v30, v31 offset:6948
    s_mov_b64 exec, -1
    s_cmp_ge_u32 s3, 2
    s_cbranch_scc1 L_qkp_done
L_spin72:
    ds_read_b32 v31, v30 offset:6956
    s_waitcnt lgkmcnt(0)
    v_readfirstlane_b32 s40, v31
    s_nop 0
    s_cmp_ge_u32 s40, 3
    s_cbranch_scc1 L_spun73
    s_sleep 1
    s_branch L_spin72
L_spun73:
    s_mul_i32 s40, s3, 0x3000
    s_add_u32 s40, s40, 0x1f800
    v_add_u32 v34, s40, v34
    v_add_u32 v35, s40, v35
    v_add_u32 v36, s40, v36
    v_add_u32 v37, s40, v37
    ds_read_b64 v[100:101], v34
    ds_read_b64 v[102:103], v35
    ds_read_b64 v[104:105], v36
    ds_read_b64 v[106:107], v37
    ds_read_b64 v[108:109], v34 offset:128
    ds_read_b64 v[110:111], v35 offset:128
    ds_read_b64 v[112:113], v36 offset:128
    ds_read_b64 v[114:115], v37 offset:128
    ds_read_b64 v[116:117], v34 offset:256
    ds_read_b64 v[118:119], v35 offset:256
    ds_read_b64 v[120:121], v36 offset:256
    ds_read_b64 v[122:123], v37 offset:256
    ds_read_b64 v[124:125], v34 offset:6144
    ds_read_b64 v[126:127], v35 offset:6144
    ds_read_b64 v[128:129], v36 offset:6144
    ds_read_b64 v[130:131], v37 offset:6144
    ds_read_b64 v[132:133], v34 offset:6272
    ds_read_b64 v[134:135], v35 offset:6272
    ds_read_b64 v[136:137], v36 offset:6272
    ds_read_b64 v[138:139], v37 offset:6272
    ds_read_b64 v[140:141], v34 offset:6400
    ds_read_b64 v[142:143], v35 offset:6400
    ds_read_b64 v[144:145], v36 offset:6400
    ds_read_b64 v[146:147], v37 offset:6400
L_spin74:
    ds_read_b32 v31, v30 offset:6948
    s_waitcnt lgkmcnt(0)
    v_readfirstlane_b32 s40, v31
    s_nop 0
    s_cmp_ge_u32 s40, 4
    s_cbranch_scc1 L_spun75
    s_sleep 1
    s_branch L_spin74
L_spun75:
    ds_read_b128 v[52:55], v47
    ds_read_b128 v[56:59], v47 offset:1024
    ds_read_b128 v[60:63], v47 offset:2048
    ds_read_b128 v[64:67], v47 offset:3072
    ds_read_b128 v[68:71], v47 offset:4096
    ds_read_b128 v[72:75], v47 offset:5120
    s_lshl_b32 s42, s2, 1
    s_add_u32 s42, s42, s3
    s_lshl_b32 s42, s42, 10
    s_add_u32 s42, s42, 0
    v_lshlrev_b32 v33, 4, v0
    s_waitcnt lgkmcnt(5)
    v_mfma_f32_16x16x32_bf16 v[88:91], v[100:103], v[52:55], 0
    v_mfma_f32_16x16x32_bf16 v[92:95], v[124:127], v[52:55], 0
    s_waitcnt lgkmcnt(4)
    v_mfma_f32_16x16x32_bf16 v[88:91], v[104:107], v[56:59], v[88:91]
    v_mfma_f32_16x16x32_bf16 v[92:95], v[128:131], v[56:59], v[92:95]
    s_waitcnt lgkmcnt(3)
    v_mfma_f32_16x16x32_bf16 v[88:91], v[108:111], v[60:63], v[88:91]
    v_mfma_f32_16x16x32_bf16 v[92:95], v[132:135], v[60:63], v[92:95]
    s_waitcnt lgkmcnt(2)
    v_mfma_f32_16x16x32_bf16 v[88:91], v[112:115], v[64:67], v[88:91]
    v_mfma_f32_16x16x32_bf16 v[92:95], v[136:139], v[64:67], v[92:95]
    s_waitcnt lgkmcnt(1)
    v_mfma_f32_16x16x32_bf16 v[88:91], v[116:119], v[68:71], v[88:91]
    v_mfma_f32_16x16x32_bf16 v[92:95], v[140:143], v[68:71], v[92:95]
    s_waitcnt lgkmcnt(0)
    v_mfma_f32_16x16x32_bf16 v[88:91], v[120:123], v[72:75], v[88:91]
    v_mfma_f32_16x16x32_bf16 v[92:95], v[144:147], v[72:75], v[92:95]
    s_nop 7
L_spin76:
    ds_read_b32 v31, v30 offset:6960
    s_waitcnt lgkmcnt(0)
    v_readfirstlane_b32 s40, v31
    s_nop 0
    s_cmp_ge_u32 s40, 1
    s_cbranch_scc1 L_spun77
    s_sleep 1
    s_branch L_spin76
L_spun77:
    s_mov_b32 s40, 0x3dd53b95
    v_mul_f32 v88, s40, v88
    v_mul_f32 v89, s40, v89
    v_mul_f32 v90, s40, v90
    v_mul_f32 v91, s40, v91
    v_cvt_pk_bf16_f32 v76, v88, v89
    v_cvt_pk_bf16_f32 v77, v90, v91
    v_mul_f32 v92, s40, v92
    v_mul_f32 v93, s40, v93
    v_mul_f32 v94, s40, v94
    v_mul_f32 v95, s40, v95
    v_cvt_pk_bf16_f32 v78, v92, v93
    v_cvt_pk_bf16_f32 v79, v94, v95
    v_min_u32 v76, -2, v76
    v_min_u32 v77, -2, v77
    v_min_u32 v78, -2, v78
    v_min_u32 v79, -2, v79
    buffer_store_dwordx4 v[76:79], v33, s[32:35], s42 offen sc1
    s_nop 1
L_qkp_done:
    v_mov_b32 v31, 1
    s_mov_b64 exec, 1
    ds_add_u32 v30, v31 offset:6952
    s_mov_b64 exec, -1
    s_waitcnt lgkmcnt(0)
    s_branch L_c_start
L_wvprod:
    s_getpc_b64 s[28:29]
    s_mov_b32 s30, 0x1000
    s_mov_b32 s31, 0x20000
    v_lshlrev_b32 v148, 6, v0
    buffer_load_dword v156, v148, s[28:31], 0 offen
    v_mov_b32 v150, 0
    v_add_u32 v152, 0x6400, v244
    v_add_u32 v153, 0x6400, v245
    v_add_u32 v154, 0x18400, v244
    v_add_u32 v155, 0x18400, v245
    v_lshrrev_b32 v148, 4, v0
    v_bfe_u32 v149, v0, 2, 2
    v_lshl_add_u32 v148, v148, 3, v149
    v_and_b32 v149, 3, v0
    v_lshlrev_b32 v149, 3, v149
    v_lshl_add_u32 v151, v148, 7, v149
    s_lshl_b32 s40, s3, 5
    s_add_u32 s40, s40, 0x21400
    v_add_u32 v151, s40, v151
    s_nop 1
L_spin78:
    ds_read_b32 v148, v150 offset:6956
    s_waitcnt lgkmcnt(0)
    v_readfirstlane_b32 s40, v148
    s_nop 0
    s_cmp_ge_u32 s40, 1
    s_cbranch_scc1 L_spun79
    s_sleep 1
    s_branch L_spin78
L_spun79:
    ds_read_b64_tr_b16 v[28:29], v151
    ds_read_b64_tr_b16 v[30:31], v151 offset:512
    ds_read_b64_tr_b16 v[32:33], v151 offset:4096
    ds_read_b64_tr_b16 v[34:35], v151 offset:4608
    ds_read_b64_tr_b16 v[36:37], v151 offset:8192
    ds_read_b64_tr_b16 v[38:39], v151 offset:8704
    ds_read_b64_tr_b16 v[40:41], v151 offset:12288
    ds_read_b64_tr_b16 v[42:43], v151 offset:12800
    ds_read_b64_tr_b16 v[44:45], v151 offset:16384
    ds_read_b64_tr_b16 v[46:47], v151 offset:16896
    ds_read_b64_tr_b16 v[48:49], v151 offset:20480
    ds_read_b64_tr_b16 v[50:51], v151 offset:20992
L_spin80:
    ds_read_b32 v148, v150 offset:6956
    s_waitcnt lgkmcnt(0)
    v_readfirstlane_b32 s40, v148
    s_nop 0
    s_cmp_ge_u32 s40, 2
    s_cbranch_scc1 L_spun81
    s_sleep 1
    s_branch L_spin80
L_spun81:
    s_waitcnt vmcnt(0)
    ds_read_b128 v[100:103], v152
    ds_read_b128 v[104:107], v153
    ds_read_b128 v[108:111], v152 offset:128
    ds_read_b128 v[112:115], v153 offset:128
    ds_read_b128 v[116:119], v152 offset:256
    ds_read_b128 v[120:123], v153 offset:256
    s_waitcnt lgkmcnt(5)
    v_mfma_f32_16x16x32_bf16 v[52:55], v[100:103], v[28:31], 0
    ds_read_b128 v[124:127], v152 offset:6144
    s_waitcnt lgkmcnt(5)
    v_mfma_f32_16x16x32_bf16 v[52:55], v[104:107], v[32:35], v[52:55]
    ds_read_b128 v[128:131], v153 offset:6144
    s_waitcnt lgkmcnt(5)
    v_mfma_f32_16x16x32_bf16 v[52:55], v[108:111], v[36:39], v[52:55]
    ds_read_b128 v[132:135], v152 offset:6272
    s_waitcnt lgkmcnt(5)
    v_mfma_f32_16x16x32_bf16 v[52:55], v[112:115], v[40:43], v[52:55]
    ds_read_b128 v[136:139], v153 offset:6272
    s_waitcnt lgkmcnt(5)
    v_mfma_f32_16x16x32_bf16 v[52:55], v[116:119], v[44:47], v[52:55]
    ds_read_b128 v[140:143], v152 offset:6400
    s_waitcnt lgkmcnt(5)
    v_mfma_f32_16x16x32_bf16 v[52:55], v[120:123], v[48:51], v[52:55]
    ds_read_b128 v[144:147], v153 offset:6400
    s_waitcnt lgkmcnt(5)
    v_mfma_f32_16x16x32_bf16 v[56:59], v[124:127], v[28:31], 0
    ds_read_b128 v[100:103], v152 offset:12288
    s_waitcnt lgkmcnt(5)
    v_mfma_f32_16x16x32_bf16 v[56:59], v[128:131], v[32:35], v[56:59]
    ds_read_b128 v[104:107], v153 offset:12288
    s_waitcnt lgkmcnt(5)
    v_mfma_f32_16x16x32_bf16 v[56:59], v[132:135], v[36:39], v[56:59]
    ds_read_b128 v[108:111], v152 offset:12416
    s_waitcnt lgkmcnt(5)
    v_mfma_f32_16x16x32_bf16 v[56:59], v[136:139], v[40:43], v[56:59]
    ds_read_b128 v[112:115], v153 offset:12416
    s_waitcnt lgkmcnt(5)
    v_mfma_f32_16x16x32_bf16 v[56:59], v[140:143], v[44:47], v[56:59]
    ds_read_b128 v[116:119], v152 offset:12544
    s_waitcnt lgkmcnt(5)
    v_mfma_f32_16x16x32_bf16 v[56:59], v[144:147], v[48:51], v[56:59]
    ds_read_b128 v[120:123], v153 offset:12544
    s_waitcnt lgkmcnt(5)
    v_mfma_f32_16x16x32_bf16 v[60:63], v[100:103], v[28:31], 0
    ds_read_b128 v[124:127], v152 offset:18432
    s_waitcnt lgkmcnt(5)
    v_mfma_f32_16x16x32_bf16 v[60:63], v[104:107], v[32:35], v[60:63]
    ds_read_b128 v[128:131], v153 offset:18432
    s_waitcnt lgkmcnt(5)
    v_mfma_f32_16x16x32_bf16 v[60:63], v[108:111], v[36:39], v[60:63]
    ds_read_b128 v[132:135], v152 offset:18560
    s_waitcnt lgkmcnt(5)
    v_mfma_f32_16x16x32_bf16 v[60:63], v[112:115], v[40:43], v[60:63]
    ds_read_b128 v[136:139], v153 offset:18560
    s_waitcnt lgkmcnt(5)
    v_mfma_f32_16x16x32_bf16 v[60:63], v[116:119], v[44:47], v[60:63]
    ds_read_b128 v[140:143], v152 offset:18688
    s_waitcnt lgkmcnt(5)
    v_mfma_f32_16x16x32_bf16 v[60:63], v[120:123], v[48:51], v[60:63]
    ds_read_b128 v[144:147], v153 offset:18688
    s_waitcnt lgkmcnt(5)
    v_mfma_f32_16x16x32_bf16 v[64:67], v[124:127], v[28:31], 0
    ds_read_b128 v[100:103], v152 offset:36864
    s_waitcnt lgkmcnt(5)
    v_mfma_f32_16x16x32_bf16 v[64:67], v[128:131], v[32:35], v[64:67]
    ds_read_b128 v[104:107], v153 offset:36864
    s_waitcnt lgkmcnt(5)
    v_mfma_f32_16x16x32_bf16 v[64:67], v[132:135], v[36:39], v[64:67]
    ds_read_b128 v[108:111], v152 offset:36992
    s_waitcnt lgkmcnt(5)
    v_mfma_f32_16x16x32_bf16 v[64:67], v[136:139], v[40:43], v[64:67]
    ds_read_b128 v[112:115], v153 offset:36992
    s_waitcnt lgkmcnt(5)
    v_mfma_f32_16x16x32_bf16 v[64:67], v[140:143], v[44:47], v[64:67]
    ds_read_b128 v[116:119], v152 offset:37120
    s_waitcnt lgkmcnt(5)
    v_mfma_f32_16x16x32_bf16 v[64:67], v[144:147], v[48:51], v[64:67]
    ds_read_b128 v[120:123], v153 offset:37120
    s_waitcnt lgkmcnt(5)
    v_mfma_f32_16x16x32_bf16 v[68:71], v[100:103], v[28:31], 0
    ds_read_b128 v[124:127], v152 offset:43008
    s_waitcnt lgkmcnt(5)
    v_mfma_f32_16x16x32_bf16 v[68:71], v[104:107], v[32:35], v[68:71]
    ds_read_b128 v[128:131], v153 offset:43008
    s_waitcnt lgkmcnt(5)
    v_mfma_f32_16x16x32_bf16 v[68:71], v[108:111], v[36:39], v[68:71]
    ds_read_b128 v[132:135], v152 offset:43136
    s_waitcnt lgkmcnt(5)
    v_mfma_f32_16x16x32_bf16 v[68:71], v[112:115], v[40:43], v[68:71]
    ds_read_b128 v[136:139], v153 offset:43136
    s_waitcnt lgkmcnt(5)
    v_mfma_f32_16x16x32_bf16 v[68:71], v[116:119], v[44:47], v[68:71]
    ds_read_b128 v[140:143], v152 offset:43264
    s_waitcnt lgkmcnt(5)
    v_mfma_f32_16x16x32_bf16 v[68:71], v[120:123], v[48:51], v[68:71]
    ds_read_b128 v[144:147], v153 offset:43264
    s_waitcnt lgkmcnt(5)
    v_mfma_f32_16x16x32_bf16 v[72:75], v[124:127], v[28:31], 0
    ds_read_b128 v[100:103], v152 offset:49152
    s_waitcnt lgkmcnt(5)
    v_mfma_f32_16x16x32_bf16 v[72:75], v[128:131], v[32:35], v[72:75]
    ds_read_b128 v[104:107], v153 offset:49152
    s_waitcnt lgkmcnt(5)
    v_mfma_f32_16x16x32_bf16 v[72:75], v[132:135], v[36:39], v[72:75]
    ds_read_b128 v[108:111], v152 offset:49280
    s_waitcnt lgkmcnt(5)
    v_mfma_f32_16x16x32_bf16 v[72:75], v[136:139], v[40:43], v[72:75]
    ds_read_b128 v[112:115], v153 offset:49280
    s_waitcnt lgkmcnt(5)
    v_mfma_f32_16x16x32_bf16 v[72:75], v[140:143], v[44:47], v[72:75]
    ds_read_b128 v[116:119], v152 offset:49408
    s_waitcnt lgkmcnt(5)
    v_mfma_f32_16x16x32_bf16 v[72:75], v[144:147], v[48:51], v[72:75]
    ds_read_b128 v[120:123], v153 offset:49408
    s_waitcnt lgkmcnt(5)
    v_mfma_f32_16x16x32_bf16 v[76:79], v[100:103], v[28:31], 0
    ds_read_b128 v[124:127], v152 offset:55296
    s_waitcnt lgkmcnt(5)
    v_mfma_f32_16x16x32_bf16 v[76:79], v[104:107], v[32:35], v[76:79]
    ds_read_b128 v[128:131], v153 offset:55296
    s_waitcnt lgkmcnt(5)
    v_mfma_f32_16x16x32_bf16 v[76:79], v[108:111], v[36:39], v[76:79]
    ds_read_b128 v[132:135], v152 offset:55424
    s_waitcnt lgkmcnt(5)
    v_mfma_f32_16x16x32_bf16 v[76:79], v[112:115], v[40:43], v[76:79]
    ds_read_b128 v[136:139], v153 offset:55424
    s_waitcnt lgkmcnt(5)
    v_mfma_f32_16x16x32_bf16 v[76:79], v[116:119], v[44:47], v[76:79]
    ds_read_b128 v[140:143], v152 offset:55552
    s_waitcnt lgkmcnt(5)
    v_mfma_f32_16x16x32_bf16 v[76:79], v[120:123], v[48:51], v[76:79]
    ds_read_b128 v[144:147], v153 offset:55552
    s_nop 6
L_spin82:
    ds_read_b32 v148, v150 offset:6956
    s_waitcnt lgkmcnt(0)
    v_readfirstlane_b32 s40, v148
    s_nop 0
    s_cmp_ge_u32 s40, 3
    s_cbranch_scc1 L_spun83
    s_sleep 1
    s_branch L_spin82
L_spun83:
    s_waitcnt lgkmcnt(5)
    v_mfma_f32_16x16x32_bf16 v[80:83], v[124:127], v[28:31], 0
    ds_read_b128 v[100:103], v154
    s_waitcnt lgkmcnt(5)
    v_mfma_f32_16x16x32_bf16 v[80:83], v[128:131], v[32:35], v[80:83]
    ds_read_b128 v[104:107], v155
    s_waitcnt lgkmcnt(5)
    v_mfma_f32_16x16x32_bf16 v[80:83], v[132:135], v[36:39], v[80:83]
    ds_read_b128 v[108:111], v154 offset:128
    s_waitcnt lgkmcnt(5)
    v_mfma_f32_16x16x32_bf16 v[80:83], v[136:139], v[40:43], v[80:83]
    ds_read_b128 v[112:115], v155 offset:128
    s_waitcnt lgkmcnt(5)
    v_mfma_f32_16x16x32_bf16 v[80:83], v[140:143], v[44:47], v[80:83]
    ds_read_b128 v[116:119], v154 offset:256
    s_waitcnt lgkmcnt(5)
    v_mfma_f32_16x16x32_bf16 v[80:83], v[144:147], v[48:51], v[80:83]
    ds_read_b128 v[120:123], v155 offset:256
    s_waitcnt lgkmcnt(5)
    v_mfma_f32_16x16x32_bf16 v[84:87], v[100:103], v[28:31], 0
    ds_read_b128 v[124:127], v154 offset:6144
    s_waitcnt lgkmcnt(5)
    v_mfma_f32_16x16x32_bf16 v[84:87], v[104:107], v[32:35], v[84:87]
    ds_read_b128 v[128:131], v155 offset:6144
    s_waitcnt lgkmcnt(5)
    v_mfma_f32_16x16x32_bf16 v[84:87], v[108:111], v[36:39], v[84:87]
    ds_read_b128 v[132:135], v154 offset:6272
    s_waitcnt lgkmcnt(5)
    v_mfma_f32_16x16x32_bf16 v[84:87], v[112:115], v[40:43], v[84:87]
    ds_read_b128 v[136:139], v155 offset:6272
    s_waitcnt lgkmcnt(5)
    v_mfma_f32_16x16x32_bf16 v[84:87], v[116:119], v[44:47], v[84:87]
    ds_read_b128 v[140:143], v154 offset:6400
    s_waitcnt lgkmcnt(5)
    v_mfma_f32_16x16x32_bf16 v[84:87], v[120:123], v[48:51], v[84:87]
    ds_read_b128 v[144:147], v155 offset:6400
    s_waitcnt lgkmcnt(5)
    v_mfma_f32_16x16x32_bf16 v[88:91], v[124:127], v[28:31], 0
    ds_read_b128 v[100:103], v154 offset:12288
    s_waitcnt lgkmcnt(5)
    v_mfma_f32_16x16x32_bf16 v[88:91], v[128:131], v[32:35], v[88:91]
    ds_read_b128 v[104:107], v155 offset:12288
    s_waitcnt lgkmcnt(5)
    v_mfma_f32_16x16x32_bf16 v[88:91], v[132:135], v[36:39], v[88:91]
    ds_read_b128 v[108:111], v154 offset:12416
    s_waitcnt lgkmcnt(5)
    v_mfma_f32_16x16x32_bf16 v[88:91], v[136:139], v[40:43], v[88:91]
    ds_read_b128 v[112:115], v155 offset:12416
    s_waitcnt lgkmcnt(5)
    v_mfma_f32_16x16x32_bf16 v[88:91], v[140:143], v[44:47], v[88:91]
    ds_read_b128 v[116:119], v154 offset:12544
    s_waitcnt lgkmcnt(5)
    v_mfma_f32_16x16x32_bf16 v[88:91], v[144:147], v[48:51], v[88:91]
    ds_read_b128 v[120:123], v155 offset:12544
    s_waitcnt lgkmcnt(5)
    v_mfma_f32_16x16x32_bf16 v[92:95], v[100:103], v[28:31], 0
    ds_read_b128 v[124:127], v154 offset:18432
    s_waitcnt lgkmcnt(5)
    v_mfma_f32_16x16x32_bf16 v[92:95], v[104:107], v[32:35], v[92:95]
    ds_read_b128 v[128:131], v155 offset:18432
    s_waitcnt lgkmcnt(5)
    v_mfma_f32_16x16x32_bf16 v[92:95], v[108:111], v[36:39], v[92:95]
    ds_read_b128 v[132:135], v154 offset:18560
    s_waitcnt lgkmcnt(5)
    v_mfma_f32_16x16x32_bf16 v[92:95], v[112:115], v[40:43], v[92:95]
    ds_read_b128 v[136:139], v155 offset:18560
    s_waitcnt lgkmcnt(5)
    v_mfma_f32_16x16x32_bf16 v[92:95], v[116:119], v[44:47], v[92:95]
    ds_read_b128 v[140:143], v154 offset:18688
    s_waitcnt lgkmcnt(5)
    v_mfma_f32_16x16x32_bf16 v[92:95], v[120:123], v[48:51], v[92:95]
    ds_read_b128 v[144:147], v155 offset:18688
    s_waitcnt lgkmcnt(5)
    v_mfma_f32_16x16x32_bf16 v[96:99], v[124:127], v[28:31], 0
    s_waitcnt lgkmcnt(4)
    s_waitcnt lgkmcnt(5)
    v_mfma_f32_16x16x32_bf16 v[96:99], v[128:131], v[32:35], v[96:99]
    s_waitcnt lgkmcnt(3)
    s_waitcnt lgkmcnt(5)
    v_mfma_f32_16x16x32_bf16 v[96:99], v[132:135], v[36:39], v[96:99]
    s_waitcnt lgkmcnt(2)
    s_waitcnt lgkmcnt(5)
    v_mfma_f32_16x16x32_bf16 v[96:99], v[136:139], v[40:43], v[96:99]
    s_waitcnt lgkmcnt(1)
    s_waitcnt lgkmcnt(5)
    v_mfma_f32_16x16x32_bf16 v[96:99], v[140:143], v[44:47], v[96:99]
    s_waitcnt lgkmcnt(0)
    s_waitcnt lgkmcnt(5)
    v_mfma_f32_16x16x32_bf16 v[96:99], v[144:147], v[48:51], v[96:99]
    v_mov_b32 v148, 1
    s_mov_b64 exec, 1
    ds_add_u32 v150, v148 offset:6952
    s_mov_b64 exec, -1
    v_pk_add_f32 v[158:159], v[52:53], v[56:57]
    v_pk_add_f32 v[160:161], v[54:55], v[58:59]
    v_pk_add_f32 v[158:159], v[158:159], v[60:61]
    v_pk_add_f32 v[160:161], v[160:161], v[62:63]
    v_pk_add_f32 v[158:159], v[158:159], v[64:65]
    v_pk_add_f32 v[160:161], v[160:161], v[66:67]
    v_pk_add_f32 v[158:159], v[158:159], v[68:69]
    v_pk_add_f32 v[160:161], v[160:161], v[70:71]
    v_pk_add_f32 v[158:159], v[158:159], v[72:73]
    v_pk_add_f32 v[160:161], v[160:161], v[74:75]
    v_pk_add_f32 v[158:159], v[158:159], v[76:77]
    v_pk_add_f32 v[160:161], v[160:161], v[78:79]
    v_pk_add_f32 v[158:159], v[158:159], v[80:81]
    v_pk_add_f32 v[160:161], v[160:161], v[82:83]
    v_pk_add_f32 v[158:159], v[158:159], v[84:85]
    v_pk_add_f32 v[160:161], v[160:161], v[86:87]
    v_pk_add_f32 v[158:159], v[158:159], v[88:89]
    v_pk_add_f32 v[160:161], v[160:161], v[90:91]
    v_pk_add_f32 v[158:159], v[158:159], v[92:93]
    v_pk_add_f32 v[160:161], v[160:161], v[94:95]
    v_pk_add_f32 v[158:159], v[158:159], v[96:97]
    v_pk_add_f32 v[160:161], v[160:161], v[98:99]
    v_pk_add_f32 v[158:159], v[158:159], v[160:161]
    v_add_f32 v158, v158, v159
    v_mov_b32 v148, v158
    v_mov_b32 v149, v158
    s_nop 1
    v_permlane32_swap_b32 v148, v149
    v_add_f32 v158, v148, v149
    v_mov_b32 v148, v158
    v_mov_b32 v149, v158
    s_nop 1
    v_permlane16_swap_b32 v148, v149
    v_add_f32 v158, v148, v149
    v_mul_f32 v158, s44, v158
    s_sub_u32 s40, s2, 3
    s_lshl_b32 s40, s40, 2
    s_add_u32 s40, s40, s3
    s_mul_i32 s40, s40, 0x1800
    s_add_u32 s40, s40, 0x10000
    v_lshlrev_b32 v148, 4, v0
    v_pk_add_f32 v[52:53], v[52:53], v[158:159] op_sel_hi:[1,0] neg_lo:[0,1] neg_hi:[0,1]
    v_cvt_pk_bf16_f32 v164, v52, v53
    v_pk_add_f32 v[54:55], v[54:55], v[158:159] op_sel_hi:[1,0] neg_lo:[0,1] neg_hi:[0,1]
    v_cvt_pk_bf16_f32 v165, v54, v55
    v_pk_add_f32 v[56:57], v[56:57], v[158:159] op_sel_hi:[1,0] neg_lo:[0,1] neg_hi:[0,1]
    v_cvt_pk_bf16_f32 v166, v56, v57
    v_pk_add_f32 v[58:59], v[58:59], v[158:159] op_sel_hi:[1,0] neg_lo:[0,1] neg_hi:[0,1]
    v_cvt_pk_bf16_f32 v167, v58, v59
    s_add_u32 s42, s40, 0
    buffer_store_dwordx4 v[164:167], v148, s[32:35], s42 offen sc1
    v_pk_add_f32 v[60:61], v[60:61], v[158:159] op_sel_hi:[1,0] neg_lo:[0,1] neg_hi:[0,1]
    v_cvt_pk_bf16_f32 v168, v60, v61
    v_pk_add_f32 v[62:63], v[62:63], v[158:159] op_sel_hi:[1,0] neg_lo:[0,1] neg_hi:[0,1]
    v_cvt_pk_bf16_f32 v169, v62, v63
    v_pk_add_f32 v[64:65], v[64:65], v[158:159] op_sel_hi:[1,0] neg_lo:[0,1] neg_hi:[0,1]
    v_cvt_pk_bf16_f32 v170, v64, v65
    v_pk_add_f32 v[66:67], v[66:67], v[158:159] op_sel_hi:[1,0] neg_lo:[0,1] neg_hi:[0,1]
    v_cvt_pk_bf16_f32 v171, v66, v67
    s_add_u32 s42, s40, 0x400
    buffer_store_dwordx4 v[168:171], v148, s[32:35], s42 offen sc1
    v_pk_add_f32 v[68:69], v[68:69], v[158:159] op_sel_hi:[1,0] neg_lo:[0,1] neg_hi:[0,1]
    v_cvt_pk_bf16_f32 v172, v68, v69
    v_pk_add_f32 v[70:71], v[70:71], v[158:159] op_sel_hi:[1,0] neg_lo:[0,1] neg_hi:[0,1]
    v_cvt_pk_bf16_f32 v173, v70, v71
    v_pk_add_f32 v[72:73], v[72:73], v[158:159] op_sel_hi:[1,0] neg_lo:[0,1] neg_hi:[0,1]
    v_cvt_pk_bf16_f32 v174, v72, v73
    v_pk_add_f32 v[74:75], v[74:75], v[158:159] op_sel_hi:[1,0] neg_lo:[0,1] neg_hi:[0,1]
    v_cvt_pk_bf16_f32 v175, v74, v75
    s_add_u32 s42, s40, 0x800
    buffer_store_dwordx4 v[172:175], v148, s[32:35], s42 offen sc1
    v_pk_add_f32 v[76:77], v[76:77], v[158:159] op_sel_hi:[1,0] neg_lo:[0,1] neg_hi:[0,1]
    v_cvt_pk_bf16_f32 v176, v76, v77
    v_pk_add_f32 v[78:79], v[78:79], v[158:159] op_sel_hi:[1,0] neg_lo:[0,1] neg_hi:[0,1]
    v_cvt_pk_bf16_f32 v177, v78, v79
    v_pk_add_f32 v[80:81], v[80:81], v[158:159] op_sel_hi:[1,0] neg_lo:[0,1] neg_hi:[0,1]
    v_cvt_pk_bf16_f32 v178, v80, v81
    v_pk_add_f32 v[82:83], v[82:83], v[158:159] op_sel_hi:[1,0] neg_lo:[0,1] neg_hi:[0,1]
    v_cvt_pk_bf16_f32 v179, v82, v83
    s_add_u32 s42, s40, 0xc00
    buffer_store_dwordx4 v[176:179], v148, s[32:35], s42 offen sc1
    v_pk_add_f32 v[84:85], v[84:85], v[158:159] op_sel_hi:[1,0] neg_lo:[0,1] neg_hi:[0,1]
    v_cvt_pk_bf16_f32 v180, v84, v85
    v_pk_add_f32 v[86:87], v[86:87], v[158:159] op_sel_hi:[1,0] neg_lo:[0,1] neg_hi:[0,1]
    v_cvt_pk_bf16_f32 v181, v86, v87
    v_pk_add_f32 v[88:89], v[88:89], v[158:159] op_sel_hi:[1,0] neg_lo:[0,1] neg_hi:[0,1]
    v_cvt_pk_bf16_f32 v182, v88, v89
    v_pk_add_f32 v[90:91], v[90:91], v[158:159] op_sel_hi:[1,0] neg_lo:[0,1] neg_hi:[0,1]
    v_cvt_pk_bf16_f32 v183, v90, v91
    s_add_u32 s42, s40, 0x1000
    buffer_store_dwordx4 v[180:183], v148, s[32:35], s42 offen sc1
    v_pk_add_f32 v[92:93], v[92:93], v[158:159] op_sel_hi:[1,0] neg_lo:[0,1] neg_hi:[0,1]
    v_cvt_pk_bf16_f32 v184, v92, v93
    v_pk_add_f32 v[94:95], v[94:95], v[158:159] op_sel_hi:[1,0] neg_lo:[0,1] neg_hi:[0,1]
    v_cvt_pk_bf16_f32 v185, v94, v95
    v_pk_add_f32 v[96:97], v[96:97], v[158:159] op_sel_hi:[1,0] neg_lo:[0,1] neg_hi:[0,1]
    v_cvt_pk_bf16_f32 v186, v96, v97
    v_pk_add_f32 v[98:99], v[98:99], v[158:159] op_sel_hi:[1,0] neg_lo:[0,1] neg_hi:[0,1]
    v_cvt_pk_bf16_f32 v187, v98, v99
    s_add_u32 s42, s40, 0x1400
    buffer_store_dwordx4 v[184:187], v148, s[32:35], s42 offen sc1
    s_waitcnt lgkmcnt(0)
    s_nop 1
    s_branch L_c_start
L_aux:
    s_sub_u32 s36, s3, 5
    v_mov_b32 v11, 0
    v_and_b32 v1, 15, v0
    v_lshrrev_b32 v2, 4, v0
    v_lshlrev_b32 v12, 4, v0
    v_mov_b32 v16, -1
    v_mov_b32 v17, -1
    v_mov_b32 v18, -1
    v_mov_b32 v19, -1
    s_waitcnt lgkmcnt(0)
    s_mov_b32 s32, s22
    s_mov_b32 s33, s23
    s_mov_b32 s34, 0x1000000
    s_mov_b32 s35, 0x20000
    s_cmp_ge_u32 s2, 3
    s_cbranch_scc1 L_aux_noinv0
    s_cmp_lg_u32 s36, 1
    s_cbranch_scc1 L_aux_noinv0
    s_lshl_b32 s38, s2, 11
    s_add_u32 s38, s38, 0
    buffer_store_dwordx4 v[16:19], v12, s[32:35], s38 offen sc1
    buffer_store_dwordx4 v[16:19], v12, s[32:35], s38 offen offset:1024 sc1
    s_memrealtime s[52:53]
    s_waitcnt lgkmcnt(0)
    s_mul_i32 s54, s52, 0x9e3779b1
    s_mov_b32 s55, s53
    s_lshr_b64 s[56:57], s[54:55], 0
    s_lshl_b32 s39, s56, 1
    s_and_b32 s39, s39, 0xfffe
    v_mov_b32 v20, s39
    s_lshr_b64 s[56:57], s[54:55], 15
    s_lshl_b32 s39, s56, 1
    s_and_b32 s39, s39, 0xfffe
    v_mov_b32 v21, s39
    s_lshr_b64 s[56:57], s[54:55], 30
    s_lshl_b32 s39, s56, 1
    s_and_b32 s39, s39, 0xfffe
    v_mov_b32 v22, s39
    s_mul_i32 s39, s54, 0x85ebca6b
    s_lshr_b32 s39, s39, 16
    s_and_b32 s39, s39, 0xfffe
    v_mov_b32 v23, s39
    s_lshl_b32 s38, s2, 7
    s_add_u32 s38, s38, 0x1800
    s_mov_b64 exec, 1
    buffer_store_dwordx4 v[20:23], v11, s[32:35], s38 offen sc1
    s_mov_b64 exec, -1
L_aux_noinv0:
    s_barrier
    s_mov_b32 s44, s20
    s_mov_b32 s45, s21
    s_mov_b32 s46, 0x100
    s_mov_b32 s47, 0x20000
    s_cmp_ge_u32 s2, 3
    s_cbranch_scc1 L_aux_noinv
    s_cmp_lg_u32 s36, 1
    s_cbranch_scc1 L_aux_noinv
    v_mov_b32 v14, 1
    s_lshl_b32 s38, s2, 5
    s_waitcnt vmcnt(0)
    ds_write_b32 v11, v14 offset:6960
    s_mov_b64 exec, 1
    buffer_store_dword v14, v11, s[44:47], s38 offen sc1
    s_mov_b64 exec, -1
    s_nop 2
L_aux_noinv:
    s_cmp_lt_u32 s2, 3
    s_cselect_b32 s39, 40, 0
    v_mov_b32 v15, s39
    s_cmp_lg_u32 s36, 0
    s_cbranch_scc1 L_aux_w
    v_mul_u32_u24 v14, 0x180, v1
    v_and_b32 v16, 1, v2
    v_lshl_add_u32 v14, v16, 3, v14
    v_lshrrev_b32 v16, 1, v2
    v_and_b32 v13, 6, v1
    v_xor_b32 v16, v16, v13
    v_xor_b32 v13, 0, v16
    v_lshl_add_u32 v232, v13, 4, v14
    v_xor_b32 v13, 2, v16
    v_lshl_add_u32 v233, v13, 4, v14
    v_xor_b32 v13, 4, v16
    v_lshl_add_u32 v234, v13, 4, v14
    v_xor_b32 v13, 6, v16
    v_lshl_add_u32 v235, v13, 4, v14
    v_lshlrev_b32 v13, 5, v0
    s_cmp_lt_u32 s2, 6
    s_cselect_b32 s38, 1, 3
L_spin84:
    ds_read_b32 v14, v15 offset:6912
    s_waitcnt lgkmcnt(0)
    v_readfirstlane_b32 s37, v14
    s_nop 0
    s_cmp_ge_u32 s37, s38
    s_cbranch_scc1 L_spun85
    s_sleep 4
    s_branch L_spin84
L_spun85:
    s_mov_b64 exec, 7
L_qpoll:
    buffer_load_dword v14, v13, s[44:47], 0 offen sc1
    s_waitcnt vmcnt(0)
    v_cmp_eq_u32 vcc, 0, v14
    s_cbranch_vccz L_qpolled
    s_sleep 8
    s_branch L_qpoll
L_qpolled:
    s_mov_b64 exec, -1
    s_cmp_lt_u32 s2, 6
    s_cselect_b32 s38, 3, 6
    s_cmp_lt_u32 s2, 3
    s_cselect_b32 s38, 4, s38
L_spin86:
    ds_read_b32 v14, v15 offset:6912
    s_waitcnt lgkmcnt(0)
    v_readfirstlane_b32 s37, v14
    s_nop 0
    s_cmp_ge_u32 s37, s38
    s_cbranch_scc1 L_spun87
    s_sleep 2
    s_branch L_spin86
L_spun87:
    s_mov_b32 s38, 0x1800
    buffer_load_dwordx4 v[236:239], v11, s[32:35], s38 offen sc1
L_qdata:
    s_mov_b32 s38, 0
    buffer_load_dwordx4 v[208:211], v12, s[32:35], s38 offen sc1
    s_mov_b32 s38, 0x400
    buffer_load_dwordx4 v[212:215], v12, s[32:35], s38 offen sc1
    s_mov_b32 s38, 0x800
    buffer_load_dwordx4 v[216:219], v12, s[32:35], s38 offen sc1
    s_mov_b32 s38, 0xc00
    buffer_load_dwordx4 v[220:223], v12, s[32:35], s38 offen sc1
    s_mov_b32 s38, 0x1000
    buffer_load_dwordx4 v[224:227], v12, s[32:35], s38 offen sc1
    s_mov_b32 s38, 0x1400
    buffer_load_dwordx4 v[228:231], v12, s[32:35], s38 offen sc1
    s_waitcnt vmcnt(0)
    v_max3_u32 v14, v208, v209, v210
    v_max3_u32 v14, v14, v211, v212
    v_max3_u32 v14, v14, v213, v214
    v_max3_u32 v14, v14, v215, v216
    v_max3_u32 v14, v14, v217, v218
    v_max3_u32 v14, v14, v219, v220
    v_max3_u32 v14, v14, v221, v222
    v_max3_u32 v14, v14, v223, v224
    v_max3_u32 v14, v14, v225, v226
    v_max3_u32 v14, v14, v227, v228
    v_max3_u32 v14, v14, v229, v230
    v_max_u32 v14, v14, v231
    v_cmp_eq_u32 vcc, -1, v14
    s_cbranch_vccnz L_qdata
    ds_write_b128 v11, v[236:239] offset:7040
    ds_write_b64 v232, v[208:209]
    ds_write_b64 v233, v[210:211]
    ds_write_b64 v234, v[212:213]
    ds_write_b64 v235, v[214:215]
    ds_write_b64 v232, v[216:217] offset:128
    ds_write_b64 v233, v[218:219] offset:128
    ds_write_b64 v234, v[220:221] offset:128
    ds_write_b64 v235, v[222:223] offset:128
    ds_write_b64 v232, v[224:225] offset:256
    ds_write_b64 v233, v[226:227] offset:256
    ds_write_b64 v234, v[228:229] offset:256
    ds_write_b64 v235, v[230:231] offset:256
    v_mov_b32 v14, 1
    ds_write_b32 v11, v14 offset:6944
    s_nop 0
L_aux_w:
    s_cmp_lg_u32 s36, 2
    s_cbranch_scc1 L_aux_wf2
    v_lshlrev_b32 v13, 2, v0
    s_nop 1
L_spin88:
    ds_read_b32 v14, v11 offset:6912
    s_waitcnt lgkmcnt(0)
    v_readfirstlane_b32 s37, v14
    s_nop 0
    s_cmp_ge_u32 s37, 10
    s_cbranch_scc1 L_spun89
    s_sleep 8
    s_branch L_spin88
L_spun89:
L_spin90:
    ds_read_b32 v14, v11 offset:6944
    s_waitcnt lgkmcnt(0)
    v_readfirstlane_b32 s37, v14
    s_nop 0
    s_cmp_ge_u32 s37, 1
    s_cbranch_scc1 L_spun91
    s_sleep 8
    s_branch L_spin90
L_spun91:
    s_mov_b64 exec, 0xfff
L_wpoll:
    buffer_load_dword v14, v13, s[44:47], 0 offen offset:128 sc1
    s_waitcnt vmcnt(0)
    v_cmp_eq_u32 vcc, 0, v14
    s_cbranch_vccz L_wpolled
    s_sleep 16
    s_branch L_wpoll
L_wpolled:
    s_mov_b64 exec, -1
    v_mov_b32 v14, 1
    ds_write_b32 v11, v14 offset:6976
    s_nop 0
L_aux_wf2:
L_spin92:
    ds_read_b32 v14, v11 offset:6976
    s_waitcnt lgkmcnt(0)
    v_readfirstlane_b32 s37, v14
    s_nop 0
    s_cmp_ge_u32 s37, 1
    s_cbranch_scc1 L_spun93
    s_sleep 8
    s_branch L_spin92
L_spun93:
    s_mul_i32 s37, s36, 0x4800
    s_add_u32 s37, s37, 0x10000
    s_add_u32 s38, s37, 0
    buffer_load_dwordx4 v[112:115], v12, s[32:35], s38 offen sc1
    s_add_u32 s38, s37, 0x400
    buffer_load_dwordx4 v[124:127], v12, s[32:35], s38 offen sc1
    s_add_u32 s38, s37, 0x800
    buffer_load_dwordx4 v[136:139], v12, s[32:35], s38 offen sc1
    s_waitcnt vmcnt(0)
    s_add_u32 s38, s37, 0xc00
    buffer_load_dwordx4 v[148:151], v12, s[32:35], s38 offen sc1
    s_add_u32 s38, s37, 0x1000
    buffer_load_dwordx4 v[160:163], v12, s[32:35], s38 offen sc1
    s_add_u32 s38, s37, 0x1400
    buffer_load_dwordx4 v[172:175], v12, s[32:35], s38 offen sc1
    s_waitcnt vmcnt(0)
    s_add_u32 s38, s37, 0x1800
    buffer_load_dwordx4 v[116:119], v12, s[32:35], s38 offen sc1
    s_add_u32 s38, s37, 0x1c00
    buffer_load_dwordx4 v[128:131], v12, s[32:35], s38 offen sc1
    s_add_u32 s38, s37, 0x2000
    buffer_load_dwordx4 v[140:143], v12, s[32:35], s38 offen sc1
    s_waitcnt vmcnt(0)
    s_add_u32 s38, s37, 0x2400
    buffer_load_dwordx4 v[152:155], v12, s[32:35], s38 offen sc1
    s_add_u32 s38, s37, 0x2800
    buffer_load_dwordx4 v[164:167], v12, s[32:35], s38 offen sc1
    s_add_u32 s38, s37, 0x2c00
    buffer_load_dwordx4 v[176:179], v12, s[32:35], s38 offen sc1
    s_waitcnt vmcnt(0)
    s_add_u32 s38, s37, 0x3000
    buffer_load_dwordx4 v[120:123], v12, s[32:35], s38 offen sc1
    s_add_u32 s38, s37, 0x3400
    buffer_load_dwordx4 v[132:135], v12, s[32:35], s38 offen sc1
    s_add_u32 s38, s37, 0x3800
    buffer_load_dwordx4 v[144:147], v12, s[32:35], s38 offen sc1
    s_waitcnt vmcnt(0)
    s_add_u32 s38, s37, 0x3c00
    buffer_load_dwordx4 v[156:159], v12, s[32:35], s38 offen sc1
    s_add_u32 s38, s37, 0x4000
    buffer_load_dwordx4 v[168:171], v12, s[32:35], s38 offen sc1
    s_add_u32 s38, s37, 0x4400
    buffer_load_dwordx4 v[180:183], v12, s[32:35], s38 offen sc1
    s_waitcnt vmcnt(0)
L_tail:
    v_lshlrev_b32 v6, 4, v1
    v_add_u32 v2, 0x3400, v12
    v_add_u32 v3, 0x15400, v12
    v_add_u32 v4, 0x6400, v6
    v_add_u32 v5, 0x18400, v6
    s_lshl_b32 s49, s2, 13
    s_lshl_b32 s38, s36, 11
    s_add_u32 s49, s49, s38
    s_add_u32 s49, s49, 0x80000
    s_mov_b32 s51, 0x42200000
    v_and_b32 v8, 3, v1
    v_lshlrev_b32 v8, 2, v8
    ds_read_b32 v200, v8 offset:7040
    s_nop 0
L_spin94:
    ds_read_b32 v15, v11 offset:6992
    s_waitcnt lgkmcnt(0)
    v_readfirstlane_b32 s37, v15
    s_nop 0
    s_cmp_ge_u32 s37, 22
    s_cbranch_scc1 L_spun95
    s_sleep 1
    s_branch L_spin94
L_spun95:
    ds_read_b128 v[48:51], v2
    ds_read_b128 v[52:55], v2 offset:1024
    ds_read_b128 v[56:59], v2 offset:2048
    ds_read_b128 v[60:63], v2 offset:3072
    ds_read_b128 v[64:67], v2 offset:4096
    ds_read_b128 v[68:71], v2 offset:5120
    ds_read_b128 v[72:75], v4
    s_cmp_ge_u32 s37, 32
    s_cbranch_scc1 L_agen
    s_waitcnt vmcnt(0)
    s_waitcnt lgkmcnt(6)
    v_mfma_f32_16x16x32_bf16 v[16:19], v[112:115], v[48:51], 0
    ds_read_b32 v108, v11 offset:6996
    v_mfma_f32_16x16x32_bf16 v[20:23], v[116:119], v[48:51], 0
    ds_read_b128 v[80:83], v2 offset:36864
    v_mfma_f32_16x16x32_bf16 v[24:27], v[120:123], v[48:51], 0
    ds_read_b128 v[84:87], v2 offset:37888
    s_waitcnt lgkmcnt(8)
    v_mfma_f32_16x16x32_bf16 v[16:19], v[124:127], v[52:55], v[16:19]
    ds_read_b128 v[88:91], v2 offset:38912
    v_mfma_f32_16x16x32_bf16 v[20:23], v[128:131], v[52:55], v[20:23]
    ds_read_b128 v[92:95], v2 offset:39936
    v_mfma_f32_16x16x32_bf16 v[24:27], v[132:135], v[52:55], v[24:27]
    ds_read_b128 v[96:99], v2 offset:40960
    s_waitcnt lgkmcnt(6)
    v_mfma_f32_16x16x32_bf16 v[16:19], v[136:139], v[56:59], v[16:19]
    ds_read_b128 v[100:103], v2 offset:41984
    v_mfma_f32_16x16x32_bf16 v[20:23], v[140:143], v[56:59], v[20:23]
    ds_read_b128 v[104:107], v4 offset:36864
    v_mfma_f32_16x16x32_bf16 v[24:27], v[144:147], v[56:59], v[24:27]
    v_add_f32 v72, v72, v73
    v_mfma_f32_16x16x32_bf16 v[16:19], v[148:151], v[60:63], v[16:19]
    v_add_f32 v74, v74, v75
    v_mfma_f32_16x16x32_bf16 v[20:23], v[152:155], v[60:63], v[20:23]
    v_add_f32 v7, v72, v74
    v_mfma_f32_16x16x32_bf16 v[24:27], v[156:159], v[60:63], v[24:27]
    v_mfma_f32_16x16x32_bf16 v[16:19], v[160:163], v[64:67], v[16:19]
    v_mfma_f32_16x16x32_bf16 v[20:23], v[164:167], v[64:67], v[20:23]
    v_mfma_f32_16x16x32_bf16 v[24:27], v[168:171], v[64:67], v[24:27]
    s_waitcnt lgkmcnt(0)
    v_readfirstlane_b32 s37, v108
    v_mfma_f32_16x16x32_bf16 v[16:19], v[172:175], v[68:71], v[16:19]
    v_mfma_f32_16x16x32_bf16 v[20:23], v[176:179], v[68:71], v[20:23]
    s_cmp_eq_u32 s37, 22
    v_mfma_f32_16x16x32_bf16 v[24:27], v[180:183], v[68:71], v[24:27]
    s_cbranch_scc1 L_bo97
    s_branch L_bt96x
L_bt96:
    s_waitcnt lgkmcnt(0)
    v_readfirstlane_b32 s37, v108
    s_nop 0
    s_cmp_eq_u32 s37, 22
    s_cbranch_scc1 L_bo97
L_bt96x:
    s_cmp_ge_u32 s37, 32
    s_cbranch_scc1 L_agen
    ds_read_b32 v108, v11 offset:6996
    ds_read_b128 v[80:83], v2 offset:36864
    ds_read_b128 v[84:87], v2 offset:37888
    ds_read_b128 v[88:91], v2 offset:38912
    ds_read_b128 v[92:95], v2 offset:39936
    ds_read_b128 v[96:99], v2 offset:40960
    ds_read_b128 v[100:103], v2 offset:41984
    ds_read_b128 v[104:107], v4 offset:36864
    s_branch L_bt96
L_bo97:
    v_mfma_f32_16x16x32_bf16 v[16:19], v[112:115], v[80:83], v[16:19]
    ds_read_b32 v76, v11 offset:7000
    v_mfma_f32_16x16x32_bf16 v[20:23], v[116:119], v[80:83], v[20:23]
    ds_read_b128 v[48:51], v3
    v_mfma_f32_16x16x32_bf16 v[24:27], v[120:123], v[80:83], v[24:27]
    ds_read_b128 v[52:55], v3 offset:1024
    v_mfma_f32_16x16x32_bf16 v[16:19], v[124:127], v[84:87], v[16:19]
    ds_read_b128 v[56:59], v3 offset:2048
    v_mfma_f32_16x16x32_bf16 v[20:23], v[128:131], v[84:87], v[20:23]
    ds_read_b128 v[60:63], v3 offset:3072
    v_mfma_f32_16x16x32_bf16 v[24:27], v[132:135], v[84:87], v[24:27]
    ds_read_b128 v[64:67], v3 offset:4096
    v_mfma_f32_16x16x32_bf16 v[16:19], v[136:139], v[88:91], v[16:19]
    ds_read_b128 v[68:71], v3 offset:5120
    v_mfma_f32_16x16x32_bf16 v[20:23], v[140:143], v[88:91], v[20:23]
    ds_read_b128 v[72:75], v5
    v_mfma_f32_16x16x32_bf16 v[24:27], v[144:147], v[88:91], v[24:27]
    v_add_f32 v104, v104, v105
    v_mfma_f32_16x16x32_bf16 v[16:19], v[148:151], v[92:95], v[16:19]
    v_add_f32 v106, v106, v107
    v_mfma_f32_16x16x32_bf16 v[20:23], v[152:155], v[92:95], v[20:23]
    v_add_f32 v104, v104, v106
    v_mfma_f32_16x16x32_bf16 v[24:27], v[156:159], v[92:95], v[24:27]
    v_add_f32 v7, v7, v104
    v_mfma_f32_16x16x32_bf16 v[16:19], v[160:163], v[96:99], v[16:19]
    v_mfma_f32_16x16x32_bf16 v[20:23], v[164:167], v[96:99], v[20:23]
    v_mfma_f32_16x16x32_bf16 v[24:27], v[168:171], v[96:99], v[24:27]
    s_waitcnt lgkmcnt(0)
    v_readfirstlane_b32 s37, v76
    v_mfma_f32_16x16x32_bf16 v[16:19], v[172:175], v[100:103], v[16:19]
    v_mfma_f32_16x16x32_bf16 v[20:23], v[176:179], v[100:103], v[20:23]
    s_cmp_eq_u32 s37, 22
    v_mfma_f32_16x16x32_bf16 v[24:27], v[180:183], v[100:103], v[24:27]
    s_cbranch_scc1 L_bo99
    s_branch L_bt98x
L_bt98:
    s_waitcnt lgkmcnt(0)
    v_readfirstlane_b32 s37, v76
    s_nop 0
    s_cmp_eq_u32 s37, 22
    s_cbranch_scc1 L_bo99
L_bt98x:
    s_cmp_ge_u32 s37, 32
    s_cbranch_scc1 L_agen
    ds_read_b32 v76, v11 offset:7000
    ds_read_b128 v[48:51], v3
    ds_read_b128 v[52:55], v3 offset:1024
    ds_read_b128 v[56:59], v3 offset:2048
    ds_read_b128 v[60:63], v3 offset:3072
    ds_read_b128 v[64:67], v3 offset:4096
    ds_read_b128 v[68:71], v3 offset:5120
    ds_read_b128 v[72:75], v5
    s_branch L_bt98
L_bo99:
    v_mfma_f32_16x16x32_bf16 v[16:19], v[112:115], v[48:51], v[16:19]
    ds_read_b32 v108, v11 offset:7004
    v_mfma_f32_16x16x32_bf16 v[20:23], v[116:119], v[48:51], v[20:23]
    ds_read_b128 v[80:83], v3 offset:36864
    v_mfma_f32_16x16x32_bf16 v[24:27], v[120:123], v[48:51], v[24:27]
    ds_read_b128 v[84:87], v3 offset:37888
    v_mfma_f32_16x16x32_bf16 v[16:19], v[124:127], v[52:55], v[16:19]
    ds_read_b128 v[88:91], v3 offset:38912
    v_mfma_f32_16x16x32_bf16 v[20:23], v[128:131], v[52:55], v[20:23]
    ds_read_b128 v[92:95], v3 offset:39936
    v_mfma_f32_16x16x32_bf16 v[24:27], v[132:135], v[52:55], v[24:27]
    ds_read_b128 v[96:99], v3 offset:40960
    v_mfma_f32_16x16x32_bf16 v[16:19], v[136:139], v[56:59], v[16:19]
    ds_read_b128 v[100:103], v3 offset:41984
    v_mfma_f32_16x16x32_bf16 v[20:23], v[140:143], v[56:59], v[20:23]
    ds_read_b128 v[104:107], v5 offset:36864
    v_mfma_f32_16x16x32_bf16 v[24:27], v[144:147], v[56:59], v[24:27]
    v_add_f32 v72, v72, v73
    v_mfma_f32_16x16x32_bf16 v[16:19], v[148:151], v[60:63], v[16:19]
    v_add_f32 v74, v74, v75
    v_mfma_f32_16x16x32_bf16 v[20:23], v[152:155], v[60:63], v[20:23]
    v_add_f32 v72, v72, v74
    v_mfma_f32_16x16x32_bf16 v[24:27], v[156:159], v[60:63], v[24:27]
    v_add_f32 v7, v7, v72
    v_mfma_f32_16x16x32_bf16 v[16:19], v[160:163], v[64:67], v[16:19]
    v_mfma_f32_16x16x32_bf16 v[20:23], v[164:167], v[64:67], v[20:23]
    v_mfma_f32_16x16x32_bf16 v[24:27], v[168:171], v[64:67], v[24:27]
    s_waitcnt lgkmcnt(0)
    v_readfirstlane_b32 s37, v108
    v_mfma_f32_16x16x32_bf16 v[16:19], v[172:175], v[68:71], v[16:19]
    v_mfma_f32_16x16x32_bf16 v[20:23], v[176:179], v[68:71], v[20:23]
    s_cmp_eq_u32 s37, 22
    v_mfma_f32_16x16x32_bf16 v[24:27], v[180:183], v[68:71], v[24:27]
    s_cbranch_scc0 L_prog
    v_mfma_f32_16x16x32_bf16 v[16:19], v[112:115], v[80:83], v[16:19]
    v_add_f32 v104, v104, v105
    v_mfma_f32_16x16x32_bf16 v[20:23], v[116:119], v[80:83], v[20:23]
    v_add_f32 v106, v106, v107
    v_mfma_f32_16x16x32_bf16 v[16:19], v[124:127], v[84:87], v[16:19]
    v_add_f32 v104, v104, v106
    v_mfma_f32_16x16x32_bf16 v[20:23], v[128:131], v[84:87], v[20:23]
    v_add_f32 v7, v7, v104
    v_mfma_f32_16x16x32_bf16 v[16:19], v[136:139], v[88:91], v[16:19]
    v_cvt_pk_bf16_f32 v8, 0, v7
    v_mfma_f32_16x16x32_bf16 v[20:23], v[140:143], v[88:91], v[20:23]
    v_or_b32 v195, v8, v200
    v_mfma_f32_16x16x32_bf16 v[16:19], v[148:151], v[92:95], v[16:19]
    v_or_b32 v199, v8, v200
    v_mfma_f32_16x16x32_bf16 v[20:23], v[152:155], v[92:95], v[20:23]
    v_mfma_f32_16x16x32_bf16 v[16:19], v[160:163], v[96:99], v[16:19]
    v_mfma_f32_16x16x32_bf16 v[20:23], v[164:167], v[96:99], v[20:23]
    v_mfma_f32_16x16x32_bf16 v[16:19], v[172:175], v[100:103], v[16:19]
    v_mfma_f32_16x16x32_bf16 v[20:23], v[176:179], v[100:103], v[20:23]
    v_mfma_f32_16x16x32_bf16 v[24:27], v[120:123], v[80:83], v[24:27]
    v_mfma_f32_16x16x32_bf16 v[24:27], v[132:135], v[84:87], v[24:27]
    v_mfma_f32_16x16x32_bf16 v[24:27], v[144:147], v[88:91], v[24:27]
    s_nop 2
    s_nop 0
    v_cvt_pk_bf16_f32 v192, v16, v17
    v_cvt_pk_bf16_f32 v193, v18, v19
    v_mfma_f32_16x16x32_bf16 v[24:27], v[156:159], v[92:95], v[24:27]
    v_cvt_pk_bf16_f32 v194, v20, v21
    buffer_store_dwordx4 v[192:195], v12, s[32:35], s49 offen sc1
    v_mfma_f32_16x16x32_bf16 v[24:27], v[168:171], v[96:99], v[24:27]
    v_cvt_pk_bf16_f32 v196, v22, v23
    v_mfma_f32_16x16x32_bf16 v[24:27], v[180:183], v[100:103], v[24:27]
    s_nop 7
    v_cvt_pk_bf16_f32 v197, v24, v25
    v_cvt_pk_bf16_f32 v198, v26, v27
    buffer_store_dwordx4 v[196:199], v12, s[32:35], s49 offen offset:1024 sc1
L_aend:
    v_mov_b32 v15, 1
    s_mov_b64 exec, 1
    ds_add_u32 v11, v15 offset:6964
    s_mov_b64 exec, -1
    s_endpgm
L_prog:
    s_cmp_ge_u32 s37, 18
    s_cbranch_scc1 L_pg0k
L_pg0:
    ds_read_b32 v108, v11 offset:7004
    ds_read_b128 v[80:83], v3 offset:36864
    ds_read_b128 v[84:87], v3 offset:37888
    ds_read_b128 v[104:107], v5 offset:36864
    s_waitcnt lgkmcnt(0)
    v_readfirstlane_b32 s37, v108
    s_nop 0
    s_cmp_ge_u32 s37, 18
    s_cbranch_scc0 L_pg0
L_pg0k:
    s_cmp_ge_u32 s37, 32
    s_cbranch_scc1 L_agen
    v_mfma_f32_16x16x32_bf16 v[16:19], v[112:115], v[80:83], v[16:19]
    ds_read_b32 v108, v11 offset:7004
    v_add_f32 v104, v104, v105
    v_mfma_f32_16x16x32_bf16 v[20:23], v[116:119], v[80:83], v[20:23]
    ds_read_b128 v[88:91], v3 offset:38912
    v_add_f32 v106, v106, v107
    v_mfma_f32_16x16x32_bf16 v[24:27], v[120:123], v[80:83], v[24:27]
    ds_read_b128 v[92:95], v3 offset:39936
    v_add_f32 v104, v104, v106
    v_mfma_f32_16x16x32_bf16 v[16:19], v[124:127], v[84:87], v[16:19]
    v_add_f32 v7, v7, v104
    v_mfma_f32_16x16x32_bf16 v[20:23], v[128:131], v[84:87], v[20:23]
    v_cvt_pk_bf16_f32 v8, 0, v7
    v_mfma_f32_16x16x32_bf16 v[24:27], v[132:135], v[84:87], v[24:27]
    v_or_b32 v195, v8, v200
    s_waitcnt lgkmcnt(0)
    v_readfirstlane_b32 s37, v108
    s_nop 0
    s_cmp_ge_u32 s37, 20
    s_cbranch_scc1 L_pg1k
L_pg1:
    ds_read_b32 v108, v11 offset:7004
    ds_read_b128 v[88:91], v3 offset:38912
    ds_read_b128 v[92:95], v3 offset:39936
    s_waitcnt lgkmcnt(0)
    v_readfirstlane_b32 s37, v108
    s_nop 0
    s_cmp_ge_u32 s37, 20
    s_cbranch_scc0 L_pg1
L_pg1k:
    v_mfma_f32_16x16x32_bf16 v[16:19], v[136:139], v[88:91], v[16:19]
    ds_read_b32 v108, v11 offset:7004
    v_or_b32 v199, v8, v200
    v_mfma_f32_16x16x32_bf16 v[20:23], v[140:143], v[88:91], v[20:23]
    ds_read_b128 v[96:99], v3 offset:40960
    v_mfma_f32_16x16x32_bf16 v[24:27], v[144:147], v[88:91], v[24:27]
    ds_read_b128 v[100:103], v3 offset:41984
    v_mfma_f32_16x16x32_bf16 v[16:19], v[148:151], v[92:95], v[16:19]
    v_mfma_f32_16x16x32_bf16 v[20:23], v[152:155], v[92:95], v[20:23]
    v_mfma_f32_16x16x32_bf16 v[24:27], v[156:159], v[92:95], v[24:27]
    s_waitcnt lgkmcnt(0)
    v_readfirstlane_b32 s37, v108
    s_nop 0
    s_cmp_ge_u32 s37, 22
    s_cbranch_scc1 L_pg2k
L_pg2:
    ds_read_b32 v108, v11 offset:7004
    ds_read_b128 v[96:99], v3 offset:40960
    ds_read_b128 v[100:103], v3 offset:41984
    s_waitcnt lgkmcnt(0)
    v_readfirstlane_b32 s37, v108
    s_nop 0
    s_cmp_ge_u32 s37, 22
    s_cbranch_scc0 L_pg2
L_pg2k:
    v_mfma_f32_16x16x32_bf16 v[16:19], v[160:163], v[96:99], v[16:19]
    v_mfma_f32_16x16x32_bf16 v[20:23], v[164:167], v[96:99], v[20:23]
    v_mfma_f32_16x16x32_bf16 v[24:27], v[168:171], v[96:99], v[24:27]
    v_mfma_f32_16x16x32_bf16 v[16:19], v[172:175], v[100:103], v[16:19]
    v_mfma_f32_16x16x32_bf16 v[20:23], v[176:179], v[100:103], v[20:23]
    v_mfma_f32_16x16x32_bf16 v[24:27], v[180:183], v[100:103], v[24:27]
    s_nop 5
    v_cvt_pk_bf16_f32 v192, v16, v17
    v_cvt_pk_bf16_f32 v193, v18, v19
    v_cvt_pk_bf16_f32 v194, v20, v21
    buffer_store_dwordx4 v[192:195], v12, s[32:35], s49 offen sc1
    v_cvt_pk_bf16_f32 v196, v22, v23
    v_cvt_pk_bf16_f32 v197, v24, v25
    v_cvt_pk_bf16_f32 v198, v26, v27
    buffer_store_dwordx4 v[196:199], v12, s[32:35], s49 offen offset:1024 sc1
    s_branch L_aend
L_agen:
    s_waitcnt vmcnt(0)
L_agw100:
    ds_read_b32 v15, v11 offset:6992
    s_waitcnt lgkmcnt(0)
    v_readfirstlane_b32 s37, v15
    s_nop 0
    s_and_b32 s37, s37, 15
    s_cmp_eq_u32 s37, 6
    s_cbranch_scc0 L_agw100
    v_add_u32 v3, 0x6400, v6
    ds_read_b32 v205, v3 offset:512
    s_waitcnt lgkmcnt(0)
    v_mov_b32 v9, v205
    s_nop 1
L_agw101:
    ds_read_b32 v15, v11 offset:6996
    s_waitcnt lgkmcnt(0)
    v_readfirstlane_b32 s37, v15
    s_nop 0
    s_and_b32 s37, s37, 15
    s_cmp_eq_u32 s37, 6
    s_cbranch_scc0 L_agw101
    v_add_u32 v3, 0xf400, v6
    ds_read_b32 v205, v3 offset:512
    s_waitcnt lgkmcnt(0)
    v_max_f32 v9, v9, v205
    s_nop 1
L_agw102:
    ds_read_b32 v15, v11 offset:7000
    s_waitcnt lgkmcnt(0)
    v_readfirstlane_b32 s37, v15
    s_nop 0
    s_and_b32 s37, s37, 15
    s_cmp_eq_u32 s37, 6
    s_cbranch_scc0 L_agw102
    v_add_u32 v3, 0x18400, v6
    ds_read_b32 v205, v3 offset:512
    s_waitcnt lgkmcnt(0)
    v_max_f32 v9, v9, v205
    s_nop 1
L_agw103:
    ds_read_b32 v15, v11 offset:7004
    s_waitcnt lgkmcnt(0)
    v_readfirstlane_b32 s37, v15
    s_nop 0
    s_and_b32 s37, s37, 15
    s_cmp_eq_u32 s37, 6
    s_cbranch_scc0 L_agw103
    v_add_u32 v3, 0x21400, v6
    ds_read_b32 v205, v3 offset:512
    s_waitcnt lgkmcnt(0)
    v_max_f32 v9, v9, v205
    v_cmp_nlt_f32_e64 s[56:57], |v9|, s51
    s_nop 1
    v_cndmask_b32 v10, 0, v9, s[56:57]
    v_mov_b32 v7, 0
    v_mov_b32 v16, 0
    v_mov_b32 v17, 0
    v_mov_b32 v18, 0
    v_mov_b32 v19, 0
    v_mov_b32 v20, 0
    v_mov_b32 v21, 0
    v_mov_b32 v22, 0
    v_mov_b32 v23, 0
    v_mov_b32 v24, 0
    v_mov_b32 v25, 0
    v_mov_b32 v26, 0
    v_mov_b32 v27, 0
    s_mov_b32 s58, 0
    s_nop 0
L_agen_w:
    s_mul_i32 s59, s58, 0x9000
    s_add_u32 s59, s59, 0x3400
    v_add_u32 v2, s59, v12
    v_add_u32 v3, s59, v6
    ds_read_b128 v[48:51], v2
    ds_read_b128 v[52:55], v2 offset:1024
    ds_read_b128 v[56:59], v2 offset:2048
    ds_read_b128 v[60:63], v2 offset:3072
    ds_read_b128 v[64:67], v2 offset:4096
    ds_read_b128 v[68:71], v2 offset:5120
    ds_read_b32 v205, v3 offset:12800
    ds_read_b128 v[72:75], v3 offset:12288
    s_waitcnt lgkmcnt(0)
    v_mfma_f32_16x16x32_bf16 v[32:35], v[112:115], v[48:51], 0
    v_mfma_f32_16x16x32_bf16 v[36:39], v[116:119], v[48:51], 0
    v_mfma_f32_16x16x32_bf16 v[40:43], v[120:123], v[48:51], 0
    v_mfma_f32_16x16x32_bf16 v[32:35], v[124:127], v[52:55], v[32:35]
    v_mfma_f32_16x16x32_bf16 v[36:39], v[128:131], v[52:55], v[36:39]
    v_mfma_f32_16x16x32_bf16 v[40:43], v[132:135], v[52:55], v[40:43]
    v_mfma_f32_16x16x32_bf16 v[32:35], v[136:139], v[56:59], v[32:35]
    v_mfma_f32_16x16x32_bf16 v[36:39], v[140:143], v[56:59], v[36:39]
    v_mfma_f32_16x16x32_bf16 v[40:43], v[144:147], v[56:59], v[40:43]
    v_mfma_f32_16x16x32_bf16 v[32:35], v[148:151], v[60:63], v[32:35]
    v_mfma_f32_16x16x32_bf16 v[36:39], v[152:155], v[60:63], v[36:39]
    v_mfma_f32_16x16x32_bf16 v[40:43], v[156:159], v[60:63], v[40:43]
    v_mfma_f32_16x16x32_bf16 v[32:35], v[160:163], v[64:67], v[32:35]
    v_mfma_f32_16x16x32_bf16 v[36:39], v[164:167], v[64:67], v[36:39]
    v_mfma_f32_16x16x32_bf16 v[40:43], v[168:171], v[64:67], v[40:43]
    v_mfma_f32_16x16x32_bf16 v[32:35], v[172:175], v[68:71], v[32:35]
    v_mfma_f32_16x16x32_bf16 v[36:39], v[176:179], v[68:71], v[36:39]
    v_mfma_f32_16x16x32_bf16 v[40:43], v[180:183], v[68:71], v[40:43]
    v_sub_f32 v14, v205, v10
    v_exp_f32 v13, v14
    v_add_f32 v72, v72, v73
    v_add_f32 v74, v74, v75
    v_add_f32 v72, v72, v74
    v_fmac_f32 v7, v13, v72
    v_fmac_f32 v16, v13, v32
    v_fmac_f32 v17, v13, v33
    v_fmac_f32 v18, v13, v34
    v_fmac_f32 v19, v13, v35
    v_fmac_f32 v20, v13, v36
    v_fmac_f32 v21, v13, v37
    v_fmac_f32 v22, v13, v38
    v_fmac_f32 v23, v13, v39
    v_fmac_f32 v24, v13, v40
    v_fmac_f32 v25, v13, v41
    v_fmac_f32 v26, v13, v42
    v_fmac_f32 v27, v13, v43
    s_add_u32 s58, s58, 1
    s_cmp_lt_u32 s58, 4
    s_cbranch_scc1 L_agen_w
    v_cndmask_b32 v14, 0, 1, s[56:57]
    v_or_b32 v200, v200, v14
    ds_read_b64 v[74:75], v11 offset:7040
    v_mov_b32 v72, v10
    v_lshrrev_b32 v14, 1, v6
    s_lshl_b32 s38, s2, 7
    s_add_u32 s38, s38, 0x30000
    s_waitcnt lgkmcnt(0)
    v_lshl_or_b32 v73, v75, 16, v74
    s_mov_b64 exec, 0xffff
    buffer_store_dwordx2 v[72:73], v14, s[32:35], s38 offen sc1
    s_mov_b64 exec, -1
    v_cvt_pk_bf16_f32 v8, 0, v7
    v_or_b32 v195, v8, v200
    v_or_b32 v199, v8, v200
    v_cvt_pk_bf16_f32 v192, v16, v17
    v_cvt_pk_bf16_f32 v193, v18, v19
    v_cvt_pk_bf16_f32 v194, v20, v21
    buffer_store_dwordx4 v[192:195], v12, s[32:35], s49 offen sc1
    v_cvt_pk_bf16_f32 v196, v22, v23
    v_cvt_pk_bf16_f32 v197, v24, v25
    v_cvt_pk_bf16_f32 v198, v26, v27
    buffer_store_dwordx4 v[196:199], v12, s[32:35], s49 offen offset:1024 sc1
    s_nop 1
    s_branch L_aend
L_exit:
    s_endpgm
L_code_end:
.section .rodata,"a"
.p2align 6
.amdhsa_kernel standalone__detection_seg_dino__vision_kernel
  .amdhsa_next_free_vgpr 256
  .amdhsa_next_free_sgpr 96
  .amdhsa_accum_offset 256
  .amdhsa_group_segment_fixed_size 0
  .amdhsa_kernarg_size 80
  .amdhsa_user_sgpr_count 2
  .amdhsa_user_sgpr_kernarg_segment_ptr 1
  .amdhsa_system_sgpr_workgroup_id_x 1
  .amdhsa_float_denorm_mode_32 3
.end_amdhsa_kernel
```
